```python
import torch

def _softmax(x, axis=-1):
    return torch.softmax(x, dim=axis)

def _gelu(x):
    return torch.nn.functional.gelu(x, approximate='tanh')

def _silu(x):
    return torch.nn.functional.silu(x)

def _sigmoid(x):
    return torch.sigmoid(x)

def _layernorm(x, axis=-1, eps=1e-05):
    m = x.mean(dim=axis, keepdim=True)
    v = x.var(dim=axis, keepdim=True, unbiased=False)
    return (x - m) / torch.sqrt(v + eps)

def _scatter_add(tgt, idx, src, axis=0):
    return tgt.clone().index_add_(axis, idx, src)

def _segment_sum(src, seg, n):
    out = torch.zeros((n,) + src.shape[1:], dtype=src.dtype)
    return out.index_add_(0, seg, src)

def _pad(x, pw):
    flat = tuple((v for pair in reversed(pw) for v in pair))
    return torch.nn.functional.pad(x, flat)
kernel_name = 'adaLN_cond__ssm_conv_s4d__moe_arch_mod__prompt'

def setup_inputs():

    _w = lambda a: (lambda t: t.to(torch.bfloat16) if t.is_floating_point() else t)(torch.as_tensor(a))

    def _A_setup():
        Bsz, L, D, N = (1, 2048, 576, 128)
        return {'u': _w((lambda *s: torch.randn(*s, dtype=torch.bfloat16) * 0.1)(Bsz, L, D)), 'log_A_real': _w((lambda *s: torch.randn(*s, dtype=torch.bfloat16) * 3.2)(D, N) * 0.5), 'A_imag': _w((lambda *s: torch.randn(*s, dtype=torch.bfloat16) * 0.4)(D, N) * 3.14), 'C_real': _w((lambda *s: torch.randn(*s, dtype=torch.bfloat16) * 0.8)(D, N) / N ** 0.5), 'C_imag': _w((lambda *s: torch.randn(*s, dtype=torch.bfloat16) * 0.8)(D, N) / N ** 0.5), 'log_dt': _w((lambda *s: torch.randn(*s, dtype=torch.bfloat16) * 0.4)(D) * 0.5 - 4.0), 'D_skip': _w((lambda *s: torch.randn(*s, dtype=torch.bfloat16) * 0.4)(D))}
    _A_in = _A_setup()

    def _B_setup():
        B, S, D, F, C = (1, 2048, 576, 4608, 8)
        return {'x': _w((lambda *s: torch.randn(*s, dtype=torch.bfloat16) * 0.1)(B, S, D)), 'w_r': _w((lambda *s: torch.randn(*s, dtype=torch.bfloat16) * 0.4)(D)), 'w_gate': _w((lambda *s: torch.randn(*s, dtype=torch.bfloat16) * 0.4)(D, F)), 'w_up': _w((lambda *s: torch.randn(*s, dtype=torch.bfloat16) * 0.4)(D, F)), 'w_down': _w((lambda *s: torch.randn(*s, dtype=torch.bfloat16) * 0.4)(F, D))}
    _B_in = _B_setup()
    return {'A_u': _A_in['u'], 'A_log_A_real': _A_in['log_A_real'], 'A_A_imag': _A_in['A_imag'], 'A_C_real': _A_in['C_real'], 'A_C_imag': _A_in['C_imag'], 'A_log_dt': _A_in['log_dt'], 'A_D_skip': _A_in['D_skip'], 'B_x': _B_in['x'], 'B_w_r': _B_in['w_r'], 'B_w_gate': _B_in['w_gate'], 'B_w_up': _B_in['w_up'], 'B_w_down': _B_in['w_down'], 'c': _w((lambda *s: torch.randn(*s, dtype=torch.bfloat16) * 0.2)(1, 576) * 8.0), 'w_mod': _w((lambda *s: torch.randn(*s, dtype=torch.bfloat16) * 0.2)(576, 6 * 576) * 576 ** (-0.5) * 8.0)}

def reference(A_u, A_log_A_real, A_A_imag, A_C_real, A_C_imag, A_log_dt, A_D_skip, B_x, B_w_r, B_w_gate, B_w_up, B_w_down, c, w_mod):

    def _A_ref(u, log_A_real, A_imag, C_real, C_imag, log_dt, D_skip):
        L = u.shape[1]
        dt = torch.exp(log_dt)
        A = -torch.exp(log_A_real) + 1j * A_imag
        C = (C_real + 1j * C_imag) * dt[:, None]
        pos = (lambda x, dt: x.to(dt))(torch.arange(L), log_dt.dtype)
        P = torch.exp((A * dt[:, None])[:, :, None] * pos[None, None, :])
        K = 2.0 * torch.einsum('dn,dnl->dl', C, P).real
        L2 = 2 * L
        u_t = (lambda x, *d: x.permute(*d))(u, 0, 2, 1)
        Kf = (lambda x, *a, **k: torch.fft.rfft(x.float(), *a, **k))(K, L2)
        Uf = (lambda x, *a, **k: torch.fft.rfft(x.float(), *a, **k))(u_t, L2)
        y = (lambda x, *a, **k: torch.fft.irfft(x, *a, **k).to(torch.bfloat16))(Uf * Kf[None, :, :], L2)[:, :, :L]
        y = (lambda x, *d: x.permute(*d))(y, 0, 2, 1)
        return y + u * D_skip[None, None, :]

    def _B_ref(x, w_r, w_gate, w_up, w_down):
        B, S, D = x.shape
        C = 8
        r = x @ w_r
        idx = torch.argsort(-r, axis=-1)[:, :C]
        idx_e = (lambda x, n, axis: torch.repeat_interleave(x, n, dim=axis))(idx.reshape(B, C, 1), D, axis=2)
        x_sel = (lambda x, i, axis: torch.take_along_dim(x, i, dim=axis))(x, idx_e, axis=1)
        g = _silu(x_sel @ w_gate)
        u = x_sel @ w_up
        y = g * u @ w_down
        r_sel = _sigmoid((lambda x, i, axis: torch.take_along_dim(x, i, dim=axis))(r, idx, axis=1))
        y = y * r_sel.reshape(B, C, 1)
        b_off = (torch.arange(B) * S).reshape(B, 1)
        flat_idx = (idx + b_off).reshape(B * C)
        zero = (x * 0.0).reshape(B * S, D)
        upd = _scatter_add(zero, flat_idx, y.reshape(B * C, D), axis=0)
        return x + upd.reshape(B, S, D)
    x = A_u
    mod = (_silu(c) @ w_mod).reshape(c.shape[0], 6, 1, -1)
    sa, ca, ga, sb, cb, gb = (mod[:, 0].clone(), mod[:, 1].clone(), mod[:, 2].clone(), mod[:, 3].clone(), mod[:, 4].clone(), mod[:, 5].clone())
    h = _layernorm(x, axis=-1) * (1 + ca) + sa
    x = x + ga * _A_ref(h, A_log_A_real, A_A_imag, A_C_real, A_C_imag, A_log_dt, A_D_skip)
    h = _layernorm(x, axis=-1) * (1 + cb) + sb
    x = x + gb * _B_ref(h, B_w_r, B_w_gate, B_w_up, B_w_down)
    return x
```

```asm
; @launch grid=(256,1,1) block=(512,1,1) lds=144896
.amdgcn_target "amdgcn-amd-amdhsa--gfx950"
.text
.globl adaLN_cond__ssm_conv_s4d__moe_arch_mod__prompt_kernel
.p2align 8
.type adaLN_cond__ssm_conv_s4d__moe_arch_mod__prompt_kernel,@function
adaLN_cond__ssm_conv_s4d__moe_arch_mod__prompt_kernel:
    s_cmp_ge_u32 s2, 256
    s_cbranch_scc1 EXIT
    s_load_dwordx16 s[36:51], s[0:1], 0
    s_load_dwordx16 s[52:67], s[0:1], 64
    s_load_dwordx2 s[68:69], s[0:1], 128
    v_lshrrev_b32 v2, 6, v0
    v_and_b32 v1, 63, v0
    v_readfirstlane_b32 s3, v2
    s_and_b32 s4, s2, 7
    s_lshr_b32 s5, s2, 3
    s_mul_i32 s6, s4, 18
    s_add_u32 s6, s6, s5
    s_sub_u32 s8, s6, 14
    s_mul_i32 s7, s4, 14
    s_add_u32 s7, s7, s5
    s_sub_u32 s7, s7, 18
    s_and_b32 s9, s3, 3
    s_mov_b32 s10, 0x20000
    s_mov_b32 s12, 0xffff0000
    s_lshl_b32 s11, s2, 3
    s_add_u32 s11, s11, s3
    v_lshlrev_b32 v7, 4, v1
    v_lshlrev_b32 v13, 1, v1
    v_add_u32 v13, 1024, v13
    s_cmp_ge_u32 s5, 18
    s_cbranch_scc1 NONCONV
    s_cmp_ge_u32 s3, 4
    s_cbranch_scc1 CONV_B
    s_lshl_b32 s20, s6, 2
    s_add_u32 s20, s20, s3
    s_lshl_b32 s21, s20, 8
    v_lshl_add_u32 v64, v1, 2, s21
    s_lshl_b32 s14, s20, 1
    v_mov_b32 v65, s14
    s_mul_i32 s15, s3, 31232
    s_waitcnt lgkmcnt(0)
    global_load_ushort v70, v65, s[46:47]
    global_load_dword v66, v64, s[38:39]
    global_load_dword v67, v64, s[40:41]
    global_load_dword v68, v64, s[42:43]
    global_load_dword v69, v64, s[44:45]
    global_load_ushort v71, v65, s[48:49]
    s_mul_i32 s20, s11, 1152
    v_add_u32 v52, s20, v7
    v_add_u32 v53, s20, v13
    global_load_dwordx4 v[2:5], v52, s[36:37]
    global_load_ushort v6, v53, s[36:37]
    global_load_dwordx4 v[8:11], v7, s[52:53]
    global_load_ushort v12, v13, s[52:53]
    v_lshl_add_u32 v224, v1, 3, s15
    v_bfe_u32 v72, v1, 2, 3
    v_mov_b32 v73, 0
    v_cmp_eq_u32 vcc, 0, v72
    v_mov_b32 v74, 0x3020100
    s_nop 0
    v_cndmask_b32 v73, v73, v74, vcc
    v_cmp_eq_u32 vcc, 1, v72
    v_mov_b32 v74, 0x6050404
    s_nop 0
    v_cndmask_b32 v73, v73, v74, vcc
    v_cmp_eq_u32 vcc, 2, v72
    v_mov_b32 v74, 0xa090807
    s_nop 0
    v_cndmask_b32 v73, v73, v74, vcc
    v_cmp_eq_u32 vcc, 3, v72
    v_mov_b32 v74, 0xc0b0606
    s_nop 0
    v_cndmask_b32 v73, v73, v74, vcc
    v_cmp_eq_u32 vcc, 4, v72
    v_mov_b32 v74, 0xf0f0e0d
    s_nop 0
    v_cndmask_b32 v73, v73, v74, vcc
    v_cmp_eq_u32 vcc, 5, v72
    v_mov_b32 v74, 0x12121110
    s_nop 0
    v_cndmask_b32 v73, v73, v74, vcc
    v_cmp_eq_u32 vcc, 6, v72
    v_mov_b32 v74, 0x16151413
    s_nop 0
    v_cndmask_b32 v73, v73, v74, vcc
    v_cmp_eq_u32 vcc, 7, v72
    v_mov_b32 v74, 0x1a191817
    s_nop 0
    v_cndmask_b32 v73, v73, v74, vcc
    v_and_b32 v72, 3, v1
    v_lshlrev_b32 v72, 3, v72
    v_bfe_u32 v73, v73, v72, 8
    v_lshrrev_b32 v72, 5, v1
    v_lshl_add_u32 v72, v72, 4, s15
    s_movk_i32 s20, 528
    v_mad_u32_u24 v225, v73, s20, v72
    v_and_b32 v73, 31, v1
    v_add_u32 v73, 27, v73
    v_mad_u32_u24 v226, v73, s20, v72
    v_lshlrev_b32 v72, 4, v1
    v_sub_u32 v227, 1008, v72
    v_add_u32 v227, s15, v227
    v_and_b32 v72, 3, v1
    v_sub_u32 v72, 3, v72
    s_movk_i32 s20, 4160
    v_mul_u32_u24 v72, s20, v72
    v_bfe_u32 v73, v1, 2, 2
    v_sub_u32 v73, 3, v73
    v_lshl_add_u32 v72, v73, 3, v72
    v_lshrrev_b32 v73, 4, v1
    v_lshl_add_u32 v72, v73, 4, v72
    v_add_u32 v228, s15, v72
    v_and_b32 v72, 15, v1
    v_lshlrev_b32 v72, 5, v72
    v_lshl_add_u32 v74, v73, 4, v72
    s_mul_i32 s20, s3, 4608
    s_add_u32 s20, s20, 124928
    v_add_u32 v229, s20, v74
    v_lshl_add_u32 v74, v73, 3, v72
    s_lshl_b32 s20, s3, 6
    s_add_u32 s20, s20, s15
    v_add_u32 v230, s20, v74
    s_mov_b32 s16, 0x3fb8aa3b
    s_mov_b32 s17, 0x3e22f983
    s_waitcnt vmcnt(8)
    v_lshlrev_b32 v70, 16, v70
    v_mul_f32 v70, s16, v70
    v_exp_f32 v70, v70
    v_lshlrev_b32 v74, 16, v66
    v_and_b32 v75, s12, v66
    v_mul_f32 v74, s16, v74
    v_mul_f32 v75, s16, v75
    v_exp_f32 v74, v74
    v_exp_f32 v75, v75
    v_cvt_pk_bf16_f32 v70, v70, v70
    v_and_b32 v70, s12, v70
    v_cvt_pk_bf16_f32 v74, v74, v75
    v_and_b32 v75, s12, v74
    v_lshlrev_b32 v74, 16, v74
    v_mul_f32 v74, v74, v70
    v_mul_f32 v75, v75, v70
    v_mul_f32 v74, 0xbfb8aa3b, v74
    v_mul_f32 v75, 0xbfb8aa3b, v75
    s_waitcnt vmcnt(7)
    v_lshlrev_b32 v76, 16, v67
    v_and_b32 v77, s12, v67
    v_mul_f32 v76, v76, v70
    v_mul_f32 v77, v77, v70
    v_mul_f32 v76, s17, v76
    v_mul_f32 v77, s17, v77
    v_exp_f32 v96, v74
    v_fract_f32 v97, v76
    v_cos_f32 v98, v97
    v_sin_f32 v99, v97
    v_exp_f32 v100, v75
    v_fract_f32 v101, v77
    v_cos_f32 v102, v101
    v_sin_f32 v103, v101
    v_mul_f32 v84, v96, v98
    v_mul_f32 v86, v96, v99
    v_mul_f32 v85, v100, v102
    v_mul_f32 v87, v100, v103
    v_mul_f32 v96, 0x41000000, v74
    v_mul_f32 v97, 0x41000000, v76
    v_exp_f32 v96, v96
    v_fract_f32 v97, v97
    v_cos_f32 v98, v97
    v_sin_f32 v99, v97
    v_mul_f32 v100, 0x41000000, v75
    v_mul_f32 v101, 0x41000000, v77
    v_exp_f32 v100, v100
    v_fract_f32 v101, v101
    v_cos_f32 v102, v101
    v_sin_f32 v103, v101
    v_mul_f32 v88, v96, v98
    v_mul_f32 v90, v96, v99
    v_mul_f32 v89, v100, v102
    v_mul_f32 v91, v100, v103
    v_mul_f32 v96, 0x43800000, v74
    v_mul_f32 v97, 0x43800000, v76
    v_exp_f32 v96, v96
    v_fract_f32 v97, v97
    v_cos_f32 v98, v97
    v_sin_f32 v99, v97
    v_mul_f32 v100, 0x43800000, v75
    v_mul_f32 v101, 0x43800000, v77
    v_exp_f32 v100, v100
    v_fract_f32 v101, v101
    v_cos_f32 v102, v101
    v_sin_f32 v103, v101
    v_mul_f32 v92, v96, v98
    v_mul_f32 v94, v96, v99
    v_mul_f32 v93, v100, v102
    v_mul_f32 v95, v100, v103
    s_waitcnt vmcnt(4)
    v_lshlrev_b32 v78, 16, v68
    v_and_b32 v79, s12, v68
    v_lshlrev_b32 v80, 16, v69
    v_and_b32 v81, s12, v69
    v_max_f32 v82, |v78|, |v79|
    v_max3_f32 v82, |v80|, |v81|, v82
    s_nop 1
    v_max_f32_dpp v82, v82, v82 row_ror:8 row_mask:0xf bank_mask:0xf
    s_nop 1
    v_max_f32_dpp v82, v82, v82 row_ror:4 row_mask:0xf bank_mask:0xf
    s_nop 1
    v_max_f32_dpp v82, v82, v82 row_ror:2 row_mask:0xf bank_mask:0xf
    s_nop 1
    v_max_f32_dpp v82, v82, v82 row_ror:1 row_mask:0xf bank_mask:0xf
    v_mov_b32 v83, v82
    s_nop 1
    v_permlane16_swap_b32 v82, v83
    v_max_f32 v82, v82, v83
    v_mov_b32 v83, v82
    s_nop 1
    v_permlane32_swap_b32 v82, v83
    v_max_f32 v82, v82, v83
    v_max_f32 v82, 0x0da24260, v82
    v_rcp_f32 v83, v82
    v_lshlrev_b32 v71, 16, v71
    v_mul_f32 v82, v82, v70
    v_add_f32 v82, v82, v82
    v_and_b32 v72, 0x7fffffff, v71
    v_mul_f32 v72, 0x3a800000, v72
    v_max_f32 v72, v72, v82
    v_max_f32 v72, 0x0da24260, v72
    v_rcp_f32 v73, v72
    v_mov_b32 v233, v72
    v_mul_f32 v231, v82, v73
    v_mul_f32 v232, v71, v73
    v_pk_mul_f32 v[104:105], v[78:79], v[82:83] op_sel:[0,1] op_sel_hi:[1,1]
    v_pk_mul_f32 v[106:107], v[80:81], v[82:83] op_sel:[0,1] op_sel_hi:[1,1]
    v_mov_b32 v148, 0x3c00
    v_cvt_pk_f16_f32 v144, v104, v106
    v_mov_b32 v149, 0x3c00
    v_cvt_pk_f16_f32 v145, v105, v107
    ds_write_b64 v224, v[148:149] offset:14256
    ds_write_b64 v224, v[144:145] offset:0
    v_pk_mul_f32 v[128:129], v[88:89], 1.0 op_sel_hi:[1,0]
    v_pk_mul_f32 v[136:137], v[106:107], v[86:87]
    v_pk_mul_f32 v[130:131], v[90:91], -1.0 op_sel_hi:[1,0]
    v_pk_mul_f32 v[138:139], v[106:107], v[84:85]
    v_cvt_pk_f16_f32 v150, v128, v130
    v_pk_fma_f32 v[126:127], v[104:105], v[86:87], v[138:139]
    v_cvt_pk_f16_f32 v151, v129, v131
    v_pk_fma_f32 v[124:125], v[104:105], v[84:85], v[136:137] neg_lo:[0,0,1] neg_hi:[0,0,1]
    ds_write_b64 v224, v[150:151] offset:14784
    v_cvt_pk_f16_f32 v146, v124, v126
    v_pk_mul_f32 v[140:141], v[130:131], v[90:91]
    v_cvt_pk_f16_f32 v147, v125, v127
    v_pk_mul_f32 v[142:143], v[130:131], v[88:89]
    ds_write_b64 v224, v[146:147] offset:528
    v_pk_fma_f32 v[130:131], v[128:129], v[90:91], v[142:143] neg_lo:[0,1,0] neg_hi:[0,1,0]
    v_pk_mul_f32 v[136:137], v[126:127], v[86:87]
    v_pk_fma_f32 v[128:129], v[128:129], v[88:89], v[140:141]
    v_pk_mul_f32 v[138:139], v[126:127], v[84:85]
    v_cvt_pk_f16_f32 v148, v128, v130
    v_pk_fma_f32 v[110:111], v[124:125], v[86:87], v[138:139]
    v_cvt_pk_f16_f32 v149, v129, v131
    v_pk_fma_f32 v[108:109], v[124:125], v[84:85], v[136:137] neg_lo:[0,0,1] neg_hi:[0,0,1]
    ds_write_b64 v224, v[148:149] offset:15312
    v_cvt_pk_f16_f32 v144, v108, v110
    v_pk_mul_f32 v[140:141], v[130:131], v[90:91]
    v_cvt_pk_f16_f32 v145, v109, v111
    v_pk_mul_f32 v[142:143], v[130:131], v[88:89]
    ds_write_b64 v224, v[144:145] offset:1056
    v_pk_fma_f32 v[130:131], v[128:129], v[90:91], v[142:143] neg_lo:[0,1,0] neg_hi:[0,1,0]
    v_pk_mul_f32 v[136:137], v[110:111], v[86:87]
    v_pk_fma_f32 v[128:129], v[128:129], v[88:89], v[140:141]
    v_pk_mul_f32 v[138:139], v[110:111], v[84:85]
    v_cvt_pk_f16_f32 v150, v128, v130
    v_pk_fma_f32 v[126:127], v[108:109], v[86:87], v[138:139]
    v_cvt_pk_f16_f32 v151, v129, v131
    v_pk_fma_f32 v[124:125], v[108:109], v[84:85], v[136:137] neg_lo:[0,0,1] neg_hi:[0,0,1]
    ds_write_b64 v224, v[150:151] offset:15840
    v_cvt_pk_f16_f32 v146, v124, v126
    v_pk_mul_f32 v[140:141], v[130:131], v[90:91]
    v_cvt_pk_f16_f32 v147, v125, v127
    v_pk_mul_f32 v[142:143], v[130:131], v[88:89]
    ds_write_b64 v224, v[146:147] offset:1584
    v_pk_fma_f32 v[130:131], v[128:129], v[90:91], v[142:143] neg_lo:[0,1,0] neg_hi:[0,1,0]
    v_pk_mul_f32 v[136:137], v[126:127], v[86:87]
    v_pk_fma_f32 v[128:129], v[128:129], v[88:89], v[140:141]
    v_pk_mul_f32 v[138:139], v[126:127], v[84:85]
    v_cvt_pk_f16_f32 v148, v128, v130
    v_pk_fma_f32 v[114:115], v[124:125], v[86:87], v[138:139]
    v_cvt_pk_f16_f32 v149, v129, v131
    v_pk_fma_f32 v[112:113], v[124:125], v[84:85], v[136:137] neg_lo:[0,0,1] neg_hi:[0,0,1]
    ds_write_b64 v224, v[148:149] offset:16368
    v_cvt_pk_f16_f32 v144, v112, v114
    v_pk_mul_f32 v[140:141], v[130:131], v[90:91]
    v_cvt_pk_f16_f32 v145, v113, v115
    v_pk_mul_f32 v[142:143], v[130:131], v[88:89]
    ds_write_b64 v224, v[144:145] offset:3696
    v_pk_fma_f32 v[130:131], v[128:129], v[90:91], v[142:143] neg_lo:[0,1,0] neg_hi:[0,1,0]
    v_pk_mul_f32 v[136:137], v[114:115], v[86:87]
    v_pk_fma_f32 v[128:129], v[128:129], v[88:89], v[140:141]
    v_pk_mul_f32 v[138:139], v[114:115], v[84:85]
    v_cvt_pk_f16_f32 v150, v128, v130
    v_pk_fma_f32 v[126:127], v[112:113], v[86:87], v[138:139]
    v_cvt_pk_f16_f32 v151, v129, v131
    v_pk_fma_f32 v[124:125], v[112:113], v[84:85], v[136:137] neg_lo:[0,0,1] neg_hi:[0,0,1]
    ds_write_b64 v224, v[150:151] offset:16896
    v_cvt_pk_f16_f32 v146, v124, v126
    v_pk_mul_f32 v[140:141], v[130:131], v[90:91]
    v_cvt_pk_f16_f32 v147, v125, v127
    v_pk_mul_f32 v[142:143], v[130:131], v[88:89]
    ds_write_b64 v224, v[146:147] offset:4224
    v_pk_fma_f32 v[130:131], v[128:129], v[90:91], v[142:143] neg_lo:[0,1,0] neg_hi:[0,1,0]
    v_pk_mul_f32 v[136:137], v[126:127], v[86:87]
    v_pk_fma_f32 v[128:129], v[128:129], v[88:89], v[140:141]
    v_pk_mul_f32 v[138:139], v[126:127], v[84:85]
    v_cvt_pk_f16_f32 v148, v128, v130
    v_pk_fma_f32 v[118:119], v[124:125], v[86:87], v[138:139]
    v_cvt_pk_f16_f32 v149, v129, v131
    v_pk_fma_f32 v[116:117], v[124:125], v[84:85], v[136:137] neg_lo:[0,0,1] neg_hi:[0,0,1]
    ds_write_b64 v224, v[148:149] offset:17424
    v_cvt_pk_f16_f32 v144, v116, v118
    v_pk_mul_f32 v[140:141], v[130:131], v[90:91]
    v_cvt_pk_f16_f32 v145, v117, v119
    v_pk_mul_f32 v[142:143], v[130:131], v[88:89]
    ds_write_b64 v224, v[144:145] offset:4752
    v_pk_fma_f32 v[130:131], v[128:129], v[90:91], v[142:143] neg_lo:[0,1,0] neg_hi:[0,1,0]
    v_pk_mul_f32 v[136:137], v[118:119], v[86:87]
    v_pk_fma_f32 v[128:129], v[128:129], v[88:89], v[140:141]
    v_pk_mul_f32 v[138:139], v[118:119], v[84:85]
    v_cvt_pk_f16_f32 v150, v128, v130
    v_pk_fma_f32 v[126:127], v[116:117], v[86:87], v[138:139]
    v_cvt_pk_f16_f32 v151, v129, v131
    v_pk_fma_f32 v[124:125], v[116:117], v[84:85], v[136:137] neg_lo:[0,0,1] neg_hi:[0,0,1]
    ds_write_b64 v224, v[150:151] offset:17952
    v_cvt_pk_f16_f32 v146, v124, v126
    v_pk_mul_f32 v[140:141], v[130:131], v[90:91]
    v_cvt_pk_f16_f32 v147, v125, v127
    v_pk_mul_f32 v[142:143], v[130:131], v[88:89]
    ds_write_b64 v224, v[146:147] offset:5280
    v_pk_fma_f32 v[130:131], v[128:129], v[90:91], v[142:143] neg_lo:[0,1,0] neg_hi:[0,1,0]
    v_pk_mul_f32 v[136:137], v[126:127], v[86:87]
    v_pk_fma_f32 v[128:129], v[128:129], v[88:89], v[140:141]
    v_pk_mul_f32 v[138:139], v[126:127], v[84:85]
    v_cvt_pk_f16_f32 v148, v128, v130
    v_pk_fma_f32 v[122:123], v[124:125], v[86:87], v[138:139]
    v_cvt_pk_f16_f32 v149, v129, v131
    v_pk_fma_f32 v[120:121], v[124:125], v[84:85], v[136:137] neg_lo:[0,0,1] neg_hi:[0,0,1]
    ds_write_b64 v224, v[148:149] offset:18480
    v_pk_mul_f32 v[136:137], v[106:107], v[94:95]
    v_pk_mul_f32 v[140:141], v[130:131], v[90:91]
    v_pk_mul_f32 v[138:139], v[106:107], v[92:93]
    v_pk_mul_f32 v[142:143], v[130:131], v[88:89]
    v_pk_fma_f32 v[106:107], v[104:105], v[94:95], v[138:139]
    v_pk_fma_f32 v[130:131], v[128:129], v[90:91], v[142:143] neg_lo:[0,1,0] neg_hi:[0,1,0]
    v_pk_fma_f32 v[104:105], v[104:105], v[92:93], v[136:137] neg_lo:[0,0,1] neg_hi:[0,0,1]
    v_pk_fma_f32 v[128:129], v[128:129], v[88:89], v[140:141]
    v_cvt_pk_f16_f32 v146, v104, v106
    v_cvt_pk_f16_f32 v150, v128, v130
    v_cvt_pk_f16_f32 v147, v105, v107
    v_cvt_pk_f16_f32 v151, v129, v131
    ds_write_b64 v224, v[146:147] offset:2112
    ds_write_b64 v224, v[150:151] offset:19008
    v_pk_mul_f32 v[136:137], v[110:111], v[94:95]
    v_pk_mul_f32 v[140:141], v[130:131], v[90:91]
    v_pk_mul_f32 v[138:139], v[110:111], v[92:93]
    v_pk_mul_f32 v[142:143], v[130:131], v[88:89]
    v_pk_fma_f32 v[110:111], v[108:109], v[94:95], v[138:139]
    v_pk_fma_f32 v[130:131], v[128:129], v[90:91], v[142:143] neg_lo:[0,1,0] neg_hi:[0,1,0]
    v_pk_fma_f32 v[108:109], v[108:109], v[92:93], v[136:137] neg_lo:[0,0,1] neg_hi:[0,0,1]
    v_pk_fma_f32 v[128:129], v[128:129], v[88:89], v[140:141]
    v_cvt_pk_f16_f32 v144, v108, v110
    v_cvt_pk_f16_f32 v148, v128, v130
    v_cvt_pk_f16_f32 v145, v109, v111
    v_cvt_pk_f16_f32 v149, v129, v131
    ds_write_b64 v224, v[144:145] offset:2640
    ds_write_b64 v224, v[148:149] offset:19536
    v_pk_mul_f32 v[136:137], v[114:115], v[94:95]
    v_pk_mul_f32 v[140:141], v[130:131], v[90:91]
    v_pk_mul_f32 v[138:139], v[114:115], v[92:93]
    v_pk_mul_f32 v[142:143], v[130:131], v[88:89]
    v_pk_fma_f32 v[114:115], v[112:113], v[94:95], v[138:139]
    v_pk_fma_f32 v[130:131], v[128:129], v[90:91], v[142:143] neg_lo:[0,1,0] neg_hi:[0,1,0]
    v_pk_fma_f32 v[112:113], v[112:113], v[92:93], v[136:137] neg_lo:[0,0,1] neg_hi:[0,0,1]
    v_pk_fma_f32 v[128:129], v[128:129], v[88:89], v[140:141]
    v_cvt_pk_f16_f32 v146, v112, v114
    v_cvt_pk_f16_f32 v150, v128, v130
    v_cvt_pk_f16_f32 v147, v113, v115
    v_cvt_pk_f16_f32 v151, v129, v131
    ds_write_b64 v224, v[146:147] offset:3168
    ds_write_b64 v224, v[150:151] offset:20064
    v_pk_mul_f32 v[136:137], v[118:119], v[94:95]
    v_pk_mul_f32 v[140:141], v[130:131], v[90:91]
    v_pk_mul_f32 v[138:139], v[118:119], v[92:93]
    v_pk_mul_f32 v[142:143], v[130:131], v[88:89]
    v_pk_fma_f32 v[118:119], v[116:117], v[94:95], v[138:139]
    v_pk_fma_f32 v[130:131], v[128:129], v[90:91], v[142:143] neg_lo:[0,1,0] neg_hi:[0,1,0]
    v_pk_fma_f32 v[116:117], v[116:117], v[92:93], v[136:137] neg_lo:[0,0,1] neg_hi:[0,0,1]
    v_pk_fma_f32 v[128:129], v[128:129], v[88:89], v[140:141]
    v_cvt_pk_f16_f32 v144, v116, v118
    v_cvt_pk_f16_f32 v148, v128, v130
    v_cvt_pk_f16_f32 v145, v117, v119
    v_cvt_pk_f16_f32 v149, v129, v131
    ds_write_b64 v224, v[144:145] offset:5808
    ds_write_b64 v224, v[148:149] offset:20592
    v_pk_mul_f32 v[136:137], v[122:123], v[94:95]
    v_pk_mul_f32 v[140:141], v[130:131], v[90:91]
    v_pk_mul_f32 v[138:139], v[122:123], v[92:93]
    v_pk_mul_f32 v[142:143], v[130:131], v[88:89]
    v_pk_fma_f32 v[122:123], v[120:121], v[94:95], v[138:139]
    v_pk_fma_f32 v[130:131], v[128:129], v[90:91], v[142:143] neg_lo:[0,1,0] neg_hi:[0,1,0]
    v_pk_fma_f32 v[120:121], v[120:121], v[92:93], v[136:137] neg_lo:[0,0,1] neg_hi:[0,0,1]
    v_pk_fma_f32 v[128:129], v[128:129], v[88:89], v[140:141]
    v_cvt_pk_f16_f32 v146, v120, v122
    v_cvt_pk_f16_f32 v150, v128, v130
    v_cvt_pk_f16_f32 v147, v121, v123
    v_cvt_pk_f16_f32 v151, v129, v131
    ds_write_b64 v224, v[146:147] offset:6336
    ds_write_b64 v224, v[150:151] offset:21120
    v_pk_mul_f32 v[136:137], v[106:107], v[94:95]
    v_pk_mul_f32 v[140:141], v[130:131], v[90:91]
    v_pk_mul_f32 v[138:139], v[106:107], v[92:93]
    v_pk_mul_f32 v[142:143], v[130:131], v[88:89]
    v_pk_fma_f32 v[106:107], v[104:105], v[94:95], v[138:139]
    v_pk_fma_f32 v[130:131], v[128:129], v[90:91], v[142:143] neg_lo:[0,1,0] neg_hi:[0,1,0]
    v_pk_fma_f32 v[104:105], v[104:105], v[92:93], v[136:137] neg_lo:[0,0,1] neg_hi:[0,0,1]
    v_pk_fma_f32 v[128:129], v[128:129], v[88:89], v[140:141]
    v_cvt_pk_f16_f32 v144, v104, v106
    v_cvt_pk_f16_f32 v148, v128, v130
    v_cvt_pk_f16_f32 v145, v105, v107
    v_cvt_pk_f16_f32 v149, v129, v131
    ds_write_b64 v224, v[144:145] offset:6864
    ds_write_b64 v224, v[148:149] offset:21648
    v_pk_mul_f32 v[136:137], v[114:115], v[94:95]
    v_pk_mul_f32 v[140:141], v[130:131], v[90:91]
    v_pk_mul_f32 v[138:139], v[114:115], v[92:93]
    v_pk_mul_f32 v[142:143], v[130:131], v[88:89]
    v_pk_fma_f32 v[114:115], v[112:113], v[94:95], v[138:139]
    v_pk_fma_f32 v[130:131], v[128:129], v[90:91], v[142:143] neg_lo:[0,1,0] neg_hi:[0,1,0]
    v_pk_fma_f32 v[112:113], v[112:113], v[92:93], v[136:137] neg_lo:[0,0,1] neg_hi:[0,0,1]
    v_pk_fma_f32 v[128:129], v[128:129], v[88:89], v[140:141]
    v_cvt_pk_f16_f32 v146, v112, v114
    v_cvt_pk_f16_f32 v150, v128, v130
    v_cvt_pk_f16_f32 v147, v113, v115
    v_cvt_pk_f16_f32 v151, v129, v131
    ds_write_b64 v224, v[146:147] offset:7392
    ds_write_b64 v224, v[150:151] offset:22176
    v_pk_mul_f32 v[136:137], v[122:123], v[94:95]
    v_pk_mul_f32 v[140:141], v[130:131], v[90:91]
    v_pk_mul_f32 v[138:139], v[122:123], v[92:93]
    v_pk_mul_f32 v[142:143], v[130:131], v[88:89]
    v_pk_fma_f32 v[122:123], v[120:121], v[94:95], v[138:139]
    v_pk_fma_f32 v[130:131], v[128:129], v[90:91], v[142:143] neg_lo:[0,1,0] neg_hi:[0,1,0]
    v_pk_fma_f32 v[120:121], v[120:121], v[92:93], v[136:137] neg_lo:[0,0,1] neg_hi:[0,0,1]
    v_pk_fma_f32 v[128:129], v[128:129], v[88:89], v[140:141]
    v_cvt_pk_f16_f32 v144, v120, v122
    v_cvt_pk_f16_f32 v148, v128, v130
    v_cvt_pk_f16_f32 v145, v121, v123
    v_cvt_pk_f16_f32 v149, v129, v131
    ds_write_b64 v224, v[144:145] offset:7920
    ds_write_b64 v224, v[148:149] offset:22704
    v_pk_mul_f32 v[136:137], v[106:107], v[94:95]
    v_pk_mul_f32 v[140:141], v[130:131], v[90:91]
    v_pk_mul_f32 v[138:139], v[106:107], v[92:93]
    v_pk_mul_f32 v[142:143], v[130:131], v[88:89]
    v_pk_fma_f32 v[106:107], v[104:105], v[94:95], v[138:139]
    v_pk_fma_f32 v[130:131], v[128:129], v[90:91], v[142:143] neg_lo:[0,1,0] neg_hi:[0,1,0]
    v_pk_fma_f32 v[104:105], v[104:105], v[92:93], v[136:137] neg_lo:[0,0,1] neg_hi:[0,0,1]
    v_pk_fma_f32 v[128:129], v[128:129], v[88:89], v[140:141]
    v_cvt_pk_f16_f32 v146, v104, v106
    v_cvt_pk_f16_f32 v150, v128, v130
    v_cvt_pk_f16_f32 v147, v105, v107
    v_cvt_pk_f16_f32 v151, v129, v131
    ds_write_b64 v224, v[146:147] offset:8448
    ds_write_b64 v224, v[150:151] offset:23232
    v_pk_mul_f32 v[136:137], v[114:115], v[94:95]
    v_pk_mul_f32 v[140:141], v[130:131], v[90:91]
    v_pk_mul_f32 v[138:139], v[114:115], v[92:93]
    v_pk_mul_f32 v[142:143], v[130:131], v[88:89]
    v_pk_fma_f32 v[114:115], v[112:113], v[94:95], v[138:139]
    v_pk_fma_f32 v[130:131], v[128:129], v[90:91], v[142:143] neg_lo:[0,1,0] neg_hi:[0,1,0]
    v_pk_fma_f32 v[112:113], v[112:113], v[92:93], v[136:137] neg_lo:[0,0,1] neg_hi:[0,0,1]
    v_pk_fma_f32 v[128:129], v[128:129], v[88:89], v[140:141]
    v_cvt_pk_f16_f32 v144, v112, v114
    v_cvt_pk_f16_f32 v148, v128, v130
    v_cvt_pk_f16_f32 v145, v113, v115
    v_cvt_pk_f16_f32 v149, v129, v131
    ds_write_b64 v224, v[144:145] offset:8976
    ds_write_b64 v224, v[148:149] offset:23760
    v_pk_mul_f32 v[136:137], v[122:123], v[94:95]
    v_pk_mul_f32 v[140:141], v[130:131], v[90:91]
    v_pk_mul_f32 v[138:139], v[122:123], v[92:93]
    v_pk_mul_f32 v[142:143], v[130:131], v[88:89]
    v_pk_fma_f32 v[122:123], v[120:121], v[94:95], v[138:139]
    v_pk_fma_f32 v[130:131], v[128:129], v[90:91], v[142:143] neg_lo:[0,1,0] neg_hi:[0,1,0]
    v_pk_fma_f32 v[120:121], v[120:121], v[92:93], v[136:137] neg_lo:[0,0,1] neg_hi:[0,0,1]
    v_pk_fma_f32 v[128:129], v[128:129], v[88:89], v[140:141]
    v_cvt_pk_f16_f32 v146, v120, v122
    v_cvt_pk_f16_f32 v150, v128, v130
    v_cvt_pk_f16_f32 v147, v121, v123
    v_cvt_pk_f16_f32 v151, v129, v131
    ds_write_b64 v224, v[146:147] offset:9504
    ds_write_b64 v224, v[150:151] offset:24288
    v_pk_mul_f32 v[136:137], v[106:107], v[94:95]
    v_pk_mul_f32 v[140:141], v[130:131], v[90:91]
    v_pk_mul_f32 v[138:139], v[106:107], v[92:93]
    v_pk_mul_f32 v[142:143], v[130:131], v[88:89]
    v_pk_fma_f32 v[106:107], v[104:105], v[94:95], v[138:139]
    v_pk_fma_f32 v[130:131], v[128:129], v[90:91], v[142:143] neg_lo:[0,1,0] neg_hi:[0,1,0]
    v_pk_fma_f32 v[104:105], v[104:105], v[92:93], v[136:137] neg_lo:[0,0,1] neg_hi:[0,0,1]
    v_pk_fma_f32 v[128:129], v[128:129], v[88:89], v[140:141]
    v_cvt_pk_f16_f32 v144, v104, v106
    v_cvt_pk_f16_f32 v148, v128, v130
    v_cvt_pk_f16_f32 v145, v105, v107
    v_cvt_pk_f16_f32 v149, v129, v131
    ds_write_b64 v224, v[144:145] offset:10032
    ds_write_b64 v224, v[148:149] offset:24816
    v_pk_mul_f32 v[136:137], v[122:123], v[94:95]
    v_pk_mul_f32 v[140:141], v[130:131], v[90:91]
    v_pk_mul_f32 v[138:139], v[122:123], v[92:93]
    v_pk_mul_f32 v[142:143], v[130:131], v[88:89]
    v_pk_fma_f32 v[122:123], v[120:121], v[94:95], v[138:139]
    v_pk_fma_f32 v[130:131], v[128:129], v[90:91], v[142:143] neg_lo:[0,1,0] neg_hi:[0,1,0]
    v_pk_fma_f32 v[120:121], v[120:121], v[92:93], v[136:137] neg_lo:[0,0,1] neg_hi:[0,0,1]
    v_pk_fma_f32 v[128:129], v[128:129], v[88:89], v[140:141]
    v_cvt_pk_f16_f32 v146, v120, v122
    v_cvt_pk_f16_f32 v150, v128, v130
    v_cvt_pk_f16_f32 v147, v121, v123
    v_cvt_pk_f16_f32 v151, v129, v131
    ds_write_b64 v224, v[146:147] offset:10560
    ds_write_b64 v224, v[150:151] offset:25344
    v_pk_mul_f32 v[136:137], v[106:107], v[94:95]
    v_pk_mul_f32 v[140:141], v[130:131], v[90:91]
    v_pk_mul_f32 v[138:139], v[106:107], v[92:93]
    v_pk_mul_f32 v[142:143], v[130:131], v[88:89]
    v_pk_fma_f32 v[106:107], v[104:105], v[94:95], v[138:139]
    v_pk_fma_f32 v[130:131], v[128:129], v[90:91], v[142:143] neg_lo:[0,1,0] neg_hi:[0,1,0]
    v_pk_fma_f32 v[104:105], v[104:105], v[92:93], v[136:137] neg_lo:[0,0,1] neg_hi:[0,0,1]
    v_pk_fma_f32 v[128:129], v[128:129], v[88:89], v[140:141]
    v_cvt_pk_f16_f32 v144, v104, v106
    v_cvt_pk_f16_f32 v148, v128, v130
    v_cvt_pk_f16_f32 v145, v105, v107
    v_cvt_pk_f16_f32 v149, v129, v131
    ds_write_b64 v224, v[144:145] offset:12144
    ds_write_b64 v224, v[148:149] offset:25872
    v_pk_mul_f32 v[136:137], v[122:123], v[94:95]
    v_pk_mul_f32 v[140:141], v[130:131], v[90:91]
    v_pk_mul_f32 v[138:139], v[122:123], v[92:93]
    v_pk_mul_f32 v[142:143], v[130:131], v[88:89]
    v_pk_fma_f32 v[122:123], v[120:121], v[94:95], v[138:139]
    v_pk_fma_f32 v[130:131], v[128:129], v[90:91], v[142:143] neg_lo:[0,1,0] neg_hi:[0,1,0]
    v_pk_fma_f32 v[120:121], v[120:121], v[92:93], v[136:137] neg_lo:[0,0,1] neg_hi:[0,0,1]
    v_pk_fma_f32 v[128:129], v[128:129], v[88:89], v[140:141]
    v_cvt_pk_f16_f32 v146, v120, v122
    v_cvt_pk_f16_f32 v150, v128, v130
    v_cvt_pk_f16_f32 v147, v121, v123
    v_cvt_pk_f16_f32 v151, v129, v131
    ds_write_b64 v224, v[146:147] offset:12672
    ds_write_b64 v224, v[150:151] offset:26400
    v_pk_mul_f32 v[136:137], v[106:107], v[94:95]
    v_pk_mul_f32 v[140:141], v[130:131], v[90:91]
    v_pk_mul_f32 v[138:139], v[106:107], v[92:93]
    v_pk_mul_f32 v[142:143], v[130:131], v[88:89]
    v_pk_fma_f32 v[106:107], v[104:105], v[94:95], v[138:139]
    v_pk_fma_f32 v[130:131], v[128:129], v[90:91], v[142:143] neg_lo:[0,1,0] neg_hi:[0,1,0]
    v_pk_fma_f32 v[104:105], v[104:105], v[92:93], v[136:137] neg_lo:[0,0,1] neg_hi:[0,0,1]
    v_pk_fma_f32 v[128:129], v[128:129], v[88:89], v[140:141]
    v_cvt_pk_f16_f32 v144, v104, v106
    v_cvt_pk_f16_f32 v148, v128, v130
    v_cvt_pk_f16_f32 v145, v105, v107
    v_cvt_pk_f16_f32 v149, v129, v131
    ds_write_b64 v224, v[144:145] offset:11088
    ds_write_b64 v224, v[148:149] offset:26928
    v_pk_mul_f32 v[136:137], v[122:123], v[94:95]
    v_pk_mul_f32 v[140:141], v[130:131], v[90:91]
    v_pk_mul_f32 v[138:139], v[122:123], v[92:93]
    v_pk_mul_f32 v[142:143], v[130:131], v[88:89]
    v_pk_fma_f32 v[122:123], v[120:121], v[94:95], v[138:139]
    v_pk_fma_f32 v[130:131], v[128:129], v[90:91], v[142:143] neg_lo:[0,1,0] neg_hi:[0,1,0]
    v_pk_fma_f32 v[120:121], v[120:121], v[92:93], v[136:137] neg_lo:[0,0,1] neg_hi:[0,0,1]
    v_pk_fma_f32 v[128:129], v[128:129], v[88:89], v[140:141]
    v_cvt_pk_f16_f32 v146, v120, v122
    v_cvt_pk_f16_f32 v150, v128, v130
    v_cvt_pk_f16_f32 v147, v121, v123
    v_cvt_pk_f16_f32 v151, v129, v131
    ds_write_b64 v224, v[146:147] offset:11616
    ds_write_b64 v224, v[150:151] offset:27456
    v_pk_mul_f32 v[136:137], v[106:107], v[94:95]
    v_pk_mul_f32 v[140:141], v[130:131], v[90:91]
    v_pk_mul_f32 v[138:139], v[106:107], v[92:93]
    v_pk_mul_f32 v[142:143], v[130:131], v[88:89]
    v_pk_fma_f32 v[106:107], v[104:105], v[94:95], v[138:139]
    v_pk_fma_f32 v[130:131], v[128:129], v[90:91], v[142:143] neg_lo:[0,1,0] neg_hi:[0,1,0]
    v_pk_fma_f32 v[104:105], v[104:105], v[92:93], v[136:137] neg_lo:[0,0,1] neg_hi:[0,0,1]
    v_pk_fma_f32 v[128:129], v[128:129], v[88:89], v[140:141]
    v_cvt_pk_f16_f32 v144, v104, v106
    v_cvt_pk_f16_f32 v148, v128, v130
    v_cvt_pk_f16_f32 v145, v105, v107
    v_cvt_pk_f16_f32 v149, v129, v131
    ds_write_b64 v224, v[144:145] offset:13200
    ds_write_b64 v224, v[148:149] offset:27984
    v_pk_mul_f32 v[136:137], v[122:123], v[94:95]
    v_pk_mul_f32 v[140:141], v[130:131], v[90:91]
    v_pk_mul_f32 v[138:139], v[122:123], v[92:93]
    v_pk_mul_f32 v[142:143], v[130:131], v[88:89]
    v_pk_fma_f32 v[122:123], v[120:121], v[94:95], v[138:139]
    v_pk_fma_f32 v[130:131], v[128:129], v[90:91], v[142:143] neg_lo:[0,1,0] neg_hi:[0,1,0]
    v_pk_fma_f32 v[120:121], v[120:121], v[92:93], v[136:137] neg_lo:[0,0,1] neg_hi:[0,0,1]
    v_pk_fma_f32 v[128:129], v[128:129], v[88:89], v[140:141]
    v_cvt_pk_f16_f32 v146, v120, v122
    v_cvt_pk_f16_f32 v150, v128, v130
    v_cvt_pk_f16_f32 v147, v121, v123
    v_cvt_pk_f16_f32 v151, v129, v131
    ds_write_b64 v224, v[146:147] offset:13728
    ds_write_b64 v224, v[150:151] offset:28512
    v_pk_mul_f32 v[140:141], v[130:131], v[90:91]
    v_pk_mul_f32 v[142:143], v[130:131], v[88:89]
    v_pk_fma_f32 v[130:131], v[128:129], v[90:91], v[142:143] neg_lo:[0,1,0] neg_hi:[0,1,0]
    v_pk_fma_f32 v[128:129], v[128:129], v[88:89], v[140:141]
    v_cvt_pk_f16_f32 v148, v128, v130
    v_cvt_pk_f16_f32 v149, v129, v131
    ds_write_b64 v224, v[148:149] offset:29040
    v_pk_mul_f32 v[140:141], v[130:131], v[90:91]
    v_pk_mul_f32 v[142:143], v[130:131], v[88:89]
    v_pk_fma_f32 v[130:131], v[128:129], v[90:91], v[142:143] neg_lo:[0,1,0] neg_hi:[0,1,0]
    v_pk_fma_f32 v[128:129], v[128:129], v[88:89], v[140:141]
    v_cvt_pk_f16_f32 v150, v128, v130
    v_cvt_pk_f16_f32 v151, v129, v131
    ds_write_b64 v224, v[150:151] offset:29568
    v_pk_mul_f32 v[140:141], v[130:131], v[90:91]
    v_pk_mul_f32 v[142:143], v[130:131], v[88:89]
    v_pk_fma_f32 v[130:131], v[128:129], v[90:91], v[142:143] neg_lo:[0,1,0] neg_hi:[0,1,0]
    v_pk_fma_f32 v[128:129], v[128:129], v[88:89], v[140:141]
    v_cvt_pk_f16_f32 v148, v128, v130
    v_cvt_pk_f16_f32 v149, v129, v131
    ds_write_b64 v224, v[148:149] offset:30096
    v_pk_mul_f32 v[140:141], v[130:131], v[90:91]
    v_pk_mul_f32 v[142:143], v[130:131], v[88:89]
    v_pk_fma_f32 v[130:131], v[128:129], v[90:91], v[142:143] neg_lo:[0,1,0] neg_hi:[0,1,0]
    v_pk_fma_f32 v[128:129], v[128:129], v[88:89], v[140:141]
    v_cvt_pk_f16_f32 v150, v128, v130
    v_cvt_pk_f16_f32 v151, v129, v131
    ds_write_b64 v224, v[150:151] offset:30624
    s_waitcnt lgkmcnt(0)
    ds_read_b128 v[64:67], v225 offset:0
    ds_read_b128 v[68:71], v226 offset:0
    ds_read_b128 v[72:75], v225 offset:32
    ds_read_b128 v[76:79], v226 offset:32
    ds_read_b128 v[80:83], v225 offset:64
    ds_read_b128 v[84:87], v226 offset:64
    ds_read_b128 v[88:91], v225 offset:96
    ds_read_b128 v[92:95], v226 offset:96
    ds_read_b128 v[96:99], v225 offset:128
    ds_read_b128 v[100:103], v226 offset:128
    ds_read_b128 v[104:107], v225 offset:160
    ds_read_b128 v[108:111], v226 offset:160
    s_waitcnt lgkmcnt(10)
    v_mfma_f32_32x32x16_f16 v[176:191], v[64:67], v[68:71], 0
    ds_read_b128 v[64:67], v225 offset:192
    ds_read_b128 v[68:71], v226 offset:192
    s_waitcnt lgkmcnt(10)
    v_mfma_f32_32x32x16_f16 v[176:191], v[72:75], v[76:79], v[176:191]
    ds_read_b128 v[72:75], v225 offset:224
    ds_read_b128 v[76:79], v226 offset:224
    s_waitcnt lgkmcnt(10)
    v_mfma_f32_32x32x16_f16 v[176:191], v[80:83], v[84:87], v[176:191]
    ds_read_b128 v[80:83], v225 offset:256
    ds_read_b128 v[84:87], v226 offset:256
    s_waitcnt lgkmcnt(10)
    v_mfma_f32_32x32x16_f16 v[176:191], v[88:91], v[92:95], v[176:191]
    ds_read_b128 v[88:91], v225 offset:288
    ds_read_b128 v[92:95], v226 offset:288
    s_waitcnt lgkmcnt(10)
    v_mfma_f32_32x32x16_f16 v[176:191], v[96:99], v[100:103], v[176:191]
    ds_read_b128 v[96:99], v225 offset:320
    ds_read_b128 v[100:103], v226 offset:320
    s_waitcnt lgkmcnt(10)
    v_mfma_f32_32x32x16_f16 v[176:191], v[104:107], v[108:111], v[176:191]
    ds_read_b128 v[104:107], v225 offset:352
    ds_read_b128 v[108:111], v226 offset:352
    s_waitcnt lgkmcnt(10)
    v_mfma_f32_32x32x16_f16 v[176:191], v[64:67], v[68:71], v[176:191]
    ds_read_b128 v[64:67], v225 offset:384
    ds_read_b128 v[68:71], v226 offset:384
    s_waitcnt lgkmcnt(10)
    v_mfma_f32_32x32x16_f16 v[176:191], v[72:75], v[76:79], v[176:191]
    ds_read_b128 v[72:75], v225 offset:416
    ds_read_b128 v[76:79], v226 offset:416
    s_waitcnt lgkmcnt(10)
    v_mfma_f32_32x32x16_f16 v[176:191], v[80:83], v[84:87], v[176:191]
    ds_read_b128 v[80:83], v225 offset:448
    ds_read_b128 v[84:87], v226 offset:448
    s_waitcnt lgkmcnt(10)
    v_mfma_f32_32x32x16_f16 v[176:191], v[88:91], v[92:95], v[176:191]
    ds_read_b128 v[88:91], v225 offset:480
    ds_read_b128 v[92:95], v226 offset:480
    s_waitcnt lgkmcnt(10)
    v_mfma_f32_32x32x16_f16 v[176:191], v[96:99], v[100:103], v[176:191]
    s_waitcnt lgkmcnt(8)
    v_mfma_f32_32x32x16_f16 v[176:191], v[104:107], v[108:111], v[176:191]
    s_waitcnt lgkmcnt(6)
    v_mfma_f32_32x32x16_f16 v[176:191], v[64:67], v[68:71], v[176:191]
    s_waitcnt lgkmcnt(4)
    v_mfma_f32_32x32x16_f16 v[176:191], v[72:75], v[76:79], v[176:191]
    s_waitcnt lgkmcnt(2)
    v_mfma_f32_32x32x16_f16 v[176:191], v[80:83], v[84:87], v[176:191]
    s_waitcnt lgkmcnt(0)
    v_mfma_f32_32x32x16_f16 v[176:191], v[88:91], v[92:95], v[176:191]
    v_mov_b32 v235, s14
    v_add_u32 v235, 10496, v235
    global_load_ushort v234, v235, s[68:69] sc1
    v_add_u32 v52, 8192, v7
    v_add_u32 v53, 8192, v13
    v_add_u32 v54, 3456, v52
    v_add_u32 v55, 3456, v53
    global_load_dwordx4 v[20:23], v54, s[68:69] sc1
    global_load_ushort v24, v55, s[68:69] sc1
    v_add_u32 v54, 4608, v52
    v_add_u32 v55, 4608, v53
    global_load_dwordx4 v[14:17], v54, s[68:69] sc1
    global_load_ushort v18, v55, s[68:69] sc1
    v_add_u32 v54, 5760, v52
    v_add_u32 v55, 5760, v53
    global_load_dwordx4 v[26:29], v54, s[68:69] sc1
    global_load_ushort v30, v55, s[68:69] sc1
    v_mov_b32 v64, 0
    v_mov_b32 v65, 0
    v_mov_b32 v66, 0
    v_mov_b32 v67, 0
    v_lshrrev_b32 v68, 1, v1
    s_movk_i32 s20, 4160
    v_mul_u32_u24 v68, s20, v68
    v_and_b32 v69, 1, v1
    v_lshl_add_u32 v68, v69, 4, v68
    v_add_u32 v68, s15, v68
    v_cmp_eq_u32 vcc, 0, v69
    v_cmp_eq_u32 s[20:21], 0, v1
    s_nop 1
    v_cndmask_b32 v70, 0, v232, s[20:21]
    v_pk_mul_f32 v[176:177], v[176:177], v[230:231] op_sel:[0,1] op_sel_hi:[1,1]
    v_pk_mul_f32 v[178:179], v[178:179], v[230:231] op_sel:[0,1] op_sel_hi:[1,1]
    v_pk_mul_f32 v[180:181], v[180:181], v[230:231] op_sel:[0,1] op_sel_hi:[1,1]
    v_pk_mul_f32 v[182:183], v[182:183], v[230:231] op_sel:[0,1] op_sel_hi:[1,1]
    v_pk_mul_f32 v[184:185], v[184:185], v[230:231] op_sel:[0,1] op_sel_hi:[1,1]
    v_pk_mul_f32 v[186:187], v[186:187], v[230:231] op_sel:[0,1] op_sel_hi:[1,1]
    v_pk_mul_f32 v[188:189], v[188:189], v[230:231] op_sel:[0,1] op_sel_hi:[1,1]
    v_pk_mul_f32 v[190:191], v[190:191], v[230:231] op_sel:[0,1] op_sel_hi:[1,1]
    v_add_f32 v176, v176, v70
    v_cndmask_b32 v71, v189, v188, vcc
    v_cndmask_b32 v72, v191, v190, vcc
    s_mov_b64 exec, 0xff
    ds_write_b128 v68, v[64:67] offset:4096
    s_mov_b64 exec, -1
    v_cvt_pk_f16_f32 v76, v183, v182
    v_cvt_pk_f16_f32 v77, v181, v180
    v_cvt_pk_f16_f32 v78, v179, v178
    v_cvt_pk_f16_f32 v79, v177, v176
    v_mov_b32 v83, 0
    v_mov_b32 v91, 0
    v_cvt_pk_f16_f32 v80, v181, v180
    v_cvt_pk_f16_f32 v81, v179, v178
    v_cvt_pk_f16_f32 v82, v177, v176
    v_alignbit_b32 v84, v77, v76, 16
    v_alignbit_b32 v85, v78, v77, 16
    v_alignbit_b32 v86, v79, v78, 16
    v_mov_b32_dpp v83, v76 wave_shr:1 row_mask:0xf bank_mask:0xf
    v_mov_b32_dpp v91, v84 wave_shr:1 row_mask:0xf bank_mask:0xf
    ds_write_b128 v227, v[76:79] offset:3072
    v_mov_b32 v88, v85
    v_mov_b32 v89, v86
    v_alignbit_b32 v87, v83, v79, 16
    v_alignbit_b32 v90, v83, v79, 16
    ds_write_b128 v227, v[80:83] offset:11392
    ds_write_b128 v227, v[84:87] offset:7232
    ds_write_b128 v227, v[88:91] offset:15552
    v_cvt_pk_f16_f32 v96, v186, v186
    v_cvt_pk_f16_f32 v97, v185, v185
    v_cvt_pk_f16_f32 v98, v185, v184
    v_cvt_pk_f16_f32 v99, v184, v184
    v_mov_b32_dpp v103, v76 wave_ror:1 row_mask:0xf bank_mask:0xf
    v_mov_b32_dpp v111, v84 wave_ror:1 row_mask:0xf bank_mask:0xf
    v_cvt_pk_f16_f32 v100, v185, v185
    v_cvt_pk_f16_f32 v101, v185, v184
    v_cvt_pk_f16_f32 v102, v184, v184
    v_alignbit_b32 v104, v97, v96, 16
    v_alignbit_b32 v105, v98, v97, 16
    v_alignbit_b32 v106, v99, v98, 16
    v_mov_b32_dpp v103, v96 wave_shr:1 row_mask:0xf bank_mask:0xf
    v_mov_b32_dpp v111, v104 wave_shr:1 row_mask:0xf bank_mask:0xf
    ds_write_b128 v227, v[96:99] offset:2048
    v_mov_b32 v108, v105
    v_mov_b32 v109, v106
    v_alignbit_b32 v107, v103, v99, 16
    v_alignbit_b32 v110, v103, v99, 16
    ds_write_b128 v227, v[100:103] offset:10368
    ds_write_b128 v227, v[104:107] offset:6208
    ds_write_b128 v227, v[108:111] offset:14528
    v_cvt_pk_f16_f32 v116, v189, v189
    v_cvt_pk_f16_f32 v117, v189, v71
    v_cvt_pk_f16_f32 v118, v188, v188
    v_cvt_pk_f16_f32 v119, v188, v188
    v_mov_b32_dpp v123, v96 wave_ror:1 row_mask:0xf bank_mask:0xf
    v_mov_b32_dpp v131, v104 wave_ror:1 row_mask:0xf bank_mask:0xf
    v_cvt_pk_f16_f32 v120, v189, v71
    v_cvt_pk_f16_f32 v121, v188, v188
    v_cvt_pk_f16_f32 v122, v188, v188
    v_alignbit_b32 v124, v117, v116, 16
    v_alignbit_b32 v125, v118, v117, 16
    v_alignbit_b32 v126, v119, v118, 16
    v_mov_b32_dpp v123, v116 wave_shr:1 row_mask:0xf bank_mask:0xf
    v_mov_b32_dpp v131, v124 wave_shr:1 row_mask:0xf bank_mask:0xf
    ds_write_b128 v227, v[116:119] offset:1024
    v_mov_b32 v128, v125
    v_mov_b32 v129, v126
    v_alignbit_b32 v127, v123, v119, 16
    v_alignbit_b32 v130, v123, v119, 16
    ds_write_b128 v227, v[120:123] offset:9344
    ds_write_b128 v227, v[124:127] offset:5184
    ds_write_b128 v227, v[128:131] offset:13504
    v_cvt_pk_f16_f32 v136, v191, v191
    v_cvt_pk_f16_f32 v137, v191, v72
    v_cvt_pk_f16_f32 v138, v190, v190
    v_cvt_pk_f16_f32 v139, v190, v190
    v_mov_b32_dpp v143, v116 wave_ror:1 row_mask:0xf bank_mask:0xf
    v_mov_b32_dpp v151, v124 wave_ror:1 row_mask:0xf bank_mask:0xf
    v_cvt_pk_f16_f32 v140, v191, v72
    v_cvt_pk_f16_f32 v141, v190, v190
    v_cvt_pk_f16_f32 v142, v190, v190
    v_alignbit_b32 v144, v137, v136, 16
    v_alignbit_b32 v145, v138, v137, 16
    v_alignbit_b32 v146, v139, v138, 16
    v_mov_b32_dpp v143, v136 wave_shr:1 row_mask:0xf bank_mask:0xf
    v_mov_b32_dpp v151, v144 wave_shr:1 row_mask:0xf bank_mask:0xf
    ds_write_b128 v227, v[136:139] offset:0
    v_mov_b32 v148, v145
    v_mov_b32 v149, v146
    v_alignbit_b32 v147, v143, v139, 16
    v_alignbit_b32 v150, v143, v139, 16
    ds_write_b128 v227, v[140:143] offset:8320
    ds_write_b128 v227, v[144:147] offset:4160
    ds_write_b128 v227, v[148:151] offset:12480
    s_waitcnt lgkmcnt(0)
    ds_read_b64 v[64:65], v228 offset:4032
    ds_read_b64 v[66:67], v228 offset:4040
    ds_read_b64 v[68:69], v228 offset:3520
    ds_read_b64 v[70:71], v228 offset:3528
    ds_read_b64 v[72:73], v228 offset:3008
    ds_read_b64 v[74:75], v228 offset:3016
    ds_read_b64 v[76:77], v228 offset:2496
    ds_read_b64 v[78:79], v228 offset:2504
    ds_read_b64 v[80:81], v228 offset:1984
    ds_read_b64 v[82:83], v228 offset:1992
    ds_read_b64 v[84:85], v228 offset:1472
    ds_read_b64 v[86:87], v228 offset:1480
    ds_read_b64 v[88:89], v228 offset:960
    ds_read_b64 v[90:91], v228 offset:968
    ds_read_b64 v[92:93], v228 offset:448
    ds_read_b64 v[94:95], v228 offset:456
    s_waitcnt lgkmcnt(0)
    s_barrier
    ds_read_b128 v[96:99], v229 offset:480
    ds_read_b128 v[100:103], v229 offset:992
    ds_read_b128 v[104:107], v229 offset:1504
    ds_read_b128 v[108:111], v229 offset:2016
    ds_read_b128 v[112:115], v229 offset:2528
    ds_read_b128 v[116:119], v229 offset:3040
    ds_read_b128 v[120:123], v229 offset:3552
    ds_read_b128 v[124:127], v229 offset:4064
    s_waitcnt lgkmcnt(0)
    v_mfma_f32_16x16x32_f16 v[192:195], v[64:67], v[96:99], 0
    ds_read_b64 v[128:129], v228 offset:3968
    v_mfma_f32_16x16x32_f16 v[196:199], v[64:67], v[100:103], 0
    ds_read_b64 v[130:131], v228 offset:3976
    v_mfma_f32_16x16x32_f16 v[200:203], v[64:67], v[104:107], 0
    ds_read_b128 v[160:163], v229 offset:416
    v_mfma_f32_16x16x32_f16 v[204:207], v[64:67], v[108:111], 0
    ds_read_b128 v[164:167], v229 offset:928
    v_mfma_f32_16x16x32_f16 v[208:211], v[64:67], v[112:115], 0
    ds_read_b128 v[168:171], v229 offset:1440
    v_mfma_f32_16x16x32_f16 v[212:215], v[64:67], v[116:119], 0
    ds_read_b128 v[172:175], v229 offset:1952
    v_mfma_f32_16x16x32_f16 v[216:219], v[64:67], v[120:123], 0
    ds_read_b128 v[176:179], v229 offset:2464
    v_mfma_f32_16x16x32_f16 v[220:223], v[64:67], v[124:127], 0
    ds_read_b128 v[180:183], v229 offset:2976
    v_mfma_f32_16x16x32_f16 v[196:199], v[68:71], v[96:99], v[196:199]
    ds_read_b128 v[184:187], v229 offset:3488
    v_mfma_f32_16x16x32_f16 v[200:203], v[68:71], v[100:103], v[200:203]
    ds_read_b128 v[188:191], v229 offset:4000
    v_mfma_f32_16x16x32_f16 v[204:207], v[68:71], v[104:107], v[204:207]
    ds_read_b64 v[132:133], v228 offset:3456
    v_mfma_f32_16x16x32_f16 v[208:211], v[68:71], v[108:111], v[208:211]
    ds_read_b64 v[134:135], v228 offset:3464
    v_mfma_f32_16x16x32_f16 v[212:215], v[68:71], v[112:115], v[212:215]
    ds_read_b64 v[136:137], v228 offset:2944
    v_mfma_f32_16x16x32_f16 v[216:219], v[68:71], v[116:119], v[216:219]
    ds_read_b64 v[138:139], v228 offset:2952
    v_mfma_f32_16x16x32_f16 v[220:223], v[68:71], v[120:123], v[220:223]
    ds_read_b64 v[140:141], v228 offset:2432
    v_mfma_f32_16x16x32_f16 v[200:203], v[72:75], v[96:99], v[200:203]
    ds_read_b64 v[142:143], v228 offset:2440
    v_mfma_f32_16x16x32_f16 v[204:207], v[72:75], v[100:103], v[204:207]
    ds_read_b64 v[144:145], v228 offset:1920
    v_mfma_f32_16x16x32_f16 v[208:211], v[72:75], v[104:107], v[208:211]
    ds_read_b64 v[146:147], v228 offset:1928
    v_mfma_f32_16x16x32_f16 v[212:215], v[72:75], v[108:111], v[212:215]
    ds_read_b64 v[148:149], v228 offset:1408
    v_mfma_f32_16x16x32_f16 v[216:219], v[72:75], v[112:115], v[216:219]
    ds_read_b64 v[150:151], v228 offset:1416
    v_mfma_f32_16x16x32_f16 v[220:223], v[72:75], v[116:119], v[220:223]
    ds_read_b64 v[152:153], v228 offset:896
    v_mfma_f32_16x16x32_f16 v[204:207], v[76:79], v[96:99], v[204:207]
    ds_read_b64 v[154:155], v228 offset:904
    v_mfma_f32_16x16x32_f16 v[208:211], v[76:79], v[100:103], v[208:211]
    ds_read_b64 v[156:157], v228 offset:384
    v_mfma_f32_16x16x32_f16 v[212:215], v[76:79], v[104:107], v[212:215]
    ds_read_b64 v[158:159], v228 offset:392
    v_mfma_f32_16x16x32_f16 v[216:219], v[76:79], v[108:111], v[216:219]
    v_mfma_f32_16x16x32_f16 v[220:223], v[76:79], v[112:115], v[220:223]
    v_mfma_f32_16x16x32_f16 v[208:211], v[80:83], v[96:99], v[208:211]
    v_mfma_f32_16x16x32_f16 v[212:215], v[80:83], v[100:103], v[212:215]
    v_mfma_f32_16x16x32_f16 v[216:219], v[80:83], v[104:107], v[216:219]
    v_mfma_f32_16x16x32_f16 v[220:223], v[80:83], v[108:111], v[220:223]
    v_mfma_f32_16x16x32_f16 v[212:215], v[84:87], v[96:99], v[212:215]
    v_mfma_f32_16x16x32_f16 v[216:219], v[84:87], v[100:103], v[216:219]
    v_mfma_f32_16x16x32_f16 v[220:223], v[84:87], v[104:107], v[220:223]
    v_mfma_f32_16x16x32_f16 v[216:219], v[88:91], v[96:99], v[216:219]
    v_mfma_f32_16x16x32_f16 v[220:223], v[88:91], v[100:103], v[220:223]
    v_mfma_f32_16x16x32_f16 v[220:223], v[92:95], v[96:99], v[220:223]
    s_waitcnt lgkmcnt(0)
    v_mfma_f32_16x16x32_f16 v[192:195], v[128:131], v[160:163], v[192:195]
    ds_read_b64 v[64:65], v228 offset:3904
    v_mfma_f32_16x16x32_f16 v[196:199], v[128:131], v[164:167], v[196:199]
    ds_read_b64 v[66:67], v228 offset:3912
    v_mfma_f32_16x16x32_f16 v[200:203], v[128:131], v[168:171], v[200:203]
    ds_read_b128 v[96:99], v229 offset:352
    v_mfma_f32_16x16x32_f16 v[204:207], v[128:131], v[172:175], v[204:207]
    ds_read_b128 v[100:103], v229 offset:864
    v_mfma_f32_16x16x32_f16 v[208:211], v[128:131], v[176:179], v[208:211]
    ds_read_b128 v[104:107], v229 offset:1376
    v_mfma_f32_16x16x32_f16 v[212:215], v[128:131], v[180:183], v[212:215]
    ds_read_b128 v[108:111], v229 offset:1888
    v_mfma_f32_16x16x32_f16 v[216:219], v[128:131], v[184:187], v[216:219]
    ds_read_b128 v[112:115], v229 offset:2400
    v_mfma_f32_16x16x32_f16 v[220:223], v[128:131], v[188:191], v[220:223]
    ds_read_b128 v[116:119], v229 offset:2912
    v_mfma_f32_16x16x32_f16 v[196:199], v[132:135], v[160:163], v[196:199]
    ds_read_b128 v[120:123], v229 offset:3424
    v_mfma_f32_16x16x32_f16 v[200:203], v[132:135], v[164:167], v[200:203]
    ds_read_b128 v[124:127], v229 offset:3936
    v_mfma_f32_16x16x32_f16 v[204:207], v[132:135], v[168:171], v[204:207]
    ds_read_b64 v[68:69], v228 offset:3392
    v_mfma_f32_16x16x32_f16 v[208:211], v[132:135], v[172:175], v[208:211]
    ds_read_b64 v[70:71], v228 offset:3400
    v_mfma_f32_16x16x32_f16 v[212:215], v[132:135], v[176:179], v[212:215]
    ds_read_b64 v[72:73], v228 offset:2880
    v_mfma_f32_16x16x32_f16 v[216:219], v[132:135], v[180:183], v[216:219]
    ds_read_b64 v[74:75], v228 offset:2888
    v_mfma_f32_16x16x32_f16 v[220:223], v[132:135], v[184:187], v[220:223]
    ds_read_b64 v[76:77], v228 offset:2368
    v_mfma_f32_16x16x32_f16 v[200:203], v[136:139], v[160:163], v[200:203]
    ds_read_b64 v[78:79], v228 offset:2376
    v_mfma_f32_16x16x32_f16 v[204:207], v[136:139], v[164:167], v[204:207]
    ds_read_b64 v[80:81], v228 offset:1856
    v_mfma_f32_16x16x32_f16 v[208:211], v[136:139], v[168:171], v[208:211]
    ds_read_b64 v[82:83], v228 offset:1864
    v_mfma_f32_16x16x32_f16 v[212:215], v[136:139], v[172:175], v[212:215]
    ds_read_b64 v[84:85], v228 offset:1344
    v_mfma_f32_16x16x32_f16 v[216:219], v[136:139], v[176:179], v[216:219]
    ds_read_b64 v[86:87], v228 offset:1352
    v_mfma_f32_16x16x32_f16 v[220:223], v[136:139], v[180:183], v[220:223]
    ds_read_b64 v[88:89], v228 offset:832
    v_mfma_f32_16x16x32_f16 v[204:207], v[140:143], v[160:163], v[204:207]
    ds_read_b64 v[90:91], v228 offset:840
    v_mfma_f32_16x16x32_f16 v[208:211], v[140:143], v[164:167], v[208:211]
    ds_read_b64 v[92:93], v228 offset:320
    v_mfma_f32_16x16x32_f16 v[212:215], v[140:143], v[168:171], v[212:215]
    ds_read_b64 v[94:95], v228 offset:328
    v_mfma_f32_16x16x32_f16 v[216:219], v[140:143], v[172:175], v[216:219]
    v_mfma_f32_16x16x32_f16 v[220:223], v[140:143], v[176:179], v[220:223]
    v_mfma_f32_16x16x32_f16 v[208:211], v[144:147], v[160:163], v[208:211]
    v_mfma_f32_16x16x32_f16 v[212:215], v[144:147], v[164:167], v[212:215]
    v_mfma_f32_16x16x32_f16 v[216:219], v[144:147], v[168:171], v[216:219]
    v_mfma_f32_16x16x32_f16 v[220:223], v[144:147], v[172:175], v[220:223]
    v_mfma_f32_16x16x32_f16 v[212:215], v[148:151], v[160:163], v[212:215]
    v_mfma_f32_16x16x32_f16 v[216:219], v[148:151], v[164:167], v[216:219]
    v_mfma_f32_16x16x32_f16 v[220:223], v[148:151], v[168:171], v[220:223]
    v_mfma_f32_16x16x32_f16 v[216:219], v[152:155], v[160:163], v[216:219]
    v_mfma_f32_16x16x32_f16 v[220:223], v[152:155], v[164:167], v[220:223]
    v_mfma_f32_16x16x32_f16 v[220:223], v[156:159], v[160:163], v[220:223]
    s_waitcnt lgkmcnt(0)
    v_mfma_f32_16x16x32_f16 v[192:195], v[64:67], v[96:99], v[192:195]
    ds_read_b64 v[128:129], v228 offset:3840
    v_mfma_f32_16x16x32_f16 v[196:199], v[64:67], v[100:103], v[196:199]
    ds_read_b64 v[130:131], v228 offset:3848
    v_mfma_f32_16x16x32_f16 v[200:203], v[64:67], v[104:107], v[200:203]
    ds_read_b128 v[160:163], v229 offset:288
    v_mfma_f32_16x16x32_f16 v[204:207], v[64:67], v[108:111], v[204:207]
    ds_read_b128 v[164:167], v229 offset:800
    v_mfma_f32_16x16x32_f16 v[208:211], v[64:67], v[112:115], v[208:211]
    ds_read_b128 v[168:171], v229 offset:1312
    v_mfma_f32_16x16x32_f16 v[212:215], v[64:67], v[116:119], v[212:215]
    ds_read_b128 v[172:175], v229 offset:1824
    v_mfma_f32_16x16x32_f16 v[216:219], v[64:67], v[120:123], v[216:219]
    ds_read_b128 v[176:179], v229 offset:2336
    v_mfma_f32_16x16x32_f16 v[220:223], v[64:67], v[124:127], v[220:223]
    ds_read_b128 v[180:183], v229 offset:2848
    v_mfma_f32_16x16x32_f16 v[196:199], v[68:71], v[96:99], v[196:199]
    ds_read_b128 v[184:187], v229 offset:3360
    v_mfma_f32_16x16x32_f16 v[200:203], v[68:71], v[100:103], v[200:203]
    ds_read_b128 v[188:191], v229 offset:3872
    v_mfma_f32_16x16x32_f16 v[204:207], v[68:71], v[104:107], v[204:207]
    ds_read_b64 v[132:133], v228 offset:3328
    v_mfma_f32_16x16x32_f16 v[208:211], v[68:71], v[108:111], v[208:211]
    ds_read_b64 v[134:135], v228 offset:3336
    v_mfma_f32_16x16x32_f16 v[212:215], v[68:71], v[112:115], v[212:215]
    ds_read_b64 v[136:137], v228 offset:2816
    v_mfma_f32_16x16x32_f16 v[216:219], v[68:71], v[116:119], v[216:219]
    ds_read_b64 v[138:139], v228 offset:2824
    v_mfma_f32_16x16x32_f16 v[220:223], v[68:71], v[120:123], v[220:223]
    ds_read_b64 v[140:141], v228 offset:2304
    v_mfma_f32_16x16x32_f16 v[200:203], v[72:75], v[96:99], v[200:203]
    ds_read_b64 v[142:143], v228 offset:2312
    v_mfma_f32_16x16x32_f16 v[204:207], v[72:75], v[100:103], v[204:207]
    ds_read_b64 v[144:145], v228 offset:1792
    v_mfma_f32_16x16x32_f16 v[208:211], v[72:75], v[104:107], v[208:211]
    ds_read_b64 v[146:147], v228 offset:1800
    v_mfma_f32_16x16x32_f16 v[212:215], v[72:75], v[108:111], v[212:215]
    ds_read_b64 v[148:149], v228 offset:1280
    v_mfma_f32_16x16x32_f16 v[216:219], v[72:75], v[112:115], v[216:219]
    ds_read_b64 v[150:151], v228 offset:1288
    v_mfma_f32_16x16x32_f16 v[220:223], v[72:75], v[116:119], v[220:223]
    ds_read_b64 v[152:153], v228 offset:768
    v_mfma_f32_16x16x32_f16 v[204:207], v[76:79], v[96:99], v[204:207]
    ds_read_b64 v[154:155], v228 offset:776
    v_mfma_f32_16x16x32_f16 v[208:211], v[76:79], v[100:103], v[208:211]
    ds_read_b64 v[156:157], v228 offset:256
    v_mfma_f32_16x16x32_f16 v[212:215], v[76:79], v[104:107], v[212:215]
    ds_read_b64 v[158:159], v228 offset:264
    v_mfma_f32_16x16x32_f16 v[216:219], v[76:79], v[108:111], v[216:219]
    v_mfma_f32_16x16x32_f16 v[220:223], v[76:79], v[112:115], v[220:223]
    v_mfma_f32_16x16x32_f16 v[208:211], v[80:83], v[96:99], v[208:211]
    v_mfma_f32_16x16x32_f16 v[212:215], v[80:83], v[100:103], v[212:215]
    v_mfma_f32_16x16x32_f16 v[216:219], v[80:83], v[104:107], v[216:219]
    v_mfma_f32_16x16x32_f16 v[220:223], v[80:83], v[108:111], v[220:223]
    v_mfma_f32_16x16x32_f16 v[212:215], v[84:87], v[96:99], v[212:215]
    v_mfma_f32_16x16x32_f16 v[216:219], v[84:87], v[100:103], v[216:219]
    v_mfma_f32_16x16x32_f16 v[220:223], v[84:87], v[104:107], v[220:223]
    v_mfma_f32_16x16x32_f16 v[216:219], v[88:91], v[96:99], v[216:219]
    v_mfma_f32_16x16x32_f16 v[220:223], v[88:91], v[100:103], v[220:223]
    v_mfma_f32_16x16x32_f16 v[220:223], v[92:95], v[96:99], v[220:223]
    s_waitcnt lgkmcnt(0)
    v_mfma_f32_16x16x32_f16 v[192:195], v[128:131], v[160:163], v[192:195]
    ds_read_b64 v[64:65], v228 offset:3776
    v_mfma_f32_16x16x32_f16 v[196:199], v[128:131], v[164:167], v[196:199]
    ds_read_b64 v[66:67], v228 offset:3784
    v_mfma_f32_16x16x32_f16 v[200:203], v[128:131], v[168:171], v[200:203]
    ds_read_b128 v[96:99], v229 offset:224
    v_mfma_f32_16x16x32_f16 v[204:207], v[128:131], v[172:175], v[204:207]
    ds_read_b128 v[100:103], v229 offset:736
    v_mfma_f32_16x16x32_f16 v[208:211], v[128:131], v[176:179], v[208:211]
    ds_read_b128 v[104:107], v229 offset:1248
    v_mfma_f32_16x16x32_f16 v[212:215], v[128:131], v[180:183], v[212:215]
    ds_read_b128 v[108:111], v229 offset:1760
    v_mfma_f32_16x16x32_f16 v[216:219], v[128:131], v[184:187], v[216:219]
    ds_read_b128 v[112:115], v229 offset:2272
    v_mfma_f32_16x16x32_f16 v[220:223], v[128:131], v[188:191], v[220:223]
    ds_read_b128 v[116:119], v229 offset:2784
    v_mfma_f32_16x16x32_f16 v[196:199], v[132:135], v[160:163], v[196:199]
    ds_read_b128 v[120:123], v229 offset:3296
    v_mfma_f32_16x16x32_f16 v[200:203], v[132:135], v[164:167], v[200:203]
    ds_read_b128 v[124:127], v229 offset:3808
    v_mfma_f32_16x16x32_f16 v[204:207], v[132:135], v[168:171], v[204:207]
    ds_read_b64 v[68:69], v228 offset:3264
    v_mfma_f32_16x16x32_f16 v[208:211], v[132:135], v[172:175], v[208:211]
    ds_read_b64 v[70:71], v228 offset:3272
    v_mfma_f32_16x16x32_f16 v[212:215], v[132:135], v[176:179], v[212:215]
    ds_read_b64 v[72:73], v228 offset:2752
    v_mfma_f32_16x16x32_f16 v[216:219], v[132:135], v[180:183], v[216:219]
    ds_read_b64 v[74:75], v228 offset:2760
    v_mfma_f32_16x16x32_f16 v[220:223], v[132:135], v[184:187], v[220:223]
    ds_read_b64 v[76:77], v228 offset:2240
    v_mfma_f32_16x16x32_f16 v[200:203], v[136:139], v[160:163], v[200:203]
    ds_read_b64 v[78:79], v228 offset:2248
    v_mfma_f32_16x16x32_f16 v[204:207], v[136:139], v[164:167], v[204:207]
    ds_read_b64 v[80:81], v228 offset:1728
    v_mfma_f32_16x16x32_f16 v[208:211], v[136:139], v[168:171], v[208:211]
    ds_read_b64 v[82:83], v228 offset:1736
    v_mfma_f32_16x16x32_f16 v[212:215], v[136:139], v[172:175], v[212:215]
    ds_read_b64 v[84:85], v228 offset:1216
    v_mfma_f32_16x16x32_f16 v[216:219], v[136:139], v[176:179], v[216:219]
    ds_read_b64 v[86:87], v228 offset:1224
    v_mfma_f32_16x16x32_f16 v[220:223], v[136:139], v[180:183], v[220:223]
    ds_read_b64 v[88:89], v228 offset:704
    v_mfma_f32_16x16x32_f16 v[204:207], v[140:143], v[160:163], v[204:207]
    ds_read_b64 v[90:91], v228 offset:712
    v_mfma_f32_16x16x32_f16 v[208:211], v[140:143], v[164:167], v[208:211]
    ds_read_b64 v[92:93], v228 offset:192
    v_mfma_f32_16x16x32_f16 v[212:215], v[140:143], v[168:171], v[212:215]
    ds_read_b64 v[94:95], v228 offset:200
    v_mfma_f32_16x16x32_f16 v[216:219], v[140:143], v[172:175], v[216:219]
    v_mfma_f32_16x16x32_f16 v[220:223], v[140:143], v[176:179], v[220:223]
    v_mfma_f32_16x16x32_f16 v[208:211], v[144:147], v[160:163], v[208:211]
    v_mfma_f32_16x16x32_f16 v[212:215], v[144:147], v[164:167], v[212:215]
    v_mfma_f32_16x16x32_f16 v[216:219], v[144:147], v[168:171], v[216:219]
    v_mfma_f32_16x16x32_f16 v[220:223], v[144:147], v[172:175], v[220:223]
    v_mfma_f32_16x16x32_f16 v[212:215], v[148:151], v[160:163], v[212:215]
    v_mfma_f32_16x16x32_f16 v[216:219], v[148:151], v[164:167], v[216:219]
    v_mfma_f32_16x16x32_f16 v[220:223], v[148:151], v[168:171], v[220:223]
    v_mfma_f32_16x16x32_f16 v[216:219], v[152:155], v[160:163], v[216:219]
    v_mfma_f32_16x16x32_f16 v[220:223], v[152:155], v[164:167], v[220:223]
    v_mfma_f32_16x16x32_f16 v[220:223], v[156:159], v[160:163], v[220:223]
    s_waitcnt lgkmcnt(0)
    v_mfma_f32_16x16x32_f16 v[192:195], v[64:67], v[96:99], v[192:195]
    ds_read_b64 v[128:129], v228 offset:3712
    v_mfma_f32_16x16x32_f16 v[196:199], v[64:67], v[100:103], v[196:199]
    ds_read_b64 v[130:131], v228 offset:3720
    v_mfma_f32_16x16x32_f16 v[200:203], v[64:67], v[104:107], v[200:203]
    ds_read_b128 v[160:163], v229 offset:160
    v_mfma_f32_16x16x32_f16 v[204:207], v[64:67], v[108:111], v[204:207]
    ds_read_b128 v[164:167], v229 offset:672
    v_mfma_f32_16x16x32_f16 v[208:211], v[64:67], v[112:115], v[208:211]
    ds_read_b128 v[168:171], v229 offset:1184
    v_mfma_f32_16x16x32_f16 v[212:215], v[64:67], v[116:119], v[212:215]
    ds_read_b128 v[172:175], v229 offset:1696
    v_mfma_f32_16x16x32_f16 v[216:219], v[64:67], v[120:123], v[216:219]
    ds_read_b128 v[176:179], v229 offset:2208
    v_mfma_f32_16x16x32_f16 v[220:223], v[64:67], v[124:127], v[220:223]
    ds_read_b128 v[180:183], v229 offset:2720
    v_mfma_f32_16x16x32_f16 v[196:199], v[68:71], v[96:99], v[196:199]
    ds_read_b128 v[184:187], v229 offset:3232
    v_mfma_f32_16x16x32_f16 v[200:203], v[68:71], v[100:103], v[200:203]
    ds_read_b128 v[188:191], v229 offset:3744
    v_mfma_f32_16x16x32_f16 v[204:207], v[68:71], v[104:107], v[204:207]
    ds_read_b64 v[132:133], v228 offset:3200
    v_mfma_f32_16x16x32_f16 v[208:211], v[68:71], v[108:111], v[208:211]
    ds_read_b64 v[134:135], v228 offset:3208
    v_mfma_f32_16x16x32_f16 v[212:215], v[68:71], v[112:115], v[212:215]
    ds_read_b64 v[136:137], v228 offset:2688
    v_mfma_f32_16x16x32_f16 v[216:219], v[68:71], v[116:119], v[216:219]
    ds_read_b64 v[138:139], v228 offset:2696
    v_mfma_f32_16x16x32_f16 v[220:223], v[68:71], v[120:123], v[220:223]
    ds_read_b64 v[140:141], v228 offset:2176
    v_mfma_f32_16x16x32_f16 v[200:203], v[72:75], v[96:99], v[200:203]
    ds_read_b64 v[142:143], v228 offset:2184
    v_mfma_f32_16x16x32_f16 v[204:207], v[72:75], v[100:103], v[204:207]
    ds_read_b64 v[144:145], v228 offset:1664
    v_mfma_f32_16x16x32_f16 v[208:211], v[72:75], v[104:107], v[208:211]
    ds_read_b64 v[146:147], v228 offset:1672
    v_mfma_f32_16x16x32_f16 v[212:215], v[72:75], v[108:111], v[212:215]
    ds_read_b64 v[148:149], v228 offset:1152
    v_mfma_f32_16x16x32_f16 v[216:219], v[72:75], v[112:115], v[216:219]
    ds_read_b64 v[150:151], v228 offset:1160
    v_mfma_f32_16x16x32_f16 v[220:223], v[72:75], v[116:119], v[220:223]
    ds_read_b64 v[152:153], v228 offset:640
    v_mfma_f32_16x16x32_f16 v[204:207], v[76:79], v[96:99], v[204:207]
    ds_read_b64 v[154:155], v228 offset:648
    v_mfma_f32_16x16x32_f16 v[208:211], v[76:79], v[100:103], v[208:211]
    ds_read_b64 v[156:157], v228 offset:128
    v_mfma_f32_16x16x32_f16 v[212:215], v[76:79], v[104:107], v[212:215]
    ds_read_b64 v[158:159], v228 offset:136
    v_mfma_f32_16x16x32_f16 v[216:219], v[76:79], v[108:111], v[216:219]
    v_mfma_f32_16x16x32_f16 v[220:223], v[76:79], v[112:115], v[220:223]
    v_mfma_f32_16x16x32_f16 v[208:211], v[80:83], v[96:99], v[208:211]
    v_mfma_f32_16x16x32_f16 v[212:215], v[80:83], v[100:103], v[212:215]
    v_mfma_f32_16x16x32_f16 v[216:219], v[80:83], v[104:107], v[216:219]
    v_mfma_f32_16x16x32_f16 v[220:223], v[80:83], v[108:111], v[220:223]
    v_mfma_f32_16x16x32_f16 v[212:215], v[84:87], v[96:99], v[212:215]
    v_mfma_f32_16x16x32_f16 v[216:219], v[84:87], v[100:103], v[216:219]
    v_mfma_f32_16x16x32_f16 v[220:223], v[84:87], v[104:107], v[220:223]
    v_mfma_f32_16x16x32_f16 v[216:219], v[88:91], v[96:99], v[216:219]
    v_mfma_f32_16x16x32_f16 v[220:223], v[88:91], v[100:103], v[220:223]
    v_mfma_f32_16x16x32_f16 v[220:223], v[92:95], v[96:99], v[220:223]
    s_waitcnt lgkmcnt(0)
    v_mfma_f32_16x16x32_f16 v[192:195], v[128:131], v[160:163], v[192:195]
    ds_read_b64 v[64:65], v228 offset:3648
    v_mfma_f32_16x16x32_f16 v[196:199], v[128:131], v[164:167], v[196:199]
    ds_read_b64 v[66:67], v228 offset:3656
    v_mfma_f32_16x16x32_f16 v[200:203], v[128:131], v[168:171], v[200:203]
    ds_read_b128 v[96:99], v229 offset:96
    v_mfma_f32_16x16x32_f16 v[204:207], v[128:131], v[172:175], v[204:207]
    ds_read_b128 v[100:103], v229 offset:608
    v_mfma_f32_16x16x32_f16 v[208:211], v[128:131], v[176:179], v[208:211]
    ds_read_b128 v[104:107], v229 offset:1120
    v_mfma_f32_16x16x32_f16 v[212:215], v[128:131], v[180:183], v[212:215]
    ds_read_b128 v[108:111], v229 offset:1632
    v_mfma_f32_16x16x32_f16 v[216:219], v[128:131], v[184:187], v[216:219]
    ds_read_b128 v[112:115], v229 offset:2144
    v_mfma_f32_16x16x32_f16 v[220:223], v[128:131], v[188:191], v[220:223]
    ds_read_b128 v[116:119], v229 offset:2656
    v_mfma_f32_16x16x32_f16 v[196:199], v[132:135], v[160:163], v[196:199]
    ds_read_b128 v[120:123], v229 offset:3168
    v_mfma_f32_16x16x32_f16 v[200:203], v[132:135], v[164:167], v[200:203]
    ds_read_b128 v[124:127], v229 offset:3680
    v_mfma_f32_16x16x32_f16 v[204:207], v[132:135], v[168:171], v[204:207]
    ds_read_b64 v[68:69], v228 offset:3136
    v_mfma_f32_16x16x32_f16 v[208:211], v[132:135], v[172:175], v[208:211]
    ds_read_b64 v[70:71], v228 offset:3144
    v_mfma_f32_16x16x32_f16 v[212:215], v[132:135], v[176:179], v[212:215]
    ds_read_b64 v[72:73], v228 offset:2624
    v_mfma_f32_16x16x32_f16 v[216:219], v[132:135], v[180:183], v[216:219]
    ds_read_b64 v[74:75], v228 offset:2632
    v_mfma_f32_16x16x32_f16 v[220:223], v[132:135], v[184:187], v[220:223]
    ds_read_b64 v[76:77], v228 offset:2112
    v_mfma_f32_16x16x32_f16 v[200:203], v[136:139], v[160:163], v[200:203]
    ds_read_b64 v[78:79], v228 offset:2120
    v_mfma_f32_16x16x32_f16 v[204:207], v[136:139], v[164:167], v[204:207]
    ds_read_b64 v[80:81], v228 offset:1600
    v_mfma_f32_16x16x32_f16 v[208:211], v[136:139], v[168:171], v[208:211]
    ds_read_b64 v[82:83], v228 offset:1608
    v_mfma_f32_16x16x32_f16 v[212:215], v[136:139], v[172:175], v[212:215]
    ds_read_b64 v[84:85], v228 offset:1088
    v_mfma_f32_16x16x32_f16 v[216:219], v[136:139], v[176:179], v[216:219]
    ds_read_b64 v[86:87], v228 offset:1096
    v_mfma_f32_16x16x32_f16 v[220:223], v[136:139], v[180:183], v[220:223]
    ds_read_b64 v[88:89], v228 offset:576
    v_mfma_f32_16x16x32_f16 v[204:207], v[140:143], v[160:163], v[204:207]
    ds_read_b64 v[90:91], v228 offset:584
    v_mfma_f32_16x16x32_f16 v[208:211], v[140:143], v[164:167], v[208:211]
    ds_read_b64 v[92:93], v228 offset:64
    v_mfma_f32_16x16x32_f16 v[212:215], v[140:143], v[168:171], v[212:215]
    ds_read_b64 v[94:95], v228 offset:72
    v_mfma_f32_16x16x32_f16 v[216:219], v[140:143], v[172:175], v[216:219]
    v_mfma_f32_16x16x32_f16 v[220:223], v[140:143], v[176:179], v[220:223]
    v_mfma_f32_16x16x32_f16 v[208:211], v[144:147], v[160:163], v[208:211]
    v_mfma_f32_16x16x32_f16 v[212:215], v[144:147], v[164:167], v[212:215]
    v_mfma_f32_16x16x32_f16 v[216:219], v[144:147], v[168:171], v[216:219]
    v_mfma_f32_16x16x32_f16 v[220:223], v[144:147], v[172:175], v[220:223]
    v_mfma_f32_16x16x32_f16 v[212:215], v[148:151], v[160:163], v[212:215]
    v_mfma_f32_16x16x32_f16 v[216:219], v[148:151], v[164:167], v[216:219]
    v_mfma_f32_16x16x32_f16 v[220:223], v[148:151], v[168:171], v[220:223]
    v_mfma_f32_16x16x32_f16 v[216:219], v[152:155], v[160:163], v[216:219]
    v_mfma_f32_16x16x32_f16 v[220:223], v[152:155], v[164:167], v[220:223]
    v_mfma_f32_16x16x32_f16 v[220:223], v[156:159], v[160:163], v[220:223]
    s_waitcnt lgkmcnt(0)
    v_mfma_f32_16x16x32_f16 v[192:195], v[64:67], v[96:99], v[192:195]
    ds_read_b64 v[128:129], v228 offset:3584
    v_mfma_f32_16x16x32_f16 v[196:199], v[64:67], v[100:103], v[196:199]
    ds_read_b64 v[130:131], v228 offset:3592
    v_mfma_f32_16x16x32_f16 v[200:203], v[64:67], v[104:107], v[200:203]
    ds_read_b128 v[160:163], v229 offset:32
    v_mfma_f32_16x16x32_f16 v[204:207], v[64:67], v[108:111], v[204:207]
    ds_read_b128 v[164:167], v229 offset:544
    v_mfma_f32_16x16x32_f16 v[208:211], v[64:67], v[112:115], v[208:211]
    ds_read_b128 v[168:171], v229 offset:1056
    v_mfma_f32_16x16x32_f16 v[212:215], v[64:67], v[116:119], v[212:215]
    ds_read_b128 v[172:175], v229 offset:1568
    v_mfma_f32_16x16x32_f16 v[216:219], v[64:67], v[120:123], v[216:219]
    ds_read_b128 v[176:179], v229 offset:2080
    v_mfma_f32_16x16x32_f16 v[220:223], v[64:67], v[124:127], v[220:223]
    ds_read_b128 v[180:183], v229 offset:2592
    v_mfma_f32_16x16x32_f16 v[196:199], v[68:71], v[96:99], v[196:199]
    ds_read_b128 v[184:187], v229 offset:3104
    v_mfma_f32_16x16x32_f16 v[200:203], v[68:71], v[100:103], v[200:203]
    ds_read_b128 v[188:191], v229 offset:3616
    v_mfma_f32_16x16x32_f16 v[204:207], v[68:71], v[104:107], v[204:207]
    ds_read_b64 v[132:133], v228 offset:3072
    v_mfma_f32_16x16x32_f16 v[208:211], v[68:71], v[108:111], v[208:211]
    ds_read_b64 v[134:135], v228 offset:3080
    v_mfma_f32_16x16x32_f16 v[212:215], v[68:71], v[112:115], v[212:215]
    ds_read_b64 v[136:137], v228 offset:2560
    v_mfma_f32_16x16x32_f16 v[216:219], v[68:71], v[116:119], v[216:219]
    ds_read_b64 v[138:139], v228 offset:2568
    v_mfma_f32_16x16x32_f16 v[220:223], v[68:71], v[120:123], v[220:223]
    ds_read_b64 v[140:141], v228 offset:2048
    v_mfma_f32_16x16x32_f16 v[200:203], v[72:75], v[96:99], v[200:203]
    ds_read_b64 v[142:143], v228 offset:2056
    v_mfma_f32_16x16x32_f16 v[204:207], v[72:75], v[100:103], v[204:207]
    ds_read_b64 v[144:145], v228 offset:1536
    v_mfma_f32_16x16x32_f16 v[208:211], v[72:75], v[104:107], v[208:211]
    ds_read_b64 v[146:147], v228 offset:1544
    v_mfma_f32_16x16x32_f16 v[212:215], v[72:75], v[108:111], v[212:215]
    ds_read_b64 v[148:149], v228 offset:1024
    v_mfma_f32_16x16x32_f16 v[216:219], v[72:75], v[112:115], v[216:219]
    ds_read_b64 v[150:151], v228 offset:1032
    v_mfma_f32_16x16x32_f16 v[220:223], v[72:75], v[116:119], v[220:223]
    ds_read_b64 v[152:153], v228 offset:512
    v_mfma_f32_16x16x32_f16 v[204:207], v[76:79], v[96:99], v[204:207]
    ds_read_b64 v[154:155], v228 offset:520
    v_mfma_f32_16x16x32_f16 v[208:211], v[76:79], v[100:103], v[208:211]
    ds_read_b64 v[156:157], v228 offset:0
    v_mfma_f32_16x16x32_f16 v[212:215], v[76:79], v[104:107], v[212:215]
    ds_read_b64 v[158:159], v228 offset:8
    v_mfma_f32_16x16x32_f16 v[216:219], v[76:79], v[108:111], v[216:219]
    v_mfma_f32_16x16x32_f16 v[220:223], v[76:79], v[112:115], v[220:223]
    v_mfma_f32_16x16x32_f16 v[208:211], v[80:83], v[96:99], v[208:211]
    v_mfma_f32_16x16x32_f16 v[212:215], v[80:83], v[100:103], v[212:215]
    v_mfma_f32_16x16x32_f16 v[216:219], v[80:83], v[104:107], v[216:219]
    v_mfma_f32_16x16x32_f16 v[220:223], v[80:83], v[108:111], v[220:223]
    v_mfma_f32_16x16x32_f16 v[212:215], v[84:87], v[96:99], v[212:215]
    v_mfma_f32_16x16x32_f16 v[216:219], v[84:87], v[100:103], v[216:219]
    v_mfma_f32_16x16x32_f16 v[220:223], v[84:87], v[104:107], v[220:223]
    v_mfma_f32_16x16x32_f16 v[216:219], v[88:91], v[96:99], v[216:219]
    v_mfma_f32_16x16x32_f16 v[220:223], v[88:91], v[100:103], v[220:223]
    v_mfma_f32_16x16x32_f16 v[220:223], v[92:95], v[96:99], v[220:223]
    s_waitcnt lgkmcnt(0)
    v_mfma_f32_16x16x32_f16 v[192:195], v[128:131], v[160:163], v[192:195]
    v_mfma_f32_16x16x32_f16 v[196:199], v[128:131], v[164:167], v[196:199]
    v_mfma_f32_16x16x32_f16 v[200:203], v[128:131], v[168:171], v[200:203]
    v_mfma_f32_16x16x32_f16 v[204:207], v[128:131], v[172:175], v[204:207]
    v_mfma_f32_16x16x32_f16 v[208:211], v[128:131], v[176:179], v[208:211]
    v_mfma_f32_16x16x32_f16 v[212:215], v[128:131], v[180:183], v[212:215]
    v_mfma_f32_16x16x32_f16 v[216:219], v[128:131], v[184:187], v[216:219]
    v_mfma_f32_16x16x32_f16 v[220:223], v[128:131], v[188:191], v[220:223]
    v_mfma_f32_16x16x32_f16 v[196:199], v[132:135], v[160:163], v[196:199]
    v_mfma_f32_16x16x32_f16 v[200:203], v[132:135], v[164:167], v[200:203]
    v_mfma_f32_16x16x32_f16 v[204:207], v[132:135], v[168:171], v[204:207]
    v_mfma_f32_16x16x32_f16 v[208:211], v[132:135], v[172:175], v[208:211]
    v_mfma_f32_16x16x32_f16 v[212:215], v[132:135], v[176:179], v[212:215]
    v_mfma_f32_16x16x32_f16 v[216:219], v[132:135], v[180:183], v[216:219]
    v_mfma_f32_16x16x32_f16 v[220:223], v[132:135], v[184:187], v[220:223]
    v_mfma_f32_16x16x32_f16 v[200:203], v[136:139], v[160:163], v[200:203]
    v_mfma_f32_16x16x32_f16 v[204:207], v[136:139], v[164:167], v[204:207]
    v_mfma_f32_16x16x32_f16 v[208:211], v[136:139], v[168:171], v[208:211]
    v_mfma_f32_16x16x32_f16 v[212:215], v[136:139], v[172:175], v[212:215]
    v_mfma_f32_16x16x32_f16 v[216:219], v[136:139], v[176:179], v[216:219]
    v_mfma_f32_16x16x32_f16 v[220:223], v[136:139], v[180:183], v[220:223]
    v_mfma_f32_16x16x32_f16 v[204:207], v[140:143], v[160:163], v[204:207]
    v_mfma_f32_16x16x32_f16 v[208:211], v[140:143], v[164:167], v[208:211]
    v_mfma_f32_16x16x32_f16 v[212:215], v[140:143], v[168:171], v[212:215]
    v_mfma_f32_16x16x32_f16 v[216:219], v[140:143], v[172:175], v[216:219]
    v_mfma_f32_16x16x32_f16 v[220:223], v[140:143], v[176:179], v[220:223]
    v_mfma_f32_16x16x32_f16 v[208:211], v[144:147], v[160:163], v[208:211]
    v_mfma_f32_16x16x32_f16 v[212:215], v[144:147], v[164:167], v[212:215]
    v_mfma_f32_16x16x32_f16 v[216:219], v[144:147], v[168:171], v[216:219]
    v_mfma_f32_16x16x32_f16 v[220:223], v[144:147], v[172:175], v[220:223]
    v_mfma_f32_16x16x32_f16 v[212:215], v[148:151], v[160:163], v[212:215]
    v_mfma_f32_16x16x32_f16 v[216:219], v[148:151], v[164:167], v[216:219]
    v_mfma_f32_16x16x32_f16 v[220:223], v[148:151], v[168:171], v[220:223]
    v_mfma_f32_16x16x32_f16 v[216:219], v[152:155], v[160:163], v[216:219]
    v_mfma_f32_16x16x32_f16 v[220:223], v[152:155], v[164:167], v[220:223]
    v_mfma_f32_16x16x32_f16 v[220:223], v[156:159], v[160:163], v[220:223]
    s_cmp_lg_u32 s3, 0
    s_cbranch_scc1 NOF
    s_cmp_ge_u32 s2, 112
    s_cbranch_scc1 NOF
    s_lshl_b32 s20, s2, 6
    s_add_u32 s20, s20, 29696
    v_mov_b32 v64, s20
    v_mov_b32 v65, 0
    s_mov_b64 exec, 1
    global_store_dword v64, v65, s[68:69] sc1
    s_mov_b64 exec, -1
NOF:
GAP:
    s_waitcnt vmcnt(1)
    v_cmp_eq_u32 vcc, 0xffff, v234
    s_cbranch_vccz GAD
    global_load_ushort v234, v235, s[68:69] sc1
    s_waitcnt vmcnt(0)
    s_sub_u32 s10, s10, 1
    s_cbranch_scc1 EXIT
    s_branch GAP
GAD:
    v_lshlrev_b32 v234, 16, v234
    v_mul_f32 v234, v234, v233
    v_pk_mul_f32 v[192:193], v[192:193], v[234:235] op_sel_hi:[1,0]
    v_pk_mul_f32 v[194:195], v[194:195], v[234:235] op_sel_hi:[1,0]
    v_cvt_pk_bf16_f32 v192, v192, v193
    v_cvt_pk_bf16_f32 v193, v194, v195
    ds_write_b64 v230, v[192:193] offset:0
    v_pk_mul_f32 v[196:197], v[196:197], v[234:235] op_sel_hi:[1,0]
    v_pk_mul_f32 v[198:199], v[198:199], v[234:235] op_sel_hi:[1,0]
    v_cvt_pk_bf16_f32 v196, v196, v197
    v_cvt_pk_bf16_f32 v197, v198, v199
    ds_write_b64 v230, v[196:197] offset:512
    v_pk_mul_f32 v[200:201], v[200:201], v[234:235] op_sel_hi:[1,0]
    v_pk_mul_f32 v[202:203], v[202:203], v[234:235] op_sel_hi:[1,0]
    v_cvt_pk_bf16_f32 v200, v200, v201
    v_cvt_pk_bf16_f32 v201, v202, v203
    ds_write_b64 v230, v[200:201] offset:1024
    v_pk_mul_f32 v[204:205], v[204:205], v[234:235] op_sel_hi:[1,0]
    v_pk_mul_f32 v[206:207], v[206:207], v[234:235] op_sel_hi:[1,0]
    v_cvt_pk_bf16_f32 v204, v204, v205
    v_cvt_pk_bf16_f32 v205, v206, v207
    ds_write_b64 v230, v[204:205] offset:1536
    v_pk_mul_f32 v[208:209], v[208:209], v[234:235] op_sel_hi:[1,0]
    v_pk_mul_f32 v[210:211], v[210:211], v[234:235] op_sel_hi:[1,0]
    v_cvt_pk_bf16_f32 v208, v208, v209
    v_cvt_pk_bf16_f32 v209, v210, v211
    ds_write_b64 v230, v[208:209] offset:2048
    v_pk_mul_f32 v[212:213], v[212:213], v[234:235] op_sel_hi:[1,0]
    v_pk_mul_f32 v[214:215], v[214:215], v[234:235] op_sel_hi:[1,0]
    v_cvt_pk_bf16_f32 v212, v212, v213
    v_cvt_pk_bf16_f32 v213, v214, v215
    ds_write_b64 v230, v[212:213] offset:2560
    v_pk_mul_f32 v[216:217], v[216:217], v[234:235] op_sel_hi:[1,0]
    v_pk_mul_f32 v[218:219], v[218:219], v[234:235] op_sel_hi:[1,0]
    v_cvt_pk_bf16_f32 v216, v216, v217
    v_cvt_pk_bf16_f32 v217, v218, v219
    ds_write_b64 v230, v[216:217] offset:3072
    v_pk_mul_f32 v[220:221], v[220:221], v[234:235] op_sel_hi:[1,0]
    v_pk_mul_f32 v[222:223], v[222:223], v[234:235] op_sel_hi:[1,0]
    v_cvt_pk_bf16_f32 v220, v220, v221
    v_cvt_pk_bf16_f32 v221, v222, v223
    ds_write_b64 v230, v[220:221] offset:3584
    s_branch CONV_JOIN
CONV_B:
    s_waitcnt lgkmcnt(0)
    s_cmp_lg_u32 s2, 0
    s_cbranch_scc1 NOT0
    v_mov_b32 v64, -1
    v_mov_b32 v65, -1
    v_mov_b32 v66, -1
    v_mov_b32 v67, -1
    s_lshl_b32 s20, s9, 12
    v_add_u32 v68, s20, v7
    global_store_dwordx4 v68, v[64:67], s[68:69] sc1
    global_store_dwordx4 v68, v[64:67], s[68:69] offset:1024 sc1
    global_store_dwordx4 v68, v[64:67], s[68:69] offset:2048 sc1
    global_store_dwordx4 v68, v[64:67], s[68:69] offset:3072 sc1
    s_lshl_b32 s20, s9, 2
    v_mov_b32 v68, s20
    s_waitcnt vmcnt(0)
    s_mov_b64 exec, 1
    global_store_dword v68, v64, s[66:67] sc1
    s_mov_b64 exec, -1
NOT0:
    s_lshl_b32 s20, s2, 2
    s_add_u32 s20, s20, s9
    s_mul_i32 s20, s20, 2304
    v_add_u32 v58, s20, v7
    v_add_u32 v59, s20, v13
    global_load_dwordx4 v[64:67], v58, s[36:37]
    global_load_ushort v68, v59, s[36:37]
    global_load_dwordx4 v[70:73], v58, s[36:37] offset:1152
    global_load_ushort v74, v59, s[36:37] offset:1152
    v_mov_b32 v60, -1
    v_mov_b32 v61, -1
    v_mov_b32 v62, -1
    v_mul_u32_u24 v57, 12, v1
    s_mul_i32 s20, s2, 9216
    s_mul_i32 s21, s9, 2304
    s_add_u32 s20, s20, s21
    s_add_u32 s20, s20, 1048576
    v_add_u32 v57, s20, v57
    global_store_dwordx3 v57, v[60:62], s[68:69] sc1
    global_store_dwordx3 v57, v[60:62], s[68:69] offset:768 sc1
    global_store_dwordx3 v57, v[60:62], s[68:69] offset:1536 sc1
    s_lshl_b32 s20, s2, 4
    s_add_u32 s20, s20, 16384
    v_lshl_add_u32 v57, v1, 2, s20
    s_lshl_b32 s20, s2, 6
    s_add_u32 s20, s20, 20480
    v_writelane_b32 v57, s20, 4
    v_mov_b32 v56, 0
    v_lshlrev_b32 v55, 3, v1
    v_add_u32 v55, 143360, v55
    s_mov_b64 exec, 0x1f
    global_store_dword v57, v60, s[68:69] sc1
    ds_write2_b32 v55, v56, v56 offset0:0 offset1:1
    s_mov_b64 exec, -1
    global_load_dwordx4 v[76:79], v56, s[66:67] sc1
    v_and_b32 v52, 255, v0
    s_movk_i32 s20, 9216
    s_lshl_b32 s21, s6, 3
    s_add_u32 s21, s21, 3456
    v_mul_u32_u24 v53, s20, v52
    v_add_u32 v53, s21, v53
    v_add_u32 v54, 4608, v53
    global_load_dwordx2 v[112:113], v53, s[36:37] offset:-3456
    global_load_dwordx2 v[114:115], v53, s[36:37] offset:-2304
    global_load_dwordx2 v[116:117], v53, s[36:37] offset:-1152
    global_load_dwordx2 v[118:119], v53, s[36:37]
    global_load_dwordx2 v[120:121], v53, s[36:37] offset:1152
    global_load_dwordx2 v[122:123], v53, s[36:37] offset:2304
    global_load_dwordx2 v[124:125], v53, s[36:37] offset:3456
    global_load_dwordx2 v[126:127], v54, s[36:37]
    v_mov_b32 v54, 0
    v_mov_b32 v55, 0
    s_mul_i32 s20, s9, 4608
    s_add_u32 s20, s20, 124928
    v_lshl_add_u32 v53, v1, 3, s20
    ds_write_b64 v53, v[54:55]
    s_waitcnt vmcnt(13)
    v_lshlrev_b32 v80, 16, v64
    v_and_b32 v81, s12, v64
    v_lshlrev_b32 v82, 16, v65
    v_and_b32 v83, s12, v65
    v_lshlrev_b32 v84, 16, v66
    v_and_b32 v85, s12, v66
    v_lshlrev_b32 v86, 16, v67
    v_and_b32 v87, s12, v67
    v_lshlrev_b32 v88, 16, v68
    v_lshlrev_b32 v90, 16, v70
    v_and_b32 v91, s12, v70
    v_lshlrev_b32 v92, 16, v71
    v_and_b32 v93, s12, v71
    v_lshlrev_b32 v94, 16, v72
    v_and_b32 v95, s12, v72
    v_lshlrev_b32 v96, 16, v73
    v_and_b32 v97, s12, v73
    v_lshlrev_b32 v98, 16, v74
    v_readfirstlane_b32 s22, v80
    s_nop 1
    v_subrev_f32 v80, s22, v80
    v_subrev_f32 v81, s22, v81
    v_subrev_f32 v82, s22, v82
    v_subrev_f32 v83, s22, v83
    v_subrev_f32 v84, s22, v84
    v_subrev_f32 v85, s22, v85
    v_subrev_f32 v86, s22, v86
    v_subrev_f32 v87, s22, v87
    v_subrev_f32 v88, s22, v88
    v_pk_add_f32 v[100:101], v[80:81], v[82:83]
    v_pk_mul_f32 v[102:103], v[80:81], v[80:81]
    v_pk_add_f32 v[100:101], v[100:101], v[84:85]
    v_pk_fma_f32 v[102:103], v[82:83], v[82:83], v[102:103]
    v_pk_add_f32 v[100:101], v[100:101], v[86:87]
    v_pk_fma_f32 v[102:103], v[84:85], v[84:85], v[102:103]
    v_add_f32 v100, v100, v88
    v_pk_fma_f32 v[102:103], v[86:87], v[86:87], v[102:103]
    v_add_f32 v100, v100, v101
    v_fmac_f32 v102, v88, v88
    v_add_f32 v102, v102, v103
    v_readfirstlane_b32 s23, v90
    s_nop 1
    v_subrev_f32 v90, s23, v90
    v_subrev_f32 v91, s23, v91
    v_subrev_f32 v92, s23, v92
    v_subrev_f32 v93, s23, v93
    v_subrev_f32 v94, s23, v94
    v_subrev_f32 v95, s23, v95
    v_subrev_f32 v96, s23, v96
    v_subrev_f32 v97, s23, v97
    v_subrev_f32 v98, s23, v98
    v_pk_add_f32 v[104:105], v[90:91], v[92:93]
    v_pk_mul_f32 v[106:107], v[90:91], v[90:91]
    v_pk_add_f32 v[104:105], v[104:105], v[94:95]
    v_pk_fma_f32 v[106:107], v[92:93], v[92:93], v[106:107]
    v_pk_add_f32 v[104:105], v[104:105], v[96:97]
    v_pk_fma_f32 v[106:107], v[94:95], v[94:95], v[106:107]
    v_add_f32 v104, v104, v98
    v_pk_fma_f32 v[106:107], v[96:97], v[96:97], v[106:107]
    v_add_f32 v104, v104, v105
    v_fmac_f32 v106, v98, v98
    v_add_f32 v106, v106, v107
    v_permlane32_swap_b32 v100, v104
    s_nop 0
    v_permlane32_swap_b32 v102, v106
    v_add_f32 v100, v100, v104
    v_add_f32 v102, v102, v106
    s_nop 1
    v_permlane16_swap_b32 v100, v102
    v_add_f32 v100, v100, v102
    s_nop 1
    v_add_f32_dpp v100, v100, v100 row_ror:8 row_mask:0xf bank_mask:0xf
    s_nop 1
    v_add_f32_dpp v100, v100, v100 row_ror:4 row_mask:0xf bank_mask:0xf
    s_nop 1
    v_add_f32_dpp v100, v100, v100 row_ror:2 row_mask:0xf bank_mask:0xf
    s_nop 1
    v_add_f32_dpp v100, v100, v100 row_ror:1 row_mask:0xf bank_mask:0xf
    v_mov_b32 v102, v100
    s_nop 1
    v_permlane16_swap_b32 v100, v102
    v_mov_b32 v104, s22
    v_mov_b32 v105, s23
    v_cmp_gt_u32 vcc, 32, v1
    s_nop 1
    v_cndmask_b32 v104, v105, v104, vcc
    v_mul_f32 v100, 0x3ae38e39, v100
    v_mul_f32 v102, 0x3ae38e39, v102
    v_add_f32 v105, v104, v100
    v_fma_f32 v107, -v100, v100, v102
    v_max_f32 v107, 0, v107
    v_cvt_pk_bf16_f32 v107, v107, v107
    v_and_b32 v107, s12, v107
    v_add_f32 v107, 0x3727c5ac, v107
    v_cvt_pk_bf16_f32 v107, v107, v107
    v_and_b32 v107, s12, v107
    v_sqrt_f32 v106, v107
    s_nop 0
    v_cvt_pk_bf16_f32 v105, v105, v106
    v_min_u32 v105, -2, v105
    s_lshl_b32 s20, s2, 2
    s_add_u32 s20, s20, s9
    s_lshl_b32 s20, s20, 3
    v_lshrrev_b32 v104, 5, v1
    v_lshl_add_u32 v104, v104, 2, s20
    s_waitcnt vmcnt(8)
GO_1:
    v_min3_u32 v80, v76, v77, v78
    v_min_u32 v80, v80, v79
    v_cmp_eq_u32 vcc, 0, v80
    s_cbranch_vccz GOD_2
    v_mov_b32 v80, 0
    global_load_dwordx4 v[76:79], v80, s[66:67] sc1
    s_waitcnt vmcnt(0)
    s_sub_u32 s10, s10, 1
    s_cbranch_scc1 EXIT
    s_branch GO_1
GOD_2:
    s_mov_b32 exec_lo, 1
    s_mov_b32 exec_hi, 1
    global_store_dword v104, v105, s[68:69] sc1
    s_mov_b64 exec, -1
    s_waitcnt vmcnt(1)
    v_lshlrev_b32 v128, 16, v112
    v_and_b32 v129, s12, v112
    v_lshlrev_b32 v130, 16, v113
    v_and_b32 v131, s12, v113
    v_lshlrev_b32 v132, 16, v114
    v_and_b32 v133, s12, v114
    v_lshlrev_b32 v134, 16, v115
    v_and_b32 v135, s12, v115
    v_lshlrev_b32 v136, 16, v116
    v_and_b32 v137, s12, v116
    v_lshlrev_b32 v138, 16, v117
    v_and_b32 v139, s12, v117
    v_lshlrev_b32 v140, 16, v118
    v_and_b32 v141, s12, v118
    v_lshlrev_b32 v142, 16, v119
    v_and_b32 v143, s12, v119
    v_lshlrev_b32 v144, 16, v120
    v_and_b32 v145, s12, v120
    v_lshlrev_b32 v146, 16, v121
    v_and_b32 v147, s12, v121
    v_lshlrev_b32 v148, 16, v122
    v_and_b32 v149, s12, v122
    v_lshlrev_b32 v150, 16, v123
    v_and_b32 v151, s12, v123
    v_lshlrev_b32 v152, 16, v124
    v_and_b32 v153, s12, v124
    v_lshlrev_b32 v154, 16, v125
    v_and_b32 v155, s12, v125
    v_lshlrev_b32 v156, 16, v126
    v_and_b32 v157, s12, v126
    v_lshlrev_b32 v158, 16, v127
    v_and_b32 v159, s12, v127
    v_lshlrev_b32 v53, 5, v52
    s_lshl_b32 s20, s6, 3
    s_add_u32 s20, s20, 8192
    v_mov_b32 v54, s20
    v_lshlrev_b32 v55, 4, v52
    v_add_u32 v55, 125440, v55
    s_waitcnt vmcnt(0)
STP:
    global_load_dwordx4 v[64:67], v53, s[68:69] sc1
    global_load_dwordx4 v[68:71], v53, s[68:69] offset:16 sc1
    global_load_dwordx2 v[72:73], v54, s[68:69] sc1
    global_load_dwordx2 v[74:75], v54, s[68:69] offset:1152 sc1
    s_waitcnt vmcnt(2)
    v_max3_u32 v76, v64, v65, v66
    v_max3_u32 v76, v76, v67, v68
    v_max3_u32 v76, v76, v69, v70
    v_max_u32 v76, v76, v71
    v_cmp_eq_u32 vcc, -1, v76
    s_cbranch_vccz STD
    s_waitcnt vmcnt(0)
    s_sub_u32 s10, s10, 1
    s_cbranch_scc1 EXIT
    s_branch STP
STD:
    v_and_b32 v80, s12, v64
    v_lshlrev_b32 v81, 16, v64
    v_rcp_f32 v80, v80
    v_and_b32 v82, s12, v65
    v_lshlrev_b32 v83, 16, v65
    v_rcp_f32 v82, v82
    v_and_b32 v84, s12, v66
    v_lshlrev_b32 v85, 16, v66
    v_rcp_f32 v84, v84
    v_and_b32 v86, s12, v67
    v_lshlrev_b32 v87, 16, v67
    v_rcp_f32 v86, v86
    v_and_b32 v88, s12, v68
    v_lshlrev_b32 v89, 16, v68
    v_rcp_f32 v88, v88
    v_and_b32 v90, s12, v69
    v_lshlrev_b32 v91, 16, v69
    v_rcp_f32 v90, v90
    v_and_b32 v92, s12, v70
    v_lshlrev_b32 v93, 16, v70
    v_rcp_f32 v92, v92
    v_and_b32 v94, s12, v71
    v_lshlrev_b32 v95, 16, v71
    v_rcp_f32 v94, v94
    v_mul_f32 v81, -v81, v80
    v_mul_f32 v83, -v83, v82
    v_mul_f32 v85, -v85, v84
    v_mul_f32 v87, -v87, v86
    v_mul_f32 v89, -v89, v88
    v_mul_f32 v91, -v91, v90
    v_mul_f32 v93, -v93, v92
    v_mul_f32 v95, -v95, v94
    v_pk_fma_f32 v[128:129], v[128:129], v[80:81], v[80:81] op_sel:[0,0,1] op_sel_hi:[1,0,1]
    v_pk_fma_f32 v[130:131], v[130:131], v[80:81], v[80:81] op_sel:[0,0,1] op_sel_hi:[1,0,1]
    v_pk_fma_f32 v[132:133], v[132:133], v[82:83], v[82:83] op_sel:[0,0,1] op_sel_hi:[1,0,1]
    v_pk_fma_f32 v[134:135], v[134:135], v[82:83], v[82:83] op_sel:[0,0,1] op_sel_hi:[1,0,1]
    v_pk_fma_f32 v[136:137], v[136:137], v[84:85], v[84:85] op_sel:[0,0,1] op_sel_hi:[1,0,1]
    v_pk_fma_f32 v[138:139], v[138:139], v[84:85], v[84:85] op_sel:[0,0,1] op_sel_hi:[1,0,1]
    v_pk_fma_f32 v[140:141], v[140:141], v[86:87], v[86:87] op_sel:[0,0,1] op_sel_hi:[1,0,1]
    v_pk_fma_f32 v[142:143], v[142:143], v[86:87], v[86:87] op_sel:[0,0,1] op_sel_hi:[1,0,1]
    v_pk_fma_f32 v[144:145], v[144:145], v[88:89], v[88:89] op_sel:[0,0,1] op_sel_hi:[1,0,1]
    v_pk_fma_f32 v[146:147], v[146:147], v[88:89], v[88:89] op_sel:[0,0,1] op_sel_hi:[1,0,1]
    v_pk_fma_f32 v[148:149], v[148:149], v[90:91], v[90:91] op_sel:[0,0,1] op_sel_hi:[1,0,1]
    v_pk_fma_f32 v[150:151], v[150:151], v[90:91], v[90:91] op_sel:[0,0,1] op_sel_hi:[1,0,1]
    v_pk_fma_f32 v[152:153], v[152:153], v[92:93], v[92:93] op_sel:[0,0,1] op_sel_hi:[1,0,1]
    v_pk_fma_f32 v[154:155], v[154:155], v[92:93], v[92:93] op_sel:[0,0,1] op_sel_hi:[1,0,1]
    v_pk_fma_f32 v[156:157], v[156:157], v[94:95], v[94:95] op_sel:[0,0,1] op_sel_hi:[1,0,1]
    v_pk_fma_f32 v[158:159], v[158:159], v[94:95], v[94:95] op_sel:[0,0,1] op_sel_hi:[1,0,1]
MDP:
    s_waitcnt vmcnt(0)
    v_max3_u32 v76, v72, v73, v74
    v_max_u32 v76, v76, v75
    v_cmp_eq_u32 vcc, -1, v76
    s_cbranch_vccz MDD
    global_load_dwordx2 v[72:73], v54, s[68:69] sc1
    global_load_dwordx2 v[74:75], v54, s[68:69] offset:1152 sc1
    s_sub_u32 s10, s10, 1
    s_cbranch_scc1 EXIT
    s_branch MDP
MDD:
    v_lshlrev_b32 v84, 16, v74
    v_and_b32 v85, s12, v74
    v_lshlrev_b32 v86, 16, v75
    v_and_b32 v87, s12, v75
    v_lshlrev_b32 v80, 16, v72
    v_and_b32 v81, s12, v72
    v_lshlrev_b32 v82, 16, v73
    v_and_b32 v83, s12, v73
    v_pk_add_f32 v[84:85], v[84:85], 1.0 op_sel_hi:[1,0]
    v_pk_add_f32 v[86:87], v[86:87], 1.0 op_sel_hi:[1,0]
    v_cvt_pk_bf16_f32 v74, v84, v85
    v_cvt_pk_bf16_f32 v75, v86, v87
    v_lshlrev_b32 v84, 16, v74
    v_and_b32 v85, s12, v74
    v_lshlrev_b32 v86, 16, v75
    v_and_b32 v87, s12, v75
    v_pk_fma_f32 v[128:129], v[128:129], v[84:85], v[80:81]
    v_pk_fma_f32 v[132:133], v[132:133], v[84:85], v[80:81]
    v_pk_fma_f32 v[136:137], v[136:137], v[84:85], v[80:81]
    v_pk_fma_f32 v[140:141], v[140:141], v[84:85], v[80:81]
    v_pk_fma_f32 v[144:145], v[144:145], v[84:85], v[80:81]
    v_pk_fma_f32 v[148:149], v[148:149], v[84:85], v[80:81]
    v_pk_fma_f32 v[152:153], v[152:153], v[84:85], v[80:81]
    v_pk_fma_f32 v[156:157], v[156:157], v[84:85], v[80:81]
    v_cvt_pk_f16_f32 v88, v128, v132
    v_cvt_pk_f16_f32 v89, v136, v140
    v_cvt_pk_f16_f32 v90, v144, v148
    v_cvt_pk_f16_f32 v91, v152, v156
    ds_write_b128 v55, v[88:91] offset:0
    v_cvt_pk_f16_f32 v92, v129, v133
    v_cvt_pk_f16_f32 v93, v137, v141
    v_cvt_pk_f16_f32 v94, v145, v149
    v_cvt_pk_f16_f32 v95, v153, v157
    ds_write_b128 v55, v[92:95] offset:4608
    v_pk_fma_f32 v[130:131], v[130:131], v[86:87], v[82:83]
    v_pk_fma_f32 v[134:135], v[134:135], v[86:87], v[82:83]
    v_pk_fma_f32 v[138:139], v[138:139], v[86:87], v[82:83]
    v_pk_fma_f32 v[142:143], v[142:143], v[86:87], v[82:83]
    v_pk_fma_f32 v[146:147], v[146:147], v[86:87], v[82:83]
    v_pk_fma_f32 v[150:151], v[150:151], v[86:87], v[82:83]
    v_pk_fma_f32 v[154:155], v[154:155], v[86:87], v[82:83]
    v_pk_fma_f32 v[158:159], v[158:159], v[86:87], v[82:83]
    v_cvt_pk_f16_f32 v96, v130, v134
    v_cvt_pk_f16_f32 v97, v138, v142
    v_cvt_pk_f16_f32 v98, v146, v150
    v_cvt_pk_f16_f32 v99, v154, v158
    ds_write_b128 v55, v[96:99] offset:9216
    v_cvt_pk_f16_f32 v100, v131, v135
    v_cvt_pk_f16_f32 v101, v139, v143
    v_cvt_pk_f16_f32 v102, v147, v151
    v_cvt_pk_f16_f32 v103, v155, v159
    ds_write_b128 v55, v[100:103] offset:13824
    s_waitcnt lgkmcnt(0)
    s_barrier
    s_mul_i32 s20, s11, 1152
    v_add_u32 v52, s20, v7
    v_add_u32 v53, s20, v13
    global_load_dwordx4 v[2:5], v52, s[36:37]
    global_load_ushort v6, v53, s[36:37]
    global_load_dwordx4 v[8:11], v7, s[52:53]
    global_load_ushort v12, v13, s[52:53]
    s_cmp_ge_u32 s5, 14
    s_cbranch_scc1 CB_MOE
    v_mov_b32 v60, -1
    v_mov_b32 v61, -1
    v_mov_b32 v62, -1
    v_mul_u32_u24 v59, 12, v1
    s_mul_i32 s20, s2, 9216
    s_mul_i32 s21, s9, 2304
    s_add_u32 s20, s20, s21
    s_add_u32 s20, s20, 4194304
    v_add_u32 v58, s20, v59
    global_store_dwordx3 v58, v[60:62], s[68:69] sc1
    global_store_dwordx3 v58, v[60:62], s[68:69] offset:768 sc1
    global_store_dwordx3 v58, v[60:62], s[68:69] offset:1536 sc1
    s_cmp_ge_u32 s2, 8
    s_cbranch_scc1 X1I_3
    s_mul_i32 s20, s2, 3072
    s_mul_i32 s21, s9, 768
    s_add_u32 s20, s20, s21
    s_add_u32 s20, s20, 36864
    v_add_u32 v58, s20, v59
    global_store_dwordx3 v58, v[60:62], s[68:69] sc1
X1I_3:
    s_branch CB_MOD
CB_MOE:
    v_mov_b32 v60, -1
    v_mov_b32 v61, -1
    v_mov_b32 v62, -1
    v_mul_u32_u24 v59, 12, v1
    s_mul_i32 s20, s2, 9216
    s_mul_i32 s21, s9, 2304
    s_add_u32 s20, s20, s21
    s_add_u32 s20, s20, 4194304
    v_add_u32 v58, s20, v59
    global_store_dwordx3 v58, v[60:62], s[68:69] sc1
    global_store_dwordx3 v58, v[60:62], s[68:69] offset:768 sc1
    global_store_dwordx3 v58, v[60:62], s[68:69] offset:1536 sc1
    s_mul_i32 s20, s8, 18432
    s_mul_i32 s21, s9, 4608
    s_add_u32 s20, s20, s21
    s_add_u32 s20, s20, 7342336
    v_add_u32 v58, s20, v59
    global_store_dwordx3 v58, v[60:62], s[68:69] offset:-2304 sc1
    global_store_dwordx3 v58, v[60:62], s[68:69] offset:-1536 sc1
    global_store_dwordx3 v58, v[60:62], s[68:69] offset:-768 sc1
    global_store_dwordx3 v58, v[60:62], s[68:69] sc1
    global_store_dwordx3 v58, v[60:62], s[68:69] offset:768 sc1
    global_store_dwordx3 v58, v[60:62], s[68:69] offset:1536 sc1
    v_and_b32 v52, 7, v1
    v_lshlrev_b32 v52, 3, v52
    v_lshrrev_b32 v53, 4, v1
    s_mul_i32 s20, s9, 294912
    s_lshl_b32 s21, s8, 6
    s_add_u32 s20, s20, s21
    s_mov_b32 s21, 73728
    v_mad_u32_u24 v52, v53, s21, v52
    v_add_u32 v52, s20, v52
    v_and_b32 v54, 8, v1
    v_cmp_eq_u32 vcc, 0, v54
    v_mov_b32 v54, s56
    v_mov_b32 v55, s54
    v_cndmask_b32 v54, v54, v55, vcc
    v_mov_b32 v55, s57
    v_mov_b32 v56, s55
    v_cndmask_b32 v55, v55, v56, vcc
    v_add_co_u32 v54, vcc, v54, v52
    s_nop 1
    v_addc_co_u32 v55, vcc, 0, v55, vcc
    s_mov_b32 s20, 9216
    s_mov_b32 s21, 0
    s_mov_b32 s22, 1115136
    s_mov_b32 s23, 0
    global_load_dwordx2 v[128:129], v[54:55], off
    v_lshl_add_u64 v[54:55], v[54:55], 0, s[20:21]
    global_load_dwordx2 v[130:131], v[54:55], off
    v_lshl_add_u64 v[54:55], v[54:55], 0, s[20:21]
    global_load_dwordx2 v[132:133], v[54:55], off
    v_lshl_add_u64 v[54:55], v[54:55], 0, s[20:21]
    global_load_dwordx2 v[134:135], v[54:55], off
    v_lshl_add_u64 v[54:55], v[54:55], 0, s[20:21]
    global_load_dwordx2 v[136:137], v[54:55], off
    v_lshl_add_u64 v[54:55], v[54:55], 0, s[20:21]
    global_load_dwordx2 v[138:139], v[54:55], off
    v_lshl_add_u64 v[54:55], v[54:55], 0, s[20:21]
    global_load_dwordx2 v[140:141], v[54:55], off
    v_lshl_add_u64 v[54:55], v[54:55], 0, s[20:21]
    global_load_dwordx2 v[142:143], v[54:55], off
    v_lshl_add_u64 v[54:55], v[54:55], 0, s[22:23]
    global_load_dwordx2 v[144:145], v[54:55], off
    v_lshl_add_u64 v[54:55], v[54:55], 0, s[20:21]
    global_load_dwordx2 v[146:147], v[54:55], off
    v_lshl_add_u64 v[54:55], v[54:55], 0, s[20:21]
    global_load_dwordx2 v[148:149], v[54:55], off
    v_lshl_add_u64 v[54:55], v[54:55], 0, s[20:21]
    global_load_dwordx2 v[150:151], v[54:55], off
    v_lshl_add_u64 v[54:55], v[54:55], 0, s[20:21]
    global_load_dwordx2 v[152:153], v[54:55], off
    v_lshl_add_u64 v[54:55], v[54:55], 0, s[20:21]
    global_load_dwordx2 v[154:155], v[54:55], off
    v_lshl_add_u64 v[54:55], v[54:55], 0, s[20:21]
    global_load_dwordx2 v[156:157], v[54:55], off
    v_lshl_add_u64 v[54:55], v[54:55], 0, s[20:21]
    global_load_dwordx2 v[158:159], v[54:55], off
    v_lshl_add_u64 v[54:55], v[54:55], 0, s[22:23]
    global_load_dwordx2 v[160:161], v[54:55], off
    v_lshl_add_u64 v[54:55], v[54:55], 0, s[20:21]
    global_load_dwordx2 v[162:163], v[54:55], off
    v_lshl_add_u64 v[54:55], v[54:55], 0, s[20:21]
    global_load_dwordx2 v[164:165], v[54:55], off
    v_lshl_add_u64 v[54:55], v[54:55], 0, s[20:21]
    global_load_dwordx2 v[166:167], v[54:55], off
    v_lshl_add_u64 v[54:55], v[54:55], 0, s[20:21]
    global_load_dwordx2 v[168:169], v[54:55], off
    v_lshl_add_u64 v[54:55], v[54:55], 0, s[20:21]
    global_load_dwordx2 v[170:171], v[54:55], off
    v_lshl_add_u64 v[54:55], v[54:55], 0, s[20:21]
    global_load_dwordx2 v[172:173], v[54:55], off
    v_lshl_add_u64 v[54:55], v[54:55], 0, s[20:21]
    global_load_dwordx2 v[174:175], v[54:55], off
    v_lshl_add_u64 v[54:55], v[54:55], 0, s[22:23]
    global_load_dwordx2 v[176:177], v[54:55], off
    v_lshl_add_u64 v[54:55], v[54:55], 0, s[20:21]
    global_load_dwordx2 v[178:179], v[54:55], off
    v_lshl_add_u64 v[54:55], v[54:55], 0, s[20:21]
    global_load_dwordx2 v[180:181], v[54:55], off
    v_lshl_add_u64 v[54:55], v[54:55], 0, s[20:21]
    global_load_dwordx2 v[182:183], v[54:55], off
    v_lshl_add_u64 v[54:55], v[54:55], 0, s[20:21]
    global_load_dwordx2 v[184:185], v[54:55], off
    v_lshl_add_u64 v[54:55], v[54:55], 0, s[20:21]
    global_load_dwordx2 v[186:187], v[54:55], off
    v_lshl_add_u64 v[54:55], v[54:55], 0, s[20:21]
    global_load_dwordx2 v[188:189], v[54:55], off
    v_lshl_add_u64 v[54:55], v[54:55], 0, s[20:21]
    global_load_dwordx2 v[190:191], v[54:55], off
    v_lshl_add_u64 v[54:55], v[54:55], 0, s[22:23]
    s_cmp_ge_u32 s9, 2
    s_cbranch_scc1 W5_4
    global_load_dwordx2 v[192:193], v[54:55], off
    v_lshl_add_u64 v[54:55], v[54:55], 0, s[20:21]
    global_load_dwordx2 v[194:195], v[54:55], off
    v_lshl_add_u64 v[54:55], v[54:55], 0, s[20:21]
    global_load_dwordx2 v[196:197], v[54:55], off
    v_lshl_add_u64 v[54:55], v[54:55], 0, s[20:21]
    global_load_dwordx2 v[198:199], v[54:55], off
    v_lshl_add_u64 v[54:55], v[54:55], 0, s[20:21]
    global_load_dwordx2 v[200:201], v[54:55], off
    v_lshl_add_u64 v[54:55], v[54:55], 0, s[20:21]
    global_load_dwordx2 v[202:203], v[54:55], off
    v_lshl_add_u64 v[54:55], v[54:55], 0, s[20:21]
    global_load_dwordx2 v[204:205], v[54:55], off
    v_lshl_add_u64 v[54:55], v[54:55], 0, s[20:21]
    global_load_dwordx2 v[206:207], v[54:55], off
W5_4:
    v_and_b32 v52, 15, v1
    v_lshlrev_b32 v52, 3, v52
    s_movk_i32 s21, 1152
    v_mad_u32_u24 v52, v53, s21, v52
    s_mul_i32 s20, s8, 36864
    s_lshl_b32 s21, s9, 7
    s_add_u32 s20, s20, s21
    v_add_u32 v52, s20, v52
    global_load_dwordx2 v[208:209], v52, s[58:59]
    global_load_dwordx2 v[224:225], v52, s[58:59] offset:512
    v_add_u32 v52, 4608, v52
    global_load_dwordx2 v[210:211], v52, s[58:59]
    global_load_dwordx2 v[226:227], v52, s[58:59] offset:512
    v_add_u32 v52, 4608, v52
    global_load_dwordx2 v[212:213], v52, s[58:59]
    global_load_dwordx2 v[228:229], v52, s[58:59] offset:512
    v_add_u32 v52, 4608, v52
    global_load_dwordx2 v[214:215], v52, s[58:59]
    global_load_dwordx2 v[230:231], v52, s[58:59] offset:512
    v_add_u32 v52, 4608, v52
    global_load_dwordx2 v[216:217], v52, s[58:59]
    global_load_dwordx2 v[232:233], v52, s[58:59] offset:512
    v_add_u32 v52, 4608, v52
    global_load_dwordx2 v[218:219], v52, s[58:59]
    global_load_dwordx2 v[234:235], v52, s[58:59] offset:512
    v_add_u32 v52, 4608, v52
    global_load_dwordx2 v[220:221], v52, s[58:59]
    global_load_dwordx2 v[236:237], v52, s[58:59] offset:512
    v_add_u32 v52, 4608, v52
    global_load_dwordx2 v[222:223], v52, s[58:59]
    global_load_dwordx2 v[238:239], v52, s[58:59] offset:512
    s_cmp_lg_u32 s9, 3
    s_cbranch_scc1 W8_5
    global_load_dwordx2 v[254:255], v52, s[58:59] offset:640
    v_subrev_u32 v52, 4608, v52
    global_load_dwordx2 v[252:253], v52, s[58:59] offset:640
    v_subrev_u32 v52, 4608, v52
    global_load_dwordx2 v[250:251], v52, s[58:59] offset:640
    v_subrev_u32 v52, 4608, v52
    global_load_dwordx2 v[248:249], v52, s[58:59] offset:640
    v_subrev_u32 v52, 4608, v52
    global_load_dwordx2 v[246:247], v52, s[58:59] offset:640
    v_subrev_u32 v52, 4608, v52
    global_load_dwordx2 v[244:245], v52, s[58:59] offset:640
    v_subrev_u32 v52, 4608, v52
    global_load_dwordx2 v[242:243], v52, s[58:59] offset:640
    v_subrev_u32 v52, 4608, v52
    global_load_dwordx2 v[240:241], v52, s[58:59] offset:640
W8_5:
CB_MOD:
    v_add_u32 v52, 8192, v7
    v_add_u32 v53, 8192, v13
    v_add_u32 v54, 3456, v52
    v_add_u32 v55, 3456, v53
    global_load_dwordx4 v[20:23], v54, s[68:69] sc1
    global_load_ushort v24, v55, s[68:69] sc1
    v_add_u32 v54, 4608, v52
    v_add_u32 v55, 4608, v53
    global_load_dwordx4 v[14:17], v54, s[68:69] sc1
    global_load_ushort v18, v55, s[68:69] sc1
    v_add_u32 v54, 5760, v52
    v_add_u32 v55, 5760, v53
    global_load_dwordx4 v[26:29], v54, s[68:69] sc1
    global_load_ushort v30, v55, s[68:69] sc1
CONV_JOIN:
    v_and_b32 v56, 3, v0
    v_lshrrev_b32 v57, 2, v0
    s_mov_b32 s20, 31296
    v_mul_u32_u24 v58, s20, v56
    v_lshl_add_u32 v58, v57, 4, v58
    s_movk_i32 s20, 9216
    v_mul_u32_u24 v59, s20, v57
    v_lshl_add_u32 v59, v56, 4, v59
    s_lshl_b32 s20, s6, 6
    s_add_u32 s20, s20, 1048576
    v_add_u32 v59, s20, v59
    v_add_u32 v60, 1179648, v59
    s_waitcnt lgkmcnt(0)
    s_barrier
    ds_read_b128 v[64:67], v58
    ds_read_b128 v[68:71], v58 offset:2048
    s_waitcnt lgkmcnt(1)
    global_store_dwordx4 v59, v[64:67], s[68:69] sc1
    s_waitcnt lgkmcnt(0)
    global_store_dwordx4 v60, v[68:71], s[68:69] sc1
    s_waitcnt vmcnt(2)
    s_cmp_lt_u32 s3, 4
    s_cbranch_scc1 CJ_NP
    s_cmp_lt_u32 s5, 14
    s_cbranch_scc1 CJ_NP
    s_mov_b32 s20, 0x05040100
    s_mov_b32 s21, 0x07060302
    v_perm_b32 v112, v130, v128, s20
    v_perm_b32 v116, v130, v128, s21
    v_perm_b32 v120, v131, v129, s20
    v_perm_b32 v124, v131, v129, s21
    v_perm_b32 v113, v134, v132, s20
    v_perm_b32 v117, v134, v132, s21
    v_perm_b32 v121, v135, v133, s20
    v_perm_b32 v125, v135, v133, s21
    v_perm_b32 v114, v138, v136, s20
    v_perm_b32 v118, v138, v136, s21
    v_perm_b32 v122, v139, v137, s20
    v_perm_b32 v126, v139, v137, s21
    v_perm_b32 v115, v142, v140, s20
    v_perm_b32 v119, v142, v140, s21
    v_perm_b32 v123, v143, v141, s20
    v_perm_b32 v127, v143, v141, s21
    v_perm_b32 v128, v146, v144, s20
    v_perm_b32 v132, v146, v144, s21
    v_perm_b32 v136, v147, v145, s20
    v_perm_b32 v140, v147, v145, s21
    v_perm_b32 v129, v150, v148, s20
    v_perm_b32 v133, v150, v148, s21
    v_perm_b32 v137, v151, v149, s20
    v_perm_b32 v141, v151, v149, s21
    v_perm_b32 v130, v154, v152, s20
    v_perm_b32 v134, v154, v152, s21
    v_perm_b32 v138, v155, v153, s20
    v_perm_b32 v142, v155, v153, s21
    v_perm_b32 v131, v158, v156, s20
    v_perm_b32 v135, v158, v156, s21
    v_perm_b32 v139, v159, v157, s20
    v_perm_b32 v143, v159, v157, s21
    v_perm_b32 v144, v162, v160, s20
    v_perm_b32 v148, v162, v160, s21
    v_perm_b32 v152, v163, v161, s20
    v_perm_b32 v156, v163, v161, s21
    v_perm_b32 v145, v166, v164, s20
    v_perm_b32 v149, v166, v164, s21
    v_perm_b32 v153, v167, v165, s20
    v_perm_b32 v157, v167, v165, s21
    v_perm_b32 v146, v170, v168, s20
    v_perm_b32 v150, v170, v168, s21
    v_perm_b32 v154, v171, v169, s20
    v_perm_b32 v158, v171, v169, s21
    v_perm_b32 v147, v174, v172, s20
    v_perm_b32 v151, v174, v172, s21
    v_perm_b32 v155, v175, v173, s20
    v_perm_b32 v159, v175, v173, s21
    v_perm_b32 v160, v178, v176, s20
    v_perm_b32 v164, v178, v176, s21
    v_perm_b32 v168, v179, v177, s20
    v_perm_b32 v172, v179, v177, s21
    v_perm_b32 v161, v182, v180, s20
    v_perm_b32 v165, v182, v180, s21
    v_perm_b32 v169, v183, v181, s20
    v_perm_b32 v173, v183, v181, s21
    v_perm_b32 v162, v186, v184, s20
    v_perm_b32 v166, v186, v184, s21
    v_perm_b32 v170, v187, v185, s20
    v_perm_b32 v174, v187, v185, s21
    v_perm_b32 v163, v190, v188, s20
    v_perm_b32 v167, v190, v188, s21
    v_perm_b32 v171, v191, v189, s20
    v_perm_b32 v175, v191, v189, s21
    v_perm_b32 v176, v194, v192, s20
    v_perm_b32 v180, v194, v192, s21
    v_perm_b32 v184, v195, v193, s20
    v_perm_b32 v188, v195, v193, s21
    v_perm_b32 v177, v198, v196, s20
    v_perm_b32 v181, v198, v196, s21
    v_perm_b32 v185, v199, v197, s20
    v_perm_b32 v189, v199, v197, s21
    v_perm_b32 v178, v202, v200, s20
    v_perm_b32 v182, v202, v200, s21
    v_perm_b32 v186, v203, v201, s20
    v_perm_b32 v190, v203, v201, s21
    v_perm_b32 v179, v206, v204, s20
    v_perm_b32 v183, v206, v204, s21
    v_perm_b32 v187, v207, v205, s20
    v_perm_b32 v191, v207, v205, s21
    v_perm_b32 v192, v210, v208, s20
    v_perm_b32 v196, v210, v208, s21
    v_perm_b32 v200, v211, v209, s20
    v_perm_b32 v204, v211, v209, s21
    v_perm_b32 v193, v214, v212, s20
    v_perm_b32 v197, v214, v212, s21
    v_perm_b32 v201, v215, v213, s20
    v_perm_b32 v205, v215, v213, s21
    v_perm_b32 v194, v218, v216, s20
    v_perm_b32 v198, v218, v216, s21
    v_perm_b32 v202, v219, v217, s20
    v_perm_b32 v206, v219, v217, s21
    v_perm_b32 v195, v222, v220, s20
    v_perm_b32 v199, v222, v220, s21
    v_perm_b32 v203, v223, v221, s20
    v_perm_b32 v207, v223, v221, s21
    v_perm_b32 v208, v226, v224, s20
    v_perm_b32 v212, v226, v224, s21
    v_perm_b32 v216, v227, v225, s20
    v_perm_b32 v220, v227, v225, s21
    v_perm_b32 v209, v230, v228, s20
    v_perm_b32 v213, v230, v228, s21
    v_perm_b32 v217, v231, v229, s20
    v_perm_b32 v221, v231, v229, s21
    v_perm_b32 v210, v234, v232, s20
    v_perm_b32 v214, v234, v232, s21
    v_perm_b32 v218, v235, v233, s20
    v_perm_b32 v222, v235, v233, s21
    v_perm_b32 v211, v238, v236, s20
    v_perm_b32 v215, v238, v236, s21
    v_perm_b32 v219, v239, v237, s20
    v_perm_b32 v223, v239, v237, s21
    v_perm_b32 v224, v242, v240, s20
    v_perm_b32 v228, v242, v240, s21
    v_perm_b32 v232, v243, v241, s20
    v_perm_b32 v236, v243, v241, s21
    v_perm_b32 v225, v246, v244, s20
    v_perm_b32 v229, v246, v244, s21
    v_perm_b32 v233, v247, v245, s20
    v_perm_b32 v237, v247, v245, s21
    v_perm_b32 v226, v250, v248, s20
    v_perm_b32 v230, v250, v248, s21
    v_perm_b32 v234, v251, v249, s20
    v_perm_b32 v238, v251, v249, s21
    v_perm_b32 v227, v254, v252, s20
    v_perm_b32 v231, v254, v252, s21
    v_perm_b32 v235, v255, v253, s20
    v_perm_b32 v239, v255, v253, s21
CJ_NP:
MC_6:
    v_or_b32 v53, s12, v24
    v_or_b32 v54, s12, v18
    v_or_b32 v55, s12, v30
    v_max3_u32 v52, v20, v21, v22
    v_max3_u32 v52, v52, v23, v14
    v_max3_u32 v52, v52, v15, v16
    v_max3_u32 v52, v52, v17, v26
    v_max3_u32 v52, v52, v27, v28
    v_max3_u32 v52, v52, v29, v53
    v_max3_u32 v52, v52, v54, v55
    v_cmp_eq_u32 vcc, -1, v52
    s_cbranch_vccz MCD_7
    v_add_u32 v52, 8192, v7
    v_add_u32 v53, 8192, v13
    v_add_u32 v54, 3456, v52
    v_add_u32 v55, 3456, v53
    global_load_dwordx4 v[20:23], v54, s[68:69] sc1
    global_load_ushort v24, v55, s[68:69] sc1
    v_add_u32 v54, 4608, v52
    v_add_u32 v55, 4608, v53
    global_load_dwordx4 v[14:17], v54, s[68:69] sc1
    global_load_ushort v18, v55, s[68:69] sc1
    v_add_u32 v54, 5760, v52
    v_add_u32 v55, 5760, v53
    global_load_dwordx4 v[26:29], v54, s[68:69] sc1
    global_load_ushort v30, v55, s[68:69] sc1
    s_waitcnt vmcnt(0)
    s_sub_u32 s10, s10, 1
    s_cbranch_scc1 EXIT
    s_branch MC_6
MCD_7:
    v_lshlrev_b32 v32, 16, v14
    v_and_b32 v33, s12, v14
    v_lshlrev_b32 v34, 16, v15
    v_and_b32 v35, s12, v15
    v_lshlrev_b32 v36, 16, v16
    v_and_b32 v37, s12, v16
    v_lshlrev_b32 v38, 16, v17
    v_and_b32 v39, s12, v17
    v_lshlrev_b32 v40, 16, v18
    v_lshlrev_b32 v42, 16, v20
    v_and_b32 v43, s12, v20
    v_lshlrev_b32 v44, 16, v21
    v_and_b32 v45, s12, v21
    v_lshlrev_b32 v46, 16, v22
    v_and_b32 v47, s12, v22
    v_lshlrev_b32 v48, 16, v23
    v_and_b32 v49, s12, v23
    v_lshlrev_b32 v50, 16, v24
    v_pk_add_f32 v[32:33], v[32:33], 1.0 op_sel_hi:[1,0]
    v_pk_add_f32 v[34:35], v[34:35], 1.0 op_sel_hi:[1,0]
    v_pk_add_f32 v[36:37], v[36:37], 1.0 op_sel_hi:[1,0]
    v_pk_add_f32 v[38:39], v[38:39], 1.0 op_sel_hi:[1,0]
    v_add_f32 v40, 1.0, v40
    v_cvt_pk_bf16_f32 v52, v32, v33
    v_cvt_pk_bf16_f32 v53, v34, v35
    v_cvt_pk_bf16_f32 v54, v36, v37
    v_cvt_pk_bf16_f32 v55, v38, v39
    v_cvt_pk_bf16_f32 v56, v40, v40
    v_lshlrev_b32 v32, 16, v52
    v_and_b32 v33, s12, v52
    v_lshlrev_b32 v34, 16, v53
    v_and_b32 v35, s12, v53
    v_lshlrev_b32 v36, 16, v54
    v_and_b32 v37, s12, v54
    v_lshlrev_b32 v38, 16, v55
    v_and_b32 v39, s12, v55
    v_lshlrev_b32 v40, 16, v56
    s_waitcnt vmcnt(0)
    s_branch GPOLL
NONCONV:
    s_waitcnt lgkmcnt(0)
    s_cmp_lt_u32 s3, 4
    s_cbranch_scc1 NC_A0
    s_lshl_b32 s20, s2, 2
    s_add_u32 s20, s20, s9
    s_mul_i32 s20, s20, 2304
    v_add_u32 v58, s20, v7
    v_add_u32 v59, s20, v13
    global_load_dwordx4 v[64:67], v58, s[36:37]
    global_load_ushort v68, v59, s[36:37]
    global_load_dwordx4 v[70:73], v58, s[36:37] offset:1152
    global_load_ushort v74, v59, s[36:37] offset:1152
    v_mov_b32 v60, -1
    v_mov_b32 v61, -1
    v_mov_b32 v62, -1
    v_mul_u32_u24 v57, 12, v1
    s_mul_i32 s20, s2, 9216
    s_mul_i32 s21, s9, 2304
    s_add_u32 s20, s20, s21
    s_add_u32 s20, s20, 1048576
    v_add_u32 v57, s20, v57
    global_store_dwordx3 v57, v[60:62], s[68:69] sc1
    global_store_dwordx3 v57, v[60:62], s[68:69] offset:768 sc1
    global_store_dwordx3 v57, v[60:62], s[68:69] offset:1536 sc1
    s_lshl_b32 s20, s2, 4
    s_add_u32 s20, s20, 16384
    v_lshl_add_u32 v57, v1, 2, s20
    s_lshl_b32 s20, s2, 6
    s_add_u32 s20, s20, 20480
    v_writelane_b32 v57, s20, 4
    v_mov_b32 v56, 0
    v_lshlrev_b32 v55, 3, v1
    v_add_u32 v55, 143360, v55
    s_mov_b64 exec, 0x1f
    global_store_dword v57, v60, s[68:69] sc1
    ds_write2_b32 v55, v56, v56 offset0:0 offset1:1
    s_mov_b64 exec, -1
    global_load_dwordx4 v[76:79], v56, s[66:67] sc1
    s_branch NC_J0
NC_A0:
    v_mov_b32 v56, 0
    global_load_dwordx4 v[76:79], v56, s[66:67] sc1
NC_J0:
    s_cmp_lt_u32 s7, 108
    s_cbranch_scc1 NC_MOD1
    s_waitcnt vmcnt(0)
    s_branch NC_NOMOD1
NC_MOD1:
    v_lshrrev_b32 v52, 2, v1
    s_mul_i32 s20, s3, 72
    v_add_u32 v52, s20, v52
    v_lshlrev_b32 v53, 1, v52
    s_movk_i32 s20, 6912
    v_mul_u32_u24 v52, s20, v52
    v_and_b32 v54, 3, v1
    s_lshl_b32 s21, s7, 6
    v_lshl_add_u32 v54, v54, 4, s21
    v_add_u32 v52, v52, v54
    v_mov_b32 v128, 0
    v_mov_b32 v129, 0
    v_mov_b32 v130, 0
    v_mov_b32 v131, 0
    v_mov_b32 v132, 0
    v_mov_b32 v136, 0
    global_load_dwordx4 v[112:115], v52, s[62:63]
    v_add_u32 v52, 110592, v52
    global_load_dwordx4 v[116:119], v52, s[62:63]
    v_add_u32 v52, 110592, v52
    global_load_dwordx4 v[120:123], v52, s[62:63]
    v_add_u32 v52, 110592, v52
    global_load_dwordx4 v[124:127], v52, s[62:63]
    v_add_u32 v52, 110592, v52
    s_mov_b32 exec_hi, 0
    global_load_dwordx4 v[128:131], v52, s[62:63]
    global_load_ushort v136, v53, s[60:61] offset:128
    s_mov_b32 exec_hi, -1
    global_load_ushort v132, v53, s[60:61]
    global_load_ushort v133, v53, s[60:61] offset:32
    global_load_ushort v134, v53, s[60:61] offset:64
    global_load_ushort v135, v53, s[60:61] offset:96
NC_NOMOD1:
    s_cmp_lt_u32 s3, 4
    s_cbranch_scc1 NC_A1
    s_waitcnt vmcnt(15)
    v_lshlrev_b32 v80, 16, v64
    v_and_b32 v81, s12, v64
    v_lshlrev_b32 v82, 16, v65
    v_and_b32 v83, s12, v65
    v_lshlrev_b32 v84, 16, v66
    v_and_b32 v85, s12, v66
    v_lshlrev_b32 v86, 16, v67
    v_and_b32 v87, s12, v67
    v_lshlrev_b32 v88, 16, v68
    v_lshlrev_b32 v90, 16, v70
    v_and_b32 v91, s12, v70
    v_lshlrev_b32 v92, 16, v71
    v_and_b32 v93, s12, v71
    v_lshlrev_b32 v94, 16, v72
    v_and_b32 v95, s12, v72
    v_lshlrev_b32 v96, 16, v73
    v_and_b32 v97, s12, v73
    v_lshlrev_b32 v98, 16, v74
    v_readfirstlane_b32 s22, v80
    s_nop 1
    v_subrev_f32 v80, s22, v80
    v_subrev_f32 v81, s22, v81
    v_subrev_f32 v82, s22, v82
    v_subrev_f32 v83, s22, v83
    v_subrev_f32 v84, s22, v84
    v_subrev_f32 v85, s22, v85
    v_subrev_f32 v86, s22, v86
    v_subrev_f32 v87, s22, v87
    v_subrev_f32 v88, s22, v88
    v_pk_add_f32 v[100:101], v[80:81], v[82:83]
    v_pk_mul_f32 v[102:103], v[80:81], v[80:81]
    v_pk_add_f32 v[100:101], v[100:101], v[84:85]
    v_pk_fma_f32 v[102:103], v[82:83], v[82:83], v[102:103]
    v_pk_add_f32 v[100:101], v[100:101], v[86:87]
    v_pk_fma_f32 v[102:103], v[84:85], v[84:85], v[102:103]
    v_add_f32 v100, v100, v88
    v_pk_fma_f32 v[102:103], v[86:87], v[86:87], v[102:103]
    v_add_f32 v100, v100, v101
    v_fmac_f32 v102, v88, v88
    v_add_f32 v102, v102, v103
    v_readfirstlane_b32 s23, v90
    s_nop 1
    v_subrev_f32 v90, s23, v90
    v_subrev_f32 v91, s23, v91
    v_subrev_f32 v92, s23, v92
    v_subrev_f32 v93, s23, v93
    v_subrev_f32 v94, s23, v94
    v_subrev_f32 v95, s23, v95
    v_subrev_f32 v96, s23, v96
    v_subrev_f32 v97, s23, v97
    v_subrev_f32 v98, s23, v98
    v_pk_add_f32 v[104:105], v[90:91], v[92:93]
    v_pk_mul_f32 v[106:107], v[90:91], v[90:91]
    v_pk_add_f32 v[104:105], v[104:105], v[94:95]
    v_pk_fma_f32 v[106:107], v[92:93], v[92:93], v[106:107]
    v_pk_add_f32 v[104:105], v[104:105], v[96:97]
    v_pk_fma_f32 v[106:107], v[94:95], v[94:95], v[106:107]
    v_add_f32 v104, v104, v98
    v_pk_fma_f32 v[106:107], v[96:97], v[96:97], v[106:107]
    v_add_f32 v104, v104, v105
    v_fmac_f32 v106, v98, v98
    v_add_f32 v106, v106, v107
    v_permlane32_swap_b32 v100, v104
    s_nop 0
    v_permlane32_swap_b32 v102, v106
    v_add_f32 v100, v100, v104
    v_add_f32 v102, v102, v106
    s_nop 1
    v_permlane16_swap_b32 v100, v102
    v_add_f32 v100, v100, v102
    s_nop 1
    v_add_f32_dpp v100, v100, v100 row_ror:8 row_mask:0xf bank_mask:0xf
    s_nop 1
    v_add_f32_dpp v100, v100, v100 row_ror:4 row_mask:0xf bank_mask:0xf
    s_nop 1
    v_add_f32_dpp v100, v100, v100 row_ror:2 row_mask:0xf bank_mask:0xf
    s_nop 1
    v_add_f32_dpp v100, v100, v100 row_ror:1 row_mask:0xf bank_mask:0xf
    v_mov_b32 v102, v100
    s_nop 1
    v_permlane16_swap_b32 v100, v102
    v_mov_b32 v104, s22
    v_mov_b32 v105, s23
    v_cmp_gt_u32 vcc, 32, v1
    s_nop 1
    v_cndmask_b32 v104, v105, v104, vcc
    v_mul_f32 v100, 0x3ae38e39, v100
    v_mul_f32 v102, 0x3ae38e39, v102
    v_add_f32 v105, v104, v100
    v_fma_f32 v107, -v100, v100, v102
    v_max_f32 v107, 0, v107
    v_cvt_pk_bf16_f32 v107, v107, v107
    v_and_b32 v107, s12, v107
    v_add_f32 v107, 0x3727c5ac, v107
    v_cvt_pk_bf16_f32 v107, v107, v107
    v_and_b32 v107, s12, v107
    v_sqrt_f32 v106, v107
    s_nop 0
    v_cvt_pk_bf16_f32 v105, v105, v106
    v_min_u32 v105, -2, v105
    s_lshl_b32 s20, s2, 2
    s_add_u32 s20, s20, s9
    s_lshl_b32 s20, s20, 3
    v_lshrrev_b32 v104, 5, v1
    v_lshl_add_u32 v104, v104, 2, s20
    s_waitcnt vmcnt(10)
GO_8:
    v_min3_u32 v80, v76, v77, v78
    v_min_u32 v80, v80, v79
    v_cmp_eq_u32 vcc, 0, v80
    s_cbranch_vccz GOD_9
    v_mov_b32 v80, 0
    global_load_dwordx4 v[76:79], v80, s[66:67] sc1
    s_waitcnt vmcnt(0)
    s_sub_u32 s10, s10, 1
    s_cbranch_scc1 EXIT
    s_branch GO_8
GOD_9:
    s_mov_b32 exec_lo, 1
    s_mov_b32 exec_hi, 1
    global_store_dword v104, v105, s[68:69] sc1
    s_mov_b64 exec, -1
    s_branch NC_J1
NC_A1:
    s_waitcnt vmcnt(0)
NC_J1:
    s_cmp_ge_u32 s7, 108
    s_cbranch_scc1 NC_NOMOD2
    s_waitcnt vmcnt(1)
    v_lshlrev_b32 v132, 16, v132
    v_mul_f32 v64, 0xbfb8aa3b, v132
    v_exp_f32 v64, v64
    v_lshlrev_b32 v133, 16, v133
    v_mul_f32 v65, 0xbfb8aa3b, v133
    v_exp_f32 v65, v65
    v_lshlrev_b32 v134, 16, v134
    v_mul_f32 v66, 0xbfb8aa3b, v134
    v_exp_f32 v66, v66
    v_lshlrev_b32 v135, 16, v135
    v_mul_f32 v67, 0xbfb8aa3b, v135
    v_exp_f32 v67, v67
    v_lshlrev_b32 v136, 16, v136
    v_mul_f32 v68, 0xbfb8aa3b, v136
    v_exp_f32 v68, v68
    v_add_f32 v64, 1.0, v64
    v_rcp_f32 v64, v64
    v_add_f32 v65, 1.0, v65
    v_rcp_f32 v65, v65
    v_add_f32 v66, 1.0, v66
    v_rcp_f32 v66, v66
    v_add_f32 v67, 1.0, v67
    v_rcp_f32 v67, v67
    v_add_f32 v68, 1.0, v68
    v_rcp_f32 v68, v68
    v_mul_f32 v64, v132, v64
    v_mul_f32 v65, v133, v65
    v_mul_f32 v66, v134, v66
    v_mul_f32 v67, v135, v67
    v_mul_f32 v68, v136, v68
    v_cvt_pk_bf16_f32 v80, v64, v64
    v_and_b32 v80, s12, v80
    v_cvt_pk_bf16_f32 v82, v65, v65
    v_and_b32 v82, s12, v82
    v_cvt_pk_bf16_f32 v84, v66, v66
    v_and_b32 v84, s12, v84
    v_cvt_pk_bf16_f32 v86, v67, v67
    v_and_b32 v86, s12, v86
    v_cvt_pk_bf16_f32 v88, v68, v68
    v_and_b32 v88, s12, v88
    v_lshlrev_b32 v64, 16, v112
    v_and_b32 v65, s12, v112
    v_lshlrev_b32 v66, 16, v113
    v_and_b32 v67, s12, v113
    v_lshlrev_b32 v68, 16, v114
    v_and_b32 v69, s12, v114
    v_lshlrev_b32 v70, 16, v115
    v_and_b32 v71, s12, v115
    v_pk_mul_f32 v[140:141], v[64:65], v[80:81] op_sel_hi:[1,0]
    v_pk_mul_f32 v[142:143], v[66:67], v[80:81] op_sel_hi:[1,0]
    v_pk_mul_f32 v[144:145], v[68:69], v[80:81] op_sel_hi:[1,0]
    v_pk_mul_f32 v[146:147], v[70:71], v[80:81] op_sel_hi:[1,0]
    v_lshlrev_b32 v64, 16, v116
    v_and_b32 v65, s12, v116
    v_lshlrev_b32 v66, 16, v117
    v_and_b32 v67, s12, v117
    v_lshlrev_b32 v68, 16, v118
    v_and_b32 v69, s12, v118
    v_lshlrev_b32 v70, 16, v119
    v_and_b32 v71, s12, v119
    v_pk_fma_f32 v[140:141], v[64:65], v[82:83], v[140:141] op_sel_hi:[1,0,1]
    v_pk_fma_f32 v[142:143], v[66:67], v[82:83], v[142:143] op_sel_hi:[1,0,1]
    v_pk_fma_f32 v[144:145], v[68:69], v[82:83], v[144:145] op_sel_hi:[1,0,1]
    v_pk_fma_f32 v[146:147], v[70:71], v[82:83], v[146:147] op_sel_hi:[1,0,1]
    v_lshlrev_b32 v64, 16, v120
    v_and_b32 v65, s12, v120
    v_lshlrev_b32 v66, 16, v121
    v_and_b32 v67, s12, v121
    v_lshlrev_b32 v68, 16, v122
    v_and_b32 v69, s12, v122
    v_lshlrev_b32 v70, 16, v123
    v_and_b32 v71, s12, v123
    v_pk_fma_f32 v[140:141], v[64:65], v[84:85], v[140:141] op_sel_hi:[1,0,1]
    v_pk_fma_f32 v[142:143], v[66:67], v[84:85], v[142:143] op_sel_hi:[1,0,1]
    v_pk_fma_f32 v[144:145], v[68:69], v[84:85], v[144:145] op_sel_hi:[1,0,1]
    v_pk_fma_f32 v[146:147], v[70:71], v[84:85], v[146:147] op_sel_hi:[1,0,1]
    v_lshlrev_b32 v64, 16, v124
    v_and_b32 v65, s12, v124
    v_lshlrev_b32 v66, 16, v125
    v_and_b32 v67, s12, v125
    v_lshlrev_b32 v68, 16, v126
    v_and_b32 v69, s12, v126
    v_lshlrev_b32 v70, 16, v127
    v_and_b32 v71, s12, v127
    v_pk_fma_f32 v[140:141], v[64:65], v[86:87], v[140:141] op_sel_hi:[1,0,1]
    v_pk_fma_f32 v[142:143], v[66:67], v[86:87], v[142:143] op_sel_hi:[1,0,1]
    v_pk_fma_f32 v[144:145], v[68:69], v[86:87], v[144:145] op_sel_hi:[1,0,1]
    v_pk_fma_f32 v[146:147], v[70:71], v[86:87], v[146:147] op_sel_hi:[1,0,1]
    v_lshlrev_b32 v64, 16, v128
    v_and_b32 v65, s12, v128
    v_lshlrev_b32 v66, 16, v129
    v_and_b32 v67, s12, v129
    v_lshlrev_b32 v68, 16, v130
    v_and_b32 v69, s12, v130
    v_lshlrev_b32 v70, 16, v131
    v_and_b32 v71, s12, v131
    v_pk_fma_f32 v[140:141], v[64:65], v[88:89], v[140:141] op_sel_hi:[1,0,1]
    v_pk_fma_f32 v[142:143], v[66:67], v[88:89], v[142:143] op_sel_hi:[1,0,1]
    v_pk_fma_f32 v[144:145], v[68:69], v[88:89], v[144:145] op_sel_hi:[1,0,1]
    v_pk_fma_f32 v[146:147], v[70:71], v[88:89], v[146:147] op_sel_hi:[1,0,1]
    s_nop 0
    v_permlane32_swap_b32 v140, v144
    v_permlane32_swap_b32 v141, v145
    v_permlane32_swap_b32 v142, v146
    v_permlane32_swap_b32 v143, v147
    v_pk_add_f32 v[140:141], v[140:141], v[144:145]
    v_pk_add_f32 v[142:143], v[142:143], v[146:147]
    s_nop 1
    v_permlane16_swap_b32 v140, v142
    v_permlane16_swap_b32 v141, v143
    v_pk_add_f32 v[140:141], v[140:141], v[142:143]
    s_nop 1
    v_add_f32_dpp v140, v140, v140 row_ror:4 row_mask:0xf bank_mask:0xf
    v_add_f32_dpp v141, v141, v141 row_ror:4 row_mask:0xf bank_mask:0xf
    s_nop 0
    v_add_f32_dpp v140, v140, v140 row_ror:8 row_mask:0xf bank_mask:0xf
    v_add_f32_dpp v141, v141, v141 row_ror:8 row_mask:0xf bank_mask:0xf
    v_and_b32 v64, 3, v1
    v_lshlrev_b32 v64, 5, v64
    v_lshrrev_b32 v65, 4, v1
    v_lshl_add_u32 v64, v65, 3, v64
    s_lshl_b32 s20, s3, 7
    s_add_u32 s20, s20, 143872
    v_add_u32 v64, s20, v64
    s_mov_b32 exec_lo, 0x000f000f
    s_mov_b32 exec_hi, 0x000f000f
    ds_write_b64 v64, v[140:141]
    s_mov_b64 exec, -1
    s_waitcnt lgkmcnt(0)
    s_barrier
    s_cmp_lg_u32 s3, 0
    s_cbranch_scc1 NC_NOMOD2
    v_and_b32 v64, 15, v1
    v_lshlrev_b32 v65, 3, v64
    v_add_u32 v65, 143872, v65
    ds_read_b64 v[80:81], v65 offset:0
    ds_read_b64 v[82:83], v65 offset:128
    ds_read_b64 v[84:85], v65 offset:256
    ds_read_b64 v[86:87], v65 offset:384
    ds_read_b64 v[88:89], v65 offset:512
    ds_read_b64 v[90:91], v65 offset:640
    ds_read_b64 v[92:93], v65 offset:768
    ds_read_b64 v[94:95], v65 offset:896
    s_lshl_b32 s20, s7, 6
    s_add_u32 s20, s20, 8192
    v_lshl_add_u32 v64, v64, 2, s20
    s_waitcnt lgkmcnt(0)
    v_pk_add_f32 v[80:81], v[80:81], v[88:89]
    v_pk_add_f32 v[82:83], v[82:83], v[90:91]
    v_pk_add_f32 v[84:85], v[84:85], v[92:93]
    v_pk_add_f32 v[86:87], v[86:87], v[94:95]
    v_pk_add_f32 v[80:81], v[80:81], v[84:85]
    v_pk_add_f32 v[82:83], v[82:83], v[86:87]
    v_pk_add_f32 v[80:81], v[80:81], v[82:83]
    v_cvt_pk_bf16_f32 v66, v80, v81
    v_min_u32 v66, -2, v66
    s_waitcnt vmcnt(0)
GO_10:
    v_min3_u32 v80, v76, v77, v78
    v_min_u32 v80, v80, v79
    v_cmp_eq_u32 vcc, 0, v80
    s_cbranch_vccz GOD_11
    v_mov_b32 v80, 0
    global_load_dwordx4 v[76:79], v80, s[66:67] sc1
    s_waitcnt vmcnt(0)
    s_sub_u32 s10, s10, 1
    s_cbranch_scc1 EXIT
    s_branch GO_10
GOD_11:
    s_mov_b64 exec, 0xffff
    global_store_dword v64, v66, s[68:69] sc1
    s_mov_b64 exec, -1
NC_NOMOD2:
    s_mul_i32 s20, s11, 1152
    v_add_u32 v52, s20, v7
    v_add_u32 v53, s20, v13
    global_load_dwordx4 v[2:5], v52, s[36:37]
    global_load_ushort v6, v53, s[36:37]
    global_load_dwordx4 v[8:11], v7, s[52:53]
    global_load_ushort v12, v13, s[52:53]
    s_cmp_lt_u32 s3, 4
    s_cbranch_scc1 NC_A2
    v_mov_b32 v60, -1
    v_mov_b32 v61, -1
    v_mov_b32 v62, -1
    v_mul_u32_u24 v59, 12, v1
    s_mul_i32 s20, s2, 9216
    s_mul_i32 s21, s9, 2304
    s_add_u32 s20, s20, s21
    s_add_u32 s20, s20, 4194304
    v_add_u32 v58, s20, v59
    global_store_dwordx3 v58, v[60:62], s[68:69] sc1
    global_store_dwordx3 v58, v[60:62], s[68:69] offset:768 sc1
    global_store_dwordx3 v58, v[60:62], s[68:69] offset:1536 sc1
    s_mul_i32 s20, s8, 18432
    s_mul_i32 s21, s9, 4608
    s_add_u32 s20, s20, s21
    s_add_u32 s20, s20, 7342336
    v_add_u32 v58, s20, v59
    global_store_dwordx3 v58, v[60:62], s[68:69] offset:-2304 sc1
    global_store_dwordx3 v58, v[60:62], s[68:69] offset:-1536 sc1
    global_store_dwordx3 v58, v[60:62], s[68:69] offset:-768 sc1
    global_store_dwordx3 v58, v[60:62], s[68:69] sc1
    global_store_dwordx3 v58, v[60:62], s[68:69] offset:768 sc1
    global_store_dwordx3 v58, v[60:62], s[68:69] offset:1536 sc1
    v_and_b32 v52, 7, v1
    v_lshlrev_b32 v52, 3, v52
    v_lshrrev_b32 v53, 4, v1
    s_mul_i32 s20, s9, 294912
    s_lshl_b32 s21, s8, 6
    s_add_u32 s20, s20, s21
    s_mov_b32 s21, 73728
    v_mad_u32_u24 v52, v53, s21, v52
    v_add_u32 v52, s20, v52
    v_and_b32 v54, 8, v1
    v_cmp_eq_u32 vcc, 0, v54
    v_mov_b32 v54, s56
    v_mov_b32 v55, s54
    v_cndmask_b32 v54, v54, v55, vcc
    v_mov_b32 v55, s57
    v_mov_b32 v56, s55
    v_cndmask_b32 v55, v55, v56, vcc
    v_add_co_u32 v54, vcc, v54, v52
    s_nop 1
    v_addc_co_u32 v55, vcc, 0, v55, vcc
    s_mov_b32 s20, 9216
    s_mov_b32 s21, 0
    s_mov_b32 s22, 1115136
    s_mov_b32 s23, 0
    global_load_dwordx2 v[128:129], v[54:55], off
    v_lshl_add_u64 v[54:55], v[54:55], 0, s[20:21]
    global_load_dwordx2 v[130:131], v[54:55], off
    v_lshl_add_u64 v[54:55], v[54:55], 0, s[20:21]
    global_load_dwordx2 v[132:133], v[54:55], off
    v_lshl_add_u64 v[54:55], v[54:55], 0, s[20:21]
    global_load_dwordx2 v[134:135], v[54:55], off
    v_lshl_add_u64 v[54:55], v[54:55], 0, s[20:21]
    global_load_dwordx2 v[136:137], v[54:55], off
    v_lshl_add_u64 v[54:55], v[54:55], 0, s[20:21]
    global_load_dwordx2 v[138:139], v[54:55], off
    v_lshl_add_u64 v[54:55], v[54:55], 0, s[20:21]
    global_load_dwordx2 v[140:141], v[54:55], off
    v_lshl_add_u64 v[54:55], v[54:55], 0, s[20:21]
    global_load_dwordx2 v[142:143], v[54:55], off
    v_lshl_add_u64 v[54:55], v[54:55], 0, s[22:23]
    global_load_dwordx2 v[144:145], v[54:55], off
    v_lshl_add_u64 v[54:55], v[54:55], 0, s[20:21]
    global_load_dwordx2 v[146:147], v[54:55], off
    v_lshl_add_u64 v[54:55], v[54:55], 0, s[20:21]
    global_load_dwordx2 v[148:149], v[54:55], off
    v_lshl_add_u64 v[54:55], v[54:55], 0, s[20:21]
    global_load_dwordx2 v[150:151], v[54:55], off
    v_lshl_add_u64 v[54:55], v[54:55], 0, s[20:21]
    global_load_dwordx2 v[152:153], v[54:55], off
    v_lshl_add_u64 v[54:55], v[54:55], 0, s[20:21]
    global_load_dwordx2 v[154:155], v[54:55], off
    v_lshl_add_u64 v[54:55], v[54:55], 0, s[20:21]
    global_load_dwordx2 v[156:157], v[54:55], off
    v_lshl_add_u64 v[54:55], v[54:55], 0, s[20:21]
    global_load_dwordx2 v[158:159], v[54:55], off
    v_lshl_add_u64 v[54:55], v[54:55], 0, s[22:23]
    global_load_dwordx2 v[160:161], v[54:55], off
    v_lshl_add_u64 v[54:55], v[54:55], 0, s[20:21]
    global_load_dwordx2 v[162:163], v[54:55], off
    v_lshl_add_u64 v[54:55], v[54:55], 0, s[20:21]
    global_load_dwordx2 v[164:165], v[54:55], off
    v_lshl_add_u64 v[54:55], v[54:55], 0, s[20:21]
    global_load_dwordx2 v[166:167], v[54:55], off
    v_lshl_add_u64 v[54:55], v[54:55], 0, s[20:21]
    global_load_dwordx2 v[168:169], v[54:55], off
    v_lshl_add_u64 v[54:55], v[54:55], 0, s[20:21]
    global_load_dwordx2 v[170:171], v[54:55], off
    v_lshl_add_u64 v[54:55], v[54:55], 0, s[20:21]
    global_load_dwordx2 v[172:173], v[54:55], off
    v_lshl_add_u64 v[54:55], v[54:55], 0, s[20:21]
    global_load_dwordx2 v[174:175], v[54:55], off
    v_lshl_add_u64 v[54:55], v[54:55], 0, s[22:23]
    global_load_dwordx2 v[176:177], v[54:55], off
    v_lshl_add_u64 v[54:55], v[54:55], 0, s[20:21]
    global_load_dwordx2 v[178:179], v[54:55], off
    v_lshl_add_u64 v[54:55], v[54:55], 0, s[20:21]
    global_load_dwordx2 v[180:181], v[54:55], off
    v_lshl_add_u64 v[54:55], v[54:55], 0, s[20:21]
    global_load_dwordx2 v[182:183], v[54:55], off
    v_lshl_add_u64 v[54:55], v[54:55], 0, s[20:21]
    global_load_dwordx2 v[184:185], v[54:55], off
    v_lshl_add_u64 v[54:55], v[54:55], 0, s[20:21]
    global_load_dwordx2 v[186:187], v[54:55], off
    v_lshl_add_u64 v[54:55], v[54:55], 0, s[20:21]
    global_load_dwordx2 v[188:189], v[54:55], off
    v_lshl_add_u64 v[54:55], v[54:55], 0, s[20:21]
    global_load_dwordx2 v[190:191], v[54:55], off
    v_lshl_add_u64 v[54:55], v[54:55], 0, s[22:23]
    s_cmp_ge_u32 s9, 2
    s_cbranch_scc1 W5_12
    global_load_dwordx2 v[192:193], v[54:55], off
    v_lshl_add_u64 v[54:55], v[54:55], 0, s[20:21]
    global_load_dwordx2 v[194:195], v[54:55], off
    v_lshl_add_u64 v[54:55], v[54:55], 0, s[20:21]
    global_load_dwordx2 v[196:197], v[54:55], off
    v_lshl_add_u64 v[54:55], v[54:55], 0, s[20:21]
    global_load_dwordx2 v[198:199], v[54:55], off
    v_lshl_add_u64 v[54:55], v[54:55], 0, s[20:21]
    global_load_dwordx2 v[200:201], v[54:55], off
    v_lshl_add_u64 v[54:55], v[54:55], 0, s[20:21]
    global_load_dwordx2 v[202:203], v[54:55], off
    v_lshl_add_u64 v[54:55], v[54:55], 0, s[20:21]
    global_load_dwordx2 v[204:205], v[54:55], off
    v_lshl_add_u64 v[54:55], v[54:55], 0, s[20:21]
    global_load_dwordx2 v[206:207], v[54:55], off
W5_12:
    v_and_b32 v52, 15, v1
    v_lshlrev_b32 v52, 3, v52
    s_movk_i32 s21, 1152
    v_mad_u32_u24 v52, v53, s21, v52
    s_mul_i32 s20, s8, 36864
    s_lshl_b32 s21, s9, 7
    s_add_u32 s20, s20, s21
    v_add_u32 v52, s20, v52
    global_load_dwordx2 v[208:209], v52, s[58:59]
    global_load_dwordx2 v[224:225], v52, s[58:59] offset:512
    v_add_u32 v52, 4608, v52
    global_load_dwordx2 v[210:211], v52, s[58:59]
    global_load_dwordx2 v[226:227], v52, s[58:59] offset:512
    v_add_u32 v52, 4608, v52
    global_load_dwordx2 v[212:213], v52, s[58:59]
    global_load_dwordx2 v[228:229], v52, s[58:59] offset:512
    v_add_u32 v52, 4608, v52
    global_load_dwordx2 v[214:215], v52, s[58:59]
    global_load_dwordx2 v[230:231], v52, s[58:59] offset:512
    v_add_u32 v52, 4608, v52
    global_load_dwordx2 v[216:217], v52, s[58:59]
    global_load_dwordx2 v[232:233], v52, s[58:59] offset:512
    v_add_u32 v52, 4608, v52
    global_load_dwordx2 v[218:219], v52, s[58:59]
    global_load_dwordx2 v[234:235], v52, s[58:59] offset:512
    v_add_u32 v52, 4608, v52
    global_load_dwordx2 v[220:221], v52, s[58:59]
    global_load_dwordx2 v[236:237], v52, s[58:59] offset:512
    v_add_u32 v52, 4608, v52
    global_load_dwordx2 v[222:223], v52, s[58:59]
    global_load_dwordx2 v[238:239], v52, s[58:59] offset:512
    s_cmp_lg_u32 s9, 3
    s_cbranch_scc1 W8_13
    global_load_dwordx2 v[254:255], v52, s[58:59] offset:640
    v_subrev_u32 v52, 4608, v52
    global_load_dwordx2 v[252:253], v52, s[58:59] offset:640
    v_subrev_u32 v52, 4608, v52
    global_load_dwordx2 v[250:251], v52, s[58:59] offset:640
    v_subrev_u32 v52, 4608, v52
    global_load_dwordx2 v[248:249], v52, s[58:59] offset:640
    v_subrev_u32 v52, 4608, v52
    global_load_dwordx2 v[246:247], v52, s[58:59] offset:640
    v_subrev_u32 v52, 4608, v52
    global_load_dwordx2 v[244:245], v52, s[58:59] offset:640
    v_subrev_u32 v52, 4608, v52
    global_load_dwordx2 v[242:243], v52, s[58:59] offset:640
    v_subrev_u32 v52, 4608, v52
    global_load_dwordx2 v[240:241], v52, s[58:59] offset:640
W8_13:
    s_waitcnt vmcnt(0)
    s_mov_b32 s20, 0x05040100
    s_mov_b32 s21, 0x07060302
    v_perm_b32 v112, v130, v128, s20
    v_perm_b32 v116, v130, v128, s21
    v_perm_b32 v120, v131, v129, s20
    v_perm_b32 v124, v131, v129, s21
    v_perm_b32 v113, v134, v132, s20
    v_perm_b32 v117, v134, v132, s21
    v_perm_b32 v121, v135, v133, s20
    v_perm_b32 v125, v135, v133, s21
    v_perm_b32 v114, v138, v136, s20
    v_perm_b32 v118, v138, v136, s21
    v_perm_b32 v122, v139, v137, s20
    v_perm_b32 v126, v139, v137, s21
    v_perm_b32 v115, v142, v140, s20
    v_perm_b32 v119, v142, v140, s21
    v_perm_b32 v123, v143, v141, s20
    v_perm_b32 v127, v143, v141, s21
    v_perm_b32 v128, v146, v144, s20
    v_perm_b32 v132, v146, v144, s21
    v_perm_b32 v136, v147, v145, s20
    v_perm_b32 v140, v147, v145, s21
    v_perm_b32 v129, v150, v148, s20
    v_perm_b32 v133, v150, v148, s21
    v_perm_b32 v137, v151, v149, s20
    v_perm_b32 v141, v151, v149, s21
    v_perm_b32 v130, v154, v152, s20
    v_perm_b32 v134, v154, v152, s21
    v_perm_b32 v138, v155, v153, s20
    v_perm_b32 v142, v155, v153, s21
    v_perm_b32 v131, v158, v156, s20
    v_perm_b32 v135, v158, v156, s21
    v_perm_b32 v139, v159, v157, s20
    v_perm_b32 v143, v159, v157, s21
    v_perm_b32 v144, v162, v160, s20
    v_perm_b32 v148, v162, v160, s21
    v_perm_b32 v152, v163, v161, s20
    v_perm_b32 v156, v163, v161, s21
    v_perm_b32 v145, v166, v164, s20
    v_perm_b32 v149, v166, v164, s21
    v_perm_b32 v153, v167, v165, s20
    v_perm_b32 v157, v167, v165, s21
    v_perm_b32 v146, v170, v168, s20
    v_perm_b32 v150, v170, v168, s21
    v_perm_b32 v154, v171, v169, s20
    v_perm_b32 v158, v171, v169, s21
    v_perm_b32 v147, v174, v172, s20
    v_perm_b32 v151, v174, v172, s21
    v_perm_b32 v155, v175, v173, s20
    v_perm_b32 v159, v175, v173, s21
    v_perm_b32 v160, v178, v176, s20
    v_perm_b32 v164, v178, v176, s21
    v_perm_b32 v168, v179, v177, s20
    v_perm_b32 v172, v179, v177, s21
    v_perm_b32 v161, v182, v180, s20
    v_perm_b32 v165, v182, v180, s21
    v_perm_b32 v169, v183, v181, s20
    v_perm_b32 v173, v183, v181, s21
    v_perm_b32 v162, v186, v184, s20
    v_perm_b32 v166, v186, v184, s21
    v_perm_b32 v170, v187, v185, s20
    v_perm_b32 v174, v187, v185, s21
    v_perm_b32 v163, v190, v188, s20
    v_perm_b32 v167, v190, v188, s21
    v_perm_b32 v171, v191, v189, s20
    v_perm_b32 v175, v191, v189, s21
    v_perm_b32 v176, v194, v192, s20
    v_perm_b32 v180, v194, v192, s21
    v_perm_b32 v184, v195, v193, s20
    v_perm_b32 v188, v195, v193, s21
    v_perm_b32 v177, v198, v196, s20
    v_perm_b32 v181, v198, v196, s21
    v_perm_b32 v185, v199, v197, s20
    v_perm_b32 v189, v199, v197, s21
    v_perm_b32 v178, v202, v200, s20
    v_perm_b32 v182, v202, v200, s21
    v_perm_b32 v186, v203, v201, s20
    v_perm_b32 v190, v203, v201, s21
    v_perm_b32 v179, v206, v204, s20
    v_perm_b32 v183, v206, v204, s21
    v_perm_b32 v187, v207, v205, s20
    v_perm_b32 v191, v207, v205, s21
    v_perm_b32 v192, v210, v208, s20
    v_perm_b32 v196, v210, v208, s21
    v_perm_b32 v200, v211, v209, s20
    v_perm_b32 v204, v211, v209, s21
    v_perm_b32 v193, v214, v212, s20
    v_perm_b32 v197, v214, v212, s21
    v_perm_b32 v201, v215, v213, s20
    v_perm_b32 v205, v215, v213, s21
    v_perm_b32 v194, v218, v216, s20
    v_perm_b32 v198, v218, v216, s21
    v_perm_b32 v202, v219, v217, s20
    v_perm_b32 v206, v219, v217, s21
    v_perm_b32 v195, v222, v220, s20
    v_perm_b32 v199, v222, v220, s21
    v_perm_b32 v203, v223, v221, s20
    v_perm_b32 v207, v223, v221, s21
    v_perm_b32 v208, v226, v224, s20
    v_perm_b32 v212, v226, v224, s21
    v_perm_b32 v216, v227, v225, s20
    v_perm_b32 v220, v227, v225, s21
    v_perm_b32 v209, v230, v228, s20
    v_perm_b32 v213, v230, v228, s21
    v_perm_b32 v217, v231, v229, s20
    v_perm_b32 v221, v231, v229, s21
    v_perm_b32 v210, v234, v232, s20
    v_perm_b32 v214, v234, v232, s21
    v_perm_b32 v218, v235, v233, s20
    v_perm_b32 v222, v235, v233, s21
    v_perm_b32 v211, v238, v236, s20
    v_perm_b32 v215, v238, v236, s21
    v_perm_b32 v219, v239, v237, s20
    v_perm_b32 v223, v239, v237, s21
    v_perm_b32 v224, v242, v240, s20
    v_perm_b32 v228, v242, v240, s21
    v_perm_b32 v232, v243, v241, s20
    v_perm_b32 v236, v243, v241, s21
    v_perm_b32 v225, v246, v244, s20
    v_perm_b32 v229, v246, v244, s21
    v_perm_b32 v233, v247, v245, s20
    v_perm_b32 v237, v247, v245, s21
    v_perm_b32 v226, v250, v248, s20
    v_perm_b32 v230, v250, v248, s21
    v_perm_b32 v234, v251, v249, s20
    v_perm_b32 v238, v251, v249, s21
    v_perm_b32 v227, v254, v252, s20
    v_perm_b32 v231, v254, v252, s21
    v_perm_b32 v235, v255, v253, s20
    v_perm_b32 v239, v255, v253, s21
NC_A2:
    s_barrier
    v_add_u32 v52, 8192, v7
    v_add_u32 v53, 8192, v13
    v_add_u32 v54, 3456, v52
    v_add_u32 v55, 3456, v53
    global_load_dwordx4 v[20:23], v54, s[68:69] sc1
    global_load_ushort v24, v55, s[68:69] sc1
    v_add_u32 v54, 4608, v52
    v_add_u32 v55, 4608, v53
    global_load_dwordx4 v[14:17], v54, s[68:69] sc1
    global_load_ushort v18, v55, s[68:69] sc1
    v_add_u32 v54, 5760, v52
    v_add_u32 v55, 5760, v53
    global_load_dwordx4 v[26:29], v54, s[68:69] sc1
    global_load_ushort v30, v55, s[68:69] sc1
    s_waitcnt vmcnt(0)
MC_14:
    v_or_b32 v53, s12, v24
    v_or_b32 v54, s12, v18
    v_or_b32 v55, s12, v30
    v_max3_u32 v52, v20, v21, v22
    v_max3_u32 v52, v52, v23, v14
    v_max3_u32 v52, v52, v15, v16
    v_max3_u32 v52, v52, v17, v26
    v_max3_u32 v52, v52, v27, v28
    v_max3_u32 v52, v52, v29, v53
    v_max3_u32 v52, v52, v54, v55
    v_cmp_eq_u32 vcc, -1, v52
    s_cbranch_vccz MCD_15
    v_add_u32 v52, 8192, v7
    v_add_u32 v53, 8192, v13
    v_add_u32 v54, 3456, v52
    v_add_u32 v55, 3456, v53
    global_load_dwordx4 v[20:23], v54, s[68:69] sc1
    global_load_ushort v24, v55, s[68:69] sc1
    v_add_u32 v54, 4608, v52
    v_add_u32 v55, 4608, v53
    global_load_dwordx4 v[14:17], v54, s[68:69] sc1
    global_load_ushort v18, v55, s[68:69] sc1
    v_add_u32 v54, 5760, v52
    v_add_u32 v55, 5760, v53
    global_load_dwordx4 v[26:29], v54, s[68:69] sc1
    global_load_ushort v30, v55, s[68:69] sc1
    s_waitcnt vmcnt(0)
    s_sub_u32 s10, s10, 1
    s_cbranch_scc1 EXIT
    s_branch MC_14
MCD_15:
    v_lshlrev_b32 v32, 16, v14
    v_and_b32 v33, s12, v14
    v_lshlrev_b32 v34, 16, v15
    v_and_b32 v35, s12, v15
    v_lshlrev_b32 v36, 16, v16
    v_and_b32 v37, s12, v16
    v_lshlrev_b32 v38, 16, v17
    v_and_b32 v39, s12, v17
    v_lshlrev_b32 v40, 16, v18
    v_lshlrev_b32 v42, 16, v20
    v_and_b32 v43, s12, v20
    v_lshlrev_b32 v44, 16, v21
    v_and_b32 v45, s12, v21
    v_lshlrev_b32 v46, 16, v22
    v_and_b32 v47, s12, v22
    v_lshlrev_b32 v48, 16, v23
    v_and_b32 v49, s12, v23
    v_lshlrev_b32 v50, 16, v24
    v_pk_add_f32 v[32:33], v[32:33], 1.0 op_sel_hi:[1,0]
    v_pk_add_f32 v[34:35], v[34:35], 1.0 op_sel_hi:[1,0]
    v_pk_add_f32 v[36:37], v[36:37], 1.0 op_sel_hi:[1,0]
    v_pk_add_f32 v[38:39], v[38:39], 1.0 op_sel_hi:[1,0]
    v_add_f32 v40, 1.0, v40
    v_cvt_pk_bf16_f32 v52, v32, v33
    v_cvt_pk_bf16_f32 v53, v34, v35
    v_cvt_pk_bf16_f32 v54, v36, v37
    v_cvt_pk_bf16_f32 v55, v38, v39
    v_cvt_pk_bf16_f32 v56, v40, v40
    v_lshlrev_b32 v32, 16, v52
    v_and_b32 v33, s12, v52
    v_lshlrev_b32 v34, 16, v53
    v_and_b32 v35, s12, v53
    v_lshlrev_b32 v36, 16, v54
    v_and_b32 v37, s12, v54
    v_lshlrev_b32 v38, 16, v55
    v_and_b32 v39, s12, v55
    v_lshlrev_b32 v40, 16, v56
    s_cmp_lg_u32 s3, 4
    s_cbranch_scc1 NC_FD
    s_lshl_b32 s20, s2, 6
    s_add_u32 s20, s20, 20480
    v_mov_b32 v52, s20
NC_FP:
    global_load_dword v53, v52, s[68:69] sc1
    s_waitcnt vmcnt(0)
    v_cmp_eq_u32 vcc, -1, v53
    s_cbranch_vccz NC_FD
    s_sub_u32 s10, s10, 1
    s_cbranch_scc1 EXIT
    s_branch NC_FP
NC_FD:
    s_barrier
GPOLL:
    s_mul_i32 s20, s2, 9216
    s_add_u32 s20, s20, 1048576
    v_lshl_add_u32 v52, v0, 4, s20
    v_and_b32 v53, 7, v1
    v_lshl_add_u32 v53, s3, 3, v53
    v_add_u32 v53, 512, v53
    v_lshlrev_b32 v55, 2, v53
    v_lshl_add_u32 v53, v53, 4, s20
    v_lshlrev_b32 v54, 2, v0
GP:
    global_load_dwordx4 v[64:67], v52, s[68:69] sc1
    global_load_dwordx4 v[68:71], v53, s[68:69] sc1
    v_lshlrev_b32 v80, 16, v2
    v_and_b32 v81, s12, v2
    v_lshlrev_b32 v82, 16, v3
    v_and_b32 v83, s12, v3
    v_lshlrev_b32 v84, 16, v4
    v_and_b32 v85, s12, v4
    v_lshlrev_b32 v86, 16, v5
    v_and_b32 v87, s12, v5
    v_lshlrev_b32 v88, 16, v6
    s_waitcnt vmcnt(0)
    v_max3_u32 v72, v64, v65, v66
    v_max3_u32 v72, v72, v67, v68
    v_max3_u32 v72, v72, v69, v70
    v_max_u32 v72, v72, v71
    v_cmp_eq_u32 vcc, -1, v72
    s_cbranch_vccz GPD
    s_sub_u32 s10, s10, 1
    s_cbranch_scc1 EXIT
    s_branch GP
GPD:
    ds_write_b32 v54, v64 offset:8192
    ds_write_b32 v54, v65 offset:10496
    ds_write_b32 v54, v66 offset:12800
    ds_write_b32 v54, v67 offset:15104
    s_mov_b64 exec, 0xff
    ds_write_b32 v55, v68 offset:8192
    ds_write_b32 v55, v69 offset:10496
    ds_write_b32 v55, v70 offset:12800
    ds_write_b32 v55, v71 offset:15104
    s_mov_b64 exec, -1
    s_lshr_b32 s20, s3, 1
    s_mul_i32 s20, s20, 2304
    v_lshl_add_u32 v52, v1, 5, s20
    v_lshl_add_u32 v53, v1, 2, s20
    s_mov_b32 s21, 0x01000c0c
    s_bitcmp1_b32 s3, 0
    s_cselect_b32 s21, 0x03020c0c, s21
    s_mul_i32 s22, s11, 1152
    s_add_u32 s23, s22, 4194304
    v_add_u32 v56, s23, v7
    v_add_u32 v57, s23, v13
    s_waitcnt lgkmcnt(0)
    s_barrier
    ds_read_b128 v[64:67], v52 offset:8192
    ds_read_b128 v[68:71], v52 offset:8208
    ds_read_b32 v72, v53 offset:10240
    s_waitcnt lgkmcnt(0)
    v_perm_b32 v64, v64, v64, s21
    v_perm_b32 v65, v65, v65, s21
    v_perm_b32 v66, v66, v66, s21
    v_perm_b32 v67, v67, v67, s21
    v_perm_b32 v68, v68, v68, s21
    v_perm_b32 v69, v69, v69, s21
    v_perm_b32 v70, v70, v70, s21
    v_perm_b32 v71, v71, v71, s21
    v_perm_b32 v72, v72, v72, s21
    v_pk_add_f32 v[64:65], v[64:65], v[80:81]
    v_pk_add_f32 v[66:67], v[66:67], v[82:83]
    v_pk_add_f32 v[68:69], v[68:69], v[84:85]
    v_pk_add_f32 v[70:71], v[70:71], v[86:87]
    v_add_f32 v72, v72, v88
    v_cvt_pk_bf16_f32 v2, v64, v65
    v_cvt_pk_bf16_f32 v3, v66, v67
    v_cvt_pk_bf16_f32 v4, v68, v69
    v_cvt_pk_bf16_f32 v5, v70, v71
    v_cvt_pk_bf16_f32 v6, v72, v72
    v_lshlrev_b32 v64, 16, v2
    v_and_b32 v65, s12, v2
    v_lshlrev_b32 v66, 16, v3
    v_and_b32 v67, s12, v3
    v_lshlrev_b32 v68, 16, v4
    v_and_b32 v69, s12, v4
    v_lshlrev_b32 v70, 16, v5
    v_and_b32 v71, s12, v5
    v_lshlrev_b32 v72, 16, v6
    v_readfirstlane_b32 s24, v64
    s_nop 1
    v_subrev_f32 v64, s24, v64
    v_subrev_f32 v65, s24, v65
    v_subrev_f32 v66, s24, v66
    v_subrev_f32 v67, s24, v67
    v_subrev_f32 v68, s24, v68
    v_subrev_f32 v69, s24, v69
    v_subrev_f32 v70, s24, v70
    v_subrev_f32 v71, s24, v71
    v_subrev_f32 v72, s24, v72
    v_pk_add_f32 v[74:75], v[64:65], v[66:67]
    v_pk_mul_f32 v[76:77], v[64:65], v[64:65]
    v_pk_add_f32 v[74:75], v[74:75], v[68:69]
    v_pk_fma_f32 v[76:77], v[66:67], v[66:67], v[76:77]
    v_pk_add_f32 v[74:75], v[74:75], v[70:71]
    v_pk_fma_f32 v[76:77], v[68:69], v[68:69], v[76:77]
    v_add_f32 v74, v74, v72
    v_pk_fma_f32 v[76:77], v[70:71], v[70:71], v[76:77]
    v_add_f32 v74, v74, v75
    v_fmac_f32 v76, v72, v72
    v_add_f32 v76, v76, v77
    s_nop 1
    v_permlane32_swap_b32 v74, v76
    v_add_f32 v74, v74, v76
    v_mov_b32 v76, v74
    s_nop 1
    v_permlane16_swap_b32 v74, v76
    v_add_f32 v74, v74, v76
    s_nop 1
    v_add_f32_dpp v74, v74, v74 row_ror:8 row_mask:0xf bank_mask:0xf
    s_nop 1
    v_add_f32_dpp v74, v74, v74 row_ror:4 row_mask:0xf bank_mask:0xf
    s_nop 1
    v_add_f32_dpp v74, v74, v74 row_ror:2 row_mask:0xf bank_mask:0xf
    s_nop 1
    v_add_f32_dpp v74, v74, v74 row_ror:1 row_mask:0xf bank_mask:0xf
    v_mov_b32 v76, v74
    s_nop 1
    v_permlane32_swap_b32 v74, v76
    v_mul_f32 v74, 0x3ae38e39, v74
    v_mul_f32 v76, 0x3ae38e39, v76
    v_add_f32 v75, s24, v74
    v_fma_f32 v77, -v74, v74, v76
    v_max_f32 v77, 0, v77
    v_cvt_pk_bf16_f32 v77, v77, v77
    v_and_b32 v77, s12, v77
    v_add_f32 v77, 0x3727c5ac, v77
    v_cvt_pk_bf16_f32 v77, v77, v77
    v_and_b32 v77, s12, v77
    v_sqrt_f32 v78, v77
    v_cvt_pk_bf16_f32 v75, v75, v75
    v_and_b32 v75, s12, v75
    v_cvt_pk_bf16_f32 v78, v78, v78
    v_and_b32 v78, s12, v78
    v_rcp_f32 v78, v78
    v_sub_f32 v79, s24, v75
    v_mul_f32 v79, v79, v78
    v_pk_fma_f32 v[64:65], v[64:65], v[78:79], v[78:79] op_sel:[0,0,1] op_sel_hi:[1,0,1]
    v_pk_fma_f32 v[66:67], v[66:67], v[78:79], v[78:79] op_sel:[0,0,1] op_sel_hi:[1,0,1]
    v_pk_fma_f32 v[68:69], v[68:69], v[78:79], v[78:79] op_sel:[0,0,1] op_sel_hi:[1,0,1]
    v_pk_fma_f32 v[70:71], v[70:71], v[78:79], v[78:79] op_sel:[0,0,1] op_sel_hi:[1,0,1]
    v_fma_f32 v72, v72, v78, v79
    v_pk_fma_f32 v[64:65], v[64:65], v[32:33], v[42:43]
    v_pk_fma_f32 v[66:67], v[66:67], v[34:35], v[44:45]
    v_pk_fma_f32 v[68:69], v[68:69], v[36:37], v[46:47]
    v_pk_fma_f32 v[70:71], v[70:71], v[38:39], v[48:49]
    v_fma_f32 v72, v72, v40, v50
    v_cvt_pk_bf16_f32 v90, v64, v65
    v_cvt_pk_bf16_f32 v91, v66, v67
    v_cvt_pk_bf16_f32 v92, v68, v69
    v_cvt_pk_bf16_f32 v93, v70, v71
    v_cvt_pk_bf16_f32 v94, v72, v72
    v_dot2_f32_bf16 v74, v90, v8, 0
    v_dot2_f32_bf16 v75, v91, v9, 0
    global_store_dwordx4 v56, v[90:93], s[68:69] sc1
    global_store_short v57, v94, s[68:69] sc1
    v_dot2_f32_bf16 v74, v92, v10, v74
    v_dot2_f32_bf16 v75, v93, v11, v75
    v_dot2_f32_bf16 v74, v94, v12, v74
    s_nop 2
    v_add_f32 v74, v74, v75
    v_mov_b32 v76, v74
    s_nop 1
    v_permlane32_swap_b32 v74, v76
    v_add_f32 v74, v74, v76
    v_mov_b32 v76, v74
    s_nop 1
    v_permlane16_swap_b32 v74, v76
    v_add_f32 v74, v74, v76
    s_nop 1
    v_add_f32_dpp v74, v74, v74 row_ror:8 row_mask:0xf bank_mask:0xf
    s_nop 1
    v_add_f32_dpp v74, v74, v74 row_ror:4 row_mask:0xf bank_mask:0xf
    s_nop 1
    v_add_f32_dpp v74, v74, v74 row_ror:2 row_mask:0xf bank_mask:0xf
    s_nop 1
    v_add_f32_dpp v74, v74, v74 row_ror:1 row_mask:0xf bank_mask:0xf
    v_cvt_pk_bf16_f32 v74, v74, v74
    v_ashrrev_i32 v75, 31, v74
    v_or_b32 v75, 0x80008000, v75
    v_xor_b32 v74, v74, v75
    v_min_u32 v74, 0xfffefffe, v74
    s_lshl_b32 s20, s3, 1
    s_add_u32 s20, s20, 143424
    v_mov_b32 v75, s20
    s_mov_b64 exec, 1
    ds_write_b16_d16_hi v75, v74
    s_mov_b64 exec, -1
    s_waitcnt lgkmcnt(0)
    s_barrier
    s_cmp_lg_u32 s3, 4
    s_cbranch_scc1 NORS
    v_mov_b32 v52, 143424
    ds_read_b128 v[64:67], v52
    s_lshl_b32 s20, s2, 4
    s_add_u32 s20, s20, 16384
    v_mov_b32 v52, s20
    s_mov_b64 exec, 1
    s_waitcnt lgkmcnt(0)
    global_store_dwordx4 v52, v[64:67], s[68:69] sc1
    s_mov_b64 exec, -1
NORS:
    s_nop 0
    v_lshlrev_b32 v64, 16, v2
    v_and_b32 v65, s12, v2
    v_lshlrev_b32 v66, 16, v3
    v_and_b32 v67, s12, v3
    v_lshlrev_b32 v68, 16, v4
    v_and_b32 v69, s12, v4
    v_lshlrev_b32 v70, 16, v5
    v_and_b32 v71, s12, v5
    v_lshlrev_b32 v72, 16, v6
    v_lshlrev_b32 v74, 16, v90
    v_and_b32 v75, s12, v90
    v_lshlrev_b32 v76, 16, v91
    v_and_b32 v77, s12, v91
    v_lshlrev_b32 v78, 16, v92
    v_and_b32 v79, s12, v92
    v_lshlrev_b32 v80, 16, v93
    v_and_b32 v81, s12, v93
    v_lshlrev_b32 v82, 16, v94
    v_lshlrev_b32 v96, 16, v26
    v_and_b32 v97, s12, v26
    v_lshlrev_b32 v98, 16, v27
    v_and_b32 v99, s12, v27
    v_lshlrev_b32 v100, 16, v28
    v_and_b32 v101, s12, v28
    v_lshlrev_b32 v102, 16, v29
    v_and_b32 v103, s12, v29
    v_lshlrev_b32 v104, 16, v30
    v_pk_fma_f32 v[64:65], v[74:75], v[96:97], v[64:65]
    v_pk_fma_f32 v[66:67], v[76:77], v[98:99], v[66:67]
    v_pk_fma_f32 v[68:69], v[78:79], v[100:101], v[68:69]
    v_pk_fma_f32 v[70:71], v[80:81], v[102:103], v[70:71]
    v_fma_f32 v72, v82, v104, v72
    v_cvt_pk_bf16_f32 v8, v64, v65
    v_cvt_pk_bf16_f32 v9, v66, v67
    v_cvt_pk_bf16_f32 v10, v68, v69
    v_cvt_pk_bf16_f32 v11, v70, v71
    v_cvt_pk_bf16_f32 v12, v72, v72
    s_cmp_lt_u32 s3, 4
    s_cbranch_scc1 T8_B5
    v_and_b32 v52, 255, v0
    v_lshlrev_b32 v53, 4, v52
    v_add_u32 v53, 16384, v53
    v_lshlrev_b32 v52, 3, v52
    v_sub_u32 v52, 2047, v52
    v_and_b32 v54, 1, v1
    v_cmp_eq_u32 s[20:21], 0, v54
    v_and_b32 v54, 2, v1
    v_cmp_eq_u32 s[22:23], 0, v54
    v_and_b32 v54, 4, v1
    v_cmp_eq_u32 s[24:25], 0, v54
    v_and_b32 v54, 7, v1
    v_lshlrev_b32 v54, 2, v54
    s_waitcnt vmcnt(0)
RP:
    global_load_dwordx4 v[64:67], v53, s[68:69] sc1
    s_waitcnt vmcnt(0)
    v_max3_u32 v68, v64, v65, v66
    v_max_u32 v68, v68, v67
    v_cmp_eq_u32 vcc, -1, v68
    s_cbranch_vccz RPD
    s_sub_u32 s10, s10, 1
    s_cbranch_scc1 EXIT
    s_branch RP
RPD:
    v_cndmask_b32 v68, v66, v64, s[20:21]
    v_cndmask_b32 v69, v67, v65, s[20:21]
    v_cndmask_b32 v70, v64, v66, s[20:21]
    v_cndmask_b32 v71, v65, v67, s[20:21]
    s_nop 0
    v_mov_b32_dpp v72, v70 quad_perm:[1,0,3,2] row_mask:0xf bank_mask:0xf
    v_mov_b32_dpp v73, v71 quad_perm:[1,0,3,2] row_mask:0xf bank_mask:0xf
    v_pk_max_u16 v68, v68, v72
    v_pk_max_u16 v69, v69, v73
    v_cndmask_b32 v70, v69, v68, s[22:23]
    v_cndmask_b32 v71, v68, v69, s[22:23]
    s_nop 1
    v_mov_b32_dpp v72, v71 quad_perm:[2,3,0,1] row_mask:0xf bank_mask:0xf
    v_pk_max_u16 v70, v70, v72
    s_nop 1
    v_mov_b32_dpp v72, v70 row_ror:4 row_mask:0xf bank_mask:0xf
    v_pk_max_u16 v70, v70, v72
    v_and_b32 v71, 0xffff, v70
    v_lshrrev_b32 v70, 16, v70
    v_cndmask_b32 v70, v70, v71, s[24:25]
    v_add_u32 v54, 143360, v54
    ds_max_u32 v54, v70
    v_subrev_u32 v80, 0, v52
    v_lshl_or_b32 v80, v64, 16, v80
    v_subrev_u32 v81, 1, v52
    v_and_or_b32 v81, v64, s12, v81
    v_subrev_u32 v82, 2, v52
    v_lshl_or_b32 v82, v65, 16, v82
    v_subrev_u32 v83, 3, v52
    v_and_or_b32 v83, v65, s12, v83
    v_subrev_u32 v84, 4, v52
    v_lshl_or_b32 v84, v66, 16, v84
    v_subrev_u32 v85, 5, v52
    v_and_or_b32 v85, v66, s12, v85
    v_subrev_u32 v86, 6, v52
    v_lshl_or_b32 v86, v67, 16, v86
    v_subrev_u32 v87, 7, v52
    v_and_or_b32 v87, v67, s12, v87
    s_waitcnt lgkmcnt(0)
T8_B5:
    s_barrier
    s_cmp_lt_u32 s3, 4
    s_cbranch_scc1 T8_B6
    v_mov_b32 v54, 143360
    ds_read_b128 v[64:67], v54
    ds_read_b128 v[68:71], v54 offset:16
    v_mov_b32 v72, 0
    s_waitcnt lgkmcnt(0)
    v_min3_u32 v64, v64, v65, v66
    v_min3_u32 v67, v67, v68, v69
    v_min3_u32 v64, v64, v70, v71
    v_min_u32 v64, v64, v67
    v_lshlrev_b32 v64, 16, v64
    v_cmp_ge_u32 s[20:21], v80, v64
    v_cmp_ge_u32 s[22:23], v81, v64
    v_cmp_ge_u32 s[24:25], v82, v64
    v_cmp_ge_u32 s[26:27], v83, v64
    v_cmp_ge_u32 s[28:29], v84, v64
    v_cmp_ge_u32 s[30:31], v85, v64
    v_cmp_ge_u32 s[32:33], v86, v64
    v_cmp_ge_u32 s[34:35], v87, v64
    v_addc_co_u32 v72, vcc, 0, v72, s[20:21]
    s_nop 1
    v_addc_co_u32 v72, vcc, 0, v72, s[22:23]
    s_nop 1
    v_addc_co_u32 v72, vcc, 0, v72, s[24:25]
    s_nop 1
    v_addc_co_u32 v72, vcc, 0, v72, s[26:27]
    s_nop 1
    v_addc_co_u32 v72, vcc, 0, v72, s[28:29]
    s_nop 1
    v_addc_co_u32 v72, vcc, 0, v72, s[30:31]
    s_nop 1
    v_addc_co_u32 v72, vcc, 0, v72, s[32:33]
    s_nop 1
    v_addc_co_u32 v72, vcc, 0, v72, s[34:35]
    v_cmp_lt_u32 vcc, 0, v72
    s_nop 0
    s_mov_b64 exec, vcc
    ds_add_rtn_u32 v73, v54, v72 offset:32
    s_waitcnt lgkmcnt(0)
    v_lshlrev_b32 v73, 2, v73
    s_mov_b64 exec, s[20:21]
    ds_write_b32 v73, v80 offset:17408
    v_add_u32 v73, 4, v73
    s_mov_b64 exec, s[22:23]
    ds_write_b32 v73, v81 offset:17408
    v_add_u32 v73, 4, v73
    s_mov_b64 exec, s[24:25]
    ds_write_b32 v73, v82 offset:17408
    v_add_u32 v73, 4, v73
    s_mov_b64 exec, s[26:27]
    ds_write_b32 v73, v83 offset:17408
    v_add_u32 v73, 4, v73
    s_mov_b64 exec, s[28:29]
    ds_write_b32 v73, v84 offset:17408
    v_add_u32 v73, 4, v73
    s_mov_b64 exec, s[30:31]
    ds_write_b32 v73, v85 offset:17408
    v_add_u32 v73, 4, v73
    s_mov_b64 exec, s[32:33]
    ds_write_b32 v73, v86 offset:17408
    v_add_u32 v73, 4, v73
    s_mov_b64 exec, s[34:35]
    ds_write_b32 v73, v87 offset:17408
    v_add_u32 v73, 4, v73
    s_mov_b64 exec, -1
    s_waitcnt lgkmcnt(0)
T8_B6:
    s_barrier
    v_mov_b32 v54, 143392
    ds_read_b32 v55, v54
    v_lshlrev_b32 v52, 2, v1
    ds_read_b32 v64, v52 offset:17408
    v_mov_b32 v53, 0
    s_lshl_b32 s22, s3, 5
    s_add_u32 s22, s22, 143488
    s_mov_b32 s21, 0
    s_waitcnt lgkmcnt(1)
    v_readfirstlane_b32 s20, v55
    v_lshl_add_u32 v55, v55, 2, v52
    s_mov_b64 exec, 0xffff
    ds_write_b32 v55, v53 offset:17408
    s_mov_b64 exec, -1
RK_O:
    v_mov_b32 v65, 0
    v_mov_b32 v54, 0
    s_mov_b32 s23, 0
RK_I:
    ds_read_b128 v[68:71], v54 offset:17408
    ds_read_b128 v[72:75], v54 offset:17424
    ds_read_b128 v[76:79], v54 offset:17440
    ds_read_b128 v[80:83], v54 offset:17456
    v_add_u32 v54, 64, v54
    s_add_u32 s23, s23, 16
    s_waitcnt lgkmcnt(3)
    v_cmp_gt_u32 s[24:25], v68, v64
    v_cmp_gt_u32 s[26:27], v69, v64
    v_cmp_gt_u32 s[28:29], v70, v64
    v_cmp_gt_u32 s[30:31], v71, v64
    v_addc_co_u32 v65, vcc, 0, v65, s[24:25]
    s_nop 1
    v_addc_co_u32 v65, vcc, 0, v65, s[26:27]
    s_nop 1
    v_addc_co_u32 v65, vcc, 0, v65, s[28:29]
    s_nop 1
    v_addc_co_u32 v65, vcc, 0, v65, s[30:31]
    s_waitcnt lgkmcnt(2)
    v_cmp_gt_u32 s[24:25], v72, v64
    v_cmp_gt_u32 s[26:27], v73, v64
    v_cmp_gt_u32 s[28:29], v74, v64
    v_cmp_gt_u32 s[30:31], v75, v64
    v_addc_co_u32 v65, vcc, 0, v65, s[24:25]
    s_nop 1
    v_addc_co_u32 v65, vcc, 0, v65, s[26:27]
    s_nop 1
    v_addc_co_u32 v65, vcc, 0, v65, s[28:29]
    s_nop 1
    v_addc_co_u32 v65, vcc, 0, v65, s[30:31]
    s_waitcnt lgkmcnt(1)
    v_cmp_gt_u32 s[24:25], v76, v64
    v_cmp_gt_u32 s[26:27], v77, v64
    v_cmp_gt_u32 s[28:29], v78, v64
    v_cmp_gt_u32 s[30:31], v79, v64
    v_addc_co_u32 v65, vcc, 0, v65, s[24:25]
    s_nop 1
    v_addc_co_u32 v65, vcc, 0, v65, s[26:27]
    s_nop 1
    v_addc_co_u32 v65, vcc, 0, v65, s[28:29]
    s_nop 1
    v_addc_co_u32 v65, vcc, 0, v65, s[30:31]
    s_waitcnt lgkmcnt(0)
    v_cmp_gt_u32 s[24:25], v80, v64
    v_cmp_gt_u32 s[26:27], v81, v64
    v_cmp_gt_u32 s[28:29], v82, v64
    v_cmp_gt_u32 s[30:31], v83, v64
    v_addc_co_u32 v65, vcc, 0, v65, s[24:25]
    s_nop 1
    v_addc_co_u32 v65, vcc, 0, v65, s[26:27]
    s_nop 1
    v_addc_co_u32 v65, vcc, 0, v65, s[28:29]
    s_nop 1
    v_addc_co_u32 v65, vcc, 0, v65, s[30:31]
    s_cmp_lt_u32 s23, s20
    s_cbranch_scc1 RK_I
    v_add_u32 v66, s21, v1
    v_cmp_gt_u32 vcc, s20, v66
    v_cmp_gt_u32 s[24:25], 8, v65
    s_nop 0
    s_and_b64 exec, vcc, s[24:25]
    v_lshl_add_u32 v65, v65, 2, s22
    ds_write_b32 v65, v64
    s_mov_b64 exec, -1
    s_add_u32 s21, s21, 64
    s_cmp_ge_u32 s21, s20
    s_cbranch_scc1 RK_D
    v_add_u32 v52, 256, v52
    ds_read_b32 v64, v52 offset:17408
    s_branch RK_O
RK_D:
    v_and_b32 v54, 7, v1
    v_lshl_add_u32 v54, v54, 2, s22
    ds_read_b32 v64, v54
    s_mul_i32 s23, s11, 1152
    s_waitcnt lgkmcnt(0)
    v_and_b32 v65, 0x7ff, v64
    v_sub_u32 v65, 2047, v65
    s_cmp_lt_u32 s3, 4
    s_cbranch_scc1 NOAF
    s_cmp_lt_u32 s5, 14
    s_cbranch_scc1 NOAF
    s_movk_i32 s20, 1152
    v_lshrrev_b32 v52, 4, v1
    v_lshlrev_b32 v52, 4, v52
    s_lshl_b32 s21, s9, 6
    s_add_u32 s21, s21, 4194304
    v_mad_u32_u24 v52, v65, s20, v52
    v_add_u32 v52, s21, v52
    s_movk_i32 s21, 1024
    s_cmp_ge_u32 s9, 2
    s_cselect_b32 s21, 768, s21
    v_add_u32 v53, s21, v52
    global_load_dwordx4 v[68:71], v52, s[68:69] sc1
    global_load_dwordx4 v[72:75], v52, s[68:69] offset:256 sc1
    global_load_dwordx4 v[76:79], v52, s[68:69] offset:512 sc1
    global_load_dwordx4 v[80:83], v52, s[68:69] offset:768 sc1
    global_load_dwordx4 v[84:87], v53, s[68:69] sc1
NOAF:
    v_cmp_eq_u32 vcc, s11, v65
    s_cbranch_vccnz OWN_SEL
    v_add_u32 v54, s23, v7
    v_add_u32 v55, s23, v13
    global_store_dwordx4 v54, v[8:11], s[64:65]
    global_store_short v55, v12, s[64:65]
    s_branch OWN_D
OWN_SEL:
    s_ff1_i32_b64 s20, vcc
    s_mul_i32 s20, s20, 3072
    s_add_u32 s20, s20, 36864
    v_add_u32 v54, s20, v7
    v_add_u32 v55, s20, v13
    global_store_dwordx4 v54, v[2:5], s[68:69] sc1
    global_store_short v55, v6, s[68:69] sc1
OWN_D:
    s_cmp_lt_u32 s5, 14
    s_cbranch_scc1 FIN
    s_cmp_lt_u32 s3, 4
    s_cbranch_scc1 MOE_A
    s_waitcnt vmcnt(2)
AFP:
    v_max3_u32 v88, v68, v69, v70
    v_max3_u32 v88, v88, v71, v72
    v_max3_u32 v88, v88, v73, v74
    v_max3_u32 v88, v88, v75, v76
    v_max3_u32 v88, v88, v77, v78
    v_max3_u32 v88, v88, v79, v80
    v_max3_u32 v88, v88, v81, v82
    v_max3_u32 v88, v88, v83, v84
    v_max3_u32 v88, v88, v85, v86
    v_max_u32 v88, v88, v87
    v_cmp_eq_u32 vcc, -1, v88
    s_cbranch_vccz AFD
    global_load_dwordx4 v[68:71], v52, s[68:69] sc1
    global_load_dwordx4 v[72:75], v52, s[68:69] offset:256 sc1
    global_load_dwordx4 v[76:79], v52, s[68:69] offset:512 sc1
    global_load_dwordx4 v[80:83], v52, s[68:69] offset:768 sc1
    global_load_dwordx4 v[84:87], v53, s[68:69] sc1
    s_waitcnt vmcnt(0)
    s_sub_u32 s10, s10, 1
    s_cbranch_scc1 EXIT
    s_branch AFP
AFD:
    v_mfma_f32_16x16x32_bf16 v[92:95], v[112:115], v[68:71], 0
    v_mfma_f32_16x16x32_bf16 v[96:99], v[116:119], v[68:71], 0
    v_mfma_f32_16x16x32_bf16 v[100:103], v[120:123], v[68:71], 0
    v_mfma_f32_16x16x32_bf16 v[104:107], v[124:127], v[68:71], 0
    v_mfma_f32_16x16x32_bf16 v[92:95], v[128:131], v[72:75], v[92:95]
    v_mfma_f32_16x16x32_bf16 v[96:99], v[132:135], v[72:75], v[96:99]
    v_mfma_f32_16x16x32_bf16 v[100:103], v[136:139], v[72:75], v[100:103]
    v_mfma_f32_16x16x32_bf16 v[104:107], v[140:143], v[72:75], v[104:107]
    v_mfma_f32_16x16x32_bf16 v[92:95], v[144:147], v[76:79], v[92:95]
    v_mfma_f32_16x16x32_bf16 v[96:99], v[148:151], v[76:79], v[96:99]
    v_mfma_f32_16x16x32_bf16 v[100:103], v[152:155], v[76:79], v[100:103]
    v_mfma_f32_16x16x32_bf16 v[104:107], v[156:159], v[76:79], v[104:107]
    v_mfma_f32_16x16x32_bf16 v[92:95], v[160:163], v[80:83], v[92:95]
    v_mfma_f32_16x16x32_bf16 v[96:99], v[164:167], v[80:83], v[96:99]
    v_mfma_f32_16x16x32_bf16 v[100:103], v[168:171], v[80:83], v[100:103]
    v_mfma_f32_16x16x32_bf16 v[104:107], v[172:175], v[80:83], v[104:107]
    s_cmp_ge_u32 s9, 2
    s_cbranch_scc1 MF4
    v_mfma_f32_16x16x32_bf16 v[92:95], v[176:179], v[84:87], v[92:95]
    v_mfma_f32_16x16x32_bf16 v[96:99], v[180:183], v[84:87], v[96:99]
    v_mfma_f32_16x16x32_bf16 v[100:103], v[184:187], v[84:87], v[100:103]
    v_mfma_f32_16x16x32_bf16 v[104:107], v[188:191], v[84:87], v[104:107]
MF4:
    s_mul_i32 s20, s9, 4608
    v_lshl_add_u32 v52, v1, 4, s20
    v_lshrrev_b32 v53, 4, v1
    s_movk_i32 s20, 1152
    v_mul_u32_u24 v54, s20, v53
    v_and_b32 v55, 7, v1
    v_lshl_add_u32 v54, v55, 4, v54
    v_and_b32 v55, 8, v1
    v_lshl_add_u32 v54, v55, 5, v54
    v_cmp_eq_u32 s[24:25], 0, v55
    s_nop 4
    ds_write_b128 v52, v[92:95] offset:36864
    ds_write_b128 v52, v[96:99] offset:38016
    ds_write_b128 v52, v[100:103] offset:39168
    ds_write_b128 v52, v[104:107] offset:40320
    s_waitcnt lgkmcnt(0)
    s_barrier
    ds_read_b128 v[64:67], v54 offset:36864
    ds_read_b128 v[68:71], v54 offset:37376
    ds_read_b128 v[72:75], v54 offset:41472
    ds_read_b128 v[76:79], v54 offset:41984
    ds_read_b128 v[80:83], v54 offset:46080
    ds_read_b128 v[84:87], v54 offset:46592
    ds_read_b128 v[88:91], v54 offset:50688
    ds_read_b128 v[92:95], v54 offset:51200
    v_and_b32 v53, 1, v53
    s_mov_b32 s20, 1327104
    v_mul_u32_u24 v53, s20, v53
    v_lshrrev_b32 v55, 3, v55
    s_movk_i32 s20, 18432
    v_mad_u32_u24 v53, v55, s20, v53
    v_and_b32 v55, 7, v1
    v_lshl_add_u32 v53, v55, 4, v53
    s_lshl_b32 s20, s8, 7
    s_add_u32 s20, s20, 7340032
    v_add_u32 v53, s20, v53
    s_mul_i32 s21, s9, 147456
    s_waitcnt lgkmcnt(4)
    v_pk_add_f32 v[64:65], v[64:65], v[72:73]
    v_pk_add_f32 v[66:67], v[66:67], v[74:75]
    v_pk_add_f32 v[68:69], v[68:69], v[76:77]
    v_pk_add_f32 v[70:71], v[70:71], v[78:79]
    s_waitcnt lgkmcnt(0)
    v_pk_add_f32 v[80:81], v[80:81], v[88:89]
    v_pk_add_f32 v[82:83], v[82:83], v[90:91]
    v_pk_add_f32 v[84:85], v[84:85], v[92:93]
    v_pk_add_f32 v[86:87], v[86:87], v[94:95]
    v_pk_add_f32 v[64:65], v[64:65], v[80:81]
    v_pk_add_f32 v[66:67], v[66:67], v[82:83]
    v_pk_add_f32 v[68:69], v[68:69], v[84:85]
    v_pk_add_f32 v[70:71], v[70:71], v[86:87]
    v_cvt_pk_bf16_f32 v72, v64, v65
    v_cvt_pk_bf16_f32 v73, v66, v67
    v_cvt_pk_bf16_f32 v74, v68, v69
    v_cvt_pk_bf16_f32 v75, v70, v71
    v_lshlrev_b32 v64, 16, v72
    v_and_b32 v65, s12, v72
    v_lshlrev_b32 v66, 16, v73
    v_and_b32 v67, s12, v73
    v_lshlrev_b32 v68, 16, v74
    v_and_b32 v69, s12, v74
    v_lshlrev_b32 v70, 16, v75
    v_and_b32 v71, s12, v75
    v_mul_f32 v72, 0xbfb8aa3b, v64
    v_exp_f32 v72, v72
    v_mul_f32 v73, 0xbfb8aa3b, v65
    v_exp_f32 v73, v73
    v_mul_f32 v74, 0xbfb8aa3b, v66
    v_exp_f32 v74, v74
    v_mul_f32 v75, 0xbfb8aa3b, v67
    v_exp_f32 v75, v75
    v_add_f32 v72, 1.0, v72
    v_rcp_f32 v72, v72
    v_add_f32 v73, 1.0, v73
    v_rcp_f32 v73, v73
    v_add_f32 v74, 1.0, v74
    v_rcp_f32 v74, v74
    v_add_f32 v75, 1.0, v75
    v_rcp_f32 v75, v75
    v_pk_mul_f32 v[64:65], v[64:65], v[72:73]
    v_pk_mul_f32 v[66:67], v[66:67], v[74:75]
    v_cvt_pk_bf16_f32 v72, v64, v65
    v_cvt_pk_bf16_f32 v73, v66, v67
    v_lshlrev_b32 v64, 16, v72
    v_and_b32 v65, s12, v72
    v_lshlrev_b32 v66, 16, v73
    v_and_b32 v67, s12, v73
    v_pk_mul_f32 v[64:65], v[64:65], v[68:69]
    v_pk_mul_f32 v[66:67], v[66:67], v[70:71]
    v_cvt_pk_bf16_f32 v72, v64, v65
    v_cvt_pk_bf16_f32 v73, v66, v67
    s_nop 0
    v_mov_b32_dpp v74, v72 row_ror:8 row_mask:0xf bank_mask:0xf
    v_mov_b32_dpp v75, v73 row_ror:8 row_mask:0xf bank_mask:0xf
    v_cndmask_b32 v76, v74, v72, s[24:25]
    v_cndmask_b32 v77, v75, v73, s[24:25]
    v_cndmask_b32 v78, v72, v74, s[24:25]
    v_cndmask_b32 v79, v73, v75, s[24:25]
    s_nop 1
    v_mfma_f32_16x16x32_bf16 v[80:83], v[76:79], v[192:195], 0
    v_mfma_f32_16x16x32_bf16 v[84:87], v[76:79], v[196:199], 0
    v_mfma_f32_16x16x32_bf16 v[88:91], v[76:79], v[200:203], 0
    v_mfma_f32_16x16x32_bf16 v[92:95], v[76:79], v[204:207], 0
    v_mfma_f32_16x16x32_bf16 v[96:99], v[76:79], v[208:211], 0
    v_mfma_f32_16x16x32_bf16 v[100:103], v[76:79], v[212:215], 0
    v_mfma_f32_16x16x32_bf16 v[104:107], v[76:79], v[216:219], 0
    v_mfma_f32_16x16x32_bf16 v[108:111], v[76:79], v[220:223], 0
    s_mov_b32 exec_hi, 0
    v_add_u32 v52, s21, v53
    global_store_dwordx4 v52, v[80:83], s[68:69] sc1
    v_add_u32 v52, 36864, v52
    global_store_dwordx4 v52, v[84:87], s[68:69] sc1
    v_add_u32 v52, 36864, v52
    global_store_dwordx4 v52, v[88:91], s[68:69] sc1
    v_add_u32 v52, 36864, v52
    global_store_dwordx4 v52, v[92:95], s[68:69] sc1
    s_add_u32 s21, s21, 589824
    v_add_u32 v52, s21, v53
    global_store_dwordx4 v52, v[96:99], s[68:69] sc1
    v_add_u32 v52, 36864, v52
    global_store_dwordx4 v52, v[100:103], s[68:69] sc1
    v_add_u32 v52, 36864, v52
    global_store_dwordx4 v52, v[104:107], s[68:69] sc1
    v_add_u32 v52, 36864, v52
    global_store_dwordx4 v52, v[108:111], s[68:69] sc1
    s_mov_b32 exec_hi, -1
    s_cmp_lg_u32 s9, 3
    s_cbranch_scc1 NOB8
    v_mfma_f32_16x16x32_bf16 v[80:83], v[76:79], v[224:227], 0
    v_mfma_f32_16x16x32_bf16 v[84:87], v[76:79], v[228:231], 0
    v_mfma_f32_16x16x32_bf16 v[88:91], v[76:79], v[232:235], 0
    v_mfma_f32_16x16x32_bf16 v[92:95], v[76:79], v[236:239], 0
    s_mov_b32 s21, 1179648
    s_mov_b32 exec_hi, 0
    v_add_u32 v52, s21, v53
    s_nop 1
    global_store_dwordx4 v52, v[80:83], s[68:69] sc1
    v_add_u32 v52, 36864, v52
    global_store_dwordx4 v52, v[84:87], s[68:69] sc1
    v_add_u32 v52, 36864, v52
    global_store_dwordx4 v52, v[88:91], s[68:69] sc1
    v_add_u32 v52, 36864, v52
    global_store_dwordx4 v52, v[92:95], s[68:69] sc1
    s_mov_b32 exec_hi, -1
NOB8:
    s_waitcnt vmcnt(0)
    s_branch S4
MOE_A:
    s_barrier
    s_cmp_lg_u32 s3, 0
    s_cbranch_scc1 S4
    s_cmp_ge_u32 s8, 72
    s_cselect_b32 s20, 1, 0
    s_mul_i32 s21, s20, 72
    s_sub_u32 s21, s8, s21
    s_lshr_b32 s23, s21, 3
    s_lshl_b32 s23, s23, 6
    s_and_b32 s24, s21, 1
    s_lshl_b32 s24, s24, 5
    s_add_u32 s23, s23, s24
    s_bfe_u32 s24, s21, 0x20001
    s_add_u32 s23, s23, s24
    s_lshl_b32 s23, s23, 1
    v_and_b32 v52, 7, v1
    v_lshl_add_u32 v52, v52, 3, s23
    v_lshrrev_b32 v53, 4, v1
    v_lshl_add_u32 v53, s20, 2, v53
    v_lshl_add_u32 v54, v53, 2, s22
    ds_read_b32 v40, v54
    s_movk_i32 s20, 3072
    v_mad_u32_u24 v41, v53, s20, v52
    v_add_u32 v41, 36864, v41
    v_add_u32 v42, 13952, v52
    s_movk_i32 s20, 1152
    s_waitcnt lgkmcnt(0)
    v_and_b32 v43, 0x7ff, v40
    v_sub_u32 v43, 2047, v43
    v_mad_u32_u24 v43, v43, s20, v52
    v_add_u32 v44, 4194304, v43
    v_ashrrev_i32 v45, 31, v40
    v_not_b32 v45, v45
    v_or_b32 v45, 0x80000000, v45
    v_xor_b32 v45, v45, v40
    v_and_b32 v45, s12, v45
    v_mul_f32 v45, 0xbfb8aa3b, v45
    v_exp_f32 v45, v45
    s_nop 0
    v_add_f32 v45, 1.0, v45
    v_rcp_f32 v45, v45
    s_nop 0
    v_cvt_pk_bf16_f32 v45, v45, v45
    v_and_b32 v45, s12, v45
XP:
    global_load_ushort v46, v41, s[68:69] sc1
    global_load_ushort v47, v44, s[68:69] sc1
    global_load_ushort v48, v42, s[68:69] sc1
    s_waitcnt vmcnt(0)
    v_max_u32 v49, v46, v47
    v_cmp_eq_u32 vcc, 0xffff, v49
    s_cbranch_vccz XPD
    s_sub_u32 s10, s10, 1
    s_cbranch_scc1 EXIT
    s_branch XP
XPD:
    v_lshlrev_b32 v46, 16, v46
    v_lshlrev_b32 v47, 16, v47
    v_lshlrev_b32 v48, 16, v48
S4:
    s_mul_i32 s20, s8, 18432
    s_add_u32 s20, s20, 7340032
    v_lshl_add_u32 v52, v0, 4, s20
    v_add_u32 v53, 8192, v52
    v_add_u32 v54, 16384, v52
    v_mov_b32 v72, 0
    v_mov_b32 v73, 0
    v_mov_b32 v74, 0
    v_mov_b32 v75, 0
    v_lshrrev_b32 v55, 4, v1
    v_and_b32 v56, 7, v1
    v_lshl_add_u32 v55, v55, 3, v56
    v_lshlrev_b32 v55, 2, v55
    s_lshl_b32 s20, s3, 7
    v_add_u32 v56, s20, v55
    s_barrier
PP:
    global_load_dwordx4 v[64:67], v52, s[68:69] sc1
    global_load_dwordx4 v[68:71], v53, s[68:69] sc1
    s_cmp_ge_u32 s3, 2
    s_cbranch_scc1 PP2
    global_load_dwordx4 v[72:75], v54, s[68:69] sc1
PP2:
    s_waitcnt vmcnt(0)
    v_max3_u32 v76, v64, v65, v66
    v_max3_u32 v76, v76, v67, v68
    v_max3_u32 v76, v76, v69, v70
    v_max3_u32 v76, v76, v71, v72
    v_max3_u32 v76, v76, v73, v74
    v_max_u32 v76, v76, v75
    v_cmp_eq_u32 vcc, -1, v76
    s_cbranch_vccz PPD
    s_sub_u32 s10, s10, 1
    s_cbranch_scc1 EXIT
    s_branch PP
PPD:
    v_pk_add_f32 v[64:65], v[64:65], v[68:69]
    v_pk_add_f32 v[66:67], v[66:67], v[70:71]
    v_pk_add_f32 v[64:65], v[64:65], v[72:73]
    v_pk_add_f32 v[66:67], v[66:67], v[74:75]
    s_nop 1
    v_permlane32_swap_b32 v64, v66
    v_permlane32_swap_b32 v65, v67
    v_pk_add_f32 v[64:65], v[64:65], v[66:67]
    s_nop 1
    v_permlane16_swap_b32 v64, v65
    v_add_f32 v64, v64, v65
    s_nop 1
    v_add_f32_dpp v64, v64, v64 row_ror:8 row_mask:0xf bank_mask:0xf
    s_mov_b32 exec_lo, 0x00ff00ff
    s_mov_b32 exec_hi, 0x00ff00ff
    ds_write_b32 v56, v64 offset:26624
    s_waitcnt lgkmcnt(0)
    s_barrier
    s_cmp_lg_u32 s3, 0
    s_cbranch_scc1 FIN
    ds_read_b32 v64, v55 offset:26624
    ds_read_b32 v65, v55 offset:26752
    ds_read_b32 v66, v55 offset:26880
    ds_read_b32 v67, v55 offset:27008
    ds_read_b32 v68, v55 offset:27136
    ds_read_b32 v69, v55 offset:27264
    ds_read_b32 v70, v55 offset:27392
    ds_read_b32 v71, v55 offset:27520
    s_waitcnt lgkmcnt(0)
    v_pk_add_f32 v[64:65], v[64:65], v[68:69]
    v_pk_add_f32 v[66:67], v[66:67], v[70:71]
    v_pk_add_f32 v[64:65], v[64:65], v[66:67]
    v_add_f32 v64, v64, v65
    v_cvt_pk_bf16_f32 v64, v64, v64
    v_and_b32 v64, s12, v64
    v_mul_f32 v64, v64, v45
    v_cvt_pk_bf16_f32 v64, v64, v64
    v_and_b32 v64, s12, v64
    v_add_f32 v64, v64, v47
    v_cvt_pk_bf16_f32 v64, v64, v64
    v_and_b32 v64, s12, v64
    v_mul_f32 v64, v64, v48
    v_cvt_pk_bf16_f32 v64, v64, v64
    v_and_b32 v64, s12, v64
    v_add_f32 v64, v64, v46
    v_cvt_pk_bf16_f32 v64, v64, v64
    global_store_short v43, v64, s[64:65] sc1
FIN:
EXIT:
    s_endpgm
.section .rodata,"a"
.p2align 6
.amdhsa_kernel adaLN_cond__ssm_conv_s4d__moe_arch_mod__prompt_kernel
  .amdhsa_next_free_vgpr 256
  .amdhsa_next_free_sgpr 102
  .amdhsa_accum_offset 256
  .amdhsa_group_segment_fixed_size 0
  .amdhsa_kernarg_size 136
  .amdhsa_user_sgpr_count 2
  .amdhsa_user_sgpr_kernarg_segment_ptr 1
  .amdhsa_system_sgpr_workgroup_id_x 1
.end_amdhsa_kernel
```

```asm
; @launch grid=(256,1,1) block=(512,1,1) lds=163328
.amdgcn_target "amdgcn-amd-amdhsa--gfx950"
.text
.globl adaLN_cond__ssm_conv_s4d__moe_arch_mod__prompt_kernel
.p2align 8
.type adaLN_cond__ssm_conv_s4d__moe_arch_mod__prompt_kernel,@function
adaLN_cond__ssm_conv_s4d__moe_arch_mod__prompt_kernel:
    s_cmp_ge_u32 s2, 256
    s_cbranch_scc1 EXIT
    s_load_dwordx16 s[36:51], s[0:1], 0
    s_load_dwordx16 s[52:67], s[0:1], 64
    s_load_dwordx2 s[68:69], s[0:1], 128
    v_lshrrev_b32 v2, 6, v0
    v_and_b32 v1, 63, v0
    v_readfirstlane_b32 s3, v2
    s_and_b32 s4, s2, 7
    s_lshr_b32 s5, s2, 3
    s_mul_i32 s6, s4, 18
    s_add_u32 s6, s6, s5
    s_mul_i32 s7, s4, 14
    s_add_u32 s7, s7, s5
    s_sub_u32 s7, s7, 18
    s_and_b32 s9, s3, 3
    s_sub_u32 s8, s6, 14
    s_cmp_ge_u32 s5, 14
    s_cselect_b32 s13, 1, 0
    s_cmp_ge_u32 s3, 4
    s_cselect_b32 s13, s13, 0
    s_mov_b32 s10, 0x20000
    s_mov_b32 s12, 0xffff0000
    s_lshl_b32 s11, s2, 3
    s_add_u32 s11, s11, s3
    v_lshlrev_b32 v7, 4, v1
    v_lshlrev_b32 v13, 1, v1
    v_add_u32 v13, 1024, v13
    s_cmp_lt_u32 s3, 4
    s_cbranch_scc1 ENT_A
    s_cmp_ge_u32 s2, 4
    s_cbranch_scc1 ENT_B
    v_mov_b32 v64, -1
    v_mov_b32 v65, -1
    v_mov_b32 v66, -1
    v_mov_b32 v67, -1
    s_lshl_b32 s20, s2, 2
    s_add_u32 s20, s20, s9
    s_lshl_b32 s21, s20, 11
    v_add_u32 v68, s21, v7
    s_lshl_b32 s20, s20, 2
    v_mov_b32 v69, s20
    s_waitcnt lgkmcnt(0)
    global_store_dwordx4 v68, v[64:67], s[68:69] sc1
    global_store_dwordx4 v68, v[64:67], s[68:69] offset:1024 sc1
    s_waitcnt vmcnt(0)
    s_mov_b64 exec, 1
    global_store_dword v69, v64, s[66:67] offset:192 sc1
    s_mov_b64 exec, -1
ENT_B:
    s_cmp_lg_u32 s3, 4
    s_cbranch_scc1 ENT_B2
    v_lshlrev_b32 v64, 2, v1
    v_add_u32 v64, 143360, v64
    v_cmp_gt_u32 vcc, 16, v1
    s_nop 1
    v_cndmask_b32 v65, -1, 0, vcc
    s_mov_b32 exec_hi, 0
    ds_write_b32 v64, v65
    s_mov_b32 exec_hi, -1
ENT_B2:
    s_cmp_ge_u32 s5, 18
    s_cbranch_scc0 CONV_B
    s_branch NONCONV
ENT_A:
    s_cmp_lg_u32 s3, 3
    s_cbranch_scc1 ENT_A2
    s_getpc_b64 s[20:21]
PCREF:
    s_lshl_b32 s22, s5, 10
    v_add_u32 v64, s22, v7
    v_min_u32 v64, CODE_END-PCREF-16, v64
    v_mov_b32 v65, 0
    v_lshl_add_u64 v[64:65], v[64:65], 0, s[20:21]
    global_load_dwordx4 v[240:243], v[64:65], off
ENT_A2:
    s_cmp_ge_u32 s5, 18
    s_cbranch_scc1 NONCONV
    s_lshl_b32 s20, s6, 2
    s_add_u32 s20, s20, s3
    s_lshl_b32 s21, s20, 8
    v_lshl_add_u32 v64, v1, 2, s21
    s_lshl_b32 s14, s20, 1
    v_mov_b32 v65, s14
    s_mul_i32 s15, s3, 31232
    s_waitcnt lgkmcnt(0)
    global_load_ushort v70, v65, s[46:47]
    global_load_dword v66, v64, s[38:39] nt
    global_load_dword v67, v64, s[40:41] nt
    global_load_dword v68, v64, s[42:43] nt
    global_load_dword v69, v64, s[44:45] nt
    global_load_ushort v71, v65, s[48:49]
    global_load_dwordx4 v[8:11], v7, s[52:53]
    global_load_ushort v12, v13, s[52:53]
    s_barrier
    v_lshl_add_u32 v224, v1, 3, s15
    v_bfe_u32 v72, v1, 2, 3
    v_mov_b32 v73, 0
    v_cmp_eq_u32 vcc, 0, v72
    v_mov_b32 v74, 0x3020100
    s_nop 0
    v_cndmask_b32 v73, v73, v74, vcc
    v_cmp_eq_u32 vcc, 1, v72
    v_mov_b32 v74, 0x6050404
    s_nop 0
    v_cndmask_b32 v73, v73, v74, vcc
    v_cmp_eq_u32 vcc, 2, v72
    v_mov_b32 v74, 0xa090807
    s_nop 0
    v_cndmask_b32 v73, v73, v74, vcc
    v_cmp_eq_u32 vcc, 3, v72
    v_mov_b32 v74, 0xc0b0606
    s_nop 0
    v_cndmask_b32 v73, v73, v74, vcc
    v_cmp_eq_u32 vcc, 4, v72
    v_mov_b32 v74, 0xf0f0e0d
    s_nop 0
    v_cndmask_b32 v73, v73, v74, vcc
    v_cmp_eq_u32 vcc, 5, v72
    v_mov_b32 v74, 0x12121110
    s_nop 0
    v_cndmask_b32 v73, v73, v74, vcc
    v_cmp_eq_u32 vcc, 6, v72
    v_mov_b32 v74, 0x16151413
    s_nop 0
    v_cndmask_b32 v73, v73, v74, vcc
    v_cmp_eq_u32 vcc, 7, v72
    v_mov_b32 v74, 0x1a191817
    s_nop 0
    v_cndmask_b32 v73, v73, v74, vcc
    v_and_b32 v72, 3, v1
    v_lshlrev_b32 v72, 3, v72
    v_bfe_u32 v73, v73, v72, 8
    v_lshrrev_b32 v72, 5, v1
    v_lshl_add_u32 v72, v72, 4, s15
    s_movk_i32 s20, 528
    v_mad_u32_u24 v225, v73, s20, v72
    v_and_b32 v73, 31, v1
    v_add_u32 v73, 27, v73
    v_mad_u32_u24 v226, v73, s20, v72
    v_lshlrev_b32 v72, 4, v1
    v_sub_u32 v227, 1008, v72
    v_add_u32 v227, s15, v227
    v_and_b32 v72, 3, v1
    v_sub_u32 v72, 3, v72
    s_movk_i32 s20, 4160
    v_mul_u32_u24 v72, s20, v72
    v_bfe_u32 v73, v1, 2, 2
    v_sub_u32 v73, 3, v73
    v_lshl_add_u32 v72, v73, 3, v72
    v_lshrrev_b32 v73, 4, v1
    v_lshl_add_u32 v72, v73, 4, v72
    v_add_u32 v228, s15, v72
    v_and_b32 v72, 15, v1
    v_lshlrev_b32 v72, 5, v72
    v_lshl_add_u32 v74, v73, 4, v72
    s_mul_i32 s20, s3, 4608
    s_add_u32 s20, s20, 124928
    v_add_u32 v229, s20, v74
    v_lshl_add_u32 v74, v73, 3, v72
    s_lshl_b32 s20, s3, 6
    s_add_u32 s20, s20, s15
    v_add_u32 v230, s20, v74
    s_mov_b32 s16, 0x3fb8aa3b
    s_mov_b32 s17, 0x3e22f983
    s_waitcnt vmcnt(6)
    v_lshlrev_b32 v70, 16, v70
    v_mul_f32 v70, s16, v70
    v_exp_f32 v70, v70
    v_lshlrev_b32 v74, 16, v66
    v_and_b32 v75, s12, v66
    v_mul_f32 v74, s16, v74
    v_mul_f32 v75, s16, v75
    v_exp_f32 v74, v74
    v_exp_f32 v75, v75
    v_cvt_pk_bf16_f32 v70, v70, v70
    v_and_b32 v70, s12, v70
    v_cvt_pk_bf16_f32 v74, v74, v75
    v_and_b32 v75, s12, v74
    v_lshlrev_b32 v74, 16, v74
    v_mul_f32 v74, v74, v70
    v_mul_f32 v75, v75, v70
    v_mul_f32 v74, 0xbfb8aa3b, v74
    v_mul_f32 v75, 0xbfb8aa3b, v75
    s_waitcnt vmcnt(5)
    v_lshlrev_b32 v76, 16, v67
    v_and_b32 v77, s12, v67
    v_mul_f32 v76, v76, v70
    v_mul_f32 v77, v77, v70
    v_mul_f32 v76, s17, v76
    v_mul_f32 v77, s17, v77
    v_exp_f32 v96, v74
    v_fract_f32 v97, v76
    v_cos_f32 v98, v97
    v_sin_f32 v99, v97
    v_exp_f32 v100, v75
    v_fract_f32 v101, v77
    v_cos_f32 v102, v101
    v_sin_f32 v103, v101
    v_mul_f32 v84, v96, v98
    v_mul_f32 v86, v96, v99
    v_mul_f32 v85, v100, v102
    v_mul_f32 v87, v100, v103
    v_mul_f32 v96, 0x41000000, v74
    v_mul_f32 v97, 0x41000000, v76
    v_exp_f32 v96, v96
    v_fract_f32 v97, v97
    v_cos_f32 v98, v97
    v_sin_f32 v99, v97
    v_mul_f32 v100, 0x41000000, v75
    v_mul_f32 v101, 0x41000000, v77
    v_exp_f32 v100, v100
    v_fract_f32 v101, v101
    v_cos_f32 v102, v101
    v_sin_f32 v103, v101
    v_mul_f32 v88, v96, v98
    v_mul_f32 v90, v96, v99
    v_mul_f32 v89, v100, v102
    v_mul_f32 v91, v100, v103
    v_mul_f32 v96, 0x43800000, v74
    v_mul_f32 v97, 0x43800000, v76
    v_exp_f32 v96, v96
    v_fract_f32 v97, v97
    v_cos_f32 v98, v97
    v_sin_f32 v99, v97
    v_mul_f32 v100, 0x43800000, v75
    v_mul_f32 v101, 0x43800000, v77
    v_exp_f32 v100, v100
    v_fract_f32 v101, v101
    v_cos_f32 v102, v101
    v_sin_f32 v103, v101
    v_mul_f32 v92, v96, v98
    v_mul_f32 v94, v96, v99
    v_mul_f32 v93, v100, v102
    v_mul_f32 v95, v100, v103
    s_waitcnt vmcnt(2)
    v_lshlrev_b32 v78, 16, v68
    v_and_b32 v79, s12, v68
    v_lshlrev_b32 v80, 16, v69
    v_and_b32 v81, s12, v69
    v_max_f32 v82, |v78|, |v79|
    v_max3_f32 v82, |v80|, |v81|, v82
    s_nop 1
    v_max_f32_dpp v82, v82, v82 row_ror:8 row_mask:0xf bank_mask:0xf
    s_nop 1
    v_max_f32_dpp v82, v82, v82 row_ror:4 row_mask:0xf bank_mask:0xf
    s_nop 1
    v_max_f32_dpp v82, v82, v82 row_ror:2 row_mask:0xf bank_mask:0xf
    s_nop 1
    v_max_f32_dpp v82, v82, v82 row_ror:1 row_mask:0xf bank_mask:0xf
    v_mov_b32 v83, v82
    s_nop 1
    v_permlane16_swap_b32 v82, v83
    v_max_f32 v82, v82, v83
    v_mov_b32 v83, v82
    s_nop 1
    v_permlane32_swap_b32 v82, v83
    v_max_f32 v82, v82, v83
    v_max_f32 v82, 0x0da24260, v82
    v_rcp_f32 v83, v82
    v_lshlrev_b32 v71, 16, v71
    v_mul_f32 v82, v82, v70
    v_add_f32 v82, v82, v82
    v_and_b32 v72, 0x7fffffff, v71
    v_mul_f32 v72, 0x3a800000, v72
    v_max_f32 v72, v72, v82
    v_max_f32 v72, 0x0da24260, v72
    v_rcp_f32 v73, v72
    v_mov_b32 v233, v72
    v_mul_f32 v231, v82, v73
    v_mul_f32 v232, v71, v73
    v_pk_mul_f32 v[104:105], v[78:79], v[82:83] op_sel:[0,1] op_sel_hi:[1,1]
    v_pk_mul_f32 v[106:107], v[80:81], v[82:83] op_sel:[0,1] op_sel_hi:[1,1]
    v_mov_b32 v148, 0x3c00
    v_cvt_pk_f16_f32 v144, v104, v106
    v_mov_b32 v149, 0x3c00
    v_cvt_pk_f16_f32 v145, v105, v107
    ds_write_b64 v224, v[148:149] offset:14256
    ds_write_b64 v224, v[144:145] offset:0
    v_pk_mul_f32 v[128:129], v[88:89], 1.0 op_sel_hi:[1,0]
    v_pk_mul_f32 v[136:137], v[106:107], v[86:87]
    v_pk_mul_f32 v[130:131], v[90:91], -1.0 op_sel_hi:[1,0]
    v_pk_mul_f32 v[138:139], v[106:107], v[84:85]
    v_cvt_pk_f16_f32 v150, v128, v130
    v_pk_fma_f32 v[126:127], v[104:105], v[86:87], v[138:139]
    v_cvt_pk_f16_f32 v151, v129, v131
    v_pk_fma_f32 v[124:125], v[104:105], v[84:85], v[136:137] neg_lo:[0,0,1] neg_hi:[0,0,1]
    ds_write_b64 v224, v[150:151] offset:14784
    v_cvt_pk_f16_f32 v146, v124, v126
    v_pk_mul_f32 v[140:141], v[130:131], v[90:91]
    v_cvt_pk_f16_f32 v147, v125, v127
    v_pk_mul_f32 v[142:143], v[130:131], v[88:89]
    ds_write_b64 v224, v[146:147] offset:528
    v_pk_fma_f32 v[130:131], v[128:129], v[90:91], v[142:143] neg_lo:[0,1,0] neg_hi:[0,1,0]
    v_pk_mul_f32 v[136:137], v[126:127], v[86:87]
    v_pk_fma_f32 v[128:129], v[128:129], v[88:89], v[140:141]
    v_pk_mul_f32 v[138:139], v[126:127], v[84:85]
    v_cvt_pk_f16_f32 v148, v128, v130
    v_pk_fma_f32 v[110:111], v[124:125], v[86:87], v[138:139]
    v_cvt_pk_f16_f32 v149, v129, v131
    v_pk_fma_f32 v[108:109], v[124:125], v[84:85], v[136:137] neg_lo:[0,0,1] neg_hi:[0,0,1]
    ds_write_b64 v224, v[148:149] offset:15312
    v_cvt_pk_f16_f32 v144, v108, v110
    v_pk_mul_f32 v[140:141], v[130:131], v[90:91]
    v_cvt_pk_f16_f32 v145, v109, v111
    v_pk_mul_f32 v[142:143], v[130:131], v[88:89]
    ds_write_b64 v224, v[144:145] offset:1056
    v_pk_fma_f32 v[130:131], v[128:129], v[90:91], v[142:143] neg_lo:[0,1,0] neg_hi:[0,1,0]
    v_pk_mul_f32 v[136:137], v[110:111], v[86:87]
    v_pk_fma_f32 v[128:129], v[128:129], v[88:89], v[140:141]
    v_pk_mul_f32 v[138:139], v[110:111], v[84:85]
    v_cvt_pk_f16_f32 v150, v128, v130
    v_pk_fma_f32 v[126:127], v[108:109], v[86:87], v[138:139]
    v_cvt_pk_f16_f32 v151, v129, v131
    v_pk_fma_f32 v[124:125], v[108:109], v[84:85], v[136:137] neg_lo:[0,0,1] neg_hi:[0,0,1]
    ds_write_b64 v224, v[150:151] offset:15840
    v_cvt_pk_f16_f32 v146, v124, v126
    v_pk_mul_f32 v[140:141], v[130:131], v[90:91]
    v_cvt_pk_f16_f32 v147, v125, v127
    v_pk_mul_f32 v[142:143], v[130:131], v[88:89]
    ds_write_b64 v224, v[146:147] offset:1584
    v_pk_fma_f32 v[130:131], v[128:129], v[90:91], v[142:143] neg_lo:[0,1,0] neg_hi:[0,1,0]
    v_pk_mul_f32 v[136:137], v[126:127], v[86:87]
    v_pk_fma_f32 v[128:129], v[128:129], v[88:89], v[140:141]
    v_pk_mul_f32 v[138:139], v[126:127], v[84:85]
    v_cvt_pk_f16_f32 v148, v128, v130
    v_pk_fma_f32 v[114:115], v[124:125], v[86:87], v[138:139]
    v_cvt_pk_f16_f32 v149, v129, v131
    v_pk_fma_f32 v[112:113], v[124:125], v[84:85], v[136:137] neg_lo:[0,0,1] neg_hi:[0,0,1]
    ds_write_b64 v224, v[148:149] offset:16368
    v_cvt_pk_f16_f32 v144, v112, v114
    v_pk_mul_f32 v[140:141], v[130:131], v[90:91]
    v_cvt_pk_f16_f32 v145, v113, v115
    v_pk_mul_f32 v[142:143], v[130:131], v[88:89]
    ds_write_b64 v224, v[144:145] offset:3696
    v_pk_fma_f32 v[130:131], v[128:129], v[90:91], v[142:143] neg_lo:[0,1,0] neg_hi:[0,1,0]
    v_pk_mul_f32 v[136:137], v[114:115], v[86:87]
    v_pk_fma_f32 v[128:129], v[128:129], v[88:89], v[140:141]
    v_pk_mul_f32 v[138:139], v[114:115], v[84:85]
    v_cvt_pk_f16_f32 v150, v128, v130
    v_pk_fma_f32 v[126:127], v[112:113], v[86:87], v[138:139]
    v_cvt_pk_f16_f32 v151, v129, v131
    v_pk_fma_f32 v[124:125], v[112:113], v[84:85], v[136:137] neg_lo:[0,0,1] neg_hi:[0,0,1]
    ds_write_b64 v224, v[150:151] offset:16896
    v_cvt_pk_f16_f32 v146, v124, v126
    v_pk_mul_f32 v[140:141], v[130:131], v[90:91]
    v_cvt_pk_f16_f32 v147, v125, v127
    v_pk_mul_f32 v[142:143], v[130:131], v[88:89]
    ds_write_b64 v224, v[146:147] offset:4224
    v_pk_fma_f32 v[130:131], v[128:129], v[90:91], v[142:143] neg_lo:[0,1,0] neg_hi:[0,1,0]
    v_pk_mul_f32 v[136:137], v[126:127], v[86:87]
    v_pk_fma_f32 v[128:129], v[128:129], v[88:89], v[140:141]
    v_pk_mul_f32 v[138:139], v[126:127], v[84:85]
    v_cvt_pk_f16_f32 v148, v128, v130
    v_pk_fma_f32 v[118:119], v[124:125], v[86:87], v[138:139]
    v_cvt_pk_f16_f32 v149, v129, v131
    v_pk_fma_f32 v[116:117], v[124:125], v[84:85], v[136:137] neg_lo:[0,0,1] neg_hi:[0,0,1]
    ds_write_b64 v224, v[148:149] offset:17424
    v_cvt_pk_f16_f32 v144, v116, v118
    v_pk_mul_f32 v[140:141], v[130:131], v[90:91]
    v_cvt_pk_f16_f32 v145, v117, v119
    v_pk_mul_f32 v[142:143], v[130:131], v[88:89]
    ds_write_b64 v224, v[144:145] offset:4752
    v_pk_fma_f32 v[130:131], v[128:129], v[90:91], v[142:143] neg_lo:[0,1,0] neg_hi:[0,1,0]
    v_pk_mul_f32 v[136:137], v[118:119], v[86:87]
    v_pk_fma_f32 v[128:129], v[128:129], v[88:89], v[140:141]
    v_pk_mul_f32 v[138:139], v[118:119], v[84:85]
    v_cvt_pk_f16_f32 v150, v128, v130
    v_pk_fma_f32 v[126:127], v[116:117], v[86:87], v[138:139]
    v_cvt_pk_f16_f32 v151, v129, v131
    v_pk_fma_f32 v[124:125], v[116:117], v[84:85], v[136:137] neg_lo:[0,0,1] neg_hi:[0,0,1]
    ds_write_b64 v224, v[150:151] offset:17952
    v_cvt_pk_f16_f32 v146, v124, v126
    v_pk_mul_f32 v[140:141], v[130:131], v[90:91]
    v_cvt_pk_f16_f32 v147, v125, v127
    v_pk_mul_f32 v[142:143], v[130:131], v[88:89]
    ds_write_b64 v224, v[146:147] offset:5280
    v_pk_fma_f32 v[130:131], v[128:129], v[90:91], v[142:143] neg_lo:[0,1,0] neg_hi:[0,1,0]
    v_pk_mul_f32 v[136:137], v[126:127], v[86:87]
    v_pk_fma_f32 v[128:129], v[128:129], v[88:89], v[140:141]
    v_pk_mul_f32 v[138:139], v[126:127], v[84:85]
    v_cvt_pk_f16_f32 v148, v128, v130
    v_pk_fma_f32 v[122:123], v[124:125], v[86:87], v[138:139]
    v_cvt_pk_f16_f32 v149, v129, v131
    v_pk_fma_f32 v[120:121], v[124:125], v[84:85], v[136:137] neg_lo:[0,0,1] neg_hi:[0,0,1]
    ds_write_b64 v224, v[148:149] offset:18480
    v_pk_mul_f32 v[136:137], v[106:107], v[94:95]
    v_pk_mul_f32 v[140:141], v[130:131], v[90:91]
    v_pk_mul_f32 v[138:139], v[106:107], v[92:93]
    v_pk_mul_f32 v[142:143], v[130:131], v[88:89]
    v_pk_fma_f32 v[106:107], v[104:105], v[94:95], v[138:139]
    v_pk_fma_f32 v[130:131], v[128:129], v[90:91], v[142:143] neg_lo:[0,1,0] neg_hi:[0,1,0]
    v_pk_fma_f32 v[104:105], v[104:105], v[92:93], v[136:137] neg_lo:[0,0,1] neg_hi:[0,0,1]
    v_pk_fma_f32 v[128:129], v[128:129], v[88:89], v[140:141]
    v_cvt_pk_f16_f32 v146, v104, v106
    v_cvt_pk_f16_f32 v150, v128, v130
    v_cvt_pk_f16_f32 v147, v105, v107
    v_cvt_pk_f16_f32 v151, v129, v131
    ds_write_b64 v224, v[146:147] offset:2112
    ds_write_b64 v224, v[150:151] offset:19008
    v_pk_mul_f32 v[136:137], v[110:111], v[94:95]
    v_pk_mul_f32 v[140:141], v[130:131], v[90:91]
    v_pk_mul_f32 v[138:139], v[110:111], v[92:93]
    v_pk_mul_f32 v[142:143], v[130:131], v[88:89]
    v_pk_fma_f32 v[110:111], v[108:109], v[94:95], v[138:139]
    v_pk_fma_f32 v[130:131], v[128:129], v[90:91], v[142:143] neg_lo:[0,1,0] neg_hi:[0,1,0]
    v_pk_fma_f32 v[108:109], v[108:109], v[92:93], v[136:137] neg_lo:[0,0,1] neg_hi:[0,0,1]
    v_pk_fma_f32 v[128:129], v[128:129], v[88:89], v[140:141]
    v_cvt_pk_f16_f32 v144, v108, v110
    v_cvt_pk_f16_f32 v148, v128, v130
    v_cvt_pk_f16_f32 v145, v109, v111
    v_cvt_pk_f16_f32 v149, v129, v131
    ds_write_b64 v224, v[144:145] offset:2640
    ds_write_b64 v224, v[148:149] offset:19536
    v_pk_mul_f32 v[136:137], v[114:115], v[94:95]
    v_pk_mul_f32 v[140:141], v[130:131], v[90:91]
    v_pk_mul_f32 v[138:139], v[114:115], v[92:93]
    v_pk_mul_f32 v[142:143], v[130:131], v[88:89]
    v_pk_fma_f32 v[114:115], v[112:113], v[94:95], v[138:139]
    v_pk_fma_f32 v[130:131], v[128:129], v[90:91], v[142:143] neg_lo:[0,1,0] neg_hi:[0,1,0]
    v_pk_fma_f32 v[112:113], v[112:113], v[92:93], v[136:137] neg_lo:[0,0,1] neg_hi:[0,0,1]
    v_pk_fma_f32 v[128:129], v[128:129], v[88:89], v[140:141]
    v_cvt_pk_f16_f32 v146, v112, v114
    v_cvt_pk_f16_f32 v150, v128, v130
    v_cvt_pk_f16_f32 v147, v113, v115
    v_cvt_pk_f16_f32 v151, v129, v131
    ds_write_b64 v224, v[146:147] offset:3168
    ds_write_b64 v224, v[150:151] offset:20064
    v_pk_mul_f32 v[136:137], v[118:119], v[94:95]
    v_pk_mul_f32 v[140:141], v[130:131], v[90:91]
    v_pk_mul_f32 v[138:139], v[118:119], v[92:93]
    v_pk_mul_f32 v[142:143], v[130:131], v[88:89]
    v_pk_fma_f32 v[118:119], v[116:117], v[94:95], v[138:139]
    v_pk_fma_f32 v[130:131], v[128:129], v[90:91], v[142:143] neg_lo:[0,1,0] neg_hi:[0,1,0]
    v_pk_fma_f32 v[116:117], v[116:117], v[92:93], v[136:137] neg_lo:[0,0,1] neg_hi:[0,0,1]
    v_pk_fma_f32 v[128:129], v[128:129], v[88:89], v[140:141]
    v_cvt_pk_f16_f32 v144, v116, v118
    v_cvt_pk_f16_f32 v148, v128, v130
    v_cvt_pk_f16_f32 v145, v117, v119
    v_cvt_pk_f16_f32 v149, v129, v131
    ds_write_b64 v224, v[144:145] offset:5808
    ds_write_b64 v224, v[148:149] offset:20592
    v_pk_mul_f32 v[136:137], v[122:123], v[94:95]
    v_pk_mul_f32 v[140:141], v[130:131], v[90:91]
    v_pk_mul_f32 v[138:139], v[122:123], v[92:93]
    v_pk_mul_f32 v[142:143], v[130:131], v[88:89]
    v_pk_fma_f32 v[122:123], v[120:121], v[94:95], v[138:139]
    v_pk_fma_f32 v[130:131], v[128:129], v[90:91], v[142:143] neg_lo:[0,1,0] neg_hi:[0,1,0]
    v_pk_fma_f32 v[120:121], v[120:121], v[92:93], v[136:137] neg_lo:[0,0,1] neg_hi:[0,0,1]
    v_pk_fma_f32 v[128:129], v[128:129], v[88:89], v[140:141]
    v_cvt_pk_f16_f32 v146, v120, v122
    v_cvt_pk_f16_f32 v150, v128, v130
    v_cvt_pk_f16_f32 v147, v121, v123
    v_cvt_pk_f16_f32 v151, v129, v131
    ds_write_b64 v224, v[146:147] offset:6336
    ds_write_b64 v224, v[150:151] offset:21120
    v_pk_mul_f32 v[136:137], v[106:107], v[94:95]
    v_pk_mul_f32 v[140:141], v[130:131], v[90:91]
    v_pk_mul_f32 v[138:139], v[106:107], v[92:93]
    v_pk_mul_f32 v[142:143], v[130:131], v[88:89]
    v_pk_fma_f32 v[106:107], v[104:105], v[94:95], v[138:139]
    v_pk_fma_f32 v[130:131], v[128:129], v[90:91], v[142:143] neg_lo:[0,1,0] neg_hi:[0,1,0]
    v_pk_fma_f32 v[104:105], v[104:105], v[92:93], v[136:137] neg_lo:[0,0,1] neg_hi:[0,0,1]
    v_pk_fma_f32 v[128:129], v[128:129], v[88:89], v[140:141]
    v_cvt_pk_f16_f32 v144, v104, v106
    v_cvt_pk_f16_f32 v148, v128, v130
    v_cvt_pk_f16_f32 v145, v105, v107
    v_cvt_pk_f16_f32 v149, v129, v131
    ds_write_b64 v224, v[144:145] offset:6864
    ds_write_b64 v224, v[148:149] offset:21648
    v_pk_mul_f32 v[136:137], v[114:115], v[94:95]
    v_pk_mul_f32 v[140:141], v[130:131], v[90:91]
    v_pk_mul_f32 v[138:139], v[114:115], v[92:93]
    v_pk_mul_f32 v[142:143], v[130:131], v[88:89]
    v_pk_fma_f32 v[114:115], v[112:113], v[94:95], v[138:139]
    v_pk_fma_f32 v[130:131], v[128:129], v[90:91], v[142:143] neg_lo:[0,1,0] neg_hi:[0,1,0]
    v_pk_fma_f32 v[112:113], v[112:113], v[92:93], v[136:137] neg_lo:[0,0,1] neg_hi:[0,0,1]
    v_pk_fma_f32 v[128:129], v[128:129], v[88:89], v[140:141]
    v_cvt_pk_f16_f32 v146, v112, v114
    v_cvt_pk_f16_f32 v150, v128, v130
    v_cvt_pk_f16_f32 v147, v113, v115
    v_cvt_pk_f16_f32 v151, v129, v131
    ds_write_b64 v224, v[146:147] offset:7392
    ds_write_b64 v224, v[150:151] offset:22176
    v_pk_mul_f32 v[136:137], v[122:123], v[94:95]
    v_pk_mul_f32 v[140:141], v[130:131], v[90:91]
    v_pk_mul_f32 v[138:139], v[122:123], v[92:93]
    v_pk_mul_f32 v[142:143], v[130:131], v[88:89]
    v_pk_fma_f32 v[122:123], v[120:121], v[94:95], v[138:139]
    v_pk_fma_f32 v[130:131], v[128:129], v[90:91], v[142:143] neg_lo:[0,1,0] neg_hi:[0,1,0]
    v_pk_fma_f32 v[120:121], v[120:121], v[92:93], v[136:137] neg_lo:[0,0,1] neg_hi:[0,0,1]
    v_pk_fma_f32 v[128:129], v[128:129], v[88:89], v[140:141]
    v_cvt_pk_f16_f32 v144, v120, v122
    v_cvt_pk_f16_f32 v148, v128, v130
    v_cvt_pk_f16_f32 v145, v121, v123
    v_cvt_pk_f16_f32 v149, v129, v131
    ds_write_b64 v224, v[144:145] offset:7920
    ds_write_b64 v224, v[148:149] offset:22704
    v_pk_mul_f32 v[136:137], v[106:107], v[94:95]
    v_pk_mul_f32 v[140:141], v[130:131], v[90:91]
    v_pk_mul_f32 v[138:139], v[106:107], v[92:93]
    v_pk_mul_f32 v[142:143], v[130:131], v[88:89]
    v_pk_fma_f32 v[106:107], v[104:105], v[94:95], v[138:139]
    v_pk_fma_f32 v[130:131], v[128:129], v[90:91], v[142:143] neg_lo:[0,1,0] neg_hi:[0,1,0]
    v_pk_fma_f32 v[104:105], v[104:105], v[92:93], v[136:137] neg_lo:[0,0,1] neg_hi:[0,0,1]
    v_pk_fma_f32 v[128:129], v[128:129], v[88:89], v[140:141]
    v_cvt_pk_f16_f32 v146, v104, v106
    v_cvt_pk_f16_f32 v150, v128, v130
    v_cvt_pk_f16_f32 v147, v105, v107
    v_cvt_pk_f16_f32 v151, v129, v131
    ds_write_b64 v224, v[146:147] offset:8448
    ds_write_b64 v224, v[150:151] offset:23232
    v_pk_mul_f32 v[136:137], v[114:115], v[94:95]
    v_pk_mul_f32 v[140:141], v[130:131], v[90:91]
    v_pk_mul_f32 v[138:139], v[114:115], v[92:93]
    v_pk_mul_f32 v[142:143], v[130:131], v[88:89]
    v_pk_fma_f32 v[114:115], v[112:113], v[94:95], v[138:139]
    v_pk_fma_f32 v[130:131], v[128:129], v[90:91], v[142:143] neg_lo:[0,1,0] neg_hi:[0,1,0]
    v_pk_fma_f32 v[112:113], v[112:113], v[92:93], v[136:137] neg_lo:[0,0,1] neg_hi:[0,0,1]
    v_pk_fma_f32 v[128:129], v[128:129], v[88:89], v[140:141]
    v_cvt_pk_f16_f32 v144, v112, v114
    v_cvt_pk_f16_f32 v148, v128, v130
    v_cvt_pk_f16_f32 v145, v113, v115
    v_cvt_pk_f16_f32 v149, v129, v131
    ds_write_b64 v224, v[144:145] offset:8976
    ds_write_b64 v224, v[148:149] offset:23760
    v_pk_mul_f32 v[136:137], v[122:123], v[94:95]
    v_pk_mul_f32 v[140:141], v[130:131], v[90:91]
    v_pk_mul_f32 v[138:139], v[122:123], v[92:93]
    v_pk_mul_f32 v[142:143], v[130:131], v[88:89]
    v_pk_fma_f32 v[122:123], v[120:121], v[94:95], v[138:139]
    v_pk_fma_f32 v[130:131], v[128:129], v[90:91], v[142:143] neg_lo:[0,1,0] neg_hi:[0,1,0]
    v_pk_fma_f32 v[120:121], v[120:121], v[92:93], v[136:137] neg_lo:[0,0,1] neg_hi:[0,0,1]
    v_pk_fma_f32 v[128:129], v[128:129], v[88:89], v[140:141]
    v_cvt_pk_f16_f32 v146, v120, v122
    v_cvt_pk_f16_f32 v150, v128, v130
    v_cvt_pk_f16_f32 v147, v121, v123
    v_cvt_pk_f16_f32 v151, v129, v131
    ds_write_b64 v224, v[146:147] offset:9504
    ds_write_b64 v224, v[150:151] offset:24288
    v_pk_mul_f32 v[136:137], v[106:107], v[94:95]
    v_pk_mul_f32 v[140:141], v[130:131], v[90:91]
    v_pk_mul_f32 v[138:139], v[106:107], v[92:93]
    v_pk_mul_f32 v[142:143], v[130:131], v[88:89]
    v_pk_fma_f32 v[106:107], v[104:105], v[94:95], v[138:139]
    v_pk_fma_f32 v[130:131], v[128:129], v[90:91], v[142:143] neg_lo:[0,1,0] neg_hi:[0,1,0]
    v_pk_fma_f32 v[104:105], v[104:105], v[92:93], v[136:137] neg_lo:[0,0,1] neg_hi:[0,0,1]
    v_pk_fma_f32 v[128:129], v[128:129], v[88:89], v[140:141]
    v_cvt_pk_f16_f32 v144, v104, v106
    v_cvt_pk_f16_f32 v148, v128, v130
    v_cvt_pk_f16_f32 v145, v105, v107
    v_cvt_pk_f16_f32 v149, v129, v131
    ds_write_b64 v224, v[144:145] offset:10032
    ds_write_b64 v224, v[148:149] offset:24816
    v_pk_mul_f32 v[136:137], v[122:123], v[94:95]
    v_pk_mul_f32 v[140:141], v[130:131], v[90:91]
    v_pk_mul_f32 v[138:139], v[122:123], v[92:93]
    v_pk_mul_f32 v[142:143], v[130:131], v[88:89]
    v_pk_fma_f32 v[122:123], v[120:121], v[94:95], v[138:139]
    v_pk_fma_f32 v[130:131], v[128:129], v[90:91], v[142:143] neg_lo:[0,1,0] neg_hi:[0,1,0]
    v_pk_fma_f32 v[120:121], v[120:121], v[92:93], v[136:137] neg_lo:[0,0,1] neg_hi:[0,0,1]
    v_pk_fma_f32 v[128:129], v[128:129], v[88:89], v[140:141]
    v_cvt_pk_f16_f32 v146, v120, v122
    v_cvt_pk_f16_f32 v150, v128, v130
    v_cvt_pk_f16_f32 v147, v121, v123
    v_cvt_pk_f16_f32 v151, v129, v131
    ds_write_b64 v224, v[146:147] offset:10560
    ds_write_b64 v224, v[150:151] offset:25344
    v_pk_mul_f32 v[136:137], v[106:107], v[94:95]
    v_pk_mul_f32 v[140:141], v[130:131], v[90:91]
    v_pk_mul_f32 v[138:139], v[106:107], v[92:93]
    v_pk_mul_f32 v[142:143], v[130:131], v[88:89]
    v_pk_fma_f32 v[106:107], v[104:105], v[94:95], v[138:139]
    v_pk_fma_f32 v[130:131], v[128:129], v[90:91], v[142:143] neg_lo:[0,1,0] neg_hi:[0,1,0]
    v_pk_fma_f32 v[104:105], v[104:105], v[92:93], v[136:137] neg_lo:[0,0,1] neg_hi:[0,0,1]
    v_pk_fma_f32 v[128:129], v[128:129], v[88:89], v[140:141]
    v_cvt_pk_f16_f32 v144, v104, v106
    v_cvt_pk_f16_f32 v148, v128, v130
    v_cvt_pk_f16_f32 v145, v105, v107
    v_cvt_pk_f16_f32 v149, v129, v131
    ds_write_b64 v224, v[144:145] offset:12144
    ds_write_b64 v224, v[148:149] offset:25872
    v_pk_mul_f32 v[136:137], v[122:123], v[94:95]
    v_pk_mul_f32 v[140:141], v[130:131], v[90:91]
    v_pk_mul_f32 v[138:139], v[122:123], v[92:93]
    v_pk_mul_f32 v[142:143], v[130:131], v[88:89]
    v_pk_fma_f32 v[122:123], v[120:121], v[94:95], v[138:139]
    v_pk_fma_f32 v[130:131], v[128:129], v[90:91], v[142:143] neg_lo:[0,1,0] neg_hi:[0,1,0]
    v_pk_fma_f32 v[120:121], v[120:121], v[92:93], v[136:137] neg_lo:[0,0,1] neg_hi:[0,0,1]
    v_pk_fma_f32 v[128:129], v[128:129], v[88:89], v[140:141]
    v_cvt_pk_f16_f32 v146, v120, v122
    v_cvt_pk_f16_f32 v150, v128, v130
    v_cvt_pk_f16_f32 v147, v121, v123
    v_cvt_pk_f16_f32 v151, v129, v131
    ds_write_b64 v224, v[146:147] offset:12672
    ds_write_b64 v224, v[150:151] offset:26400
    v_pk_mul_f32 v[136:137], v[106:107], v[94:95]
    v_pk_mul_f32 v[140:141], v[130:131], v[90:91]
    v_pk_mul_f32 v[138:139], v[106:107], v[92:93]
    v_pk_mul_f32 v[142:143], v[130:131], v[88:89]
    v_pk_fma_f32 v[106:107], v[104:105], v[94:95], v[138:139]
    v_pk_fma_f32 v[130:131], v[128:129], v[90:91], v[142:143] neg_lo:[0,1,0] neg_hi:[0,1,0]
    v_pk_fma_f32 v[104:105], v[104:105], v[92:93], v[136:137] neg_lo:[0,0,1] neg_hi:[0,0,1]
    v_pk_fma_f32 v[128:129], v[128:129], v[88:89], v[140:141]
    v_cvt_pk_f16_f32 v144, v104, v106
    v_cvt_pk_f16_f32 v148, v128, v130
    v_cvt_pk_f16_f32 v145, v105, v107
    v_cvt_pk_f16_f32 v149, v129, v131
    ds_write_b64 v224, v[144:145] offset:11088
    ds_write_b64 v224, v[148:149] offset:26928
    v_pk_mul_f32 v[136:137], v[122:123], v[94:95]
    v_pk_mul_f32 v[140:141], v[130:131], v[90:91]
    v_pk_mul_f32 v[138:139], v[122:123], v[92:93]
    v_pk_mul_f32 v[142:143], v[130:131], v[88:89]
    v_pk_fma_f32 v[122:123], v[120:121], v[94:95], v[138:139]
    v_pk_fma_f32 v[130:131], v[128:129], v[90:91], v[142:143] neg_lo:[0,1,0] neg_hi:[0,1,0]
    v_pk_fma_f32 v[120:121], v[120:121], v[92:93], v[136:137] neg_lo:[0,0,1] neg_hi:[0,0,1]
    v_pk_fma_f32 v[128:129], v[128:129], v[88:89], v[140:141]
    v_cvt_pk_f16_f32 v146, v120, v122
    v_cvt_pk_f16_f32 v150, v128, v130
    v_cvt_pk_f16_f32 v147, v121, v123
    v_cvt_pk_f16_f32 v151, v129, v131
    ds_write_b64 v224, v[146:147] offset:11616
    ds_write_b64 v224, v[150:151] offset:27456
    v_pk_mul_f32 v[136:137], v[106:107], v[94:95]
    v_pk_mul_f32 v[140:141], v[130:131], v[90:91]
    v_pk_mul_f32 v[138:139], v[106:107], v[92:93]
    v_pk_mul_f32 v[142:143], v[130:131], v[88:89]
    v_pk_fma_f32 v[106:107], v[104:105], v[94:95], v[138:139]
    v_pk_fma_f32 v[130:131], v[128:129], v[90:91], v[142:143] neg_lo:[0,1,0] neg_hi:[0,1,0]
    v_pk_fma_f32 v[104:105], v[104:105], v[92:93], v[136:137] neg_lo:[0,0,1] neg_hi:[0,0,1]
    v_pk_fma_f32 v[128:129], v[128:129], v[88:89], v[140:141]
    v_cvt_pk_f16_f32 v144, v104, v106
    v_cvt_pk_f16_f32 v148, v128, v130
    v_cvt_pk_f16_f32 v145, v105, v107
    v_cvt_pk_f16_f32 v149, v129, v131
    ds_write_b64 v224, v[144:145] offset:13200
    ds_write_b64 v224, v[148:149] offset:27984
    v_pk_mul_f32 v[136:137], v[122:123], v[94:95]
    v_pk_mul_f32 v[140:141], v[130:131], v[90:91]
    v_pk_mul_f32 v[138:139], v[122:123], v[92:93]
    v_pk_mul_f32 v[142:143], v[130:131], v[88:89]
    v_pk_fma_f32 v[122:123], v[120:121], v[94:95], v[138:139]
    v_pk_fma_f32 v[130:131], v[128:129], v[90:91], v[142:143] neg_lo:[0,1,0] neg_hi:[0,1,0]
    v_pk_fma_f32 v[120:121], v[120:121], v[92:93], v[136:137] neg_lo:[0,0,1] neg_hi:[0,0,1]
    v_pk_fma_f32 v[128:129], v[128:129], v[88:89], v[140:141]
    v_cvt_pk_f16_f32 v146, v120, v122
    v_cvt_pk_f16_f32 v150, v128, v130
    v_cvt_pk_f16_f32 v147, v121, v123
    v_cvt_pk_f16_f32 v151, v129, v131
    ds_write_b64 v224, v[146:147] offset:13728
    ds_write_b64 v224, v[150:151] offset:28512
    v_pk_mul_f32 v[140:141], v[130:131], v[90:91]
    v_pk_mul_f32 v[142:143], v[130:131], v[88:89]
    v_pk_fma_f32 v[130:131], v[128:129], v[90:91], v[142:143] neg_lo:[0,1,0] neg_hi:[0,1,0]
    v_pk_fma_f32 v[128:129], v[128:129], v[88:89], v[140:141]
    v_cvt_pk_f16_f32 v148, v128, v130
    v_cvt_pk_f16_f32 v149, v129, v131
    ds_write_b64 v224, v[148:149] offset:29040
    v_pk_mul_f32 v[140:141], v[130:131], v[90:91]
    v_pk_mul_f32 v[142:143], v[130:131], v[88:89]
    v_pk_fma_f32 v[130:131], v[128:129], v[90:91], v[142:143] neg_lo:[0,1,0] neg_hi:[0,1,0]
    v_pk_fma_f32 v[128:129], v[128:129], v[88:89], v[140:141]
    v_cvt_pk_f16_f32 v150, v128, v130
    v_cvt_pk_f16_f32 v151, v129, v131
    ds_write_b64 v224, v[150:151] offset:29568
    v_pk_mul_f32 v[140:141], v[130:131], v[90:91]
    v_pk_mul_f32 v[142:143], v[130:131], v[88:89]
    v_pk_fma_f32 v[130:131], v[128:129], v[90:91], v[142:143] neg_lo:[0,1,0] neg_hi:[0,1,0]
    v_pk_fma_f32 v[128:129], v[128:129], v[88:89], v[140:141]
    v_cvt_pk_f16_f32 v148, v128, v130
    v_cvt_pk_f16_f32 v149, v129, v131
    ds_write_b64 v224, v[148:149] offset:30096
    v_pk_mul_f32 v[140:141], v[130:131], v[90:91]
    v_pk_mul_f32 v[142:143], v[130:131], v[88:89]
    v_pk_fma_f32 v[130:131], v[128:129], v[90:91], v[142:143] neg_lo:[0,1,0] neg_hi:[0,1,0]
    v_pk_fma_f32 v[128:129], v[128:129], v[88:89], v[140:141]
    v_cvt_pk_f16_f32 v150, v128, v130
    v_cvt_pk_f16_f32 v151, v129, v131
    ds_write_b64 v224, v[150:151] offset:30624
    s_waitcnt lgkmcnt(0)
    ds_read_b128 v[64:67], v225 offset:0
    ds_read_b128 v[68:71], v226 offset:0
    ds_read_b128 v[72:75], v225 offset:32
    ds_read_b128 v[76:79], v226 offset:32
    ds_read_b128 v[80:83], v225 offset:64
    ds_read_b128 v[84:87], v226 offset:64
    ds_read_b128 v[88:91], v225 offset:96
    ds_read_b128 v[92:95], v226 offset:96
    ds_read_b128 v[96:99], v225 offset:128
    ds_read_b128 v[100:103], v226 offset:128
    ds_read_b128 v[104:107], v225 offset:160
    ds_read_b128 v[108:111], v226 offset:160
    s_waitcnt lgkmcnt(10)
    v_mfma_f32_32x32x16_f16 v[176:191], v[64:67], v[68:71], 0
    ds_read_b128 v[64:67], v225 offset:192
    ds_read_b128 v[68:71], v226 offset:192
    s_waitcnt lgkmcnt(10)
    v_mfma_f32_32x32x16_f16 v[176:191], v[72:75], v[76:79], v[176:191]
    ds_read_b128 v[72:75], v225 offset:224
    ds_read_b128 v[76:79], v226 offset:224
    s_waitcnt lgkmcnt(10)
    v_mfma_f32_32x32x16_f16 v[176:191], v[80:83], v[84:87], v[176:191]
    ds_read_b128 v[80:83], v225 offset:256
    ds_read_b128 v[84:87], v226 offset:256
    s_waitcnt lgkmcnt(10)
    v_mfma_f32_32x32x16_f16 v[176:191], v[88:91], v[92:95], v[176:191]
    ds_read_b128 v[88:91], v225 offset:288
    ds_read_b128 v[92:95], v226 offset:288
    s_waitcnt lgkmcnt(10)
    v_mfma_f32_32x32x16_f16 v[176:191], v[96:99], v[100:103], v[176:191]
    ds_read_b128 v[96:99], v225 offset:320
    ds_read_b128 v[100:103], v226 offset:320
    s_waitcnt lgkmcnt(10)
    v_mfma_f32_32x32x16_f16 v[176:191], v[104:107], v[108:111], v[176:191]
    ds_read_b128 v[104:107], v225 offset:352
    ds_read_b128 v[108:111], v226 offset:352
    s_waitcnt lgkmcnt(10)
    v_mfma_f32_32x32x16_f16 v[176:191], v[64:67], v[68:71], v[176:191]
    ds_read_b128 v[64:67], v225 offset:384
    ds_read_b128 v[68:71], v226 offset:384
    s_waitcnt lgkmcnt(10)
    v_mfma_f32_32x32x16_f16 v[176:191], v[72:75], v[76:79], v[176:191]
    ds_read_b128 v[72:75], v225 offset:416
    ds_read_b128 v[76:79], v226 offset:416
    s_waitcnt lgkmcnt(10)
    v_mfma_f32_32x32x16_f16 v[176:191], v[80:83], v[84:87], v[176:191]
    ds_read_b128 v[80:83], v225 offset:448
    ds_read_b128 v[84:87], v226 offset:448
    s_waitcnt lgkmcnt(10)
    v_mfma_f32_32x32x16_f16 v[176:191], v[88:91], v[92:95], v[176:191]
    ds_read_b128 v[88:91], v225 offset:480
    ds_read_b128 v[92:95], v226 offset:480
    s_waitcnt lgkmcnt(10)
    v_mfma_f32_32x32x16_f16 v[176:191], v[96:99], v[100:103], v[176:191]
    s_waitcnt lgkmcnt(8)
    v_mfma_f32_32x32x16_f16 v[176:191], v[104:107], v[108:111], v[176:191]
    s_waitcnt lgkmcnt(6)
    v_mfma_f32_32x32x16_f16 v[176:191], v[64:67], v[68:71], v[176:191]
    s_waitcnt lgkmcnt(4)
    v_mfma_f32_32x32x16_f16 v[176:191], v[72:75], v[76:79], v[176:191]
    s_waitcnt lgkmcnt(2)
    v_mfma_f32_32x32x16_f16 v[176:191], v[80:83], v[84:87], v[176:191]
    s_waitcnt lgkmcnt(0)
    v_mfma_f32_32x32x16_f16 v[176:191], v[88:91], v[92:95], v[176:191]
    v_mov_b32 v235, s14
    v_add_u32 v235, 10496, v235
    v_mov_b32 v64, 0
    v_mov_b32 v65, 0
    v_mov_b32 v66, 0
    v_mov_b32 v67, 0
    v_lshrrev_b32 v68, 1, v1
    s_movk_i32 s20, 4160
    v_mul_u32_u24 v68, s20, v68
    v_and_b32 v69, 1, v1
    v_lshl_add_u32 v68, v69, 4, v68
    v_add_u32 v68, s15, v68
    v_cmp_eq_u32 vcc, 0, v69
    v_cmp_eq_u32 s[20:21], 0, v1
    s_nop 1
    v_cndmask_b32 v70, 0, v232, s[20:21]
    v_pk_mul_f32 v[176:177], v[176:177], v[230:231] op_sel:[0,1] op_sel_hi:[1,1]
    v_pk_mul_f32 v[178:179], v[178:179], v[230:231] op_sel:[0,1] op_sel_hi:[1,1]
    v_pk_mul_f32 v[180:181], v[180:181], v[230:231] op_sel:[0,1] op_sel_hi:[1,1]
    v_pk_mul_f32 v[182:183], v[182:183], v[230:231] op_sel:[0,1] op_sel_hi:[1,1]
    v_pk_mul_f32 v[184:185], v[184:185], v[230:231] op_sel:[0,1] op_sel_hi:[1,1]
    v_pk_mul_f32 v[186:187], v[186:187], v[230:231] op_sel:[0,1] op_sel_hi:[1,1]
    v_pk_mul_f32 v[188:189], v[188:189], v[230:231] op_sel:[0,1] op_sel_hi:[1,1]
    v_pk_mul_f32 v[190:191], v[190:191], v[230:231] op_sel:[0,1] op_sel_hi:[1,1]
    v_add_f32 v176, v176, v70
    v_cndmask_b32 v71, v189, v188, vcc
    v_cndmask_b32 v72, v191, v190, vcc
    s_mov_b64 exec, 0xff
    ds_write_b128 v68, v[64:67] offset:4096
    s_mov_b64 exec, -1
    v_cvt_pk_f16_f32 v76, v183, v182
    v_cvt_pk_f16_f32 v77, v181, v180
    v_cvt_pk_f16_f32 v78, v179, v178
    v_cvt_pk_f16_f32 v79, v177, v176
    v_mov_b32 v83, 0
    v_mov_b32 v91, 0
    v_cvt_pk_f16_f32 v80, v181, v180
    v_cvt_pk_f16_f32 v81, v179, v178
    v_cvt_pk_f16_f32 v82, v177, v176
    v_alignbit_b32 v84, v77, v76, 16
    v_alignbit_b32 v85, v78, v77, 16
    v_alignbit_b32 v86, v79, v78, 16
    v_mov_b32_dpp v83, v76 wave_shr:1 row_mask:0xf bank_mask:0xf
    v_mov_b32_dpp v91, v84 wave_shr:1 row_mask:0xf bank_mask:0xf
    ds_write_b128 v227, v[76:79] offset:3072
    v_mov_b32 v88, v85
    v_mov_b32 v89, v86
    v_alignbit_b32 v87, v83, v79, 16
    v_alignbit_b32 v90, v83, v79, 16
    ds_write_b128 v227, v[80:83] offset:11392
    ds_write_b128 v227, v[84:87] offset:7232
    ds_write_b128 v227, v[88:91] offset:15552
    v_cvt_pk_f16_f32 v96, v186, v186
    v_cvt_pk_f16_f32 v97, v185, v185
    v_cvt_pk_f16_f32 v98, v185, v184
    v_cvt_pk_f16_f32 v99, v184, v184
    v_mov_b32_dpp v103, v76 wave_ror:1 row_mask:0xf bank_mask:0xf
    v_mov_b32_dpp v111, v84 wave_ror:1 row_mask:0xf bank_mask:0xf
    v_cvt_pk_f16_f32 v100, v185, v185
    v_cvt_pk_f16_f32 v101, v185, v184
    v_cvt_pk_f16_f32 v102, v184, v184
    v_alignbit_b32 v104, v97, v96, 16
    v_alignbit_b32 v105, v98, v97, 16
    v_alignbit_b32 v106, v99, v98, 16
    v_mov_b32_dpp v103, v96 wave_shr:1 row_mask:0xf bank_mask:0xf
    v_mov_b32_dpp v111, v104 wave_shr:1 row_mask:0xf bank_mask:0xf
    ds_write_b128 v227, v[96:99] offset:2048
    v_mov_b32 v108, v105
    v_mov_b32 v109, v106
    v_alignbit_b32 v107, v103, v99, 16
    v_alignbit_b32 v110, v103, v99, 16
    ds_write_b128 v227, v[100:103] offset:10368
    ds_write_b128 v227, v[104:107] offset:6208
    ds_write_b128 v227, v[108:111] offset:14528
    v_cvt_pk_f16_f32 v116, v189, v189
    v_cvt_pk_f16_f32 v117, v189, v71
    v_cvt_pk_f16_f32 v118, v188, v188
    v_cvt_pk_f16_f32 v119, v188, v188
    v_mov_b32_dpp v123, v96 wave_ror:1 row_mask:0xf bank_mask:0xf
    v_mov_b32_dpp v131, v104 wave_ror:1 row_mask:0xf bank_mask:0xf
    v_cvt_pk_f16_f32 v120, v189, v71
    v_cvt_pk_f16_f32 v121, v188, v188
    v_cvt_pk_f16_f32 v122, v188, v188
    v_alignbit_b32 v124, v117, v116, 16
    v_alignbit_b32 v125, v118, v117, 16
    v_alignbit_b32 v126, v119, v118, 16
    v_mov_b32_dpp v123, v116 wave_shr:1 row_mask:0xf bank_mask:0xf
    v_mov_b32_dpp v131, v124 wave_shr:1 row_mask:0xf bank_mask:0xf
    ds_write_b128 v227, v[116:119] offset:1024
    v_mov_b32 v128, v125
    v_mov_b32 v129, v126
    v_alignbit_b32 v127, v123, v119, 16
    v_alignbit_b32 v130, v123, v119, 16
    ds_write_b128 v227, v[120:123] offset:9344
    ds_write_b128 v227, v[124:127] offset:5184
    ds_write_b128 v227, v[128:131] offset:13504
    v_cvt_pk_f16_f32 v136, v191, v191
    v_cvt_pk_f16_f32 v137, v191, v72
    v_cvt_pk_f16_f32 v138, v190, v190
    v_cvt_pk_f16_f32 v139, v190, v190
    v_mov_b32_dpp v143, v116 wave_ror:1 row_mask:0xf bank_mask:0xf
    v_mov_b32_dpp v151, v124 wave_ror:1 row_mask:0xf bank_mask:0xf
    v_cvt_pk_f16_f32 v140, v191, v72
    v_cvt_pk_f16_f32 v141, v190, v190
    v_cvt_pk_f16_f32 v142, v190, v190
    v_alignbit_b32 v144, v137, v136, 16
    v_alignbit_b32 v145, v138, v137, 16
    v_alignbit_b32 v146, v139, v138, 16
    v_mov_b32_dpp v143, v136 wave_shr:1 row_mask:0xf bank_mask:0xf
    v_mov_b32_dpp v151, v144 wave_shr:1 row_mask:0xf bank_mask:0xf
    ds_write_b128 v227, v[136:139] offset:0
    v_mov_b32 v148, v145
    v_mov_b32 v149, v146
    v_alignbit_b32 v147, v143, v139, 16
    v_alignbit_b32 v150, v143, v139, 16
    ds_write_b128 v227, v[140:143] offset:8320
    ds_write_b128 v227, v[144:147] offset:4160
    ds_write_b128 v227, v[148:151] offset:12480
    s_waitcnt lgkmcnt(0)
    ds_read_b64 v[64:65], v228 offset:4032
    ds_read_b64 v[66:67], v228 offset:4040
    ds_read_b64 v[68:69], v228 offset:3520
    ds_read_b64 v[70:71], v228 offset:3528
    ds_read_b64 v[72:73], v228 offset:3008
    ds_read_b64 v[74:75], v228 offset:3016
    ds_read_b64 v[76:77], v228 offset:2496
    ds_read_b64 v[78:79], v228 offset:2504
    ds_read_b64 v[80:81], v228 offset:1984
    ds_read_b64 v[82:83], v228 offset:1992
    ds_read_b64 v[84:85], v228 offset:1472
    ds_read_b64 v[86:87], v228 offset:1480
    ds_read_b64 v[88:89], v228 offset:960
    ds_read_b64 v[90:91], v228 offset:968
    ds_read_b64 v[92:93], v228 offset:448
    ds_read_b64 v[94:95], v228 offset:456
    s_waitcnt lgkmcnt(0)
    s_barrier
    ds_read_b128 v[96:99], v229 offset:480
    ds_read_b128 v[100:103], v229 offset:992
    ds_read_b128 v[104:107], v229 offset:1504
    ds_read_b128 v[108:111], v229 offset:2016
    ds_read_b128 v[112:115], v229 offset:2528
    ds_read_b128 v[116:119], v229 offset:3040
    ds_read_b128 v[120:123], v229 offset:3552
    ds_read_b128 v[124:127], v229 offset:4064
    global_load_ushort v234, v235, s[68:69]
    v_add_u32 v52, 8192, v7
    v_add_u32 v53, 8192, v13
    v_add_u32 v54, 3456, v52
    v_add_u32 v55, 3456, v53
    global_load_dwordx4 v[20:23], v54, s[68:69]
    global_load_ushort v24, v55, s[68:69]
    v_add_u32 v54, 4608, v52
    v_add_u32 v55, 4608, v53
    global_load_dwordx4 v[14:17], v54, s[68:69]
    global_load_ushort v18, v55, s[68:69]
    v_add_u32 v54, 5760, v52
    v_add_u32 v55, 5760, v53
    global_load_dwordx4 v[26:29], v54, s[68:69]
    global_load_ushort v30, v55, s[68:69]
    s_waitcnt lgkmcnt(0)
    v_mfma_f32_16x16x32_f16 v[192:195], v[64:67], v[96:99], 0
    ds_read_b64 v[128:129], v228 offset:3968
    v_mfma_f32_16x16x32_f16 v[196:199], v[64:67], v[100:103], 0
    ds_read_b64 v[130:131], v228 offset:3976
    v_mfma_f32_16x16x32_f16 v[200:203], v[64:67], v[104:107], 0
    ds_read_b128 v[160:163], v229 offset:416
    v_mfma_f32_16x16x32_f16 v[204:207], v[64:67], v[108:111], 0
    ds_read_b128 v[164:167], v229 offset:928
    v_mfma_f32_16x16x32_f16 v[208:211], v[64:67], v[112:115], 0
    ds_read_b128 v[168:171], v229 offset:1440
    v_mfma_f32_16x16x32_f16 v[212:215], v[64:67], v[116:119], 0
    ds_read_b128 v[172:175], v229 offset:1952
    v_mfma_f32_16x16x32_f16 v[216:219], v[64:67], v[120:123], 0
    ds_read_b128 v[176:179], v229 offset:2464
    v_mfma_f32_16x16x32_f16 v[220:223], v[64:67], v[124:127], 0
    ds_read_b128 v[180:183], v229 offset:2976
    v_mfma_f32_16x16x32_f16 v[196:199], v[68:71], v[96:99], v[196:199]
    ds_read_b128 v[184:187], v229 offset:3488
    v_mfma_f32_16x16x32_f16 v[200:203], v[68:71], v[100:103], v[200:203]
    ds_read_b128 v[188:191], v229 offset:4000
    v_mfma_f32_16x16x32_f16 v[204:207], v[68:71], v[104:107], v[204:207]
    ds_read_b64 v[132:133], v228 offset:3456
    v_mfma_f32_16x16x32_f16 v[208:211], v[68:71], v[108:111], v[208:211]
    ds_read_b64 v[134:135], v228 offset:3464
    v_mfma_f32_16x16x32_f16 v[212:215], v[68:71], v[112:115], v[212:215]
    ds_read_b64 v[136:137], v228 offset:2944
    v_mfma_f32_16x16x32_f16 v[216:219], v[68:71], v[116:119], v[216:219]
    ds_read_b64 v[138:139], v228 offset:2952
    v_mfma_f32_16x16x32_f16 v[220:223], v[68:71], v[120:123], v[220:223]
    ds_read_b64 v[140:141], v228 offset:2432
    v_mfma_f32_16x16x32_f16 v[200:203], v[72:75], v[96:99], v[200:203]
    ds_read_b64 v[142:143], v228 offset:2440
    v_mfma_f32_16x16x32_f16 v[204:207], v[72:75], v[100:103], v[204:207]
    ds_read_b64 v[144:145], v228 offset:1920
    v_mfma_f32_16x16x32_f16 v[208:211], v[72:75], v[104:107], v[208:211]
    ds_read_b64 v[146:147], v228 offset:1928
    v_mfma_f32_16x16x32_f16 v[212:215], v[72:75], v[108:111], v[212:215]
    ds_read_b64 v[148:149], v228 offset:1408
    v_mfma_f32_16x16x32_f16 v[216:219], v[72:75], v[112:115], v[216:219]
    ds_read_b64 v[150:151], v228 offset:1416
    v_mfma_f32_16x16x32_f16 v[220:223], v[72:75], v[116:119], v[220:223]
    ds_read_b64 v[152:153], v228 offset:896
    v_mfma_f32_16x16x32_f16 v[204:207], v[76:79], v[96:99], v[204:207]
    ds_read_b64 v[154:155], v228 offset:904
    v_mfma_f32_16x16x32_f16 v[208:211], v[76:79], v[100:103], v[208:211]
    ds_read_b64 v[156:157], v228 offset:384
    v_mfma_f32_16x16x32_f16 v[212:215], v[76:79], v[104:107], v[212:215]
    ds_read_b64 v[158:159], v228 offset:392
    v_mfma_f32_16x16x32_f16 v[216:219], v[76:79], v[108:111], v[216:219]
    v_mfma_f32_16x16x32_f16 v[220:223], v[76:79], v[112:115], v[220:223]
    v_mfma_f32_16x16x32_f16 v[208:211], v[80:83], v[96:99], v[208:211]
    v_mfma_f32_16x16x32_f16 v[212:215], v[80:83], v[100:103], v[212:215]
    v_mfma_f32_16x16x32_f16 v[216:219], v[80:83], v[104:107], v[216:219]
    v_mfma_f32_16x16x32_f16 v[220:223], v[80:83], v[108:111], v[220:223]
    v_mfma_f32_16x16x32_f16 v[212:215], v[84:87], v[96:99], v[212:215]
    v_mfma_f32_16x16x32_f16 v[216:219], v[84:87], v[100:103], v[216:219]
    v_mfma_f32_16x16x32_f16 v[220:223], v[84:87], v[104:107], v[220:223]
    v_mfma_f32_16x16x32_f16 v[216:219], v[88:91], v[96:99], v[216:219]
    v_mfma_f32_16x16x32_f16 v[220:223], v[88:91], v[100:103], v[220:223]
    v_mfma_f32_16x16x32_f16 v[220:223], v[92:95], v[96:99], v[220:223]
    s_waitcnt lgkmcnt(0)
    v_mfma_f32_16x16x32_f16 v[192:195], v[128:131], v[160:163], v[192:195]
    ds_read_b64 v[64:65], v228 offset:3904
    v_mfma_f32_16x16x32_f16 v[196:199], v[128:131], v[164:167], v[196:199]
    ds_read_b64 v[66:67], v228 offset:3912
    v_mfma_f32_16x16x32_f16 v[200:203], v[128:131], v[168:171], v[200:203]
    ds_read_b128 v[96:99], v229 offset:352
    v_mfma_f32_16x16x32_f16 v[204:207], v[128:131], v[172:175], v[204:207]
    ds_read_b128 v[100:103], v229 offset:864
    v_mfma_f32_16x16x32_f16 v[208:211], v[128:131], v[176:179], v[208:211]
    ds_read_b128 v[104:107], v229 offset:1376
    v_mfma_f32_16x16x32_f16 v[212:215], v[128:131], v[180:183], v[212:215]
    ds_read_b128 v[108:111], v229 offset:1888
    v_mfma_f32_16x16x32_f16 v[216:219], v[128:131], v[184:187], v[216:219]
    ds_read_b128 v[112:115], v229 offset:2400
    v_mfma_f32_16x16x32_f16 v[220:223], v[128:131], v[188:191], v[220:223]
    ds_read_b128 v[116:119], v229 offset:2912
    v_mfma_f32_16x16x32_f16 v[196:199], v[132:135], v[160:163], v[196:199]
    ds_read_b128 v[120:123], v229 offset:3424
    v_mfma_f32_16x16x32_f16 v[200:203], v[132:135], v[164:167], v[200:203]
    ds_read_b128 v[124:127], v229 offset:3936
    v_mfma_f32_16x16x32_f16 v[204:207], v[132:135], v[168:171], v[204:207]
    ds_read_b64 v[68:69], v228 offset:3392
    v_mfma_f32_16x16x32_f16 v[208:211], v[132:135], v[172:175], v[208:211]
    ds_read_b64 v[70:71], v228 offset:3400
    v_mfma_f32_16x16x32_f16 v[212:215], v[132:135], v[176:179], v[212:215]
    ds_read_b64 v[72:73], v228 offset:2880
    v_mfma_f32_16x16x32_f16 v[216:219], v[132:135], v[180:183], v[216:219]
    ds_read_b64 v[74:75], v228 offset:2888
    v_mfma_f32_16x16x32_f16 v[220:223], v[132:135], v[184:187], v[220:223]
    ds_read_b64 v[76:77], v228 offset:2368
    v_mfma_f32_16x16x32_f16 v[200:203], v[136:139], v[160:163], v[200:203]
    ds_read_b64 v[78:79], v228 offset:2376
    v_mfma_f32_16x16x32_f16 v[204:207], v[136:139], v[164:167], v[204:207]
    ds_read_b64 v[80:81], v228 offset:1856
    v_mfma_f32_16x16x32_f16 v[208:211], v[136:139], v[168:171], v[208:211]
    ds_read_b64 v[82:83], v228 offset:1864
    v_mfma_f32_16x16x32_f16 v[212:215], v[136:139], v[172:175], v[212:215]
    ds_read_b64 v[84:85], v228 offset:1344
    v_mfma_f32_16x16x32_f16 v[216:219], v[136:139], v[176:179], v[216:219]
    ds_read_b64 v[86:87], v228 offset:1352
    v_mfma_f32_16x16x32_f16 v[220:223], v[136:139], v[180:183], v[220:223]
    ds_read_b64 v[88:89], v228 offset:832
    v_mfma_f32_16x16x32_f16 v[204:207], v[140:143], v[160:163], v[204:207]
    ds_read_b64 v[90:91], v228 offset:840
    v_mfma_f32_16x16x32_f16 v[208:211], v[140:143], v[164:167], v[208:211]
    ds_read_b64 v[92:93], v228 offset:320
    v_mfma_f32_16x16x32_f16 v[212:215], v[140:143], v[168:171], v[212:215]
    ds_read_b64 v[94:95], v228 offset:328
    v_mfma_f32_16x16x32_f16 v[216:219], v[140:143], v[172:175], v[216:219]
    v_mfma_f32_16x16x32_f16 v[220:223], v[140:143], v[176:179], v[220:223]
    v_mfma_f32_16x16x32_f16 v[208:211], v[144:147], v[160:163], v[208:211]
    v_mfma_f32_16x16x32_f16 v[212:215], v[144:147], v[164:167], v[212:215]
    v_mfma_f32_16x16x32_f16 v[216:219], v[144:147], v[168:171], v[216:219]
    v_mfma_f32_16x16x32_f16 v[220:223], v[144:147], v[172:175], v[220:223]
    v_mfma_f32_16x16x32_f16 v[212:215], v[148:151], v[160:163], v[212:215]
    v_mfma_f32_16x16x32_f16 v[216:219], v[148:151], v[164:167], v[216:219]
    v_mfma_f32_16x16x32_f16 v[220:223], v[148:151], v[168:171], v[220:223]
    v_mfma_f32_16x16x32_f16 v[216:219], v[152:155], v[160:163], v[216:219]
    v_mfma_f32_16x16x32_f16 v[220:223], v[152:155], v[164:167], v[220:223]
    v_mfma_f32_16x16x32_f16 v[220:223], v[156:159], v[160:163], v[220:223]
    s_waitcnt lgkmcnt(0)
    v_mfma_f32_16x16x32_f16 v[192:195], v[64:67], v[96:99], v[192:195]
    ds_read_b64 v[128:129], v228 offset:3840
    v_mfma_f32_16x16x32_f16 v[196:199], v[64:67], v[100:103], v[196:199]
    ds_read_b64 v[130:131], v228 offset:3848
    v_mfma_f32_16x16x32_f16 v[200:203], v[64:67], v[104:107], v[200:203]
    ds_read_b128 v[160:163], v229 offset:288
    v_mfma_f32_16x16x32_f16 v[204:207], v[64:67], v[108:111], v[204:207]
    ds_read_b128 v[164:167], v229 offset:800
    v_mfma_f32_16x16x32_f16 v[208:211], v[64:67], v[112:115], v[208:211]
    ds_read_b128 v[168:171], v229 offset:1312
    v_mfma_f32_16x16x32_f16 v[212:215], v[64:67], v[116:119], v[212:215]
    ds_read_b128 v[172:175], v229 offset:1824
    v_mfma_f32_16x16x32_f16 v[216:219], v[64:67], v[120:123], v[216:219]
    ds_read_b128 v[176:179], v229 offset:2336
    v_mfma_f32_16x16x32_f16 v[220:223], v[64:67], v[124:127], v[220:223]
    ds_read_b128 v[180:183], v229 offset:2848
    v_mfma_f32_16x16x32_f16 v[196:199], v[68:71], v[96:99], v[196:199]
    ds_read_b128 v[184:187], v229 offset:3360
    v_mfma_f32_16x16x32_f16 v[200:203], v[68:71], v[100:103], v[200:203]
    ds_read_b128 v[188:191], v229 offset:3872
    v_mfma_f32_16x16x32_f16 v[204:207], v[68:71], v[104:107], v[204:207]
    ds_read_b64 v[132:133], v228 offset:3328
    v_mfma_f32_16x16x32_f16 v[208:211], v[68:71], v[108:111], v[208:211]
    ds_read_b64 v[134:135], v228 offset:3336
    v_mfma_f32_16x16x32_f16 v[212:215], v[68:71], v[112:115], v[212:215]
    ds_read_b64 v[136:137], v228 offset:2816
    v_mfma_f32_16x16x32_f16 v[216:219], v[68:71], v[116:119], v[216:219]
    ds_read_b64 v[138:139], v228 offset:2824
    v_mfma_f32_16x16x32_f16 v[220:223], v[68:71], v[120:123], v[220:223]
    ds_read_b64 v[140:141], v228 offset:2304
    v_mfma_f32_16x16x32_f16 v[200:203], v[72:75], v[96:99], v[200:203]
    ds_read_b64 v[142:143], v228 offset:2312
    v_mfma_f32_16x16x32_f16 v[204:207], v[72:75], v[100:103], v[204:207]
    ds_read_b64 v[144:145], v228 offset:1792
    v_mfma_f32_16x16x32_f16 v[208:211], v[72:75], v[104:107], v[208:211]
    ds_read_b64 v[146:147], v228 offset:1800
    v_mfma_f32_16x16x32_f16 v[212:215], v[72:75], v[108:111], v[212:215]
    ds_read_b64 v[148:149], v228 offset:1280
    v_mfma_f32_16x16x32_f16 v[216:219], v[72:75], v[112:115], v[216:219]
    ds_read_b64 v[150:151], v228 offset:1288
    v_mfma_f32_16x16x32_f16 v[220:223], v[72:75], v[116:119], v[220:223]
    ds_read_b64 v[152:153], v228 offset:768
    v_mfma_f32_16x16x32_f16 v[204:207], v[76:79], v[96:99], v[204:207]
    ds_read_b64 v[154:155], v228 offset:776
    v_mfma_f32_16x16x32_f16 v[208:211], v[76:79], v[100:103], v[208:211]
    ds_read_b64 v[156:157], v228 offset:256
    v_mfma_f32_16x16x32_f16 v[212:215], v[76:79], v[104:107], v[212:215]
    ds_read_b64 v[158:159], v228 offset:264
    v_mfma_f32_16x16x32_f16 v[216:219], v[76:79], v[108:111], v[216:219]
    v_mfma_f32_16x16x32_f16 v[220:223], v[76:79], v[112:115], v[220:223]
    v_mfma_f32_16x16x32_f16 v[208:211], v[80:83], v[96:99], v[208:211]
    v_mfma_f32_16x16x32_f16 v[212:215], v[80:83], v[100:103], v[212:215]
    v_mfma_f32_16x16x32_f16 v[216:219], v[80:83], v[104:107], v[216:219]
    v_mfma_f32_16x16x32_f16 v[220:223], v[80:83], v[108:111], v[220:223]
    v_mfma_f32_16x16x32_f16 v[212:215], v[84:87], v[96:99], v[212:215]
    v_mfma_f32_16x16x32_f16 v[216:219], v[84:87], v[100:103], v[216:219]
    v_mfma_f32_16x16x32_f16 v[220:223], v[84:87], v[104:107], v[220:223]
    v_mfma_f32_16x16x32_f16 v[216:219], v[88:91], v[96:99], v[216:219]
    v_mfma_f32_16x16x32_f16 v[220:223], v[88:91], v[100:103], v[220:223]
    v_mfma_f32_16x16x32_f16 v[220:223], v[92:95], v[96:99], v[220:223]
    s_waitcnt lgkmcnt(0)
    v_mfma_f32_16x16x32_f16 v[192:195], v[128:131], v[160:163], v[192:195]
    ds_read_b64 v[64:65], v228 offset:3776
    v_mfma_f32_16x16x32_f16 v[196:199], v[128:131], v[164:167], v[196:199]
    ds_read_b64 v[66:67], v228 offset:3784
    v_mfma_f32_16x16x32_f16 v[200:203], v[128:131], v[168:171], v[200:203]
    ds_read_b128 v[96:99], v229 offset:224
    v_mfma_f32_16x16x32_f16 v[204:207], v[128:131], v[172:175], v[204:207]
    ds_read_b128 v[100:103], v229 offset:736
    v_mfma_f32_16x16x32_f16 v[208:211], v[128:131], v[176:179], v[208:211]
    ds_read_b128 v[104:107], v229 offset:1248
    v_mfma_f32_16x16x32_f16 v[212:215], v[128:131], v[180:183], v[212:215]
    ds_read_b128 v[108:111], v229 offset:1760
    v_mfma_f32_16x16x32_f16 v[216:219], v[128:131], v[184:187], v[216:219]
    ds_read_b128 v[112:115], v229 offset:2272
    v_mfma_f32_16x16x32_f16 v[220:223], v[128:131], v[188:191], v[220:223]
    ds_read_b128 v[116:119], v229 offset:2784
    v_mfma_f32_16x16x32_f16 v[196:199], v[132:135], v[160:163], v[196:199]
    ds_read_b128 v[120:123], v229 offset:3296
    v_mfma_f32_16x16x32_f16 v[200:203], v[132:135], v[164:167], v[200:203]
    ds_read_b128 v[124:127], v229 offset:3808
    v_mfma_f32_16x16x32_f16 v[204:207], v[132:135], v[168:171], v[204:207]
    ds_read_b64 v[68:69], v228 offset:3264
    v_mfma_f32_16x16x32_f16 v[208:211], v[132:135], v[172:175], v[208:211]
    ds_read_b64 v[70:71], v228 offset:3272
    v_mfma_f32_16x16x32_f16 v[212:215], v[132:135], v[176:179], v[212:215]
    ds_read_b64 v[72:73], v228 offset:2752
    v_mfma_f32_16x16x32_f16 v[216:219], v[132:135], v[180:183], v[216:219]
    ds_read_b64 v[74:75], v228 offset:2760
    v_mfma_f32_16x16x32_f16 v[220:223], v[132:135], v[184:187], v[220:223]
    ds_read_b64 v[76:77], v228 offset:2240
    v_mfma_f32_16x16x32_f16 v[200:203], v[136:139], v[160:163], v[200:203]
    ds_read_b64 v[78:79], v228 offset:2248
    v_mfma_f32_16x16x32_f16 v[204:207], v[136:139], v[164:167], v[204:207]
    ds_read_b64 v[80:81], v228 offset:1728
    v_mfma_f32_16x16x32_f16 v[208:211], v[136:139], v[168:171], v[208:211]
    ds_read_b64 v[82:83], v228 offset:1736
    v_mfma_f32_16x16x32_f16 v[212:215], v[136:139], v[172:175], v[212:215]
    ds_read_b64 v[84:85], v228 offset:1216
    v_mfma_f32_16x16x32_f16 v[216:219], v[136:139], v[176:179], v[216:219]
    ds_read_b64 v[86:87], v228 offset:1224
    v_mfma_f32_16x16x32_f16 v[220:223], v[136:139], v[180:183], v[220:223]
    ds_read_b64 v[88:89], v228 offset:704
    v_mfma_f32_16x16x32_f16 v[204:207], v[140:143], v[160:163], v[204:207]
    ds_read_b64 v[90:91], v228 offset:712
    v_mfma_f32_16x16x32_f16 v[208:211], v[140:143], v[164:167], v[208:211]
    ds_read_b64 v[92:93], v228 offset:192
    v_mfma_f32_16x16x32_f16 v[212:215], v[140:143], v[168:171], v[212:215]
    ds_read_b64 v[94:95], v228 offset:200
    v_mfma_f32_16x16x32_f16 v[216:219], v[140:143], v[172:175], v[216:219]
    v_mfma_f32_16x16x32_f16 v[220:223], v[140:143], v[176:179], v[220:223]
    v_mfma_f32_16x16x32_f16 v[208:211], v[144:147], v[160:163], v[208:211]
    v_mfma_f32_16x16x32_f16 v[212:215], v[144:147], v[164:167], v[212:215]
    v_mfma_f32_16x16x32_f16 v[216:219], v[144:147], v[168:171], v[216:219]
    v_mfma_f32_16x16x32_f16 v[220:223], v[144:147], v[172:175], v[220:223]
    v_mfma_f32_16x16x32_f16 v[212:215], v[148:151], v[160:163], v[212:215]
    v_mfma_f32_16x16x32_f16 v[216:219], v[148:151], v[164:167], v[216:219]
    v_mfma_f32_16x16x32_f16 v[220:223], v[148:151], v[168:171], v[220:223]
    v_mfma_f32_16x16x32_f16 v[216:219], v[152:155], v[160:163], v[216:219]
    v_mfma_f32_16x16x32_f16 v[220:223], v[152:155], v[164:167], v[220:223]
    v_mfma_f32_16x16x32_f16 v[220:223], v[156:159], v[160:163], v[220:223]
    s_waitcnt lgkmcnt(0)
    v_mfma_f32_16x16x32_f16 v[192:195], v[64:67], v[96:99], v[192:195]
    ds_read_b64 v[128:129], v228 offset:3712
    v_mfma_f32_16x16x32_f16 v[196:199], v[64:67], v[100:103], v[196:199]
    ds_read_b64 v[130:131], v228 offset:3720
    v_mfma_f32_16x16x32_f16 v[200:203], v[64:67], v[104:107], v[200:203]
    ds_read_b128 v[160:163], v229 offset:160
    v_mfma_f32_16x16x32_f16 v[204:207], v[64:67], v[108:111], v[204:207]
    ds_read_b128 v[164:167], v229 offset:672
    v_mfma_f32_16x16x32_f16 v[208:211], v[64:67], v[112:115], v[208:211]
    ds_read_b128 v[168:171], v229 offset:1184
    v_mfma_f32_16x16x32_f16 v[212:215], v[64:67], v[116:119], v[212:215]
    ds_read_b128 v[172:175], v229 offset:1696
    v_mfma_f32_16x16x32_f16 v[216:219], v[64:67], v[120:123], v[216:219]
    ds_read_b128 v[176:179], v229 offset:2208
    v_mfma_f32_16x16x32_f16 v[220:223], v[64:67], v[124:127], v[220:223]
    ds_read_b128 v[180:183], v229 offset:2720
    v_mfma_f32_16x16x32_f16 v[196:199], v[68:71], v[96:99], v[196:199]
    ds_read_b128 v[184:187], v229 offset:3232
    v_mfma_f32_16x16x32_f16 v[200:203], v[68:71], v[100:103], v[200:203]
    ds_read_b128 v[188:191], v229 offset:3744
    v_mfma_f32_16x16x32_f16 v[204:207], v[68:71], v[104:107], v[204:207]
    ds_read_b64 v[132:133], v228 offset:3200
    v_mfma_f32_16x16x32_f16 v[208:211], v[68:71], v[108:111], v[208:211]
    ds_read_b64 v[134:135], v228 offset:3208
    v_mfma_f32_16x16x32_f16 v[212:215], v[68:71], v[112:115], v[212:215]
    ds_read_b64 v[136:137], v228 offset:2688
    v_mfma_f32_16x16x32_f16 v[216:219], v[68:71], v[116:119], v[216:219]
    ds_read_b64 v[138:139], v228 offset:2696
    v_mfma_f32_16x16x32_f16 v[220:223], v[68:71], v[120:123], v[220:223]
    ds_read_b64 v[140:141], v228 offset:2176
    v_mfma_f32_16x16x32_f16 v[200:203], v[72:75], v[96:99], v[200:203]
    ds_read_b64 v[142:143], v228 offset:2184
    v_mfma_f32_16x16x32_f16 v[204:207], v[72:75], v[100:103], v[204:207]
    ds_read_b64 v[144:145], v228 offset:1664
    v_mfma_f32_16x16x32_f16 v[208:211], v[72:75], v[104:107], v[208:211]
    ds_read_b64 v[146:147], v228 offset:1672
    v_mfma_f32_16x16x32_f16 v[212:215], v[72:75], v[108:111], v[212:215]
    ds_read_b64 v[148:149], v228 offset:1152
    v_mfma_f32_16x16x32_f16 v[216:219], v[72:75], v[112:115], v[216:219]
    ds_read_b64 v[150:151], v228 offset:1160
    v_mfma_f32_16x16x32_f16 v[220:223], v[72:75], v[116:119], v[220:223]
    ds_read_b64 v[152:153], v228 offset:640
    v_mfma_f32_16x16x32_f16 v[204:207], v[76:79], v[96:99], v[204:207]
    ds_read_b64 v[154:155], v228 offset:648
    v_mfma_f32_16x16x32_f16 v[208:211], v[76:79], v[100:103], v[208:211]
    ds_read_b64 v[156:157], v228 offset:128
    v_mfma_f32_16x16x32_f16 v[212:215], v[76:79], v[104:107], v[212:215]
    ds_read_b64 v[158:159], v228 offset:136
    v_mfma_f32_16x16x32_f16 v[216:219], v[76:79], v[108:111], v[216:219]
    v_mfma_f32_16x16x32_f16 v[220:223], v[76:79], v[112:115], v[220:223]
    v_mfma_f32_16x16x32_f16 v[208:211], v[80:83], v[96:99], v[208:211]
    v_mfma_f32_16x16x32_f16 v[212:215], v[80:83], v[100:103], v[212:215]
    v_mfma_f32_16x16x32_f16 v[216:219], v[80:83], v[104:107], v[216:219]
    v_mfma_f32_16x16x32_f16 v[220:223], v[80:83], v[108:111], v[220:223]
    v_mfma_f32_16x16x32_f16 v[212:215], v[84:87], v[96:99], v[212:215]
    v_mfma_f32_16x16x32_f16 v[216:219], v[84:87], v[100:103], v[216:219]
    v_mfma_f32_16x16x32_f16 v[220:223], v[84:87], v[104:107], v[220:223]
    v_mfma_f32_16x16x32_f16 v[216:219], v[88:91], v[96:99], v[216:219]
    v_mfma_f32_16x16x32_f16 v[220:223], v[88:91], v[100:103], v[220:223]
    v_mfma_f32_16x16x32_f16 v[220:223], v[92:95], v[96:99], v[220:223]
    s_waitcnt lgkmcnt(0)
    v_mfma_f32_16x16x32_f16 v[192:195], v[128:131], v[160:163], v[192:195]
    ds_read_b64 v[64:65], v228 offset:3648
    v_mfma_f32_16x16x32_f16 v[196:199], v[128:131], v[164:167], v[196:199]
    ds_read_b64 v[66:67], v228 offset:3656
    v_mfma_f32_16x16x32_f16 v[200:203], v[128:131], v[168:171], v[200:203]
    ds_read_b128 v[96:99], v229 offset:96
    v_mfma_f32_16x16x32_f16 v[204:207], v[128:131], v[172:175], v[204:207]
    ds_read_b128 v[100:103], v229 offset:608
    v_mfma_f32_16x16x32_f16 v[208:211], v[128:131], v[176:179], v[208:211]
    ds_read_b128 v[104:107], v229 offset:1120
    v_mfma_f32_16x16x32_f16 v[212:215], v[128:131], v[180:183], v[212:215]
    ds_read_b128 v[108:111], v229 offset:1632
    v_mfma_f32_16x16x32_f16 v[216:219], v[128:131], v[184:187], v[216:219]
    ds_read_b128 v[112:115], v229 offset:2144
    v_mfma_f32_16x16x32_f16 v[220:223], v[128:131], v[188:191], v[220:223]
    ds_read_b128 v[116:119], v229 offset:2656
    v_mfma_f32_16x16x32_f16 v[196:199], v[132:135], v[160:163], v[196:199]
    ds_read_b128 v[120:123], v229 offset:3168
    v_mfma_f32_16x16x32_f16 v[200:203], v[132:135], v[164:167], v[200:203]
    ds_read_b128 v[124:127], v229 offset:3680
    v_mfma_f32_16x16x32_f16 v[204:207], v[132:135], v[168:171], v[204:207]
    ds_read_b64 v[68:69], v228 offset:3136
    v_mfma_f32_16x16x32_f16 v[208:211], v[132:135], v[172:175], v[208:211]
    ds_read_b64 v[70:71], v228 offset:3144
    v_mfma_f32_16x16x32_f16 v[212:215], v[132:135], v[176:179], v[212:215]
    ds_read_b64 v[72:73], v228 offset:2624
    v_mfma_f32_16x16x32_f16 v[216:219], v[132:135], v[180:183], v[216:219]
    ds_read_b64 v[74:75], v228 offset:2632
    v_mfma_f32_16x16x32_f16 v[220:223], v[132:135], v[184:187], v[220:223]
    ds_read_b64 v[76:77], v228 offset:2112
    v_mfma_f32_16x16x32_f16 v[200:203], v[136:139], v[160:163], v[200:203]
    ds_read_b64 v[78:79], v228 offset:2120
    v_mfma_f32_16x16x32_f16 v[204:207], v[136:139], v[164:167], v[204:207]
    ds_read_b64 v[80:81], v228 offset:1600
    v_mfma_f32_16x16x32_f16 v[208:211], v[136:139], v[168:171], v[208:211]
    ds_read_b64 v[82:83], v228 offset:1608
    v_mfma_f32_16x16x32_f16 v[212:215], v[136:139], v[172:175], v[212:215]
    ds_read_b64 v[84:85], v228 offset:1088
    v_mfma_f32_16x16x32_f16 v[216:219], v[136:139], v[176:179], v[216:219]
    ds_read_b64 v[86:87], v228 offset:1096
    v_mfma_f32_16x16x32_f16 v[220:223], v[136:139], v[180:183], v[220:223]
    ds_read_b64 v[88:89], v228 offset:576
    v_mfma_f32_16x16x32_f16 v[204:207], v[140:143], v[160:163], v[204:207]
    ds_read_b64 v[90:91], v228 offset:584
    v_mfma_f32_16x16x32_f16 v[208:211], v[140:143], v[164:167], v[208:211]
    ds_read_b64 v[92:93], v228 offset:64
    v_mfma_f32_16x16x32_f16 v[212:215], v[140:143], v[168:171], v[212:215]
    ds_read_b64 v[94:95], v228 offset:72
    v_mfma_f32_16x16x32_f16 v[216:219], v[140:143], v[172:175], v[216:219]
    v_mfma_f32_16x16x32_f16 v[220:223], v[140:143], v[176:179], v[220:223]
    v_mfma_f32_16x16x32_f16 v[208:211], v[144:147], v[160:163], v[208:211]
    v_mfma_f32_16x16x32_f16 v[212:215], v[144:147], v[164:167], v[212:215]
    v_mfma_f32_16x16x32_f16 v[216:219], v[144:147], v[168:171], v[216:219]
    v_mfma_f32_16x16x32_f16 v[220:223], v[144:147], v[172:175], v[220:223]
    v_mfma_f32_16x16x32_f16 v[212:215], v[148:151], v[160:163], v[212:215]
    v_mfma_f32_16x16x32_f16 v[216:219], v[148:151], v[164:167], v[216:219]
    v_mfma_f32_16x16x32_f16 v[220:223], v[148:151], v[168:171], v[220:223]
    v_mfma_f32_16x16x32_f16 v[216:219], v[152:155], v[160:163], v[216:219]
    v_mfma_f32_16x16x32_f16 v[220:223], v[152:155], v[164:167], v[220:223]
    v_mfma_f32_16x16x32_f16 v[220:223], v[156:159], v[160:163], v[220:223]
    s_waitcnt lgkmcnt(0)
    v_mfma_f32_16x16x32_f16 v[192:195], v[64:67], v[96:99], v[192:195]
    ds_read_b64 v[128:129], v228 offset:3584
    v_mfma_f32_16x16x32_f16 v[196:199], v[64:67], v[100:103], v[196:199]
    ds_read_b64 v[130:131], v228 offset:3592
    v_mfma_f32_16x16x32_f16 v[200:203], v[64:67], v[104:107], v[200:203]
    ds_read_b128 v[160:163], v229 offset:32
    v_mfma_f32_16x16x32_f16 v[204:207], v[64:67], v[108:111], v[204:207]
    ds_read_b128 v[164:167], v229 offset:544
    v_mfma_f32_16x16x32_f16 v[208:211], v[64:67], v[112:115], v[208:211]
    ds_read_b128 v[168:171], v229 offset:1056
    v_mfma_f32_16x16x32_f16 v[212:215], v[64:67], v[116:119], v[212:215]
    ds_read_b128 v[172:175], v229 offset:1568
    v_mfma_f32_16x16x32_f16 v[216:219], v[64:67], v[120:123], v[216:219]
    ds_read_b128 v[176:179], v229 offset:2080
    v_mfma_f32_16x16x32_f16 v[220:223], v[64:67], v[124:127], v[220:223]
    ds_read_b128 v[180:183], v229 offset:2592
    v_mfma_f32_16x16x32_f16 v[196:199], v[68:71], v[96:99], v[196:199]
    ds_read_b128 v[184:187], v229 offset:3104
    v_mfma_f32_16x16x32_f16 v[200:203], v[68:71], v[100:103], v[200:203]
    ds_read_b128 v[188:191], v229 offset:3616
    v_mfma_f32_16x16x32_f16 v[204:207], v[68:71], v[104:107], v[204:207]
    ds_read_b64 v[132:133], v228 offset:3072
    v_mfma_f32_16x16x32_f16 v[208:211], v[68:71], v[108:111], v[208:211]
    ds_read_b64 v[134:135], v228 offset:3080
    v_mfma_f32_16x16x32_f16 v[212:215], v[68:71], v[112:115], v[212:215]
    ds_read_b64 v[136:137], v228 offset:2560
    v_mfma_f32_16x16x32_f16 v[216:219], v[68:71], v[116:119], v[216:219]
    ds_read_b64 v[138:139], v228 offset:2568
    v_mfma_f32_16x16x32_f16 v[220:223], v[68:71], v[120:123], v[220:223]
    ds_read_b64 v[140:141], v228 offset:2048
    v_mfma_f32_16x16x32_f16 v[200:203], v[72:75], v[96:99], v[200:203]
    ds_read_b64 v[142:143], v228 offset:2056
    v_mfma_f32_16x16x32_f16 v[204:207], v[72:75], v[100:103], v[204:207]
    ds_read_b64 v[144:145], v228 offset:1536
    v_mfma_f32_16x16x32_f16 v[208:211], v[72:75], v[104:107], v[208:211]
    ds_read_b64 v[146:147], v228 offset:1544
    v_mfma_f32_16x16x32_f16 v[212:215], v[72:75], v[108:111], v[212:215]
    ds_read_b64 v[148:149], v228 offset:1024
    v_mfma_f32_16x16x32_f16 v[216:219], v[72:75], v[112:115], v[216:219]
    ds_read_b64 v[150:151], v228 offset:1032
    v_mfma_f32_16x16x32_f16 v[220:223], v[72:75], v[116:119], v[220:223]
    ds_read_b64 v[152:153], v228 offset:512
    v_mfma_f32_16x16x32_f16 v[204:207], v[76:79], v[96:99], v[204:207]
    ds_read_b64 v[154:155], v228 offset:520
    v_mfma_f32_16x16x32_f16 v[208:211], v[76:79], v[100:103], v[208:211]
    ds_read_b64 v[156:157], v228 offset:0
    v_mfma_f32_16x16x32_f16 v[212:215], v[76:79], v[104:107], v[212:215]
    ds_read_b64 v[158:159], v228 offset:8
    v_mfma_f32_16x16x32_f16 v[216:219], v[76:79], v[108:111], v[216:219]
    v_mfma_f32_16x16x32_f16 v[220:223], v[76:79], v[112:115], v[220:223]
    v_mfma_f32_16x16x32_f16 v[208:211], v[80:83], v[96:99], v[208:211]
    v_mfma_f32_16x16x32_f16 v[212:215], v[80:83], v[100:103], v[212:215]
    v_mfma_f32_16x16x32_f16 v[216:219], v[80:83], v[104:107], v[216:219]
    v_mfma_f32_16x16x32_f16 v[220:223], v[80:83], v[108:111], v[220:223]
    v_add_u32 v240, 15360, v7
    global_load_dwordx4 v[236:239], v240, s[68:69]
    v_mfma_f32_16x16x32_f16 v[212:215], v[84:87], v[96:99], v[212:215]
    v_mfma_f32_16x16x32_f16 v[216:219], v[84:87], v[100:103], v[216:219]
    v_mfma_f32_16x16x32_f16 v[220:223], v[84:87], v[104:107], v[220:223]
    v_mfma_f32_16x16x32_f16 v[216:219], v[88:91], v[96:99], v[216:219]
    v_mfma_f32_16x16x32_f16 v[220:223], v[88:91], v[100:103], v[220:223]
    v_mfma_f32_16x16x32_f16 v[220:223], v[92:95], v[96:99], v[220:223]
    s_waitcnt lgkmcnt(0)
    v_mfma_f32_16x16x32_f16 v[192:195], v[128:131], v[160:163], v[192:195]
    v_mfma_f32_16x16x32_f16 v[196:199], v[128:131], v[164:167], v[196:199]
    v_mfma_f32_16x16x32_f16 v[200:203], v[128:131], v[168:171], v[200:203]
    v_mfma_f32_16x16x32_f16 v[204:207], v[128:131], v[172:175], v[204:207]
    v_mfma_f32_16x16x32_f16 v[208:211], v[128:131], v[176:179], v[208:211]
    v_mfma_f32_16x16x32_f16 v[212:215], v[128:131], v[180:183], v[212:215]
    v_mfma_f32_16x16x32_f16 v[216:219], v[128:131], v[184:187], v[216:219]
    v_mfma_f32_16x16x32_f16 v[220:223], v[128:131], v[188:191], v[220:223]
    v_mfma_f32_16x16x32_f16 v[196:199], v[132:135], v[160:163], v[196:199]
    v_mfma_f32_16x16x32_f16 v[200:203], v[132:135], v[164:167], v[200:203]
    v_mfma_f32_16x16x32_f16 v[204:207], v[132:135], v[168:171], v[204:207]
    v_mfma_f32_16x16x32_f16 v[208:211], v[132:135], v[172:175], v[208:211]
    v_mfma_f32_16x16x32_f16 v[212:215], v[132:135], v[176:179], v[212:215]
    v_mfma_f32_16x16x32_f16 v[216:219], v[132:135], v[180:183], v[216:219]
    v_mfma_f32_16x16x32_f16 v[220:223], v[132:135], v[184:187], v[220:223]
    v_mfma_f32_16x16x32_f16 v[200:203], v[136:139], v[160:163], v[200:203]
    v_mfma_f32_16x16x32_f16 v[204:207], v[136:139], v[164:167], v[204:207]
    v_mfma_f32_16x16x32_f16 v[208:211], v[136:139], v[168:171], v[208:211]
    v_mfma_f32_16x16x32_f16 v[212:215], v[136:139], v[172:175], v[212:215]
    v_mfma_f32_16x16x32_f16 v[216:219], v[136:139], v[176:179], v[216:219]
    v_mfma_f32_16x16x32_f16 v[220:223], v[136:139], v[180:183], v[220:223]
    v_mfma_f32_16x16x32_f16 v[204:207], v[140:143], v[160:163], v[204:207]
    v_mfma_f32_16x16x32_f16 v[208:211], v[140:143], v[164:167], v[208:211]
    v_mfma_f32_16x16x32_f16 v[212:215], v[140:143], v[168:171], v[212:215]
    v_mfma_f32_16x16x32_f16 v[216:219], v[140:143], v[172:175], v[216:219]
    v_mfma_f32_16x16x32_f16 v[220:223], v[140:143], v[176:179], v[220:223]
    v_mfma_f32_16x16x32_f16 v[208:211], v[144:147], v[160:163], v[208:211]
    v_mfma_f32_16x16x32_f16 v[212:215], v[144:147], v[164:167], v[212:215]
    v_mfma_f32_16x16x32_f16 v[216:219], v[144:147], v[168:171], v[216:219]
    v_mfma_f32_16x16x32_f16 v[220:223], v[144:147], v[172:175], v[220:223]
    v_mfma_f32_16x16x32_f16 v[212:215], v[148:151], v[160:163], v[212:215]
    v_mfma_f32_16x16x32_f16 v[216:219], v[148:151], v[164:167], v[216:219]
    v_mfma_f32_16x16x32_f16 v[220:223], v[148:151], v[168:171], v[220:223]
    v_mfma_f32_16x16x32_f16 v[216:219], v[152:155], v[160:163], v[216:219]
    v_mfma_f32_16x16x32_f16 v[220:223], v[152:155], v[164:167], v[220:223]
    v_mfma_f32_16x16x32_f16 v[220:223], v[156:159], v[160:163], v[220:223]
    s_cmp_lg_u32 s3, 0
    s_cbranch_scc1 NOF
    s_cmp_ge_u32 s2, 112
    s_cbranch_scc1 NOF
    s_lshl_b32 s20, s2, 4
    s_add_u32 s20, s20, 20480
    v_mov_b32 v64, s20
    v_mov_b32 v65, 0
    s_mov_b64 exec, 1
    global_store_dword v64, v65, s[68:69] sc1
    s_mov_b64 exec, -1
    s_branch NOF2
NOF:
    s_waitcnt vmcnt(0)
NOF2:
    s_waitcnt vmcnt(1)
GIP:
    v_or3_b32 v236, v236, v237, v238
    v_or_b32 v236, v236, v239
    v_cmp_ne_u32 vcc, 0, v236
    s_cbranch_vccz GAP
    global_load_dwordx4 v[236:239], v240, s[68:69] sc1
    s_waitcnt vmcnt(0)
    s_sub_u32 s10, s10, 1
    s_cbranch_scc1 EXIT
    s_branch GIP
GAP:
    s_waitcnt vmcnt(1)
    v_cmp_eq_u32 vcc, 0xffff, v234
    s_cbranch_vccz GAD
    global_load_ushort v234, v235, s[68:69] sc1
    s_waitcnt vmcnt(0)
    s_sub_u32 s10, s10, 1
    s_cbranch_scc1 EXIT
    s_branch GAP
GAD:
    v_lshlrev_b32 v234, 16, v234
    v_mul_f32 v234, v234, v233
    v_pk_mul_f32 v[192:193], v[192:193], v[234:235] op_sel_hi:[1,0]
    v_pk_mul_f32 v[194:195], v[194:195], v[234:235] op_sel_hi:[1,0]
    v_cvt_pk_bf16_f32 v192, v192, v193
    v_cvt_pk_bf16_f32 v193, v194, v195
    ds_write_b64 v230, v[192:193] offset:0
    v_pk_mul_f32 v[196:197], v[196:197], v[234:235] op_sel_hi:[1,0]
    v_pk_mul_f32 v[198:199], v[198:199], v[234:235] op_sel_hi:[1,0]
    v_cvt_pk_bf16_f32 v196, v196, v197
    v_cvt_pk_bf16_f32 v197, v198, v199
    ds_write_b64 v230, v[196:197] offset:512
    v_pk_mul_f32 v[200:201], v[200:201], v[234:235] op_sel_hi:[1,0]
    v_pk_mul_f32 v[202:203], v[202:203], v[234:235] op_sel_hi:[1,0]
    v_cvt_pk_bf16_f32 v200, v200, v201
    v_cvt_pk_bf16_f32 v201, v202, v203
    ds_write_b64 v230, v[200:201] offset:1024
    v_pk_mul_f32 v[204:205], v[204:205], v[234:235] op_sel_hi:[1,0]
    v_pk_mul_f32 v[206:207], v[206:207], v[234:235] op_sel_hi:[1,0]
    v_cvt_pk_bf16_f32 v204, v204, v205
    v_cvt_pk_bf16_f32 v205, v206, v207
    ds_write_b64 v230, v[204:205] offset:1536
    v_pk_mul_f32 v[208:209], v[208:209], v[234:235] op_sel_hi:[1,0]
    v_pk_mul_f32 v[210:211], v[210:211], v[234:235] op_sel_hi:[1,0]
    v_cvt_pk_bf16_f32 v208, v208, v209
    v_cvt_pk_bf16_f32 v209, v210, v211
    ds_write_b64 v230, v[208:209] offset:2048
    v_pk_mul_f32 v[212:213], v[212:213], v[234:235] op_sel_hi:[1,0]
    v_pk_mul_f32 v[214:215], v[214:215], v[234:235] op_sel_hi:[1,0]
    v_cvt_pk_bf16_f32 v212, v212, v213
    v_cvt_pk_bf16_f32 v213, v214, v215
    ds_write_b64 v230, v[212:213] offset:2560
    v_pk_mul_f32 v[216:217], v[216:217], v[234:235] op_sel_hi:[1,0]
    v_pk_mul_f32 v[218:219], v[218:219], v[234:235] op_sel_hi:[1,0]
    v_cvt_pk_bf16_f32 v216, v216, v217
    v_cvt_pk_bf16_f32 v217, v218, v219
    ds_write_b64 v230, v[216:217] offset:3072
    v_pk_mul_f32 v[220:221], v[220:221], v[234:235] op_sel_hi:[1,0]
    v_pk_mul_f32 v[222:223], v[222:223], v[234:235] op_sel_hi:[1,0]
    v_cvt_pk_bf16_f32 v220, v220, v221
    v_cvt_pk_bf16_f32 v221, v222, v223
    ds_write_b64 v230, v[220:221] offset:3584
    s_branch CONV_JOIN
CONV_B:
    v_mov_b32 v60, -1
    v_mov_b32 v61, -1
    v_mov_b32 v62, -1
    v_mov_b32 v63, -1
    v_and_b32 v52, 255, v0
    s_lshl_b32 s20, s6, 14
    s_add_u32 s20, s20, 10485760
    v_lshl_add_u32 v112, v52, 4, s20
    v_add_u32 v113, 8192, v112
    s_waitcnt lgkmcnt(0)
    v_add_u32 v114, 4096, v112
    v_add_u32 v115, 4096, v113
    global_store_dwordx4 v112, v[60:63], s[68:69] sc1
    global_store_dwordx4 v114, v[60:63], s[68:69] sc1
    global_store_dwordx4 v113, v[60:63], s[68:69] sc1
    global_store_dwordx4 v115, v[60:63], s[68:69] sc1
    s_lshl_b32 s20, s2, 2
    s_add_u32 s20, s20, s9
    s_mul_i32 s20, s20, 2304
    v_add_u32 v58, s20, v7
    v_add_u32 v59, s20, v13
    global_load_dwordx4 v[64:67], v58, s[36:37] nt
    global_load_ushort v68, v59, s[36:37] nt
    global_load_dwordx4 v[70:73], v58, s[36:37] offset:1152 nt
    global_load_ushort v74, v59, s[36:37] offset:1152 nt
    v_mov_b32 v54, 0
    v_mov_b32 v55, 0
    s_mul_i32 s20, s9, 4608
    s_add_u32 s20, s20, 124928
    v_lshl_add_u32 v53, v1, 3, s20
    ds_write_b64 v53, v[54:55]
    s_waitcnt vmcnt(4) lgkmcnt(0)
    s_barrier
    s_cmp_lg_u32 s3, 4
    s_cbranch_scc1 NOIF
    v_mov_b32 v54, s6
    s_mov_b64 exec, 1
    global_store_byte v54, v60, s[66:67] sc1
    s_mov_b64 exec, -1
    s_waitcnt vmcnt(1)
    s_branch NOIF2
NOIF:
    s_waitcnt vmcnt(0)
NOIF2:
    s_mul_i32 s18, s9, 2304
    s_add_u32 s18, s18, 144896
    v_add_u32 v58, s18, v7
    v_add_u32 v59, s18, v13
    ds_write_b128 v58, v[64:67]
    ds_write_b16 v59, v68
    ds_write_b128 v58, v[70:73] offset:1152
    ds_write_b16 v59, v74 offset:1152
    v_lshlrev_b32 v80, 16, v64
    v_and_b32 v81, s12, v64
    v_lshlrev_b32 v82, 16, v65
    v_and_b32 v83, s12, v65
    v_lshlrev_b32 v84, 16, v66
    v_and_b32 v85, s12, v66
    v_lshlrev_b32 v86, 16, v67
    v_and_b32 v87, s12, v67
    v_lshlrev_b32 v88, 16, v68
    v_lshlrev_b32 v90, 16, v70
    v_and_b32 v91, s12, v70
    v_lshlrev_b32 v92, 16, v71
    v_and_b32 v93, s12, v71
    v_lshlrev_b32 v94, 16, v72
    v_and_b32 v95, s12, v72
    v_lshlrev_b32 v96, 16, v73
    v_and_b32 v97, s12, v73
    v_lshlrev_b32 v98, 16, v74
    v_readfirstlane_b32 s70, v80
    s_nop 1
    v_subrev_f32 v80, s70, v80
    v_subrev_f32 v81, s70, v81
    v_subrev_f32 v82, s70, v82
    v_subrev_f32 v83, s70, v83
    v_subrev_f32 v84, s70, v84
    v_subrev_f32 v85, s70, v85
    v_subrev_f32 v86, s70, v86
    v_subrev_f32 v87, s70, v87
    v_subrev_f32 v88, s70, v88
    v_pk_add_f32 v[100:101], v[80:81], v[82:83]
    v_pk_mul_f32 v[102:103], v[80:81], v[80:81]
    v_pk_add_f32 v[100:101], v[100:101], v[84:85]
    v_pk_fma_f32 v[102:103], v[82:83], v[82:83], v[102:103]
    v_pk_add_f32 v[100:101], v[100:101], v[86:87]
    v_pk_fma_f32 v[102:103], v[84:85], v[84:85], v[102:103]
    v_add_f32 v100, v100, v88
    v_pk_fma_f32 v[102:103], v[86:87], v[86:87], v[102:103]
    v_add_f32 v100, v100, v101
    v_fmac_f32 v102, v88, v88
    v_add_f32 v102, v102, v103
    v_readfirstlane_b32 s71, v90
    s_nop 1
    v_subrev_f32 v90, s71, v90
    v_subrev_f32 v91, s71, v91
    v_subrev_f32 v92, s71, v92
    v_subrev_f32 v93, s71, v93
    v_subrev_f32 v94, s71, v94
    v_subrev_f32 v95, s71, v95
    v_subrev_f32 v96, s71, v96
    v_subrev_f32 v97, s71, v97
    v_subrev_f32 v98, s71, v98
    v_pk_add_f32 v[104:105], v[90:91], v[92:93]
    v_pk_mul_f32 v[106:107], v[90:91], v[90:91]
    v_pk_add_f32 v[104:105], v[104:105], v[94:95]
    v_pk_fma_f32 v[106:107], v[92:93], v[92:93], v[106:107]
    v_pk_add_f32 v[104:105], v[104:105], v[96:97]
    v_pk_fma_f32 v[106:107], v[94:95], v[94:95], v[106:107]
    v_add_f32 v104, v104, v98
    v_pk_fma_f32 v[106:107], v[96:97], v[96:97], v[106:107]
    v_add_f32 v104, v104, v105
    v_fmac_f32 v106, v98, v98
    v_add_f32 v106, v106, v107
    v_permlane32_swap_b32 v100, v104
    s_nop 0
    v_permlane32_swap_b32 v102, v106
    v_add_f32 v100, v100, v104
    v_add_f32 v102, v102, v106
    s_nop 1
    v_permlane16_swap_b32 v100, v102
    v_add_f32 v100, v100, v102
    s_nop 1
    v_add_f32_dpp v100, v100, v100 row_ror:8 row_mask:0xf bank_mask:0xf
    s_nop 1
    v_add_f32_dpp v100, v100, v100 row_ror:4 row_mask:0xf bank_mask:0xf
    s_nop 1
    v_add_f32_dpp v100, v100, v100 row_ror:2 row_mask:0xf bank_mask:0xf
    s_nop 1
    v_add_f32_dpp v100, v100, v100 row_ror:1 row_mask:0xf bank_mask:0xf
    v_mov_b32 v102, v100
    s_nop 1
    v_permlane16_swap_b32 v100, v102
    v_mov_b32 v104, s70
    v_mov_b32 v105, s71
    v_cmp_gt_u32 vcc, 32, v1
    s_nop 1
    v_cndmask_b32 v104, v105, v104, vcc
    v_mul_f32 v100, 0x3ae38e39, v100
    v_mul_f32 v102, 0x3ae38e39, v102
    v_add_f32 v105, v104, v100
    v_fma_f32 v107, -v100, v100, v102
    v_max_f32 v107, 0, v107
    v_cvt_pk_bf16_f32 v107, v107, v107
    v_and_b32 v107, s12, v107
    v_add_f32 v107, 0x3727c5ac, v107
    v_cvt_pk_bf16_f32 v107, v107, v107
    v_and_b32 v107, s12, v107
    v_sqrt_f32 v106, v107
    v_cvt_pk_bf16_f32 v105, v105, v105
    v_and_b32 v105, s12, v105
    v_cvt_pk_bf16_f32 v106, v106, v106
    v_and_b32 v106, s12, v106
    v_rcp_f32 v100, v106
    v_sub_f32 v101, v104, v105
    v_mul_f32 v101, v101, v100
    v_mov_b32 v102, v100
    v_mov_b32 v103, v101
    s_nop 0
    v_permlane32_swap_b32 v100, v102
    v_permlane32_swap_b32 v101, v103
    s_mul_i32 s18, s9, 2304
    s_add_u32 s18, s18, 154112
    v_lshl_add_u32 v58, v1, 5, s18
    v_lshl_add_u32 v59, v1, 2, s18
    s_cmp_lg_u32 s3, 4
    s_cbranch_scc1 IW_1
    s_load_dwordx16 s[20:35], s[66:67], 0
    s_load_dwordx8 s[40:47], s[66:67], 64
    s_load_dwordx4 s[16:19], s[66:67], 96
    s_load_dwordx2 s[38:39], s[66:67], 112
    s_load_dwordx2 s[48:49], s[66:67], 120
    s_load_dwordx2 s[98:99], s[66:67], 128
    s_load_dwordx2 s[100:101], s[66:67], 136
IW_1:
    v_pk_fma_f32 v[80:81], v[80:81], v[100:101], v[100:101] op_sel:[0,0,1] op_sel_hi:[1,0,1]
    v_pk_fma_f32 v[82:83], v[82:83], v[100:101], v[100:101] op_sel:[0,0,1] op_sel_hi:[1,0,1]
    v_pk_fma_f32 v[84:85], v[84:85], v[100:101], v[100:101] op_sel:[0,0,1] op_sel_hi:[1,0,1]
    v_pk_fma_f32 v[86:87], v[86:87], v[100:101], v[100:101] op_sel:[0,0,1] op_sel_hi:[1,0,1]
    v_fma_f32 v88, v88, v100, v101
    v_pk_fma_f32 v[90:91], v[90:91], v[102:103], v[102:103] op_sel:[0,0,1] op_sel_hi:[1,0,1]
    v_pk_fma_f32 v[92:93], v[92:93], v[102:103], v[102:103] op_sel:[0,0,1] op_sel_hi:[1,0,1]
    v_pk_fma_f32 v[94:95], v[94:95], v[102:103], v[102:103] op_sel:[0,0,1] op_sel_hi:[1,0,1]
    v_pk_fma_f32 v[96:97], v[96:97], v[102:103], v[102:103] op_sel:[0,0,1] op_sel_hi:[1,0,1]
    v_fma_f32 v98, v98, v102, v103
    v_cvt_pk_bf16_f32 v64, v80, v90
    v_cvt_pk_bf16_f32 v65, v81, v91
    v_cvt_pk_bf16_f32 v66, v82, v92
    v_cvt_pk_bf16_f32 v67, v83, v93
    v_cvt_pk_bf16_f32 v68, v84, v94
    v_cvt_pk_bf16_f32 v69, v85, v95
    v_cvt_pk_bf16_f32 v70, v86, v96
    v_cvt_pk_bf16_f32 v71, v87, v97
    v_cvt_pk_bf16_f32 v72, v88, v98
    ds_write_b128 v58, v[64:67]
    ds_write_b128 v58, v[68:71] offset:16
    ds_write_b32 v59, v72 offset:2048
    s_lshl_b32 s14, s9, 2
    s_add_u32 s14, s14, 143456
    v_mov_b32 v58, s14
    v_mov_b32 v59, 0
    v_and_b32 v104, 3, v1
    v_lshlrev_b32 v100, 4, v104
    v_lshlrev_b32 v104, 2, v104
    v_add_u32 v104, 143456, v104
    v_and_b32 v52, 255, v0
    v_lshrrev_b32 v101, 2, v52
    v_lshl_add_u32 v101, v101, 14, v100
    s_lshl_b32 s14, s2, 6
    s_add_u32 s14, s14, 10485760
    v_add_u32 v101, s14, v101
    v_add_u32 v102, 1048576, v101
    v_and_b32 v103, 15, v1
    v_lshl_add_u32 v103, s9, 4, v103
    v_lshrrev_b32 v99, 2, v103
    v_lshl_add_u32 v99, v99, 14, v100
    v_add_u32 v99, s14, v99
    v_add_u32 v99, 2097152, v99
    v_lshlrev_b32 v103, 2, v103
    v_add_u32 v103, 156160, v103
    v_lshlrev_b32 v100, 2, v52
    v_add_u32 v100, 154112, v100
    s_cmp_lg_u32 s3, 4
    s_cbranch_scc1 IFD_5
    s_waitcnt lgkmcnt(0)
    s_and_b64 s[20:21], s[20:21], s[22:23]
    s_and_b64 s[20:21], s[20:21], s[24:25]
    s_and_b64 s[20:21], s[20:21], s[26:27]
    s_and_b64 s[20:21], s[20:21], s[28:29]
    s_and_b64 s[20:21], s[20:21], s[30:31]
    s_and_b64 s[20:21], s[20:21], s[32:33]
    s_and_b64 s[20:21], s[20:21], s[34:35]
    s_and_b64 s[20:21], s[20:21], s[16:17]
    s_and_b64 s[20:21], s[20:21], s[18:19]
    s_and_b64 s[20:21], s[20:21], s[38:39]
    s_and_b64 s[20:21], s[20:21], s[40:41]
    s_and_b64 s[20:21], s[20:21], s[42:43]
    s_and_b64 s[20:21], s[20:21], s[44:45]
    s_and_b64 s[20:21], s[20:21], s[46:47]
    s_and_b64 s[20:21], s[20:21], s[48:49]
    s_and_b64 s[20:21], s[20:21], s[98:99]
    s_and_b64 s[20:21], s[20:21], s[100:101]
    s_and_b32 s20, s20, s21
    s_cmp_eq_u32 s20, -1
    s_cbranch_scc1 IFD_5
    v_min_u32 v77, 35, v1
    v_lshlrev_b32 v77, 2, v77
IF_4:
    global_load_dword v76, v77, s[66:67] sc1
    s_waitcnt vmcnt(0)
    v_cmp_ne_u32 vcc, -1, v76
    s_cbranch_vccz IFD_5
    s_sub_u32 s10, s10, 1
    s_cbranch_scc1 EXIT
    s_branch IF_4
IFD_5:
    ds_write_b32 v58, v59
SL_2:
    ds_read_b32 v105, v104
    s_waitcnt lgkmcnt(0)
    v_cmp_eq_u32 vcc, -1, v105
    s_cbranch_vccz SLD_3
    s_sub_u32 s10, s10, 1
    s_cbranch_scc1 EXIT
    s_branch SL_2
SLD_3:
    ds_read_b32 v80, v100 offset:0
    ds_read_b32 v81, v100 offset:2304
    ds_read_b32 v82, v100 offset:4608
    ds_read_b32 v83, v100 offset:6912
    ds_read_b32 v84, v100 offset:1024
    ds_read_b32 v85, v100 offset:3328
    ds_read_b32 v86, v100 offset:5632
    ds_read_b32 v87, v100 offset:7936
    ds_read_b32 v88, v103 offset:0
    ds_read_b32 v89, v103 offset:2304
    ds_read_b32 v90, v103 offset:4608
    ds_read_b32 v91, v103 offset:6912
    s_waitcnt lgkmcnt(8)
    global_store_dwordx4 v101, v[80:83], s[68:69] sc1
    s_waitcnt lgkmcnt(4)
    global_store_dwordx4 v102, v[84:87], s[68:69] sc1
    s_waitcnt lgkmcnt(0)
    s_mov_b64 exec, 0xffff
    global_store_dwordx4 v99, v[88:91], s[68:69] sc1
    s_mov_b64 exec, -1
    s_load_dwordx16 s[20:35], s[66:67], 192
    v_and_b32 v54, 3, v1
    s_movk_i32 s18, 4608
    v_mul_u32_u24 v55, s18, v54
    v_lshrrev_b32 v53, 2, v52
    v_lshl_add_u32 v55, v53, 4, v55
    v_add_u32 v55, 125440, v55
    s_lshl_b32 s18, s6, 3
    s_add_u32 s18, s18, 8192
    v_lshl_add_u32 v54, v54, 1, s18
    s_waitcnt vmcnt(0) lgkmcnt(0)
    global_load_dwordx4 v[64:67], v112, s[68:69] sc1
    global_load_dwordx4 v[68:71], v114, s[68:69] sc1
    global_load_dwordx4 v[72:75], v113, s[68:69] sc1
    global_load_dwordx4 v[76:79], v115, s[68:69] sc1
    s_and_b64 s[20:21], s[20:21], s[22:23]
    s_and_b64 s[20:21], s[20:21], s[24:25]
    s_and_b64 s[20:21], s[20:21], s[26:27]
    s_and_b64 s[20:21], s[20:21], s[28:29]
    s_and_b64 s[20:21], s[20:21], s[30:31]
    s_and_b64 s[20:21], s[20:21], s[32:33]
    s_and_b64 s[20:21], s[20:21], s[34:35]
    s_and_b32 s20, s20, s21
    s_cmp_lg_u32 s20, 0
    s_cbranch_scc1 GOD_7
    v_and_b32 v59, 15, v1
    v_lshlrev_b32 v59, 2, v59
GO_6:
    global_load_dword v58, v59, s[66:67] offset:192 sc1
    s_waitcnt vmcnt(0)
    v_cmp_eq_u32 vcc, 0, v58
    s_cbranch_vccz GOD_7
    s_sub_u32 s10, s10, 1
    s_cbranch_scc1 EXIT
    s_branch GO_6
GOD_7:
    global_load_ushort v56, v54, s[68:69]
    global_load_ushort v57, v54, s[68:69] offset:1152
    s_waitcnt vmcnt(2)
NP:
    v_max3_u32 v80, v64, v65, v66
    v_max3_u32 v80, v80, v67, v68
    v_max3_u32 v80, v80, v69, v70
    v_max3_u32 v80, v80, v71, v72
    v_max3_u32 v80, v80, v73, v74
    v_max3_u32 v80, v80, v75, v76
    v_max3_u32 v80, v80, v77, v78
    v_max_u32 v80, v80, v79
    v_cmp_eq_u32 vcc, -1, v80
    s_cbranch_vccz NPD
    s_mov_b64 exec, vcc
    global_load_dwordx4 v[64:67], v112, s[68:69] sc1
    global_load_dwordx4 v[68:71], v114, s[68:69] sc1
    global_load_dwordx4 v[72:75], v113, s[68:69] sc1
    global_load_dwordx4 v[76:79], v115, s[68:69] sc1
    s_mov_b64 exec, -1
    s_waitcnt vmcnt(0)
    s_sub_u32 s10, s10, 1
    s_cbranch_scc1 EXIT
    s_branch NP
NPD:
    v_lshlrev_b32 v128, 16, v64
    v_and_b32 v129, s12, v64
    v_lshlrev_b32 v130, 16, v65
    v_and_b32 v131, s12, v65
    v_lshlrev_b32 v132, 16, v66
    v_and_b32 v133, s12, v66
    v_lshlrev_b32 v134, 16, v67
    v_and_b32 v135, s12, v67
    v_lshlrev_b32 v136, 16, v68
    v_and_b32 v137, s12, v68
    v_lshlrev_b32 v138, 16, v69
    v_and_b32 v139, s12, v69
    v_lshlrev_b32 v140, 16, v70
    v_and_b32 v141, s12, v70
    v_lshlrev_b32 v142, 16, v71
    v_and_b32 v143, s12, v71
    v_lshlrev_b32 v144, 16, v72
    v_and_b32 v145, s12, v72
    v_lshlrev_b32 v146, 16, v73
    v_and_b32 v147, s12, v73
    v_lshlrev_b32 v148, 16, v74
    v_and_b32 v149, s12, v74
    v_lshlrev_b32 v150, 16, v75
    v_and_b32 v151, s12, v75
    v_lshlrev_b32 v152, 16, v76
    v_and_b32 v153, s12, v76
    v_lshlrev_b32 v154, 16, v77
    v_and_b32 v155, s12, v77
    v_lshlrev_b32 v156, 16, v78
    v_and_b32 v157, s12, v78
    v_lshlrev_b32 v158, 16, v79
    v_and_b32 v159, s12, v79
    s_waitcnt vmcnt(0)
MDP:
    v_max_u32 v58, v56, v57
    v_cmp_eq_u32 vcc, 0xffff, v58
    s_cbranch_vccz MDPD
    global_load_ushort v56, v54, s[68:69] sc1
    global_load_ushort v57, v54, s[68:69] offset:1152 sc1
    s_waitcnt vmcnt(0)
    s_sub_u32 s10, s10, 1
    s_cbranch_scc1 EXIT
    s_branch MDP
MDPD:
    v_lshlrev_b32 v58, 16, v57
    v_lshlrev_b32 v59, 16, v56
    v_add_f32 v58, 1.0, v58
    v_cvt_pk_bf16_f32 v58, v58, v58
    v_and_b32 v58, s12, v58
    v_pk_fma_f32 v[128:129], v[128:129], v[58:59], v[58:59] op_sel:[0,0,1] op_sel_hi:[1,0,1]
    v_pk_fma_f32 v[130:131], v[130:131], v[58:59], v[58:59] op_sel:[0,0,1] op_sel_hi:[1,0,1]
    v_pk_fma_f32 v[132:133], v[132:133], v[58:59], v[58:59] op_sel:[0,0,1] op_sel_hi:[1,0,1]
    v_pk_fma_f32 v[134:135], v[134:135], v[58:59], v[58:59] op_sel:[0,0,1] op_sel_hi:[1,0,1]
    v_cvt_pk_f16_f32 v64, v128, v129
    v_cvt_pk_f16_f32 v65, v130, v131
    v_cvt_pk_f16_f32 v66, v132, v133
    v_cvt_pk_f16_f32 v67, v134, v135
    ds_write_b128 v55, v[64:67] offset:0
    v_pk_fma_f32 v[136:137], v[136:137], v[58:59], v[58:59] op_sel:[0,0,1] op_sel_hi:[1,0,1]
    v_pk_fma_f32 v[138:139], v[138:139], v[58:59], v[58:59] op_sel:[0,0,1] op_sel_hi:[1,0,1]
    v_pk_fma_f32 v[140:141], v[140:141], v[58:59], v[58:59] op_sel:[0,0,1] op_sel_hi:[1,0,1]
    v_pk_fma_f32 v[142:143], v[142:143], v[58:59], v[58:59] op_sel:[0,0,1] op_sel_hi:[1,0,1]
    v_cvt_pk_f16_f32 v68, v136, v137
    v_cvt_pk_f16_f32 v69, v138, v139
    v_cvt_pk_f16_f32 v70, v140, v141
    v_cvt_pk_f16_f32 v71, v142, v143
    ds_write_b128 v55, v[68:71] offset:1024
    v_pk_fma_f32 v[144:145], v[144:145], v[58:59], v[58:59] op_sel:[0,0,1] op_sel_hi:[1,0,1]
    v_pk_fma_f32 v[146:147], v[146:147], v[58:59], v[58:59] op_sel:[0,0,1] op_sel_hi:[1,0,1]
    v_pk_fma_f32 v[148:149], v[148:149], v[58:59], v[58:59] op_sel:[0,0,1] op_sel_hi:[1,0,1]
    v_pk_fma_f32 v[150:151], v[150:151], v[58:59], v[58:59] op_sel:[0,0,1] op_sel_hi:[1,0,1]
    v_cvt_pk_f16_f32 v72, v144, v145
    v_cvt_pk_f16_f32 v73, v146, v147
    v_cvt_pk_f16_f32 v74, v148, v149
    v_cvt_pk_f16_f32 v75, v150, v151
    ds_write_b128 v55, v[72:75] offset:2048
    v_pk_fma_f32 v[152:153], v[152:153], v[58:59], v[58:59] op_sel:[0,0,1] op_sel_hi:[1,0,1]
    v_pk_fma_f32 v[154:155], v[154:155], v[58:59], v[58:59] op_sel:[0,0,1] op_sel_hi:[1,0,1]
    v_pk_fma_f32 v[156:157], v[156:157], v[58:59], v[58:59] op_sel:[0,0,1] op_sel_hi:[1,0,1]
    v_pk_fma_f32 v[158:159], v[158:159], v[58:59], v[58:59] op_sel:[0,0,1] op_sel_hi:[1,0,1]
    v_cvt_pk_f16_f32 v76, v152, v153
    v_cvt_pk_f16_f32 v77, v154, v155
    v_cvt_pk_f16_f32 v78, v156, v157
    v_cvt_pk_f16_f32 v79, v158, v159
    ds_write_b128 v55, v[76:79] offset:3072
    s_waitcnt lgkmcnt(0)
    s_barrier
    global_load_dwordx4 v[8:11], v7, s[52:53]
    global_load_ushort v12, v13, s[52:53]
    v_mov_b32 v60, -1
    v_mov_b32 v61, -1
    v_mov_b32 v62, -1
    v_mul_u32_u24 v59, 12, v1
    s_mul_i32 s20, s2, 9216
    s_mul_i32 s21, s9, 2304
    s_add_u32 s20, s20, s21
    s_add_u32 s20, s20, 1048576
    v_add_u32 v58, s20, v59
    global_store_dwordx3 v58, v[60:62], s[68:69] sc1
    global_store_dwordx3 v58, v[60:62], s[68:69] offset:768 sc1
    global_store_dwordx3 v58, v[60:62], s[68:69] offset:1536 sc1
    v_add_u32 v58, 3145728, v58
    global_store_dwordx3 v58, v[60:62], s[68:69] sc1
    global_store_dwordx3 v58, v[60:62], s[68:69] offset:768 sc1
    global_store_dwordx3 v58, v[60:62], s[68:69] offset:1536 sc1
    s_mul_i32 s20, s6, 18432
    s_mul_i32 s21, s9, 4608
    s_add_u32 s20, s20, s21
    s_add_u32 s20, s20, 7342336
    v_add_u32 v58, s20, v59
    global_store_dwordx3 v58, v[60:62], s[68:69] offset:-2304 sc1
    global_store_dwordx3 v58, v[60:62], s[68:69] offset:-1536 sc1
    global_store_dwordx3 v58, v[60:62], s[68:69] offset:-768 sc1
    global_store_dwordx3 v58, v[60:62], s[68:69] sc1
    global_store_dwordx3 v58, v[60:62], s[68:69] offset:768 sc1
    global_store_dwordx3 v58, v[60:62], s[68:69] offset:1536 sc1
    v_add_u32 v52, 8192, v7
    v_add_u32 v53, 8192, v13
    v_add_u32 v54, 3456, v52
    v_add_u32 v55, 3456, v53
    global_load_dwordx4 v[20:23], v54, s[68:69]
    global_load_ushort v24, v55, s[68:69]
    v_add_u32 v54, 4608, v52
    v_add_u32 v55, 4608, v53
    global_load_dwordx4 v[14:17], v54, s[68:69]
    global_load_ushort v18, v55, s[68:69]
    v_add_u32 v54, 5760, v52
    v_add_u32 v55, 5760, v53
    global_load_dwordx4 v[26:29], v54, s[68:69]
    global_load_ushort v30, v55, s[68:69]
    s_lshl_b32 s20, s2, 2
    s_add_u32 s20, s20, s9
    s_add_u32 s20, s20, 15360
    v_mov_b32 v58, s20
    v_mov_b32 v59, 0
    s_waitcnt vmcnt(15)
    s_mov_b64 exec, 1
    global_store_byte v58, v59, s[68:69] sc1
    s_mov_b64 exec, -1
    s_cmp_eq_u32 s13, 0
    s_cbranch_scc1 CONV_JOIN
    v_and_b32 v52, 7, v1
    v_lshlrev_b32 v52, 3, v52
    v_lshrrev_b32 v53, 4, v1
    s_mul_i32 s20, s9, 294912
    s_lshl_b32 s21, s8, 6
    s_add_u32 s20, s20, s21
    s_mov_b32 s21, 73728
    v_mad_u32_u24 v52, v53, s21, v52
    v_add_u32 v52, s20, v52
    v_and_b32 v54, 8, v1
    v_cmp_eq_u32 vcc, 0, v54
    v_mov_b32 v54, s56
    v_mov_b32 v55, s54
    v_cndmask_b32 v54, v54, v55, vcc
    v_mov_b32 v55, s57
    v_mov_b32 v56, s55
    v_cndmask_b32 v55, v55, v56, vcc
    v_add_co_u32 v54, vcc, v54, v52
    s_nop 1
    v_addc_co_u32 v55, vcc, 0, v55, vcc
    s_mov_b32 s20, 9216
    s_mov_b32 s21, 0
    s_mov_b32 s22, 1115136
    s_mov_b32 s23, 0
    global_load_dwordx2 v[128:129], v[54:55], off nt
    v_lshl_add_u64 v[54:55], v[54:55], 0, s[20:21]
    global_load_dwordx2 v[130:131], v[54:55], off nt
    v_lshl_add_u64 v[54:55], v[54:55], 0, s[20:21]
    global_load_dwordx2 v[132:133], v[54:55], off nt
    v_lshl_add_u64 v[54:55], v[54:55], 0, s[20:21]
    global_load_dwordx2 v[134:135], v[54:55], off nt
    v_lshl_add_u64 v[54:55], v[54:55], 0, s[20:21]
    global_load_dwordx2 v[136:137], v[54:55], off nt
    v_lshl_add_u64 v[54:55], v[54:55], 0, s[20:21]
    global_load_dwordx2 v[138:139], v[54:55], off nt
    v_lshl_add_u64 v[54:55], v[54:55], 0, s[20:21]
    global_load_dwordx2 v[140:141], v[54:55], off nt
    v_lshl_add_u64 v[54:55], v[54:55], 0, s[20:21]
    global_load_dwordx2 v[142:143], v[54:55], off nt
    v_lshl_add_u64 v[54:55], v[54:55], 0, s[22:23]
    global_load_dwordx2 v[144:145], v[54:55], off nt
    v_lshl_add_u64 v[54:55], v[54:55], 0, s[20:21]
    global_load_dwordx2 v[146:147], v[54:55], off nt
    v_lshl_add_u64 v[54:55], v[54:55], 0, s[20:21]
    global_load_dwordx2 v[148:149], v[54:55], off nt
    v_lshl_add_u64 v[54:55], v[54:55], 0, s[20:21]
    global_load_dwordx2 v[150:151], v[54:55], off nt
    v_lshl_add_u64 v[54:55], v[54:55], 0, s[20:21]
    global_load_dwordx2 v[152:153], v[54:55], off nt
    v_lshl_add_u64 v[54:55], v[54:55], 0, s[20:21]
    global_load_dwordx2 v[154:155], v[54:55], off nt
    v_lshl_add_u64 v[54:55], v[54:55], 0, s[20:21]
    global_load_dwordx2 v[156:157], v[54:55], off nt
    v_lshl_add_u64 v[54:55], v[54:55], 0, s[20:21]
    global_load_dwordx2 v[158:159], v[54:55], off nt
    v_lshl_add_u64 v[54:55], v[54:55], 0, s[22:23]
    global_load_dwordx2 v[160:161], v[54:55], off nt
    v_lshl_add_u64 v[54:55], v[54:55], 0, s[20:21]
    global_load_dwordx2 v[162:163], v[54:55], off nt
    v_lshl_add_u64 v[54:55], v[54:55], 0, s[20:21]
    global_load_dwordx2 v[164:165], v[54:55], off nt
    v_lshl_add_u64 v[54:55], v[54:55], 0, s[20:21]
    global_load_dwordx2 v[166:167], v[54:55], off nt
    v_lshl_add_u64 v[54:55], v[54:55], 0, s[20:21]
    global_load_dwordx2 v[168:169], v[54:55], off nt
    v_lshl_add_u64 v[54:55], v[54:55], 0, s[20:21]
    global_load_dwordx2 v[170:171], v[54:55], off nt
    v_lshl_add_u64 v[54:55], v[54:55], 0, s[20:21]
    global_load_dwordx2 v[172:173], v[54:55], off nt
    v_lshl_add_u64 v[54:55], v[54:55], 0, s[20:21]
    global_load_dwordx2 v[174:175], v[54:55], off nt
    v_lshl_add_u64 v[54:55], v[54:55], 0, s[22:23]
    global_load_dwordx2 v[176:177], v[54:55], off nt
    v_lshl_add_u64 v[54:55], v[54:55], 0, s[20:21]
    global_load_dwordx2 v[178:179], v[54:55], off nt
    v_lshl_add_u64 v[54:55], v[54:55], 0, s[20:21]
    global_load_dwordx2 v[180:181], v[54:55], off nt
    v_lshl_add_u64 v[54:55], v[54:55], 0, s[20:21]
    global_load_dwordx2 v[182:183], v[54:55], off nt
    v_lshl_add_u64 v[54:55], v[54:55], 0, s[20:21]
    global_load_dwordx2 v[184:185], v[54:55], off nt
    v_lshl_add_u64 v[54:55], v[54:55], 0, s[20:21]
    global_load_dwordx2 v[186:187], v[54:55], off nt
    v_lshl_add_u64 v[54:55], v[54:55], 0, s[20:21]
    global_load_dwordx2 v[188:189], v[54:55], off nt
    v_lshl_add_u64 v[54:55], v[54:55], 0, s[20:21]
    global_load_dwordx2 v[190:191], v[54:55], off nt
    v_lshl_add_u64 v[54:55], v[54:55], 0, s[22:23]
    s_cmp_ge_u32 s9, 2
    s_cbranch_scc1 W5_8
    global_load_dwordx2 v[192:193], v[54:55], off nt
    v_lshl_add_u64 v[54:55], v[54:55], 0, s[20:21]
    global_load_dwordx2 v[194:195], v[54:55], off nt
    v_lshl_add_u64 v[54:55], v[54:55], 0, s[20:21]
    global_load_dwordx2 v[196:197], v[54:55], off nt
    v_lshl_add_u64 v[54:55], v[54:55], 0, s[20:21]
    global_load_dwordx2 v[198:199], v[54:55], off nt
    v_lshl_add_u64 v[54:55], v[54:55], 0, s[20:21]
    global_load_dwordx2 v[200:201], v[54:55], off nt
    v_lshl_add_u64 v[54:55], v[54:55], 0, s[20:21]
    global_load_dwordx2 v[202:203], v[54:55], off nt
    v_lshl_add_u64 v[54:55], v[54:55], 0, s[20:21]
    global_load_dwordx2 v[204:205], v[54:55], off nt
    v_lshl_add_u64 v[54:55], v[54:55], 0, s[20:21]
    global_load_dwordx2 v[206:207], v[54:55], off nt
W5_8:
CONV_JOIN:
    v_and_b32 v56, 3, v0
    v_lshrrev_b32 v57, 2, v0
    s_mov_b32 s20, 31296
    v_mul_u32_u24 v58, s20, v56
    v_lshl_add_u32 v58, v57, 4, v58
    s_movk_i32 s20, 9216
    v_mul_u32_u24 v59, s20, v57
    v_lshl_add_u32 v59, v56, 4, v59
    s_lshl_b32 s20, s6, 6
    s_add_u32 s20, s20, 1048576
    v_add_u32 v59, s20, v59
    v_add_u32 v60, 1179648, v59
    s_waitcnt lgkmcnt(0)
    s_barrier
    ds_read_b128 v[64:67], v58
    ds_read_b128 v[68:71], v58 offset:2048
    s_waitcnt lgkmcnt(1)
    global_store_dwordx4 v59, v[64:67], s[68:69] sc1
    s_waitcnt lgkmcnt(0)
    global_store_dwordx4 v60, v[68:71], s[68:69] sc1
    s_cmp_eq_u32 s13, 0
    s_cbranch_scc1 CJ_NM
    v_lshrrev_b32 v53, 4, v1
    v_and_b32 v52, 15, v1
    v_lshlrev_b32 v52, 3, v52
    s_movk_i32 s21, 1152
    v_mad_u32_u24 v52, v53, s21, v52
    s_mul_i32 s20, s8, 36864
    s_lshl_b32 s21, s9, 7
    s_add_u32 s20, s20, s21
    v_add_u32 v52, s20, v52
    global_load_dwordx2 v[208:209], v52, s[58:59] nt
    global_load_dwordx2 v[224:225], v52, s[58:59] offset:512 nt
    v_add_u32 v52, 4608, v52
    global_load_dwordx2 v[210:211], v52, s[58:59] nt
    global_load_dwordx2 v[226:227], v52, s[58:59] offset:512 nt
    v_add_u32 v52, 4608, v52
    global_load_dwordx2 v[212:213], v52, s[58:59] nt
    global_load_dwordx2 v[228:229], v52, s[58:59] offset:512 nt
    v_add_u32 v52, 4608, v52
    global_load_dwordx2 v[214:215], v52, s[58:59] nt
    global_load_dwordx2 v[230:231], v52, s[58:59] offset:512 nt
    v_add_u32 v52, 4608, v52
    global_load_dwordx2 v[216:217], v52, s[58:59] nt
    global_load_dwordx2 v[232:233], v52, s[58:59] offset:512 nt
    v_add_u32 v52, 4608, v52
    global_load_dwordx2 v[218:219], v52, s[58:59] nt
    global_load_dwordx2 v[234:235], v52, s[58:59] offset:512 nt
    v_add_u32 v52, 4608, v52
    global_load_dwordx2 v[220:221], v52, s[58:59] nt
    global_load_dwordx2 v[236:237], v52, s[58:59] offset:512 nt
    v_add_u32 v52, 4608, v52
    global_load_dwordx2 v[222:223], v52, s[58:59] nt
    global_load_dwordx2 v[238:239], v52, s[58:59] offset:512 nt
    s_cmp_lg_u32 s9, 3
    s_cbranch_scc1 W8_9
    global_load_dwordx2 v[254:255], v52, s[58:59] offset:640 nt
    v_subrev_u32 v52, 4608, v52
    global_load_dwordx2 v[252:253], v52, s[58:59] offset:640 nt
    v_subrev_u32 v52, 4608, v52
    global_load_dwordx2 v[250:251], v52, s[58:59] offset:640 nt
    v_subrev_u32 v52, 4608, v52
    global_load_dwordx2 v[248:249], v52, s[58:59] offset:640 nt
    v_subrev_u32 v52, 4608, v52
    global_load_dwordx2 v[246:247], v52, s[58:59] offset:640 nt
    v_subrev_u32 v52, 4608, v52
    global_load_dwordx2 v[244:245], v52, s[58:59] offset:640 nt
    v_subrev_u32 v52, 4608, v52
    global_load_dwordx2 v[242:243], v52, s[58:59] offset:640 nt
    v_subrev_u32 v52, 4608, v52
    global_load_dwordx2 v[240:241], v52, s[58:59] offset:640 nt
W8_9:
    s_waitcnt vmcnt(0)
    s_mov_b32 s20, 0x05040100
    s_mov_b32 s21, 0x07060302
    v_perm_b32 v112, v130, v128, s20
    v_perm_b32 v116, v130, v128, s21
    v_perm_b32 v120, v131, v129, s20
    v_perm_b32 v124, v131, v129, s21
    v_perm_b32 v113, v134, v132, s20
    v_perm_b32 v117, v134, v132, s21
    v_perm_b32 v121, v135, v133, s20
    v_perm_b32 v125, v135, v133, s21
    v_perm_b32 v114, v138, v136, s20
    v_perm_b32 v118, v138, v136, s21
    v_perm_b32 v122, v139, v137, s20
    v_perm_b32 v126, v139, v137, s21
    v_perm_b32 v115, v142, v140, s20
    v_perm_b32 v119, v142, v140, s21
    v_perm_b32 v123, v143, v141, s20
    v_perm_b32 v127, v143, v141, s21
    v_perm_b32 v128, v146, v144, s20
    v_perm_b32 v132, v146, v144, s21
    v_perm_b32 v136, v147, v145, s20
    v_perm_b32 v140, v147, v145, s21
    v_perm_b32 v129, v150, v148, s20
    v_perm_b32 v133, v150, v148, s21
    v_perm_b32 v137, v151, v149, s20
    v_perm_b32 v141, v151, v149, s21
    v_perm_b32 v130, v154, v152, s20
    v_perm_b32 v134, v154, v152, s21
    v_perm_b32 v138, v155, v153, s20
    v_perm_b32 v142, v155, v153, s21
    v_perm_b32 v131, v158, v156, s20
    v_perm_b32 v135, v158, v156, s21
    v_perm_b32 v139, v159, v157, s20
    v_perm_b32 v143, v159, v157, s21
    v_perm_b32 v144, v162, v160, s20
    v_perm_b32 v148, v162, v160, s21
    v_perm_b32 v152, v163, v161, s20
    v_perm_b32 v156, v163, v161, s21
    v_perm_b32 v145, v166, v164, s20
    v_perm_b32 v149, v166, v164, s21
    v_perm_b32 v153, v167, v165, s20
    v_perm_b32 v157, v167, v165, s21
    v_perm_b32 v146, v170, v168, s20
    v_perm_b32 v150, v170, v168, s21
    v_perm_b32 v154, v171, v169, s20
    v_perm_b32 v158, v171, v169, s21
    v_perm_b32 v147, v174, v172, s20
    v_perm_b32 v151, v174, v172, s21
    v_perm_b32 v155, v175, v173, s20
    v_perm_b32 v159, v175, v173, s21
    v_perm_b32 v160, v178, v176, s20
    v_perm_b32 v164, v178, v176, s21
    v_perm_b32 v168, v179, v177, s20
    v_perm_b32 v172, v179, v177, s21
    v_perm_b32 v161, v182, v180, s20
    v_perm_b32 v165, v182, v180, s21
    v_perm_b32 v169, v183, v181, s20
    v_perm_b32 v173, v183, v181, s21
    v_perm_b32 v162, v186, v184, s20
    v_perm_b32 v166, v186, v184, s21
    v_perm_b32 v170, v187, v185, s20
    v_perm_b32 v174, v187, v185, s21
    v_perm_b32 v163, v190, v188, s20
    v_perm_b32 v167, v190, v188, s21
    v_perm_b32 v171, v191, v189, s20
    v_perm_b32 v175, v191, v189, s21
    v_perm_b32 v176, v194, v192, s20
    v_perm_b32 v180, v194, v192, s21
    v_perm_b32 v184, v195, v193, s20
    v_perm_b32 v188, v195, v193, s21
    v_perm_b32 v177, v198, v196, s20
    v_perm_b32 v181, v198, v196, s21
    v_perm_b32 v185, v199, v197, s20
    v_perm_b32 v189, v199, v197, s21
    v_perm_b32 v178, v202, v200, s20
    v_perm_b32 v182, v202, v200, s21
    v_perm_b32 v186, v203, v201, s20
    v_perm_b32 v190, v203, v201, s21
    v_perm_b32 v179, v206, v204, s20
    v_perm_b32 v183, v206, v204, s21
    v_perm_b32 v187, v207, v205, s20
    v_perm_b32 v191, v207, v205, s21
    v_perm_b32 v192, v210, v208, s20
    v_perm_b32 v196, v210, v208, s21
    v_perm_b32 v200, v211, v209, s20
    v_perm_b32 v204, v211, v209, s21
    v_perm_b32 v193, v214, v212, s20
    v_perm_b32 v197, v214, v212, s21
    v_perm_b32 v201, v215, v213, s20
    v_perm_b32 v205, v215, v213, s21
    v_perm_b32 v194, v218, v216, s20
    v_perm_b32 v198, v218, v216, s21
    v_perm_b32 v202, v219, v217, s20
    v_perm_b32 v206, v219, v217, s21
    v_perm_b32 v195, v222, v220, s20
    v_perm_b32 v199, v222, v220, s21
    v_perm_b32 v203, v223, v221, s20
    v_perm_b32 v207, v223, v221, s21
    v_perm_b32 v208, v226, v224, s20
    v_perm_b32 v212, v226, v224, s21
    v_perm_b32 v216, v227, v225, s20
    v_perm_b32 v220, v227, v225, s21
    v_perm_b32 v209, v230, v228, s20
    v_perm_b32 v213, v230, v228, s21
    v_perm_b32 v217, v231, v229, s20
    v_perm_b32 v221, v231, v229, s21
    v_perm_b32 v210, v234, v232, s20
    v_perm_b32 v214, v234, v232, s21
    v_perm_b32 v218, v235, v233, s20
    v_perm_b32 v222, v235, v233, s21
    v_perm_b32 v211, v238, v236, s20
    v_perm_b32 v215, v238, v236, s21
    v_perm_b32 v219, v239, v237, s20
    v_perm_b32 v223, v239, v237, s21
    v_perm_b32 v224, v242, v240, s20
    v_perm_b32 v228, v242, v240, s21
    v_perm_b32 v232, v243, v241, s20
    v_perm_b32 v236, v243, v241, s21
    v_perm_b32 v225, v246, v244, s20
    v_perm_b32 v229, v246, v244, s21
    v_perm_b32 v233, v247, v245, s20
    v_perm_b32 v237, v247, v245, s21
    v_perm_b32 v226, v250, v248, s20
    v_perm_b32 v230, v250, v248, s21
    v_perm_b32 v234, v251, v249, s20
    v_perm_b32 v238, v251, v249, s21
    v_perm_b32 v227, v254, v252, s20
    v_perm_b32 v231, v254, v252, s21
    v_perm_b32 v235, v255, v253, s20
    v_perm_b32 v239, v255, v253, s21
CJ_NM:
    s_waitcnt vmcnt(2)
MC_10:
    v_or_b32 v53, s12, v24
    v_or_b32 v54, s12, v18
    v_or_b32 v55, s12, v30
    v_max3_u32 v52, v20, v21, v22
    v_max3_u32 v52, v52, v23, v14
    v_max3_u32 v52, v52, v15, v16
    v_max3_u32 v52, v52, v17, v26
    v_max3_u32 v52, v52, v27, v28
    v_max3_u32 v52, v52, v29, v53
    v_max3_u32 v52, v52, v54, v55
    v_cmp_eq_u32 vcc, -1, v52
    s_cbranch_vccz MCD_11
    v_add_u32 v52, 8192, v7
    v_add_u32 v53, 8192, v13
    v_add_u32 v54, 3456, v52
    v_add_u32 v55, 3456, v53
    global_load_dwordx4 v[20:23], v54, s[68:69] sc1
    global_load_ushort v24, v55, s[68:69] sc1
    v_add_u32 v54, 4608, v52
    v_add_u32 v55, 4608, v53
    global_load_dwordx4 v[14:17], v54, s[68:69] sc1
    global_load_ushort v18, v55, s[68:69] sc1
    v_add_u32 v54, 5760, v52
    v_add_u32 v55, 5760, v53
    global_load_dwordx4 v[26:29], v54, s[68:69] sc1
    global_load_ushort v30, v55, s[68:69] sc1
    s_waitcnt vmcnt(0)
    s_sub_u32 s10, s10, 1
    s_cbranch_scc1 EXIT
    s_branch MC_10
MCD_11:
    v_lshlrev_b32 v32, 16, v14
    v_and_b32 v33, s12, v14
    v_lshlrev_b32 v34, 16, v15
    v_and_b32 v35, s12, v15
    v_lshlrev_b32 v36, 16, v16
    v_and_b32 v37, s12, v16
    v_lshlrev_b32 v38, 16, v17
    v_and_b32 v39, s12, v17
    v_lshlrev_b32 v40, 16, v18
    v_lshlrev_b32 v42, 16, v20
    v_and_b32 v43, s12, v20
    v_lshlrev_b32 v44, 16, v21
    v_and_b32 v45, s12, v21
    v_lshlrev_b32 v46, 16, v22
    v_and_b32 v47, s12, v22
    v_lshlrev_b32 v48, 16, v23
    v_and_b32 v49, s12, v23
    v_lshlrev_b32 v50, 16, v24
    v_pk_add_f32 v[32:33], v[32:33], 1.0 op_sel_hi:[1,0]
    v_pk_add_f32 v[34:35], v[34:35], 1.0 op_sel_hi:[1,0]
    v_pk_add_f32 v[36:37], v[36:37], 1.0 op_sel_hi:[1,0]
    v_pk_add_f32 v[38:39], v[38:39], 1.0 op_sel_hi:[1,0]
    v_add_f32 v40, 1.0, v40
    v_cvt_pk_bf16_f32 v52, v32, v33
    v_cvt_pk_bf16_f32 v53, v34, v35
    v_cvt_pk_bf16_f32 v54, v36, v37
    v_cvt_pk_bf16_f32 v55, v38, v39
    v_cvt_pk_bf16_f32 v56, v40, v40
    v_lshlrev_b32 v32, 16, v52
    v_and_b32 v33, s12, v52
    v_lshlrev_b32 v34, 16, v53
    v_and_b32 v35, s12, v53
    v_lshlrev_b32 v36, 16, v54
    v_and_b32 v37, s12, v54
    v_lshlrev_b32 v38, 16, v55
    v_and_b32 v39, s12, v55
    v_lshlrev_b32 v40, 16, v56
    s_waitcnt vmcnt(0)
    s_branch GPOLL
NONCONV:
    s_waitcnt lgkmcnt(0)
    s_cmp_lt_u32 s3, 4
    s_cbranch_scc1 NC_J0
    s_lshl_b32 s20, s2, 2
    s_add_u32 s20, s20, s9
    s_mul_i32 s20, s20, 2304
    v_add_u32 v58, s20, v7
    v_add_u32 v59, s20, v13
    global_load_dwordx4 v[64:67], v58, s[36:37] nt
    global_load_ushort v68, v59, s[36:37] nt
    global_load_dwordx4 v[70:73], v58, s[36:37] offset:1152 nt
    global_load_ushort v74, v59, s[36:37] offset:1152 nt
NC_J0:
    s_cmp_lt_u32 s7, 108
    s_cbranch_scc1 NC_MOD1
    s_waitcnt vmcnt(0)
    s_branch NC_NOMOD1
NC_MOD1:
    v_lshrrev_b32 v52, 2, v1
    s_mul_i32 s20, s3, 72
    v_add_u32 v52, s20, v52
    v_lshlrev_b32 v53, 1, v52
    s_movk_i32 s20, 6912
    v_mul_u32_u24 v52, s20, v52
    v_and_b32 v54, 3, v1
    s_lshl_b32 s21, s7, 6
    v_lshl_add_u32 v54, v54, 4, s21
    v_add_u32 v52, v52, v54
    v_mov_b32 v128, 0
    v_mov_b32 v129, 0
    v_mov_b32 v130, 0
    v_mov_b32 v131, 0
    v_mov_b32 v132, 0
    v_mov_b32 v136, 0
    global_load_dwordx4 v[112:115], v52, s[62:63] nt
    v_add_u32 v52, 110592, v52
    global_load_dwordx4 v[116:119], v52, s[62:63] nt
    v_add_u32 v52, 110592, v52
    global_load_dwordx4 v[120:123], v52, s[62:63] nt
    v_add_u32 v52, 110592, v52
    global_load_dwordx4 v[124:127], v52, s[62:63] nt
    v_add_u32 v52, 110592, v52
    s_mov_b32 exec_hi, 0
    global_load_dwordx4 v[128:131], v52, s[62:63] nt
    global_load_ushort v136, v53, s[60:61] offset:128
    s_mov_b32 exec_hi, -1
    global_load_ushort v132, v53, s[60:61]
    global_load_ushort v133, v53, s[60:61] offset:32
    global_load_ushort v134, v53, s[60:61] offset:64
    global_load_ushort v135, v53, s[60:61] offset:96
NC_NOMOD1:
    s_barrier
    s_cmp_lt_u32 s3, 4
    s_cbranch_scc1 NC_A1
    s_waitcnt vmcnt(10)
    s_mul_i32 s18, s9, 2304
    s_add_u32 s18, s18, 144896
    v_add_u32 v58, s18, v7
    v_add_u32 v59, s18, v13
    ds_write_b128 v58, v[64:67]
    ds_write_b16 v59, v68
    ds_write_b128 v58, v[70:73] offset:1152
    ds_write_b16 v59, v74 offset:1152
    v_lshlrev_b32 v80, 16, v64
    v_and_b32 v81, s12, v64
    v_lshlrev_b32 v82, 16, v65
    v_and_b32 v83, s12, v65
    v_lshlrev_b32 v84, 16, v66
    v_and_b32 v85, s12, v66
    v_lshlrev_b32 v86, 16, v67
    v_and_b32 v87, s12, v67
    v_lshlrev_b32 v88, 16, v68
    v_lshlrev_b32 v90, 16, v70
    v_and_b32 v91, s12, v70
    v_lshlrev_b32 v92, 16, v71
    v_and_b32 v93, s12, v71
    v_lshlrev_b32 v94, 16, v72
    v_and_b32 v95, s12, v72
    v_lshlrev_b32 v96, 16, v73
    v_and_b32 v97, s12, v73
    v_lshlrev_b32 v98, 16, v74
    v_readfirstlane_b32 s70, v80
    s_nop 1
    v_subrev_f32 v80, s70, v80
    v_subrev_f32 v81, s70, v81
    v_subrev_f32 v82, s70, v82
    v_subrev_f32 v83, s70, v83
    v_subrev_f32 v84, s70, v84
    v_subrev_f32 v85, s70, v85
    v_subrev_f32 v86, s70, v86
    v_subrev_f32 v87, s70, v87
    v_subrev_f32 v88, s70, v88
    v_pk_add_f32 v[100:101], v[80:81], v[82:83]
    v_pk_mul_f32 v[102:103], v[80:81], v[80:81]
    v_pk_add_f32 v[100:101], v[100:101], v[84:85]
    v_pk_fma_f32 v[102:103], v[82:83], v[82:83], v[102:103]
    v_pk_add_f32 v[100:101], v[100:101], v[86:87]
    v_pk_fma_f32 v[102:103], v[84:85], v[84:85], v[102:103]
    v_add_f32 v100, v100, v88
    v_pk_fma_f32 v[102:103], v[86:87], v[86:87], v[102:103]
    v_add_f32 v100, v100, v101
    v_fmac_f32 v102, v88, v88
    v_add_f32 v102, v102, v103
    v_readfirstlane_b32 s71, v90
    s_nop 1
    v_subrev_f32 v90, s71, v90
    v_subrev_f32 v91, s71, v91
    v_subrev_f32 v92, s71, v92
    v_subrev_f32 v93, s71, v93
    v_subrev_f32 v94, s71, v94
    v_subrev_f32 v95, s71, v95
    v_subrev_f32 v96, s71, v96
    v_subrev_f32 v97, s71, v97
    v_subrev_f32 v98, s71, v98
    v_pk_add_f32 v[104:105], v[90:91], v[92:93]
    v_pk_mul_f32 v[106:107], v[90:91], v[90:91]
    v_pk_add_f32 v[104:105], v[104:105], v[94:95]
    v_pk_fma_f32 v[106:107], v[92:93], v[92:93], v[106:107]
    v_pk_add_f32 v[104:105], v[104:105], v[96:97]
    v_pk_fma_f32 v[106:107], v[94:95], v[94:95], v[106:107]
    v_add_f32 v104, v104, v98
    v_pk_fma_f32 v[106:107], v[96:97], v[96:97], v[106:107]
    v_add_f32 v104, v104, v105
    v_fmac_f32 v106, v98, v98
    v_add_f32 v106, v106, v107
    v_permlane32_swap_b32 v100, v104
    s_nop 0
    v_permlane32_swap_b32 v102, v106
    v_add_f32 v100, v100, v104
    v_add_f32 v102, v102, v106
    s_nop 1
    v_permlane16_swap_b32 v100, v102
    v_add_f32 v100, v100, v102
    s_nop 1
    v_add_f32_dpp v100, v100, v100 row_ror:8 row_mask:0xf bank_mask:0xf
    s_nop 1
    v_add_f32_dpp v100, v100, v100 row_ror:4 row_mask:0xf bank_mask:0xf
    s_nop 1
    v_add_f32_dpp v100, v100, v100 row_ror:2 row_mask:0xf bank_mask:0xf
    s_nop 1
    v_add_f32_dpp v100, v100, v100 row_ror:1 row_mask:0xf bank_mask:0xf
    v_mov_b32 v102, v100
    s_nop 1
    v_permlane16_swap_b32 v100, v102
    v_mov_b32 v104, s70
    v_mov_b32 v105, s71
    v_cmp_gt_u32 vcc, 32, v1
    s_nop 1
    v_cndmask_b32 v104, v105, v104, vcc
    v_mul_f32 v100, 0x3ae38e39, v100
    v_mul_f32 v102, 0x3ae38e39, v102
    v_add_f32 v105, v104, v100
    v_fma_f32 v107, -v100, v100, v102
    v_max_f32 v107, 0, v107
    v_cvt_pk_bf16_f32 v107, v107, v107
    v_and_b32 v107, s12, v107
    v_add_f32 v107, 0x3727c5ac, v107
    v_cvt_pk_bf16_f32 v107, v107, v107
    v_and_b32 v107, s12, v107
    v_sqrt_f32 v106, v107
    v_cvt_pk_bf16_f32 v105, v105, v105
    v_and_b32 v105, s12, v105
    v_cvt_pk_bf16_f32 v106, v106, v106
    v_and_b32 v106, s12, v106
    v_rcp_f32 v100, v106
    v_sub_f32 v101, v104, v105
    v_mul_f32 v101, v101, v100
    v_mov_b32 v102, v100
    v_mov_b32 v103, v101
    s_nop 0
    v_permlane32_swap_b32 v100, v102
    v_permlane32_swap_b32 v101, v103
    s_mul_i32 s18, s9, 2304
    s_add_u32 s18, s18, 154112
    v_lshl_add_u32 v58, v1, 5, s18
    v_lshl_add_u32 v59, v1, 2, s18
    s_cmp_lg_u32 s3, 4
    s_cbranch_scc1 IW_12
    s_load_dwordx16 s[20:35], s[66:67], 0
    s_load_dwordx8 s[40:47], s[66:67], 64
    s_load_dwordx4 s[16:19], s[66:67], 96
    s_load_dwordx2 s[38:39], s[66:67], 112
    s_load_dwordx2 s[48:49], s[66:67], 120
    s_load_dwordx2 s[98:99], s[66:67], 128
    s_load_dwordx2 s[100:101], s[66:67], 136
IW_12:
    v_pk_fma_f32 v[80:81], v[80:81], v[100:101], v[100:101] op_sel:[0,0,1] op_sel_hi:[1,0,1]
    v_pk_fma_f32 v[82:83], v[82:83], v[100:101], v[100:101] op_sel:[0,0,1] op_sel_hi:[1,0,1]
    v_pk_fma_f32 v[84:85], v[84:85], v[100:101], v[100:101] op_sel:[0,0,1] op_sel_hi:[1,0,1]
    v_pk_fma_f32 v[86:87], v[86:87], v[100:101], v[100:101] op_sel:[0,0,1] op_sel_hi:[1,0,1]
    v_fma_f32 v88, v88, v100, v101
    v_pk_fma_f32 v[90:91], v[90:91], v[102:103], v[102:103] op_sel:[0,0,1] op_sel_hi:[1,0,1]
    v_pk_fma_f32 v[92:93], v[92:93], v[102:103], v[102:103] op_sel:[0,0,1] op_sel_hi:[1,0,1]
    v_pk_fma_f32 v[94:95], v[94:95], v[102:103], v[102:103] op_sel:[0,0,1] op_sel_hi:[1,0,1]
    v_pk_fma_f32 v[96:97], v[96:97], v[102:103], v[102:103] op_sel:[0,0,1] op_sel_hi:[1,0,1]
    v_fma_f32 v98, v98, v102, v103
    v_cvt_pk_bf16_f32 v64, v80, v90
    v_cvt_pk_bf16_f32 v65, v81, v91
    v_cvt_pk_bf16_f32 v66, v82, v92
    v_cvt_pk_bf16_f32 v67, v83, v93
    v_cvt_pk_bf16_f32 v68, v84, v94
    v_cvt_pk_bf16_f32 v69, v85, v95
    v_cvt_pk_bf16_f32 v70, v86, v96
    v_cvt_pk_bf16_f32 v71, v87, v97
    v_cvt_pk_bf16_f32 v72, v88, v98
    ds_write_b128 v58, v[64:67]
    ds_write_b128 v58, v[68:71] offset:16
    ds_write_b32 v59, v72 offset:2048
    s_lshl_b32 s14, s9, 2
    s_add_u32 s14, s14, 143456
    v_mov_b32 v58, s14
    v_mov_b32 v59, 0
    v_and_b32 v104, 3, v1
    v_lshlrev_b32 v100, 4, v104
    v_lshlrev_b32 v104, 2, v104
    v_add_u32 v104, 143456, v104
    v_and_b32 v52, 255, v0
    v_lshrrev_b32 v101, 2, v52
    v_lshl_add_u32 v101, v101, 14, v100
    s_lshl_b32 s14, s2, 6
    s_add_u32 s14, s14, 10485760
    v_add_u32 v101, s14, v101
    v_add_u32 v102, 1048576, v101
    v_and_b32 v103, 15, v1
    v_lshl_add_u32 v103, s9, 4, v103
    v_lshrrev_b32 v99, 2, v103
    v_lshl_add_u32 v99, v99, 14, v100
    v_add_u32 v99, s14, v99
    v_add_u32 v99, 2097152, v99
    v_lshlrev_b32 v103, 2, v103
    v_add_u32 v103, 156160, v103
    v_lshlrev_b32 v100, 2, v52
    v_add_u32 v100, 154112, v100
    s_cmp_lg_u32 s3, 4
    s_cbranch_scc1 IFD_16
    s_waitcnt lgkmcnt(0)
    s_and_b64 s[20:21], s[20:21], s[22:23]
    s_and_b64 s[20:21], s[20:21], s[24:25]
    s_and_b64 s[20:21], s[20:21], s[26:27]
    s_and_b64 s[20:21], s[20:21], s[28:29]
    s_and_b64 s[20:21], s[20:21], s[30:31]
    s_and_b64 s[20:21], s[20:21], s[32:33]
    s_and_b64 s[20:21], s[20:21], s[34:35]
    s_and_b64 s[20:21], s[20:21], s[16:17]
    s_and_b64 s[20:21], s[20:21], s[18:19]
    s_and_b64 s[20:21], s[20:21], s[38:39]
    s_and_b64 s[20:21], s[20:21], s[40:41]
    s_and_b64 s[20:21], s[20:21], s[42:43]
    s_and_b64 s[20:21], s[20:21], s[44:45]
    s_and_b64 s[20:21], s[20:21], s[46:47]
    s_and_b64 s[20:21], s[20:21], s[48:49]
    s_and_b64 s[20:21], s[20:21], s[98:99]
    s_and_b64 s[20:21], s[20:21], s[100:101]
    s_and_b32 s20, s20, s21
    s_cmp_eq_u32 s20, -1
    s_cbranch_scc1 IFD_16
    v_min_u32 v77, 35, v1
    v_lshlrev_b32 v77, 2, v77
IF_15:
    global_load_dword v76, v77, s[66:67] sc1
    s_waitcnt vmcnt(0)
    v_cmp_ne_u32 vcc, -1, v76
    s_cbranch_vccz IFD_16
    s_sub_u32 s10, s10, 1
    s_cbranch_scc1 EXIT
    s_branch IF_15
IFD_16:
    ds_write_b32 v58, v59
SL_13:
    ds_read_b32 v105, v104
    s_waitcnt lgkmcnt(0)
    v_cmp_eq_u32 vcc, -1, v105
    s_cbranch_vccz SLD_14
    s_sub_u32 s10, s10, 1
    s_cbranch_scc1 EXIT
    s_branch SL_13
SLD_14:
    ds_read_b32 v80, v100 offset:0
    ds_read_b32 v81, v100 offset:2304
    ds_read_b32 v82, v100 offset:4608
    ds_read_b32 v83, v100 offset:6912
    ds_read_b32 v84, v100 offset:1024
    ds_read_b32 v85, v100 offset:3328
    ds_read_b32 v86, v100 offset:5632
    ds_read_b32 v87, v100 offset:7936
    ds_read_b32 v88, v103 offset:0
    ds_read_b32 v89, v103 offset:2304
    ds_read_b32 v90, v103 offset:4608
    ds_read_b32 v91, v103 offset:6912
    s_waitcnt lgkmcnt(8)
    global_store_dwordx4 v101, v[80:83], s[68:69] sc1
    s_waitcnt lgkmcnt(4)
    global_store_dwordx4 v102, v[84:87], s[68:69] sc1
    s_waitcnt lgkmcnt(0)
    s_mov_b64 exec, 0xffff
    global_store_dwordx4 v99, v[88:91], s[68:69] sc1
    s_mov_b64 exec, -1
NC_A1:
    s_load_dwordx16 s[20:35], s[66:67], 192
    s_cmp_ge_u32 s7, 108
    s_cbranch_scc1 NC_NOMOD2
    s_waitcnt vmcnt(3)
    s_cmp_ge_u32 s3, 4
    s_cbranch_scc1 NC_J1
    s_waitcnt vmcnt(0)
NC_J1:
    v_lshlrev_b32 v132, 16, v132
    v_mul_f32 v64, 0xbfb8aa3b, v132
    v_exp_f32 v64, v64
    v_lshlrev_b32 v133, 16, v133
    v_mul_f32 v65, 0xbfb8aa3b, v133
    v_exp_f32 v65, v65
    v_lshlrev_b32 v134, 16, v134
    v_mul_f32 v66, 0xbfb8aa3b, v134
    v_exp_f32 v66, v66
    v_lshlrev_b32 v135, 16, v135
    v_mul_f32 v67, 0xbfb8aa3b, v135
    v_exp_f32 v67, v67
    v_lshlrev_b32 v136, 16, v136
    v_mul_f32 v68, 0xbfb8aa3b, v136
    v_exp_f32 v68, v68
    v_add_f32 v64, 1.0, v64
    v_rcp_f32 v64, v64
    v_add_f32 v65, 1.0, v65
    v_rcp_f32 v65, v65
    v_add_f32 v66, 1.0, v66
    v_rcp_f32 v66, v66
    v_add_f32 v67, 1.0, v67
    v_rcp_f32 v67, v67
    v_add_f32 v68, 1.0, v68
    v_rcp_f32 v68, v68
    v_mul_f32 v64, v132, v64
    v_mul_f32 v65, v133, v65
    v_mul_f32 v66, v134, v66
    v_mul_f32 v67, v135, v67
    v_mul_f32 v68, v136, v68
    v_cvt_pk_bf16_f32 v80, v64, v64
    v_and_b32 v80, s12, v80
    v_cvt_pk_bf16_f32 v82, v65, v65
    v_and_b32 v82, s12, v82
    v_cvt_pk_bf16_f32 v84, v66, v66
    v_and_b32 v84, s12, v84
    v_cvt_pk_bf16_f32 v86, v67, v67
    v_and_b32 v86, s12, v86
    v_cvt_pk_bf16_f32 v88, v68, v68
    v_and_b32 v88, s12, v88
    v_lshlrev_b32 v64, 16, v112
    v_and_b32 v65, s12, v112
    v_lshlrev_b32 v66, 16, v113
    v_and_b32 v67, s12, v113
    v_lshlrev_b32 v68, 16, v114
    v_and_b32 v69, s12, v114
    v_lshlrev_b32 v70, 16, v115
    v_and_b32 v71, s12, v115
    v_pk_mul_f32 v[140:141], v[64:65], v[80:81] op_sel_hi:[1,0]
    v_pk_mul_f32 v[142:143], v[66:67], v[80:81] op_sel_hi:[1,0]
    v_pk_mul_f32 v[144:145], v[68:69], v[80:81] op_sel_hi:[1,0]
    v_pk_mul_f32 v[146:147], v[70:71], v[80:81] op_sel_hi:[1,0]
    v_lshlrev_b32 v64, 16, v116
    v_and_b32 v65, s12, v116
    v_lshlrev_b32 v66, 16, v117
    v_and_b32 v67, s12, v117
    v_lshlrev_b32 v68, 16, v118
    v_and_b32 v69, s12, v118
    v_lshlrev_b32 v70, 16, v119
    v_and_b32 v71, s12, v119
    v_pk_fma_f32 v[140:141], v[64:65], v[82:83], v[140:141] op_sel_hi:[1,0,1]
    v_pk_fma_f32 v[142:143], v[66:67], v[82:83], v[142:143] op_sel_hi:[1,0,1]
    v_pk_fma_f32 v[144:145], v[68:69], v[82:83], v[144:145] op_sel_hi:[1,0,1]
    v_pk_fma_f32 v[146:147], v[70:71], v[82:83], v[146:147] op_sel_hi:[1,0,1]
    v_lshlrev_b32 v64, 16, v120
    v_and_b32 v65, s12, v120
    v_lshlrev_b32 v66, 16, v121
    v_and_b32 v67, s12, v121
    v_lshlrev_b32 v68, 16, v122
    v_and_b32 v69, s12, v122
    v_lshlrev_b32 v70, 16, v123
    v_and_b32 v71, s12, v123
    v_pk_fma_f32 v[140:141], v[64:65], v[84:85], v[140:141] op_sel_hi:[1,0,1]
    v_pk_fma_f32 v[142:143], v[66:67], v[84:85], v[142:143] op_sel_hi:[1,0,1]
    v_pk_fma_f32 v[144:145], v[68:69], v[84:85], v[144:145] op_sel_hi:[1,0,1]
    v_pk_fma_f32 v[146:147], v[70:71], v[84:85], v[146:147] op_sel_hi:[1,0,1]
    v_lshlrev_b32 v64, 16, v124
    v_and_b32 v65, s12, v124
    v_lshlrev_b32 v66, 16, v125
    v_and_b32 v67, s12, v125
    v_lshlrev_b32 v68, 16, v126
    v_and_b32 v69, s12, v126
    v_lshlrev_b32 v70, 16, v127
    v_and_b32 v71, s12, v127
    v_pk_fma_f32 v[140:141], v[64:65], v[86:87], v[140:141] op_sel_hi:[1,0,1]
    v_pk_fma_f32 v[142:143], v[66:67], v[86:87], v[142:143] op_sel_hi:[1,0,1]
    v_pk_fma_f32 v[144:145], v[68:69], v[86:87], v[144:145] op_sel_hi:[1,0,1]
    v_pk_fma_f32 v[146:147], v[70:71], v[86:87], v[146:147] op_sel_hi:[1,0,1]
    v_lshlrev_b32 v64, 16, v128
    v_and_b32 v65, s12, v128
    v_lshlrev_b32 v66, 16, v129
    v_and_b32 v67, s12, v129
    v_lshlrev_b32 v68, 16, v130
    v_and_b32 v69, s12, v130
    v_lshlrev_b32 v70, 16, v131
    v_and_b32 v71, s12, v131
    v_pk_fma_f32 v[140:141], v[64:65], v[88:89], v[140:141] op_sel_hi:[1,0,1]
    v_pk_fma_f32 v[142:143], v[66:67], v[88:89], v[142:143] op_sel_hi:[1,0,1]
    v_pk_fma_f32 v[144:145], v[68:69], v[88:89], v[144:145] op_sel_hi:[1,0,1]
    v_pk_fma_f32 v[146:147], v[70:71], v[88:89], v[146:147] op_sel_hi:[1,0,1]
    s_nop 0
    v_permlane32_swap_b32 v140, v144
    v_permlane32_swap_b32 v141, v145
    v_permlane32_swap_b32 v142, v146
    v_permlane32_swap_b32 v143, v147
    v_pk_add_f32 v[140:141], v[140:141], v[144:145]
    v_pk_add_f32 v[142:143], v[142:143], v[146:147]
    s_nop 1
    v_permlane16_swap_b32 v140, v142
    v_permlane16_swap_b32 v141, v143
    v_pk_add_f32 v[140:141], v[140:141], v[142:143]
    s_nop 1
    v_add_f32_dpp v140, v140, v140 row_ror:4 row_mask:0xf bank_mask:0xf
    v_add_f32_dpp v141, v141, v141 row_ror:4 row_mask:0xf bank_mask:0xf
    s_nop 0
    v_add_f32_dpp v140, v140, v140 row_ror:8 row_mask:0xf bank_mask:0xf
    v_add_f32_dpp v141, v141, v141 row_ror:8 row_mask:0xf bank_mask:0xf
    v_and_b32 v64, 3, v1
    v_lshlrev_b32 v64, 5, v64
    v_lshrrev_b32 v65, 4, v1
    v_lshl_add_u32 v64, v65, 3, v64
    s_lshl_b32 s18, s3, 7
    s_add_u32 s18, s18, 143872
    v_add_u32 v64, s18, v64
    s_mov_b32 exec_lo, 0x000f000f
    s_mov_b32 exec_hi, 0x000f000f
    ds_write_b64 v64, v[140:141]
    s_mov_b64 exec, -1
    s_waitcnt lgkmcnt(0)
    s_barrier
    s_cmp_lg_u32 s3, 0
    s_cbranch_scc1 NC_NOMOD2
    v_and_b32 v64, 15, v1
    v_lshlrev_b32 v65, 3, v64
    v_add_u32 v65, 143872, v65
    ds_read_b64 v[80:81], v65 offset:0
    ds_read_b64 v[82:83], v65 offset:128
    ds_read_b64 v[84:85], v65 offset:256
    ds_read_b64 v[86:87], v65 offset:384
    ds_read_b64 v[88:89], v65 offset:512
    ds_read_b64 v[90:91], v65 offset:640
    ds_read_b64 v[92:93], v65 offset:768
    ds_read_b64 v[94:95], v65 offset:896
    s_lshl_b32 s18, s7, 6
    s_add_u32 s18, s18, 8192
    v_lshl_add_u32 v64, v64, 2, s18
    s_waitcnt lgkmcnt(0)
    v_pk_add_f32 v[80:81], v[80:81], v[88:89]
    v_pk_add_f32 v[82:83], v[82:83], v[90:91]
    v_pk_add_f32 v[84:85], v[84:85], v[92:93]
    v_pk_add_f32 v[86:87], v[86:87], v[94:95]
    v_pk_add_f32 v[80:81], v[80:81], v[84:85]
    v_pk_add_f32 v[82:83], v[82:83], v[86:87]
    v_pk_add_f32 v[80:81], v[80:81], v[82:83]
    v_cvt_pk_bf16_f32 v66, v80, v81
    v_min_u32 v66, -2, v66
    s_and_b64 s[20:21], s[20:21], s[22:23]
    s_and_b64 s[20:21], s[20:21], s[24:25]
    s_and_b64 s[20:21], s[20:21], s[26:27]
    s_and_b64 s[20:21], s[20:21], s[28:29]
    s_and_b64 s[20:21], s[20:21], s[30:31]
    s_and_b64 s[20:21], s[20:21], s[32:33]
    s_and_b64 s[20:21], s[20:21], s[34:35]
    s_and_b32 s20, s20, s21
    s_cmp_lg_u32 s20, 0
    s_cbranch_scc1 GOD_18
    v_and_b32 v69, 15, v1
    v_lshlrev_b32 v69, 2, v69
GO_17:
    global_load_dword v68, v69, s[66:67] offset:192 sc1
    s_waitcnt vmcnt(0)
    v_cmp_eq_u32 vcc, 0, v68
    s_cbranch_vccz GOD_18
    s_sub_u32 s10, s10, 1
    s_cbranch_scc1 EXIT
    s_branch GO_17
GOD_18:
    s_mov_b64 exec, 0xffff
    global_store_dword v64, v66, s[68:69] sc1
    s_mov_b64 exec, -1
    s_branch NC_GO
NC_NOMOD2:
    s_waitcnt lgkmcnt(0)
    s_and_b64 s[20:21], s[20:21], s[22:23]
    s_and_b64 s[20:21], s[20:21], s[24:25]
    s_and_b64 s[20:21], s[20:21], s[26:27]
    s_and_b64 s[20:21], s[20:21], s[28:29]
    s_and_b64 s[20:21], s[20:21], s[30:31]
    s_and_b64 s[20:21], s[20:21], s[32:33]
    s_and_b64 s[20:21], s[20:21], s[34:35]
    s_and_b32 s20, s20, s21
    s_cmp_lg_u32 s20, 0
    s_cbranch_scc1 GOD_20
    v_and_b32 v69, 15, v1
    v_lshlrev_b32 v69, 2, v69
GO_19:
    global_load_dword v68, v69, s[66:67] offset:192 sc1
    s_waitcnt vmcnt(0)
    v_cmp_eq_u32 vcc, 0, v68
    s_cbranch_vccz GOD_20
    s_sub_u32 s10, s10, 1
    s_cbranch_scc1 EXIT
    s_branch GO_19
GOD_20:
NC_GO:
    global_load_dwordx4 v[8:11], v7, s[52:53]
    global_load_ushort v12, v13, s[52:53]
    s_cmp_lt_u32 s3, 4
    s_cbranch_scc1 NC_A2
    v_mov_b32 v60, -1
    v_mov_b32 v61, -1
    v_mov_b32 v62, -1
    v_mul_u32_u24 v59, 12, v1
    s_mul_i32 s20, s2, 9216
    s_mul_i32 s21, s9, 2304
    s_add_u32 s20, s20, s21
    s_add_u32 s20, s20, 1048576
    v_add_u32 v58, s20, v59
    global_store_dwordx3 v58, v[60:62], s[68:69] sc1
    global_store_dwordx3 v58, v[60:62], s[68:69] offset:768 sc1
    global_store_dwordx3 v58, v[60:62], s[68:69] offset:1536 sc1
    v_add_u32 v58, 3145728, v58
    global_store_dwordx3 v58, v[60:62], s[68:69] sc1
    global_store_dwordx3 v58, v[60:62], s[68:69] offset:768 sc1
    global_store_dwordx3 v58, v[60:62], s[68:69] offset:1536 sc1
    s_lshl_b32 s20, s2, 2
    s_add_u32 s20, s20, s9
    s_add_u32 s20, s20, 15360
    v_mov_b32 v58, s20
    v_mov_b32 v59, 0
    s_waitcnt vmcnt(3)
    s_mov_b64 exec, 1
    global_store_byte v58, v59, s[68:69] sc1
    s_mov_b64 exec, -1
    v_and_b32 v52, 7, v1
    v_lshlrev_b32 v52, 3, v52
    v_lshrrev_b32 v53, 4, v1
    s_mul_i32 s20, s9, 294912
    s_lshl_b32 s21, s8, 6
    s_add_u32 s20, s20, s21
    s_mov_b32 s21, 73728
    v_mad_u32_u24 v52, v53, s21, v52
    v_add_u32 v52, s20, v52
    v_and_b32 v54, 8, v1
    v_cmp_eq_u32 vcc, 0, v54
    v_mov_b32 v54, s56
    v_mov_b32 v55, s54
    v_cndmask_b32 v54, v54, v55, vcc
    v_mov_b32 v55, s57
    v_mov_b32 v56, s55
    v_cndmask_b32 v55, v55, v56, vcc
    v_add_co_u32 v54, vcc, v54, v52
    s_nop 1
    v_addc_co_u32 v55, vcc, 0, v55, vcc
    s_mov_b32 s20, 9216
    s_mov_b32 s21, 0
    s_mov_b32 s22, 1115136
    s_mov_b32 s23, 0
    global_load_dwordx2 v[128:129], v[54:55], off nt
    v_lshl_add_u64 v[54:55], v[54:55], 0, s[20:21]
    global_load_dwordx2 v[130:131], v[54:55], off nt
    v_lshl_add_u64 v[54:55], v[54:55], 0, s[20:21]
    global_load_dwordx2 v[132:133], v[54:55], off nt
    v_lshl_add_u64 v[54:55], v[54:55], 0, s[20:21]
    global_load_dwordx2 v[134:135], v[54:55], off nt
    v_lshl_add_u64 v[54:55], v[54:55], 0, s[20:21]
    global_load_dwordx2 v[136:137], v[54:55], off nt
    v_lshl_add_u64 v[54:55], v[54:55], 0, s[20:21]
    global_load_dwordx2 v[138:139], v[54:55], off nt
    v_lshl_add_u64 v[54:55], v[54:55], 0, s[20:21]
    global_load_dwordx2 v[140:141], v[54:55], off nt
    v_lshl_add_u64 v[54:55], v[54:55], 0, s[20:21]
    global_load_dwordx2 v[142:143], v[54:55], off nt
    v_lshl_add_u64 v[54:55], v[54:55], 0, s[22:23]
    global_load_dwordx2 v[144:145], v[54:55], off nt
    v_lshl_add_u64 v[54:55], v[54:55], 0, s[20:21]
    global_load_dwordx2 v[146:147], v[54:55], off nt
    v_lshl_add_u64 v[54:55], v[54:55], 0, s[20:21]
    global_load_dwordx2 v[148:149], v[54:55], off nt
    v_lshl_add_u64 v[54:55], v[54:55], 0, s[20:21]
    global_load_dwordx2 v[150:151], v[54:55], off nt
    v_lshl_add_u64 v[54:55], v[54:55], 0, s[20:21]
    global_load_dwordx2 v[152:153], v[54:55], off nt
    v_lshl_add_u64 v[54:55], v[54:55], 0, s[20:21]
    global_load_dwordx2 v[154:155], v[54:55], off nt
    v_lshl_add_u64 v[54:55], v[54:55], 0, s[20:21]
    global_load_dwordx2 v[156:157], v[54:55], off nt
    v_lshl_add_u64 v[54:55], v[54:55], 0, s[20:21]
    global_load_dwordx2 v[158:159], v[54:55], off nt
    v_lshl_add_u64 v[54:55], v[54:55], 0, s[22:23]
    global_load_dwordx2 v[160:161], v[54:55], off nt
    v_lshl_add_u64 v[54:55], v[54:55], 0, s[20:21]
    global_load_dwordx2 v[162:163], v[54:55], off nt
    v_lshl_add_u64 v[54:55], v[54:55], 0, s[20:21]
    global_load_dwordx2 v[164:165], v[54:55], off nt
    v_lshl_add_u64 v[54:55], v[54:55], 0, s[20:21]
    global_load_dwordx2 v[166:167], v[54:55], off nt
    v_lshl_add_u64 v[54:55], v[54:55], 0, s[20:21]
    global_load_dwordx2 v[168:169], v[54:55], off nt
    v_lshl_add_u64 v[54:55], v[54:55], 0, s[20:21]
    global_load_dwordx2 v[170:171], v[54:55], off nt
    v_lshl_add_u64 v[54:55], v[54:55], 0, s[20:21]
    global_load_dwordx2 v[172:173], v[54:55], off nt
    v_lshl_add_u64 v[54:55], v[54:55], 0, s[20:21]
    global_load_dwordx2 v[174:175], v[54:55], off nt
    v_lshl_add_u64 v[54:55], v[54:55], 0, s[22:23]
    global_load_dwordx2 v[176:177], v[54:55], off nt
    v_lshl_add_u64 v[54:55], v[54:55], 0, s[20:21]
    global_load_dwordx2 v[178:179], v[54:55], off nt
    v_lshl_add_u64 v[54:55], v[54:55], 0, s[20:21]
    global_load_dwordx2 v[180:181], v[54:55], off nt
    v_lshl_add_u64 v[54:55], v[54:55], 0, s[20:21]
    global_load_dwordx2 v[182:183], v[54:55], off nt
    v_lshl_add_u64 v[54:55], v[54:55], 0, s[20:21]
    global_load_dwordx2 v[184:185], v[54:55], off nt
    v_lshl_add_u64 v[54:55], v[54:55], 0, s[20:21]
    global_load_dwordx2 v[186:187], v[54:55], off nt
    v_lshl_add_u64 v[54:55], v[54:55], 0, s[20:21]
    global_load_dwordx2 v[188:189], v[54:55], off nt
    v_lshl_add_u64 v[54:55], v[54:55], 0, s[20:21]
    global_load_dwordx2 v[190:191], v[54:55], off nt
    v_lshl_add_u64 v[54:55], v[54:55], 0, s[22:23]
    s_cmp_ge_u32 s9, 2
    s_cbranch_scc1 W5_21
    global_load_dwordx2 v[192:193], v[54:55], off nt
    v_lshl_add_u64 v[54:55], v[54:55], 0, s[20:21]
    global_load_dwordx2 v[194:195], v[54:55], off nt
    v_lshl_add_u64 v[54:55], v[54:55], 0, s[20:21]
    global_load_dwordx2 v[196:197], v[54:55], off nt
    v_lshl_add_u64 v[54:55], v[54:55], 0, s[20:21]
    global_load_dwordx2 v[198:199], v[54:55], off nt
    v_lshl_add_u64 v[54:55], v[54:55], 0, s[20:21]
    global_load_dwordx2 v[200:201], v[54:55], off nt
    v_lshl_add_u64 v[54:55], v[54:55], 0, s[20:21]
    global_load_dwordx2 v[202:203], v[54:55], off nt
    v_lshl_add_u64 v[54:55], v[54:55], 0, s[20:21]
    global_load_dwordx2 v[204:205], v[54:55], off nt
    v_lshl_add_u64 v[54:55], v[54:55], 0, s[20:21]
    global_load_dwordx2 v[206:207], v[54:55], off nt
W5_21:
    v_lshrrev_b32 v53, 4, v1
    v_and_b32 v52, 15, v1
    v_lshlrev_b32 v52, 3, v52
    s_movk_i32 s21, 1152
    v_mad_u32_u24 v52, v53, s21, v52
    s_mul_i32 s20, s8, 36864
    s_lshl_b32 s21, s9, 7
    s_add_u32 s20, s20, s21
    v_add_u32 v52, s20, v52
    global_load_dwordx2 v[208:209], v52, s[58:59] nt
    global_load_dwordx2 v[224:225], v52, s[58:59] offset:512 nt
    v_add_u32 v52, 4608, v52
    global_load_dwordx2 v[210:211], v52, s[58:59] nt
    global_load_dwordx2 v[226:227], v52, s[58:59] offset:512 nt
    v_add_u32 v52, 4608, v52
    global_load_dwordx2 v[212:213], v52, s[58:59] nt
    global_load_dwordx2 v[228:229], v52, s[58:59] offset:512 nt
    v_add_u32 v52, 4608, v52
    global_load_dwordx2 v[214:215], v52, s[58:59] nt
    global_load_dwordx2 v[230:231], v52, s[58:59] offset:512 nt
    v_add_u32 v52, 4608, v52
    global_load_dwordx2 v[216:217], v52, s[58:59] nt
    global_load_dwordx2 v[232:233], v52, s[58:59] offset:512 nt
    v_add_u32 v52, 4608, v52
    global_load_dwordx2 v[218:219], v52, s[58:59] nt
    global_load_dwordx2 v[234:235], v52, s[58:59] offset:512 nt
    v_add_u32 v52, 4608, v52
    global_load_dwordx2 v[220:221], v52, s[58:59] nt
    global_load_dwordx2 v[236:237], v52, s[58:59] offset:512 nt
    v_add_u32 v52, 4608, v52
    global_load_dwordx2 v[222:223], v52, s[58:59] nt
    global_load_dwordx2 v[238:239], v52, s[58:59] offset:512 nt
    s_cmp_lg_u32 s9, 3
    s_cbranch_scc1 W8_22
    global_load_dwordx2 v[254:255], v52, s[58:59] offset:640 nt
    v_subrev_u32 v52, 4608, v52
    global_load_dwordx2 v[252:253], v52, s[58:59] offset:640 nt
    v_subrev_u32 v52, 4608, v52
    global_load_dwordx2 v[250:251], v52, s[58:59] offset:640 nt
    v_subrev_u32 v52, 4608, v52
    global_load_dwordx2 v[248:249], v52, s[58:59] offset:640 nt
    v_subrev_u32 v52, 4608, v52
    global_load_dwordx2 v[246:247], v52, s[58:59] offset:640 nt
    v_subrev_u32 v52, 4608, v52
    global_load_dwordx2 v[244:245], v52, s[58:59] offset:640 nt
    v_subrev_u32 v52, 4608, v52
    global_load_dwordx2 v[242:243], v52, s[58:59] offset:640 nt
    v_subrev_u32 v52, 4608, v52
    global_load_dwordx2 v[240:241], v52, s[58:59] offset:640 nt
W8_22:
    s_waitcnt vmcnt(0)
    s_mov_b32 s20, 0x05040100
    s_mov_b32 s21, 0x07060302
    v_perm_b32 v112, v130, v128, s20
    v_perm_b32 v116, v130, v128, s21
    v_perm_b32 v120, v131, v129, s20
    v_perm_b32 v124, v131, v129, s21
    v_perm_b32 v113, v134, v132, s20
    v_perm_b32 v117, v134, v132, s21
    v_perm_b32 v121, v135, v133, s20
    v_perm_b32 v125, v135, v133, s21
    v_perm_b32 v114, v138, v136, s20
    v_perm_b32 v118, v138, v136, s21
    v_perm_b32 v122, v139, v137, s20
    v_perm_b32 v126, v139, v137, s21
    v_perm_b32 v115, v142, v140, s20
    v_perm_b32 v119, v142, v140, s21
    v_perm_b32 v123, v143, v141, s20
    v_perm_b32 v127, v143, v141, s21
    v_perm_b32 v128, v146, v144, s20
    v_perm_b32 v132, v146, v144, s21
    v_perm_b32 v136, v147, v145, s20
    v_perm_b32 v140, v147, v145, s21
    v_perm_b32 v129, v150, v148, s20
    v_perm_b32 v133, v150, v148, s21
    v_perm_b32 v137, v151, v149, s20
    v_perm_b32 v141, v151, v149, s21
    v_perm_b32 v130, v154, v152, s20
    v_perm_b32 v134, v154, v152, s21
    v_perm_b32 v138, v155, v153, s20
    v_perm_b32 v142, v155, v153, s21
    v_perm_b32 v131, v158, v156, s20
    v_perm_b32 v135, v158, v156, s21
    v_perm_b32 v139, v159, v157, s20
    v_perm_b32 v143, v159, v157, s21
    v_perm_b32 v144, v162, v160, s20
    v_perm_b32 v148, v162, v160, s21
    v_perm_b32 v152, v163, v161, s20
    v_perm_b32 v156, v163, v161, s21
    v_perm_b32 v145, v166, v164, s20
    v_perm_b32 v149, v166, v164, s21
    v_perm_b32 v153, v167, v165, s20
    v_perm_b32 v157, v167, v165, s21
    v_perm_b32 v146, v170, v168, s20
    v_perm_b32 v150, v170, v168, s21
    v_perm_b32 v154, v171, v169, s20
    v_perm_b32 v158, v171, v169, s21
    v_perm_b32 v147, v174, v172, s20
    v_perm_b32 v151, v174, v172, s21
    v_perm_b32 v155, v175, v173, s20
    v_perm_b32 v159, v175, v173, s21
    v_perm_b32 v160, v178, v176, s20
    v_perm_b32 v164, v178, v176, s21
    v_perm_b32 v168, v179, v177, s20
    v_perm_b32 v172, v179, v177, s21
    v_perm_b32 v161, v182, v180, s20
    v_perm_b32 v165, v182, v180, s21
    v_perm_b32 v169, v183, v181, s20
    v_perm_b32 v173, v183, v181, s21
    v_perm_b32 v162, v186, v184, s20
    v_perm_b32 v166, v186, v184, s21
    v_perm_b32 v170, v187, v185, s20
    v_perm_b32 v174, v187, v185, s21
    v_perm_b32 v163, v190, v188, s20
    v_perm_b32 v167, v190, v188, s21
    v_perm_b32 v171, v191, v189, s20
    v_perm_b32 v175, v191, v189, s21
    v_perm_b32 v176, v194, v192, s20
    v_perm_b32 v180, v194, v192, s21
    v_perm_b32 v184, v195, v193, s20
    v_perm_b32 v188, v195, v193, s21
    v_perm_b32 v177, v198, v196, s20
    v_perm_b32 v181, v198, v196, s21
    v_perm_b32 v185, v199, v197, s20
    v_perm_b32 v189, v199, v197, s21
    v_perm_b32 v178, v202, v200, s20
    v_perm_b32 v182, v202, v200, s21
    v_perm_b32 v186, v203, v201, s20
    v_perm_b32 v190, v203, v201, s21
    v_perm_b32 v179, v206, v204, s20
    v_perm_b32 v183, v206, v204, s21
    v_perm_b32 v187, v207, v205, s20
    v_perm_b32 v191, v207, v205, s21
    v_perm_b32 v192, v210, v208, s20
    v_perm_b32 v196, v210, v208, s21
    v_perm_b32 v200, v211, v209, s20
    v_perm_b32 v204, v211, v209, s21
    v_perm_b32 v193, v214, v212, s20
    v_perm_b32 v197, v214, v212, s21
    v_perm_b32 v201, v215, v213, s20
    v_perm_b32 v205, v215, v213, s21
    v_perm_b32 v194, v218, v216, s20
    v_perm_b32 v198, v218, v216, s21
    v_perm_b32 v202, v219, v217, s20
    v_perm_b32 v206, v219, v217, s21
    v_perm_b32 v195, v222, v220, s20
    v_perm_b32 v199, v222, v220, s21
    v_perm_b32 v203, v223, v221, s20
    v_perm_b32 v207, v223, v221, s21
    v_perm_b32 v208, v226, v224, s20
    v_perm_b32 v212, v226, v224, s21
    v_perm_b32 v216, v227, v225, s20
    v_perm_b32 v220, v227, v225, s21
    v_perm_b32 v209, v230, v228, s20
    v_perm_b32 v213, v230, v228, s21
    v_perm_b32 v217, v231, v229, s20
    v_perm_b32 v221, v231, v229, s21
    v_perm_b32 v210, v234, v232, s20
    v_perm_b32 v214, v234, v232, s21
    v_perm_b32 v218, v235, v233, s20
    v_perm_b32 v222, v235, v233, s21
    v_perm_b32 v211, v238, v236, s20
    v_perm_b32 v215, v238, v236, s21
    v_perm_b32 v219, v239, v237, s20
    v_perm_b32 v223, v239, v237, s21
    v_perm_b32 v224, v242, v240, s20
    v_perm_b32 v228, v242, v240, s21
    v_perm_b32 v232, v243, v241, s20
    v_perm_b32 v236, v243, v241, s21
    v_perm_b32 v225, v246, v244, s20
    v_perm_b32 v229, v246, v244, s21
    v_perm_b32 v233, v247, v245, s20
    v_perm_b32 v237, v247, v245, s21
    v_perm_b32 v226, v250, v248, s20
    v_perm_b32 v230, v250, v248, s21
    v_perm_b32 v234, v251, v249, s20
    v_perm_b32 v238, v251, v249, s21
    v_perm_b32 v227, v254, v252, s20
    v_perm_b32 v231, v254, v252, s21
    v_perm_b32 v235, v255, v253, s20
    v_perm_b32 v239, v255, v253, s21
NC_A2:
    s_barrier
    v_add_u32 v52, 8192, v7
    v_add_u32 v53, 8192, v13
    v_add_u32 v54, 3456, v52
    v_add_u32 v55, 3456, v53
    global_load_dwordx4 v[20:23], v54, s[68:69]
    global_load_ushort v24, v55, s[68:69]
    v_add_u32 v54, 4608, v52
    v_add_u32 v55, 4608, v53
    global_load_dwordx4 v[14:17], v54, s[68:69]
    global_load_ushort v18, v55, s[68:69]
    v_add_u32 v54, 5760, v52
    v_add_u32 v55, 5760, v53
    global_load_dwordx4 v[26:29], v54, s[68:69]
    global_load_ushort v30, v55, s[68:69]
    s_waitcnt vmcnt(0)
MC_23:
    v_or_b32 v53, s12, v24
    v_or_b32 v54, s12, v18
    v_or_b32 v55, s12, v30
    v_max3_u32 v52, v20, v21, v22
    v_max3_u32 v52, v52, v23, v14
    v_max3_u32 v52, v52, v15, v16
    v_max3_u32 v52, v52, v17, v26
    v_max3_u32 v52, v52, v27, v28
    v_max3_u32 v52, v52, v29, v53
    v_max3_u32 v52, v52, v54, v55
    v_cmp_eq_u32 vcc, -1, v52
    s_cbranch_vccz MCD_24
    v_add_u32 v52, 8192, v7
    v_add_u32 v53, 8192, v13
    v_add_u32 v54, 3456, v52
    v_add_u32 v55, 3456, v53
    global_load_dwordx4 v[20:23], v54, s[68:69] sc1
    global_load_ushort v24, v55, s[68:69] sc1
    v_add_u32 v54, 4608, v52
    v_add_u32 v55, 4608, v53
    global_load_dwordx4 v[14:17], v54, s[68:69] sc1
    global_load_ushort v18, v55, s[68:69] sc1
    v_add_u32 v54, 5760, v52
    v_add_u32 v55, 5760, v53
    global_load_dwordx4 v[26:29], v54, s[68:69] sc1
    global_load_ushort v30, v55, s[68:69] sc1
    s_waitcnt vmcnt(0)
    s_sub_u32 s10, s10, 1
    s_cbranch_scc1 EXIT
    s_branch MC_23
MCD_24:
    v_lshlrev_b32 v32, 16, v14
    v_and_b32 v33, s12, v14
    v_lshlrev_b32 v34, 16, v15
    v_and_b32 v35, s12, v15
    v_lshlrev_b32 v36, 16, v16
    v_and_b32 v37, s12, v16
    v_lshlrev_b32 v38, 16, v17
    v_and_b32 v39, s12, v17
    v_lshlrev_b32 v40, 16, v18
    v_lshlrev_b32 v42, 16, v20
    v_and_b32 v43, s12, v20
    v_lshlrev_b32 v44, 16, v21
    v_and_b32 v45, s12, v21
    v_lshlrev_b32 v46, 16, v22
    v_and_b32 v47, s12, v22
    v_lshlrev_b32 v48, 16, v23
    v_and_b32 v49, s12, v23
    v_lshlrev_b32 v50, 16, v24
    v_pk_add_f32 v[32:33], v[32:33], 1.0 op_sel_hi:[1,0]
    v_pk_add_f32 v[34:35], v[34:35], 1.0 op_sel_hi:[1,0]
    v_pk_add_f32 v[36:37], v[36:37], 1.0 op_sel_hi:[1,0]
    v_pk_add_f32 v[38:39], v[38:39], 1.0 op_sel_hi:[1,0]
    v_add_f32 v40, 1.0, v40
    v_cvt_pk_bf16_f32 v52, v32, v33
    v_cvt_pk_bf16_f32 v53, v34, v35
    v_cvt_pk_bf16_f32 v54, v36, v37
    v_cvt_pk_bf16_f32 v55, v38, v39
    v_cvt_pk_bf16_f32 v56, v40, v40
    v_lshlrev_b32 v32, 16, v52
    v_and_b32 v33, s12, v52
    v_lshlrev_b32 v34, 16, v53
    v_and_b32 v35, s12, v53
    v_lshlrev_b32 v36, 16, v54
    v_and_b32 v37, s12, v54
    v_lshlrev_b32 v38, 16, v55
    v_and_b32 v39, s12, v55
    v_lshlrev_b32 v40, 16, v56
    s_cmp_lg_u32 s3, 4
    s_cbranch_scc1 NC_FD
    s_lshl_b32 s20, s2, 4
    s_add_u32 s20, s20, 18176
    v_mov_b32 v52, s20
NC_FP:
    global_load_dword v53, v52, s[68:69] sc1
    s_waitcnt vmcnt(0)
    v_cmp_eq_u32 vcc, -1, v53
    s_cbranch_vccz NC_FD
    s_sub_u32 s10, s10, 1
    s_cbranch_scc1 EXIT
    s_branch NC_FP
NC_FD:
    s_barrier
GPOLL:
    s_mul_i32 s20, s2, 9216
    s_add_u32 s20, s20, 1048576
    v_lshl_add_u32 v52, v0, 4, s20
    v_and_b32 v53, 7, v1
    v_lshl_add_u32 v53, s3, 3, v53
    v_add_u32 v53, 512, v53
    v_lshlrev_b32 v55, 2, v53
    v_lshl_add_u32 v53, v53, 4, s20
    v_lshlrev_b32 v54, 2, v0
    global_load_dwordx4 v[64:67], v52, s[68:69] sc1
    global_load_dwordx4 v[68:71], v53, s[68:69] sc1
    s_mul_i32 s20, s3, 1152
    s_add_u32 s20, s20, 144896
    v_add_u32 v56, s20, v7
    v_add_u32 v57, s20, v13
    ds_read_b128 v[2:5], v56
    ds_read_u16 v6, v57
    s_waitcnt lgkmcnt(0)
    v_lshlrev_b32 v80, 16, v2
    v_and_b32 v81, s12, v2
    v_lshlrev_b32 v82, 16, v3
    v_and_b32 v83, s12, v3
    v_lshlrev_b32 v84, 16, v4
    v_and_b32 v85, s12, v4
    v_lshlrev_b32 v86, 16, v5
    v_and_b32 v87, s12, v5
    v_lshlrev_b32 v88, 16, v6
    s_waitcnt vmcnt(0)
GP:
    v_max3_u32 v72, v64, v65, v66
    v_max3_u32 v72, v72, v67, v68
    v_max3_u32 v72, v72, v69, v70
    v_max_u32 v72, v72, v71
    v_cmp_eq_u32 vcc, -1, v72
    s_cbranch_vccz GPD
    s_mov_b64 exec, vcc
    global_load_dwordx4 v[64:67], v52, s[68:69] sc1
    global_load_dwordx4 v[68:71], v53, s[68:69] sc1
    s_mov_b64 exec, -1
    s_waitcnt vmcnt(0)
    s_sub_u32 s10, s10, 1
    s_cbranch_scc1 EXIT
    s_branch GP
GPD:
    ds_write_b32 v54, v64 offset:8192
    ds_write_b32 v54, v65 offset:10496
    ds_write_b32 v54, v66 offset:12800
    ds_write_b32 v54, v67 offset:15104
    s_mov_b64 exec, 0xff
    ds_write_b32 v55, v68 offset:8192
    ds_write_b32 v55, v69 offset:10496
    ds_write_b32 v55, v70 offset:12800
    ds_write_b32 v55, v71 offset:15104
    s_mov_b64 exec, -1
    s_lshr_b32 s20, s3, 1
    s_mul_i32 s20, s20, 2304
    v_lshl_add_u32 v52, v1, 5, s20
    v_lshl_add_u32 v53, v1, 2, s20
    s_mov_b32 s21, 0x01000c0c
    s_bitcmp1_b32 s3, 0
    s_cselect_b32 s21, 0x03020c0c, s21
    s_mul_i32 s22, s11, 1152
    s_add_u32 s23, s22, 4194304
    v_add_u32 v56, s23, v7
    v_add_u32 v57, s23, v13
    s_waitcnt lgkmcnt(0)
    s_barrier
    ds_read_b128 v[64:67], v52 offset:8192
    ds_read_b128 v[68:71], v52 offset:8208
    ds_read_b32 v72, v53 offset:10240
    s_waitcnt lgkmcnt(0)
    v_perm_b32 v64, v64, v64, s21
    v_perm_b32 v65, v65, v65, s21
    v_perm_b32 v66, v66, v66, s21
    v_perm_b32 v67, v67, v67, s21
    v_perm_b32 v68, v68, v68, s21
    v_perm_b32 v69, v69, v69, s21
    v_perm_b32 v70, v70, v70, s21
    v_perm_b32 v71, v71, v71, s21
    v_perm_b32 v72, v72, v72, s21
    v_pk_add_f32 v[64:65], v[64:65], v[80:81]
    v_pk_add_f32 v[66:67], v[66:67], v[82:83]
    v_pk_add_f32 v[68:69], v[68:69], v[84:85]
    v_pk_add_f32 v[70:71], v[70:71], v[86:87]
    v_add_f32 v72, v72, v88
    v_cvt_pk_bf16_f32 v2, v64, v65
    v_cvt_pk_bf16_f32 v3, v66, v67
    v_cvt_pk_bf16_f32 v4, v68, v69
    v_cvt_pk_bf16_f32 v5, v70, v71
    v_cvt_pk_bf16_f32 v6, v72, v72
    v_lshlrev_b32 v64, 16, v2
    v_and_b32 v65, s12, v2
    v_lshlrev_b32 v66, 16, v3
    v_and_b32 v67, s12, v3
    v_lshlrev_b32 v68, 16, v4
    v_and_b32 v69, s12, v4
    v_lshlrev_b32 v70, 16, v5
    v_and_b32 v71, s12, v5
    v_lshlrev_b32 v72, 16, v6
    v_readfirstlane_b32 s24, v64
    s_nop 1
    v_subrev_f32 v64, s24, v64
    v_subrev_f32 v65, s24, v65
    v_subrev_f32 v66, s24, v66
    v_subrev_f32 v67, s24, v67
    v_subrev_f32 v68, s24, v68
    v_subrev_f32 v69, s24, v69
    v_subrev_f32 v70, s24, v70
    v_subrev_f32 v71, s24, v71
    v_subrev_f32 v72, s24, v72
    v_pk_add_f32 v[74:75], v[64:65], v[66:67]
    v_pk_mul_f32 v[76:77], v[64:65], v[64:65]
    v_pk_add_f32 v[74:75], v[74:75], v[68:69]
    v_pk_fma_f32 v[76:77], v[66:67], v[66:67], v[76:77]
    v_pk_add_f32 v[74:75], v[74:75], v[70:71]
    v_pk_fma_f32 v[76:77], v[68:69], v[68:69], v[76:77]
    v_add_f32 v74, v74, v72
    v_pk_fma_f32 v[76:77], v[70:71], v[70:71], v[76:77]
    v_add_f32 v74, v74, v75
    v_fmac_f32 v76, v72, v72
    v_add_f32 v76, v76, v77
    s_nop 1
    v_permlane32_swap_b32 v74, v76
    v_add_f32 v74, v74, v76
    v_mov_b32 v76, v74
    s_nop 1
    v_permlane16_swap_b32 v74, v76
    v_add_f32 v74, v74, v76
    s_nop 1
    v_add_f32_dpp v74, v74, v74 row_ror:8 row_mask:0xf bank_mask:0xf
    s_nop 1
    v_add_f32_dpp v74, v74, v74 row_ror:4 row_mask:0xf bank_mask:0xf
    s_nop 1
    v_add_f32_dpp v74, v74, v74 row_ror:2 row_mask:0xf bank_mask:0xf
    s_nop 1
    v_add_f32_dpp v74, v74, v74 row_ror:1 row_mask:0xf bank_mask:0xf
    v_mov_b32 v76, v74
    s_nop 1
    v_permlane32_swap_b32 v74, v76
    v_mul_f32 v74, 0x3ae38e39, v74
    v_mul_f32 v76, 0x3ae38e39, v76
    v_add_f32 v75, s24, v74
    v_fma_f32 v77, -v74, v74, v76
    v_max_f32 v77, 0, v77
    v_cvt_pk_bf16_f32 v77, v77, v77
    v_and_b32 v77, s12, v77
    v_add_f32 v77, 0x3727c5ac, v77
    v_cvt_pk_bf16_f32 v77, v77, v77
    v_and_b32 v77, s12, v77
    v_sqrt_f32 v78, v77
    v_cvt_pk_bf16_f32 v75, v75, v75
    v_and_b32 v75, s12, v75
    v_cvt_pk_bf16_f32 v78, v78, v78
    v_and_b32 v78, s12, v78
    v_rcp_f32 v78, v78
    v_sub_f32 v79, s24, v75
    v_mul_f32 v79, v79, v78
    v_pk_fma_f32 v[64:65], v[64:65], v[78:79], v[78:79] op_sel:[0,0,1] op_sel_hi:[1,0,1]
    v_pk_fma_f32 v[66:67], v[66:67], v[78:79], v[78:79] op_sel:[0,0,1] op_sel_hi:[1,0,1]
    v_pk_fma_f32 v[68:69], v[68:69], v[78:79], v[78:79] op_sel:[0,0,1] op_sel_hi:[1,0,1]
    v_pk_fma_f32 v[70:71], v[70:71], v[78:79], v[78:79] op_sel:[0,0,1] op_sel_hi:[1,0,1]
    v_fma_f32 v72, v72, v78, v79
    v_pk_fma_f32 v[64:65], v[64:65], v[32:33], v[42:43]
    v_pk_fma_f32 v[66:67], v[66:67], v[34:35], v[44:45]
    v_pk_fma_f32 v[68:69], v[68:69], v[36:37], v[46:47]
    v_pk_fma_f32 v[70:71], v[70:71], v[38:39], v[48:49]
    v_fma_f32 v72, v72, v40, v50
    v_cvt_pk_bf16_f32 v90, v64, v65
    v_cvt_pk_bf16_f32 v91, v66, v67
    v_cvt_pk_bf16_f32 v92, v68, v69
    v_cvt_pk_bf16_f32 v93, v70, v71
    v_cvt_pk_bf16_f32 v94, v72, v72
    v_dot2_f32_bf16 v74, v90, v8, 0
    v_dot2_f32_bf16 v75, v91, v9, 0
    v_dot2_f32_bf16 v74, v92, v10, v74
    v_dot2_f32_bf16 v75, v93, v11, v75
    v_dot2_f32_bf16 v74, v94, v12, v74
    s_nop 2
    v_add_f32 v74, v74, v75
    v_mov_b32 v76, v74
    s_nop 1
    v_permlane32_swap_b32 v74, v76
    v_add_f32 v74, v74, v76
    v_mov_b32 v76, v74
    s_nop 1
    v_permlane16_swap_b32 v74, v76
    v_add_f32 v74, v74, v76
    s_nop 1
    v_add_f32_dpp v74, v74, v74 row_ror:8 row_mask:0xf bank_mask:0xf
    s_nop 1
    v_add_f32_dpp v74, v74, v74 row_ror:4 row_mask:0xf bank_mask:0xf
    s_nop 1
    v_add_f32_dpp v74, v74, v74 row_ror:2 row_mask:0xf bank_mask:0xf
    s_nop 1
    v_add_f32_dpp v74, v74, v74 row_ror:1 row_mask:0xf bank_mask:0xf
    v_cvt_pk_bf16_f32 v74, v74, v74
    v_ashrrev_i32 v75, 31, v74
    v_or_b32 v75, 0x80008000, v75
    v_xor_b32 v74, v74, v75
    v_min_u32 v74, 0xfffefffe, v74
    s_lshl_b32 s20, s3, 1
    s_add_u32 s20, s20, 143424
    v_mov_b32 v75, s20
    s_mov_b64 exec, 1
    ds_write_b16_d16_hi v75, v74
    s_mov_b64 exec, -1
    s_waitcnt lgkmcnt(0)
    s_barrier
    s_cmp_lg_u32 s3, 4
    s_cbranch_scc1 NORS
    v_mov_b32 v52, 143424
    ds_read_b128 v[64:67], v52
    s_lshl_b32 s20, s2, 4
    s_add_u32 s20, s20, 16384
    v_mov_b32 v52, s20
    s_mov_b64 exec, 1
    s_waitcnt lgkmcnt(0)
    global_store_dwordx4 v52, v[64:67], s[68:69] sc1
    s_mov_b64 exec, -1
NORS:
    global_store_dwordx4 v56, v[90:93], s[68:69] sc1
    global_store_short v57, v94, s[68:69] sc1
    v_lshlrev_b32 v64, 16, v2
    v_and_b32 v65, s12, v2
    v_lshlrev_b32 v66, 16, v3
    v_and_b32 v67, s12, v3
    v_lshlrev_b32 v68, 16, v4
    v_and_b32 v69, s12, v4
    v_lshlrev_b32 v70, 16, v5
    v_and_b32 v71, s12, v5
    v_lshlrev_b32 v72, 16, v6
    v_lshlrev_b32 v74, 16, v90
    v_and_b32 v75, s12, v90
    v_lshlrev_b32 v76, 16, v91
    v_and_b32 v77, s12, v91
    v_lshlrev_b32 v78, 16, v92
    v_and_b32 v79, s12, v92
    v_lshlrev_b32 v80, 16, v93
    v_and_b32 v81, s12, v93
    v_lshlrev_b32 v82, 16, v94
    v_lshlrev_b32 v96, 16, v26
    v_and_b32 v97, s12, v26
    v_lshlrev_b32 v98, 16, v27
    v_and_b32 v99, s12, v27
    v_lshlrev_b32 v100, 16, v28
    v_and_b32 v101, s12, v28
    v_lshlrev_b32 v102, 16, v29
    v_and_b32 v103, s12, v29
    v_lshlrev_b32 v104, 16, v30
    v_pk_fma_f32 v[64:65], v[74:75], v[96:97], v[64:65]
    v_pk_fma_f32 v[66:67], v[76:77], v[98:99], v[66:67]
    v_pk_fma_f32 v[68:69], v[78:79], v[100:101], v[68:69]
    v_pk_fma_f32 v[70:71], v[80:81], v[102:103], v[70:71]
    v_fma_f32 v72, v82, v104, v72
    v_cvt_pk_bf16_f32 v8, v64, v65
    v_cvt_pk_bf16_f32 v9, v66, v67
    v_cvt_pk_bf16_f32 v10, v68, v69
    v_cvt_pk_bf16_f32 v11, v70, v71
    v_cvt_pk_bf16_f32 v12, v72, v72
    s_cmp_lt_u32 s3, 4
    s_cbranch_scc1 T8_B5
    v_and_b32 v52, 255, v0
    v_lshlrev_b32 v53, 4, v52
    v_add_u32 v53, 16384, v53
    v_lshlrev_b32 v52, 3, v52
    v_sub_u32 v52, 2047, v52
    v_and_b32 v54, 1, v1
    v_cmp_eq_u32 s[20:21], 0, v54
    v_and_b32 v54, 2, v1
    v_cmp_eq_u32 s[22:23], 0, v54
    v_and_b32 v54, 4, v1
    v_cmp_eq_u32 s[24:25], 0, v54
    v_and_b32 v54, 7, v1
    v_lshlrev_b32 v54, 2, v54
    s_waitcnt vmcnt(0)
    global_load_dwordx4 v[64:67], v53, s[68:69]
    s_waitcnt vmcnt(0)
RP:
    v_max3_u32 v68, v64, v65, v66
    v_max_u32 v68, v68, v67
    v_cmp_eq_u32 vcc, -1, v68
    s_cbranch_vccz RPD
    s_mov_b64 exec, vcc
    global_load_dwordx4 v[64:67], v53, s[68:69] sc1
    s_mov_b64 exec, -1
    s_waitcnt vmcnt(0)
    s_sub_u32 s10, s10, 1
    s_cbranch_scc1 EXIT
    s_branch RP
RPD:
    v_cndmask_b32 v68, v66, v64, s[20:21]
    v_cndmask_b32 v69, v67, v65, s[20:21]
    v_cndmask_b32 v70, v64, v66, s[20:21]
    v_cndmask_b32 v71, v65, v67, s[20:21]
    s_nop 0
    v_mov_b32_dpp v72, v70 quad_perm:[1,0,3,2] row_mask:0xf bank_mask:0xf
    v_mov_b32_dpp v73, v71 quad_perm:[1,0,3,2] row_mask:0xf bank_mask:0xf
    v_pk_max_u16 v68, v68, v72
    v_pk_max_u16 v69, v69, v73
    v_cndmask_b32 v70, v69, v68, s[22:23]
    v_cndmask_b32 v71, v68, v69, s[22:23]
    s_nop 1
    v_mov_b32_dpp v72, v71 quad_perm:[2,3,0,1] row_mask:0xf bank_mask:0xf
    v_pk_max_u16 v70, v70, v72
    s_nop 1
    v_mov_b32_dpp v72, v70 row_ror:4 row_mask:0xf bank_mask:0xf
    v_pk_max_u16 v70, v70, v72
    v_and_b32 v71, 0xffff, v70
    v_lshrrev_b32 v70, 16, v70
    v_cndmask_b32 v70, v70, v71, s[24:25]
    v_add_u32 v54, 143360, v54
    ds_max_u32 v54, v70
    v_subrev_u32 v80, 0, v52
    v_lshl_or_b32 v80, v64, 16, v80
    v_subrev_u32 v81, 1, v52
    v_and_or_b32 v81, v64, s12, v81
    v_subrev_u32 v82, 2, v52
    v_lshl_or_b32 v82, v65, 16, v82
    v_subrev_u32 v83, 3, v52
    v_and_or_b32 v83, v65, s12, v83
    v_subrev_u32 v84, 4, v52
    v_lshl_or_b32 v84, v66, 16, v84
    v_subrev_u32 v85, 5, v52
    v_and_or_b32 v85, v66, s12, v85
    v_subrev_u32 v86, 6, v52
    v_lshl_or_b32 v86, v67, 16, v86
    v_subrev_u32 v87, 7, v52
    v_and_or_b32 v87, v67, s12, v87
    s_waitcnt lgkmcnt(0)
T8_B5:
    s_barrier
    s_cmp_lt_u32 s3, 4
    s_cbranch_scc1 T8_B6
    v_mov_b32 v54, 143360
    ds_read_b128 v[64:67], v54
    ds_read_b128 v[68:71], v54 offset:16
    v_mov_b32 v72, 0
    s_waitcnt lgkmcnt(0)
    v_min3_u32 v64, v64, v65, v66
    v_min3_u32 v67, v67, v68, v69
    v_min3_u32 v64, v64, v70, v71
    v_min_u32 v64, v64, v67
    v_lshlrev_b32 v64, 16, v64
    v_cmp_ge_u32 s[20:21], v80, v64
    v_cmp_ge_u32 s[22:23], v81, v64
    v_cmp_ge_u32 s[24:25], v82, v64
    v_cmp_ge_u32 s[26:27], v83, v64
    v_cmp_ge_u32 s[28:29], v84, v64
    v_cmp_ge_u32 s[30:31], v85, v64
    v_cmp_ge_u32 s[32:33], v86, v64
    v_cmp_ge_u32 s[34:35], v87, v64
    v_addc_co_u32 v72, vcc, 0, v72, s[20:21]
    s_nop 1
    v_addc_co_u32 v72, vcc, 0, v72, s[22:23]
    s_nop 1
    v_addc_co_u32 v72, vcc, 0, v72, s[24:25]
    s_nop 1
    v_addc_co_u32 v72, vcc, 0, v72, s[26:27]
    s_nop 1
    v_addc_co_u32 v72, vcc, 0, v72, s[28:29]
    s_nop 1
    v_addc_co_u32 v72, vcc, 0, v72, s[30:31]
    s_nop 1
    v_addc_co_u32 v72, vcc, 0, v72, s[32:33]
    s_nop 1
    v_addc_co_u32 v72, vcc, 0, v72, s[34:35]
    v_cmp_lt_u32 vcc, 0, v72
    s_nop 0
    s_mov_b64 exec, vcc
    ds_add_rtn_u32 v73, v54, v72 offset:32
    s_waitcnt lgkmcnt(0)
    v_lshlrev_b32 v73, 2, v73
    s_mov_b64 exec, s[20:21]
    ds_write_b32 v73, v80 offset:17408
    v_add_u32 v73, 4, v73
    s_mov_b64 exec, s[22:23]
    ds_write_b32 v73, v81 offset:17408
    v_add_u32 v73, 4, v73
    s_mov_b64 exec, s[24:25]
    ds_write_b32 v73, v82 offset:17408
    v_add_u32 v73, 4, v73
    s_mov_b64 exec, s[26:27]
    ds_write_b32 v73, v83 offset:17408
    v_add_u32 v73, 4, v73
    s_mov_b64 exec, s[28:29]
    ds_write_b32 v73, v84 offset:17408
    v_add_u32 v73, 4, v73
    s_mov_b64 exec, s[30:31]
    ds_write_b32 v73, v85 offset:17408
    v_add_u32 v73, 4, v73
    s_mov_b64 exec, s[32:33]
    ds_write_b32 v73, v86 offset:17408
    v_add_u32 v73, 4, v73
    s_mov_b64 exec, s[34:35]
    ds_write_b32 v73, v87 offset:17408
    v_add_u32 v73, 4, v73
    s_mov_b64 exec, -1
    s_waitcnt lgkmcnt(0)
T8_B6:
    s_barrier
    v_mov_b32 v54, 143392
    ds_read_b32 v55, v54
    v_lshlrev_b32 v52, 2, v1
    ds_read_b32 v64, v52 offset:17408
    v_mov_b32 v53, 0
    s_lshl_b32 s22, s3, 5
    s_add_u32 s22, s22, 143488
    s_mov_b32 s21, 0
    s_waitcnt lgkmcnt(1)
    v_readfirstlane_b32 s20, v55
    v_lshl_add_u32 v55, v55, 2, v52
    s_mov_b64 exec, 0xffff
    ds_write_b32 v55, v53 offset:17408
    s_mov_b64 exec, -1
RK_O:
    v_mov_b32 v65, 0
    v_mov_b32 v54, 0
    s_mov_b32 s23, 0
RK_I:
    ds_read_b128 v[68:71], v54 offset:17408
    ds_read_b128 v[72:75], v54 offset:17424
    ds_read_b128 v[76:79], v54 offset:17440
    ds_read_b128 v[80:83], v54 offset:17456
    v_add_u32 v54, 64, v54
    s_add_u32 s23, s23, 16
    s_waitcnt lgkmcnt(3)
    v_cmp_gt_u32 s[24:25], v68, v64
    v_cmp_gt_u32 s[26:27], v69, v64
    v_cmp_gt_u32 s[28:29], v70, v64
    v_cmp_gt_u32 s[30:31], v71, v64
    v_addc_co_u32 v65, vcc, 0, v65, s[24:25]
    s_nop 1
    v_addc_co_u32 v65, vcc, 0, v65, s[26:27]
    s_nop 1
    v_addc_co_u32 v65, vcc, 0, v65, s[28:29]
    s_nop 1
    v_addc_co_u32 v65, vcc, 0, v65, s[30:31]
    s_waitcnt lgkmcnt(2)
    v_cmp_gt_u32 s[24:25], v72, v64
    v_cmp_gt_u32 s[26:27], v73, v64
    v_cmp_gt_u32 s[28:29], v74, v64
    v_cmp_gt_u32 s[30:31], v75, v64
    v_addc_co_u32 v65, vcc, 0, v65, s[24:25]
    s_nop 1
    v_addc_co_u32 v65, vcc, 0, v65, s[26:27]
    s_nop 1
    v_addc_co_u32 v65, vcc, 0, v65, s[28:29]
    s_nop 1
    v_addc_co_u32 v65, vcc, 0, v65, s[30:31]
    s_waitcnt lgkmcnt(1)
    v_cmp_gt_u32 s[24:25], v76, v64
    v_cmp_gt_u32 s[26:27], v77, v64
    v_cmp_gt_u32 s[28:29], v78, v64
    v_cmp_gt_u32 s[30:31], v79, v64
    v_addc_co_u32 v65, vcc, 0, v65, s[24:25]
    s_nop 1
    v_addc_co_u32 v65, vcc, 0, v65, s[26:27]
    s_nop 1
    v_addc_co_u32 v65, vcc, 0, v65, s[28:29]
    s_nop 1
    v_addc_co_u32 v65, vcc, 0, v65, s[30:31]
    s_waitcnt lgkmcnt(0)
    v_cmp_gt_u32 s[24:25], v80, v64
    v_cmp_gt_u32 s[26:27], v81, v64
    v_cmp_gt_u32 s[28:29], v82, v64
    v_cmp_gt_u32 s[30:31], v83, v64
    v_addc_co_u32 v65, vcc, 0, v65, s[24:25]
    s_nop 1
    v_addc_co_u32 v65, vcc, 0, v65, s[26:27]
    s_nop 1
    v_addc_co_u32 v65, vcc, 0, v65, s[28:29]
    s_nop 1
    v_addc_co_u32 v65, vcc, 0, v65, s[30:31]
    s_cmp_lt_u32 s23, s20
    s_cbranch_scc1 RK_I
    v_add_u32 v66, s21, v1
    v_cmp_gt_u32 vcc, s20, v66
    v_cmp_gt_u32 s[24:25], 8, v65
    s_nop 0
    s_and_b64 exec, vcc, s[24:25]
    v_lshl_add_u32 v65, v65, 2, s22
    ds_write_b32 v65, v64
    s_mov_b64 exec, -1
    s_add_u32 s21, s21, 64
    s_cmp_ge_u32 s21, s20
    s_cbranch_scc1 RK_D
    v_add_u32 v52, 256, v52
    ds_read_b32 v64, v52 offset:17408
    s_branch RK_O
RK_D:
    v_and_b32 v54, 7, v1
    v_lshl_add_u32 v54, v54, 2, s22
    ds_read_b32 v64, v54
    s_mul_i32 s23, s11, 1152
    s_waitcnt lgkmcnt(0)
    v_and_b32 v65, 0x7ff, v64
    v_sub_u32 v65, 2047, v65
    s_cmp_eq_u32 s13, 0
    s_cbranch_scc1 NOAF
    s_movk_i32 s20, 1152
    v_lshrrev_b32 v52, 4, v1
    v_lshlrev_b32 v52, 4, v52
    s_lshl_b32 s21, s9, 6
    s_add_u32 s21, s21, 4194304
    v_mad_u32_u24 v52, v65, s20, v52
    v_add_u32 v52, s21, v52
    s_movk_i32 s21, 1024
    s_cmp_ge_u32 s9, 2
    s_cselect_b32 s21, 768, s21
    v_add_u32 v53, s21, v52
    global_load_dwordx4 v[68:71], v52, s[68:69]
    global_load_dwordx4 v[72:75], v52, s[68:69] offset:256
    global_load_dwordx4 v[76:79], v52, s[68:69] offset:512
    global_load_dwordx4 v[80:83], v52, s[68:69] offset:768
    global_load_dwordx4 v[84:87], v53, s[68:69]
NOAF:
    v_cmp_eq_u32 vcc, s11, v65
    s_cbranch_vccnz OWN_SEL
    v_add_u32 v54, s23, v7
    v_add_u32 v55, s23, v13
    global_store_dwordx4 v54, v[8:11], s[64:65]
    global_store_short v55, v12, s[64:65]
    s_branch OWN_D
OWN_SEL:
    s_ff1_i32_b64 s20, vcc
    s_mul_i32 s20, s20, 1152
    s_add_u32 s20, s20, 22528
    v_add_u32 v54, s20, v7
    v_add_u32 v55, s20, v13
    global_store_dwordx4 v54, v[2:5], s[68:69] sc1
    global_store_short v55, v6, s[68:69] sc1
OWN_D:
    s_cmp_eq_u32 s13, 0
    s_cbranch_scc1 S4PRE
    s_waitcnt vmcnt(2)
AFP:
    v_max3_u32 v88, v68, v69, v70
    v_max3_u32 v88, v88, v71, v72
    v_max3_u32 v88, v88, v73, v74
    v_max3_u32 v88, v88, v75, v76
    v_max3_u32 v88, v88, v77, v78
    v_max3_u32 v88, v88, v79, v80
    v_max3_u32 v88, v88, v81, v82
    v_max3_u32 v88, v88, v83, v84
    v_max3_u32 v88, v88, v85, v86
    v_max_u32 v88, v88, v87
    v_cmp_eq_u32 vcc, -1, v88
    s_cbranch_vccz AFPD
    s_mov_b64 exec, vcc
    global_load_dwordx4 v[68:71], v52, s[68:69] sc1
    global_load_dwordx4 v[72:75], v52, s[68:69] offset:256 sc1
    global_load_dwordx4 v[76:79], v52, s[68:69] offset:512 sc1
    global_load_dwordx4 v[80:83], v52, s[68:69] offset:768 sc1
    global_load_dwordx4 v[84:87], v53, s[68:69] sc1
    s_mov_b64 exec, -1
    s_waitcnt vmcnt(0)
    s_sub_u32 s10, s10, 1
    s_cbranch_scc1 EXIT
    s_branch AFP
AFPD:
    v_mfma_f32_16x16x32_bf16 v[92:95], v[112:115], v[68:71], 0
    v_mfma_f32_16x16x32_bf16 v[96:99], v[116:119], v[68:71], 0
    v_mfma_f32_16x16x32_bf16 v[100:103], v[120:123], v[68:71], 0
    v_mfma_f32_16x16x32_bf16 v[104:107], v[124:127], v[68:71], 0
    v_mfma_f32_16x16x32_bf16 v[92:95], v[128:131], v[72:75], v[92:95]
    v_mfma_f32_16x16x32_bf16 v[96:99], v[132:135], v[72:75], v[96:99]
    v_mfma_f32_16x16x32_bf16 v[100:103], v[136:139], v[72:75], v[100:103]
    v_mfma_f32_16x16x32_bf16 v[104:107], v[140:143], v[72:75], v[104:107]
    v_mfma_f32_16x16x32_bf16 v[92:95], v[144:147], v[76:79], v[92:95]
    v_mfma_f32_16x16x32_bf16 v[96:99], v[148:151], v[76:79], v[96:99]
    v_mfma_f32_16x16x32_bf16 v[100:103], v[152:155], v[76:79], v[100:103]
    v_mfma_f32_16x16x32_bf16 v[104:107], v[156:159], v[76:79], v[104:107]
    v_mfma_f32_16x16x32_bf16 v[92:95], v[160:163], v[80:83], v[92:95]
    v_mfma_f32_16x16x32_bf16 v[96:99], v[164:167], v[80:83], v[96:99]
    v_mfma_f32_16x16x32_bf16 v[100:103], v[168:171], v[80:83], v[100:103]
    v_mfma_f32_16x16x32_bf16 v[104:107], v[172:175], v[80:83], v[104:107]
    s_cmp_ge_u32 s9, 2
    s_cbranch_scc1 MF4
    v_mfma_f32_16x16x32_bf16 v[92:95], v[176:179], v[84:87], v[92:95]
    v_mfma_f32_16x16x32_bf16 v[96:99], v[180:183], v[84:87], v[96:99]
    v_mfma_f32_16x16x32_bf16 v[100:103], v[184:187], v[84:87], v[100:103]
    v_mfma_f32_16x16x32_bf16 v[104:107], v[188:191], v[84:87], v[104:107]
MF4:
    s_mul_i32 s20, s9, 4608
    v_lshl_add_u32 v52, v1, 4, s20
    v_lshrrev_b32 v53, 4, v1
    s_movk_i32 s20, 1152
    v_mul_u32_u24 v54, s20, v53
    v_and_b32 v55, 7, v1
    v_lshl_add_u32 v54, v55, 4, v54
    v_and_b32 v55, 8, v1
    v_lshl_add_u32 v54, v55, 5, v54
    v_cmp_eq_u32 s[24:25], 0, v55
    s_nop 4
    ds_write_b128 v52, v[92:95] offset:27648
    ds_write_b128 v52, v[96:99] offset:28800
    ds_write_b128 v52, v[100:103] offset:29952
    ds_write_b128 v52, v[104:107] offset:31104
    s_waitcnt lgkmcnt(0)
    s_barrier
    ds_read_b128 v[64:67], v54 offset:27648
    ds_read_b128 v[68:71], v54 offset:28160
    ds_read_b128 v[72:75], v54 offset:32256
    ds_read_b128 v[76:79], v54 offset:32768
    ds_read_b128 v[80:83], v54 offset:36864
    ds_read_b128 v[84:87], v54 offset:37376
    ds_read_b128 v[88:91], v54 offset:41472
    ds_read_b128 v[92:95], v54 offset:41984
    v_and_b32 v53, 1, v53
    s_mov_b32 s20, 1327104
    v_mul_u32_u24 v53, s20, v53
    v_lshrrev_b32 v55, 3, v55
    s_movk_i32 s20, 18432
    v_mad_u32_u24 v53, v55, s20, v53
    v_and_b32 v55, 7, v1
    v_lshl_add_u32 v53, v55, 4, v53
    s_lshl_b32 s20, s8, 7
    s_add_u32 s20, s20, 7340032
    v_add_u32 v53, s20, v53
    s_mul_i32 s21, s9, 147456
    s_waitcnt lgkmcnt(4)
    v_pk_add_f32 v[64:65], v[64:65], v[72:73]
    v_pk_add_f32 v[66:67], v[66:67], v[74:75]
    v_pk_add_f32 v[68:69], v[68:69], v[76:77]
    v_pk_add_f32 v[70:71], v[70:71], v[78:79]
    s_waitcnt lgkmcnt(0)
    v_pk_add_f32 v[80:81], v[80:81], v[88:89]
    v_pk_add_f32 v[82:83], v[82:83], v[90:91]
    v_pk_add_f32 v[84:85], v[84:85], v[92:93]
    v_pk_add_f32 v[86:87], v[86:87], v[94:95]
    v_pk_add_f32 v[64:65], v[64:65], v[80:81]
    v_pk_add_f32 v[66:67], v[66:67], v[82:83]
    v_pk_add_f32 v[68:69], v[68:69], v[84:85]
    v_pk_add_f32 v[70:71], v[70:71], v[86:87]
    v_cvt_pk_bf16_f32 v72, v64, v65
    v_cvt_pk_bf16_f32 v73, v66, v67
    v_cvt_pk_bf16_f32 v74, v68, v69
    v_cvt_pk_bf16_f32 v75, v70, v71
    v_lshlrev_b32 v64, 16, v72
    v_and_b32 v65, s12, v72
    v_lshlrev_b32 v66, 16, v73
    v_and_b32 v67, s12, v73
    v_lshlrev_b32 v68, 16, v74
    v_and_b32 v69, s12, v74
    v_lshlrev_b32 v70, 16, v75
    v_and_b32 v71, s12, v75
    v_mul_f32 v72, 0xbfb8aa3b, v64
    v_exp_f32 v72, v72
    v_mul_f32 v73, 0xbfb8aa3b, v65
    v_exp_f32 v73, v73
    v_mul_f32 v74, 0xbfb8aa3b, v66
    v_exp_f32 v74, v74
    v_mul_f32 v75, 0xbfb8aa3b, v67
    v_exp_f32 v75, v75
    v_add_f32 v72, 1.0, v72
    v_rcp_f32 v72, v72
    v_add_f32 v73, 1.0, v73
    v_rcp_f32 v73, v73
    v_add_f32 v74, 1.0, v74
    v_rcp_f32 v74, v74
    v_add_f32 v75, 1.0, v75
    v_rcp_f32 v75, v75
    v_pk_mul_f32 v[64:65], v[64:65], v[72:73]
    v_pk_mul_f32 v[66:67], v[66:67], v[74:75]
    v_cvt_pk_bf16_f32 v72, v64, v65
    v_cvt_pk_bf16_f32 v73, v66, v67
    v_lshlrev_b32 v64, 16, v72
    v_and_b32 v65, s12, v72
    v_lshlrev_b32 v66, 16, v73
    v_and_b32 v67, s12, v73
    v_pk_mul_f32 v[64:65], v[64:65], v[68:69]
    v_pk_mul_f32 v[66:67], v[66:67], v[70:71]
    v_cvt_pk_bf16_f32 v72, v64, v65
    v_cvt_pk_bf16_f32 v73, v66, v67
    s_nop 0
    v_mov_b32_dpp v74, v72 row_ror:8 row_mask:0xf bank_mask:0xf
    v_mov_b32_dpp v75, v73 row_ror:8 row_mask:0xf bank_mask:0xf
    v_cndmask_b32 v76, v74, v72, s[24:25]
    v_cndmask_b32 v77, v75, v73, s[24:25]
    v_cndmask_b32 v78, v72, v74, s[24:25]
    v_cndmask_b32 v79, v73, v75, s[24:25]
    s_nop 1
    v_mfma_f32_16x16x32_bf16 v[80:83], v[76:79], v[192:195], 0
    v_mfma_f32_16x16x32_bf16 v[84:87], v[76:79], v[196:199], 0
    v_mfma_f32_16x16x32_bf16 v[88:91], v[76:79], v[200:203], 0
    v_mfma_f32_16x16x32_bf16 v[92:95], v[76:79], v[204:207], 0
    v_mfma_f32_16x16x32_bf16 v[96:99], v[76:79], v[208:211], 0
    v_mfma_f32_16x16x32_bf16 v[100:103], v[76:79], v[212:215], 0
    v_mfma_f32_16x16x32_bf16 v[104:107], v[76:79], v[216:219], 0
    v_mfma_f32_16x16x32_bf16 v[108:111], v[76:79], v[220:223], 0
    s_mov_b32 exec_hi, 0
    v_add_u32 v52, s21, v53
    global_store_dwordx4 v52, v[80:83], s[68:69] sc1
    v_add_u32 v52, 36864, v52
    global_store_dwordx4 v52, v[84:87], s[68:69] sc1
    v_add_u32 v52, 36864, v52
    global_store_dwordx4 v52, v[88:91], s[68:69] sc1
    v_add_u32 v52, 36864, v52
    global_store_dwordx4 v52, v[92:95], s[68:69] sc1
    s_add_u32 s21, s21, 589824
    v_add_u32 v52, s21, v53
    global_store_dwordx4 v52, v[96:99], s[68:69] sc1
    v_add_u32 v52, 36864, v52
    global_store_dwordx4 v52, v[100:103], s[68:69] sc1
    v_add_u32 v52, 36864, v52
    global_store_dwordx4 v52, v[104:107], s[68:69] sc1
    v_add_u32 v52, 36864, v52
    global_store_dwordx4 v52, v[108:111], s[68:69] sc1
    s_mov_b32 exec_hi, -1
    s_cmp_lg_u32 s9, 3
    s_cbranch_scc1 NOB8
    v_mfma_f32_16x16x32_bf16 v[80:83], v[76:79], v[224:227], 0
    v_mfma_f32_16x16x32_bf16 v[84:87], v[76:79], v[228:231], 0
    v_mfma_f32_16x16x32_bf16 v[88:91], v[76:79], v[232:235], 0
    v_mfma_f32_16x16x32_bf16 v[92:95], v[76:79], v[236:239], 0
    s_mov_b32 s21, 1179648
    s_mov_b32 exec_hi, 0
    v_add_u32 v52, s21, v53
    s_nop 1
    global_store_dwordx4 v52, v[80:83], s[68:69] sc1
    v_add_u32 v52, 36864, v52
    global_store_dwordx4 v52, v[84:87], s[68:69] sc1
    v_add_u32 v52, 36864, v52
    global_store_dwordx4 v52, v[88:91], s[68:69] sc1
    v_add_u32 v52, 36864, v52
    global_store_dwordx4 v52, v[92:95], s[68:69] sc1
NOB8:
    s_mov_b32 exec_hi, -1
    s_mov_b32 s8, s6
    s_cmp_lt_u32 s5, 18
    s_cbranch_scc1 S4
    s_branch FIN
S4PRE:
    s_cmp_ge_u32 s5, 18
    s_cbranch_scc1 FIN
    s_cmp_lt_u32 s5, 14
    s_cbranch_scc1 S4PRE2
    s_barrier
S4PRE2:
    s_mov_b32 s8, s6
    s_cmp_lg_u32 s3, 0
    s_cbranch_scc1 S4
    s_cmp_ge_u32 s8, 72
    s_cselect_b32 s20, 1, 0
    s_mul_i32 s21, s20, 72
    s_sub_u32 s21, s8, s21
    s_lshr_b32 s23, s21, 3
    s_lshl_b32 s23, s23, 6
    s_and_b32 s24, s21, 1
    s_lshl_b32 s24, s24, 5
    s_add_u32 s23, s23, s24
    s_bfe_u32 s24, s21, 0x20001
    s_add_u32 s23, s23, s24
    s_lshl_b32 s23, s23, 1
    v_and_b32 v52, 7, v1
    v_lshl_add_u32 v52, v52, 3, s23
    v_lshrrev_b32 v53, 4, v1
    v_lshl_add_u32 v53, s20, 2, v53
    v_lshl_add_u32 v54, v53, 2, s22
    ds_read_b32 v40, v54
    s_movk_i32 s20, 1152
    v_mad_u32_u24 v41, v53, s20, v52
    v_add_u32 v41, 22528, v41
    v_add_u32 v42, 13952, v52
    s_movk_i32 s20, 1152
    s_waitcnt lgkmcnt(0)
    v_and_b32 v43, 0x7ff, v40
    v_sub_u32 v43, 2047, v43
    v_mad_u32_u24 v43, v43, s20, v52
    v_add_u32 v44, 4194304, v43
    v_ashrrev_i32 v45, 31, v40
    v_not_b32 v45, v45
    v_or_b32 v45, 0x80000000, v45
    v_xor_b32 v45, v45, v40
    v_and_b32 v45, s12, v45
    v_mul_f32 v45, 0xbfb8aa3b, v45
    v_exp_f32 v45, v45
    s_nop 0
    v_add_f32 v45, 1.0, v45
    v_rcp_f32 v45, v45
    s_nop 0
    v_cvt_pk_bf16_f32 v45, v45, v45
    v_and_b32 v45, s12, v45
XP:
    global_load_ushort v46, v41, s[68:69] sc1
    global_load_ushort v47, v44, s[68:69] sc1
    global_load_ushort v48, v42, s[68:69] sc1
    s_waitcnt vmcnt(0)
    v_max_u32 v49, v46, v47
    v_cmp_eq_u32 vcc, 0xffff, v49
    s_cbranch_vccz XPD
    s_sub_u32 s10, s10, 1
    s_cbranch_scc1 EXIT
    s_branch XP
XPD:
    v_lshlrev_b32 v46, 16, v46
    v_lshlrev_b32 v47, 16, v47
    v_lshlrev_b32 v48, 16, v48
S4:
    s_mul_i32 s20, s8, 18432
    s_add_u32 s20, s20, 7340032
    v_lshl_add_u32 v52, v0, 4, s20
    v_add_u32 v53, 8192, v52
    v_add_u32 v54, 16384, v52
    v_mov_b32 v72, 0
    v_mov_b32 v73, 0
    v_mov_b32 v74, 0
    v_mov_b32 v75, 0
    v_lshrrev_b32 v55, 4, v1
    v_and_b32 v56, 7, v1
    v_lshl_add_u32 v55, v55, 3, v56
    v_lshlrev_b32 v55, 2, v55
    s_lshl_b32 s20, s3, 7
    v_add_u32 v56, s20, v55
    s_cmp_lg_u32 s3, 1
    s_cbranch_scc1 TRD
    s_mul_i32 s20, s8, 18432
    s_add_u32 s20, s20, 7348224
    v_mov_b32 v57, s20
TRP:
    global_load_dword v58, v57, s[68:69] sc1
    s_waitcnt vmcnt(0)
    v_cmp_eq_u32 vcc, -1, v58
    s_cbranch_vccz TRD
    s_sub_u32 s10, s10, 1
    s_cbranch_scc1 EXIT
    s_branch TRP
TRD:
    s_barrier
PP:
    global_load_dwordx4 v[64:67], v52, s[68:69] sc1
    global_load_dwordx4 v[68:71], v53, s[68:69] sc1
    s_cmp_ge_u32 s3, 2
    s_cbranch_scc1 PP2
    global_load_dwordx4 v[72:75], v54, s[68:69] sc1
PP2:
    s_waitcnt vmcnt(0)
    v_max3_u32 v76, v64, v65, v66
    v_max3_u32 v76, v76, v67, v68
    v_max3_u32 v76, v76, v69, v70
    v_max3_u32 v76, v76, v71, v72
    v_max3_u32 v76, v76, v73, v74
    v_max_u32 v76, v76, v75
    v_cmp_eq_u32 vcc, -1, v76
    s_cbranch_vccz PPD
    s_sub_u32 s10, s10, 1
    s_cbranch_scc1 EXIT
    s_branch PP
PPD:
    v_pk_add_f32 v[64:65], v[64:65], v[68:69]
    v_pk_add_f32 v[66:67], v[66:67], v[70:71]
    v_pk_add_f32 v[64:65], v[64:65], v[72:73]
    v_pk_add_f32 v[66:67], v[66:67], v[74:75]
    s_nop 1
    v_permlane32_swap_b32 v64, v66
    v_permlane32_swap_b32 v65, v67
    v_pk_add_f32 v[64:65], v[64:65], v[66:67]
    s_nop 1
    v_permlane16_swap_b32 v64, v65
    v_add_f32 v64, v64, v65
    s_nop 1
    v_add_f32_dpp v64, v64, v64 row_ror:8 row_mask:0xf bank_mask:0xf
    s_mov_b32 exec_lo, 0x00ff00ff
    s_mov_b32 exec_hi, 0x00ff00ff
    ds_write_b32 v56, v64 offset:26624
    s_waitcnt lgkmcnt(0)
    s_barrier
    s_cmp_lg_u32 s3, 0
    s_cbranch_scc1 FIN
    ds_read_b32 v64, v55 offset:26624
    ds_read_b32 v65, v55 offset:26752
    ds_read_b32 v66, v55 offset:26880
    ds_read_b32 v67, v55 offset:27008
    ds_read_b32 v68, v55 offset:27136
    ds_read_b32 v69, v55 offset:27264
    ds_read_b32 v70, v55 offset:27392
    ds_read_b32 v71, v55 offset:27520
    s_waitcnt lgkmcnt(0)
    v_pk_add_f32 v[64:65], v[64:65], v[68:69]
    v_pk_add_f32 v[66:67], v[66:67], v[70:71]
    v_pk_add_f32 v[64:65], v[64:65], v[66:67]
    v_add_f32 v64, v64, v65
    v_cvt_pk_bf16_f32 v64, v64, v64
    v_and_b32 v64, s12, v64
    v_mul_f32 v64, v64, v45
    v_cvt_pk_bf16_f32 v64, v64, v64
    v_and_b32 v64, s12, v64
    v_add_f32 v64, v64, v47
    v_cvt_pk_bf16_f32 v64, v64, v64
    v_and_b32 v64, s12, v64
    v_mul_f32 v64, v64, v48
    v_cvt_pk_bf16_f32 v64, v64, v64
    v_and_b32 v64, s12, v64
    v_add_f32 v64, v64, v46
    v_cvt_pk_bf16_f32 v64, v64, v64
    global_store_short v43, v64, s[64:65] sc1
FIN:
EXIT:
    s_endpgm
CODE_END:
.section .rodata,"a"
.p2align 6
.amdhsa_kernel adaLN_cond__ssm_conv_s4d__moe_arch_mod__prompt_kernel
  .amdhsa_next_free_vgpr 256
  .amdhsa_next_free_sgpr 102
  .amdhsa_accum_offset 256
  .amdhsa_group_segment_fixed_size 0
  .amdhsa_kernarg_size 136
  .amdhsa_user_sgpr_count 2
  .amdhsa_user_sgpr_kernarg_segment_ptr 1
  .amdhsa_system_sgpr_workgroup_id_x 1
.end_amdhsa_kernel
```

```asm
; @launch grid=(256,1,1) block=(512,1,1) lds=163456
.amdgcn_target "amdgcn-amd-amdhsa--gfx950"
.text
.globl adaLN_cond__ssm_conv_s4d__moe_arch_mod__prompt_kernel
.p2align 8
.type adaLN_cond__ssm_conv_s4d__moe_arch_mod__prompt_kernel,@function
adaLN_cond__ssm_conv_s4d__moe_arch_mod__prompt_kernel:
    s_cmp_ge_u32 s2, 256
    s_cbranch_scc1 EXIT
    s_load_dwordx16 s[36:51], s[0:1], 0
    s_load_dwordx16 s[52:67], s[0:1], 64
    s_load_dwordx2 s[68:69], s[0:1], 128
    v_lshrrev_b32 v2, 6, v0
    v_and_b32 v1, 63, v0
    v_readfirstlane_b32 s3, v2
    s_and_b32 s4, s2, 7
    s_lshr_b32 s5, s2, 3
    s_mul_i32 s6, s4, 18
    s_add_u32 s6, s6, s5
    s_sub_u32 s20, s5, 18
    s_and_b32 s21, s20, 1
    s_lshr_b32 s20, s20, 1
    s_lshl_b32 s20, s20, 4
    s_lshl1_add_u32 s7, s4, s21
    s_add_u32 s7, s7, s20
    s_and_b32 s9, s3, 3
    s_mov_b32 s8, s6
    s_cmp_lt_u32 s5, 18
    s_cselect_b32 s13, 1, 0
    s_cmp_ge_u32 s3, 4
    s_cselect_b32 s13, s13, 0
    s_mov_b32 s10, 0x20000
    s_mov_b32 s12, 0xffff0000
    s_lshl_b32 s11, s2, 3
    s_add_u32 s11, s11, s3
    v_lshlrev_b32 v7, 4, v1
    v_lshlrev_b32 v13, 1, v1
    v_add_u32 v13, 1024, v13
    s_cmp_lt_u32 s3, 4
    s_cbranch_scc1 ENT_A
ENT_B:
    s_cmp_lg_u32 s3, 4
    s_cbranch_scc1 ENT_B2
    v_lshlrev_b32 v64, 2, v1
    v_add_u32 v64, 143488, v64
    v_cmp_gt_u32 vcc, 16, v1
    s_nop 1
    v_cndmask_b32 v65, -1, 0, vcc
    s_mov_b32 exec_hi, 0
    ds_write_b32 v64, v65
    s_mov_b32 exec_hi, -1
ENT_B2:
    s_cmp_ge_u32 s5, 18
    s_cbranch_scc0 CONV_B
    s_branch NONCONV
ENT_A:
    s_cmp_lg_u32 s3, 3
    s_cbranch_scc1 ENT_A2
    s_getpc_b64 s[20:21]
PCREF:
    s_lshl_b32 s22, s5, 10
    v_add_u32 v64, s22, v7
    v_min_u32 v64, CODE_END-PCREF-16, v64
    v_mov_b32 v65, 0
    v_lshl_add_u64 v[64:65], v[64:65], 0, s[20:21]
    global_load_dwordx4 v[240:243], v[64:65], off
ENT_A2:
    s_cmp_ge_u32 s5, 18
    s_cbranch_scc1 NONCONV
    s_lshl_b32 s20, s6, 2
    s_add_u32 s20, s20, s3
    s_lshl_b32 s21, s20, 8
    v_lshl_add_u32 v64, v1, 2, s21
    s_lshl_b32 s14, s20, 1
    v_mov_b32 v65, s14
    s_mul_i32 s15, s3, 31232
    s_waitcnt lgkmcnt(0)
    global_load_ushort v70, v65, s[46:47]
    global_load_dword v66, v64, s[38:39] nt
    global_load_dword v67, v64, s[40:41] nt
    global_load_dword v68, v64, s[42:43] nt
    global_load_dword v69, v64, s[44:45] nt
    global_load_ushort v71, v65, s[48:49]
    global_load_dwordx4 v[8:11], v7, s[52:53]
    global_load_ushort v12, v13, s[52:53]
    s_barrier
    s_load_dword s99, s[68:69], 94208
    v_lshl_add_u32 v224, v1, 3, s15
    v_bfe_u32 v72, v1, 2, 3
    v_mov_b32 v73, 0
    v_cmp_eq_u32 vcc, 0, v72
    v_mov_b32 v74, 0x3020100
    s_nop 0
    v_cndmask_b32 v73, v73, v74, vcc
    v_cmp_eq_u32 vcc, 1, v72
    v_mov_b32 v74, 0x6050404
    s_nop 0
    v_cndmask_b32 v73, v73, v74, vcc
    v_cmp_eq_u32 vcc, 2, v72
    v_mov_b32 v74, 0xa090807
    s_nop 0
    v_cndmask_b32 v73, v73, v74, vcc
    v_cmp_eq_u32 vcc, 3, v72
    v_mov_b32 v74, 0xc0b0606
    s_nop 0
    v_cndmask_b32 v73, v73, v74, vcc
    v_cmp_eq_u32 vcc, 4, v72
    v_mov_b32 v74, 0xf0f0e0d
    s_nop 0
    v_cndmask_b32 v73, v73, v74, vcc
    v_cmp_eq_u32 vcc, 5, v72
    v_mov_b32 v74, 0x12121110
    s_nop 0
    v_cndmask_b32 v73, v73, v74, vcc
    v_cmp_eq_u32 vcc, 6, v72
    v_mov_b32 v74, 0x16151413
    s_nop 0
    v_cndmask_b32 v73, v73, v74, vcc
    v_cmp_eq_u32 vcc, 7, v72
    v_mov_b32 v74, 0x1a191817
    s_nop 0
    v_cndmask_b32 v73, v73, v74, vcc
    v_and_b32 v72, 3, v1
    v_lshlrev_b32 v72, 3, v72
    v_bfe_u32 v73, v73, v72, 8
    v_lshrrev_b32 v72, 5, v1
    v_lshl_add_u32 v72, v72, 4, s15
    s_movk_i32 s20, 528
    v_mad_u32_u24 v225, v73, s20, v72
    v_and_b32 v73, 31, v1
    v_add_u32 v73, 27, v73
    v_mad_u32_u24 v226, v73, s20, v72
    v_lshlrev_b32 v72, 4, v1
    v_sub_u32 v227, 1008, v72
    v_add_u32 v227, s15, v227
    v_and_b32 v72, 3, v1
    v_sub_u32 v72, 3, v72
    s_movk_i32 s20, 4160
    v_mul_u32_u24 v72, s20, v72
    v_bfe_u32 v73, v1, 2, 2
    v_sub_u32 v73, 3, v73
    v_lshl_add_u32 v72, v73, 3, v72
    v_lshrrev_b32 v73, 4, v1
    v_lshl_add_u32 v72, v73, 4, v72
    v_add_u32 v228, s15, v72
    v_and_b32 v72, 15, v1
    v_lshlrev_b32 v72, 5, v72
    v_lshl_add_u32 v74, v73, 4, v72
    s_mul_i32 s20, s3, 4640
    s_add_u32 s20, s20, 124928
    v_add_u32 v229, s20, v74
    v_lshl_add_u32 v74, v73, 3, v72
    s_lshl_b32 s20, s3, 6
    s_add_u32 s20, s20, s15
    v_add_u32 v230, s20, v74
    s_mov_b32 s16, 0x3fb8aa3b
    s_mov_b32 s17, 0x3e22f983
    s_waitcnt vmcnt(6)
    v_lshlrev_b32 v70, 16, v70
    v_mul_f32 v70, s16, v70
    v_exp_f32 v70, v70
    v_lshlrev_b32 v74, 16, v66
    v_and_b32 v75, s12, v66
    v_mul_f32 v74, s16, v74
    v_mul_f32 v75, s16, v75
    v_exp_f32 v74, v74
    v_exp_f32 v75, v75
    v_cvt_pk_bf16_f32 v70, v70, v70
    v_and_b32 v70, s12, v70
    v_cvt_pk_bf16_f32 v74, v74, v75
    v_and_b32 v75, s12, v74
    v_lshlrev_b32 v74, 16, v74
    v_mul_f32 v74, v74, v70
    v_mul_f32 v75, v75, v70
    v_mul_f32 v74, 0xbfb8aa3b, v74
    v_mul_f32 v75, 0xbfb8aa3b, v75
    s_waitcnt vmcnt(5)
    v_lshlrev_b32 v76, 16, v67
    v_and_b32 v77, s12, v67
    v_mul_f32 v76, v76, v70
    v_mul_f32 v77, v77, v70
    v_mul_f32 v76, s17, v76
    v_mul_f32 v77, s17, v77
    v_exp_f32 v96, v74
    v_fract_f32 v97, v76
    v_cos_f32 v98, v97
    v_sin_f32 v99, v97
    v_exp_f32 v100, v75
    v_fract_f32 v101, v77
    v_cos_f32 v102, v101
    v_sin_f32 v103, v101
    v_mul_f32 v84, v96, v98
    v_mul_f32 v86, v96, v99
    v_mul_f32 v85, v100, v102
    v_mul_f32 v87, v100, v103
    v_mul_f32 v96, 0x41000000, v74
    v_mul_f32 v97, 0x41000000, v76
    v_exp_f32 v96, v96
    v_fract_f32 v97, v97
    v_cos_f32 v98, v97
    v_sin_f32 v99, v97
    v_mul_f32 v100, 0x41000000, v75
    v_mul_f32 v101, 0x41000000, v77
    v_exp_f32 v100, v100
    v_fract_f32 v101, v101
    v_cos_f32 v102, v101
    v_sin_f32 v103, v101
    v_mul_f32 v88, v96, v98
    v_mul_f32 v90, v96, v99
    v_mul_f32 v89, v100, v102
    v_mul_f32 v91, v100, v103
    v_mul_f32 v96, 0x43800000, v74
    v_mul_f32 v97, 0x43800000, v76
    v_exp_f32 v96, v96
    v_fract_f32 v97, v97
    v_cos_f32 v98, v97
    v_sin_f32 v99, v97
    v_mul_f32 v100, 0x43800000, v75
    v_mul_f32 v101, 0x43800000, v77
    v_exp_f32 v100, v100
    v_fract_f32 v101, v101
    v_cos_f32 v102, v101
    v_sin_f32 v103, v101
    v_mul_f32 v92, v96, v98
    v_mul_f32 v94, v96, v99
    v_mul_f32 v93, v100, v102
    v_mul_f32 v95, v100, v103
    s_waitcnt vmcnt(2)
    v_lshlrev_b32 v78, 16, v68
    v_and_b32 v79, s12, v68
    v_lshlrev_b32 v80, 16, v69
    v_and_b32 v81, s12, v69
    v_max_f32 v82, |v78|, |v79|
    v_max3_f32 v82, |v80|, |v81|, v82
    s_nop 1
    v_max_f32_dpp v82, v82, v82 row_ror:8 row_mask:0xf bank_mask:0xf
    s_nop 1
    v_max_f32_dpp v82, v82, v82 row_ror:4 row_mask:0xf bank_mask:0xf
    s_nop 1
    v_max_f32_dpp v82, v82, v82 row_ror:2 row_mask:0xf bank_mask:0xf
    s_nop 1
    v_max_f32_dpp v82, v82, v82 row_ror:1 row_mask:0xf bank_mask:0xf
    v_mov_b32 v83, v82
    s_nop 1
    v_permlane16_swap_b32 v82, v83
    v_max_f32 v82, v82, v83
    v_mov_b32 v83, v82
    s_nop 1
    v_permlane32_swap_b32 v82, v83
    v_max_f32 v82, v82, v83
    v_max_f32 v82, 0x0da24260, v82
    v_rcp_f32 v83, v82
    v_lshlrev_b32 v71, 16, v71
    v_mul_f32 v82, v82, v70
    v_add_f32 v82, v82, v82
    v_and_b32 v72, 0x7fffffff, v71
    v_mul_f32 v72, 0x3a800000, v72
    v_max_f32 v72, v72, v82
    v_max_f32 v72, 0x0da24260, v72
    v_rcp_f32 v73, v72
    v_mov_b32 v233, v72
    v_mul_f32 v231, v82, v73
    v_mul_f32 v232, v71, v73
    v_pk_mul_f32 v[104:105], v[78:79], v[82:83] op_sel:[0,1] op_sel_hi:[1,1]
    v_pk_mul_f32 v[106:107], v[80:81], v[82:83] op_sel:[0,1] op_sel_hi:[1,1]
    v_mov_b32 v148, 0x3c00
    v_cvt_pk_f16_f32 v144, v104, v106
    v_mov_b32 v149, 0x3c00
    v_cvt_pk_f16_f32 v145, v105, v107
    ds_write_b64 v224, v[148:149] offset:14256
    ds_write_b64 v224, v[144:145] offset:0
    v_pk_mul_f32 v[128:129], v[88:89], 1.0 op_sel_hi:[1,0]
    v_pk_mul_f32 v[136:137], v[106:107], v[86:87]
    v_pk_mul_f32 v[130:131], v[90:91], -1.0 op_sel_hi:[1,0]
    v_pk_mul_f32 v[138:139], v[106:107], v[84:85]
    v_cvt_pk_f16_f32 v150, v128, v130
    v_pk_fma_f32 v[126:127], v[104:105], v[86:87], v[138:139]
    v_cvt_pk_f16_f32 v151, v129, v131
    v_pk_fma_f32 v[124:125], v[104:105], v[84:85], v[136:137] neg_lo:[0,0,1] neg_hi:[0,0,1]
    ds_write_b64 v224, v[150:151] offset:14784
    v_cvt_pk_f16_f32 v146, v124, v126
    v_pk_mul_f32 v[140:141], v[130:131], v[90:91]
    v_cvt_pk_f16_f32 v147, v125, v127
    v_pk_mul_f32 v[142:143], v[130:131], v[88:89]
    ds_write_b64 v224, v[146:147] offset:528
    v_pk_fma_f32 v[130:131], v[128:129], v[90:91], v[142:143] neg_lo:[0,1,0] neg_hi:[0,1,0]
    v_pk_mul_f32 v[136:137], v[126:127], v[86:87]
    v_pk_fma_f32 v[128:129], v[128:129], v[88:89], v[140:141]
    v_pk_mul_f32 v[138:139], v[126:127], v[84:85]
    v_cvt_pk_f16_f32 v148, v128, v130
    v_pk_fma_f32 v[110:111], v[124:125], v[86:87], v[138:139]
    v_cvt_pk_f16_f32 v149, v129, v131
    v_pk_fma_f32 v[108:109], v[124:125], v[84:85], v[136:137] neg_lo:[0,0,1] neg_hi:[0,0,1]
    ds_write_b64 v224, v[148:149] offset:15312
    v_cvt_pk_f16_f32 v144, v108, v110
    v_pk_mul_f32 v[140:141], v[130:131], v[90:91]
    v_cvt_pk_f16_f32 v145, v109, v111
    v_pk_mul_f32 v[142:143], v[130:131], v[88:89]
    ds_write_b64 v224, v[144:145] offset:1056
    v_pk_fma_f32 v[130:131], v[128:129], v[90:91], v[142:143] neg_lo:[0,1,0] neg_hi:[0,1,0]
    v_pk_mul_f32 v[136:137], v[110:111], v[86:87]
    v_pk_fma_f32 v[128:129], v[128:129], v[88:89], v[140:141]
    v_pk_mul_f32 v[138:139], v[110:111], v[84:85]
    v_cvt_pk_f16_f32 v150, v128, v130
    v_pk_fma_f32 v[126:127], v[108:109], v[86:87], v[138:139]
    v_cvt_pk_f16_f32 v151, v129, v131
    v_pk_fma_f32 v[124:125], v[108:109], v[84:85], v[136:137] neg_lo:[0,0,1] neg_hi:[0,0,1]
    ds_write_b64 v224, v[150:151] offset:15840
    v_cvt_pk_f16_f32 v146, v124, v126
    v_pk_mul_f32 v[140:141], v[130:131], v[90:91]
    v_cvt_pk_f16_f32 v147, v125, v127
    v_pk_mul_f32 v[142:143], v[130:131], v[88:89]
    ds_write_b64 v224, v[146:147] offset:1584
    v_pk_fma_f32 v[130:131], v[128:129], v[90:91], v[142:143] neg_lo:[0,1,0] neg_hi:[0,1,0]
    v_pk_mul_f32 v[136:137], v[126:127], v[86:87]
    v_pk_fma_f32 v[128:129], v[128:129], v[88:89], v[140:141]
    v_pk_mul_f32 v[138:139], v[126:127], v[84:85]
    v_cvt_pk_f16_f32 v148, v128, v130
    v_pk_fma_f32 v[114:115], v[124:125], v[86:87], v[138:139]
    v_cvt_pk_f16_f32 v149, v129, v131
    v_pk_fma_f32 v[112:113], v[124:125], v[84:85], v[136:137] neg_lo:[0,0,1] neg_hi:[0,0,1]
    ds_write_b64 v224, v[148:149] offset:16368
    v_cvt_pk_f16_f32 v144, v112, v114
    v_pk_mul_f32 v[140:141], v[130:131], v[90:91]
    v_cvt_pk_f16_f32 v145, v113, v115
    v_pk_mul_f32 v[142:143], v[130:131], v[88:89]
    ds_write_b64 v224, v[144:145] offset:3696
    v_pk_fma_f32 v[130:131], v[128:129], v[90:91], v[142:143] neg_lo:[0,1,0] neg_hi:[0,1,0]
    v_pk_mul_f32 v[136:137], v[114:115], v[86:87]
    v_pk_fma_f32 v[128:129], v[128:129], v[88:89], v[140:141]
    v_pk_mul_f32 v[138:139], v[114:115], v[84:85]
    v_cvt_pk_f16_f32 v150, v128, v130
    v_pk_fma_f32 v[126:127], v[112:113], v[86:87], v[138:139]
    v_cvt_pk_f16_f32 v151, v129, v131
    v_pk_fma_f32 v[124:125], v[112:113], v[84:85], v[136:137] neg_lo:[0,0,1] neg_hi:[0,0,1]
    ds_write_b64 v224, v[150:151] offset:16896
    v_cvt_pk_f16_f32 v146, v124, v126
    v_pk_mul_f32 v[140:141], v[130:131], v[90:91]
    v_cvt_pk_f16_f32 v147, v125, v127
    v_pk_mul_f32 v[142:143], v[130:131], v[88:89]
    ds_write_b64 v224, v[146:147] offset:4224
    v_pk_fma_f32 v[130:131], v[128:129], v[90:91], v[142:143] neg_lo:[0,1,0] neg_hi:[0,1,0]
    v_pk_mul_f32 v[136:137], v[126:127], v[86:87]
    v_pk_fma_f32 v[128:129], v[128:129], v[88:89], v[140:141]
    v_pk_mul_f32 v[138:139], v[126:127], v[84:85]
    v_cvt_pk_f16_f32 v148, v128, v130
    v_pk_fma_f32 v[118:119], v[124:125], v[86:87], v[138:139]
    v_cvt_pk_f16_f32 v149, v129, v131
    v_pk_fma_f32 v[116:117], v[124:125], v[84:85], v[136:137] neg_lo:[0,0,1] neg_hi:[0,0,1]
    ds_write_b64 v224, v[148:149] offset:17424
    v_cvt_pk_f16_f32 v144, v116, v118
    v_pk_mul_f32 v[140:141], v[130:131], v[90:91]
    v_cvt_pk_f16_f32 v145, v117, v119
    v_pk_mul_f32 v[142:143], v[130:131], v[88:89]
    ds_write_b64 v224, v[144:145] offset:4752
    v_pk_fma_f32 v[130:131], v[128:129], v[90:91], v[142:143] neg_lo:[0,1,0] neg_hi:[0,1,0]
    v_pk_mul_f32 v[136:137], v[118:119], v[86:87]
    v_pk_fma_f32 v[128:129], v[128:129], v[88:89], v[140:141]
    v_pk_mul_f32 v[138:139], v[118:119], v[84:85]
    v_cvt_pk_f16_f32 v150, v128, v130
    v_pk_fma_f32 v[126:127], v[116:117], v[86:87], v[138:139]
    v_cvt_pk_f16_f32 v151, v129, v131
    v_pk_fma_f32 v[124:125], v[116:117], v[84:85], v[136:137] neg_lo:[0,0,1] neg_hi:[0,0,1]
    ds_write_b64 v224, v[150:151] offset:17952
    v_cvt_pk_f16_f32 v146, v124, v126
    v_pk_mul_f32 v[140:141], v[130:131], v[90:91]
    v_cvt_pk_f16_f32 v147, v125, v127
    v_pk_mul_f32 v[142:143], v[130:131], v[88:89]
    ds_write_b64 v224, v[146:147] offset:5280
    v_pk_fma_f32 v[130:131], v[128:129], v[90:91], v[142:143] neg_lo:[0,1,0] neg_hi:[0,1,0]
    v_pk_mul_f32 v[136:137], v[126:127], v[86:87]
    v_pk_fma_f32 v[128:129], v[128:129], v[88:89], v[140:141]
    v_pk_mul_f32 v[138:139], v[126:127], v[84:85]
    v_cvt_pk_f16_f32 v148, v128, v130
    v_pk_fma_f32 v[122:123], v[124:125], v[86:87], v[138:139]
    v_cvt_pk_f16_f32 v149, v129, v131
    v_pk_fma_f32 v[120:121], v[124:125], v[84:85], v[136:137] neg_lo:[0,0,1] neg_hi:[0,0,1]
    ds_write_b64 v224, v[148:149] offset:18480
    v_pk_mul_f32 v[136:137], v[106:107], v[94:95]
    v_pk_mul_f32 v[140:141], v[130:131], v[90:91]
    v_pk_mul_f32 v[138:139], v[106:107], v[92:93]
    v_pk_mul_f32 v[142:143], v[130:131], v[88:89]
    v_pk_fma_f32 v[106:107], v[104:105], v[94:95], v[138:139]
    v_pk_fma_f32 v[130:131], v[128:129], v[90:91], v[142:143] neg_lo:[0,1,0] neg_hi:[0,1,0]
    v_pk_fma_f32 v[104:105], v[104:105], v[92:93], v[136:137] neg_lo:[0,0,1] neg_hi:[0,0,1]
    v_pk_fma_f32 v[128:129], v[128:129], v[88:89], v[140:141]
    v_cvt_pk_f16_f32 v146, v104, v106
    v_cvt_pk_f16_f32 v150, v128, v130
    v_cvt_pk_f16_f32 v147, v105, v107
    v_cvt_pk_f16_f32 v151, v129, v131
    ds_write_b64 v224, v[146:147] offset:2112
    ds_write_b64 v224, v[150:151] offset:19008
    v_pk_mul_f32 v[136:137], v[110:111], v[94:95]
    v_pk_mul_f32 v[140:141], v[130:131], v[90:91]
    v_pk_mul_f32 v[138:139], v[110:111], v[92:93]
    v_pk_mul_f32 v[142:143], v[130:131], v[88:89]
    v_pk_fma_f32 v[110:111], v[108:109], v[94:95], v[138:139]
    v_pk_fma_f32 v[130:131], v[128:129], v[90:91], v[142:143] neg_lo:[0,1,0] neg_hi:[0,1,0]
    v_pk_fma_f32 v[108:109], v[108:109], v[92:93], v[136:137] neg_lo:[0,0,1] neg_hi:[0,0,1]
    v_pk_fma_f32 v[128:129], v[128:129], v[88:89], v[140:141]
    v_cvt_pk_f16_f32 v144, v108, v110
    v_cvt_pk_f16_f32 v148, v128, v130
    v_cvt_pk_f16_f32 v145, v109, v111
    v_cvt_pk_f16_f32 v149, v129, v131
    ds_write_b64 v224, v[144:145] offset:2640
    ds_write_b64 v224, v[148:149] offset:19536
    v_pk_mul_f32 v[136:137], v[114:115], v[94:95]
    v_pk_mul_f32 v[140:141], v[130:131], v[90:91]
    v_pk_mul_f32 v[138:139], v[114:115], v[92:93]
    v_pk_mul_f32 v[142:143], v[130:131], v[88:89]
    v_pk_fma_f32 v[114:115], v[112:113], v[94:95], v[138:139]
    v_pk_fma_f32 v[130:131], v[128:129], v[90:91], v[142:143] neg_lo:[0,1,0] neg_hi:[0,1,0]
    v_pk_fma_f32 v[112:113], v[112:113], v[92:93], v[136:137] neg_lo:[0,0,1] neg_hi:[0,0,1]
    v_pk_fma_f32 v[128:129], v[128:129], v[88:89], v[140:141]
    v_cvt_pk_f16_f32 v146, v112, v114
    v_cvt_pk_f16_f32 v150, v128, v130
    v_cvt_pk_f16_f32 v147, v113, v115
    v_cvt_pk_f16_f32 v151, v129, v131
    ds_write_b64 v224, v[146:147] offset:3168
    ds_write_b64 v224, v[150:151] offset:20064
    v_pk_mul_f32 v[136:137], v[118:119], v[94:95]
    v_pk_mul_f32 v[140:141], v[130:131], v[90:91]
    v_pk_mul_f32 v[138:139], v[118:119], v[92:93]
    v_pk_mul_f32 v[142:143], v[130:131], v[88:89]
    v_pk_fma_f32 v[118:119], v[116:117], v[94:95], v[138:139]
    v_pk_fma_f32 v[130:131], v[128:129], v[90:91], v[142:143] neg_lo:[0,1,0] neg_hi:[0,1,0]
    v_pk_fma_f32 v[116:117], v[116:117], v[92:93], v[136:137] neg_lo:[0,0,1] neg_hi:[0,0,1]
    v_pk_fma_f32 v[128:129], v[128:129], v[88:89], v[140:141]
    v_cvt_pk_f16_f32 v144, v116, v118
    v_cvt_pk_f16_f32 v148, v128, v130
    v_cvt_pk_f16_f32 v145, v117, v119
    v_cvt_pk_f16_f32 v149, v129, v131
    ds_write_b64 v224, v[144:145] offset:5808
    ds_write_b64 v224, v[148:149] offset:20592
    v_pk_mul_f32 v[136:137], v[122:123], v[94:95]
    v_pk_mul_f32 v[140:141], v[130:131], v[90:91]
    v_pk_mul_f32 v[138:139], v[122:123], v[92:93]
    v_pk_mul_f32 v[142:143], v[130:131], v[88:89]
    v_pk_fma_f32 v[122:123], v[120:121], v[94:95], v[138:139]
    v_pk_fma_f32 v[130:131], v[128:129], v[90:91], v[142:143] neg_lo:[0,1,0] neg_hi:[0,1,0]
    v_pk_fma_f32 v[120:121], v[120:121], v[92:93], v[136:137] neg_lo:[0,0,1] neg_hi:[0,0,1]
    v_pk_fma_f32 v[128:129], v[128:129], v[88:89], v[140:141]
    v_cvt_pk_f16_f32 v146, v120, v122
    v_cvt_pk_f16_f32 v150, v128, v130
    v_cvt_pk_f16_f32 v147, v121, v123
    v_cvt_pk_f16_f32 v151, v129, v131
    ds_write_b64 v224, v[146:147] offset:6336
    ds_write_b64 v224, v[150:151] offset:21120
    v_pk_mul_f32 v[136:137], v[106:107], v[94:95]
    v_pk_mul_f32 v[140:141], v[130:131], v[90:91]
    v_pk_mul_f32 v[138:139], v[106:107], v[92:93]
    v_pk_mul_f32 v[142:143], v[130:131], v[88:89]
    v_pk_fma_f32 v[106:107], v[104:105], v[94:95], v[138:139]
    v_pk_fma_f32 v[130:131], v[128:129], v[90:91], v[142:143] neg_lo:[0,1,0] neg_hi:[0,1,0]
    v_pk_fma_f32 v[104:105], v[104:105], v[92:93], v[136:137] neg_lo:[0,0,1] neg_hi:[0,0,1]
    v_pk_fma_f32 v[128:129], v[128:129], v[88:89], v[140:141]
    v_cvt_pk_f16_f32 v144, v104, v106
    v_cvt_pk_f16_f32 v148, v128, v130
    v_cvt_pk_f16_f32 v145, v105, v107
    v_cvt_pk_f16_f32 v149, v129, v131
    ds_write_b64 v224, v[144:145] offset:6864
    ds_write_b64 v224, v[148:149] offset:21648
    v_pk_mul_f32 v[136:137], v[114:115], v[94:95]
    v_pk_mul_f32 v[140:141], v[130:131], v[90:91]
    v_pk_mul_f32 v[138:139], v[114:115], v[92:93]
    v_pk_mul_f32 v[142:143], v[130:131], v[88:89]
    v_pk_fma_f32 v[114:115], v[112:113], v[94:95], v[138:139]
    v_pk_fma_f32 v[130:131], v[128:129], v[90:91], v[142:143] neg_lo:[0,1,0] neg_hi:[0,1,0]
    v_pk_fma_f32 v[112:113], v[112:113], v[92:93], v[136:137] neg_lo:[0,0,1] neg_hi:[0,0,1]
    v_pk_fma_f32 v[128:129], v[128:129], v[88:89], v[140:141]
    v_cvt_pk_f16_f32 v146, v112, v114
    v_cvt_pk_f16_f32 v150, v128, v130
    v_cvt_pk_f16_f32 v147, v113, v115
    v_cvt_pk_f16_f32 v151, v129, v131
    ds_write_b64 v224, v[146:147] offset:7392
    ds_write_b64 v224, v[150:151] offset:22176
    v_pk_mul_f32 v[136:137], v[122:123], v[94:95]
    v_pk_mul_f32 v[140:141], v[130:131], v[90:91]
    v_pk_mul_f32 v[138:139], v[122:123], v[92:93]
    v_pk_mul_f32 v[142:143], v[130:131], v[88:89]
    v_pk_fma_f32 v[122:123], v[120:121], v[94:95], v[138:139]
    v_pk_fma_f32 v[130:131], v[128:129], v[90:91], v[142:143] neg_lo:[0,1,0] neg_hi:[0,1,0]
    v_pk_fma_f32 v[120:121], v[120:121], v[92:93], v[136:137] neg_lo:[0,0,1] neg_hi:[0,0,1]
    v_pk_fma_f32 v[128:129], v[128:129], v[88:89], v[140:141]
    v_cvt_pk_f16_f32 v144, v120, v122
    v_cvt_pk_f16_f32 v148, v128, v130
    v_cvt_pk_f16_f32 v145, v121, v123
    v_cvt_pk_f16_f32 v149, v129, v131
    ds_write_b64 v224, v[144:145] offset:7920
    ds_write_b64 v224, v[148:149] offset:22704
    v_pk_mul_f32 v[136:137], v[106:107], v[94:95]
    v_pk_mul_f32 v[140:141], v[130:131], v[90:91]
    v_pk_mul_f32 v[138:139], v[106:107], v[92:93]
    v_pk_mul_f32 v[142:143], v[130:131], v[88:89]
    v_pk_fma_f32 v[106:107], v[104:105], v[94:95], v[138:139]
    v_pk_fma_f32 v[130:131], v[128:129], v[90:91], v[142:143] neg_lo:[0,1,0] neg_hi:[0,1,0]
    v_pk_fma_f32 v[104:105], v[104:105], v[92:93], v[136:137] neg_lo:[0,0,1] neg_hi:[0,0,1]
    v_pk_fma_f32 v[128:129], v[128:129], v[88:89], v[140:141]
    v_cvt_pk_f16_f32 v146, v104, v106
    v_cvt_pk_f16_f32 v150, v128, v130
    v_cvt_pk_f16_f32 v147, v105, v107
    v_cvt_pk_f16_f32 v151, v129, v131
    ds_write_b64 v224, v[146:147] offset:8448
    ds_write_b64 v224, v[150:151] offset:23232
    v_pk_mul_f32 v[136:137], v[114:115], v[94:95]
    v_pk_mul_f32 v[140:141], v[130:131], v[90:91]
    v_pk_mul_f32 v[138:139], v[114:115], v[92:93]
    v_pk_mul_f32 v[142:143], v[130:131], v[88:89]
    v_pk_fma_f32 v[114:115], v[112:113], v[94:95], v[138:139]
    v_pk_fma_f32 v[130:131], v[128:129], v[90:91], v[142:143] neg_lo:[0,1,0] neg_hi:[0,1,0]
    v_pk_fma_f32 v[112:113], v[112:113], v[92:93], v[136:137] neg_lo:[0,0,1] neg_hi:[0,0,1]
    v_pk_fma_f32 v[128:129], v[128:129], v[88:89], v[140:141]
    v_cvt_pk_f16_f32 v144, v112, v114
    v_cvt_pk_f16_f32 v148, v128, v130
    v_cvt_pk_f16_f32 v145, v113, v115
    v_cvt_pk_f16_f32 v149, v129, v131
    ds_write_b64 v224, v[144:145] offset:8976
    ds_write_b64 v224, v[148:149] offset:23760
    v_pk_mul_f32 v[136:137], v[122:123], v[94:95]
    v_pk_mul_f32 v[140:141], v[130:131], v[90:91]
    v_pk_mul_f32 v[138:139], v[122:123], v[92:93]
    v_pk_mul_f32 v[142:143], v[130:131], v[88:89]
    v_pk_fma_f32 v[122:123], v[120:121], v[94:95], v[138:139]
    v_pk_fma_f32 v[130:131], v[128:129], v[90:91], v[142:143] neg_lo:[0,1,0] neg_hi:[0,1,0]
    v_pk_fma_f32 v[120:121], v[120:121], v[92:93], v[136:137] neg_lo:[0,0,1] neg_hi:[0,0,1]
    v_pk_fma_f32 v[128:129], v[128:129], v[88:89], v[140:141]
    v_cvt_pk_f16_f32 v146, v120, v122
    v_cvt_pk_f16_f32 v150, v128, v130
    v_cvt_pk_f16_f32 v147, v121, v123
    v_cvt_pk_f16_f32 v151, v129, v131
    ds_write_b64 v224, v[146:147] offset:9504
    ds_write_b64 v224, v[150:151] offset:24288
    v_pk_mul_f32 v[136:137], v[106:107], v[94:95]
    v_pk_mul_f32 v[140:141], v[130:131], v[90:91]
    v_pk_mul_f32 v[138:139], v[106:107], v[92:93]
    v_pk_mul_f32 v[142:143], v[130:131], v[88:89]
    v_pk_fma_f32 v[106:107], v[104:105], v[94:95], v[138:139]
    v_pk_fma_f32 v[130:131], v[128:129], v[90:91], v[142:143] neg_lo:[0,1,0] neg_hi:[0,1,0]
    v_pk_fma_f32 v[104:105], v[104:105], v[92:93], v[136:137] neg_lo:[0,0,1] neg_hi:[0,0,1]
    v_pk_fma_f32 v[128:129], v[128:129], v[88:89], v[140:141]
    v_cvt_pk_f16_f32 v144, v104, v106
    v_cvt_pk_f16_f32 v148, v128, v130
    v_cvt_pk_f16_f32 v145, v105, v107
    v_cvt_pk_f16_f32 v149, v129, v131
    ds_write_b64 v224, v[144:145] offset:10032
    ds_write_b64 v224, v[148:149] offset:24816
    v_pk_mul_f32 v[136:137], v[122:123], v[94:95]
    v_pk_mul_f32 v[140:141], v[130:131], v[90:91]
    v_pk_mul_f32 v[138:139], v[122:123], v[92:93]
    v_pk_mul_f32 v[142:143], v[130:131], v[88:89]
    v_pk_fma_f32 v[122:123], v[120:121], v[94:95], v[138:139]
    v_pk_fma_f32 v[130:131], v[128:129], v[90:91], v[142:143] neg_lo:[0,1,0] neg_hi:[0,1,0]
    v_pk_fma_f32 v[120:121], v[120:121], v[92:93], v[136:137] neg_lo:[0,0,1] neg_hi:[0,0,1]
    v_pk_fma_f32 v[128:129], v[128:129], v[88:89], v[140:141]
    v_cvt_pk_f16_f32 v146, v120, v122
    v_cvt_pk_f16_f32 v150, v128, v130
    v_cvt_pk_f16_f32 v147, v121, v123
    v_cvt_pk_f16_f32 v151, v129, v131
    ds_write_b64 v224, v[146:147] offset:10560
    ds_write_b64 v224, v[150:151] offset:25344
    v_pk_mul_f32 v[136:137], v[106:107], v[94:95]
    v_pk_mul_f32 v[140:141], v[130:131], v[90:91]
    v_pk_mul_f32 v[138:139], v[106:107], v[92:93]
    v_pk_mul_f32 v[142:143], v[130:131], v[88:89]
    v_pk_fma_f32 v[106:107], v[104:105], v[94:95], v[138:139]
    v_pk_fma_f32 v[130:131], v[128:129], v[90:91], v[142:143] neg_lo:[0,1,0] neg_hi:[0,1,0]
    v_pk_fma_f32 v[104:105], v[104:105], v[92:93], v[136:137] neg_lo:[0,0,1] neg_hi:[0,0,1]
    v_pk_fma_f32 v[128:129], v[128:129], v[88:89], v[140:141]
    v_cvt_pk_f16_f32 v144, v104, v106
    v_cvt_pk_f16_f32 v148, v128, v130
    v_cvt_pk_f16_f32 v145, v105, v107
    v_cvt_pk_f16_f32 v149, v129, v131
    ds_write_b64 v224, v[144:145] offset:12144
    ds_write_b64 v224, v[148:149] offset:25872
    v_pk_mul_f32 v[136:137], v[122:123], v[94:95]
    v_pk_mul_f32 v[140:141], v[130:131], v[90:91]
    v_pk_mul_f32 v[138:139], v[122:123], v[92:93]
    v_pk_mul_f32 v[142:143], v[130:131], v[88:89]
    v_pk_fma_f32 v[122:123], v[120:121], v[94:95], v[138:139]
    v_pk_fma_f32 v[130:131], v[128:129], v[90:91], v[142:143] neg_lo:[0,1,0] neg_hi:[0,1,0]
    v_pk_fma_f32 v[120:121], v[120:121], v[92:93], v[136:137] neg_lo:[0,0,1] neg_hi:[0,0,1]
    v_pk_fma_f32 v[128:129], v[128:129], v[88:89], v[140:141]
    v_cvt_pk_f16_f32 v146, v120, v122
    v_cvt_pk_f16_f32 v150, v128, v130
    v_cvt_pk_f16_f32 v147, v121, v123
    v_cvt_pk_f16_f32 v151, v129, v131
    ds_write_b64 v224, v[146:147] offset:12672
    ds_write_b64 v224, v[150:151] offset:26400
    v_pk_mul_f32 v[136:137], v[106:107], v[94:95]
    v_pk_mul_f32 v[140:141], v[130:131], v[90:91]
    v_pk_mul_f32 v[138:139], v[106:107], v[92:93]
    v_pk_mul_f32 v[142:143], v[130:131], v[88:89]
    v_pk_fma_f32 v[106:107], v[104:105], v[94:95], v[138:139]
    v_pk_fma_f32 v[130:131], v[128:129], v[90:91], v[142:143] neg_lo:[0,1,0] neg_hi:[0,1,0]
    v_pk_fma_f32 v[104:105], v[104:105], v[92:93], v[136:137] neg_lo:[0,0,1] neg_hi:[0,0,1]
    v_pk_fma_f32 v[128:129], v[128:129], v[88:89], v[140:141]
    v_cvt_pk_f16_f32 v144, v104, v106
    v_cvt_pk_f16_f32 v148, v128, v130
    v_cvt_pk_f16_f32 v145, v105, v107
    v_cvt_pk_f16_f32 v149, v129, v131
    ds_write_b64 v224, v[144:145] offset:11088
    ds_write_b64 v224, v[148:149] offset:26928
    v_pk_mul_f32 v[136:137], v[122:123], v[94:95]
    v_pk_mul_f32 v[140:141], v[130:131], v[90:91]
    v_pk_mul_f32 v[138:139], v[122:123], v[92:93]
    v_pk_mul_f32 v[142:143], v[130:131], v[88:89]
    v_pk_fma_f32 v[122:123], v[120:121], v[94:95], v[138:139]
    v_pk_fma_f32 v[130:131], v[128:129], v[90:91], v[142:143] neg_lo:[0,1,0] neg_hi:[0,1,0]
    v_pk_fma_f32 v[120:121], v[120:121], v[92:93], v[136:137] neg_lo:[0,0,1] neg_hi:[0,0,1]
    v_pk_fma_f32 v[128:129], v[128:129], v[88:89], v[140:141]
    v_cvt_pk_f16_f32 v146, v120, v122
    v_cvt_pk_f16_f32 v150, v128, v130
    v_cvt_pk_f16_f32 v147, v121, v123
    v_cvt_pk_f16_f32 v151, v129, v131
    ds_write_b64 v224, v[146:147] offset:11616
    ds_write_b64 v224, v[150:151] offset:27456
    v_pk_mul_f32 v[136:137], v[106:107], v[94:95]
    v_pk_mul_f32 v[140:141], v[130:131], v[90:91]
    v_pk_mul_f32 v[138:139], v[106:107], v[92:93]
    v_pk_mul_f32 v[142:143], v[130:131], v[88:89]
    v_pk_fma_f32 v[106:107], v[104:105], v[94:95], v[138:139]
    v_pk_fma_f32 v[130:131], v[128:129], v[90:91], v[142:143] neg_lo:[0,1,0] neg_hi:[0,1,0]
    v_pk_fma_f32 v[104:105], v[104:105], v[92:93], v[136:137] neg_lo:[0,0,1] neg_hi:[0,0,1]
    v_pk_fma_f32 v[128:129], v[128:129], v[88:89], v[140:141]
    v_cvt_pk_f16_f32 v144, v104, v106
    v_cvt_pk_f16_f32 v148, v128, v130
    v_cvt_pk_f16_f32 v145, v105, v107
    v_cvt_pk_f16_f32 v149, v129, v131
    ds_write_b64 v224, v[144:145] offset:13200
    ds_write_b64 v224, v[148:149] offset:27984
    v_pk_mul_f32 v[136:137], v[122:123], v[94:95]
    v_pk_mul_f32 v[140:141], v[130:131], v[90:91]
    v_pk_mul_f32 v[138:139], v[122:123], v[92:93]
    v_pk_mul_f32 v[142:143], v[130:131], v[88:89]
    v_pk_fma_f32 v[122:123], v[120:121], v[94:95], v[138:139]
    v_pk_fma_f32 v[130:131], v[128:129], v[90:91], v[142:143] neg_lo:[0,1,0] neg_hi:[0,1,0]
    v_pk_fma_f32 v[120:121], v[120:121], v[92:93], v[136:137] neg_lo:[0,0,1] neg_hi:[0,0,1]
    v_pk_fma_f32 v[128:129], v[128:129], v[88:89], v[140:141]
    v_cvt_pk_f16_f32 v146, v120, v122
    v_cvt_pk_f16_f32 v150, v128, v130
    v_cvt_pk_f16_f32 v147, v121, v123
    v_cvt_pk_f16_f32 v151, v129, v131
    ds_write_b64 v224, v[146:147] offset:13728
    ds_write_b64 v224, v[150:151] offset:28512
    v_pk_mul_f32 v[140:141], v[130:131], v[90:91]
    v_pk_mul_f32 v[142:143], v[130:131], v[88:89]
    v_pk_fma_f32 v[130:131], v[128:129], v[90:91], v[142:143] neg_lo:[0,1,0] neg_hi:[0,1,0]
    v_pk_fma_f32 v[128:129], v[128:129], v[88:89], v[140:141]
    v_cvt_pk_f16_f32 v148, v128, v130
    v_cvt_pk_f16_f32 v149, v129, v131
    ds_write_b64 v224, v[148:149] offset:29040
    v_pk_mul_f32 v[140:141], v[130:131], v[90:91]
    v_pk_mul_f32 v[142:143], v[130:131], v[88:89]
    v_pk_fma_f32 v[130:131], v[128:129], v[90:91], v[142:143] neg_lo:[0,1,0] neg_hi:[0,1,0]
    v_pk_fma_f32 v[128:129], v[128:129], v[88:89], v[140:141]
    v_cvt_pk_f16_f32 v150, v128, v130
    v_cvt_pk_f16_f32 v151, v129, v131
    ds_write_b64 v224, v[150:151] offset:29568
    v_pk_mul_f32 v[140:141], v[130:131], v[90:91]
    v_pk_mul_f32 v[142:143], v[130:131], v[88:89]
    v_pk_fma_f32 v[130:131], v[128:129], v[90:91], v[142:143] neg_lo:[0,1,0] neg_hi:[0,1,0]
    v_pk_fma_f32 v[128:129], v[128:129], v[88:89], v[140:141]
    v_cvt_pk_f16_f32 v148, v128, v130
    v_cvt_pk_f16_f32 v149, v129, v131
    ds_write_b64 v224, v[148:149] offset:30096
    v_pk_mul_f32 v[140:141], v[130:131], v[90:91]
    v_pk_mul_f32 v[142:143], v[130:131], v[88:89]
    v_pk_fma_f32 v[130:131], v[128:129], v[90:91], v[142:143] neg_lo:[0,1,0] neg_hi:[0,1,0]
    v_pk_fma_f32 v[128:129], v[128:129], v[88:89], v[140:141]
    v_cvt_pk_f16_f32 v150, v128, v130
    v_cvt_pk_f16_f32 v151, v129, v131
    ds_write_b64 v224, v[150:151] offset:30624
    s_waitcnt lgkmcnt(0)
    ds_read_b128 v[64:67], v225 offset:0
    ds_read_b128 v[68:71], v226 offset:0
    ds_read_b128 v[72:75], v225 offset:32
    ds_read_b128 v[76:79], v226 offset:32
    ds_read_b128 v[80:83], v225 offset:64
    ds_read_b128 v[84:87], v226 offset:64
    ds_read_b128 v[88:91], v225 offset:96
    ds_read_b128 v[92:95], v226 offset:96
    ds_read_b128 v[96:99], v225 offset:128
    ds_read_b128 v[100:103], v226 offset:128
    ds_read_b128 v[104:107], v225 offset:160
    ds_read_b128 v[108:111], v226 offset:160
    s_waitcnt lgkmcnt(10)
    v_mfma_f32_32x32x16_f16 v[176:191], v[64:67], v[68:71], 0
    ds_read_b128 v[64:67], v225 offset:192
    ds_read_b128 v[68:71], v226 offset:192
    s_waitcnt lgkmcnt(10)
    v_mfma_f32_32x32x16_f16 v[176:191], v[72:75], v[76:79], v[176:191]
    ds_read_b128 v[72:75], v225 offset:224
    ds_read_b128 v[76:79], v226 offset:224
    s_waitcnt lgkmcnt(10)
    v_mfma_f32_32x32x16_f16 v[176:191], v[80:83], v[84:87], v[176:191]
    ds_read_b128 v[80:83], v225 offset:256
    ds_read_b128 v[84:87], v226 offset:256
    s_waitcnt lgkmcnt(10)
    v_mfma_f32_32x32x16_f16 v[176:191], v[88:91], v[92:95], v[176:191]
    ds_read_b128 v[88:91], v225 offset:288
    ds_read_b128 v[92:95], v226 offset:288
    s_waitcnt lgkmcnt(10)
    v_mfma_f32_32x32x16_f16 v[176:191], v[96:99], v[100:103], v[176:191]
    ds_read_b128 v[96:99], v225 offset:320
    ds_read_b128 v[100:103], v226 offset:320
    s_waitcnt lgkmcnt(10)
    v_mfma_f32_32x32x16_f16 v[176:191], v[104:107], v[108:111], v[176:191]
    ds_read_b128 v[104:107], v225 offset:352
    ds_read_b128 v[108:111], v226 offset:352
    s_waitcnt lgkmcnt(10)
    v_mfma_f32_32x32x16_f16 v[176:191], v[64:67], v[68:71], v[176:191]
    ds_read_b128 v[64:67], v225 offset:384
    ds_read_b128 v[68:71], v226 offset:384
    s_waitcnt lgkmcnt(10)
    v_mfma_f32_32x32x16_f16 v[176:191], v[72:75], v[76:79], v[176:191]
    ds_read_b128 v[72:75], v225 offset:416
    ds_read_b128 v[76:79], v226 offset:416
    s_waitcnt lgkmcnt(10)
    v_mfma_f32_32x32x16_f16 v[176:191], v[80:83], v[84:87], v[176:191]
    ds_read_b128 v[80:83], v225 offset:448
    ds_read_b128 v[84:87], v226 offset:448
    s_waitcnt lgkmcnt(10)
    v_mfma_f32_32x32x16_f16 v[176:191], v[88:91], v[92:95], v[176:191]
    ds_read_b128 v[88:91], v225 offset:480
    ds_read_b128 v[92:95], v226 offset:480
    s_waitcnt lgkmcnt(10)
    v_mfma_f32_32x32x16_f16 v[176:191], v[96:99], v[100:103], v[176:191]
    s_waitcnt lgkmcnt(8)
    v_mfma_f32_32x32x16_f16 v[176:191], v[104:107], v[108:111], v[176:191]
    s_waitcnt lgkmcnt(6)
    v_mfma_f32_32x32x16_f16 v[176:191], v[64:67], v[68:71], v[176:191]
    s_waitcnt lgkmcnt(4)
    v_mfma_f32_32x32x16_f16 v[176:191], v[72:75], v[76:79], v[176:191]
    s_waitcnt lgkmcnt(2)
    v_mfma_f32_32x32x16_f16 v[176:191], v[80:83], v[84:87], v[176:191]
    s_waitcnt lgkmcnt(0)
    v_mfma_f32_32x32x16_f16 v[176:191], v[88:91], v[92:95], v[176:191]
    v_mov_b32 v64, 0
    v_mov_b32 v65, 0
    v_mov_b32 v66, 0
    v_mov_b32 v67, 0
    v_lshrrev_b32 v68, 1, v1
    s_movk_i32 s20, 4160
    v_mul_u32_u24 v68, s20, v68
    v_and_b32 v69, 1, v1
    v_lshl_add_u32 v68, v69, 4, v68
    v_add_u32 v68, s15, v68
    v_cmp_eq_u32 vcc, 0, v69
    v_cmp_eq_u32 s[20:21], 0, v1
    s_nop 1
    v_cndmask_b32 v70, 0, v232, s[20:21]
    v_pk_mul_f32 v[176:177], v[176:177], v[230:231] op_sel:[0,1] op_sel_hi:[1,1]
    v_pk_mul_f32 v[178:179], v[178:179], v[230:231] op_sel:[0,1] op_sel_hi:[1,1]
    v_pk_mul_f32 v[180:181], v[180:181], v[230:231] op_sel:[0,1] op_sel_hi:[1,1]
    v_pk_mul_f32 v[182:183], v[182:183], v[230:231] op_sel:[0,1] op_sel_hi:[1,1]
    v_pk_mul_f32 v[184:185], v[184:185], v[230:231] op_sel:[0,1] op_sel_hi:[1,1]
    v_pk_mul_f32 v[186:187], v[186:187], v[230:231] op_sel:[0,1] op_sel_hi:[1,1]
    v_pk_mul_f32 v[188:189], v[188:189], v[230:231] op_sel:[0,1] op_sel_hi:[1,1]
    v_pk_mul_f32 v[190:191], v[190:191], v[230:231] op_sel:[0,1] op_sel_hi:[1,1]
    v_add_f32 v176, v176, v70
    v_cndmask_b32 v71, v189, v188, vcc
    v_cndmask_b32 v72, v191, v190, vcc
    s_mov_b64 exec, 0xff
    ds_write_b128 v68, v[64:67] offset:4096
    s_mov_b64 exec, -1
    v_cvt_pk_f16_f32 v76, v183, v182
    v_cvt_pk_f16_f32 v77, v181, v180
    v_cvt_pk_f16_f32 v78, v179, v178
    v_cvt_pk_f16_f32 v79, v177, v176
    v_mov_b32 v83, 0
    v_mov_b32 v91, 0
    v_cvt_pk_f16_f32 v80, v181, v180
    v_cvt_pk_f16_f32 v81, v179, v178
    v_cvt_pk_f16_f32 v82, v177, v176
    v_alignbit_b32 v84, v77, v76, 16
    v_alignbit_b32 v85, v78, v77, 16
    v_alignbit_b32 v86, v79, v78, 16
    v_mov_b32_dpp v83, v76 wave_shr:1 row_mask:0xf bank_mask:0xf
    v_mov_b32_dpp v91, v84 wave_shr:1 row_mask:0xf bank_mask:0xf
    ds_write_b128 v227, v[76:79] offset:3072
    v_mov_b32 v88, v85
    v_mov_b32 v89, v86
    v_alignbit_b32 v87, v83, v79, 16
    v_alignbit_b32 v90, v83, v79, 16
    ds_write_b128 v227, v[80:83] offset:11392
    ds_write_b128 v227, v[84:87] offset:7232
    ds_write_b128 v227, v[88:91] offset:15552
    v_cvt_pk_f16_f32 v96, v186, v186
    v_cvt_pk_f16_f32 v97, v185, v185
    v_cvt_pk_f16_f32 v98, v185, v184
    v_cvt_pk_f16_f32 v99, v184, v184
    v_mov_b32_dpp v103, v76 wave_ror:1 row_mask:0xf bank_mask:0xf
    v_mov_b32_dpp v111, v84 wave_ror:1 row_mask:0xf bank_mask:0xf
    v_cvt_pk_f16_f32 v100, v185, v185
    v_cvt_pk_f16_f32 v101, v185, v184
    v_cvt_pk_f16_f32 v102, v184, v184
    v_alignbit_b32 v104, v97, v96, 16
    v_alignbit_b32 v105, v98, v97, 16
    v_alignbit_b32 v106, v99, v98, 16
    v_mov_b32_dpp v103, v96 wave_shr:1 row_mask:0xf bank_mask:0xf
    v_mov_b32_dpp v111, v104 wave_shr:1 row_mask:0xf bank_mask:0xf
    ds_write_b128 v227, v[96:99] offset:2048
    v_mov_b32 v108, v105
    v_mov_b32 v109, v106
    v_alignbit_b32 v107, v103, v99, 16
    v_alignbit_b32 v110, v103, v99, 16
    ds_write_b128 v227, v[100:103] offset:10368
    ds_write_b128 v227, v[104:107] offset:6208
    ds_write_b128 v227, v[108:111] offset:14528
    v_cvt_pk_f16_f32 v116, v189, v189
    v_cvt_pk_f16_f32 v117, v189, v71
    v_cvt_pk_f16_f32 v118, v188, v188
    v_cvt_pk_f16_f32 v119, v188, v188
    v_mov_b32_dpp v123, v96 wave_ror:1 row_mask:0xf bank_mask:0xf
    v_mov_b32_dpp v131, v104 wave_ror:1 row_mask:0xf bank_mask:0xf
    v_cvt_pk_f16_f32 v120, v189, v71
    v_cvt_pk_f16_f32 v121, v188, v188
    v_cvt_pk_f16_f32 v122, v188, v188
    v_alignbit_b32 v124, v117, v116, 16
    v_alignbit_b32 v125, v118, v117, 16
    v_alignbit_b32 v126, v119, v118, 16
    v_mov_b32_dpp v123, v116 wave_shr:1 row_mask:0xf bank_mask:0xf
    v_mov_b32_dpp v131, v124 wave_shr:1 row_mask:0xf bank_mask:0xf
    ds_write_b128 v227, v[116:119] offset:1024
    v_mov_b32 v128, v125
    v_mov_b32 v129, v126
    v_alignbit_b32 v127, v123, v119, 16
    v_alignbit_b32 v130, v123, v119, 16
    ds_write_b128 v227, v[120:123] offset:9344
    ds_write_b128 v227, v[124:127] offset:5184
    ds_write_b128 v227, v[128:131] offset:13504
    v_cvt_pk_f16_f32 v136, v191, v191
    v_cvt_pk_f16_f32 v137, v191, v72
    v_cvt_pk_f16_f32 v138, v190, v190
    v_cvt_pk_f16_f32 v139, v190, v190
    v_mov_b32_dpp v143, v116 wave_ror:1 row_mask:0xf bank_mask:0xf
    v_mov_b32_dpp v151, v124 wave_ror:1 row_mask:0xf bank_mask:0xf
    v_cvt_pk_f16_f32 v140, v191, v72
    v_cvt_pk_f16_f32 v141, v190, v190
    v_cvt_pk_f16_f32 v142, v190, v190
    v_alignbit_b32 v144, v137, v136, 16
    v_alignbit_b32 v145, v138, v137, 16
    v_alignbit_b32 v146, v139, v138, 16
    v_mov_b32_dpp v143, v136 wave_shr:1 row_mask:0xf bank_mask:0xf
    v_mov_b32_dpp v151, v144 wave_shr:1 row_mask:0xf bank_mask:0xf
    ds_write_b128 v227, v[136:139] offset:0
    v_mov_b32 v148, v145
    v_mov_b32 v149, v146
    v_alignbit_b32 v147, v143, v139, 16
    v_alignbit_b32 v150, v143, v139, 16
    ds_write_b128 v227, v[140:143] offset:8320
    ds_write_b128 v227, v[144:147] offset:4160
    ds_write_b128 v227, v[148:151] offset:12480
    s_waitcnt lgkmcnt(0)
    ds_read_b64 v[64:65], v228 offset:4032
    ds_read_b64 v[66:67], v228 offset:4040
    ds_read_b64 v[68:69], v228 offset:3520
    ds_read_b64 v[70:71], v228 offset:3528
    ds_read_b64 v[72:73], v228 offset:3008
    ds_read_b64 v[74:75], v228 offset:3016
    ds_read_b64 v[76:77], v228 offset:2496
    ds_read_b64 v[78:79], v228 offset:2504
    ds_read_b64 v[80:81], v228 offset:1984
    ds_read_b64 v[82:83], v228 offset:1992
    ds_read_b64 v[84:85], v228 offset:1472
    ds_read_b64 v[86:87], v228 offset:1480
    ds_read_b64 v[88:89], v228 offset:960
    ds_read_b64 v[90:91], v228 offset:968
    ds_read_b64 v[92:93], v228 offset:448
    ds_read_b64 v[94:95], v228 offset:456
    s_waitcnt lgkmcnt(0)
    s_add_u32 s99, s99, 1
    s_barrier
    ds_read_b128 v[96:99], v229 offset:480
    ds_read_b128 v[100:103], v229 offset:992
    ds_read_b128 v[104:107], v229 offset:1504
    ds_read_b128 v[108:111], v229 offset:2016
    ds_read_b128 v[112:115], v229 offset:2528
    ds_read_b128 v[116:119], v229 offset:3040
    ds_read_b128 v[120:123], v229 offset:3552
    ds_read_b128 v[124:127], v229 offset:4064
    s_waitcnt lgkmcnt(0)
    v_mfma_f32_16x16x32_f16 v[192:195], v[64:67], v[96:99], 0
    ds_read_b64 v[128:129], v228 offset:3968
    v_mfma_f32_16x16x32_f16 v[196:199], v[64:67], v[100:103], 0
    ds_read_b64 v[130:131], v228 offset:3976
    v_mfma_f32_16x16x32_f16 v[200:203], v[64:67], v[104:107], 0
    ds_read_b128 v[160:163], v229 offset:416
    v_mfma_f32_16x16x32_f16 v[204:207], v[64:67], v[108:111], 0
    ds_read_b128 v[164:167], v229 offset:928
    v_mfma_f32_16x16x32_f16 v[208:211], v[64:67], v[112:115], 0
    ds_read_b128 v[168:171], v229 offset:1440
    v_mfma_f32_16x16x32_f16 v[212:215], v[64:67], v[116:119], 0
    ds_read_b128 v[172:175], v229 offset:1952
    v_mfma_f32_16x16x32_f16 v[216:219], v[64:67], v[120:123], 0
    ds_read_b128 v[176:179], v229 offset:2464
    v_mfma_f32_16x16x32_f16 v[220:223], v[64:67], v[124:127], 0
    ds_read_b128 v[180:183], v229 offset:2976
    v_mfma_f32_16x16x32_f16 v[196:199], v[68:71], v[96:99], v[196:199]
    ds_read_b128 v[184:187], v229 offset:3488
    v_mfma_f32_16x16x32_f16 v[200:203], v[68:71], v[100:103], v[200:203]
    ds_read_b128 v[188:191], v229 offset:4000
    v_mfma_f32_16x16x32_f16 v[204:207], v[68:71], v[104:107], v[204:207]
    ds_read_b64 v[132:133], v228 offset:3456
    v_mfma_f32_16x16x32_f16 v[208:211], v[68:71], v[108:111], v[208:211]
    ds_read_b64 v[134:135], v228 offset:3464
    v_mfma_f32_16x16x32_f16 v[212:215], v[68:71], v[112:115], v[212:215]
    ds_read_b64 v[136:137], v228 offset:2944
    v_mfma_f32_16x16x32_f16 v[216:219], v[68:71], v[116:119], v[216:219]
    ds_read_b64 v[138:139], v228 offset:2952
    v_mfma_f32_16x16x32_f16 v[220:223], v[68:71], v[120:123], v[220:223]
    ds_read_b64 v[140:141], v228 offset:2432
    v_mfma_f32_16x16x32_f16 v[200:203], v[72:75], v[96:99], v[200:203]
    ds_read_b64 v[142:143], v228 offset:2440
    v_mfma_f32_16x16x32_f16 v[204:207], v[72:75], v[100:103], v[204:207]
    ds_read_b64 v[144:145], v228 offset:1920
    v_mfma_f32_16x16x32_f16 v[208:211], v[72:75], v[104:107], v[208:211]
    ds_read_b64 v[146:147], v228 offset:1928
    v_mfma_f32_16x16x32_f16 v[212:215], v[72:75], v[108:111], v[212:215]
    ds_read_b64 v[148:149], v228 offset:1408
    v_mfma_f32_16x16x32_f16 v[216:219], v[72:75], v[112:115], v[216:219]
    ds_read_b64 v[150:151], v228 offset:1416
    v_mfma_f32_16x16x32_f16 v[220:223], v[72:75], v[116:119], v[220:223]
    ds_read_b64 v[152:153], v228 offset:896
    v_mfma_f32_16x16x32_f16 v[204:207], v[76:79], v[96:99], v[204:207]
    ds_read_b64 v[154:155], v228 offset:904
    v_mfma_f32_16x16x32_f16 v[208:211], v[76:79], v[100:103], v[208:211]
    ds_read_b64 v[156:157], v228 offset:384
    v_mfma_f32_16x16x32_f16 v[212:215], v[76:79], v[104:107], v[212:215]
    ds_read_b64 v[158:159], v228 offset:392
    v_mfma_f32_16x16x32_f16 v[216:219], v[76:79], v[108:111], v[216:219]
    v_mfma_f32_16x16x32_f16 v[220:223], v[76:79], v[112:115], v[220:223]
    v_mfma_f32_16x16x32_f16 v[208:211], v[80:83], v[96:99], v[208:211]
    v_mfma_f32_16x16x32_f16 v[212:215], v[80:83], v[100:103], v[212:215]
    v_mfma_f32_16x16x32_f16 v[216:219], v[80:83], v[104:107], v[216:219]
    v_mfma_f32_16x16x32_f16 v[220:223], v[80:83], v[108:111], v[220:223]
    v_mfma_f32_16x16x32_f16 v[212:215], v[84:87], v[96:99], v[212:215]
    v_mfma_f32_16x16x32_f16 v[216:219], v[84:87], v[100:103], v[216:219]
    v_mfma_f32_16x16x32_f16 v[220:223], v[84:87], v[104:107], v[220:223]
    v_mfma_f32_16x16x32_f16 v[216:219], v[88:91], v[96:99], v[216:219]
    v_mfma_f32_16x16x32_f16 v[220:223], v[88:91], v[100:103], v[220:223]
    v_mfma_f32_16x16x32_f16 v[220:223], v[92:95], v[96:99], v[220:223]
    s_waitcnt lgkmcnt(0)
    v_mfma_f32_16x16x32_f16 v[192:195], v[128:131], v[160:163], v[192:195]
    ds_read_b64 v[64:65], v228 offset:3904
    v_mfma_f32_16x16x32_f16 v[196:199], v[128:131], v[164:167], v[196:199]
    ds_read_b64 v[66:67], v228 offset:3912
    v_mfma_f32_16x16x32_f16 v[200:203], v[128:131], v[168:171], v[200:203]
    ds_read_b128 v[96:99], v229 offset:352
    v_mfma_f32_16x16x32_f16 v[204:207], v[128:131], v[172:175], v[204:207]
    ds_read_b128 v[100:103], v229 offset:864
    v_mfma_f32_16x16x32_f16 v[208:211], v[128:131], v[176:179], v[208:211]
    ds_read_b128 v[104:107], v229 offset:1376
    v_mfma_f32_16x16x32_f16 v[212:215], v[128:131], v[180:183], v[212:215]
    ds_read_b128 v[108:111], v229 offset:1888
    v_mfma_f32_16x16x32_f16 v[216:219], v[128:131], v[184:187], v[216:219]
    ds_read_b128 v[112:115], v229 offset:2400
    v_mfma_f32_16x16x32_f16 v[220:223], v[128:131], v[188:191], v[220:223]
    ds_read_b128 v[116:119], v229 offset:2912
    v_mfma_f32_16x16x32_f16 v[196:199], v[132:135], v[160:163], v[196:199]
    ds_read_b128 v[120:123], v229 offset:3424
    v_mfma_f32_16x16x32_f16 v[200:203], v[132:135], v[164:167], v[200:203]
    ds_read_b128 v[124:127], v229 offset:3936
    v_mfma_f32_16x16x32_f16 v[204:207], v[132:135], v[168:171], v[204:207]
    ds_read_b64 v[68:69], v228 offset:3392
    v_mfma_f32_16x16x32_f16 v[208:211], v[132:135], v[172:175], v[208:211]
    ds_read_b64 v[70:71], v228 offset:3400
    v_mfma_f32_16x16x32_f16 v[212:215], v[132:135], v[176:179], v[212:215]
    ds_read_b64 v[72:73], v228 offset:2880
    v_mfma_f32_16x16x32_f16 v[216:219], v[132:135], v[180:183], v[216:219]
    ds_read_b64 v[74:75], v228 offset:2888
    v_mfma_f32_16x16x32_f16 v[220:223], v[132:135], v[184:187], v[220:223]
    ds_read_b64 v[76:77], v228 offset:2368
    v_mfma_f32_16x16x32_f16 v[200:203], v[136:139], v[160:163], v[200:203]
    ds_read_b64 v[78:79], v228 offset:2376
    v_mfma_f32_16x16x32_f16 v[204:207], v[136:139], v[164:167], v[204:207]
    ds_read_b64 v[80:81], v228 offset:1856
    v_mfma_f32_16x16x32_f16 v[208:211], v[136:139], v[168:171], v[208:211]
    ds_read_b64 v[82:83], v228 offset:1864
    v_mfma_f32_16x16x32_f16 v[212:215], v[136:139], v[172:175], v[212:215]
    ds_read_b64 v[84:85], v228 offset:1344
    v_mfma_f32_16x16x32_f16 v[216:219], v[136:139], v[176:179], v[216:219]
    ds_read_b64 v[86:87], v228 offset:1352
    v_mfma_f32_16x16x32_f16 v[220:223], v[136:139], v[180:183], v[220:223]
    ds_read_b64 v[88:89], v228 offset:832
    v_mfma_f32_16x16x32_f16 v[204:207], v[140:143], v[160:163], v[204:207]
    ds_read_b64 v[90:91], v228 offset:840
    v_mfma_f32_16x16x32_f16 v[208:211], v[140:143], v[164:167], v[208:211]
    ds_read_b64 v[92:93], v228 offset:320
    v_mfma_f32_16x16x32_f16 v[212:215], v[140:143], v[168:171], v[212:215]
    ds_read_b64 v[94:95], v228 offset:328
    v_mfma_f32_16x16x32_f16 v[216:219], v[140:143], v[172:175], v[216:219]
    v_mfma_f32_16x16x32_f16 v[220:223], v[140:143], v[176:179], v[220:223]
    v_mfma_f32_16x16x32_f16 v[208:211], v[144:147], v[160:163], v[208:211]
    v_mfma_f32_16x16x32_f16 v[212:215], v[144:147], v[164:167], v[212:215]
    v_mfma_f32_16x16x32_f16 v[216:219], v[144:147], v[168:171], v[216:219]
    v_mfma_f32_16x16x32_f16 v[220:223], v[144:147], v[172:175], v[220:223]
    v_mfma_f32_16x16x32_f16 v[212:215], v[148:151], v[160:163], v[212:215]
    v_mfma_f32_16x16x32_f16 v[216:219], v[148:151], v[164:167], v[216:219]
    v_mfma_f32_16x16x32_f16 v[220:223], v[148:151], v[168:171], v[220:223]
    v_mfma_f32_16x16x32_f16 v[216:219], v[152:155], v[160:163], v[216:219]
    v_mfma_f32_16x16x32_f16 v[220:223], v[152:155], v[164:167], v[220:223]
    v_mfma_f32_16x16x32_f16 v[220:223], v[156:159], v[160:163], v[220:223]
    s_waitcnt lgkmcnt(0)
    v_mfma_f32_16x16x32_f16 v[192:195], v[64:67], v[96:99], v[192:195]
    ds_read_b64 v[128:129], v228 offset:3840
    v_mfma_f32_16x16x32_f16 v[196:199], v[64:67], v[100:103], v[196:199]
    ds_read_b64 v[130:131], v228 offset:3848
    v_mfma_f32_16x16x32_f16 v[200:203], v[64:67], v[104:107], v[200:203]
    ds_read_b128 v[160:163], v229 offset:288
    v_mfma_f32_16x16x32_f16 v[204:207], v[64:67], v[108:111], v[204:207]
    ds_read_b128 v[164:167], v229 offset:800
    v_mfma_f32_16x16x32_f16 v[208:211], v[64:67], v[112:115], v[208:211]
    ds_read_b128 v[168:171], v229 offset:1312
    v_mfma_f32_16x16x32_f16 v[212:215], v[64:67], v[116:119], v[212:215]
    ds_read_b128 v[172:175], v229 offset:1824
    v_mfma_f32_16x16x32_f16 v[216:219], v[64:67], v[120:123], v[216:219]
    ds_read_b128 v[176:179], v229 offset:2336
    v_mfma_f32_16x16x32_f16 v[220:223], v[64:67], v[124:127], v[220:223]
    ds_read_b128 v[180:183], v229 offset:2848
    v_mfma_f32_16x16x32_f16 v[196:199], v[68:71], v[96:99], v[196:199]
    ds_read_b128 v[184:187], v229 offset:3360
    v_mfma_f32_16x16x32_f16 v[200:203], v[68:71], v[100:103], v[200:203]
    ds_read_b128 v[188:191], v229 offset:3872
    v_mfma_f32_16x16x32_f16 v[204:207], v[68:71], v[104:107], v[204:207]
    ds_read_b64 v[132:133], v228 offset:3328
    v_mfma_f32_16x16x32_f16 v[208:211], v[68:71], v[108:111], v[208:211]
    ds_read_b64 v[134:135], v228 offset:3336
    v_mfma_f32_16x16x32_f16 v[212:215], v[68:71], v[112:115], v[212:215]
    ds_read_b64 v[136:137], v228 offset:2816
    v_mfma_f32_16x16x32_f16 v[216:219], v[68:71], v[116:119], v[216:219]
    ds_read_b64 v[138:139], v228 offset:2824
    v_mfma_f32_16x16x32_f16 v[220:223], v[68:71], v[120:123], v[220:223]
    ds_read_b64 v[140:141], v228 offset:2304
    v_mfma_f32_16x16x32_f16 v[200:203], v[72:75], v[96:99], v[200:203]
    ds_read_b64 v[142:143], v228 offset:2312
    v_mfma_f32_16x16x32_f16 v[204:207], v[72:75], v[100:103], v[204:207]
    ds_read_b64 v[144:145], v228 offset:1792
    v_mfma_f32_16x16x32_f16 v[208:211], v[72:75], v[104:107], v[208:211]
    ds_read_b64 v[146:147], v228 offset:1800
    v_mfma_f32_16x16x32_f16 v[212:215], v[72:75], v[108:111], v[212:215]
    ds_read_b64 v[148:149], v228 offset:1280
    v_mfma_f32_16x16x32_f16 v[216:219], v[72:75], v[112:115], v[216:219]
    ds_read_b64 v[150:151], v228 offset:1288
    v_mfma_f32_16x16x32_f16 v[220:223], v[72:75], v[116:119], v[220:223]
    ds_read_b64 v[152:153], v228 offset:768
    v_mfma_f32_16x16x32_f16 v[204:207], v[76:79], v[96:99], v[204:207]
    ds_read_b64 v[154:155], v228 offset:776
    v_mfma_f32_16x16x32_f16 v[208:211], v[76:79], v[100:103], v[208:211]
    ds_read_b64 v[156:157], v228 offset:256
    v_mfma_f32_16x16x32_f16 v[212:215], v[76:79], v[104:107], v[212:215]
    ds_read_b64 v[158:159], v228 offset:264
    v_mfma_f32_16x16x32_f16 v[216:219], v[76:79], v[108:111], v[216:219]
    v_mfma_f32_16x16x32_f16 v[220:223], v[76:79], v[112:115], v[220:223]
    v_mfma_f32_16x16x32_f16 v[208:211], v[80:83], v[96:99], v[208:211]
    v_mfma_f32_16x16x32_f16 v[212:215], v[80:83], v[100:103], v[212:215]
    v_mfma_f32_16x16x32_f16 v[216:219], v[80:83], v[104:107], v[216:219]
    v_mfma_f32_16x16x32_f16 v[220:223], v[80:83], v[108:111], v[220:223]
    v_mfma_f32_16x16x32_f16 v[212:215], v[84:87], v[96:99], v[212:215]
    v_mfma_f32_16x16x32_f16 v[216:219], v[84:87], v[100:103], v[216:219]
    v_mfma_f32_16x16x32_f16 v[220:223], v[84:87], v[104:107], v[220:223]
    v_mfma_f32_16x16x32_f16 v[216:219], v[88:91], v[96:99], v[216:219]
    v_mfma_f32_16x16x32_f16 v[220:223], v[88:91], v[100:103], v[220:223]
    v_mfma_f32_16x16x32_f16 v[220:223], v[92:95], v[96:99], v[220:223]
    s_waitcnt lgkmcnt(0)
    v_mfma_f32_16x16x32_f16 v[192:195], v[128:131], v[160:163], v[192:195]
    ds_read_b64 v[64:65], v228 offset:3776
    v_mfma_f32_16x16x32_f16 v[196:199], v[128:131], v[164:167], v[196:199]
    ds_read_b64 v[66:67], v228 offset:3784
    v_mfma_f32_16x16x32_f16 v[200:203], v[128:131], v[168:171], v[200:203]
    ds_read_b128 v[96:99], v229 offset:224
    v_mfma_f32_16x16x32_f16 v[204:207], v[128:131], v[172:175], v[204:207]
    ds_read_b128 v[100:103], v229 offset:736
    v_mfma_f32_16x16x32_f16 v[208:211], v[128:131], v[176:179], v[208:211]
    ds_read_b128 v[104:107], v229 offset:1248
    v_mfma_f32_16x16x32_f16 v[212:215], v[128:131], v[180:183], v[212:215]
    ds_read_b128 v[108:111], v229 offset:1760
    v_mfma_f32_16x16x32_f16 v[216:219], v[128:131], v[184:187], v[216:219]
    ds_read_b128 v[112:115], v229 offset:2272
    v_mfma_f32_16x16x32_f16 v[220:223], v[128:131], v[188:191], v[220:223]
    ds_read_b128 v[116:119], v229 offset:2784
    v_mfma_f32_16x16x32_f16 v[196:199], v[132:135], v[160:163], v[196:199]
    ds_read_b128 v[120:123], v229 offset:3296
    v_mfma_f32_16x16x32_f16 v[200:203], v[132:135], v[164:167], v[200:203]
    ds_read_b128 v[124:127], v229 offset:3808
    v_mfma_f32_16x16x32_f16 v[204:207], v[132:135], v[168:171], v[204:207]
    ds_read_b64 v[68:69], v228 offset:3264
    v_mfma_f32_16x16x32_f16 v[208:211], v[132:135], v[172:175], v[208:211]
    ds_read_b64 v[70:71], v228 offset:3272
    v_mfma_f32_16x16x32_f16 v[212:215], v[132:135], v[176:179], v[212:215]
    ds_read_b64 v[72:73], v228 offset:2752
    v_mfma_f32_16x16x32_f16 v[216:219], v[132:135], v[180:183], v[216:219]
    ds_read_b64 v[74:75], v228 offset:2760
    v_mfma_f32_16x16x32_f16 v[220:223], v[132:135], v[184:187], v[220:223]
    ds_read_b64 v[76:77], v228 offset:2240
    v_mfma_f32_16x16x32_f16 v[200:203], v[136:139], v[160:163], v[200:203]
    ds_read_b64 v[78:79], v228 offset:2248
    v_mfma_f32_16x16x32_f16 v[204:207], v[136:139], v[164:167], v[204:207]
    ds_read_b64 v[80:81], v228 offset:1728
    v_mfma_f32_16x16x32_f16 v[208:211], v[136:139], v[168:171], v[208:211]
    ds_read_b64 v[82:83], v228 offset:1736
    v_mfma_f32_16x16x32_f16 v[212:215], v[136:139], v[172:175], v[212:215]
    ds_read_b64 v[84:85], v228 offset:1216
    v_mfma_f32_16x16x32_f16 v[216:219], v[136:139], v[176:179], v[216:219]
    ds_read_b64 v[86:87], v228 offset:1224
    v_mfma_f32_16x16x32_f16 v[220:223], v[136:139], v[180:183], v[220:223]
    ds_read_b64 v[88:89], v228 offset:704
    v_mfma_f32_16x16x32_f16 v[204:207], v[140:143], v[160:163], v[204:207]
    ds_read_b64 v[90:91], v228 offset:712
    v_mfma_f32_16x16x32_f16 v[208:211], v[140:143], v[164:167], v[208:211]
    ds_read_b64 v[92:93], v228 offset:192
    v_mfma_f32_16x16x32_f16 v[212:215], v[140:143], v[168:171], v[212:215]
    ds_read_b64 v[94:95], v228 offset:200
    v_mfma_f32_16x16x32_f16 v[216:219], v[140:143], v[172:175], v[216:219]
    v_mfma_f32_16x16x32_f16 v[220:223], v[140:143], v[176:179], v[220:223]
    v_mfma_f32_16x16x32_f16 v[208:211], v[144:147], v[160:163], v[208:211]
    v_mfma_f32_16x16x32_f16 v[212:215], v[144:147], v[164:167], v[212:215]
    v_mfma_f32_16x16x32_f16 v[216:219], v[144:147], v[168:171], v[216:219]
    v_mfma_f32_16x16x32_f16 v[220:223], v[144:147], v[172:175], v[220:223]
    v_mfma_f32_16x16x32_f16 v[212:215], v[148:151], v[160:163], v[212:215]
    v_mfma_f32_16x16x32_f16 v[216:219], v[148:151], v[164:167], v[216:219]
    v_mfma_f32_16x16x32_f16 v[220:223], v[148:151], v[168:171], v[220:223]
    v_mfma_f32_16x16x32_f16 v[216:219], v[152:155], v[160:163], v[216:219]
    v_mfma_f32_16x16x32_f16 v[220:223], v[152:155], v[164:167], v[220:223]
    v_mfma_f32_16x16x32_f16 v[220:223], v[156:159], v[160:163], v[220:223]
    s_waitcnt lgkmcnt(0)
    v_mfma_f32_16x16x32_f16 v[192:195], v[64:67], v[96:99], v[192:195]
    ds_read_b64 v[128:129], v228 offset:3712
    v_mfma_f32_16x16x32_f16 v[196:199], v[64:67], v[100:103], v[196:199]
    ds_read_b64 v[130:131], v228 offset:3720
    v_mfma_f32_16x16x32_f16 v[200:203], v[64:67], v[104:107], v[200:203]
    ds_read_b128 v[160:163], v229 offset:160
    v_mfma_f32_16x16x32_f16 v[204:207], v[64:67], v[108:111], v[204:207]
    ds_read_b128 v[164:167], v229 offset:672
    v_mfma_f32_16x16x32_f16 v[208:211], v[64:67], v[112:115], v[208:211]
    ds_read_b128 v[168:171], v229 offset:1184
    v_mfma_f32_16x16x32_f16 v[212:215], v[64:67], v[116:119], v[212:215]
    ds_read_b128 v[172:175], v229 offset:1696
    v_mfma_f32_16x16x32_f16 v[216:219], v[64:67], v[120:123], v[216:219]
    ds_read_b128 v[176:179], v229 offset:2208
    v_mfma_f32_16x16x32_f16 v[220:223], v[64:67], v[124:127], v[220:223]
    ds_read_b128 v[180:183], v229 offset:2720
    v_mfma_f32_16x16x32_f16 v[196:199], v[68:71], v[96:99], v[196:199]
    ds_read_b128 v[184:187], v229 offset:3232
    v_mfma_f32_16x16x32_f16 v[200:203], v[68:71], v[100:103], v[200:203]
    ds_read_b128 v[188:191], v229 offset:3744
    v_mfma_f32_16x16x32_f16 v[204:207], v[68:71], v[104:107], v[204:207]
    ds_read_b64 v[132:133], v228 offset:3200
    v_mfma_f32_16x16x32_f16 v[208:211], v[68:71], v[108:111], v[208:211]
    ds_read_b64 v[134:135], v228 offset:3208
    v_mfma_f32_16x16x32_f16 v[212:215], v[68:71], v[112:115], v[212:215]
    ds_read_b64 v[136:137], v228 offset:2688
    v_mfma_f32_16x16x32_f16 v[216:219], v[68:71], v[116:119], v[216:219]
    ds_read_b64 v[138:139], v228 offset:2696
    v_mfma_f32_16x16x32_f16 v[220:223], v[68:71], v[120:123], v[220:223]
    ds_read_b64 v[140:141], v228 offset:2176
    v_mfma_f32_16x16x32_f16 v[200:203], v[72:75], v[96:99], v[200:203]
    ds_read_b64 v[142:143], v228 offset:2184
    v_mfma_f32_16x16x32_f16 v[204:207], v[72:75], v[100:103], v[204:207]
    ds_read_b64 v[144:145], v228 offset:1664
    v_mfma_f32_16x16x32_f16 v[208:211], v[72:75], v[104:107], v[208:211]
    ds_read_b64 v[146:147], v228 offset:1672
    v_mfma_f32_16x16x32_f16 v[212:215], v[72:75], v[108:111], v[212:215]
    ds_read_b64 v[148:149], v228 offset:1152
    v_mfma_f32_16x16x32_f16 v[216:219], v[72:75], v[112:115], v[216:219]
    ds_read_b64 v[150:151], v228 offset:1160
    v_mfma_f32_16x16x32_f16 v[220:223], v[72:75], v[116:119], v[220:223]
    ds_read_b64 v[152:153], v228 offset:640
    v_mfma_f32_16x16x32_f16 v[204:207], v[76:79], v[96:99], v[204:207]
    ds_read_b64 v[154:155], v228 offset:648
    v_mfma_f32_16x16x32_f16 v[208:211], v[76:79], v[100:103], v[208:211]
    ds_read_b64 v[156:157], v228 offset:128
    v_mfma_f32_16x16x32_f16 v[212:215], v[76:79], v[104:107], v[212:215]
    ds_read_b64 v[158:159], v228 offset:136
    v_mfma_f32_16x16x32_f16 v[216:219], v[76:79], v[108:111], v[216:219]
    v_mfma_f32_16x16x32_f16 v[220:223], v[76:79], v[112:115], v[220:223]
    v_mfma_f32_16x16x32_f16 v[208:211], v[80:83], v[96:99], v[208:211]
    v_mfma_f32_16x16x32_f16 v[212:215], v[80:83], v[100:103], v[212:215]
    v_mfma_f32_16x16x32_f16 v[216:219], v[80:83], v[104:107], v[216:219]
    v_mfma_f32_16x16x32_f16 v[220:223], v[80:83], v[108:111], v[220:223]
    v_mfma_f32_16x16x32_f16 v[212:215], v[84:87], v[96:99], v[212:215]
    v_mfma_f32_16x16x32_f16 v[216:219], v[84:87], v[100:103], v[216:219]
    v_mfma_f32_16x16x32_f16 v[220:223], v[84:87], v[104:107], v[220:223]
    v_mfma_f32_16x16x32_f16 v[216:219], v[88:91], v[96:99], v[216:219]
    v_mfma_f32_16x16x32_f16 v[220:223], v[88:91], v[100:103], v[220:223]
    v_mfma_f32_16x16x32_f16 v[220:223], v[92:95], v[96:99], v[220:223]
    s_waitcnt lgkmcnt(0)
    v_mfma_f32_16x16x32_f16 v[192:195], v[128:131], v[160:163], v[192:195]
    ds_read_b64 v[64:65], v228 offset:3648
    v_mfma_f32_16x16x32_f16 v[196:199], v[128:131], v[164:167], v[196:199]
    ds_read_b64 v[66:67], v228 offset:3656
    v_mfma_f32_16x16x32_f16 v[200:203], v[128:131], v[168:171], v[200:203]
    ds_read_b128 v[96:99], v229 offset:96
    v_mfma_f32_16x16x32_f16 v[204:207], v[128:131], v[172:175], v[204:207]
    ds_read_b128 v[100:103], v229 offset:608
    v_mfma_f32_16x16x32_f16 v[208:211], v[128:131], v[176:179], v[208:211]
    ds_read_b128 v[104:107], v229 offset:1120
    v_mfma_f32_16x16x32_f16 v[212:215], v[128:131], v[180:183], v[212:215]
    ds_read_b128 v[108:111], v229 offset:1632
    v_mfma_f32_16x16x32_f16 v[216:219], v[128:131], v[184:187], v[216:219]
    ds_read_b128 v[112:115], v229 offset:2144
    v_mfma_f32_16x16x32_f16 v[220:223], v[128:131], v[188:191], v[220:223]
    ds_read_b128 v[116:119], v229 offset:2656
    v_mfma_f32_16x16x32_f16 v[196:199], v[132:135], v[160:163], v[196:199]
    ds_read_b128 v[120:123], v229 offset:3168
    v_mfma_f32_16x16x32_f16 v[200:203], v[132:135], v[164:167], v[200:203]
    ds_read_b128 v[124:127], v229 offset:3680
    v_mfma_f32_16x16x32_f16 v[204:207], v[132:135], v[168:171], v[204:207]
    ds_read_b64 v[68:69], v228 offset:3136
    v_mfma_f32_16x16x32_f16 v[208:211], v[132:135], v[172:175], v[208:211]
    ds_read_b64 v[70:71], v228 offset:3144
    v_mfma_f32_16x16x32_f16 v[212:215], v[132:135], v[176:179], v[212:215]
    ds_read_b64 v[72:73], v228 offset:2624
    v_mfma_f32_16x16x32_f16 v[216:219], v[132:135], v[180:183], v[216:219]
    ds_read_b64 v[74:75], v228 offset:2632
    v_mfma_f32_16x16x32_f16 v[220:223], v[132:135], v[184:187], v[220:223]
    ds_read_b64 v[76:77], v228 offset:2112
    v_mfma_f32_16x16x32_f16 v[200:203], v[136:139], v[160:163], v[200:203]
    ds_read_b64 v[78:79], v228 offset:2120
    v_mfma_f32_16x16x32_f16 v[204:207], v[136:139], v[164:167], v[204:207]
    ds_read_b64 v[80:81], v228 offset:1600
    v_mfma_f32_16x16x32_f16 v[208:211], v[136:139], v[168:171], v[208:211]
    ds_read_b64 v[82:83], v228 offset:1608
    v_mfma_f32_16x16x32_f16 v[212:215], v[136:139], v[172:175], v[212:215]
    ds_read_b64 v[84:85], v228 offset:1088
    v_mfma_f32_16x16x32_f16 v[216:219], v[136:139], v[176:179], v[216:219]
    ds_read_b64 v[86:87], v228 offset:1096
    v_mfma_f32_16x16x32_f16 v[220:223], v[136:139], v[180:183], v[220:223]
    ds_read_b64 v[88:89], v228 offset:576
    v_mfma_f32_16x16x32_f16 v[204:207], v[140:143], v[160:163], v[204:207]
    ds_read_b64 v[90:91], v228 offset:584
    v_mfma_f32_16x16x32_f16 v[208:211], v[140:143], v[164:167], v[208:211]
    ds_read_b64 v[92:93], v228 offset:64
    v_mfma_f32_16x16x32_f16 v[212:215], v[140:143], v[168:171], v[212:215]
    ds_read_b64 v[94:95], v228 offset:72
    v_mfma_f32_16x16x32_f16 v[216:219], v[140:143], v[172:175], v[216:219]
    v_mfma_f32_16x16x32_f16 v[220:223], v[140:143], v[176:179], v[220:223]
    v_mfma_f32_16x16x32_f16 v[208:211], v[144:147], v[160:163], v[208:211]
    v_mfma_f32_16x16x32_f16 v[212:215], v[144:147], v[164:167], v[212:215]
    v_mfma_f32_16x16x32_f16 v[216:219], v[144:147], v[168:171], v[216:219]
    v_mfma_f32_16x16x32_f16 v[220:223], v[144:147], v[172:175], v[220:223]
    v_mfma_f32_16x16x32_f16 v[212:215], v[148:151], v[160:163], v[212:215]
    v_mfma_f32_16x16x32_f16 v[216:219], v[148:151], v[164:167], v[216:219]
    v_mfma_f32_16x16x32_f16 v[220:223], v[148:151], v[168:171], v[220:223]
    v_mfma_f32_16x16x32_f16 v[216:219], v[152:155], v[160:163], v[216:219]
    v_mfma_f32_16x16x32_f16 v[220:223], v[152:155], v[164:167], v[220:223]
    v_mfma_f32_16x16x32_f16 v[220:223], v[156:159], v[160:163], v[220:223]
    s_waitcnt lgkmcnt(0)
    v_mfma_f32_16x16x32_f16 v[192:195], v[64:67], v[96:99], v[192:195]
    ds_read_b64 v[128:129], v228 offset:3584
    v_mfma_f32_16x16x32_f16 v[196:199], v[64:67], v[100:103], v[196:199]
    ds_read_b64 v[130:131], v228 offset:3592
    v_mfma_f32_16x16x32_f16 v[200:203], v[64:67], v[104:107], v[200:203]
    ds_read_b128 v[160:163], v229 offset:32
    v_mfma_f32_16x16x32_f16 v[204:207], v[64:67], v[108:111], v[204:207]
    ds_read_b128 v[164:167], v229 offset:544
    v_mfma_f32_16x16x32_f16 v[208:211], v[64:67], v[112:115], v[208:211]
    ds_read_b128 v[168:171], v229 offset:1056
    v_mfma_f32_16x16x32_f16 v[212:215], v[64:67], v[116:119], v[212:215]
    ds_read_b128 v[172:175], v229 offset:1568
    v_mfma_f32_16x16x32_f16 v[216:219], v[64:67], v[120:123], v[216:219]
    ds_read_b128 v[176:179], v229 offset:2080
    v_mfma_f32_16x16x32_f16 v[220:223], v[64:67], v[124:127], v[220:223]
    ds_read_b128 v[180:183], v229 offset:2592
    v_mfma_f32_16x16x32_f16 v[196:199], v[68:71], v[96:99], v[196:199]
    ds_read_b128 v[184:187], v229 offset:3104
    v_mfma_f32_16x16x32_f16 v[200:203], v[68:71], v[100:103], v[200:203]
    ds_read_b128 v[188:191], v229 offset:3616
    v_mfma_f32_16x16x32_f16 v[204:207], v[68:71], v[104:107], v[204:207]
    ds_read_b64 v[132:133], v228 offset:3072
    v_mfma_f32_16x16x32_f16 v[208:211], v[68:71], v[108:111], v[208:211]
    ds_read_b64 v[134:135], v228 offset:3080
    v_mfma_f32_16x16x32_f16 v[212:215], v[68:71], v[112:115], v[212:215]
    ds_read_b64 v[136:137], v228 offset:2560
    v_mfma_f32_16x16x32_f16 v[216:219], v[68:71], v[116:119], v[216:219]
    ds_read_b64 v[138:139], v228 offset:2568
    v_mfma_f32_16x16x32_f16 v[220:223], v[68:71], v[120:123], v[220:223]
    ds_read_b64 v[140:141], v228 offset:2048
    v_mfma_f32_16x16x32_f16 v[200:203], v[72:75], v[96:99], v[200:203]
    ds_read_b64 v[142:143], v228 offset:2056
    v_mfma_f32_16x16x32_f16 v[204:207], v[72:75], v[100:103], v[204:207]
    ds_read_b64 v[144:145], v228 offset:1536
    v_mfma_f32_16x16x32_f16 v[208:211], v[72:75], v[104:107], v[208:211]
    ds_read_b64 v[146:147], v228 offset:1544
    v_mfma_f32_16x16x32_f16 v[212:215], v[72:75], v[108:111], v[212:215]
    ds_read_b64 v[148:149], v228 offset:1024
    v_mfma_f32_16x16x32_f16 v[216:219], v[72:75], v[112:115], v[216:219]
    ds_read_b64 v[150:151], v228 offset:1032
    v_mfma_f32_16x16x32_f16 v[220:223], v[72:75], v[116:119], v[220:223]
    ds_read_b64 v[152:153], v228 offset:512
    v_mfma_f32_16x16x32_f16 v[204:207], v[76:79], v[96:99], v[204:207]
    ds_read_b64 v[154:155], v228 offset:520
    v_mfma_f32_16x16x32_f16 v[208:211], v[76:79], v[100:103], v[208:211]
    ds_read_b64 v[156:157], v228 offset:0
    v_mfma_f32_16x16x32_f16 v[212:215], v[76:79], v[104:107], v[212:215]
    ds_read_b64 v[158:159], v228 offset:8
    v_mfma_f32_16x16x32_f16 v[216:219], v[76:79], v[108:111], v[216:219]
    v_mfma_f32_16x16x32_f16 v[220:223], v[76:79], v[112:115], v[220:223]
    v_mfma_f32_16x16x32_f16 v[208:211], v[80:83], v[96:99], v[208:211]
    v_mfma_f32_16x16x32_f16 v[212:215], v[80:83], v[100:103], v[212:215]
    v_mfma_f32_16x16x32_f16 v[216:219], v[80:83], v[104:107], v[216:219]
    v_mfma_f32_16x16x32_f16 v[220:223], v[80:83], v[108:111], v[220:223]
    v_mfma_f32_16x16x32_f16 v[212:215], v[84:87], v[96:99], v[212:215]
    v_mfma_f32_16x16x32_f16 v[216:219], v[84:87], v[100:103], v[216:219]
    v_mfma_f32_16x16x32_f16 v[220:223], v[84:87], v[104:107], v[220:223]
    v_mfma_f32_16x16x32_f16 v[216:219], v[88:91], v[96:99], v[216:219]
    v_mfma_f32_16x16x32_f16 v[220:223], v[88:91], v[100:103], v[220:223]
    v_mfma_f32_16x16x32_f16 v[220:223], v[92:95], v[96:99], v[220:223]
    s_waitcnt lgkmcnt(0)
    v_mfma_f32_16x16x32_f16 v[192:195], v[128:131], v[160:163], v[192:195]
    v_mfma_f32_16x16x32_f16 v[196:199], v[128:131], v[164:167], v[196:199]
    v_mfma_f32_16x16x32_f16 v[200:203], v[128:131], v[168:171], v[200:203]
    v_mfma_f32_16x16x32_f16 v[204:207], v[128:131], v[172:175], v[204:207]
    v_mfma_f32_16x16x32_f16 v[208:211], v[128:131], v[176:179], v[208:211]
    v_mfma_f32_16x16x32_f16 v[212:215], v[128:131], v[180:183], v[212:215]
    v_mfma_f32_16x16x32_f16 v[216:219], v[128:131], v[184:187], v[216:219]
    v_mfma_f32_16x16x32_f16 v[220:223], v[128:131], v[188:191], v[220:223]
    v_mfma_f32_16x16x32_f16 v[196:199], v[132:135], v[160:163], v[196:199]
    v_mfma_f32_16x16x32_f16 v[200:203], v[132:135], v[164:167], v[200:203]
    v_mfma_f32_16x16x32_f16 v[204:207], v[132:135], v[168:171], v[204:207]
    v_mfma_f32_16x16x32_f16 v[208:211], v[132:135], v[172:175], v[208:211]
    v_mfma_f32_16x16x32_f16 v[212:215], v[132:135], v[176:179], v[212:215]
    v_mfma_f32_16x16x32_f16 v[216:219], v[132:135], v[180:183], v[216:219]
    v_mfma_f32_16x16x32_f16 v[220:223], v[132:135], v[184:187], v[220:223]
    v_mfma_f32_16x16x32_f16 v[200:203], v[136:139], v[160:163], v[200:203]
    v_mfma_f32_16x16x32_f16 v[204:207], v[136:139], v[164:167], v[204:207]
    v_mfma_f32_16x16x32_f16 v[208:211], v[136:139], v[168:171], v[208:211]
    v_mfma_f32_16x16x32_f16 v[212:215], v[136:139], v[172:175], v[212:215]
    v_mfma_f32_16x16x32_f16 v[216:219], v[136:139], v[176:179], v[216:219]
    v_mfma_f32_16x16x32_f16 v[220:223], v[136:139], v[180:183], v[220:223]
    v_mfma_f32_16x16x32_f16 v[204:207], v[140:143], v[160:163], v[204:207]
    v_mfma_f32_16x16x32_f16 v[208:211], v[140:143], v[164:167], v[208:211]
    v_mfma_f32_16x16x32_f16 v[212:215], v[140:143], v[168:171], v[212:215]
    v_mfma_f32_16x16x32_f16 v[216:219], v[140:143], v[172:175], v[216:219]
    v_mfma_f32_16x16x32_f16 v[220:223], v[140:143], v[176:179], v[220:223]
    v_mfma_f32_16x16x32_f16 v[208:211], v[144:147], v[160:163], v[208:211]
    v_mfma_f32_16x16x32_f16 v[212:215], v[144:147], v[164:167], v[212:215]
    v_mfma_f32_16x16x32_f16 v[216:219], v[144:147], v[168:171], v[216:219]
    v_mfma_f32_16x16x32_f16 v[220:223], v[144:147], v[172:175], v[220:223]
    v_mfma_f32_16x16x32_f16 v[212:215], v[148:151], v[160:163], v[212:215]
    v_mfma_f32_16x16x32_f16 v[216:219], v[148:151], v[164:167], v[216:219]
    v_mfma_f32_16x16x32_f16 v[220:223], v[148:151], v[168:171], v[220:223]
    v_mfma_f32_16x16x32_f16 v[216:219], v[152:155], v[160:163], v[216:219]
    v_mfma_f32_16x16x32_f16 v[220:223], v[152:155], v[164:167], v[220:223]
    v_mfma_f32_16x16x32_f16 v[220:223], v[156:159], v[160:163], v[220:223]
    v_mov_b32 v234, v233
    v_pk_mul_f32 v[192:193], v[192:193], v[234:235] op_sel_hi:[1,0]
    v_pk_mul_f32 v[194:195], v[194:195], v[234:235] op_sel_hi:[1,0]
    v_cvt_pk_bf16_f32 v192, v192, v193
    v_cvt_pk_bf16_f32 v193, v194, v195
    ds_write_b64 v230, v[192:193] offset:0
    v_pk_mul_f32 v[196:197], v[196:197], v[234:235] op_sel_hi:[1,0]
    v_pk_mul_f32 v[198:199], v[198:199], v[234:235] op_sel_hi:[1,0]
    v_cvt_pk_bf16_f32 v196, v196, v197
    v_cvt_pk_bf16_f32 v197, v198, v199
    ds_write_b64 v230, v[196:197] offset:512
    v_pk_mul_f32 v[200:201], v[200:201], v[234:235] op_sel_hi:[1,0]
    v_pk_mul_f32 v[202:203], v[202:203], v[234:235] op_sel_hi:[1,0]
    v_cvt_pk_bf16_f32 v200, v200, v201
    v_cvt_pk_bf16_f32 v201, v202, v203
    ds_write_b64 v230, v[200:201] offset:1024
    v_pk_mul_f32 v[204:205], v[204:205], v[234:235] op_sel_hi:[1,0]
    v_pk_mul_f32 v[206:207], v[206:207], v[234:235] op_sel_hi:[1,0]
    v_cvt_pk_bf16_f32 v204, v204, v205
    v_cvt_pk_bf16_f32 v205, v206, v207
    ds_write_b64 v230, v[204:205] offset:1536
    v_pk_mul_f32 v[208:209], v[208:209], v[234:235] op_sel_hi:[1,0]
    v_pk_mul_f32 v[210:211], v[210:211], v[234:235] op_sel_hi:[1,0]
    v_cvt_pk_bf16_f32 v208, v208, v209
    v_cvt_pk_bf16_f32 v209, v210, v211
    ds_write_b64 v230, v[208:209] offset:2048
    v_pk_mul_f32 v[212:213], v[212:213], v[234:235] op_sel_hi:[1,0]
    v_pk_mul_f32 v[214:215], v[214:215], v[234:235] op_sel_hi:[1,0]
    v_cvt_pk_bf16_f32 v212, v212, v213
    v_cvt_pk_bf16_f32 v213, v214, v215
    ds_write_b64 v230, v[212:213] offset:2560
    v_pk_mul_f32 v[216:217], v[216:217], v[234:235] op_sel_hi:[1,0]
    v_pk_mul_f32 v[218:219], v[218:219], v[234:235] op_sel_hi:[1,0]
    v_cvt_pk_bf16_f32 v216, v216, v217
    v_cvt_pk_bf16_f32 v217, v218, v219
    ds_write_b64 v230, v[216:217] offset:3072
    v_pk_mul_f32 v[220:221], v[220:221], v[234:235] op_sel_hi:[1,0]
    v_pk_mul_f32 v[222:223], v[222:223], v[234:235] op_sel_hi:[1,0]
    v_cvt_pk_bf16_f32 v220, v220, v221
    v_cvt_pk_bf16_f32 v221, v222, v223
    ds_write_b64 v230, v[220:221] offset:3584
    s_cmp_lg_u32 s3, 0
    s_cbranch_scc1 NOF
    s_cmp_ge_u32 s2, 112
    s_cbranch_scc1 NOF
    s_lshl_b32 s20, s2, 4
    s_add_u32 s20, s20, 20480
    v_mov_b32 v64, s20
    v_mov_b32 v65, 0
    s_mov_b64 exec, 1
    global_store_dword v64, v65, s[68:69] sc1
    s_mov_b64 exec, -1
NOF:
    s_branch CONV_JOIN
CONV_B:
    s_setprio 3
    v_mov_b32 v60, -1
    v_mov_b32 v61, -1
    v_mov_b32 v62, -1
    v_mov_b32 v63, -1
    v_and_b32 v52, 255, v0
    s_lshl_b32 s20, s6, 14
    s_add_u32 s20, s20, 10485760
    v_lshl_add_u32 v112, v52, 4, s20
    v_add_u32 v113, 8192, v112
    s_waitcnt lgkmcnt(0)
    v_add_u32 v114, 4096, v112
    v_add_u32 v115, 4096, v113
    s_cmp_lg_u32 s3, 4
    s_cbranch_scc1 CB_G
    s_cmp_ge_u32 s2, 5
    s_cbranch_scc1 CB_X
    s_lshl_b32 s20, s2, 14
    s_add_u32 s20, s20, 4096
    v_add_u32 v57, s20, v7
    v_add_u32 v56, 8192, v57
    global_store_dwordx4 v57, v[60:63], s[68:69] offset:-4096 sc1
    global_store_dwordx4 v57, v[60:63], s[68:69] offset:-3072 sc1
    global_store_dwordx4 v57, v[60:63], s[68:69] offset:-2048 sc1
    global_store_dwordx4 v57, v[60:63], s[68:69] offset:-1024 sc1
    global_store_dwordx4 v57, v[60:63], s[68:69] sc1
    global_store_dwordx4 v57, v[60:63], s[68:69] offset:1024 sc1
    global_store_dwordx4 v57, v[60:63], s[68:69] offset:2048 sc1
    global_store_dwordx4 v57, v[60:63], s[68:69] offset:3072 sc1
    global_store_dwordx4 v56, v[60:63], s[68:69] offset:-4096 sc1
    global_store_dwordx4 v56, v[60:63], s[68:69] offset:-3072 sc1
    global_store_dwordx4 v56, v[60:63], s[68:69] offset:-2048 sc1
    global_store_dwordx4 v56, v[60:63], s[68:69] offset:-1024 sc1
    global_store_dwordx4 v56, v[60:63], s[68:69] sc1
    global_store_dwordx4 v56, v[60:63], s[68:69] offset:1024 sc1
    global_store_dwordx4 v56, v[60:63], s[68:69] offset:2048 sc1
    global_store_dwordx4 v56, v[60:63], s[68:69] offset:3072 sc1
CB_G:
CB_X:
    s_lshl_b32 s20, s2, 2
    s_add_u32 s20, s20, s9
    s_mul_i32 s20, s20, 2304
    v_add_u32 v58, s20, v7
    v_add_u32 v59, s20, v13
    global_load_dwordx4 v[64:67], v58, s[36:37] nt
    global_load_ushort v68, v59, s[36:37] nt
    global_load_dwordx4 v[70:73], v58, s[36:37] offset:1152 nt
    global_load_ushort v74, v59, s[36:37] offset:1152 nt
    s_cmp_lg_u32 s3, 7
    s_cbranch_scc1 CB_Y
    s_mul_i32 s20, s2, 9216
    s_add_u32 s20, s20, 1052672
    v_add_u32 v57, s20, v7
    v_add_u32 v56, 4096, v57
    global_store_dwordx4 v57, v[60:63], s[68:69] offset:-4096 sc1
    global_store_dwordx4 v57, v[60:63], s[68:69] offset:-3072 sc1
    global_store_dwordx4 v57, v[60:63], s[68:69] offset:-2048 sc1
    global_store_dwordx4 v57, v[60:63], s[68:69] offset:-1024 sc1
    global_store_dwordx4 v57, v[60:63], s[68:69] sc1
    global_store_dwordx4 v57, v[60:63], s[68:69] offset:1024 sc1
    global_store_dwordx4 v57, v[60:63], s[68:69] offset:2048 sc1
    global_store_dwordx4 v57, v[60:63], s[68:69] offset:3072 sc1
    global_store_dwordx4 v56, v[60:63], s[68:69] sc1
CB_Y:
    v_mov_b32 v54, 0
    v_mov_b32 v55, 0
    s_mul_i32 s20, s9, 4640
    s_add_u32 s20, s20, 124928
    v_lshl_add_u32 v53, v1, 3, s20
    ds_write_b64 v53, v[54:55]
    s_waitcnt lgkmcnt(0)
    s_barrier
    s_load_dword s99, s[68:69], 94208
    v_and_b32 v52, 7, v1
    v_lshlrev_b32 v52, 3, v52
    v_lshrrev_b32 v53, 4, v1
    s_mul_i32 s20, s9, 294912
    s_lshl_b32 s21, s8, 6
    s_add_u32 s20, s20, s21
    s_add_u32 s20, s20, 0
    s_mov_b32 s21, 73728
    v_mad_u32_u24 v52, v53, s21, v52
    v_add_u32 v52, s20, v52
    v_and_b32 v54, 8, v1
    v_cmp_eq_u32 vcc, 0, v54
    v_mov_b32 v54, s56
    v_mov_b32 v55, s54
    v_cndmask_b32 v54, v54, v55, vcc
    v_mov_b32 v55, s57
    v_mov_b32 v56, s55
    v_cndmask_b32 v55, v55, v56, vcc
    v_add_co_u32 v54, vcc, v54, v52
    s_nop 1
    v_addc_co_u32 v55, vcc, 0, v55, vcc
    s_mov_b32 s20, 9216
    s_mov_b32 s21, 0
    s_mov_b32 s22, 1115136
    s_mov_b32 s23, 0
    global_load_dwordx2 v[128:129], v[54:55], off nt
    v_lshl_add_u64 v[54:55], v[54:55], 0, s[20:21]
    global_load_dwordx2 v[130:131], v[54:55], off nt
    v_lshl_add_u64 v[54:55], v[54:55], 0, s[20:21]
    global_load_dwordx2 v[132:133], v[54:55], off nt
    v_lshl_add_u64 v[54:55], v[54:55], 0, s[20:21]
    global_load_dwordx2 v[134:135], v[54:55], off nt
    v_lshl_add_u64 v[54:55], v[54:55], 0, s[20:21]
    global_load_dwordx2 v[136:137], v[54:55], off nt
    v_lshl_add_u64 v[54:55], v[54:55], 0, s[20:21]
    global_load_dwordx2 v[138:139], v[54:55], off nt
    v_lshl_add_u64 v[54:55], v[54:55], 0, s[20:21]
    global_load_dwordx2 v[140:141], v[54:55], off nt
    v_lshl_add_u64 v[54:55], v[54:55], 0, s[20:21]
    global_load_dwordx2 v[142:143], v[54:55], off nt
    v_lshl_add_u64 v[54:55], v[54:55], 0, s[22:23]
    global_load_dwordx2 v[144:145], v[54:55], off nt
    v_lshl_add_u64 v[54:55], v[54:55], 0, s[20:21]
    global_load_dwordx2 v[146:147], v[54:55], off nt
    v_lshl_add_u64 v[54:55], v[54:55], 0, s[20:21]
    global_load_dwordx2 v[148:149], v[54:55], off nt
    v_lshl_add_u64 v[54:55], v[54:55], 0, s[20:21]
    global_load_dwordx2 v[150:151], v[54:55], off nt
    v_lshl_add_u64 v[54:55], v[54:55], 0, s[20:21]
    global_load_dwordx2 v[152:153], v[54:55], off nt
    v_lshl_add_u64 v[54:55], v[54:55], 0, s[20:21]
    global_load_dwordx2 v[154:155], v[54:55], off nt
    v_lshl_add_u64 v[54:55], v[54:55], 0, s[20:21]
    global_load_dwordx2 v[156:157], v[54:55], off nt
    v_lshl_add_u64 v[54:55], v[54:55], 0, s[20:21]
    global_load_dwordx2 v[158:159], v[54:55], off nt
W5_1:
    v_and_b32 v52, 255, v0
    s_cmp_eq_u32 s3, 7
    s_cbranch_scc1 NOIF3
    s_cmp_lg_u32 s3, 4
    s_cbranch_scc1 NOIF
    s_cmp_ge_u32 s2, 5
    s_cbranch_scc1 NOIF
    s_lshl_b32 s20, s2, 2
    v_mov_b32 v54, s20
    s_mov_b64 exec, 1
    s_waitcnt vmcnt(20)
    global_store_dword v54, v60, s[66:67] sc1
    s_mov_b64 exec, -1
    s_waitcnt vmcnt(17)
    s_branch NOIF2
NOIF:
    s_waitcnt vmcnt(16)
NOIF3:
    s_waitcnt vmcnt(25)
NOIF2:
    s_mul_i32 s18, s9, 2304
    s_add_u32 s18, s18, 145024
    v_add_u32 v58, s18, v7
    v_add_u32 v59, s18, v13
    ds_write_b128 v58, v[64:67]
    ds_write_b16 v59, v68
    ds_write_b128 v58, v[70:73] offset:1152
    ds_write_b16 v59, v74 offset:1152
    v_lshlrev_b32 v80, 16, v64
    v_and_b32 v81, s12, v64
    v_lshlrev_b32 v82, 16, v65
    v_and_b32 v83, s12, v65
    v_lshlrev_b32 v84, 16, v66
    v_and_b32 v85, s12, v66
    v_lshlrev_b32 v86, 16, v67
    v_and_b32 v87, s12, v67
    v_lshlrev_b32 v88, 16, v68
    v_lshlrev_b32 v90, 16, v70
    v_and_b32 v91, s12, v70
    v_lshlrev_b32 v92, 16, v71
    v_and_b32 v93, s12, v71
    v_lshlrev_b32 v94, 16, v72
    v_and_b32 v95, s12, v72
    v_lshlrev_b32 v96, 16, v73
    v_and_b32 v97, s12, v73
    v_lshlrev_b32 v98, 16, v74
    v_readfirstlane_b32 s70, v80
    s_nop 1
    v_subrev_f32 v80, s70, v80
    v_subrev_f32 v81, s70, v81
    v_subrev_f32 v82, s70, v82
    v_subrev_f32 v83, s70, v83
    v_subrev_f32 v84, s70, v84
    v_subrev_f32 v85, s70, v85
    v_subrev_f32 v86, s70, v86
    v_subrev_f32 v87, s70, v87
    v_subrev_f32 v88, s70, v88
    v_pk_add_f32 v[100:101], v[80:81], v[82:83]
    v_pk_mul_f32 v[102:103], v[80:81], v[80:81]
    v_pk_add_f32 v[100:101], v[100:101], v[84:85]
    v_pk_fma_f32 v[102:103], v[82:83], v[82:83], v[102:103]
    v_pk_add_f32 v[100:101], v[100:101], v[86:87]
    v_pk_fma_f32 v[102:103], v[84:85], v[84:85], v[102:103]
    v_add_f32 v100, v100, v88
    v_pk_fma_f32 v[102:103], v[86:87], v[86:87], v[102:103]
    v_add_f32 v100, v100, v101
    v_fmac_f32 v102, v88, v88
    v_add_f32 v102, v102, v103
    v_readfirstlane_b32 s71, v90
    s_nop 1
    v_subrev_f32 v90, s71, v90
    v_subrev_f32 v91, s71, v91
    v_subrev_f32 v92, s71, v92
    v_subrev_f32 v93, s71, v93
    v_subrev_f32 v94, s71, v94
    v_subrev_f32 v95, s71, v95
    v_subrev_f32 v96, s71, v96
    v_subrev_f32 v97, s71, v97
    v_subrev_f32 v98, s71, v98
    v_pk_add_f32 v[104:105], v[90:91], v[92:93]
    v_pk_mul_f32 v[106:107], v[90:91], v[90:91]
    v_pk_add_f32 v[104:105], v[104:105], v[94:95]
    v_pk_fma_f32 v[106:107], v[92:93], v[92:93], v[106:107]
    v_pk_add_f32 v[104:105], v[104:105], v[96:97]
    v_pk_fma_f32 v[106:107], v[94:95], v[94:95], v[106:107]
    v_add_f32 v104, v104, v98
    v_pk_fma_f32 v[106:107], v[96:97], v[96:97], v[106:107]
    v_add_f32 v104, v104, v105
    v_fmac_f32 v106, v98, v98
    v_add_f32 v106, v106, v107
    v_permlane32_swap_b32 v100, v104
    s_nop 0
    v_permlane32_swap_b32 v102, v106
    v_add_f32 v100, v100, v104
    v_add_f32 v102, v102, v106
    s_nop 1
    v_permlane16_swap_b32 v100, v102
    v_add_f32 v100, v100, v102
    s_nop 1
    v_add_f32_dpp v100, v100, v100 row_ror:8 row_mask:0xf bank_mask:0xf
    s_nop 1
    v_add_f32_dpp v100, v100, v100 row_ror:4 row_mask:0xf bank_mask:0xf
    s_nop 1
    v_add_f32_dpp v100, v100, v100 row_ror:2 row_mask:0xf bank_mask:0xf
    s_nop 1
    v_add_f32_dpp v100, v100, v100 row_ror:1 row_mask:0xf bank_mask:0xf
    v_mov_b32 v102, v100
    s_nop 1
    v_permlane16_swap_b32 v100, v102
    v_mov_b32 v104, s70
    v_mov_b32 v105, s71
    v_cmp_gt_u32 vcc, 32, v1
    s_nop 1
    v_cndmask_b32 v104, v105, v104, vcc
    v_mul_f32 v100, 0x3ae38e39, v100
    v_mul_f32 v102, 0x3ae38e39, v102
    v_add_f32 v105, v104, v100
    v_fma_f32 v107, -v100, v100, v102
    v_max_f32 v107, 0, v107
    v_cvt_pk_bf16_f32 v107, v107, v107
    v_and_b32 v107, s12, v107
    v_add_f32 v107, 0x3727c5ac, v107
    v_cvt_pk_bf16_f32 v107, v107, v107
    v_and_b32 v107, s12, v107
    v_sqrt_f32 v106, v107
    v_cvt_pk_bf16_f32 v105, v105, v105
    v_and_b32 v105, s12, v105
    v_cvt_pk_bf16_f32 v106, v106, v106
    v_and_b32 v106, s12, v106
    v_rcp_f32 v100, v106
    v_sub_f32 v101, v104, v105
    v_mul_f32 v101, v101, v100
    v_mov_b32 v102, v100
    v_mov_b32 v103, v101
    s_nop 0
    v_permlane32_swap_b32 v100, v102
    v_permlane32_swap_b32 v101, v103
    s_mul_i32 s18, s9, 2304
    s_add_u32 s18, s18, 154240
    v_lshl_add_u32 v58, v1, 5, s18
    v_lshl_add_u32 v59, v1, 2, s18
    v_pk_fma_f32 v[80:81], v[80:81], v[100:101], v[100:101] op_sel:[0,0,1] op_sel_hi:[1,0,1]
    v_pk_fma_f32 v[82:83], v[82:83], v[100:101], v[100:101] op_sel:[0,0,1] op_sel_hi:[1,0,1]
    v_pk_fma_f32 v[84:85], v[84:85], v[100:101], v[100:101] op_sel:[0,0,1] op_sel_hi:[1,0,1]
    v_pk_fma_f32 v[86:87], v[86:87], v[100:101], v[100:101] op_sel:[0,0,1] op_sel_hi:[1,0,1]
    v_fma_f32 v88, v88, v100, v101
    v_pk_fma_f32 v[90:91], v[90:91], v[102:103], v[102:103] op_sel:[0,0,1] op_sel_hi:[1,0,1]
    v_pk_fma_f32 v[92:93], v[92:93], v[102:103], v[102:103] op_sel:[0,0,1] op_sel_hi:[1,0,1]
    v_pk_fma_f32 v[94:95], v[94:95], v[102:103], v[102:103] op_sel:[0,0,1] op_sel_hi:[1,0,1]
    v_pk_fma_f32 v[96:97], v[96:97], v[102:103], v[102:103] op_sel:[0,0,1] op_sel_hi:[1,0,1]
    v_fma_f32 v98, v98, v102, v103
    v_cvt_pkrtz_f16_f32 v64, v80, v90
    v_cvt_pkrtz_f16_f32 v65, v81, v91
    v_cvt_pkrtz_f16_f32 v66, v82, v92
    v_cvt_pkrtz_f16_f32 v67, v83, v93
    v_cvt_pkrtz_f16_f32 v68, v84, v94
    v_cvt_pkrtz_f16_f32 v69, v85, v95
    v_cvt_pkrtz_f16_f32 v70, v86, v96
    v_cvt_pkrtz_f16_f32 v71, v87, v97
    v_cvt_pkrtz_f16_f32 v72, v88, v98
    v_add_u32 v64, 0x00040004, v64
    v_add_u32 v65, 0x00040004, v65
    v_add_u32 v66, 0x00040004, v66
    v_add_u32 v67, 0x00040004, v67
    v_add_u32 v68, 0x00040004, v68
    v_add_u32 v69, 0x00040004, v69
    v_add_u32 v70, 0x00040004, v70
    v_add_u32 v71, 0x00040004, v71
    v_add_u32 v72, 0x00040004, v72
    ds_write_b128 v58, v[64:67]
    ds_write_b128 v58, v[68:71] offset:16
    ds_write_b32 v59, v72 offset:2048
    s_lshl_b32 s14, s9, 2
    s_add_u32 s14, s14, 143584
    v_mov_b32 v58, s14
    v_mov_b32 v59, 0
    v_and_b32 v104, 3, v1
    v_lshlrev_b32 v100, 4, v104
    v_lshlrev_b32 v104, 2, v104
    v_add_u32 v104, 143584, v104
    v_and_b32 v52, 255, v0
    v_lshrrev_b32 v101, 2, v52
    v_lshl_add_u32 v101, v101, 14, v100
    s_lshl_b32 s14, s2, 6
    s_add_u32 s14, s14, 10485760
    v_add_u32 v101, s14, v101
    v_add_u32 v102, 1048576, v101
    v_and_b32 v103, 15, v1
    v_lshl_add_u32 v103, s9, 4, v103
    v_lshrrev_b32 v99, 2, v103
    v_lshl_add_u32 v99, v99, 14, v100
    v_add_u32 v99, s14, v99
    v_add_u32 v99, 2097152, v99
    v_lshlrev_b32 v103, 2, v103
    v_add_u32 v103, 156288, v103
    v_lshlrev_b32 v100, 2, v52
    v_add_u32 v100, 154240, v100
IFD_5:
    ds_write_b32 v58, v59
    s_waitcnt lgkmcnt(0)
    s_add_u32 s99, s99, 1
    s_mov_b32 s98, 458759
    s_lshr_b32 s20, s99, 0
    s_and_b32 s20, s20, s98
    v_mov_b32 v108, s20
    s_lshr_b32 s20, s99, 3
    s_and_b32 s20, s20, s98
    v_mov_b32 v109, s20
    s_lshr_b32 s20, s99, 6
    s_and_b32 s20, s20, s98
    v_mov_b32 v110, s20
    s_lshr_b32 s20, s99, 9
    s_and_b32 s20, s20, s98
    v_mov_b32 v111, s20
SL_2:
    ds_read_b32 v105, v104
    s_waitcnt lgkmcnt(0)
    v_cmp_eq_u32 vcc, -1, v105
    s_cbranch_vccz SLD_3
    s_sub_u32 s10, s10, 1
    s_cbranch_scc1 EXIT
    s_branch SL_2
SLD_3:
    ds_read_b32 v80, v100 offset:0
    ds_read_b32 v81, v100 offset:2304
    ds_read_b32 v82, v100 offset:4608
    ds_read_b32 v83, v100 offset:6912
    ds_read_b32 v84, v100 offset:1024
    ds_read_b32 v85, v100 offset:3328
    ds_read_b32 v86, v100 offset:5632
    ds_read_b32 v87, v100 offset:7936
    ds_read_b32 v88, v103 offset:0
    ds_read_b32 v89, v103 offset:2304
    ds_read_b32 v90, v103 offset:4608
    ds_read_b32 v91, v103 offset:6912
    s_waitcnt lgkmcnt(8)
    v_bfi_b32 v80, s98, v108, v80
    v_bfi_b32 v81, s98, v109, v81
    v_bfi_b32 v82, s98, v110, v82
    v_bfi_b32 v83, s98, v111, v83
    global_store_dwordx4 v101, v[80:83], s[68:69] sc1
    s_waitcnt lgkmcnt(4)
    v_bfi_b32 v84, s98, v108, v84
    v_bfi_b32 v85, s98, v109, v85
    v_bfi_b32 v86, s98, v110, v86
    v_bfi_b32 v87, s98, v111, v87
    global_store_dwordx4 v102, v[84:87], s[68:69] sc1
    s_waitcnt lgkmcnt(0)
    v_bfi_b32 v88, s98, v108, v88
    v_bfi_b32 v89, s98, v109, v89
    v_bfi_b32 v90, s98, v110, v90
    v_bfi_b32 v91, s98, v111, v91
    s_mov_b64 exec, 0xffff
    global_store_dwordx4 v99, v[88:91], s[68:69] sc1
    s_mov_b64 exec, -1
    s_cmp_lg_u32 s3, 7
    s_cbranch_scc1 GIF_6
    s_lshl_b32 s20, s2, 4
    s_add_u32 s20, s20, 90112
    v_mov_b32 v92, s20
    v_mov_b32 v76, s99
    v_mov_b32 v77, s99
    v_mov_b32 v78, s99
    v_mov_b32 v79, s99
    s_mov_b64 exec, 1
    s_waitcnt vmcnt(3)
    global_store_dwordx4 v92, v[76:79], s[68:69] sc1
    s_mov_b64 exec, -1
GIF_6:
    s_setprio 0
    v_and_b32 v54, 3, v1
    s_movk_i32 s18, 4640
    v_mul_u32_u24 v55, s18, v54
    v_lshrrev_b32 v53, 2, v52
    v_lshl_add_u32 v55, v53, 4, v55
    v_add_u32 v55, 125440, v55
    s_lshl_b32 s18, s6, 4
    s_add_u32 s18, s18, 81920
    v_lshl_add_u32 v54, v54, 2, s18
    s_waitcnt vmcnt(0) lgkmcnt(0)
    global_load_dwordx4 v[64:67], v112, s[68:69] sc1
    global_load_dwordx4 v[68:71], v114, s[68:69] sc1
    global_load_dwordx4 v[72:75], v113, s[68:69] sc1
    global_load_dwordx4 v[76:79], v115, s[68:69] sc1
    global_load_dword v56, v54, s[68:69] sc1
    global_load_dword v57, v54, s[68:69] offset:2304 sc1
    s_waitcnt vmcnt(2)
NP:
    v_xor_b32 v176, v64, v108
    v_xor_b32 v177, v65, v109
    v_xor_b32 v178, v66, v110
    v_xor_b32 v179, v67, v111
    v_xor_b32 v180, v68, v108
    v_xor_b32 v181, v69, v109
    v_xor_b32 v182, v70, v110
    v_xor_b32 v183, v71, v111
    v_xor_b32 v184, v72, v108
    v_xor_b32 v185, v73, v109
    v_xor_b32 v186, v74, v110
    v_xor_b32 v187, v75, v111
    v_xor_b32 v188, v76, v108
    v_xor_b32 v189, v77, v109
    v_xor_b32 v190, v78, v110
    v_xor_b32 v191, v79, v111
    v_or3_b32 v80, v176, v177, v178
    v_or3_b32 v81, v179, v180, v181
    v_or3_b32 v82, v182, v183, v184
    v_or3_b32 v83, v185, v186, v187
    v_or3_b32 v84, v188, v189, v190
    v_or3_b32 v80, v80, v81, v82
    v_or3_b32 v83, v83, v84, v191
    v_or_b32 v80, v80, v83
    v_and_b32 v80, s98, v80
    s_nop 1
    v_or_b32_dpp v80, v80, v80 quad_perm:[1,0,3,2] row_mask:0xf bank_mask:0xf
    s_nop 1
    v_or_b32_dpp v80, v80, v80 quad_perm:[2,3,0,1] row_mask:0xf bank_mask:0xf
    v_cmp_ne_u32 vcc, 0, v80
    s_cbranch_vccz NPD
    s_mov_b64 exec, vcc
    global_load_dwordx4 v[64:67], v112, s[68:69] sc1
    global_load_dwordx4 v[68:71], v114, s[68:69] sc1
    global_load_dwordx4 v[72:75], v113, s[68:69] sc1
    global_load_dwordx4 v[76:79], v115, s[68:69] sc1
    s_mov_b64 exec, -1
    s_waitcnt vmcnt(0)
    s_sub_u32 s10, s10, 1
    s_cbranch_scc1 EXIT
    s_branch NP
NPD:
    s_waitcnt vmcnt(0)
MDP:
    v_xor_b32 v58, s99, v56
    v_xor_b32 v59, s99, v57
    v_or_b32 v58, v58, v59
    v_lshlrev_b32 v58, 16, v58
    v_cmp_ne_u32 vcc, 0, v58
    s_cbranch_vccz MDPD
    global_load_dword v56, v54, s[68:69] sc1
    global_load_dword v57, v54, s[68:69] offset:2304 sc1
    s_waitcnt vmcnt(0)
    s_sub_u32 s10, s10, 1
    s_cbranch_scc1 EXIT
    s_branch MDP
MDPD:
    v_and_b32 v58, s12, v57
    v_and_b32 v59, s12, v56
    v_add_f32 v58, 1.0, v58
    v_cvt_pk_bf16_f32 v58, v58, v58
    v_and_b32 v58, s12, v58
    v_cvt_pk_f16_f32 v58, v58, v59
    v_pk_fma_f16 v64, v176, v58, v58 op_sel:[0,0,1] op_sel_hi:[1,0,1]
    v_pk_fma_f16 v65, v177, v58, v58 op_sel:[0,0,1] op_sel_hi:[1,0,1]
    v_pk_fma_f16 v66, v178, v58, v58 op_sel:[0,0,1] op_sel_hi:[1,0,1]
    v_pk_fma_f16 v67, v179, v58, v58 op_sel:[0,0,1] op_sel_hi:[1,0,1]
    ds_write_b128 v55, v[64:67] offset:0
    v_pk_fma_f16 v68, v180, v58, v58 op_sel:[0,0,1] op_sel_hi:[1,0,1]
    v_pk_fma_f16 v69, v181, v58, v58 op_sel:[0,0,1] op_sel_hi:[1,0,1]
    v_pk_fma_f16 v70, v182, v58, v58 op_sel:[0,0,1] op_sel_hi:[1,0,1]
    v_pk_fma_f16 v71, v183, v58, v58 op_sel:[0,0,1] op_sel_hi:[1,0,1]
    ds_write_b128 v55, v[68:71] offset:1024
    v_pk_fma_f16 v72, v184, v58, v58 op_sel:[0,0,1] op_sel_hi:[1,0,1]
    v_pk_fma_f16 v73, v185, v58, v58 op_sel:[0,0,1] op_sel_hi:[1,0,1]
    v_pk_fma_f16 v74, v186, v58, v58 op_sel:[0,0,1] op_sel_hi:[1,0,1]
    v_pk_fma_f16 v75, v187, v58, v58 op_sel:[0,0,1] op_sel_hi:[1,0,1]
    ds_write_b128 v55, v[72:75] offset:2048
    v_pk_fma_f16 v76, v188, v58, v58 op_sel:[0,0,1] op_sel_hi:[1,0,1]
    v_pk_fma_f16 v77, v189, v58, v58 op_sel:[0,0,1] op_sel_hi:[1,0,1]
    v_pk_fma_f16 v78, v190, v58, v58 op_sel:[0,0,1] op_sel_hi:[1,0,1]
    v_pk_fma_f16 v79, v191, v58, v58 op_sel:[0,0,1] op_sel_hi:[1,0,1]
    ds_write_b128 v55, v[76:79] offset:3072
    s_waitcnt lgkmcnt(0)
    s_barrier
    s_load_dwordx8 s[28:35], s[66:67], 0
    global_load_dwordx4 v[8:11], v7, s[52:53]
    global_load_ushort v12, v13, s[52:53]
    v_mov_b32 v60, -1
    v_mov_b32 v61, -1
    v_mov_b32 v62, -1
    v_mul_u32_u24 v59, 12, v1
    v_mov_b32 v63, -1
    s_mul_i32 s20, s2, 3
    s_add_u32 s20, s20, s9
    s_mul_i32 s20, s20, 1152
    s_add_u32 s20, s20, 4193152
    v_add_u32 v57, s20, v7
    v_add_u32 v58, s20, v13
    s_cmp_eq_u32 s3, 4
    s_cbranch_scc1 LI1
    global_store_dwordx4 v57, v[60:63], s[68:69] sc1
    global_store_short v58, v60, s[68:69] sc1
LI1:
    s_mul_i32 s20, s6, 18432
    s_mul_i32 s21, s9, 4608
    s_add_u32 s20, s20, s21
    s_add_u32 s20, s20, 7342336
    v_add_u32 v58, s20, v59
    global_store_dwordx3 v58, v[60:62], s[68:69] offset:-2304 sc1
    global_store_dwordx3 v58, v[60:62], s[68:69] offset:-1536 sc1
    global_store_dwordx3 v58, v[60:62], s[68:69] offset:-768 sc1
    global_store_dwordx3 v58, v[60:62], s[68:69] sc1
    global_store_dwordx3 v58, v[60:62], s[68:69] offset:768 sc1
    global_store_dwordx3 v58, v[60:62], s[68:69] offset:1536 sc1
    s_waitcnt lgkmcnt(0)
    s_and_b64 s[28:29], s[28:29], s[30:31]
    s_and_b32 s28, s28, s32
    s_and_b32 s28, s28, s29
    s_cmp_lg_u32 s28, 0
    s_cbranch_scc1 GOK_7
    v_min_u32 v59, 4, v1
    v_lshlrev_b32 v59, 2, v59
    global_load_dword v58, v59, s[66:67] sc1
GO_8:
    s_waitcnt vmcnt(0)
    v_cmp_eq_u32 vcc, 0, v58
    s_cbranch_vccz GOD_9
    global_load_dword v58, v59, s[66:67] sc1
    s_sub_u32 s10, s10, 1
    s_cbranch_scc1 EXIT
    s_branch GO_8
GOD_9:
GOK_7:
    s_lshl_b32 s20, s9, 10
    s_add_u32 s20, s20, 90112
    v_add_u32 v80, s20, v7
    global_load_dwordx4 v[76:79], v80, s[68:69]
    v_and_b32 v52, 7, v1
    v_lshlrev_b32 v52, 3, v52
    v_lshrrev_b32 v53, 4, v1
    s_mul_i32 s20, s9, 294912
    s_lshl_b32 s21, s8, 6
    s_add_u32 s20, s20, s21
    s_add_u32 s20, s20, 2359296
    s_mov_b32 s21, 73728
    v_mad_u32_u24 v52, v53, s21, v52
    v_add_u32 v52, s20, v52
    v_and_b32 v54, 8, v1
    v_cmp_eq_u32 vcc, 0, v54
    v_mov_b32 v54, s56
    v_mov_b32 v55, s54
    v_cndmask_b32 v54, v54, v55, vcc
    v_mov_b32 v55, s57
    v_mov_b32 v56, s55
    v_cndmask_b32 v55, v55, v56, vcc
    v_add_co_u32 v54, vcc, v54, v52
    s_nop 1
    v_addc_co_u32 v55, vcc, 0, v55, vcc
    s_mov_b32 s20, 9216
    s_mov_b32 s21, 0
    s_mov_b32 s22, 1115136
    s_mov_b32 s23, 0
    global_load_dwordx2 v[160:161], v[54:55], off nt
    v_lshl_add_u64 v[54:55], v[54:55], 0, s[20:21]
    global_load_dwordx2 v[162:163], v[54:55], off nt
    v_lshl_add_u64 v[54:55], v[54:55], 0, s[20:21]
    global_load_dwordx2 v[164:165], v[54:55], off nt
    v_lshl_add_u64 v[54:55], v[54:55], 0, s[20:21]
    global_load_dwordx2 v[166:167], v[54:55], off nt
    v_lshl_add_u64 v[54:55], v[54:55], 0, s[20:21]
    global_load_dwordx2 v[168:169], v[54:55], off nt
    v_lshl_add_u64 v[54:55], v[54:55], 0, s[20:21]
    global_load_dwordx2 v[170:171], v[54:55], off nt
    v_lshl_add_u64 v[54:55], v[54:55], 0, s[20:21]
    global_load_dwordx2 v[172:173], v[54:55], off nt
    v_lshl_add_u64 v[54:55], v[54:55], 0, s[20:21]
    global_load_dwordx2 v[174:175], v[54:55], off nt
    v_lshl_add_u64 v[54:55], v[54:55], 0, s[22:23]
    global_load_dwordx2 v[176:177], v[54:55], off nt
    v_lshl_add_u64 v[54:55], v[54:55], 0, s[20:21]
    global_load_dwordx2 v[178:179], v[54:55], off nt
    v_lshl_add_u64 v[54:55], v[54:55], 0, s[20:21]
    global_load_dwordx2 v[180:181], v[54:55], off nt
    v_lshl_add_u64 v[54:55], v[54:55], 0, s[20:21]
    global_load_dwordx2 v[182:183], v[54:55], off nt
    v_lshl_add_u64 v[54:55], v[54:55], 0, s[20:21]
    global_load_dwordx2 v[184:185], v[54:55], off nt
    v_lshl_add_u64 v[54:55], v[54:55], 0, s[20:21]
    global_load_dwordx2 v[186:187], v[54:55], off nt
    v_lshl_add_u64 v[54:55], v[54:55], 0, s[20:21]
    global_load_dwordx2 v[188:189], v[54:55], off nt
    v_lshl_add_u64 v[54:55], v[54:55], 0, s[20:21]
    global_load_dwordx2 v[190:191], v[54:55], off nt
    v_lshl_add_u64 v[54:55], v[54:55], 0, s[22:23]
    s_cmp_ge_u32 s9, 2
    s_cbranch_scc1 W5_10
    global_load_dwordx2 v[192:193], v[54:55], off nt
    v_lshl_add_u64 v[54:55], v[54:55], 0, s[20:21]
    global_load_dwordx2 v[194:195], v[54:55], off nt
    v_lshl_add_u64 v[54:55], v[54:55], 0, s[20:21]
    global_load_dwordx2 v[196:197], v[54:55], off nt
    v_lshl_add_u64 v[54:55], v[54:55], 0, s[20:21]
    global_load_dwordx2 v[198:199], v[54:55], off nt
    v_lshl_add_u64 v[54:55], v[54:55], 0, s[20:21]
    global_load_dwordx2 v[200:201], v[54:55], off nt
    v_lshl_add_u64 v[54:55], v[54:55], 0, s[20:21]
    global_load_dwordx2 v[202:203], v[54:55], off nt
    v_lshl_add_u64 v[54:55], v[54:55], 0, s[20:21]
    global_load_dwordx2 v[204:205], v[54:55], off nt
    v_lshl_add_u64 v[54:55], v[54:55], 0, s[20:21]
    global_load_dwordx2 v[206:207], v[54:55], off nt
W5_10:
    s_waitcnt vmcnt(24)
    s_cmp_lt_u32 s9, 2
    s_cbranch_scc1 GIP
    s_waitcnt vmcnt(16)
GIP:
    v_cmp_ne_u32 vcc, s99, v76
    v_cmp_ne_u32 s[20:21], s99, v77
    v_cmp_ne_u32 s[22:23], s99, v78
    v_cmp_ne_u32 s[24:25], s99, v79
    s_or_b64 vcc, vcc, s[20:21]
    s_or_b64 s[22:23], s[22:23], s[24:25]
    s_or_b64 vcc, vcc, s[22:23]
    s_cbranch_vccz CONV_JOIN
    global_load_dwordx4 v[76:79], v80, s[68:69] sc1
    s_waitcnt vmcnt(0)
    s_sub_u32 s10, s10, 1
    s_cbranch_scc1 EXIT
    s_branch GIP
CONV_JOIN:
    v_and_b32 v56, 3, v0
    v_lshrrev_b32 v57, 2, v0
    s_mov_b32 s20, 31296
    v_mul_u32_u24 v58, s20, v56
    v_lshl_add_u32 v58, v57, 4, v58
    s_movk_i32 s20, 9216
    v_mul_u32_u24 v59, s20, v57
    v_lshl_add_u32 v59, v56, 4, v59
    s_lshl_b32 s20, s6, 6
    s_add_u32 s20, s20, 1048576
    v_add_u32 v59, s20, v59
    v_add_u32 v60, 1179648, v59
    s_waitcnt lgkmcnt(0)
    s_barrier
    ds_read_b128 v[64:67], v58
    ds_read_b128 v[68:71], v58 offset:2048
    s_waitcnt lgkmcnt(1)
    global_store_dwordx4 v59, v[64:67], s[68:69] sc1
    s_waitcnt lgkmcnt(0)
    global_store_dwordx4 v60, v[68:71], s[68:69] sc1
    v_add_u32 v52, 8192, v7
    v_add_u32 v53, 8192, v13
    v_add_u32 v54, 2304, v52
    v_add_u32 v55, 2304, v53
    global_load_dwordx4 v[106:109], v54, s[68:69]
    global_load_ushort v110, v55, s[68:69]
    v_add_u32 v54, 3456, v52
    v_add_u32 v55, 3456, v53
    global_load_dwordx4 v[20:23], v54, s[68:69]
    global_load_ushort v24, v55, s[68:69]
    v_add_u32 v54, 4608, v52
    v_add_u32 v55, 4608, v53
    global_load_dwordx4 v[14:17], v54, s[68:69]
    global_load_ushort v18, v55, s[68:69]
    v_add_u32 v54, 5760, v52
    v_add_u32 v55, 5760, v53
    global_load_dwordx4 v[26:29], v54, s[68:69]
    global_load_ushort v30, v55, s[68:69]
    s_waitcnt vmcnt(0)
MC_11:
    v_or_b32 v53, s12, v24
    v_or_b32 v54, s12, v18
    v_or_b32 v55, s12, v30
    v_or_b32 v56, s12, v110
    v_max3_u32 v52, v20, v21, v22
    v_max3_u32 v52, v52, v23, v14
    v_max3_u32 v52, v52, v15, v16
    v_max3_u32 v52, v52, v17, v26
    v_max3_u32 v52, v52, v27, v28
    v_max3_u32 v52, v52, v29, v106
    v_max3_u32 v52, v52, v107, v108
    v_max3_u32 v52, v52, v109, v53
    v_max3_u32 v52, v52, v54, v55
    v_max_u32 v52, v52, v56
    v_cmp_eq_u32 vcc, -1, v52
    s_cbranch_vccz MCD_12
    v_add_u32 v52, 8192, v7
    v_add_u32 v53, 8192, v13
    v_add_u32 v54, 2304, v52
    v_add_u32 v55, 2304, v53
    global_load_dwordx4 v[106:109], v54, s[68:69] sc1
    global_load_ushort v110, v55, s[68:69] sc1
    v_add_u32 v54, 3456, v52
    v_add_u32 v55, 3456, v53
    global_load_dwordx4 v[20:23], v54, s[68:69] sc1
    global_load_ushort v24, v55, s[68:69] sc1
    v_add_u32 v54, 4608, v52
    v_add_u32 v55, 4608, v53
    global_load_dwordx4 v[14:17], v54, s[68:69] sc1
    global_load_ushort v18, v55, s[68:69] sc1
    v_add_u32 v54, 5760, v52
    v_add_u32 v55, 5760, v53
    global_load_dwordx4 v[26:29], v54, s[68:69] sc1
    global_load_ushort v30, v55, s[68:69] sc1
    s_waitcnt vmcnt(0)
    s_sub_u32 s10, s10, 1
    s_cbranch_scc1 EXIT
    s_branch MC_11
MCD_12:
    v_lshlrev_b32 v32, 16, v14
    v_and_b32 v33, s12, v14
    v_lshlrev_b32 v34, 16, v15
    v_and_b32 v35, s12, v15
    v_lshlrev_b32 v36, 16, v16
    v_and_b32 v37, s12, v16
    v_lshlrev_b32 v38, 16, v17
    v_and_b32 v39, s12, v17
    v_lshlrev_b32 v40, 16, v18
    v_lshlrev_b32 v42, 16, v20
    v_and_b32 v43, s12, v20
    v_lshlrev_b32 v44, 16, v21
    v_and_b32 v45, s12, v21
    v_lshlrev_b32 v46, 16, v22
    v_and_b32 v47, s12, v22
    v_lshlrev_b32 v48, 16, v23
    v_and_b32 v49, s12, v23
    v_lshlrev_b32 v50, 16, v24
    v_pk_add_f32 v[32:33], v[32:33], 1.0 op_sel_hi:[1,0]
    v_pk_add_f32 v[34:35], v[34:35], 1.0 op_sel_hi:[1,0]
    v_pk_add_f32 v[36:37], v[36:37], 1.0 op_sel_hi:[1,0]
    v_pk_add_f32 v[38:39], v[38:39], 1.0 op_sel_hi:[1,0]
    v_add_f32 v40, 1.0, v40
    v_cvt_pk_bf16_f32 v52, v32, v33
    v_cvt_pk_bf16_f32 v53, v34, v35
    v_cvt_pk_bf16_f32 v54, v36, v37
    v_cvt_pk_bf16_f32 v55, v38, v39
    v_cvt_pk_bf16_f32 v56, v40, v40
    v_lshlrev_b32 v32, 16, v52
    v_and_b32 v33, s12, v52
    v_lshlrev_b32 v34, 16, v53
    v_and_b32 v35, s12, v53
    v_lshlrev_b32 v36, 16, v54
    v_and_b32 v37, s12, v54
    v_lshlrev_b32 v38, 16, v55
    v_and_b32 v39, s12, v55
    v_lshlrev_b32 v40, 16, v56
    s_branch GPOLL
NONCONV:
    s_cmp_lt_u32 s3, 4
    s_cbranch_scc1 NC_A0
    v_mov_b32 v60, -1
    v_mov_b32 v61, -1
    v_mov_b32 v62, -1
    v_mov_b32 v63, -1
    s_waitcnt lgkmcnt(0)
    s_lshl_b32 s20, s2, 2
    s_add_u32 s20, s20, s9
    s_mul_i32 s20, s20, 2304
    v_add_u32 v58, s20, v7
    v_add_u32 v59, s20, v13
    global_load_dwordx4 v[64:67], v58, s[36:37] nt
    global_load_ushort v68, v59, s[36:37] nt
    global_load_dwordx4 v[70:73], v58, s[36:37] offset:1152 nt
    global_load_ushort v74, v59, s[36:37] offset:1152 nt
    s_cmp_lg_u32 s3, 7
    s_cbranch_scc1 NC_B0
    s_mul_i32 s20, s2, 9216
    s_add_u32 s20, s20, 1052672
    v_add_u32 v57, s20, v7
    v_add_u32 v56, 4096, v57
    global_store_dwordx4 v57, v[60:63], s[68:69] offset:-4096 sc1
    global_store_dwordx4 v57, v[60:63], s[68:69] offset:-3072 sc1
    global_store_dwordx4 v57, v[60:63], s[68:69] offset:-2048 sc1
    global_store_dwordx4 v57, v[60:63], s[68:69] offset:-1024 sc1
    global_store_dwordx4 v57, v[60:63], s[68:69] sc1
    global_store_dwordx4 v57, v[60:63], s[68:69] offset:1024 sc1
    global_store_dwordx4 v57, v[60:63], s[68:69] offset:2048 sc1
    global_store_dwordx4 v57, v[60:63], s[68:69] offset:3072 sc1
    global_store_dwordx4 v56, v[60:63], s[68:69] sc1
NC_B0:
    s_barrier
    s_load_dword s99, s[68:69], 94208
    s_cmp_eq_u32 s3, 7
    s_cbranch_scc1 NC_B1
    s_waitcnt vmcnt(0)
NC_B1:
    s_waitcnt vmcnt(9)
    s_mul_i32 s18, s9, 2304
    s_add_u32 s18, s18, 145024
    v_add_u32 v58, s18, v7
    v_add_u32 v59, s18, v13
    ds_write_b128 v58, v[64:67]
    ds_write_b16 v59, v68
    ds_write_b128 v58, v[70:73] offset:1152
    ds_write_b16 v59, v74 offset:1152
    v_lshlrev_b32 v80, 16, v64
    v_and_b32 v81, s12, v64
    v_lshlrev_b32 v82, 16, v65
    v_and_b32 v83, s12, v65
    v_lshlrev_b32 v84, 16, v66
    v_and_b32 v85, s12, v66
    v_lshlrev_b32 v86, 16, v67
    v_and_b32 v87, s12, v67
    v_lshlrev_b32 v88, 16, v68
    v_lshlrev_b32 v90, 16, v70
    v_and_b32 v91, s12, v70
    v_lshlrev_b32 v92, 16, v71
    v_and_b32 v93, s12, v71
    v_lshlrev_b32 v94, 16, v72
    v_and_b32 v95, s12, v72
    v_lshlrev_b32 v96, 16, v73
    v_and_b32 v97, s12, v73
    v_lshlrev_b32 v98, 16, v74
    v_readfirstlane_b32 s70, v80
    s_nop 1
    v_subrev_f32 v80, s70, v80
    v_subrev_f32 v81, s70, v81
    v_subrev_f32 v82, s70, v82
    v_subrev_f32 v83, s70, v83
    v_subrev_f32 v84, s70, v84
    v_subrev_f32 v85, s70, v85
    v_subrev_f32 v86, s70, v86
    v_subrev_f32 v87, s70, v87
    v_subrev_f32 v88, s70, v88
    v_pk_add_f32 v[100:101], v[80:81], v[82:83]
    v_pk_mul_f32 v[102:103], v[80:81], v[80:81]
    v_pk_add_f32 v[100:101], v[100:101], v[84:85]
    v_pk_fma_f32 v[102:103], v[82:83], v[82:83], v[102:103]
    v_pk_add_f32 v[100:101], v[100:101], v[86:87]
    v_pk_fma_f32 v[102:103], v[84:85], v[84:85], v[102:103]
    v_add_f32 v100, v100, v88
    v_pk_fma_f32 v[102:103], v[86:87], v[86:87], v[102:103]
    v_add_f32 v100, v100, v101
    v_fmac_f32 v102, v88, v88
    v_add_f32 v102, v102, v103
    v_readfirstlane_b32 s71, v90
    s_nop 1
    v_subrev_f32 v90, s71, v90
    v_subrev_f32 v91, s71, v91
    v_subrev_f32 v92, s71, v92
    v_subrev_f32 v93, s71, v93
    v_subrev_f32 v94, s71, v94
    v_subrev_f32 v95, s71, v95
    v_subrev_f32 v96, s71, v96
    v_subrev_f32 v97, s71, v97
    v_subrev_f32 v98, s71, v98
    v_pk_add_f32 v[104:105], v[90:91], v[92:93]
    v_pk_mul_f32 v[106:107], v[90:91], v[90:91]
    v_pk_add_f32 v[104:105], v[104:105], v[94:95]
    v_pk_fma_f32 v[106:107], v[92:93], v[92:93], v[106:107]
    v_pk_add_f32 v[104:105], v[104:105], v[96:97]
    v_pk_fma_f32 v[106:107], v[94:95], v[94:95], v[106:107]
    v_add_f32 v104, v104, v98
    v_pk_fma_f32 v[106:107], v[96:97], v[96:97], v[106:107]
    v_add_f32 v104, v104, v105
    v_fmac_f32 v106, v98, v98
    v_add_f32 v106, v106, v107
    v_permlane32_swap_b32 v100, v104
    s_nop 0
    v_permlane32_swap_b32 v102, v106
    v_add_f32 v100, v100, v104
    v_add_f32 v102, v102, v106
    s_nop 1
    v_permlane16_swap_b32 v100, v102
    v_add_f32 v100, v100, v102
    s_nop 1
    v_add_f32_dpp v100, v100, v100 row_ror:8 row_mask:0xf bank_mask:0xf
    s_nop 1
    v_add_f32_dpp v100, v100, v100 row_ror:4 row_mask:0xf bank_mask:0xf
    s_nop 1
    v_add_f32_dpp v100, v100, v100 row_ror:2 row_mask:0xf bank_mask:0xf
    s_nop 1
    v_add_f32_dpp v100, v100, v100 row_ror:1 row_mask:0xf bank_mask:0xf
    v_mov_b32 v102, v100
    s_nop 1
    v_permlane16_swap_b32 v100, v102
    v_mov_b32 v104, s70
    v_mov_b32 v105, s71
    v_cmp_gt_u32 vcc, 32, v1
    s_nop 1
    v_cndmask_b32 v104, v105, v104, vcc
    v_mul_f32 v100, 0x3ae38e39, v100
    v_mul_f32 v102, 0x3ae38e39, v102
    v_add_f32 v105, v104, v100
    v_fma_f32 v107, -v100, v100, v102
    v_max_f32 v107, 0, v107
    v_cvt_pk_bf16_f32 v107, v107, v107
    v_and_b32 v107, s12, v107
    v_add_f32 v107, 0x3727c5ac, v107
    v_cvt_pk_bf16_f32 v107, v107, v107
    v_and_b32 v107, s12, v107
    v_sqrt_f32 v106, v107
    v_cvt_pk_bf16_f32 v105, v105, v105
    v_and_b32 v105, s12, v105
    v_cvt_pk_bf16_f32 v106, v106, v106
    v_and_b32 v106, s12, v106
    v_rcp_f32 v100, v106
    v_sub_f32 v101, v104, v105
    v_mul_f32 v101, v101, v100
    v_mov_b32 v102, v100
    v_mov_b32 v103, v101
    s_nop 0
    v_permlane32_swap_b32 v100, v102
    v_permlane32_swap_b32 v101, v103
    s_mul_i32 s18, s9, 2304
    s_add_u32 s18, s18, 154240
    v_lshl_add_u32 v58, v1, 5, s18
    v_lshl_add_u32 v59, v1, 2, s18
    v_pk_fma_f32 v[80:81], v[80:81], v[100:101], v[100:101] op_sel:[0,0,1] op_sel_hi:[1,0,1]
    v_pk_fma_f32 v[82:83], v[82:83], v[100:101], v[100:101] op_sel:[0,0,1] op_sel_hi:[1,0,1]
    v_pk_fma_f32 v[84:85], v[84:85], v[100:101], v[100:101] op_sel:[0,0,1] op_sel_hi:[1,0,1]
    v_pk_fma_f32 v[86:87], v[86:87], v[100:101], v[100:101] op_sel:[0,0,1] op_sel_hi:[1,0,1]
    v_fma_f32 v88, v88, v100, v101
    v_pk_fma_f32 v[90:91], v[90:91], v[102:103], v[102:103] op_sel:[0,0,1] op_sel_hi:[1,0,1]
    v_pk_fma_f32 v[92:93], v[92:93], v[102:103], v[102:103] op_sel:[0,0,1] op_sel_hi:[1,0,1]
    v_pk_fma_f32 v[94:95], v[94:95], v[102:103], v[102:103] op_sel:[0,0,1] op_sel_hi:[1,0,1]
    v_pk_fma_f32 v[96:97], v[96:97], v[102:103], v[102:103] op_sel:[0,0,1] op_sel_hi:[1,0,1]
    v_fma_f32 v98, v98, v102, v103
    v_cvt_pkrtz_f16_f32 v64, v80, v90
    v_cvt_pkrtz_f16_f32 v65, v81, v91
    v_cvt_pkrtz_f16_f32 v66, v82, v92
    v_cvt_pkrtz_f16_f32 v67, v83, v93
    v_cvt_pkrtz_f16_f32 v68, v84, v94
    v_cvt_pkrtz_f16_f32 v69, v85, v95
    v_cvt_pkrtz_f16_f32 v70, v86, v96
    v_cvt_pkrtz_f16_f32 v71, v87, v97
    v_cvt_pkrtz_f16_f32 v72, v88, v98
    v_add_u32 v64, 0x00040004, v64
    v_add_u32 v65, 0x00040004, v65
    v_add_u32 v66, 0x00040004, v66
    v_add_u32 v67, 0x00040004, v67
    v_add_u32 v68, 0x00040004, v68
    v_add_u32 v69, 0x00040004, v69
    v_add_u32 v70, 0x00040004, v70
    v_add_u32 v71, 0x00040004, v71
    v_add_u32 v72, 0x00040004, v72
    ds_write_b128 v58, v[64:67]
    ds_write_b128 v58, v[68:71] offset:16
    ds_write_b32 v59, v72 offset:2048
    s_lshl_b32 s14, s9, 2
    s_add_u32 s14, s14, 143584
    v_mov_b32 v58, s14
    v_mov_b32 v59, 0
    v_and_b32 v104, 3, v1
    v_lshlrev_b32 v100, 4, v104
    v_lshlrev_b32 v104, 2, v104
    v_add_u32 v104, 143584, v104
    v_and_b32 v52, 255, v0
    v_lshrrev_b32 v101, 2, v52
    v_lshl_add_u32 v101, v101, 14, v100
    s_lshl_b32 s14, s2, 6
    s_add_u32 s14, s14, 10485760
    v_add_u32 v101, s14, v101
    v_add_u32 v102, 1048576, v101
    v_and_b32 v103, 15, v1
    v_lshl_add_u32 v103, s9, 4, v103
    v_lshrrev_b32 v99, 2, v103
    v_lshl_add_u32 v99, v99, 14, v100
    v_add_u32 v99, s14, v99
    v_add_u32 v99, 2097152, v99
    v_lshlrev_b32 v103, 2, v103
    v_add_u32 v103, 156288, v103
    v_lshlrev_b32 v100, 2, v52
    v_add_u32 v100, 154240, v100
IFD_16:
    ds_write_b32 v58, v59
    s_waitcnt lgkmcnt(0)
    s_add_u32 s99, s99, 1
    s_mov_b32 s98, 458759
    s_lshr_b32 s20, s99, 0
    s_and_b32 s20, s20, s98
    v_mov_b32 v108, s20
    s_lshr_b32 s20, s99, 3
    s_and_b32 s20, s20, s98
    v_mov_b32 v109, s20
    s_lshr_b32 s20, s99, 6
    s_and_b32 s20, s20, s98
    v_mov_b32 v110, s20
    s_lshr_b32 s20, s99, 9
    s_and_b32 s20, s20, s98
    v_mov_b32 v111, s20
SL_13:
    ds_read_b32 v105, v104
    s_waitcnt lgkmcnt(0)
    v_cmp_eq_u32 vcc, -1, v105
    s_cbranch_vccz SLD_14
    s_sub_u32 s10, s10, 1
    s_cbranch_scc1 EXIT
    s_branch SL_13
SLD_14:
    ds_read_b32 v80, v100 offset:0
    ds_read_b32 v81, v100 offset:2304
    ds_read_b32 v82, v100 offset:4608
    ds_read_b32 v83, v100 offset:6912
    ds_read_b32 v84, v100 offset:1024
    ds_read_b32 v85, v100 offset:3328
    ds_read_b32 v86, v100 offset:5632
    ds_read_b32 v87, v100 offset:7936
    ds_read_b32 v88, v103 offset:0
    ds_read_b32 v89, v103 offset:2304
    ds_read_b32 v90, v103 offset:4608
    ds_read_b32 v91, v103 offset:6912
    s_waitcnt lgkmcnt(8)
    v_bfi_b32 v80, s98, v108, v80
    v_bfi_b32 v81, s98, v109, v81
    v_bfi_b32 v82, s98, v110, v82
    v_bfi_b32 v83, s98, v111, v83
    global_store_dwordx4 v101, v[80:83], s[68:69] sc1
    s_waitcnt lgkmcnt(4)
    v_bfi_b32 v84, s98, v108, v84
    v_bfi_b32 v85, s98, v109, v85
    v_bfi_b32 v86, s98, v110, v86
    v_bfi_b32 v87, s98, v111, v87
    global_store_dwordx4 v102, v[84:87], s[68:69] sc1
    s_waitcnt lgkmcnt(0)
    v_bfi_b32 v88, s98, v108, v88
    v_bfi_b32 v89, s98, v109, v89
    v_bfi_b32 v90, s98, v110, v90
    v_bfi_b32 v91, s98, v111, v91
    s_mov_b64 exec, 0xffff
    global_store_dwordx4 v99, v[88:91], s[68:69] sc1
    s_mov_b64 exec, -1
    s_cmp_lg_u32 s3, 7
    s_cbranch_scc1 GIF_17
    s_lshl_b32 s20, s2, 4
    s_add_u32 s20, s20, 90112
    v_mov_b32 v92, s20
    v_mov_b32 v76, s99
    v_mov_b32 v77, s99
    v_mov_b32 v78, s99
    v_mov_b32 v79, s99
    s_mov_b64 exec, 1
    s_waitcnt vmcnt(3)
    global_store_dwordx4 v92, v[76:79], s[68:69] sc1
    s_mov_b64 exec, -1
GIF_17:
    s_barrier
    global_load_dwordx4 v[8:11], v7, s[52:53]
    global_load_ushort v12, v13, s[52:53]
    v_mov_b32 v60, -1
    v_mov_b32 v61, -1
    v_mov_b32 v62, -1
    v_mul_u32_u24 v59, 12, v1
    v_mov_b32 v63, -1
    s_mul_i32 s20, s2, 3
    s_add_u32 s20, s20, s9
    s_mul_i32 s20, s20, 1152
    s_add_u32 s20, s20, 4193152
    v_add_u32 v57, s20, v7
    v_add_u32 v58, s20, v13
    s_cmp_eq_u32 s3, 4
    s_cbranch_scc1 LI0
    global_store_dwordx4 v57, v[60:63], s[68:69] sc1
    global_store_short v58, v60, s[68:69] sc1
LI0:
    s_branch NC_A2
NC_A0:
    s_cmp_lt_u32 s7, 108
    s_cbranch_scc1 NC_MOD1
    s_waitcnt lgkmcnt(0)
    s_barrier
    s_barrier
    s_branch NC_A1
NC_MOD1:
    v_lshrrev_b32 v52, 2, v1
    s_mul_i32 s20, s3, 144
    v_add_u32 v52, s20, v52
    v_lshlrev_b32 v53, 1, v52
    s_movk_i32 s20, 6912
    v_mul_u32_u24 v52, s20, v52
    v_and_b32 v54, 3, v1
    s_lshl_b32 s21, s7, 6
    v_lshl_add_u32 v54, v54, 4, s21
    v_add_u32 v52, v52, v54
    s_waitcnt lgkmcnt(0)
    global_load_ushort v148, v53, s[60:61]
    global_load_ushort v149, v53, s[60:61] offset:32
    global_load_ushort v150, v53, s[60:61] offset:64
    global_load_ushort v151, v53, s[60:61] offset:96
    global_load_ushort v152, v53, s[60:61] offset:128
    global_load_ushort v153, v53, s[60:61] offset:160
    global_load_ushort v154, v53, s[60:61] offset:192
    global_load_ushort v155, v53, s[60:61] offset:224
    global_load_ushort v156, v53, s[60:61] offset:256
    s_barrier
    s_load_dword s99, s[68:69], 94208
    s_cmp_lt_u32 s7, 36
    s_cbranch_scc1 NC_CR
    s_barrier
NC_CR:
    global_load_dwordx4 v[112:115], v52, s[62:63] nt
    v_add_u32 v52, 110592, v52
    global_load_dwordx4 v[116:119], v52, s[62:63] nt
    v_add_u32 v52, 110592, v52
    global_load_dwordx4 v[120:123], v52, s[62:63] nt
    v_add_u32 v52, 110592, v52
    global_load_dwordx4 v[124:127], v52, s[62:63] nt
    v_add_u32 v52, 110592, v52
    global_load_dwordx4 v[128:131], v52, s[62:63] nt
    v_add_u32 v52, 110592, v52
    global_load_dwordx4 v[132:135], v52, s[62:63] nt
    v_add_u32 v52, 110592, v52
    global_load_dwordx4 v[136:139], v52, s[62:63] nt
    v_add_u32 v52, 110592, v52
    global_load_dwordx4 v[140:143], v52, s[62:63] nt
    v_add_u32 v52, 110592, v52
    global_load_dwordx4 v[144:147], v52, s[62:63] nt
    s_waitcnt vmcnt(9)
    v_lshlrev_b32 v148, 16, v148
    v_mul_f32 v64, 0xbfb8aa3b, v148
    v_exp_f32 v64, v64
    v_lshlrev_b32 v149, 16, v149
    v_mul_f32 v65, 0xbfb8aa3b, v149
    v_exp_f32 v65, v65
    v_lshlrev_b32 v150, 16, v150
    v_mul_f32 v66, 0xbfb8aa3b, v150
    v_exp_f32 v66, v66
    v_lshlrev_b32 v151, 16, v151
    v_mul_f32 v67, 0xbfb8aa3b, v151
    v_exp_f32 v67, v67
    v_lshlrev_b32 v152, 16, v152
    v_mul_f32 v68, 0xbfb8aa3b, v152
    v_exp_f32 v68, v68
    v_lshlrev_b32 v153, 16, v153
    v_mul_f32 v69, 0xbfb8aa3b, v153
    v_exp_f32 v69, v69
    v_lshlrev_b32 v154, 16, v154
    v_mul_f32 v70, 0xbfb8aa3b, v154
    v_exp_f32 v70, v70
    v_lshlrev_b32 v155, 16, v155
    v_mul_f32 v71, 0xbfb8aa3b, v155
    v_exp_f32 v71, v71
    v_lshlrev_b32 v156, 16, v156
    v_mul_f32 v72, 0xbfb8aa3b, v156
    v_exp_f32 v72, v72
    v_add_f32 v64, 1.0, v64
    v_rcp_f32 v64, v64
    v_add_f32 v65, 1.0, v65
    v_rcp_f32 v65, v65
    v_add_f32 v66, 1.0, v66
    v_rcp_f32 v66, v66
    v_add_f32 v67, 1.0, v67
    v_rcp_f32 v67, v67
    v_add_f32 v68, 1.0, v68
    v_rcp_f32 v68, v68
    v_add_f32 v69, 1.0, v69
    v_rcp_f32 v69, v69
    v_add_f32 v70, 1.0, v70
    v_rcp_f32 v70, v70
    v_add_f32 v71, 1.0, v71
    v_rcp_f32 v71, v71
    v_add_f32 v72, 1.0, v72
    v_rcp_f32 v72, v72
    v_mul_f32 v64, v148, v64
    v_mul_f32 v65, v149, v65
    v_mul_f32 v66, v150, v66
    v_mul_f32 v67, v151, v67
    v_mul_f32 v68, v152, v68
    v_mul_f32 v69, v153, v69
    v_mul_f32 v70, v154, v70
    v_mul_f32 v71, v155, v71
    v_mul_f32 v72, v156, v72
    v_cvt_pk_bf16_f32 v80, v64, v64
    v_and_b32 v80, s12, v80
    v_cvt_pk_bf16_f32 v82, v65, v65
    v_and_b32 v82, s12, v82
    v_cvt_pk_bf16_f32 v84, v66, v66
    v_and_b32 v84, s12, v84
    v_cvt_pk_bf16_f32 v86, v67, v67
    v_and_b32 v86, s12, v86
    v_cvt_pk_bf16_f32 v88, v68, v68
    v_and_b32 v88, s12, v88
    v_cvt_pk_bf16_f32 v90, v69, v69
    v_and_b32 v90, s12, v90
    v_cvt_pk_bf16_f32 v92, v70, v70
    v_and_b32 v92, s12, v92
    v_cvt_pk_bf16_f32 v94, v71, v71
    v_and_b32 v94, s12, v94
    v_cvt_pk_bf16_f32 v96, v72, v72
    v_and_b32 v96, s12, v96
    s_waitcnt vmcnt(8)
    v_lshlrev_b32 v64, 16, v112
    v_and_b32 v65, s12, v112
    v_lshlrev_b32 v66, 16, v113
    v_and_b32 v67, s12, v113
    v_lshlrev_b32 v68, 16, v114
    v_and_b32 v69, s12, v114
    v_lshlrev_b32 v70, 16, v115
    v_and_b32 v71, s12, v115
    v_pk_mul_f32 v[160:161], v[64:65], v[80:81] op_sel_hi:[1,0]
    v_pk_mul_f32 v[162:163], v[66:67], v[80:81] op_sel_hi:[1,0]
    v_pk_mul_f32 v[164:165], v[68:69], v[80:81] op_sel_hi:[1,0]
    v_pk_mul_f32 v[166:167], v[70:71], v[80:81] op_sel_hi:[1,0]
    s_waitcnt vmcnt(7)
    v_lshlrev_b32 v64, 16, v116
    v_and_b32 v65, s12, v116
    v_lshlrev_b32 v66, 16, v117
    v_and_b32 v67, s12, v117
    v_lshlrev_b32 v68, 16, v118
    v_and_b32 v69, s12, v118
    v_lshlrev_b32 v70, 16, v119
    v_and_b32 v71, s12, v119
    v_pk_fma_f32 v[160:161], v[64:65], v[82:83], v[160:161] op_sel_hi:[1,0,1]
    v_pk_fma_f32 v[162:163], v[66:67], v[82:83], v[162:163] op_sel_hi:[1,0,1]
    v_pk_fma_f32 v[164:165], v[68:69], v[82:83], v[164:165] op_sel_hi:[1,0,1]
    v_pk_fma_f32 v[166:167], v[70:71], v[82:83], v[166:167] op_sel_hi:[1,0,1]
    s_waitcnt vmcnt(6)
    v_lshlrev_b32 v64, 16, v120
    v_and_b32 v65, s12, v120
    v_lshlrev_b32 v66, 16, v121
    v_and_b32 v67, s12, v121
    v_lshlrev_b32 v68, 16, v122
    v_and_b32 v69, s12, v122
    v_lshlrev_b32 v70, 16, v123
    v_and_b32 v71, s12, v123
    v_pk_fma_f32 v[160:161], v[64:65], v[84:85], v[160:161] op_sel_hi:[1,0,1]
    v_pk_fma_f32 v[162:163], v[66:67], v[84:85], v[162:163] op_sel_hi:[1,0,1]
    v_pk_fma_f32 v[164:165], v[68:69], v[84:85], v[164:165] op_sel_hi:[1,0,1]
    v_pk_fma_f32 v[166:167], v[70:71], v[84:85], v[166:167] op_sel_hi:[1,0,1]
    s_waitcnt vmcnt(5)
    v_lshlrev_b32 v64, 16, v124
    v_and_b32 v65, s12, v124
    v_lshlrev_b32 v66, 16, v125
    v_and_b32 v67, s12, v125
    v_lshlrev_b32 v68, 16, v126
    v_and_b32 v69, s12, v126
    v_lshlrev_b32 v70, 16, v127
    v_and_b32 v71, s12, v127
    v_pk_fma_f32 v[160:161], v[64:65], v[86:87], v[160:161] op_sel_hi:[1,0,1]
    v_pk_fma_f32 v[162:163], v[66:67], v[86:87], v[162:163] op_sel_hi:[1,0,1]
    v_pk_fma_f32 v[164:165], v[68:69], v[86:87], v[164:165] op_sel_hi:[1,0,1]
    v_pk_fma_f32 v[166:167], v[70:71], v[86:87], v[166:167] op_sel_hi:[1,0,1]
    s_waitcnt vmcnt(4)
    v_lshlrev_b32 v64, 16, v128
    v_and_b32 v65, s12, v128
    v_lshlrev_b32 v66, 16, v129
    v_and_b32 v67, s12, v129
    v_lshlrev_b32 v68, 16, v130
    v_and_b32 v69, s12, v130
    v_lshlrev_b32 v70, 16, v131
    v_and_b32 v71, s12, v131
    v_pk_fma_f32 v[160:161], v[64:65], v[88:89], v[160:161] op_sel_hi:[1,0,1]
    v_pk_fma_f32 v[162:163], v[66:67], v[88:89], v[162:163] op_sel_hi:[1,0,1]
    v_pk_fma_f32 v[164:165], v[68:69], v[88:89], v[164:165] op_sel_hi:[1,0,1]
    v_pk_fma_f32 v[166:167], v[70:71], v[88:89], v[166:167] op_sel_hi:[1,0,1]
    v_min_u32 v75, 4, v1
    v_lshlrev_b32 v75, 2, v75
    s_cmp_eq_u32 s3, 0
    s_cselect_b64 exec, -1, 0
    global_load_dword v74, v75, s[66:67] sc1
    s_mov_b64 exec, -1
    s_waitcnt vmcnt(4)
    v_lshlrev_b32 v64, 16, v132
    v_and_b32 v65, s12, v132
    v_lshlrev_b32 v66, 16, v133
    v_and_b32 v67, s12, v133
    v_lshlrev_b32 v68, 16, v134
    v_and_b32 v69, s12, v134
    v_lshlrev_b32 v70, 16, v135
    v_and_b32 v71, s12, v135
    v_pk_fma_f32 v[160:161], v[64:65], v[90:91], v[160:161] op_sel_hi:[1,0,1]
    v_pk_fma_f32 v[162:163], v[66:67], v[90:91], v[162:163] op_sel_hi:[1,0,1]
    v_pk_fma_f32 v[164:165], v[68:69], v[90:91], v[164:165] op_sel_hi:[1,0,1]
    v_pk_fma_f32 v[166:167], v[70:71], v[90:91], v[166:167] op_sel_hi:[1,0,1]
    s_waitcnt vmcnt(3)
    v_lshlrev_b32 v64, 16, v136
    v_and_b32 v65, s12, v136
    v_lshlrev_b32 v66, 16, v137
    v_and_b32 v67, s12, v137
    v_lshlrev_b32 v68, 16, v138
    v_and_b32 v69, s12, v138
    v_lshlrev_b32 v70, 16, v139
    v_and_b32 v71, s12, v139
    v_pk_fma_f32 v[160:161], v[64:65], v[92:93], v[160:161] op_sel_hi:[1,0,1]
    v_pk_fma_f32 v[162:163], v[66:67], v[92:93], v[162:163] op_sel_hi:[1,0,1]
    v_pk_fma_f32 v[164:165], v[68:69], v[92:93], v[164:165] op_sel_hi:[1,0,1]
    v_pk_fma_f32 v[166:167], v[70:71], v[92:93], v[166:167] op_sel_hi:[1,0,1]
    s_waitcnt vmcnt(2)
    v_lshlrev_b32 v64, 16, v140
    v_and_b32 v65, s12, v140
    v_lshlrev_b32 v66, 16, v141
    v_and_b32 v67, s12, v141
    v_lshlrev_b32 v68, 16, v142
    v_and_b32 v69, s12, v142
    v_lshlrev_b32 v70, 16, v143
    v_and_b32 v71, s12, v143
    v_pk_fma_f32 v[160:161], v[64:65], v[94:95], v[160:161] op_sel_hi:[1,0,1]
    v_pk_fma_f32 v[162:163], v[66:67], v[94:95], v[162:163] op_sel_hi:[1,0,1]
    v_pk_fma_f32 v[164:165], v[68:69], v[94:95], v[164:165] op_sel_hi:[1,0,1]
    v_pk_fma_f32 v[166:167], v[70:71], v[94:95], v[166:167] op_sel_hi:[1,0,1]
    s_waitcnt vmcnt(1)
    v_lshlrev_b32 v64, 16, v144
    v_and_b32 v65, s12, v144
    v_lshlrev_b32 v66, 16, v145
    v_and_b32 v67, s12, v145
    v_lshlrev_b32 v68, 16, v146
    v_and_b32 v69, s12, v146
    v_lshlrev_b32 v70, 16, v147
    v_and_b32 v71, s12, v147
    v_pk_fma_f32 v[160:161], v[64:65], v[96:97], v[160:161] op_sel_hi:[1,0,1]
    v_pk_fma_f32 v[162:163], v[66:67], v[96:97], v[162:163] op_sel_hi:[1,0,1]
    v_pk_fma_f32 v[164:165], v[68:69], v[96:97], v[164:165] op_sel_hi:[1,0,1]
    v_pk_fma_f32 v[166:167], v[70:71], v[96:97], v[166:167] op_sel_hi:[1,0,1]
    s_nop 0
    v_permlane32_swap_b32 v160, v164
    v_permlane32_swap_b32 v161, v165
    v_permlane32_swap_b32 v162, v166
    v_permlane32_swap_b32 v163, v167
    v_pk_add_f32 v[160:161], v[160:161], v[164:165]
    v_pk_add_f32 v[162:163], v[162:163], v[166:167]
    s_nop 1
    v_permlane16_swap_b32 v160, v162
    v_permlane16_swap_b32 v161, v163
    v_pk_add_f32 v[160:161], v[160:161], v[162:163]
    s_nop 1
    v_add_f32_dpp v160, v160, v160 row_ror:4 row_mask:0xf bank_mask:0xf
    v_add_f32_dpp v161, v161, v161 row_ror:4 row_mask:0xf bank_mask:0xf
    s_nop 0
    v_add_f32_dpp v160, v160, v160 row_ror:8 row_mask:0xf bank_mask:0xf
    v_add_f32_dpp v161, v161, v161 row_ror:8 row_mask:0xf bank_mask:0xf
    v_and_b32 v64, 3, v1
    v_lshlrev_b32 v64, 5, v64
    v_lshrrev_b32 v65, 4, v1
    v_lshl_add_u32 v64, v65, 3, v64
    s_lshl_b32 s18, s3, 7
    s_add_u32 s18, s18, 144000
    v_add_u32 v64, s18, v64
    s_lshl_b32 s18, s3, 2
    s_add_u32 s18, s18, 143568
    v_mov_b32 v66, s18
    v_mov_b32 v67, 0
    s_mov_b32 exec_lo, 0x000f000f
    s_mov_b32 exec_hi, 0x000f000f
    ds_write_b64 v64, v[160:161]
    ds_write_b32 v66, v67
    s_mov_b64 exec, -1
    s_cmp_lg_u32 s3, 0
    s_cbranch_scc1 NC_A1
    v_and_b32 v64, 15, v1
    v_lshlrev_b32 v65, 3, v64
    v_add_u32 v65, 144000, v65
    v_and_b32 v66, 3, v1
    v_lshlrev_b32 v66, 2, v66
    v_add_u32 v66, 143568, v66
    s_lshl_b32 s18, s7, 6
    s_add_u32 s18, s18, 8192
    v_lshl_add_u32 v64, v64, 2, s18
MRP:
    ds_read_b32 v67, v66
    ds_read_b64 v[80:81], v65 offset:0
    ds_read_b64 v[82:83], v65 offset:128
    ds_read_b64 v[84:85], v65 offset:256
    ds_read_b64 v[86:87], v65 offset:384
    s_waitcnt lgkmcnt(0)
    v_cmp_eq_u32 vcc, -1, v67
    s_cbranch_vccz MRD
    s_sub_u32 s10, s10, 1
    s_cbranch_scc1 EXIT
    s_branch MRP
MRD:
    v_pk_add_f32 v[80:81], v[80:81], v[84:85]
    v_pk_add_f32 v[82:83], v[82:83], v[86:87]
    v_pk_add_f32 v[80:81], v[80:81], v[82:83]
    v_cvt_pk_bf16_f32 v66, v80, v81
    s_cmp_ge_u32 s7, 36
    s_cbranch_scc1 MUT
    s_add_u32 s99, s99, 1
    s_and_b32 s20, s99, 0xffff
    v_lshl_or_b32 v80, v66, 16, s20
    v_mov_b32 v81, s20
    v_and_or_b32 v81, v66, s12, v81
    v_lshlrev_b32 v64, 1, v64
    v_add_u32 v64, 65536, v64
    s_mov_b64 exec, 0xffff
    global_store_dwordx2 v64, v[80:81], s[68:69] sc1
    s_branch MUD
MUT:
    v_min_u32 v66, -2, v66
GO_18:
    s_waitcnt vmcnt(0)
    v_cmp_eq_u32 vcc, 0, v74
    s_cbranch_vccz GOD_19
    global_load_dword v74, v75, s[66:67] sc1
    s_sub_u32 s10, s10, 1
    s_cbranch_scc1 EXIT
    s_branch GO_18
GOD_19:
    s_mov_b64 exec, 0xffff
    global_store_dword v64, v66, s[68:69] sc1
MUD:
    s_mov_b64 exec, -1
NC_A1:
    global_load_dwordx4 v[8:11], v7, s[52:53]
    global_load_ushort v12, v13, s[52:53]
    s_cmp_ge_u32 s7, 36
    s_cbranch_scc1 NC_A2
    s_barrier
NC_A2:
    s_barrier
    s_mul_i32 s20, s3, 14
    s_add_u32 s20, s20, s5
    s_sub_u32 s20, s20, 18
    s_cmp_ge_u32 s20, 0
    s_cbranch_scc1 PF_D
    s_add_u32 s20, s20, 81
    s_mul_i32 s22, s4, 1152
    s_movk_i32 s24, 7282
    s_movk_i32 s25, 9216-9*128
    v_lshl_add_u32 v64, s20, 6, v1
    v_mul_u32_u24 v65, s24, v64
    v_lshrrev_b32 v65, 16, v65
    v_lshl_add_u32 v64, v64, 7, s22
    v_mad_u32_u24 v64, v65, s25, v64
    global_load_dword v65, v64, s[54:55] nt
    global_load_dword v66, v64, s[56:57] nt
    s_branch PF_E
PF_D:
    s_sub_u32 s20, s20, 0
    s_cmp_ge_u32 s20, 81
    s_cbranch_scc1 PF_E
    s_mul_i32 s23, s4, 663552
    v_lshl_add_u32 v64, s20, 6, v1
    v_lshl_add_u32 v67, v64, 7, s23
    global_load_dword v68, v67, s[58:59] nt
    s_cmp_ge_u32 s20, 0
    s_cbranch_scc1 PF_E
    v_add_u32 v67, 917504, v67
    global_load_dword v70, v67, s[58:59] nt
PF_E:
NC_A4:
    s_cmp_lg_u32 s3, 4
    s_cbranch_scc1 NC_FD
    s_lshl_b32 s20, s2, 4
    s_add_u32 s20, s20, 18176
    v_mov_b32 v52, s20
    s_waitcnt vmcnt(0)
    v_min_u32 v55, 4, v1
    v_lshlrev_b32 v55, 2, v55
    global_load_dword v54, v55, s[66:67] sc1
GO_20:
    s_waitcnt vmcnt(0)
    v_cmp_eq_u32 vcc, 0, v54
    s_cbranch_vccz GOD_21
    global_load_dword v54, v55, s[66:67] sc1
    s_sub_u32 s10, s10, 1
    s_cbranch_scc1 EXIT
    s_branch GO_20
GOD_21:
NC_FP:
    global_load_dword v53, v52, s[68:69] sc1
    s_waitcnt vmcnt(0)
    v_cmp_eq_u32 vcc, -1, v53
    s_cbranch_vccz NC_FD
    s_sub_u32 s10, s10, 1
    s_cbranch_scc1 EXIT
    s_branch NC_FP
NC_FD:
    s_barrier
    v_add_u32 v52, 8192, v7
    v_add_u32 v53, 8192, v13
    v_add_u32 v54, 2304, v52
    v_add_u32 v55, 2304, v53
    global_load_dwordx4 v[106:109], v54, s[68:69]
    global_load_ushort v110, v55, s[68:69]
    v_add_u32 v54, 3456, v52
    v_add_u32 v55, 3456, v53
    global_load_dwordx4 v[20:23], v54, s[68:69]
    global_load_ushort v24, v55, s[68:69]
    v_add_u32 v54, 4608, v52
    v_add_u32 v55, 4608, v53
    global_load_dwordx4 v[14:17], v54, s[68:69]
    global_load_ushort v18, v55, s[68:69]
    v_add_u32 v54, 5760, v52
    v_add_u32 v55, 5760, v53
    global_load_dwordx4 v[26:29], v54, s[68:69]
    global_load_ushort v30, v55, s[68:69]
    s_waitcnt vmcnt(0)
MC_22:
    v_or_b32 v53, s12, v24
    v_or_b32 v54, s12, v18
    v_or_b32 v55, s12, v30
    v_or_b32 v56, s12, v110
    v_max3_u32 v52, v20, v21, v22
    v_max3_u32 v52, v52, v23, v14
    v_max3_u32 v52, v52, v15, v16
    v_max3_u32 v52, v52, v17, v26
    v_max3_u32 v52, v52, v27, v28
    v_max3_u32 v52, v52, v29, v106
    v_max3_u32 v52, v52, v107, v108
    v_max3_u32 v52, v52, v109, v53
    v_max3_u32 v52, v52, v54, v55
    v_max_u32 v52, v52, v56
    v_cmp_eq_u32 vcc, -1, v52
    s_cbranch_vccz MCD_23
    v_add_u32 v52, 8192, v7
    v_add_u32 v53, 8192, v13
    v_add_u32 v54, 2304, v52
    v_add_u32 v55, 2304, v53
    global_load_dwordx4 v[106:109], v54, s[68:69] sc1
    global_load_ushort v110, v55, s[68:69] sc1
    v_add_u32 v54, 3456, v52
    v_add_u32 v55, 3456, v53
    global_load_dwordx4 v[20:23], v54, s[68:69] sc1
    global_load_ushort v24, v55, s[68:69] sc1
    v_add_u32 v54, 4608, v52
    v_add_u32 v55, 4608, v53
    global_load_dwordx4 v[14:17], v54, s[68:69] sc1
    global_load_ushort v18, v55, s[68:69] sc1
    v_add_u32 v54, 5760, v52
    v_add_u32 v55, 5760, v53
    global_load_dwordx4 v[26:29], v54, s[68:69] sc1
    global_load_ushort v30, v55, s[68:69] sc1
    s_waitcnt vmcnt(0)
    s_sub_u32 s10, s10, 1
    s_cbranch_scc1 EXIT
    s_branch MC_22
MCD_23:
    v_lshlrev_b32 v32, 16, v14
    v_and_b32 v33, s12, v14
    v_lshlrev_b32 v34, 16, v15
    v_and_b32 v35, s12, v15
    v_lshlrev_b32 v36, 16, v16
    v_and_b32 v37, s12, v16
    v_lshlrev_b32 v38, 16, v17
    v_and_b32 v39, s12, v17
    v_lshlrev_b32 v40, 16, v18
    v_lshlrev_b32 v42, 16, v20
    v_and_b32 v43, s12, v20
    v_lshlrev_b32 v44, 16, v21
    v_and_b32 v45, s12, v21
    v_lshlrev_b32 v46, 16, v22
    v_and_b32 v47, s12, v22
    v_lshlrev_b32 v48, 16, v23
    v_and_b32 v49, s12, v23
    v_lshlrev_b32 v50, 16, v24
    v_pk_add_f32 v[32:33], v[32:33], 1.0 op_sel_hi:[1,0]
    v_pk_add_f32 v[34:35], v[34:35], 1.0 op_sel_hi:[1,0]
    v_pk_add_f32 v[36:37], v[36:37], 1.0 op_sel_hi:[1,0]
    v_pk_add_f32 v[38:39], v[38:39], 1.0 op_sel_hi:[1,0]
    v_add_f32 v40, 1.0, v40
    v_cvt_pk_bf16_f32 v52, v32, v33
    v_cvt_pk_bf16_f32 v53, v34, v35
    v_cvt_pk_bf16_f32 v54, v36, v37
    v_cvt_pk_bf16_f32 v55, v38, v39
    v_cvt_pk_bf16_f32 v56, v40, v40
    v_lshlrev_b32 v32, 16, v52
    v_and_b32 v33, s12, v52
    v_lshlrev_b32 v34, 16, v53
    v_and_b32 v35, s12, v53
    v_lshlrev_b32 v36, 16, v54
    v_and_b32 v37, s12, v54
    v_lshlrev_b32 v38, 16, v55
    v_and_b32 v39, s12, v55
    v_lshlrev_b32 v40, 16, v56
GPOLL:
    s_mul_i32 s20, s2, 9216
    s_add_u32 s20, s20, 1048576
    v_lshl_add_u32 v52, v0, 4, s20
    v_and_b32 v53, 7, v1
    v_lshl_add_u32 v53, s3, 3, v53
    v_add_u32 v53, 512, v53
    v_lshlrev_b32 v55, 2, v53
    v_lshl_add_u32 v53, v53, 4, s20
    v_lshlrev_b32 v54, 2, v0
    global_load_dwordx4 v[64:67], v52, s[68:69] sc1
    global_load_dwordx4 v[68:71], v53, s[68:69] sc1
    s_mul_i32 s20, s3, 1152
    s_add_u32 s20, s20, 145024
    v_add_u32 v56, s20, v7
    v_add_u32 v57, s20, v13
    ds_read_b128 v[2:5], v56
    ds_read_u16 v6, v57
    s_waitcnt lgkmcnt(0)
    v_lshlrev_b32 v80, 16, v2
    v_and_b32 v81, s12, v2
    v_lshlrev_b32 v82, 16, v3
    v_and_b32 v83, s12, v3
    v_lshlrev_b32 v84, 16, v4
    v_and_b32 v85, s12, v4
    v_lshlrev_b32 v86, 16, v5
    v_and_b32 v87, s12, v5
    v_lshlrev_b32 v88, 16, v6
    v_lshlrev_b32 v96, 16, v106
    v_and_b32 v97, s12, v106
    v_lshlrev_b32 v98, 16, v107
    v_and_b32 v99, s12, v107
    v_lshlrev_b32 v100, 16, v108
    v_and_b32 v101, s12, v108
    v_lshlrev_b32 v102, 16, v109
    v_and_b32 v103, s12, v109
    v_lshlrev_b32 v104, 16, v110
    s_waitcnt vmcnt(0)
GP:
    v_max3_u32 v72, v64, v65, v66
    v_max3_u32 v72, v72, v67, v68
    v_max3_u32 v72, v72, v69, v70
    v_max_u32 v72, v72, v71
    v_cmp_eq_u32 vcc, -1, v72
    s_cbranch_vccz GPD
    s_mov_b64 exec, vcc
    global_load_dwordx4 v[64:67], v52, s[68:69] sc1
    global_load_dwordx4 v[68:71], v53, s[68:69] sc1
    s_mov_b64 exec, -1
    s_waitcnt vmcnt(0)
    s_sub_u32 s10, s10, 1
    s_cbranch_scc1 EXIT
    s_branch GP
GPD:
    ds_write_b32 v54, v64 offset:8192
    ds_write_b32 v54, v65 offset:10496
    ds_write_b32 v54, v66 offset:12800
    ds_write_b32 v54, v67 offset:15104
    s_mov_b64 exec, 0xff
    ds_write_b32 v55, v68 offset:8192
    ds_write_b32 v55, v69 offset:10496
    ds_write_b32 v55, v70 offset:12800
    ds_write_b32 v55, v71 offset:15104
    s_mov_b64 exec, -1
    s_lshr_b32 s20, s3, 1
    s_mul_i32 s20, s20, 2304
    v_lshl_add_u32 v52, v1, 5, s20
    v_lshl_add_u32 v53, v1, 2, s20
    s_mov_b32 s21, 0x01000c0c
    s_bitcmp1_b32 s3, 0
    s_cselect_b32 s21, 0x03020c0c, s21
    s_mul_i32 s22, s2, 3456
    s_add_u32 s23, s22, 4194304
    v_add_u32 v56, s23, v7
    v_add_u32 v57, s23, v13
    s_waitcnt lgkmcnt(0)
    s_barrier
    ds_read_b128 v[64:67], v52 offset:8192
    ds_read_b128 v[68:71], v52 offset:8208
    ds_read_b32 v72, v53 offset:10240
    s_waitcnt lgkmcnt(0)
    v_perm_b32 v64, v64, v64, s21
    v_perm_b32 v65, v65, v65, s21
    v_perm_b32 v66, v66, v66, s21
    v_perm_b32 v67, v67, v67, s21
    v_perm_b32 v68, v68, v68, s21
    v_perm_b32 v69, v69, v69, s21
    v_perm_b32 v70, v70, v70, s21
    v_perm_b32 v71, v71, v71, s21
    v_perm_b32 v72, v72, v72, s21
    v_pk_fma_f32 v[64:65], v[64:65], v[96:97], v[80:81]
    v_pk_fma_f32 v[66:67], v[66:67], v[98:99], v[82:83]
    v_pk_fma_f32 v[68:69], v[68:69], v[100:101], v[84:85]
    v_pk_fma_f32 v[70:71], v[70:71], v[102:103], v[86:87]
    v_fma_f32 v72, v72, v104, v88
    v_cvt_pk_bf16_f32 v2, v64, v65
    v_cvt_pk_bf16_f32 v3, v66, v67
    v_cvt_pk_bf16_f32 v4, v68, v69
    v_cvt_pk_bf16_f32 v5, v70, v71
    v_cvt_pk_bf16_f32 v6, v72, v72
    v_lshlrev_b32 v64, 16, v2
    v_and_b32 v65, s12, v2
    v_lshlrev_b32 v66, 16, v3
    v_and_b32 v67, s12, v3
    v_lshlrev_b32 v68, 16, v4
    v_and_b32 v69, s12, v4
    v_lshlrev_b32 v70, 16, v5
    v_and_b32 v71, s12, v5
    v_lshlrev_b32 v72, 16, v6
    v_readfirstlane_b32 s24, v64
    s_nop 1
    v_subrev_f32 v64, s24, v64
    v_subrev_f32 v65, s24, v65
    v_subrev_f32 v66, s24, v66
    v_subrev_f32 v67, s24, v67
    v_subrev_f32 v68, s24, v68
    v_subrev_f32 v69, s24, v69
    v_subrev_f32 v70, s24, v70
    v_subrev_f32 v71, s24, v71
    v_subrev_f32 v72, s24, v72
    v_pk_add_f32 v[74:75], v[64:65], v[66:67]
    v_pk_mul_f32 v[76:77], v[64:65], v[64:65]
    v_pk_add_f32 v[74:75], v[74:75], v[68:69]
    v_pk_fma_f32 v[76:77], v[66:67], v[66:67], v[76:77]
    v_pk_add_f32 v[74:75], v[74:75], v[70:71]
    v_pk_fma_f32 v[76:77], v[68:69], v[68:69], v[76:77]
    v_add_f32 v74, v74, v72
    v_pk_fma_f32 v[76:77], v[70:71], v[70:71], v[76:77]
    v_add_f32 v74, v74, v75
    v_fmac_f32 v76, v72, v72
    v_add_f32 v76, v76, v77
    s_nop 1
    v_permlane32_swap_b32 v74, v76
    v_add_f32 v74, v74, v76
    v_mov_b32 v76, v74
    s_nop 1
    v_permlane16_swap_b32 v74, v76
    v_add_f32 v74, v74, v76
    s_nop 1
    v_add_f32_dpp v74, v74, v74 row_ror:8 row_mask:0xf bank_mask:0xf
    s_nop 1
    v_add_f32_dpp v74, v74, v74 row_ror:4 row_mask:0xf bank_mask:0xf
    s_nop 1
    v_add_f32_dpp v74, v74, v74 row_ror:2 row_mask:0xf bank_mask:0xf
    s_nop 1
    v_add_f32_dpp v74, v74, v74 row_ror:1 row_mask:0xf bank_mask:0xf
    v_mov_b32 v76, v74
    s_nop 1
    v_permlane32_swap_b32 v74, v76
    v_mul_f32 v74, 0x3ae38e39, v74
    v_mul_f32 v76, 0x3ae38e39, v76
    v_add_f32 v75, s24, v74
    v_fma_f32 v77, -v74, v74, v76
    v_max_f32 v77, 0, v77
    v_cvt_pk_bf16_f32 v77, v77, v77
    v_and_b32 v77, s12, v77
    v_add_f32 v77, 0x3727c5ac, v77
    v_cvt_pk_bf16_f32 v77, v77, v77
    v_and_b32 v77, s12, v77
    v_sqrt_f32 v78, v77
    v_cvt_pk_bf16_f32 v75, v75, v75
    v_and_b32 v75, s12, v75
    v_cvt_pk_bf16_f32 v78, v78, v78
    v_and_b32 v78, s12, v78
    v_rcp_f32 v78, v78
    v_sub_f32 v79, s24, v75
    v_mul_f32 v79, v79, v78
    v_pk_fma_f32 v[64:65], v[64:65], v[78:79], v[78:79] op_sel:[0,0,1] op_sel_hi:[1,0,1]
    v_pk_fma_f32 v[66:67], v[66:67], v[78:79], v[78:79] op_sel:[0,0,1] op_sel_hi:[1,0,1]
    v_pk_fma_f32 v[68:69], v[68:69], v[78:79], v[78:79] op_sel:[0,0,1] op_sel_hi:[1,0,1]
    v_pk_fma_f32 v[70:71], v[70:71], v[78:79], v[78:79] op_sel:[0,0,1] op_sel_hi:[1,0,1]
    v_fma_f32 v72, v72, v78, v79
    v_pk_fma_f32 v[64:65], v[64:65], v[32:33], v[42:43]
    v_pk_fma_f32 v[66:67], v[66:67], v[34:35], v[44:45]
    v_pk_fma_f32 v[68:69], v[68:69], v[36:37], v[46:47]
    v_pk_fma_f32 v[70:71], v[70:71], v[38:39], v[48:49]
    v_fma_f32 v72, v72, v40, v50
    v_cvt_pk_bf16_f32 v90, v64, v65
    v_cvt_pk_bf16_f32 v91, v66, v67
    v_cvt_pk_bf16_f32 v92, v68, v69
    v_cvt_pk_bf16_f32 v93, v70, v71
    v_cvt_pk_bf16_f32 v94, v72, v72
    v_dot2_f32_bf16 v74, v90, v8, 0
    v_dot2_f32_bf16 v75, v91, v9, 0
    v_dot2_f32_bf16 v74, v92, v10, v74
    v_dot2_f32_bf16 v75, v93, v11, v75
    v_dot2_f32_bf16 v74, v94, v12, v74
    s_nop 2
    v_add_f32 v74, v74, v75
    v_mov_b32 v76, v74
    s_nop 1
    v_permlane32_swap_b32 v74, v76
    v_add_f32 v74, v74, v76
    v_mov_b32 v76, v74
    s_nop 1
    v_permlane16_swap_b32 v74, v76
    v_add_f32 v74, v74, v76
    s_nop 1
    v_add_f32_dpp v74, v74, v74 row_ror:8 row_mask:0xf bank_mask:0xf
    s_nop 1
    v_add_f32_dpp v74, v74, v74 row_ror:4 row_mask:0xf bank_mask:0xf
    s_nop 1
    v_add_f32_dpp v74, v74, v74 row_ror:2 row_mask:0xf bank_mask:0xf
    s_nop 1
    v_add_f32_dpp v74, v74, v74 row_ror:1 row_mask:0xf bank_mask:0xf
    v_cvt_pk_bf16_f32 v74, v74, v74
    v_ashrrev_i32 v75, 31, v74
    v_or_b32 v75, 0x80008000, v75
    v_xor_b32 v74, v74, v75
    v_min_u32 v74, 0xfffefffe, v74
    s_lshl_b32 s20, s3, 1
    s_add_u32 s20, s20, 143552
    v_mov_b32 v75, s20
    s_mov_b64 exec, 1
    ds_write_b16_d16_hi v75, v74
    s_mov_b64 exec, -1
    s_waitcnt lgkmcnt(0)
    v_and_b32 v53, 7, v1
    v_lshlrev_b32 v54, 1, v53
    v_add_u32 v54, 143552, v54
    v_sub_u32 v53, 7, v53
    s_barrier
    ds_read_u16 v54, v54
    s_cmp_lg_u32 s3, 0
    s_cbranch_scc1 NORS
    v_mov_b32 v52, 143552
    ds_read_b128 v[64:67], v52
    s_lshl_b32 s20, s2, 4
    s_add_u32 s20, s20, 49152
    v_lshl_add_u32 v52, v1, 12, s20
    s_mov_b64 exec, 0xff
    s_waitcnt lgkmcnt(0)
    global_store_dwordx4 v52, v[64:67], s[68:69] sc1
    s_mov_b64 exec, -1
NORS:
    s_waitcnt lgkmcnt(0)
    v_lshl_or_b32 v54, v54, 3, v53
    s_nop 0
    v_readlane_b32 s20, v54, s3
    s_nop 1
    v_cmp_lt_u32 vcc, s20, v54
    s_nop 0
    s_and_b32 s14, vcc_lo, 0xff
    s_bcnt1_i32_b32 s14, s14
    s_mul_i32 s20, s14, 1152
    v_add_u32 v56, s20, v56
    v_add_u32 v57, s20, v57
    s_cmp_ge_u32 s14, 3
    s_cbranch_scc1 NOBEST
    global_store_dwordx4 v56, v[90:93], s[68:69] sc1
    global_store_short v57, v94, s[68:69] sc1
NOBEST:
    v_lshlrev_b32 v64, 16, v2
    v_and_b32 v65, s12, v2
    v_lshlrev_b32 v66, 16, v3
    v_and_b32 v67, s12, v3
    v_lshlrev_b32 v68, 16, v4
    v_and_b32 v69, s12, v4
    v_lshlrev_b32 v70, 16, v5
    v_and_b32 v71, s12, v5
    v_lshlrev_b32 v72, 16, v6
    v_lshlrev_b32 v74, 16, v90
    v_and_b32 v75, s12, v90
    v_lshlrev_b32 v76, 16, v91
    v_and_b32 v77, s12, v91
    v_lshlrev_b32 v78, 16, v92
    v_and_b32 v79, s12, v92
    v_lshlrev_b32 v80, 16, v93
    v_and_b32 v81, s12, v93
    v_lshlrev_b32 v82, 16, v94
    v_lshlrev_b32 v96, 16, v26
    v_and_b32 v97, s12, v26
    v_lshlrev_b32 v98, 16, v27
    v_and_b32 v99, s12, v27
    v_lshlrev_b32 v100, 16, v28
    v_and_b32 v101, s12, v28
    v_lshlrev_b32 v102, 16, v29
    v_and_b32 v103, s12, v29
    v_lshlrev_b32 v104, 16, v30
    v_pk_fma_f32 v[64:65], v[74:75], v[96:97], v[64:65]
    v_pk_fma_f32 v[66:67], v[76:77], v[98:99], v[66:67]
    v_pk_fma_f32 v[68:69], v[78:79], v[100:101], v[68:69]
    v_pk_fma_f32 v[70:71], v[80:81], v[102:103], v[70:71]
    v_fma_f32 v72, v82, v104, v72
    v_cvt_pk_bf16_f32 v8, v64, v65
    v_cvt_pk_bf16_f32 v9, v66, v67
    v_cvt_pk_bf16_f32 v10, v68, v69
    v_cvt_pk_bf16_f32 v11, v70, v71
    v_cvt_pk_bf16_f32 v12, v72, v72
    s_cmp_lt_u32 s3, 4
    s_cbranch_scc1 T8_A
    s_cmp_eq_u32 s13, 0
    s_cbranch_scc1 T8_B5
    v_lshrrev_b32 v53, 4, v1
    v_and_b32 v52, 15, v1
    v_lshlrev_b32 v52, 3, v52
    s_movk_i32 s21, 1152
    v_mad_u32_u24 v52, v53, s21, v52
    s_mul_i32 s20, s8, 36864
    s_lshl_b32 s21, s9, 7
    s_add_u32 s20, s20, s21
    v_add_u32 v52, s20, v52
    global_load_dwordx2 v[208:209], v52, s[58:59] nt
    global_load_dwordx2 v[224:225], v52, s[58:59] offset:512 nt
    v_add_u32 v52, 4608, v52
    global_load_dwordx2 v[210:211], v52, s[58:59] nt
    global_load_dwordx2 v[226:227], v52, s[58:59] offset:512 nt
    v_add_u32 v52, 4608, v52
    global_load_dwordx2 v[212:213], v52, s[58:59] nt
    global_load_dwordx2 v[228:229], v52, s[58:59] offset:512 nt
    v_add_u32 v52, 4608, v52
    global_load_dwordx2 v[214:215], v52, s[58:59] nt
    global_load_dwordx2 v[230:231], v52, s[58:59] offset:512 nt
    v_add_u32 v52, 4608, v52
    global_load_dwordx2 v[216:217], v52, s[58:59] nt
    global_load_dwordx2 v[232:233], v52, s[58:59] offset:512 nt
    v_add_u32 v52, 4608, v52
    global_load_dwordx2 v[218:219], v52, s[58:59] nt
    global_load_dwordx2 v[234:235], v52, s[58:59] offset:512 nt
    v_add_u32 v52, 4608, v52
    global_load_dwordx2 v[220:221], v52, s[58:59] nt
    global_load_dwordx2 v[236:237], v52, s[58:59] offset:512 nt
    v_add_u32 v52, 4608, v52
    global_load_dwordx2 v[222:223], v52, s[58:59] nt
    global_load_dwordx2 v[238:239], v52, s[58:59] offset:512 nt
    s_cmp_lg_u32 s9, 3
    s_cbranch_scc1 W8_24
    global_load_dwordx2 v[254:255], v52, s[58:59] offset:640 nt
    v_subrev_u32 v52, 4608, v52
    global_load_dwordx2 v[252:253], v52, s[58:59] offset:640 nt
    v_subrev_u32 v52, 4608, v52
    global_load_dwordx2 v[250:251], v52, s[58:59] offset:640 nt
    v_subrev_u32 v52, 4608, v52
    global_load_dwordx2 v[248:249], v52, s[58:59] offset:640 nt
    v_subrev_u32 v52, 4608, v52
    global_load_dwordx2 v[246:247], v52, s[58:59] offset:640 nt
    v_subrev_u32 v52, 4608, v52
    global_load_dwordx2 v[244:245], v52, s[58:59] offset:640 nt
    v_subrev_u32 v52, 4608, v52
    global_load_dwordx2 v[242:243], v52, s[58:59] offset:640 nt
    v_subrev_u32 v52, 4608, v52
    global_load_dwordx2 v[240:241], v52, s[58:59] offset:640 nt
W8_24:
    s_branch T8_B5
T8_A:
    v_and_b32 v52, 255, v0
    s_lshl_b32 s20, s4, 12
    s_add_u32 s20, s20, 49152
    v_lshl_add_u32 v53, v52, 4, s20
    v_lshlrev_b32 v52, 3, v52
    v_sub_u32 v52, 2047, v52
    v_and_b32 v54, 1, v1
    v_cmp_eq_u32 s[20:21], 0, v54
    v_and_b32 v54, 2, v1
    v_cmp_eq_u32 s[22:23], 0, v54
    v_and_b32 v54, 4, v1
    v_cmp_eq_u32 s[24:25], 0, v54
    v_and_b32 v54, 7, v1
    v_lshlrev_b32 v54, 2, v54
    s_waitcnt vmcnt(0)
    global_load_dwordx4 v[64:67], v53, s[68:69]
    s_waitcnt vmcnt(0)
RP:
    v_max3_u32 v68, v64, v65, v66
    v_max_u32 v68, v68, v67
    v_cmp_eq_u32 vcc, -1, v68
    s_cbranch_vccz RPD
    s_mov_b64 exec, vcc
    global_load_dwordx4 v[64:67], v53, s[68:69] sc1
    s_mov_b64 exec, -1
    s_waitcnt vmcnt(0)
    s_sub_u32 s10, s10, 1
    s_cbranch_scc1 EXIT
    s_branch RP
RPD:
    s_add_u32 s26, s2, s9
    s_cmp_lg_u32 s26, 0
    s_cbranch_scc1 NOEP
    v_mov_b32 v68, 94208
    v_mov_b32 v69, s99
    global_store_dword v68, v69, s[68:69] sc1
NOEP:
    v_cndmask_b32 v68, v66, v64, s[20:21]
    v_cndmask_b32 v69, v67, v65, s[20:21]
    v_cndmask_b32 v70, v64, v66, s[20:21]
    v_cndmask_b32 v71, v65, v67, s[20:21]
    s_nop 0
    v_mov_b32_dpp v72, v70 quad_perm:[1,0,3,2] row_mask:0xf bank_mask:0xf
    v_mov_b32_dpp v73, v71 quad_perm:[1,0,3,2] row_mask:0xf bank_mask:0xf
    v_pk_max_u16 v68, v68, v72
    v_pk_max_u16 v69, v69, v73
    v_cndmask_b32 v70, v69, v68, s[22:23]
    v_cndmask_b32 v71, v68, v69, s[22:23]
    s_nop 1
    v_mov_b32_dpp v72, v71 quad_perm:[2,3,0,1] row_mask:0xf bank_mask:0xf
    v_pk_max_u16 v70, v70, v72
    s_nop 1
    v_mov_b32_dpp v72, v70 row_ror:4 row_mask:0xf bank_mask:0xf
    v_pk_max_u16 v70, v70, v72
    v_and_b32 v71, 0xffff, v70
    v_lshrrev_b32 v70, 16, v70
    v_cndmask_b32 v70, v70, v71, s[24:25]
    v_add_u32 v54, 143488, v54
    ds_max_u32 v54, v70
    v_subrev_u32 v80, 0, v52
    v_lshl_or_b32 v80, v64, 16, v80
    v_subrev_u32 v81, 1, v52
    v_and_or_b32 v81, v64, s12, v81
    v_subrev_u32 v82, 2, v52
    v_lshl_or_b32 v82, v65, 16, v82
    v_subrev_u32 v83, 3, v52
    v_and_or_b32 v83, v65, s12, v83
    v_subrev_u32 v84, 4, v52
    v_lshl_or_b32 v84, v66, 16, v84
    v_subrev_u32 v85, 5, v52
    v_and_or_b32 v85, v66, s12, v85
    v_subrev_u32 v86, 6, v52
    v_lshl_or_b32 v86, v67, 16, v86
    v_subrev_u32 v87, 7, v52
    v_and_or_b32 v87, v67, s12, v87
    s_waitcnt lgkmcnt(0)
T8_B5:
    s_barrier
    s_cmp_ge_u32 s3, 4
    s_cbranch_scc1 T8_B6
    v_mov_b32 v54, 143488
    ds_read_b128 v[64:67], v54
    ds_read_b128 v[68:71], v54 offset:16
    v_mov_b32 v72, 0
    s_waitcnt lgkmcnt(0)
    v_min3_u32 v64, v64, v65, v66
    v_min3_u32 v67, v67, v68, v69
    v_min3_u32 v64, v64, v70, v71
    v_min_u32 v64, v64, v67
    v_lshlrev_b32 v64, 16, v64
    v_cmp_ge_u32 s[20:21], v80, v64
    v_cmp_ge_u32 s[22:23], v81, v64
    v_cmp_ge_u32 s[24:25], v82, v64
    v_cmp_ge_u32 s[26:27], v83, v64
    v_cmp_ge_u32 s[28:29], v84, v64
    v_cmp_ge_u32 s[30:31], v85, v64
    v_cmp_ge_u32 s[32:33], v86, v64
    v_cmp_ge_u32 s[34:35], v87, v64
    v_addc_co_u32 v72, vcc, 0, v72, s[20:21]
    s_nop 1
    v_addc_co_u32 v72, vcc, 0, v72, s[22:23]
    s_nop 1
    v_addc_co_u32 v72, vcc, 0, v72, s[24:25]
    s_nop 1
    v_addc_co_u32 v72, vcc, 0, v72, s[26:27]
    s_nop 1
    v_addc_co_u32 v72, vcc, 0, v72, s[28:29]
    s_nop 1
    v_addc_co_u32 v72, vcc, 0, v72, s[30:31]
    s_nop 1
    v_addc_co_u32 v72, vcc, 0, v72, s[32:33]
    s_nop 1
    v_addc_co_u32 v72, vcc, 0, v72, s[34:35]
    v_cmp_lt_u32 vcc, 0, v72
    s_nop 0
    s_mov_b64 exec, vcc
    ds_add_rtn_u32 v73, v54, v72 offset:32
    s_waitcnt lgkmcnt(0)
    v_lshlrev_b32 v73, 2, v73
    s_mov_b64 exec, s[20:21]
    ds_write_b32 v73, v80 offset:17408
    v_add_u32 v73, 4, v73
    s_mov_b64 exec, s[22:23]
    ds_write_b32 v73, v81 offset:17408
    v_add_u32 v73, 4, v73
    s_mov_b64 exec, s[24:25]
    ds_write_b32 v73, v82 offset:17408
    v_add_u32 v73, 4, v73
    s_mov_b64 exec, s[26:27]
    ds_write_b32 v73, v83 offset:17408
    v_add_u32 v73, 4, v73
    s_mov_b64 exec, s[28:29]
    ds_write_b32 v73, v84 offset:17408
    v_add_u32 v73, 4, v73
    s_mov_b64 exec, s[30:31]
    ds_write_b32 v73, v85 offset:17408
    v_add_u32 v73, 4, v73
    s_mov_b64 exec, s[32:33]
    ds_write_b32 v73, v86 offset:17408
    v_add_u32 v73, 4, v73
    s_mov_b64 exec, s[34:35]
    ds_write_b32 v73, v87 offset:17408
    v_add_u32 v73, 4, v73
    s_mov_b64 exec, -1
    s_waitcnt lgkmcnt(0)
T8_B6:
    s_barrier
    v_mov_b32 v54, 143520
    ds_read_b32 v55, v54
    v_lshlrev_b32 v52, 2, v1
    ds_read_b32 v64, v52 offset:17408
    v_mov_b32 v53, 0
    s_lshl_b32 s22, s3, 5
    s_add_u32 s22, s22, 143616
    s_mov_b32 s21, 0
    s_waitcnt lgkmcnt(1)
    v_readfirstlane_b32 s20, v55
    v_lshl_add_u32 v55, v55, 2, v52
    s_mov_b64 exec, 0xffff
    ds_write_b32 v55, v53 offset:17408
    s_mov_b64 exec, -1
RK_O:
    v_mov_b32 v65, 0
    v_mov_b32 v54, 0
    s_mov_b32 s23, 0
RK_I:
    ds_read_b128 v[68:71], v54 offset:17408
    ds_read_b128 v[72:75], v54 offset:17424
    ds_read_b128 v[76:79], v54 offset:17440
    ds_read_b128 v[80:83], v54 offset:17456
    v_add_u32 v54, 64, v54
    s_add_u32 s23, s23, 16
    s_waitcnt lgkmcnt(3)
    v_cmp_gt_u32 s[24:25], v68, v64
    v_cmp_gt_u32 s[26:27], v69, v64
    v_cmp_gt_u32 s[28:29], v70, v64
    v_cmp_gt_u32 s[30:31], v71, v64
    v_addc_co_u32 v65, vcc, 0, v65, s[24:25]
    s_nop 1
    v_addc_co_u32 v65, vcc, 0, v65, s[26:27]
    s_nop 1
    v_addc_co_u32 v65, vcc, 0, v65, s[28:29]
    s_nop 1
    v_addc_co_u32 v65, vcc, 0, v65, s[30:31]
    s_waitcnt lgkmcnt(2)
    v_cmp_gt_u32 s[24:25], v72, v64
    v_cmp_gt_u32 s[26:27], v73, v64
    v_cmp_gt_u32 s[28:29], v74, v64
    v_cmp_gt_u32 s[30:31], v75, v64
    v_addc_co_u32 v65, vcc, 0, v65, s[24:25]
    s_nop 1
    v_addc_co_u32 v65, vcc, 0, v65, s[26:27]
    s_nop 1
    v_addc_co_u32 v65, vcc, 0, v65, s[28:29]
    s_nop 1
    v_addc_co_u32 v65, vcc, 0, v65, s[30:31]
    s_waitcnt lgkmcnt(1)
    v_cmp_gt_u32 s[24:25], v76, v64
    v_cmp_gt_u32 s[26:27], v77, v64
    v_cmp_gt_u32 s[28:29], v78, v64
    v_cmp_gt_u32 s[30:31], v79, v64
    v_addc_co_u32 v65, vcc, 0, v65, s[24:25]
    s_nop 1
    v_addc_co_u32 v65, vcc, 0, v65, s[26:27]
    s_nop 1
    v_addc_co_u32 v65, vcc, 0, v65, s[28:29]
    s_nop 1
    v_addc_co_u32 v65, vcc, 0, v65, s[30:31]
    s_waitcnt lgkmcnt(0)
    v_cmp_gt_u32 s[24:25], v80, v64
    v_cmp_gt_u32 s[26:27], v81, v64
    v_cmp_gt_u32 s[28:29], v82, v64
    v_cmp_gt_u32 s[30:31], v83, v64
    v_addc_co_u32 v65, vcc, 0, v65, s[24:25]
    s_nop 1
    v_addc_co_u32 v65, vcc, 0, v65, s[26:27]
    s_nop 1
    v_addc_co_u32 v65, vcc, 0, v65, s[28:29]
    s_nop 1
    v_addc_co_u32 v65, vcc, 0, v65, s[30:31]
    s_cmp_lt_u32 s23, s20
    s_cbranch_scc1 RK_I
    v_add_u32 v66, s21, v1
    v_cmp_gt_u32 vcc, s20, v66
    v_cmp_gt_u32 s[24:25], 8, v65
    s_nop 0
    s_and_b64 exec, vcc, s[24:25]
    v_lshl_add_u32 v65, v65, 2, s22
    ds_write_b32 v65, v64
    s_mov_b64 exec, -1
    s_add_u32 s21, s21, 64
    s_cmp_ge_u32 s21, s20
    s_cbranch_scc1 RK_D
    v_add_u32 v52, 256, v52
    ds_read_b32 v64, v52 offset:17408
    s_branch RK_O
RK_D:
    v_and_b32 v54, 7, v1
    v_lshl_add_u32 v54, v54, 2, s22
    ds_read_b32 v64, v54
    s_mul_i32 s23, s11, 1152
    s_waitcnt lgkmcnt(0)
    v_and_b32 v65, 0x7ff, v64
    v_sub_u32 v65, 2047, v65
    v_lshrrev_b32 v66, 3, v65
    v_mov_b32 v67, 0
    v_readlane_b32 s20, v66, 0
    s_nop 1
    v_cmp_eq_u32 vcc, s20, v66
    s_nop 0
    s_and_b32 s26, vcc_lo, 0xfefefefe
    s_mov_b32 s27, s26
    v_addc_co_u32 v67, vcc, 0, v67, s[26:27]
    v_readlane_b32 s20, v66, 1
    s_nop 1
    v_cmp_eq_u32 vcc, s20, v66
    s_nop 0
    s_and_b32 s26, vcc_lo, 0xfcfcfcfc
    s_mov_b32 s27, s26
    v_addc_co_u32 v67, vcc, 0, v67, s[26:27]
    v_readlane_b32 s20, v66, 2
    s_nop 1
    v_cmp_eq_u32 vcc, s20, v66
    s_nop 0
    s_and_b32 s26, vcc_lo, 0xf8f8f8f8
    s_mov_b32 s27, s26
    v_addc_co_u32 v67, vcc, 0, v67, s[26:27]
    v_readlane_b32 s20, v66, 3
    s_nop 1
    v_cmp_eq_u32 vcc, s20, v66
    s_nop 0
    s_and_b32 s26, vcc_lo, 0xf0f0f0f0
    s_mov_b32 s27, s26
    v_addc_co_u32 v67, vcc, 0, v67, s[26:27]
    v_readlane_b32 s20, v66, 4
    s_nop 1
    v_cmp_eq_u32 vcc, s20, v66
    s_nop 0
    s_and_b32 s26, vcc_lo, 0xe0e0e0e0
    s_mov_b32 s27, s26
    v_addc_co_u32 v67, vcc, 0, v67, s[26:27]
    v_readlane_b32 s20, v66, 5
    s_nop 1
    v_cmp_eq_u32 vcc, s20, v66
    s_nop 0
    s_and_b32 s26, vcc_lo, 0xc0c0c0c0
    s_mov_b32 s27, s26
    v_addc_co_u32 v67, vcc, 0, v67, s[26:27]
    v_readlane_b32 s20, v66, 6
    s_nop 1
    v_cmp_eq_u32 vcc, s20, v66
    s_nop 0
    s_and_b32 s26, vcc_lo, 0x80808080
    s_mov_b32 s27, s26
    v_addc_co_u32 v67, vcc, 0, v67, s[26:27]
    v_cmp_le_u32 vcc, 3, v67
    v_mad_u32_u24 v66, v66, 3, v67
    v_and_b32 v67, 7, v1
    s_movk_i32 s20, 1152
    v_mul_u32_u24 v66, s20, v66
    v_mul_u32_u24 v67, s20, v67
    v_add_u32 v66, 4194304, v66
    v_add_u32 v67, 32768, v67
    v_cndmask_b32 v66, v66, v67, vcc
    s_cmp_eq_u32 s13, 0
    s_cbranch_scc1 NOAF
    s_movk_i32 s20, 1152
    v_lshrrev_b32 v52, 4, v1
    v_lshlrev_b32 v52, 4, v52
    s_lshl_b32 s21, s9, 6
    v_add3_u32 v52, v66, s21, v52
    s_movk_i32 s21, 1024
    s_cmp_ge_u32 s9, 2
    s_cselect_b32 s21, 768, s21
    v_add_u32 v53, s21, v52
    global_load_dwordx4 v[68:71], v52, s[68:69]
    global_load_dwordx4 v[72:75], v52, s[68:69] offset:256
    global_load_dwordx4 v[76:79], v52, s[68:69] offset:512
    global_load_dwordx4 v[80:83], v52, s[68:69] offset:768
    global_load_dwordx4 v[84:87], v53, s[68:69]
NOAF:
    v_cmp_eq_u32 vcc, s11, v65
    s_cbranch_vccnz OWN_SEL
    v_add_u32 v54, s23, v7
    v_add_u32 v55, s23, v13
    global_store_dwordx4 v54, v[8:11], s[64:65]
    global_store_short v55, v12, s[64:65]
    s_branch OWN_D
OWN_SEL:
    s_ff1_i32_b64 s20, vcc
    s_mul_i32 s20, s20, 1152
    s_add_u32 s20, s20, 22528
    v_add_u32 v54, s20, v7
    v_add_u32 v55, s20, v13
    s_cmp_lt_u32 s14, 3
    s_cbranch_scc1 OWN_B
    v_add_u32 v56, 10240, v54
    v_add_u32 v57, 10240, v55
    global_store_dwordx4 v56, v[90:93], s[68:69] sc1
    global_store_short v57, v94, s[68:69] sc1
OWN_B:
    global_store_dwordx4 v54, v[2:5], s[68:69] sc1
    global_store_short v55, v6, s[68:69] sc1
OWN_D:
    s_cmp_eq_u32 s13, 0
    s_cbranch_scc1 S4PRE
    s_waitcnt vmcnt(7)
    s_mov_b32 s26, 0x05040100
    s_mov_b32 s27, 0x07060302
    v_perm_b32 v112, v130, v128, s26
    v_perm_b32 v116, v130, v128, s27
    v_perm_b32 v120, v131, v129, s26
    v_perm_b32 v124, v131, v129, s27
    v_perm_b32 v113, v134, v132, s26
    v_perm_b32 v117, v134, v132, s27
    v_perm_b32 v121, v135, v133, s26
    v_perm_b32 v125, v135, v133, s27
    v_perm_b32 v114, v138, v136, s26
    v_perm_b32 v118, v138, v136, s27
    v_perm_b32 v122, v139, v137, s26
    v_perm_b32 v126, v139, v137, s27
    v_perm_b32 v115, v142, v140, s26
    v_perm_b32 v119, v142, v140, s27
    v_perm_b32 v123, v143, v141, s26
    v_perm_b32 v127, v143, v141, s27
    v_perm_b32 v128, v146, v144, s26
    v_perm_b32 v132, v146, v144, s27
    v_perm_b32 v136, v147, v145, s26
    v_perm_b32 v140, v147, v145, s27
    v_perm_b32 v129, v150, v148, s26
    v_perm_b32 v133, v150, v148, s27
    v_perm_b32 v137, v151, v149, s26
    v_perm_b32 v141, v151, v149, s27
    v_perm_b32 v130, v154, v152, s26
    v_perm_b32 v134, v154, v152, s27
    v_perm_b32 v138, v155, v153, s26
    v_perm_b32 v142, v155, v153, s27
    v_perm_b32 v131, v158, v156, s26
    v_perm_b32 v135, v158, v156, s27
    v_perm_b32 v139, v159, v157, s26
    v_perm_b32 v143, v159, v157, s27
    v_perm_b32 v144, v162, v160, s26
    v_perm_b32 v148, v162, v160, s27
    v_perm_b32 v152, v163, v161, s26
    v_perm_b32 v156, v163, v161, s27
    v_perm_b32 v145, v166, v164, s26
    v_perm_b32 v149, v166, v164, s27
    v_perm_b32 v153, v167, v165, s26
    v_perm_b32 v157, v167, v165, s27
    v_perm_b32 v146, v170, v168, s26
    v_perm_b32 v150, v170, v168, s27
    v_perm_b32 v154, v171, v169, s26
    v_perm_b32 v158, v171, v169, s27
    v_perm_b32 v147, v174, v172, s26
    v_perm_b32 v151, v174, v172, s27
    v_perm_b32 v155, v175, v173, s26
    v_perm_b32 v159, v175, v173, s27
    v_perm_b32 v160, v178, v176, s26
    v_perm_b32 v164, v178, v176, s27
    v_perm_b32 v168, v179, v177, s26
    v_perm_b32 v172, v179, v177, s27
    v_perm_b32 v161, v182, v180, s26
    v_perm_b32 v165, v182, v180, s27
    v_perm_b32 v169, v183, v181, s26
    v_perm_b32 v173, v183, v181, s27
    v_perm_b32 v162, v186, v184, s26
    v_perm_b32 v166, v186, v184, s27
    v_perm_b32 v170, v187, v185, s26
    v_perm_b32 v174, v187, v185, s27
    v_perm_b32 v163, v190, v188, s26
    v_perm_b32 v167, v190, v188, s27
    v_perm_b32 v171, v191, v189, s26
    v_perm_b32 v175, v191, v189, s27
    v_perm_b32 v176, v194, v192, s26
    v_perm_b32 v180, v194, v192, s27
    v_perm_b32 v184, v195, v193, s26
    v_perm_b32 v188, v195, v193, s27
    v_perm_b32 v177, v198, v196, s26
    v_perm_b32 v181, v198, v196, s27
    v_perm_b32 v185, v199, v197, s26
    v_perm_b32 v189, v199, v197, s27
    v_perm_b32 v178, v202, v200, s26
    v_perm_b32 v182, v202, v200, s27
    v_perm_b32 v186, v203, v201, s26
    v_perm_b32 v190, v203, v201, s27
    v_perm_b32 v179, v206, v204, s26
    v_perm_b32 v183, v206, v204, s27
    v_perm_b32 v187, v207, v205, s26
    v_perm_b32 v191, v207, v205, s27
    v_perm_b32 v192, v210, v208, s26
    v_perm_b32 v196, v210, v208, s27
    v_perm_b32 v200, v211, v209, s26
    v_perm_b32 v204, v211, v209, s27
    v_perm_b32 v193, v214, v212, s26
    v_perm_b32 v197, v214, v212, s27
    v_perm_b32 v201, v215, v213, s26
    v_perm_b32 v205, v215, v213, s27
    v_perm_b32 v194, v218, v216, s26
    v_perm_b32 v198, v218, v216, s27
    v_perm_b32 v202, v219, v217, s26
    v_perm_b32 v206, v219, v217, s27
    v_perm_b32 v195, v222, v220, s26
    v_perm_b32 v199, v222, v220, s27
    v_perm_b32 v203, v223, v221, s26
    v_perm_b32 v207, v223, v221, s27
    v_perm_b32 v208, v226, v224, s26
    v_perm_b32 v212, v226, v224, s27
    v_perm_b32 v216, v227, v225, s26
    v_perm_b32 v220, v227, v225, s27
    v_perm_b32 v209, v230, v228, s26
    v_perm_b32 v213, v230, v228, s27
    v_perm_b32 v217, v231, v229, s26
    v_perm_b32 v221, v231, v229, s27
    v_perm_b32 v210, v234, v232, s26
    v_perm_b32 v214, v234, v232, s27
    v_perm_b32 v218, v235, v233, s26
    v_perm_b32 v222, v235, v233, s27
    v_perm_b32 v211, v238, v236, s26
    v_perm_b32 v215, v238, v236, s27
    v_perm_b32 v219, v239, v237, s26
    v_perm_b32 v223, v239, v237, s27
    v_perm_b32 v224, v242, v240, s26
    v_perm_b32 v228, v242, v240, s27
    v_perm_b32 v232, v243, v241, s26
    v_perm_b32 v236, v243, v241, s27
    v_perm_b32 v225, v246, v244, s26
    v_perm_b32 v229, v246, v244, s27
    v_perm_b32 v233, v247, v245, s26
    v_perm_b32 v237, v247, v245, s27
    v_perm_b32 v226, v250, v248, s26
    v_perm_b32 v230, v250, v248, s27
    v_perm_b32 v234, v251, v249, s26
    v_perm_b32 v238, v251, v249, s27
    v_perm_b32 v227, v254, v252, s26
    v_perm_b32 v231, v254, v252, s27
    v_perm_b32 v235, v255, v253, s26
    v_perm_b32 v239, v255, v253, s27
    s_waitcnt vmcnt(2)
AFP:
    v_max3_u32 v88, v68, v69, v70
    v_max3_u32 v88, v88, v71, v72
    v_max3_u32 v88, v88, v73, v74
    v_max3_u32 v88, v88, v75, v76
    v_max3_u32 v88, v88, v77, v78
    v_max3_u32 v88, v88, v79, v80
    v_max3_u32 v88, v88, v81, v82
    v_max3_u32 v88, v88, v83, v84
    v_max3_u32 v88, v88, v85, v86
    v_max_u32 v88, v88, v87
    v_cmp_eq_u32 vcc, -1, v88
    s_cbranch_vccz AFPD
    s_mov_b64 exec, vcc
    global_load_dwordx4 v[68:71], v52, s[68:69] sc1
    global_load_dwordx4 v[72:75], v52, s[68:69] offset:256 sc1
    global_load_dwordx4 v[76:79], v52, s[68:69] offset:512 sc1
    global_load_dwordx4 v[80:83], v52, s[68:69] offset:768 sc1
    global_load_dwordx4 v[84:87], v53, s[68:69] sc1
    s_mov_b64 exec, -1
    s_waitcnt vmcnt(0)
    s_sub_u32 s10, s10, 1
    s_cbranch_scc1 EXIT
    s_branch AFP
AFPD:
    v_mfma_f32_16x16x32_bf16 v[92:95], v[112:115], v[68:71], 0
    v_mfma_f32_16x16x32_bf16 v[96:99], v[116:119], v[68:71], 0
    v_mfma_f32_16x16x32_bf16 v[100:103], v[120:123], v[68:71], 0
    v_mfma_f32_16x16x32_bf16 v[104:107], v[124:127], v[68:71], 0
    v_mfma_f32_16x16x32_bf16 v[92:95], v[128:131], v[72:75], v[92:95]
    v_mfma_f32_16x16x32_bf16 v[96:99], v[132:135], v[72:75], v[96:99]
    v_mfma_f32_16x16x32_bf16 v[100:103], v[136:139], v[72:75], v[100:103]
    v_mfma_f32_16x16x32_bf16 v[104:107], v[140:143], v[72:75], v[104:107]
    v_mfma_f32_16x16x32_bf16 v[92:95], v[144:147], v[76:79], v[92:95]
    v_mfma_f32_16x16x32_bf16 v[96:99], v[148:151], v[76:79], v[96:99]
    v_mfma_f32_16x16x32_bf16 v[100:103], v[152:155], v[76:79], v[100:103]
    v_mfma_f32_16x16x32_bf16 v[104:107], v[156:159], v[76:79], v[104:107]
    v_mfma_f32_16x16x32_bf16 v[92:95], v[160:163], v[80:83], v[92:95]
    v_mfma_f32_16x16x32_bf16 v[96:99], v[164:167], v[80:83], v[96:99]
    v_mfma_f32_16x16x32_bf16 v[100:103], v[168:171], v[80:83], v[100:103]
    v_mfma_f32_16x16x32_bf16 v[104:107], v[172:175], v[80:83], v[104:107]
    s_cmp_ge_u32 s9, 2
    s_cbranch_scc1 MF4
    v_mfma_f32_16x16x32_bf16 v[92:95], v[176:179], v[84:87], v[92:95]
    v_mfma_f32_16x16x32_bf16 v[96:99], v[180:183], v[84:87], v[96:99]
    v_mfma_f32_16x16x32_bf16 v[100:103], v[184:187], v[84:87], v[100:103]
    v_mfma_f32_16x16x32_bf16 v[104:107], v[188:191], v[84:87], v[104:107]
MF4:
    s_mul_i32 s20, s9, 4608
    v_lshl_add_u32 v52, v1, 4, s20
    v_lshrrev_b32 v53, 4, v1
    s_movk_i32 s20, 1152
    v_mul_u32_u24 v54, s20, v53
    v_and_b32 v55, 7, v1
    v_lshl_add_u32 v54, v55, 4, v54
    v_and_b32 v55, 8, v1
    v_lshl_add_u32 v54, v55, 5, v54
    v_cmp_eq_u32 s[24:25], 0, v55
    s_nop 4
    ds_write_b128 v52, v[92:95] offset:27648
    ds_write_b128 v52, v[96:99] offset:28800
    ds_write_b128 v52, v[100:103] offset:29952
    ds_write_b128 v52, v[104:107] offset:31104
    s_waitcnt lgkmcnt(0)
    s_barrier
    ds_read_b128 v[64:67], v54 offset:27648
    ds_read_b128 v[68:71], v54 offset:28160
    ds_read_b128 v[72:75], v54 offset:32256
    ds_read_b128 v[76:79], v54 offset:32768
    ds_read_b128 v[80:83], v54 offset:36864
    ds_read_b128 v[84:87], v54 offset:37376
    ds_read_b128 v[88:91], v54 offset:41472
    ds_read_b128 v[92:95], v54 offset:41984
    v_and_b32 v53, 1, v53
    s_mov_b32 s20, 1327104
    v_mul_u32_u24 v53, s20, v53
    v_lshrrev_b32 v55, 3, v55
    s_movk_i32 s20, 18432
    v_mad_u32_u24 v53, v55, s20, v53
    v_and_b32 v55, 7, v1
    v_lshl_add_u32 v53, v55, 4, v53
    s_lshl_b32 s20, s8, 7
    s_add_u32 s20, s20, 7340032
    v_add_u32 v53, s20, v53
    s_mul_i32 s21, s9, 147456
    s_waitcnt lgkmcnt(4)
    v_pk_add_f32 v[64:65], v[64:65], v[72:73]
    v_pk_add_f32 v[66:67], v[66:67], v[74:75]
    v_pk_add_f32 v[68:69], v[68:69], v[76:77]
    v_pk_add_f32 v[70:71], v[70:71], v[78:79]
    s_waitcnt lgkmcnt(0)
    v_pk_add_f32 v[80:81], v[80:81], v[88:89]
    v_pk_add_f32 v[82:83], v[82:83], v[90:91]
    v_pk_add_f32 v[84:85], v[84:85], v[92:93]
    v_pk_add_f32 v[86:87], v[86:87], v[94:95]
    v_pk_add_f32 v[64:65], v[64:65], v[80:81]
    v_pk_add_f32 v[66:67], v[66:67], v[82:83]
    v_pk_add_f32 v[68:69], v[68:69], v[84:85]
    v_pk_add_f32 v[70:71], v[70:71], v[86:87]
    v_cvt_pk_bf16_f32 v72, v64, v65
    v_cvt_pk_bf16_f32 v73, v66, v67
    v_cvt_pk_bf16_f32 v74, v68, v69
    v_cvt_pk_bf16_f32 v75, v70, v71
    v_lshlrev_b32 v64, 16, v72
    v_and_b32 v65, s12, v72
    v_lshlrev_b32 v66, 16, v73
    v_and_b32 v67, s12, v73
    v_lshlrev_b32 v68, 16, v74
    v_and_b32 v69, s12, v74
    v_lshlrev_b32 v70, 16, v75
    v_and_b32 v71, s12, v75
    v_mul_f32 v72, 0xbfb8aa3b, v64
    v_exp_f32 v72, v72
    v_mul_f32 v73, 0xbfb8aa3b, v65
    v_exp_f32 v73, v73
    v_mul_f32 v74, 0xbfb8aa3b, v66
    v_exp_f32 v74, v74
    v_mul_f32 v75, 0xbfb8aa3b, v67
    v_exp_f32 v75, v75
    v_add_f32 v72, 1.0, v72
    v_rcp_f32 v72, v72
    v_add_f32 v73, 1.0, v73
    v_rcp_f32 v73, v73
    v_add_f32 v74, 1.0, v74
    v_rcp_f32 v74, v74
    v_add_f32 v75, 1.0, v75
    v_rcp_f32 v75, v75
    v_pk_mul_f32 v[64:65], v[64:65], v[72:73]
    v_pk_mul_f32 v[66:67], v[66:67], v[74:75]
    v_cvt_pk_bf16_f32 v72, v64, v65
    v_cvt_pk_bf16_f32 v73, v66, v67
    v_lshlrev_b32 v64, 16, v72
    v_and_b32 v65, s12, v72
    v_lshlrev_b32 v66, 16, v73
    v_and_b32 v67, s12, v73
    v_pk_mul_f32 v[64:65], v[64:65], v[68:69]
    v_pk_mul_f32 v[66:67], v[66:67], v[70:71]
    v_cvt_pk_bf16_f32 v72, v64, v65
    v_cvt_pk_bf16_f32 v73, v66, v67
    s_nop 0
    v_mov_b32_dpp v74, v72 row_ror:8 row_mask:0xf bank_mask:0xf
    v_mov_b32_dpp v75, v73 row_ror:8 row_mask:0xf bank_mask:0xf
    v_cndmask_b32 v76, v74, v72, s[24:25]
    v_cndmask_b32 v77, v75, v73, s[24:25]
    v_cndmask_b32 v78, v72, v74, s[24:25]
    v_cndmask_b32 v79, v73, v75, s[24:25]
    s_nop 1
    v_mfma_f32_16x16x32_bf16 v[80:83], v[76:79], v[192:195], 0
    v_mfma_f32_16x16x32_bf16 v[84:87], v[76:79], v[196:199], 0
    v_mfma_f32_16x16x32_bf16 v[88:91], v[76:79], v[200:203], 0
    v_mfma_f32_16x16x32_bf16 v[92:95], v[76:79], v[204:207], 0
    v_mfma_f32_16x16x32_bf16 v[96:99], v[76:79], v[208:211], 0
    v_mfma_f32_16x16x32_bf16 v[100:103], v[76:79], v[212:215], 0
    v_mfma_f32_16x16x32_bf16 v[104:107], v[76:79], v[216:219], 0
    v_mfma_f32_16x16x32_bf16 v[108:111], v[76:79], v[220:223], 0
    s_mov_b32 exec_hi, 0
    v_add_u32 v52, s21, v53
    global_store_dwordx4 v52, v[80:83], s[68:69] sc1
    v_add_u32 v52, 36864, v52
    global_store_dwordx4 v52, v[84:87], s[68:69] sc1
    v_add_u32 v52, 36864, v52
    global_store_dwordx4 v52, v[88:91], s[68:69] sc1
    v_add_u32 v52, 36864, v52
    global_store_dwordx4 v52, v[92:95], s[68:69] sc1
    s_add_u32 s21, s21, 589824
    v_add_u32 v52, s21, v53
    global_store_dwordx4 v52, v[96:99], s[68:69] sc1
    v_add_u32 v52, 36864, v52
    global_store_dwordx4 v52, v[100:103], s[68:69] sc1
    v_add_u32 v52, 36864, v52
    global_store_dwordx4 v52, v[104:107], s[68:69] sc1
    v_add_u32 v52, 36864, v52
    global_store_dwordx4 v52, v[108:111], s[68:69] sc1
    s_mov_b32 exec_hi, -1
    s_cmp_lg_u32 s9, 3
    s_cbranch_scc1 NOB8
    v_mfma_f32_16x16x32_bf16 v[80:83], v[76:79], v[224:227], 0
    v_mfma_f32_16x16x32_bf16 v[84:87], v[76:79], v[228:231], 0
    v_mfma_f32_16x16x32_bf16 v[88:91], v[76:79], v[232:235], 0
    v_mfma_f32_16x16x32_bf16 v[92:95], v[76:79], v[236:239], 0
    s_mov_b32 s21, 1179648
    s_mov_b32 exec_hi, 0
    v_add_u32 v52, s21, v53
    s_nop 1
    global_store_dwordx4 v52, v[80:83], s[68:69] sc1
    v_add_u32 v52, 36864, v52
    global_store_dwordx4 v52, v[84:87], s[68:69] sc1
    v_add_u32 v52, 36864, v52
    global_store_dwordx4 v52, v[88:91], s[68:69] sc1
    v_add_u32 v52, 36864, v52
    global_store_dwordx4 v52, v[92:95], s[68:69] sc1
NOB8:
    s_mov_b32 exec_hi, -1
    s_branch S4
S4PRE:
    s_cmp_ge_u32 s5, 18
    s_cbranch_scc1 FIN
    s_barrier
    s_cmp_lg_u32 s3, 0
    s_cbranch_scc1 S4
    s_cmp_ge_u32 s8, 72
    s_cselect_b32 s20, 1, 0
    s_mul_i32 s21, s20, 72
    s_sub_u32 s21, s8, s21
    s_lshr_b32 s23, s21, 3
    s_lshl_b32 s23, s23, 6
    s_and_b32 s24, s21, 1
    s_lshl_b32 s24, s24, 5
    s_add_u32 s23, s23, s24
    s_bfe_u32 s24, s21, 0x20001
    s_add_u32 s23, s23, s24
    s_lshl_b32 s23, s23, 1
    v_and_b32 v52, 7, v1
    v_lshl_add_u32 v52, v52, 3, s23
    v_lshrrev_b32 v53, 4, v1
    v_lshl_add_u32 v53, s20, 2, v53
    v_lshl_add_u32 v54, v53, 2, s22
    ds_read_b32 v40, v54
    v_lshlrev_b32 v44, 2, v53
    ds_bpermute_b32 v44, v44, v66
    s_movk_i32 s20, 1152
    v_mad_u32_u24 v41, v53, s20, v52
    v_add_u32 v41, 22528, v41
    v_add_u32 v42, 13952, v52
    s_movk_i32 s20, 1152
    s_waitcnt lgkmcnt(0)
    v_and_b32 v43, 0x7ff, v40
    v_sub_u32 v43, 2047, v43
    v_mad_u32_u24 v43, v43, s20, v52
    v_add_u32 v44, v44, v52
    v_ashrrev_i32 v45, 31, v40
    v_not_b32 v45, v45
    v_or_b32 v45, 0x80000000, v45
    v_xor_b32 v45, v45, v40
    v_and_b32 v45, s12, v45
    v_mul_f32 v45, 0xbfb8aa3b, v45
    v_exp_f32 v45, v45
    s_nop 0
    v_add_f32 v45, 1.0, v45
    v_rcp_f32 v45, v45
    s_nop 0
    v_cvt_pk_bf16_f32 v45, v45, v45
    v_and_b32 v45, s12, v45
XP:
    global_load_ushort v46, v41, s[68:69] sc1
    global_load_ushort v47, v44, s[68:69] sc1
    global_load_ushort v48, v42, s[68:69] sc1
    s_waitcnt vmcnt(0)
    v_max_u32 v49, v46, v47
    v_cmp_eq_u32 vcc, 0xffff, v49
    s_cbranch_vccz XPD
    s_sub_u32 s10, s10, 1
    s_cbranch_scc1 EXIT
    s_branch XP
XPD:
    v_lshlrev_b32 v46, 16, v46
    v_lshlrev_b32 v47, 16, v47
    v_lshlrev_b32 v48, 16, v48
S4:
    s_mul_i32 s20, s8, 18432
    s_add_u32 s20, s20, 7340032
    v_lshl_add_u32 v52, v0, 4, s20
    v_add_u32 v53, 8192, v52
    v_add_u32 v54, 16384, v52
    v_mov_b32 v72, 0
    v_mov_b32 v73, 0
    v_mov_b32 v74, 0
    v_mov_b32 v75, 0
    v_lshrrev_b32 v55, 4, v1
    v_and_b32 v56, 7, v1
    v_lshl_add_u32 v55, v55, 3, v56
    v_lshlrev_b32 v55, 2, v55
    s_lshl_b32 s20, s3, 7
    v_add_u32 v56, s20, v55
    s_cmp_lg_u32 s3, 1
    s_cbranch_scc1 TRD
    s_mul_i32 s20, s8, 18432
    s_add_u32 s20, s20, 7348224
    v_mov_b32 v57, s20
TRP:
    global_load_dword v58, v57, s[68:69] sc1
    s_waitcnt vmcnt(0)
    v_cmp_eq_u32 vcc, -1, v58
    s_cbranch_vccz TRD
    s_sub_u32 s10, s10, 1
    s_cbranch_scc1 EXIT
    s_branch TRP
TRD:
    s_barrier
PP:
    global_load_dwordx4 v[64:67], v52, s[68:69] sc1
    global_load_dwordx4 v[68:71], v53, s[68:69] sc1
    s_cmp_ge_u32 s3, 2
    s_cbranch_scc1 PP2
    global_load_dwordx4 v[72:75], v54, s[68:69] sc1
PP2:
    s_waitcnt vmcnt(0)
    v_max3_u32 v76, v64, v65, v66
    v_max3_u32 v76, v76, v67, v68
    v_max3_u32 v76, v76, v69, v70
    v_max3_u32 v76, v76, v71, v72
    v_max3_u32 v76, v76, v73, v74
    v_max_u32 v76, v76, v75
    v_cmp_eq_u32 vcc, -1, v76
    s_cbranch_vccz PPD
    s_sub_u32 s10, s10, 1
    s_cbranch_scc1 EXIT
    s_branch PP
PPD:
    v_pk_add_f32 v[64:65], v[64:65], v[68:69]
    v_pk_add_f32 v[66:67], v[66:67], v[70:71]
    v_pk_add_f32 v[64:65], v[64:65], v[72:73]
    v_pk_add_f32 v[66:67], v[66:67], v[74:75]
    s_nop 1
    v_permlane32_swap_b32 v64, v66
    v_permlane32_swap_b32 v65, v67
    v_pk_add_f32 v[64:65], v[64:65], v[66:67]
    s_nop 1
    v_permlane16_swap_b32 v64, v65
    v_add_f32 v64, v64, v65
    s_nop 1
    v_add_f32_dpp v64, v64, v64 row_ror:8 row_mask:0xf bank_mask:0xf
    s_mov_b32 exec_lo, 0x00ff00ff
    s_mov_b32 exec_hi, 0x00ff00ff
    ds_write_b32 v56, v64 offset:26624
    s_waitcnt lgkmcnt(0)
    s_barrier
    s_cmp_lg_u32 s3, 0
    s_cbranch_scc1 FIN
    ds_read_b32 v64, v55 offset:26624
    ds_read_b32 v65, v55 offset:26752
    ds_read_b32 v66, v55 offset:26880
    ds_read_b32 v67, v55 offset:27008
    ds_read_b32 v68, v55 offset:27136
    ds_read_b32 v69, v55 offset:27264
    ds_read_b32 v70, v55 offset:27392
    ds_read_b32 v71, v55 offset:27520
    s_waitcnt lgkmcnt(0)
    v_pk_add_f32 v[64:65], v[64:65], v[68:69]
    v_pk_add_f32 v[66:67], v[66:67], v[70:71]
    v_pk_add_f32 v[64:65], v[64:65], v[66:67]
    v_add_f32 v64, v64, v65
    v_cvt_pk_bf16_f32 v64, v64, v64
    v_and_b32 v64, s12, v64
    v_mul_f32 v64, v64, v45
    v_cvt_pk_bf16_f32 v64, v64, v64
    v_and_b32 v64, s12, v64
    v_add_f32 v64, v64, v47
    v_cvt_pk_bf16_f32 v64, v64, v64
    v_and_b32 v64, s12, v64
    v_mul_f32 v64, v64, v48
    v_cvt_pk_bf16_f32 v64, v64, v64
    v_and_b32 v64, s12, v64
    v_add_f32 v64, v64, v46
    v_cvt_pk_bf16_f32 v64, v64, v64
    global_store_short v43, v64, s[64:65] sc1
FIN:
EXIT:
    s_endpgm
CODE_END:
.section .rodata,"a"
.p2align 6
.amdhsa_kernel adaLN_cond__ssm_conv_s4d__moe_arch_mod__prompt_kernel
  .amdhsa_next_free_vgpr 256
  .amdhsa_next_free_sgpr 102
  .amdhsa_accum_offset 256
  .amdhsa_group_segment_fixed_size 0
  .amdhsa_kernarg_size 136
  .amdhsa_user_sgpr_count 2
  .amdhsa_user_sgpr_kernarg_segment_ptr 1
  .amdhsa_system_sgpr_workgroup_id_x 1
.end_amdhsa_kernel
```

```asm
; @launch grid=(256,1,1) block=(512,1,1) lds=163456
.amdgcn_target "amdgcn-amd-amdhsa--gfx950"
.text
.globl adaLN_cond__ssm_conv_s4d__moe_arch_mod__prompt_kernel
.p2align 8
.type adaLN_cond__ssm_conv_s4d__moe_arch_mod__prompt_kernel,@function
adaLN_cond__ssm_conv_s4d__moe_arch_mod__prompt_kernel:
    s_cmp_ge_u32 s2, 256
    s_cbranch_scc1 EXIT
    s_load_dwordx16 s[36:51], s[0:1], 0
    s_load_dwordx16 s[52:67], s[0:1], 64
    s_load_dwordx2 s[68:69], s[0:1], 128
    v_lshrrev_b32 v2, 6, v0
    v_and_b32 v1, 63, v0
    v_readfirstlane_b32 s3, v2
    s_and_b32 s4, s2, 7
    s_lshr_b32 s5, s2, 3
    s_mul_i32 s6, s4, 18
    s_add_u32 s6, s6, s5
    s_sub_u32 s20, s5, 18
    s_and_b32 s21, s20, 1
    s_lshr_b32 s20, s20, 1
    s_lshl_b32 s20, s20, 4
    s_lshl1_add_u32 s7, s4, s21
    s_add_u32 s7, s7, s20
    s_and_b32 s9, s3, 3
    s_mov_b32 s8, s6
    s_cmp_lt_u32 s5, 18
    s_cselect_b32 s13, 1, 0
    s_cmp_ge_u32 s3, 4
    s_cselect_b32 s13, s13, 0
    s_mov_b32 s10, 0x20000
    s_mov_b32 s12, 0xffff0000
    s_lshl_b32 s11, s2, 3
    s_add_u32 s11, s11, s3
    v_lshlrev_b32 v7, 4, v1
    v_lshlrev_b32 v13, 1, v1
    v_add_u32 v13, 1024, v13
    s_cmp_lt_u32 s3, 4
    s_cbranch_scc1 ENT_A
ENT_B:
    s_cmp_lg_u32 s3, 4
    s_cbranch_scc1 ENT_B2
    v_lshlrev_b32 v64, 2, v1
    v_add_u32 v64, 143488, v64
    v_cmp_gt_u32 vcc, 16, v1
    s_nop 1
    v_cndmask_b32 v65, -1, 0, vcc
    s_mov_b32 exec_hi, 0
    ds_write_b32 v64, v65
    s_mov_b32 exec_hi, -1
ENT_B2:
    s_cmp_ge_u32 s5, 18
    s_cbranch_scc0 CONV_B
    s_branch NONCONV
ENT_A:
    s_cmp_lg_u32 s3, 3
    s_cbranch_scc1 ENT_A2
    s_getpc_b64 s[20:21]
PCREF:
    s_lshl_b32 s22, s5, 10
    v_add_u32 v64, s22, v7
    v_min_u32 v64, CODE_END-PCREF-16, v64
    v_mov_b32 v65, 0
    v_lshl_add_u64 v[64:65], v[64:65], 0, s[20:21]
    global_load_dwordx4 v[240:243], v[64:65], off
ENT_A2:
    s_cmp_ge_u32 s5, 18
    s_cbranch_scc1 NONCONV
    s_lshl_b32 s20, s6, 2
    s_add_u32 s20, s20, s3
    s_lshl_b32 s21, s20, 8
    v_lshl_add_u32 v64, v1, 2, s21
    s_lshl_b32 s14, s20, 1
    v_mov_b32 v65, s14
    s_mul_i32 s15, s3, 31232
    s_waitcnt lgkmcnt(0)
    global_load_ushort v70, v65, s[46:47]
    global_load_dword v66, v64, s[38:39] nt
    global_load_dword v67, v64, s[40:41] nt
    global_load_dword v68, v64, s[42:43] nt
    global_load_dword v69, v64, s[44:45] nt
    global_load_ushort v71, v65, s[48:49]
    global_load_dwordx4 v[8:11], v7, s[52:53]
    global_load_ushort v12, v13, s[52:53]
    s_barrier
    s_load_dword s99, s[68:69], 94208
    v_lshl_add_u32 v224, v1, 3, s15
    v_bfe_u32 v72, v1, 2, 3
    v_mov_b32 v73, 0
    v_cmp_eq_u32 vcc, 0, v72
    v_mov_b32 v74, 0x3020100
    s_nop 0
    v_cndmask_b32 v73, v73, v74, vcc
    v_cmp_eq_u32 vcc, 1, v72
    v_mov_b32 v74, 0x6050404
    s_nop 0
    v_cndmask_b32 v73, v73, v74, vcc
    v_cmp_eq_u32 vcc, 2, v72
    v_mov_b32 v74, 0xa090807
    s_nop 0
    v_cndmask_b32 v73, v73, v74, vcc
    v_cmp_eq_u32 vcc, 3, v72
    v_mov_b32 v74, 0xc0b0606
    s_nop 0
    v_cndmask_b32 v73, v73, v74, vcc
    v_cmp_eq_u32 vcc, 4, v72
    v_mov_b32 v74, 0xf0f0e0d
    s_nop 0
    v_cndmask_b32 v73, v73, v74, vcc
    v_cmp_eq_u32 vcc, 5, v72
    v_mov_b32 v74, 0x12121110
    s_nop 0
    v_cndmask_b32 v73, v73, v74, vcc
    v_cmp_eq_u32 vcc, 6, v72
    v_mov_b32 v74, 0x16151413
    s_nop 0
    v_cndmask_b32 v73, v73, v74, vcc
    v_cmp_eq_u32 vcc, 7, v72
    v_mov_b32 v74, 0x1a191817
    s_nop 0
    v_cndmask_b32 v73, v73, v74, vcc
    v_and_b32 v72, 3, v1
    v_lshlrev_b32 v72, 3, v72
    v_bfe_u32 v73, v73, v72, 8
    v_lshrrev_b32 v72, 5, v1
    v_lshl_add_u32 v72, v72, 4, s15
    s_movk_i32 s20, 528
    v_mad_u32_u24 v225, v73, s20, v72
    v_and_b32 v73, 31, v1
    v_add_u32 v73, 27, v73
    v_mad_u32_u24 v226, v73, s20, v72
    v_lshlrev_b32 v72, 4, v1
    v_sub_u32 v227, 1008, v72
    v_add_u32 v227, s15, v227
    v_and_b32 v72, 3, v1
    v_sub_u32 v72, 3, v72
    s_movk_i32 s20, 4160
    v_mul_u32_u24 v72, s20, v72
    v_bfe_u32 v73, v1, 2, 2
    v_sub_u32 v73, 3, v73
    v_lshl_add_u32 v72, v73, 3, v72
    v_lshrrev_b32 v73, 4, v1
    v_lshl_add_u32 v72, v73, 4, v72
    v_add_u32 v228, s15, v72
    v_and_b32 v72, 15, v1
    v_lshlrev_b32 v72, 5, v72
    v_lshl_add_u32 v74, v73, 4, v72
    s_mul_i32 s20, s3, 4640
    s_add_u32 s20, s20, 124928
    v_add_u32 v229, s20, v74
    v_lshl_add_u32 v74, v73, 3, v72
    s_lshl_b32 s20, s3, 6
    s_add_u32 s20, s20, s15
    v_add_u32 v230, s20, v74
    s_mov_b32 s16, 0x3fb8aa3b
    s_mov_b32 s17, 0x3e22f983
    s_waitcnt vmcnt(6)
    v_lshlrev_b32 v70, 16, v70
    v_mul_f32 v70, s16, v70
    v_exp_f32 v70, v70
    v_lshlrev_b32 v74, 16, v66
    v_and_b32 v75, s12, v66
    v_mul_f32 v74, s16, v74
    v_mul_f32 v75, s16, v75
    v_exp_f32 v74, v74
    v_exp_f32 v75, v75
    v_cvt_pk_bf16_f32 v70, v70, v70
    v_and_b32 v70, s12, v70
    v_cvt_pk_bf16_f32 v74, v74, v75
    v_and_b32 v75, s12, v74
    v_lshlrev_b32 v74, 16, v74
    v_mul_f32 v74, v74, v70
    v_mul_f32 v75, v75, v70
    v_mul_f32 v74, 0xbfb8aa3b, v74
    v_mul_f32 v75, 0xbfb8aa3b, v75
    s_waitcnt vmcnt(5)
    v_lshlrev_b32 v76, 16, v67
    v_and_b32 v77, s12, v67
    v_mul_f32 v76, v76, v70
    v_mul_f32 v77, v77, v70
    v_mul_f32 v76, s17, v76
    v_mul_f32 v77, s17, v77
    v_exp_f32 v96, v74
    v_fract_f32 v97, v76
    v_cos_f32 v98, v97
    v_sin_f32 v99, v97
    v_exp_f32 v100, v75
    v_fract_f32 v101, v77
    v_cos_f32 v102, v101
    v_sin_f32 v103, v101
    v_mul_f32 v84, v96, v98
    v_mul_f32 v86, v96, v99
    v_mul_f32 v85, v100, v102
    v_mul_f32 v87, v100, v103
    v_mul_f32 v96, 0x41000000, v74
    v_mul_f32 v97, 0x41000000, v76
    v_exp_f32 v96, v96
    v_fract_f32 v97, v97
    v_cos_f32 v98, v97
    v_sin_f32 v99, v97
    v_mul_f32 v100, 0x41000000, v75
    v_mul_f32 v101, 0x41000000, v77
    v_exp_f32 v100, v100
    v_fract_f32 v101, v101
    v_cos_f32 v102, v101
    v_sin_f32 v103, v101
    v_mul_f32 v88, v96, v98
    v_mul_f32 v90, v96, v99
    v_mul_f32 v89, v100, v102
    v_mul_f32 v91, v100, v103
    v_mul_f32 v96, 0x43800000, v74
    v_mul_f32 v97, 0x43800000, v76
    v_exp_f32 v96, v96
    v_fract_f32 v97, v97
    v_cos_f32 v98, v97
    v_sin_f32 v99, v97
    v_mul_f32 v100, 0x43800000, v75
    v_mul_f32 v101, 0x43800000, v77
    v_exp_f32 v100, v100
    v_fract_f32 v101, v101
    v_cos_f32 v102, v101
    v_sin_f32 v103, v101
    v_mul_f32 v92, v96, v98
    v_mul_f32 v94, v96, v99
    v_mul_f32 v93, v100, v102
    v_mul_f32 v95, v100, v103
    s_waitcnt vmcnt(2)
    v_lshlrev_b32 v78, 16, v68
    v_and_b32 v79, s12, v68
    v_lshlrev_b32 v80, 16, v69
    v_and_b32 v81, s12, v69
    v_max_f32 v82, |v78|, |v79|
    v_max3_f32 v82, |v80|, |v81|, v82
    s_nop 1
    v_max_f32_dpp v82, v82, v82 row_ror:8 row_mask:0xf bank_mask:0xf
    s_nop 1
    v_max_f32_dpp v82, v82, v82 row_ror:4 row_mask:0xf bank_mask:0xf
    s_nop 1
    v_max_f32_dpp v82, v82, v82 row_ror:2 row_mask:0xf bank_mask:0xf
    s_nop 1
    v_max_f32_dpp v82, v82, v82 row_ror:1 row_mask:0xf bank_mask:0xf
    v_mov_b32 v83, v82
    s_nop 1
    v_permlane16_swap_b32 v82, v83
    v_max_f32 v82, v82, v83
    v_mov_b32 v83, v82
    s_nop 1
    v_permlane32_swap_b32 v82, v83
    v_max_f32 v82, v82, v83
    v_max_f32 v82, 0x0da24260, v82
    v_rcp_f32 v83, v82
    v_lshlrev_b32 v71, 16, v71
    v_mul_f32 v82, v82, v70
    v_add_f32 v82, v82, v82
    v_and_b32 v72, 0x7fffffff, v71
    v_mul_f32 v72, 0x3a800000, v72
    v_max_f32 v72, v72, v82
    v_max_f32 v72, 0x0da24260, v72
    v_rcp_f32 v73, v72
    v_mov_b32 v233, v72
    v_mul_f32 v231, v82, v73
    v_mul_f32 v232, v71, v73
    v_pk_mul_f32 v[104:105], v[78:79], v[82:83] op_sel:[0,1] op_sel_hi:[1,1]
    v_pk_mul_f32 v[106:107], v[80:81], v[82:83] op_sel:[0,1] op_sel_hi:[1,1]
    v_mov_b32 v148, 0x3c00
    v_cvt_pk_f16_f32 v144, v104, v106
    v_mov_b32 v149, 0x3c00
    v_cvt_pk_f16_f32 v145, v105, v107
    ds_write_b64 v224, v[148:149] offset:14256
    ds_write_b64 v224, v[144:145] offset:0
    v_pk_mul_f32 v[128:129], v[88:89], 1.0 op_sel_hi:[1,0]
    v_pk_mul_f32 v[136:137], v[106:107], v[86:87]
    v_pk_mul_f32 v[130:131], v[90:91], -1.0 op_sel_hi:[1,0]
    v_pk_mul_f32 v[138:139], v[106:107], v[84:85]
    v_cvt_pk_f16_f32 v150, v128, v130
    v_pk_fma_f32 v[126:127], v[104:105], v[86:87], v[138:139]
    v_cvt_pk_f16_f32 v151, v129, v131
    v_pk_fma_f32 v[124:125], v[104:105], v[84:85], v[136:137] neg_lo:[0,0,1] neg_hi:[0,0,1]
    ds_write_b64 v224, v[150:151] offset:14784
    v_cvt_pk_f16_f32 v146, v124, v126
    v_pk_mul_f32 v[140:141], v[130:131], v[90:91]
    v_cvt_pk_f16_f32 v147, v125, v127
    v_pk_mul_f32 v[142:143], v[130:131], v[88:89]
    ds_write_b64 v224, v[146:147] offset:528
    v_pk_fma_f32 v[130:131], v[128:129], v[90:91], v[142:143] neg_lo:[0,1,0] neg_hi:[0,1,0]
    v_pk_mul_f32 v[136:137], v[126:127], v[86:87]
    v_pk_fma_f32 v[128:129], v[128:129], v[88:89], v[140:141]
    v_pk_mul_f32 v[138:139], v[126:127], v[84:85]
    v_cvt_pk_f16_f32 v148, v128, v130
    v_pk_fma_f32 v[110:111], v[124:125], v[86:87], v[138:139]
    v_cvt_pk_f16_f32 v149, v129, v131
    v_pk_fma_f32 v[108:109], v[124:125], v[84:85], v[136:137] neg_lo:[0,0,1] neg_hi:[0,0,1]
    ds_write_b64 v224, v[148:149] offset:15312
    v_cvt_pk_f16_f32 v144, v108, v110
    v_pk_mul_f32 v[140:141], v[130:131], v[90:91]
    v_cvt_pk_f16_f32 v145, v109, v111
    v_pk_mul_f32 v[142:143], v[130:131], v[88:89]
    ds_write_b64 v224, v[144:145] offset:1056
    v_pk_fma_f32 v[130:131], v[128:129], v[90:91], v[142:143] neg_lo:[0,1,0] neg_hi:[0,1,0]
    v_pk_mul_f32 v[136:137], v[110:111], v[86:87]
    v_pk_fma_f32 v[128:129], v[128:129], v[88:89], v[140:141]
    v_pk_mul_f32 v[138:139], v[110:111], v[84:85]
    v_cvt_pk_f16_f32 v150, v128, v130
    v_pk_fma_f32 v[126:127], v[108:109], v[86:87], v[138:139]
    v_cvt_pk_f16_f32 v151, v129, v131
    v_pk_fma_f32 v[124:125], v[108:109], v[84:85], v[136:137] neg_lo:[0,0,1] neg_hi:[0,0,1]
    ds_write_b64 v224, v[150:151] offset:15840
    v_cvt_pk_f16_f32 v146, v124, v126
    v_pk_mul_f32 v[140:141], v[130:131], v[90:91]
    v_cvt_pk_f16_f32 v147, v125, v127
    v_pk_mul_f32 v[142:143], v[130:131], v[88:89]
    ds_write_b64 v224, v[146:147] offset:1584
    v_pk_fma_f32 v[130:131], v[128:129], v[90:91], v[142:143] neg_lo:[0,1,0] neg_hi:[0,1,0]
    v_pk_mul_f32 v[136:137], v[126:127], v[86:87]
    v_pk_fma_f32 v[128:129], v[128:129], v[88:89], v[140:141]
    v_pk_mul_f32 v[138:139], v[126:127], v[84:85]
    v_cvt_pk_f16_f32 v148, v128, v130
    v_pk_fma_f32 v[114:115], v[124:125], v[86:87], v[138:139]
    v_cvt_pk_f16_f32 v149, v129, v131
    v_pk_fma_f32 v[112:113], v[124:125], v[84:85], v[136:137] neg_lo:[0,0,1] neg_hi:[0,0,1]
    ds_write_b64 v224, v[148:149] offset:16368
    v_cvt_pk_f16_f32 v144, v112, v114
    v_pk_mul_f32 v[140:141], v[130:131], v[90:91]
    v_cvt_pk_f16_f32 v145, v113, v115
    v_pk_mul_f32 v[142:143], v[130:131], v[88:89]
    ds_write_b64 v224, v[144:145] offset:3696
    v_pk_fma_f32 v[130:131], v[128:129], v[90:91], v[142:143] neg_lo:[0,1,0] neg_hi:[0,1,0]
    v_pk_mul_f32 v[136:137], v[114:115], v[86:87]
    v_pk_fma_f32 v[128:129], v[128:129], v[88:89], v[140:141]
    v_pk_mul_f32 v[138:139], v[114:115], v[84:85]
    v_cvt_pk_f16_f32 v150, v128, v130
    v_pk_fma_f32 v[126:127], v[112:113], v[86:87], v[138:139]
    v_cvt_pk_f16_f32 v151, v129, v131
    v_pk_fma_f32 v[124:125], v[112:113], v[84:85], v[136:137] neg_lo:[0,0,1] neg_hi:[0,0,1]
    ds_write_b64 v224, v[150:151] offset:16896
    v_cvt_pk_f16_f32 v146, v124, v126
    v_pk_mul_f32 v[140:141], v[130:131], v[90:91]
    v_cvt_pk_f16_f32 v147, v125, v127
    v_pk_mul_f32 v[142:143], v[130:131], v[88:89]
    ds_write_b64 v224, v[146:147] offset:4224
    v_pk_fma_f32 v[130:131], v[128:129], v[90:91], v[142:143] neg_lo:[0,1,0] neg_hi:[0,1,0]
    v_pk_mul_f32 v[136:137], v[126:127], v[86:87]
    v_pk_fma_f32 v[128:129], v[128:129], v[88:89], v[140:141]
    v_pk_mul_f32 v[138:139], v[126:127], v[84:85]
    v_cvt_pk_f16_f32 v148, v128, v130
    v_pk_fma_f32 v[118:119], v[124:125], v[86:87], v[138:139]
    v_cvt_pk_f16_f32 v149, v129, v131
    v_pk_fma_f32 v[116:117], v[124:125], v[84:85], v[136:137] neg_lo:[0,0,1] neg_hi:[0,0,1]
    ds_write_b64 v224, v[148:149] offset:17424
    v_cvt_pk_f16_f32 v144, v116, v118
    v_pk_mul_f32 v[140:141], v[130:131], v[90:91]
    v_cvt_pk_f16_f32 v145, v117, v119
    v_pk_mul_f32 v[142:143], v[130:131], v[88:89]
    ds_write_b64 v224, v[144:145] offset:4752
    v_pk_fma_f32 v[130:131], v[128:129], v[90:91], v[142:143] neg_lo:[0,1,0] neg_hi:[0,1,0]
    v_pk_mul_f32 v[136:137], v[118:119], v[86:87]
    v_pk_fma_f32 v[128:129], v[128:129], v[88:89], v[140:141]
    v_pk_mul_f32 v[138:139], v[118:119], v[84:85]
    v_cvt_pk_f16_f32 v150, v128, v130
    v_pk_fma_f32 v[126:127], v[116:117], v[86:87], v[138:139]
    v_cvt_pk_f16_f32 v151, v129, v131
    v_pk_fma_f32 v[124:125], v[116:117], v[84:85], v[136:137] neg_lo:[0,0,1] neg_hi:[0,0,1]
    ds_write_b64 v224, v[150:151] offset:17952
    v_cvt_pk_f16_f32 v146, v124, v126
    v_pk_mul_f32 v[140:141], v[130:131], v[90:91]
    v_cvt_pk_f16_f32 v147, v125, v127
    v_pk_mul_f32 v[142:143], v[130:131], v[88:89]
    ds_write_b64 v224, v[146:147] offset:5280
    v_pk_fma_f32 v[130:131], v[128:129], v[90:91], v[142:143] neg_lo:[0,1,0] neg_hi:[0,1,0]
    v_pk_mul_f32 v[136:137], v[126:127], v[86:87]
    v_pk_fma_f32 v[128:129], v[128:129], v[88:89], v[140:141]
    v_pk_mul_f32 v[138:139], v[126:127], v[84:85]
    v_cvt_pk_f16_f32 v148, v128, v130
    v_pk_fma_f32 v[122:123], v[124:125], v[86:87], v[138:139]
    v_cvt_pk_f16_f32 v149, v129, v131
    v_pk_fma_f32 v[120:121], v[124:125], v[84:85], v[136:137] neg_lo:[0,0,1] neg_hi:[0,0,1]
    ds_write_b64 v224, v[148:149] offset:18480
    v_pk_mul_f32 v[136:137], v[106:107], v[94:95]
    v_pk_mul_f32 v[140:141], v[130:131], v[90:91]
    v_pk_mul_f32 v[138:139], v[106:107], v[92:93]
    v_pk_mul_f32 v[142:143], v[130:131], v[88:89]
    v_pk_fma_f32 v[106:107], v[104:105], v[94:95], v[138:139]
    v_pk_fma_f32 v[130:131], v[128:129], v[90:91], v[142:143] neg_lo:[0,1,0] neg_hi:[0,1,0]
    v_pk_fma_f32 v[104:105], v[104:105], v[92:93], v[136:137] neg_lo:[0,0,1] neg_hi:[0,0,1]
    v_pk_fma_f32 v[128:129], v[128:129], v[88:89], v[140:141]
    v_cvt_pk_f16_f32 v146, v104, v106
    v_cvt_pk_f16_f32 v150, v128, v130
    v_cvt_pk_f16_f32 v147, v105, v107
    v_cvt_pk_f16_f32 v151, v129, v131
    ds_write_b64 v224, v[146:147] offset:2112
    ds_write_b64 v224, v[150:151] offset:19008
    v_pk_mul_f32 v[136:137], v[110:111], v[94:95]
    v_pk_mul_f32 v[140:141], v[130:131], v[90:91]
    v_pk_mul_f32 v[138:139], v[110:111], v[92:93]
    v_pk_mul_f32 v[142:143], v[130:131], v[88:89]
    v_pk_fma_f32 v[110:111], v[108:109], v[94:95], v[138:139]
    v_pk_fma_f32 v[130:131], v[128:129], v[90:91], v[142:143] neg_lo:[0,1,0] neg_hi:[0,1,0]
    v_pk_fma_f32 v[108:109], v[108:109], v[92:93], v[136:137] neg_lo:[0,0,1] neg_hi:[0,0,1]
    v_pk_fma_f32 v[128:129], v[128:129], v[88:89], v[140:141]
    v_cvt_pk_f16_f32 v144, v108, v110
    v_cvt_pk_f16_f32 v148, v128, v130
    v_cvt_pk_f16_f32 v145, v109, v111
    v_cvt_pk_f16_f32 v149, v129, v131
    ds_write_b64 v224, v[144:145] offset:2640
    ds_write_b64 v224, v[148:149] offset:19536
    v_pk_mul_f32 v[136:137], v[114:115], v[94:95]
    v_pk_mul_f32 v[140:141], v[130:131], v[90:91]
    v_pk_mul_f32 v[138:139], v[114:115], v[92:93]
    v_pk_mul_f32 v[142:143], v[130:131], v[88:89]
    v_pk_fma_f32 v[114:115], v[112:113], v[94:95], v[138:139]
    v_pk_fma_f32 v[130:131], v[128:129], v[90:91], v[142:143] neg_lo:[0,1,0] neg_hi:[0,1,0]
    v_pk_fma_f32 v[112:113], v[112:113], v[92:93], v[136:137] neg_lo:[0,0,1] neg_hi:[0,0,1]
    v_pk_fma_f32 v[128:129], v[128:129], v[88:89], v[140:141]
    v_cvt_pk_f16_f32 v146, v112, v114
    v_cvt_pk_f16_f32 v150, v128, v130
    v_cvt_pk_f16_f32 v147, v113, v115
    v_cvt_pk_f16_f32 v151, v129, v131
    ds_write_b64 v224, v[146:147] offset:3168
    ds_write_b64 v224, v[150:151] offset:20064
    v_pk_mul_f32 v[136:137], v[118:119], v[94:95]
    v_pk_mul_f32 v[140:141], v[130:131], v[90:91]
    v_pk_mul_f32 v[138:139], v[118:119], v[92:93]
    v_pk_mul_f32 v[142:143], v[130:131], v[88:89]
    v_pk_fma_f32 v[118:119], v[116:117], v[94:95], v[138:139]
    v_pk_fma_f32 v[130:131], v[128:129], v[90:91], v[142:143] neg_lo:[0,1,0] neg_hi:[0,1,0]
    v_pk_fma_f32 v[116:117], v[116:117], v[92:93], v[136:137] neg_lo:[0,0,1] neg_hi:[0,0,1]
    v_pk_fma_f32 v[128:129], v[128:129], v[88:89], v[140:141]
    v_cvt_pk_f16_f32 v144, v116, v118
    v_cvt_pk_f16_f32 v148, v128, v130
    v_cvt_pk_f16_f32 v145, v117, v119
    v_cvt_pk_f16_f32 v149, v129, v131
    ds_write_b64 v224, v[144:145] offset:5808
    ds_write_b64 v224, v[148:149] offset:20592
    v_pk_mul_f32 v[136:137], v[122:123], v[94:95]
    v_pk_mul_f32 v[140:141], v[130:131], v[90:91]
    v_pk_mul_f32 v[138:139], v[122:123], v[92:93]
    v_pk_mul_f32 v[142:143], v[130:131], v[88:89]
    v_pk_fma_f32 v[122:123], v[120:121], v[94:95], v[138:139]
    v_pk_fma_f32 v[130:131], v[128:129], v[90:91], v[142:143] neg_lo:[0,1,0] neg_hi:[0,1,0]
    v_pk_fma_f32 v[120:121], v[120:121], v[92:93], v[136:137] neg_lo:[0,0,1] neg_hi:[0,0,1]
    v_pk_fma_f32 v[128:129], v[128:129], v[88:89], v[140:141]
    v_cvt_pk_f16_f32 v146, v120, v122
    v_cvt_pk_f16_f32 v150, v128, v130
    v_cvt_pk_f16_f32 v147, v121, v123
    v_cvt_pk_f16_f32 v151, v129, v131
    ds_write_b64 v224, v[146:147] offset:6336
    ds_write_b64 v224, v[150:151] offset:21120
    v_pk_mul_f32 v[136:137], v[106:107], v[94:95]
    v_pk_mul_f32 v[140:141], v[130:131], v[90:91]
    v_pk_mul_f32 v[138:139], v[106:107], v[92:93]
    v_pk_mul_f32 v[142:143], v[130:131], v[88:89]
    v_pk_fma_f32 v[106:107], v[104:105], v[94:95], v[138:139]
    v_pk_fma_f32 v[130:131], v[128:129], v[90:91], v[142:143] neg_lo:[0,1,0] neg_hi:[0,1,0]
    v_pk_fma_f32 v[104:105], v[104:105], v[92:93], v[136:137] neg_lo:[0,0,1] neg_hi:[0,0,1]
    v_pk_fma_f32 v[128:129], v[128:129], v[88:89], v[140:141]
    v_cvt_pk_f16_f32 v144, v104, v106
    v_cvt_pk_f16_f32 v148, v128, v130
    v_cvt_pk_f16_f32 v145, v105, v107
    v_cvt_pk_f16_f32 v149, v129, v131
    ds_write_b64 v224, v[144:145] offset:6864
    ds_write_b64 v224, v[148:149] offset:21648
    v_pk_mul_f32 v[136:137], v[114:115], v[94:95]
    v_pk_mul_f32 v[140:141], v[130:131], v[90:91]
    v_pk_mul_f32 v[138:139], v[114:115], v[92:93]
    v_pk_mul_f32 v[142:143], v[130:131], v[88:89]
    v_pk_fma_f32 v[114:115], v[112:113], v[94:95], v[138:139]
    v_pk_fma_f32 v[130:131], v[128:129], v[90:91], v[142:143] neg_lo:[0,1,0] neg_hi:[0,1,0]
    v_pk_fma_f32 v[112:113], v[112:113], v[92:93], v[136:137] neg_lo:[0,0,1] neg_hi:[0,0,1]
    v_pk_fma_f32 v[128:129], v[128:129], v[88:89], v[140:141]
    v_cvt_pk_f16_f32 v146, v112, v114
    v_cvt_pk_f16_f32 v150, v128, v130
    v_cvt_pk_f16_f32 v147, v113, v115
    v_cvt_pk_f16_f32 v151, v129, v131
    ds_write_b64 v224, v[146:147] offset:7392
    ds_write_b64 v224, v[150:151] offset:22176
    v_pk_mul_f32 v[136:137], v[122:123], v[94:95]
    v_pk_mul_f32 v[140:141], v[130:131], v[90:91]
    v_pk_mul_f32 v[138:139], v[122:123], v[92:93]
    v_pk_mul_f32 v[142:143], v[130:131], v[88:89]
    v_pk_fma_f32 v[122:123], v[120:121], v[94:95], v[138:139]
    v_pk_fma_f32 v[130:131], v[128:129], v[90:91], v[142:143] neg_lo:[0,1,0] neg_hi:[0,1,0]
    v_pk_fma_f32 v[120:121], v[120:121], v[92:93], v[136:137] neg_lo:[0,0,1] neg_hi:[0,0,1]
    v_pk_fma_f32 v[128:129], v[128:129], v[88:89], v[140:141]
    v_cvt_pk_f16_f32 v144, v120, v122
    v_cvt_pk_f16_f32 v148, v128, v130
    v_cvt_pk_f16_f32 v145, v121, v123
    v_cvt_pk_f16_f32 v149, v129, v131
    ds_write_b64 v224, v[144:145] offset:7920
    ds_write_b64 v224, v[148:149] offset:22704
    v_pk_mul_f32 v[136:137], v[106:107], v[94:95]
    v_pk_mul_f32 v[140:141], v[130:131], v[90:91]
    v_pk_mul_f32 v[138:139], v[106:107], v[92:93]
    v_pk_mul_f32 v[142:143], v[130:131], v[88:89]
    v_pk_fma_f32 v[106:107], v[104:105], v[94:95], v[138:139]
    v_pk_fma_f32 v[130:131], v[128:129], v[90:91], v[142:143] neg_lo:[0,1,0] neg_hi:[0,1,0]
    v_pk_fma_f32 v[104:105], v[104:105], v[92:93], v[136:137] neg_lo:[0,0,1] neg_hi:[0,0,1]
    v_pk_fma_f32 v[128:129], v[128:129], v[88:89], v[140:141]
    v_cvt_pk_f16_f32 v146, v104, v106
    v_cvt_pk_f16_f32 v150, v128, v130
    v_cvt_pk_f16_f32 v147, v105, v107
    v_cvt_pk_f16_f32 v151, v129, v131
    ds_write_b64 v224, v[146:147] offset:8448
    ds_write_b64 v224, v[150:151] offset:23232
    v_pk_mul_f32 v[136:137], v[114:115], v[94:95]
    v_pk_mul_f32 v[140:141], v[130:131], v[90:91]
    v_pk_mul_f32 v[138:139], v[114:115], v[92:93]
    v_pk_mul_f32 v[142:143], v[130:131], v[88:89]
    v_pk_fma_f32 v[114:115], v[112:113], v[94:95], v[138:139]
    v_pk_fma_f32 v[130:131], v[128:129], v[90:91], v[142:143] neg_lo:[0,1,0] neg_hi:[0,1,0]
    v_pk_fma_f32 v[112:113], v[112:113], v[92:93], v[136:137] neg_lo:[0,0,1] neg_hi:[0,0,1]
    v_pk_fma_f32 v[128:129], v[128:129], v[88:89], v[140:141]
    v_cvt_pk_f16_f32 v144, v112, v114
    v_cvt_pk_f16_f32 v148, v128, v130
    v_cvt_pk_f16_f32 v145, v113, v115
    v_cvt_pk_f16_f32 v149, v129, v131
    ds_write_b64 v224, v[144:145] offset:8976
    ds_write_b64 v224, v[148:149] offset:23760
    v_pk_mul_f32 v[136:137], v[122:123], v[94:95]
    v_pk_mul_f32 v[140:141], v[130:131], v[90:91]
    v_pk_mul_f32 v[138:139], v[122:123], v[92:93]
    v_pk_mul_f32 v[142:143], v[130:131], v[88:89]
    v_pk_fma_f32 v[122:123], v[120:121], v[94:95], v[138:139]
    v_pk_fma_f32 v[130:131], v[128:129], v[90:91], v[142:143] neg_lo:[0,1,0] neg_hi:[0,1,0]
    v_pk_fma_f32 v[120:121], v[120:121], v[92:93], v[136:137] neg_lo:[0,0,1] neg_hi:[0,0,1]
    v_pk_fma_f32 v[128:129], v[128:129], v[88:89], v[140:141]
    v_cvt_pk_f16_f32 v146, v120, v122
    v_cvt_pk_f16_f32 v150, v128, v130
    v_cvt_pk_f16_f32 v147, v121, v123
    v_cvt_pk_f16_f32 v151, v129, v131
    ds_write_b64 v224, v[146:147] offset:9504
    ds_write_b64 v224, v[150:151] offset:24288
    v_pk_mul_f32 v[136:137], v[106:107], v[94:95]
    v_pk_mul_f32 v[140:141], v[130:131], v[90:91]
    v_pk_mul_f32 v[138:139], v[106:107], v[92:93]
    v_pk_mul_f32 v[142:143], v[130:131], v[88:89]
    v_pk_fma_f32 v[106:107], v[104:105], v[94:95], v[138:139]
    v_pk_fma_f32 v[130:131], v[128:129], v[90:91], v[142:143] neg_lo:[0,1,0] neg_hi:[0,1,0]
    v_pk_fma_f32 v[104:105], v[104:105], v[92:93], v[136:137] neg_lo:[0,0,1] neg_hi:[0,0,1]
    v_pk_fma_f32 v[128:129], v[128:129], v[88:89], v[140:141]
    v_cvt_pk_f16_f32 v144, v104, v106
    v_cvt_pk_f16_f32 v148, v128, v130
    v_cvt_pk_f16_f32 v145, v105, v107
    v_cvt_pk_f16_f32 v149, v129, v131
    ds_write_b64 v224, v[144:145] offset:10032
    ds_write_b64 v224, v[148:149] offset:24816
    v_pk_mul_f32 v[136:137], v[122:123], v[94:95]
    v_pk_mul_f32 v[140:141], v[130:131], v[90:91]
    v_pk_mul_f32 v[138:139], v[122:123], v[92:93]
    v_pk_mul_f32 v[142:143], v[130:131], v[88:89]
    v_pk_fma_f32 v[122:123], v[120:121], v[94:95], v[138:139]
    v_pk_fma_f32 v[130:131], v[128:129], v[90:91], v[142:143] neg_lo:[0,1,0] neg_hi:[0,1,0]
    v_pk_fma_f32 v[120:121], v[120:121], v[92:93], v[136:137] neg_lo:[0,0,1] neg_hi:[0,0,1]
    v_pk_fma_f32 v[128:129], v[128:129], v[88:89], v[140:141]
    v_cvt_pk_f16_f32 v146, v120, v122
    v_cvt_pk_f16_f32 v150, v128, v130
    v_cvt_pk_f16_f32 v147, v121, v123
    v_cvt_pk_f16_f32 v151, v129, v131
    ds_write_b64 v224, v[146:147] offset:10560
    ds_write_b64 v224, v[150:151] offset:25344
    v_pk_mul_f32 v[136:137], v[106:107], v[94:95]
    v_pk_mul_f32 v[140:141], v[130:131], v[90:91]
    v_pk_mul_f32 v[138:139], v[106:107], v[92:93]
    v_pk_mul_f32 v[142:143], v[130:131], v[88:89]
    v_pk_fma_f32 v[106:107], v[104:105], v[94:95], v[138:139]
    v_pk_fma_f32 v[130:131], v[128:129], v[90:91], v[142:143] neg_lo:[0,1,0] neg_hi:[0,1,0]
    v_pk_fma_f32 v[104:105], v[104:105], v[92:93], v[136:137] neg_lo:[0,0,1] neg_hi:[0,0,1]
    v_pk_fma_f32 v[128:129], v[128:129], v[88:89], v[140:141]
    v_cvt_pk_f16_f32 v144, v104, v106
    v_cvt_pk_f16_f32 v148, v128, v130
    v_cvt_pk_f16_f32 v145, v105, v107
    v_cvt_pk_f16_f32 v149, v129, v131
    ds_write_b64 v224, v[144:145] offset:12144
    ds_write_b64 v224, v[148:149] offset:25872
    v_pk_mul_f32 v[136:137], v[122:123], v[94:95]
    v_pk_mul_f32 v[140:141], v[130:131], v[90:91]
    v_pk_mul_f32 v[138:139], v[122:123], v[92:93]
    v_pk_mul_f32 v[142:143], v[130:131], v[88:89]
    v_pk_fma_f32 v[122:123], v[120:121], v[94:95], v[138:139]
    v_pk_fma_f32 v[130:131], v[128:129], v[90:91], v[142:143] neg_lo:[0,1,0] neg_hi:[0,1,0]
    v_pk_fma_f32 v[120:121], v[120:121], v[92:93], v[136:137] neg_lo:[0,0,1] neg_hi:[0,0,1]
    v_pk_fma_f32 v[128:129], v[128:129], v[88:89], v[140:141]
    v_cvt_pk_f16_f32 v146, v120, v122
    v_cvt_pk_f16_f32 v150, v128, v130
    v_cvt_pk_f16_f32 v147, v121, v123
    v_cvt_pk_f16_f32 v151, v129, v131
    ds_write_b64 v224, v[146:147] offset:12672
    ds_write_b64 v224, v[150:151] offset:26400
    v_pk_mul_f32 v[136:137], v[106:107], v[94:95]
    v_pk_mul_f32 v[140:141], v[130:131], v[90:91]
    v_pk_mul_f32 v[138:139], v[106:107], v[92:93]
    v_pk_mul_f32 v[142:143], v[130:131], v[88:89]
    v_pk_fma_f32 v[106:107], v[104:105], v[94:95], v[138:139]
    v_pk_fma_f32 v[130:131], v[128:129], v[90:91], v[142:143] neg_lo:[0,1,0] neg_hi:[0,1,0]
    v_pk_fma_f32 v[104:105], v[104:105], v[92:93], v[136:137] neg_lo:[0,0,1] neg_hi:[0,0,1]
    v_pk_fma_f32 v[128:129], v[128:129], v[88:89], v[140:141]
    v_cvt_pk_f16_f32 v144, v104, v106
    v_cvt_pk_f16_f32 v148, v128, v130
    v_cvt_pk_f16_f32 v145, v105, v107
    v_cvt_pk_f16_f32 v149, v129, v131
    ds_write_b64 v224, v[144:145] offset:11088
    ds_write_b64 v224, v[148:149] offset:26928
    v_pk_mul_f32 v[136:137], v[122:123], v[94:95]
    v_pk_mul_f32 v[140:141], v[130:131], v[90:91]
    v_pk_mul_f32 v[138:139], v[122:123], v[92:93]
    v_pk_mul_f32 v[142:143], v[130:131], v[88:89]
    v_pk_fma_f32 v[122:123], v[120:121], v[94:95], v[138:139]
    v_pk_fma_f32 v[130:131], v[128:129], v[90:91], v[142:143] neg_lo:[0,1,0] neg_hi:[0,1,0]
    v_pk_fma_f32 v[120:121], v[120:121], v[92:93], v[136:137] neg_lo:[0,0,1] neg_hi:[0,0,1]
    v_pk_fma_f32 v[128:129], v[128:129], v[88:89], v[140:141]
    v_cvt_pk_f16_f32 v146, v120, v122
    v_cvt_pk_f16_f32 v150, v128, v130
    v_cvt_pk_f16_f32 v147, v121, v123
    v_cvt_pk_f16_f32 v151, v129, v131
    ds_write_b64 v224, v[146:147] offset:11616
    ds_write_b64 v224, v[150:151] offset:27456
    v_pk_mul_f32 v[136:137], v[106:107], v[94:95]
    v_pk_mul_f32 v[140:141], v[130:131], v[90:91]
    v_pk_mul_f32 v[138:139], v[106:107], v[92:93]
    v_pk_mul_f32 v[142:143], v[130:131], v[88:89]
    v_pk_fma_f32 v[106:107], v[104:105], v[94:95], v[138:139]
    v_pk_fma_f32 v[130:131], v[128:129], v[90:91], v[142:143] neg_lo:[0,1,0] neg_hi:[0,1,0]
    v_pk_fma_f32 v[104:105], v[104:105], v[92:93], v[136:137] neg_lo:[0,0,1] neg_hi:[0,0,1]
    v_pk_fma_f32 v[128:129], v[128:129], v[88:89], v[140:141]
    v_cvt_pk_f16_f32 v144, v104, v106
    v_cvt_pk_f16_f32 v148, v128, v130
    v_cvt_pk_f16_f32 v145, v105, v107
    v_cvt_pk_f16_f32 v149, v129, v131
    ds_write_b64 v224, v[144:145] offset:13200
    ds_write_b64 v224, v[148:149] offset:27984
    v_pk_mul_f32 v[136:137], v[122:123], v[94:95]
    v_pk_mul_f32 v[140:141], v[130:131], v[90:91]
    v_pk_mul_f32 v[138:139], v[122:123], v[92:93]
    v_pk_mul_f32 v[142:143], v[130:131], v[88:89]
    v_pk_fma_f32 v[122:123], v[120:121], v[94:95], v[138:139]
    v_pk_fma_f32 v[130:131], v[128:129], v[90:91], v[142:143] neg_lo:[0,1,0] neg_hi:[0,1,0]
    v_pk_fma_f32 v[120:121], v[120:121], v[92:93], v[136:137] neg_lo:[0,0,1] neg_hi:[0,0,1]
    v_pk_fma_f32 v[128:129], v[128:129], v[88:89], v[140:141]
    v_cvt_pk_f16_f32 v146, v120, v122
    v_cvt_pk_f16_f32 v150, v128, v130
    v_cvt_pk_f16_f32 v147, v121, v123
    v_cvt_pk_f16_f32 v151, v129, v131
    ds_write_b64 v224, v[146:147] offset:13728
    ds_write_b64 v224, v[150:151] offset:28512
    v_pk_mul_f32 v[140:141], v[130:131], v[90:91]
    v_pk_mul_f32 v[142:143], v[130:131], v[88:89]
    v_pk_fma_f32 v[130:131], v[128:129], v[90:91], v[142:143] neg_lo:[0,1,0] neg_hi:[0,1,0]
    v_pk_fma_f32 v[128:129], v[128:129], v[88:89], v[140:141]
    v_cvt_pk_f16_f32 v148, v128, v130
    v_cvt_pk_f16_f32 v149, v129, v131
    ds_write_b64 v224, v[148:149] offset:29040
    v_pk_mul_f32 v[140:141], v[130:131], v[90:91]
    v_pk_mul_f32 v[142:143], v[130:131], v[88:89]
    v_pk_fma_f32 v[130:131], v[128:129], v[90:91], v[142:143] neg_lo:[0,1,0] neg_hi:[0,1,0]
    v_pk_fma_f32 v[128:129], v[128:129], v[88:89], v[140:141]
    v_cvt_pk_f16_f32 v150, v128, v130
    v_cvt_pk_f16_f32 v151, v129, v131
    ds_write_b64 v224, v[150:151] offset:29568
    v_pk_mul_f32 v[140:141], v[130:131], v[90:91]
    v_pk_mul_f32 v[142:143], v[130:131], v[88:89]
    v_pk_fma_f32 v[130:131], v[128:129], v[90:91], v[142:143] neg_lo:[0,1,0] neg_hi:[0,1,0]
    v_pk_fma_f32 v[128:129], v[128:129], v[88:89], v[140:141]
    v_cvt_pk_f16_f32 v148, v128, v130
    v_cvt_pk_f16_f32 v149, v129, v131
    ds_write_b64 v224, v[148:149] offset:30096
    v_pk_mul_f32 v[140:141], v[130:131], v[90:91]
    v_pk_mul_f32 v[142:143], v[130:131], v[88:89]
    v_pk_fma_f32 v[130:131], v[128:129], v[90:91], v[142:143] neg_lo:[0,1,0] neg_hi:[0,1,0]
    v_pk_fma_f32 v[128:129], v[128:129], v[88:89], v[140:141]
    v_cvt_pk_f16_f32 v150, v128, v130
    v_cvt_pk_f16_f32 v151, v129, v131
    ds_write_b64 v224, v[150:151] offset:30624
    s_waitcnt lgkmcnt(0)
    ds_read_b128 v[64:67], v225 offset:0
    ds_read_b128 v[68:71], v226 offset:0
    ds_read_b128 v[72:75], v225 offset:32
    ds_read_b128 v[76:79], v226 offset:32
    ds_read_b128 v[80:83], v225 offset:64
    ds_read_b128 v[84:87], v226 offset:64
    ds_read_b128 v[88:91], v225 offset:96
    ds_read_b128 v[92:95], v226 offset:96
    ds_read_b128 v[96:99], v225 offset:128
    ds_read_b128 v[100:103], v226 offset:128
    ds_read_b128 v[104:107], v225 offset:160
    ds_read_b128 v[108:111], v226 offset:160
    s_waitcnt lgkmcnt(10)
    v_mfma_f32_32x32x16_f16 v[176:191], v[64:67], v[68:71], 0
    ds_read_b128 v[64:67], v225 offset:192
    ds_read_b128 v[68:71], v226 offset:192
    s_waitcnt lgkmcnt(10)
    v_mfma_f32_32x32x16_f16 v[176:191], v[72:75], v[76:79], v[176:191]
    ds_read_b128 v[72:75], v225 offset:224
    ds_read_b128 v[76:79], v226 offset:224
    s_waitcnt lgkmcnt(10)
    v_mfma_f32_32x32x16_f16 v[176:191], v[80:83], v[84:87], v[176:191]
    ds_read_b128 v[80:83], v225 offset:256
    ds_read_b128 v[84:87], v226 offset:256
    s_waitcnt lgkmcnt(10)
    v_mfma_f32_32x32x16_f16 v[176:191], v[88:91], v[92:95], v[176:191]
    ds_read_b128 v[88:91], v225 offset:288
    ds_read_b128 v[92:95], v226 offset:288
    s_waitcnt lgkmcnt(10)
    v_mfma_f32_32x32x16_f16 v[176:191], v[96:99], v[100:103], v[176:191]
    ds_read_b128 v[96:99], v225 offset:320
    ds_read_b128 v[100:103], v226 offset:320
    s_waitcnt lgkmcnt(10)
    v_mfma_f32_32x32x16_f16 v[176:191], v[104:107], v[108:111], v[176:191]
    ds_read_b128 v[104:107], v225 offset:352
    ds_read_b128 v[108:111], v226 offset:352
    s_waitcnt lgkmcnt(10)
    v_mfma_f32_32x32x16_f16 v[176:191], v[64:67], v[68:71], v[176:191]
    ds_read_b128 v[64:67], v225 offset:384
    ds_read_b128 v[68:71], v226 offset:384
    s_waitcnt lgkmcnt(10)
    v_mfma_f32_32x32x16_f16 v[176:191], v[72:75], v[76:79], v[176:191]
    ds_read_b128 v[72:75], v225 offset:416
    ds_read_b128 v[76:79], v226 offset:416
    s_waitcnt lgkmcnt(10)
    v_mfma_f32_32x32x16_f16 v[176:191], v[80:83], v[84:87], v[176:191]
    ds_read_b128 v[80:83], v225 offset:448
    ds_read_b128 v[84:87], v226 offset:448
    s_waitcnt lgkmcnt(10)
    v_mfma_f32_32x32x16_f16 v[176:191], v[88:91], v[92:95], v[176:191]
    ds_read_b128 v[88:91], v225 offset:480
    ds_read_b128 v[92:95], v226 offset:480
    s_waitcnt lgkmcnt(10)
    v_mfma_f32_32x32x16_f16 v[176:191], v[96:99], v[100:103], v[176:191]
    s_waitcnt lgkmcnt(8)
    v_mfma_f32_32x32x16_f16 v[176:191], v[104:107], v[108:111], v[176:191]
    s_waitcnt lgkmcnt(6)
    v_mfma_f32_32x32x16_f16 v[176:191], v[64:67], v[68:71], v[176:191]
    s_waitcnt lgkmcnt(4)
    v_mfma_f32_32x32x16_f16 v[176:191], v[72:75], v[76:79], v[176:191]
    s_waitcnt lgkmcnt(2)
    v_mfma_f32_32x32x16_f16 v[176:191], v[80:83], v[84:87], v[176:191]
    s_waitcnt lgkmcnt(0)
    v_mfma_f32_32x32x16_f16 v[176:191], v[88:91], v[92:95], v[176:191]
    v_mov_b32 v64, 0
    v_mov_b32 v65, 0
    v_mov_b32 v66, 0
    v_mov_b32 v67, 0
    v_lshrrev_b32 v68, 1, v1
    s_movk_i32 s20, 4160
    v_mul_u32_u24 v68, s20, v68
    v_and_b32 v69, 1, v1
    v_lshl_add_u32 v68, v69, 4, v68
    v_add_u32 v68, s15, v68
    v_cmp_eq_u32 vcc, 0, v69
    v_cmp_eq_u32 s[20:21], 0, v1
    s_nop 1
    v_cndmask_b32 v70, 0, v232, s[20:21]
    v_pk_mul_f32 v[176:177], v[176:177], v[230:231] op_sel:[0,1] op_sel_hi:[1,1]
    v_pk_mul_f32 v[178:179], v[178:179], v[230:231] op_sel:[0,1] op_sel_hi:[1,1]
    v_pk_mul_f32 v[180:181], v[180:181], v[230:231] op_sel:[0,1] op_sel_hi:[1,1]
    v_pk_mul_f32 v[182:183], v[182:183], v[230:231] op_sel:[0,1] op_sel_hi:[1,1]
    v_pk_mul_f32 v[184:185], v[184:185], v[230:231] op_sel:[0,1] op_sel_hi:[1,1]
    v_pk_mul_f32 v[186:187], v[186:187], v[230:231] op_sel:[0,1] op_sel_hi:[1,1]
    v_pk_mul_f32 v[188:189], v[188:189], v[230:231] op_sel:[0,1] op_sel_hi:[1,1]
    v_pk_mul_f32 v[190:191], v[190:191], v[230:231] op_sel:[0,1] op_sel_hi:[1,1]
    v_add_f32 v176, v176, v70
    v_cndmask_b32 v71, v189, v188, vcc
    v_cndmask_b32 v72, v191, v190, vcc
    s_mov_b64 exec, 0xff
    ds_write_b128 v68, v[64:67] offset:4096
    s_mov_b64 exec, -1
    v_cvt_pk_f16_f32 v76, v183, v182
    v_cvt_pk_f16_f32 v77, v181, v180
    v_cvt_pk_f16_f32 v78, v179, v178
    v_cvt_pk_f16_f32 v79, v177, v176
    v_mov_b32 v83, 0
    v_mov_b32 v91, 0
    v_cvt_pk_f16_f32 v80, v181, v180
    v_cvt_pk_f16_f32 v81, v179, v178
    v_cvt_pk_f16_f32 v82, v177, v176
    v_alignbit_b32 v84, v77, v76, 16
    v_alignbit_b32 v85, v78, v77, 16
    v_alignbit_b32 v86, v79, v78, 16
    v_mov_b32_dpp v83, v76 wave_shr:1 row_mask:0xf bank_mask:0xf
    v_mov_b32_dpp v91, v84 wave_shr:1 row_mask:0xf bank_mask:0xf
    ds_write_b128 v227, v[76:79] offset:3072
    v_mov_b32 v88, v85
    v_mov_b32 v89, v86
    v_alignbit_b32 v87, v83, v79, 16
    v_alignbit_b32 v90, v83, v79, 16
    ds_write_b128 v227, v[80:83] offset:11392
    ds_write_b128 v227, v[84:87] offset:7232
    ds_write_b128 v227, v[88:91] offset:15552
    v_cvt_pk_f16_f32 v96, v186, v186
    v_cvt_pk_f16_f32 v97, v185, v185
    v_cvt_pk_f16_f32 v98, v185, v184
    v_cvt_pk_f16_f32 v99, v184, v184
    v_mov_b32_dpp v103, v76 wave_ror:1 row_mask:0xf bank_mask:0xf
    v_mov_b32_dpp v111, v84 wave_ror:1 row_mask:0xf bank_mask:0xf
    v_cvt_pk_f16_f32 v100, v185, v185
    v_cvt_pk_f16_f32 v101, v185, v184
    v_cvt_pk_f16_f32 v102, v184, v184
    v_alignbit_b32 v104, v97, v96, 16
    v_alignbit_b32 v105, v98, v97, 16
    v_alignbit_b32 v106, v99, v98, 16
    v_mov_b32_dpp v103, v96 wave_shr:1 row_mask:0xf bank_mask:0xf
    v_mov_b32_dpp v111, v104 wave_shr:1 row_mask:0xf bank_mask:0xf
    ds_write_b128 v227, v[96:99] offset:2048
    v_mov_b32 v108, v105
    v_mov_b32 v109, v106
    v_alignbit_b32 v107, v103, v99, 16
    v_alignbit_b32 v110, v103, v99, 16
    ds_write_b128 v227, v[100:103] offset:10368
    ds_write_b128 v227, v[104:107] offset:6208
    ds_write_b128 v227, v[108:111] offset:14528
    v_cvt_pk_f16_f32 v116, v189, v189
    v_cvt_pk_f16_f32 v117, v189, v71
    v_cvt_pk_f16_f32 v118, v188, v188
    v_cvt_pk_f16_f32 v119, v188, v188
    v_mov_b32_dpp v123, v96 wave_ror:1 row_mask:0xf bank_mask:0xf
    v_mov_b32_dpp v131, v104 wave_ror:1 row_mask:0xf bank_mask:0xf
    v_cvt_pk_f16_f32 v120, v189, v71
    v_cvt_pk_f16_f32 v121, v188, v188
    v_cvt_pk_f16_f32 v122, v188, v188
    v_alignbit_b32 v124, v117, v116, 16
    v_alignbit_b32 v125, v118, v117, 16
    v_alignbit_b32 v126, v119, v118, 16
    v_mov_b32_dpp v123, v116 wave_shr:1 row_mask:0xf bank_mask:0xf
    v_mov_b32_dpp v131, v124 wave_shr:1 row_mask:0xf bank_mask:0xf
    ds_write_b128 v227, v[116:119] offset:1024
    v_mov_b32 v128, v125
    v_mov_b32 v129, v126
    v_alignbit_b32 v127, v123, v119, 16
    v_alignbit_b32 v130, v123, v119, 16
    ds_write_b128 v227, v[120:123] offset:9344
    ds_write_b128 v227, v[124:127] offset:5184
    ds_write_b128 v227, v[128:131] offset:13504
    v_cvt_pk_f16_f32 v136, v191, v191
    v_cvt_pk_f16_f32 v137, v191, v72
    v_cvt_pk_f16_f32 v138, v190, v190
    v_cvt_pk_f16_f32 v139, v190, v190
    v_mov_b32_dpp v143, v116 wave_ror:1 row_mask:0xf bank_mask:0xf
    v_mov_b32_dpp v151, v124 wave_ror:1 row_mask:0xf bank_mask:0xf
    v_cvt_pk_f16_f32 v140, v191, v72
    v_cvt_pk_f16_f32 v141, v190, v190
    v_cvt_pk_f16_f32 v142, v190, v190
    v_alignbit_b32 v144, v137, v136, 16
    v_alignbit_b32 v145, v138, v137, 16
    v_alignbit_b32 v146, v139, v138, 16
    v_mov_b32_dpp v143, v136 wave_shr:1 row_mask:0xf bank_mask:0xf
    v_mov_b32_dpp v151, v144 wave_shr:1 row_mask:0xf bank_mask:0xf
    ds_write_b128 v227, v[136:139] offset:0
    v_mov_b32 v148, v145
    v_mov_b32 v149, v146
    v_alignbit_b32 v147, v143, v139, 16
    v_alignbit_b32 v150, v143, v139, 16
    ds_write_b128 v227, v[140:143] offset:8320
    ds_write_b128 v227, v[144:147] offset:4160
    ds_write_b128 v227, v[148:151] offset:12480
    s_waitcnt lgkmcnt(0)
    ds_read_b64 v[64:65], v228 offset:4032
    ds_read_b64 v[66:67], v228 offset:4040
    ds_read_b64 v[68:69], v228 offset:3520
    ds_read_b64 v[70:71], v228 offset:3528
    ds_read_b64 v[72:73], v228 offset:3008
    ds_read_b64 v[74:75], v228 offset:3016
    ds_read_b64 v[76:77], v228 offset:2496
    ds_read_b64 v[78:79], v228 offset:2504
    ds_read_b64 v[80:81], v228 offset:1984
    ds_read_b64 v[82:83], v228 offset:1992
    ds_read_b64 v[84:85], v228 offset:1472
    ds_read_b64 v[86:87], v228 offset:1480
    ds_read_b64 v[88:89], v228 offset:960
    ds_read_b64 v[90:91], v228 offset:968
    ds_read_b64 v[92:93], v228 offset:448
    ds_read_b64 v[94:95], v228 offset:456
    s_waitcnt lgkmcnt(0)
    s_add_u32 s99, s99, 1
    s_barrier
    ds_read_b128 v[96:99], v229 offset:480
    ds_read_b128 v[100:103], v229 offset:992
    ds_read_b128 v[104:107], v229 offset:1504
    ds_read_b128 v[108:111], v229 offset:2016
    ds_read_b128 v[112:115], v229 offset:2528
    ds_read_b128 v[116:119], v229 offset:3040
    ds_read_b128 v[120:123], v229 offset:3552
    ds_read_b128 v[124:127], v229 offset:4064
    s_waitcnt lgkmcnt(0)
    v_mfma_f32_16x16x32_f16 v[220:223], v[64:67], v[124:127], 0
    ds_read_b64 v[128:129], v228 offset:3968
    v_mfma_f32_16x16x32_f16 v[216:219], v[64:67], v[120:123], 0
    ds_read_b64 v[130:131], v228 offset:3976
    v_mfma_f32_16x16x32_f16 v[212:215], v[64:67], v[116:119], 0
    ds_read_b128 v[160:163], v229 offset:416
    v_mfma_f32_16x16x32_f16 v[208:211], v[64:67], v[112:115], 0
    ds_read_b128 v[164:167], v229 offset:928
    v_mfma_f32_16x16x32_f16 v[220:223], v[68:71], v[120:123], v[220:223]
    ds_read_b128 v[168:171], v229 offset:1440
    v_mfma_f32_16x16x32_f16 v[216:219], v[68:71], v[116:119], v[216:219]
    ds_read_b128 v[172:175], v229 offset:1952
    v_mfma_f32_16x16x32_f16 v[212:215], v[68:71], v[112:115], v[212:215]
    ds_read_b128 v[176:179], v229 offset:2464
    v_mfma_f32_16x16x32_f16 v[204:207], v[64:67], v[108:111], 0
    ds_read_b128 v[180:183], v229 offset:2976
    v_mfma_f32_16x16x32_f16 v[220:223], v[72:75], v[116:119], v[220:223]
    ds_read_b128 v[184:187], v229 offset:3488
    v_mfma_f32_16x16x32_f16 v[216:219], v[72:75], v[112:115], v[216:219]
    ds_read_b128 v[188:191], v229 offset:4000
    v_mfma_f32_16x16x32_f16 v[208:211], v[68:71], v[108:111], v[208:211]
    ds_read_b64 v[132:133], v228 offset:3456
    v_mfma_f32_16x16x32_f16 v[212:215], v[72:75], v[108:111], v[212:215]
    ds_read_b64 v[134:135], v228 offset:3464
    v_mfma_f32_16x16x32_f16 v[220:223], v[76:79], v[112:115], v[220:223]
    ds_read_b64 v[136:137], v228 offset:2944
    v_mfma_f32_16x16x32_f16 v[216:219], v[76:79], v[108:111], v[216:219]
    ds_read_b64 v[138:139], v228 offset:2952
    v_mfma_f32_16x16x32_f16 v[200:203], v[64:67], v[104:107], 0
    ds_read_b64 v[140:141], v228 offset:2432
    v_mfma_f32_16x16x32_f16 v[204:207], v[68:71], v[104:107], v[204:207]
    ds_read_b64 v[142:143], v228 offset:2440
    v_mfma_f32_16x16x32_f16 v[220:223], v[80:83], v[108:111], v[220:223]
    ds_read_b64 v[144:145], v228 offset:1920
    v_mfma_f32_16x16x32_f16 v[208:211], v[72:75], v[104:107], v[208:211]
    ds_read_b64 v[146:147], v228 offset:1928
    v_mfma_f32_16x16x32_f16 v[212:215], v[76:79], v[104:107], v[212:215]
    ds_read_b64 v[148:149], v228 offset:1408
    v_mfma_f32_16x16x32_f16 v[216:219], v[80:83], v[104:107], v[216:219]
    ds_read_b64 v[150:151], v228 offset:1416
    v_mfma_f32_16x16x32_f16 v[220:223], v[84:87], v[104:107], v[220:223]
    ds_read_b64 v[152:153], v228 offset:896
    v_mfma_f32_16x16x32_f16 v[196:199], v[64:67], v[100:103], 0
    ds_read_b64 v[154:155], v228 offset:904
    v_mfma_f32_16x16x32_f16 v[200:203], v[68:71], v[100:103], v[200:203]
    ds_read_b64 v[156:157], v228 offset:384
    v_mfma_f32_16x16x32_f16 v[204:207], v[72:75], v[100:103], v[204:207]
    ds_read_b64 v[158:159], v228 offset:392
    v_mfma_f32_16x16x32_f16 v[208:211], v[76:79], v[100:103], v[208:211]
    v_mfma_f32_16x16x32_f16 v[212:215], v[80:83], v[100:103], v[212:215]
    v_mfma_f32_16x16x32_f16 v[216:219], v[84:87], v[100:103], v[216:219]
    v_mfma_f32_16x16x32_f16 v[220:223], v[88:91], v[100:103], v[220:223]
    v_mfma_f32_16x16x32_f16 v[192:195], v[64:67], v[96:99], 0
    v_mfma_f32_16x16x32_f16 v[196:199], v[68:71], v[96:99], v[196:199]
    v_mfma_f32_16x16x32_f16 v[200:203], v[72:75], v[96:99], v[200:203]
    v_mfma_f32_16x16x32_f16 v[204:207], v[76:79], v[96:99], v[204:207]
    v_mfma_f32_16x16x32_f16 v[208:211], v[80:83], v[96:99], v[208:211]
    v_mfma_f32_16x16x32_f16 v[212:215], v[84:87], v[96:99], v[212:215]
    v_mfma_f32_16x16x32_f16 v[216:219], v[88:91], v[96:99], v[216:219]
    v_mfma_f32_16x16x32_f16 v[220:223], v[92:95], v[96:99], v[220:223]
    s_waitcnt lgkmcnt(0)
    v_mfma_f32_16x16x32_f16 v[208:211], v[128:131], v[176:179], v[208:211]
    ds_read_b64 v[64:65], v228 offset:3904
    v_mfma_f32_16x16x32_f16 v[212:215], v[128:131], v[180:183], v[212:215]
    ds_read_b64 v[66:67], v228 offset:3912
    v_mfma_f32_16x16x32_f16 v[216:219], v[128:131], v[184:187], v[216:219]
    ds_read_b128 v[96:99], v229 offset:352
    v_mfma_f32_16x16x32_f16 v[220:223], v[128:131], v[188:191], v[220:223]
    ds_read_b128 v[100:103], v229 offset:864
    v_mfma_f32_16x16x32_f16 v[204:207], v[128:131], v[172:175], v[204:207]
    ds_read_b128 v[104:107], v229 offset:1376
    v_mfma_f32_16x16x32_f16 v[212:215], v[132:135], v[176:179], v[212:215]
    ds_read_b128 v[108:111], v229 offset:1888
    v_mfma_f32_16x16x32_f16 v[216:219], v[132:135], v[180:183], v[216:219]
    ds_read_b128 v[112:115], v229 offset:2400
    v_mfma_f32_16x16x32_f16 v[220:223], v[132:135], v[184:187], v[220:223]
    ds_read_b128 v[116:119], v229 offset:2912
    v_mfma_f32_16x16x32_f16 v[208:211], v[132:135], v[172:175], v[208:211]
    ds_read_b128 v[120:123], v229 offset:3424
    v_mfma_f32_16x16x32_f16 v[212:215], v[136:139], v[172:175], v[212:215]
    ds_read_b128 v[124:127], v229 offset:3936
    v_mfma_f32_16x16x32_f16 v[216:219], v[136:139], v[176:179], v[216:219]
    ds_read_b64 v[68:69], v228 offset:3392
    v_mfma_f32_16x16x32_f16 v[220:223], v[136:139], v[180:183], v[220:223]
    ds_read_b64 v[70:71], v228 offset:3400
    v_mfma_f32_16x16x32_f16 v[200:203], v[128:131], v[168:171], v[200:203]
    ds_read_b64 v[72:73], v228 offset:2880
    v_mfma_f32_16x16x32_f16 v[204:207], v[132:135], v[168:171], v[204:207]
    ds_read_b64 v[74:75], v228 offset:2888
    v_mfma_f32_16x16x32_f16 v[216:219], v[140:143], v[172:175], v[216:219]
    ds_read_b64 v[76:77], v228 offset:2368
    v_mfma_f32_16x16x32_f16 v[220:223], v[140:143], v[176:179], v[220:223]
    ds_read_b64 v[78:79], v228 offset:2376
    v_mfma_f32_16x16x32_f16 v[208:211], v[136:139], v[168:171], v[208:211]
    ds_read_b64 v[80:81], v228 offset:1856
    v_mfma_f32_16x16x32_f16 v[212:215], v[140:143], v[168:171], v[212:215]
    ds_read_b64 v[82:83], v228 offset:1864
    v_mfma_f32_16x16x32_f16 v[216:219], v[144:147], v[168:171], v[216:219]
    ds_read_b64 v[84:85], v228 offset:1344
    v_mfma_f32_16x16x32_f16 v[220:223], v[144:147], v[172:175], v[220:223]
    ds_read_b64 v[86:87], v228 offset:1352
    v_mfma_f32_16x16x32_f16 v[196:199], v[128:131], v[164:167], v[196:199]
    ds_read_b64 v[88:89], v228 offset:832
    v_mfma_f32_16x16x32_f16 v[200:203], v[132:135], v[164:167], v[200:203]
    ds_read_b64 v[90:91], v228 offset:840
    v_mfma_f32_16x16x32_f16 v[204:207], v[136:139], v[164:167], v[204:207]
    ds_read_b64 v[92:93], v228 offset:320
    v_mfma_f32_16x16x32_f16 v[220:223], v[148:151], v[168:171], v[220:223]
    ds_read_b64 v[94:95], v228 offset:328
    v_mfma_f32_16x16x32_f16 v[208:211], v[140:143], v[164:167], v[208:211]
    v_mfma_f32_16x16x32_f16 v[212:215], v[144:147], v[164:167], v[212:215]
    v_mfma_f32_16x16x32_f16 v[216:219], v[148:151], v[164:167], v[216:219]
    v_mfma_f32_16x16x32_f16 v[220:223], v[152:155], v[164:167], v[220:223]
    v_mfma_f32_16x16x32_f16 v[192:195], v[128:131], v[160:163], v[192:195]
    v_mfma_f32_16x16x32_f16 v[196:199], v[132:135], v[160:163], v[196:199]
    v_mfma_f32_16x16x32_f16 v[200:203], v[136:139], v[160:163], v[200:203]
    v_mfma_f32_16x16x32_f16 v[204:207], v[140:143], v[160:163], v[204:207]
    v_mfma_f32_16x16x32_f16 v[208:211], v[144:147], v[160:163], v[208:211]
    v_mfma_f32_16x16x32_f16 v[212:215], v[148:151], v[160:163], v[212:215]
    v_mfma_f32_16x16x32_f16 v[216:219], v[152:155], v[160:163], v[216:219]
    v_mfma_f32_16x16x32_f16 v[220:223], v[156:159], v[160:163], v[220:223]
    s_waitcnt lgkmcnt(0)
    v_mfma_f32_16x16x32_f16 v[208:211], v[64:67], v[112:115], v[208:211]
    ds_read_b64 v[128:129], v228 offset:3840
    v_mfma_f32_16x16x32_f16 v[212:215], v[64:67], v[116:119], v[212:215]
    ds_read_b64 v[130:131], v228 offset:3848
    v_mfma_f32_16x16x32_f16 v[216:219], v[64:67], v[120:123], v[216:219]
    ds_read_b128 v[160:163], v229 offset:288
    v_mfma_f32_16x16x32_f16 v[220:223], v[64:67], v[124:127], v[220:223]
    ds_read_b128 v[164:167], v229 offset:800
    v_mfma_f32_16x16x32_f16 v[204:207], v[64:67], v[108:111], v[204:207]
    ds_read_b128 v[168:171], v229 offset:1312
    v_mfma_f32_16x16x32_f16 v[212:215], v[68:71], v[112:115], v[212:215]
    ds_read_b128 v[172:175], v229 offset:1824
    v_mfma_f32_16x16x32_f16 v[216:219], v[68:71], v[116:119], v[216:219]
    ds_read_b128 v[176:179], v229 offset:2336
    v_mfma_f32_16x16x32_f16 v[220:223], v[68:71], v[120:123], v[220:223]
    ds_read_b128 v[180:183], v229 offset:2848
    v_mfma_f32_16x16x32_f16 v[208:211], v[68:71], v[108:111], v[208:211]
    ds_read_b128 v[184:187], v229 offset:3360
    v_mfma_f32_16x16x32_f16 v[212:215], v[72:75], v[108:111], v[212:215]
    ds_read_b128 v[188:191], v229 offset:3872
    v_mfma_f32_16x16x32_f16 v[216:219], v[72:75], v[112:115], v[216:219]
    ds_read_b64 v[132:133], v228 offset:3328
    v_mfma_f32_16x16x32_f16 v[220:223], v[72:75], v[116:119], v[220:223]
    ds_read_b64 v[134:135], v228 offset:3336
    v_mfma_f32_16x16x32_f16 v[200:203], v[64:67], v[104:107], v[200:203]
    ds_read_b64 v[136:137], v228 offset:2816
    v_mfma_f32_16x16x32_f16 v[204:207], v[68:71], v[104:107], v[204:207]
    ds_read_b64 v[138:139], v228 offset:2824
    v_mfma_f32_16x16x32_f16 v[216:219], v[76:79], v[108:111], v[216:219]
    ds_read_b64 v[140:141], v228 offset:2304
    v_mfma_f32_16x16x32_f16 v[220:223], v[76:79], v[112:115], v[220:223]
    ds_read_b64 v[142:143], v228 offset:2312
    v_mfma_f32_16x16x32_f16 v[208:211], v[72:75], v[104:107], v[208:211]
    ds_read_b64 v[144:145], v228 offset:1792
    v_mfma_f32_16x16x32_f16 v[212:215], v[76:79], v[104:107], v[212:215]
    ds_read_b64 v[146:147], v228 offset:1800
    v_mfma_f32_16x16x32_f16 v[216:219], v[80:83], v[104:107], v[216:219]
    ds_read_b64 v[148:149], v228 offset:1280
    v_mfma_f32_16x16x32_f16 v[220:223], v[80:83], v[108:111], v[220:223]
    ds_read_b64 v[150:151], v228 offset:1288
    v_mfma_f32_16x16x32_f16 v[196:199], v[64:67], v[100:103], v[196:199]
    ds_read_b64 v[152:153], v228 offset:768
    v_mfma_f32_16x16x32_f16 v[200:203], v[68:71], v[100:103], v[200:203]
    ds_read_b64 v[154:155], v228 offset:776
    v_mfma_f32_16x16x32_f16 v[204:207], v[72:75], v[100:103], v[204:207]
    ds_read_b64 v[156:157], v228 offset:256
    v_mfma_f32_16x16x32_f16 v[220:223], v[84:87], v[104:107], v[220:223]
    ds_read_b64 v[158:159], v228 offset:264
    v_mfma_f32_16x16x32_f16 v[208:211], v[76:79], v[100:103], v[208:211]
    v_mfma_f32_16x16x32_f16 v[212:215], v[80:83], v[100:103], v[212:215]
    v_mfma_f32_16x16x32_f16 v[216:219], v[84:87], v[100:103], v[216:219]
    v_mfma_f32_16x16x32_f16 v[220:223], v[88:91], v[100:103], v[220:223]
    v_mfma_f32_16x16x32_f16 v[192:195], v[64:67], v[96:99], v[192:195]
    v_mfma_f32_16x16x32_f16 v[196:199], v[68:71], v[96:99], v[196:199]
    v_mfma_f32_16x16x32_f16 v[200:203], v[72:75], v[96:99], v[200:203]
    v_mfma_f32_16x16x32_f16 v[204:207], v[76:79], v[96:99], v[204:207]
    v_mfma_f32_16x16x32_f16 v[208:211], v[80:83], v[96:99], v[208:211]
    v_mfma_f32_16x16x32_f16 v[212:215], v[84:87], v[96:99], v[212:215]
    v_mfma_f32_16x16x32_f16 v[216:219], v[88:91], v[96:99], v[216:219]
    v_mfma_f32_16x16x32_f16 v[220:223], v[92:95], v[96:99], v[220:223]
    s_waitcnt lgkmcnt(0)
    v_mfma_f32_16x16x32_f16 v[208:211], v[128:131], v[176:179], v[208:211]
    ds_read_b64 v[64:65], v228 offset:3776
    v_mfma_f32_16x16x32_f16 v[212:215], v[128:131], v[180:183], v[212:215]
    ds_read_b64 v[66:67], v228 offset:3784
    v_mfma_f32_16x16x32_f16 v[216:219], v[128:131], v[184:187], v[216:219]
    ds_read_b128 v[96:99], v229 offset:224
    v_mfma_f32_16x16x32_f16 v[220:223], v[128:131], v[188:191], v[220:223]
    ds_read_b128 v[100:103], v229 offset:736
    v_mfma_f32_16x16x32_f16 v[204:207], v[128:131], v[172:175], v[204:207]
    ds_read_b128 v[104:107], v229 offset:1248
    v_mfma_f32_16x16x32_f16 v[212:215], v[132:135], v[176:179], v[212:215]
    ds_read_b128 v[108:111], v229 offset:1760
    v_mfma_f32_16x16x32_f16 v[216:219], v[132:135], v[180:183], v[216:219]
    ds_read_b128 v[112:115], v229 offset:2272
    v_mfma_f32_16x16x32_f16 v[220:223], v[132:135], v[184:187], v[220:223]
    ds_read_b128 v[116:119], v229 offset:2784
    v_mfma_f32_16x16x32_f16 v[208:211], v[132:135], v[172:175], v[208:211]
    ds_read_b128 v[120:123], v229 offset:3296
    v_mfma_f32_16x16x32_f16 v[212:215], v[136:139], v[172:175], v[212:215]
    ds_read_b128 v[124:127], v229 offset:3808
    v_mfma_f32_16x16x32_f16 v[216:219], v[136:139], v[176:179], v[216:219]
    ds_read_b64 v[68:69], v228 offset:3264
    v_mfma_f32_16x16x32_f16 v[220:223], v[136:139], v[180:183], v[220:223]
    ds_read_b64 v[70:71], v228 offset:3272
    v_mfma_f32_16x16x32_f16 v[200:203], v[128:131], v[168:171], v[200:203]
    ds_read_b64 v[72:73], v228 offset:2752
    v_mfma_f32_16x16x32_f16 v[204:207], v[132:135], v[168:171], v[204:207]
    ds_read_b64 v[74:75], v228 offset:2760
    v_mfma_f32_16x16x32_f16 v[216:219], v[140:143], v[172:175], v[216:219]
    ds_read_b64 v[76:77], v228 offset:2240
    v_mfma_f32_16x16x32_f16 v[220:223], v[140:143], v[176:179], v[220:223]
    ds_read_b64 v[78:79], v228 offset:2248
    v_mfma_f32_16x16x32_f16 v[208:211], v[136:139], v[168:171], v[208:211]
    ds_read_b64 v[80:81], v228 offset:1728
    v_mfma_f32_16x16x32_f16 v[212:215], v[140:143], v[168:171], v[212:215]
    ds_read_b64 v[82:83], v228 offset:1736
    v_mfma_f32_16x16x32_f16 v[216:219], v[144:147], v[168:171], v[216:219]
    ds_read_b64 v[84:85], v228 offset:1216
    v_mfma_f32_16x16x32_f16 v[220:223], v[144:147], v[172:175], v[220:223]
    ds_read_b64 v[86:87], v228 offset:1224
    v_mfma_f32_16x16x32_f16 v[196:199], v[128:131], v[164:167], v[196:199]
    ds_read_b64 v[88:89], v228 offset:704
    v_mfma_f32_16x16x32_f16 v[200:203], v[132:135], v[164:167], v[200:203]
    ds_read_b64 v[90:91], v228 offset:712
    v_mfma_f32_16x16x32_f16 v[204:207], v[136:139], v[164:167], v[204:207]
    ds_read_b64 v[92:93], v228 offset:192
    v_mfma_f32_16x16x32_f16 v[220:223], v[148:151], v[168:171], v[220:223]
    ds_read_b64 v[94:95], v228 offset:200
    v_mfma_f32_16x16x32_f16 v[208:211], v[140:143], v[164:167], v[208:211]
    v_mfma_f32_16x16x32_f16 v[212:215], v[144:147], v[164:167], v[212:215]
    v_mfma_f32_16x16x32_f16 v[216:219], v[148:151], v[164:167], v[216:219]
    v_mfma_f32_16x16x32_f16 v[220:223], v[152:155], v[164:167], v[220:223]
    v_mfma_f32_16x16x32_f16 v[192:195], v[128:131], v[160:163], v[192:195]
    v_mfma_f32_16x16x32_f16 v[196:199], v[132:135], v[160:163], v[196:199]
    v_mfma_f32_16x16x32_f16 v[200:203], v[136:139], v[160:163], v[200:203]
    v_mfma_f32_16x16x32_f16 v[204:207], v[140:143], v[160:163], v[204:207]
    v_mfma_f32_16x16x32_f16 v[208:211], v[144:147], v[160:163], v[208:211]
    v_mfma_f32_16x16x32_f16 v[212:215], v[148:151], v[160:163], v[212:215]
    v_mfma_f32_16x16x32_f16 v[216:219], v[152:155], v[160:163], v[216:219]
    v_mfma_f32_16x16x32_f16 v[220:223], v[156:159], v[160:163], v[220:223]
    s_waitcnt lgkmcnt(0)
    v_mfma_f32_16x16x32_f16 v[208:211], v[64:67], v[112:115], v[208:211]
    ds_read_b64 v[128:129], v228 offset:3712
    v_mfma_f32_16x16x32_f16 v[212:215], v[64:67], v[116:119], v[212:215]
    ds_read_b64 v[130:131], v228 offset:3720
    v_mfma_f32_16x16x32_f16 v[216:219], v[64:67], v[120:123], v[216:219]
    ds_read_b128 v[160:163], v229 offset:160
    v_mfma_f32_16x16x32_f16 v[220:223], v[64:67], v[124:127], v[220:223]
    ds_read_b128 v[164:167], v229 offset:672
    v_mfma_f32_16x16x32_f16 v[204:207], v[64:67], v[108:111], v[204:207]
    ds_read_b128 v[168:171], v229 offset:1184
    v_mfma_f32_16x16x32_f16 v[212:215], v[68:71], v[112:115], v[212:215]
    ds_read_b128 v[172:175], v229 offset:1696
    v_mfma_f32_16x16x32_f16 v[216:219], v[68:71], v[116:119], v[216:219]
    ds_read_b128 v[176:179], v229 offset:2208
    v_mfma_f32_16x16x32_f16 v[220:223], v[68:71], v[120:123], v[220:223]
    ds_read_b128 v[180:183], v229 offset:2720
    v_mfma_f32_16x16x32_f16 v[208:211], v[68:71], v[108:111], v[208:211]
    ds_read_b128 v[184:187], v229 offset:3232
    v_mfma_f32_16x16x32_f16 v[212:215], v[72:75], v[108:111], v[212:215]
    ds_read_b128 v[188:191], v229 offset:3744
    v_mfma_f32_16x16x32_f16 v[216:219], v[72:75], v[112:115], v[216:219]
    ds_read_b64 v[132:133], v228 offset:3200
    v_mfma_f32_16x16x32_f16 v[220:223], v[72:75], v[116:119], v[220:223]
    ds_read_b64 v[134:135], v228 offset:3208
    v_mfma_f32_16x16x32_f16 v[200:203], v[64:67], v[104:107], v[200:203]
    ds_read_b64 v[136:137], v228 offset:2688
    v_mfma_f32_16x16x32_f16 v[204:207], v[68:71], v[104:107], v[204:207]
    ds_read_b64 v[138:139], v228 offset:2696
    v_mfma_f32_16x16x32_f16 v[216:219], v[76:79], v[108:111], v[216:219]
    ds_read_b64 v[140:141], v228 offset:2176
    v_mfma_f32_16x16x32_f16 v[220:223], v[76:79], v[112:115], v[220:223]
    ds_read_b64 v[142:143], v228 offset:2184
    v_mfma_f32_16x16x32_f16 v[208:211], v[72:75], v[104:107], v[208:211]
    ds_read_b64 v[144:145], v228 offset:1664
    v_mfma_f32_16x16x32_f16 v[212:215], v[76:79], v[104:107], v[212:215]
    ds_read_b64 v[146:147], v228 offset:1672
    v_mfma_f32_16x16x32_f16 v[216:219], v[80:83], v[104:107], v[216:219]
    ds_read_b64 v[148:149], v228 offset:1152
    v_mfma_f32_16x16x32_f16 v[220:223], v[80:83], v[108:111], v[220:223]
    ds_read_b64 v[150:151], v228 offset:1160
    v_mfma_f32_16x16x32_f16 v[196:199], v[64:67], v[100:103], v[196:199]
    ds_read_b64 v[152:153], v228 offset:640
    v_mfma_f32_16x16x32_f16 v[200:203], v[68:71], v[100:103], v[200:203]
    ds_read_b64 v[154:155], v228 offset:648
    v_mfma_f32_16x16x32_f16 v[204:207], v[72:75], v[100:103], v[204:207]
    ds_read_b64 v[156:157], v228 offset:128
    v_mfma_f32_16x16x32_f16 v[220:223], v[84:87], v[104:107], v[220:223]
    ds_read_b64 v[158:159], v228 offset:136
    v_mfma_f32_16x16x32_f16 v[208:211], v[76:79], v[100:103], v[208:211]
    v_mfma_f32_16x16x32_f16 v[212:215], v[80:83], v[100:103], v[212:215]
    v_mfma_f32_16x16x32_f16 v[216:219], v[84:87], v[100:103], v[216:219]
    v_mfma_f32_16x16x32_f16 v[220:223], v[88:91], v[100:103], v[220:223]
    v_mfma_f32_16x16x32_f16 v[192:195], v[64:67], v[96:99], v[192:195]
    v_mfma_f32_16x16x32_f16 v[196:199], v[68:71], v[96:99], v[196:199]
    v_mfma_f32_16x16x32_f16 v[200:203], v[72:75], v[96:99], v[200:203]
    v_mfma_f32_16x16x32_f16 v[204:207], v[76:79], v[96:99], v[204:207]
    v_mfma_f32_16x16x32_f16 v[208:211], v[80:83], v[96:99], v[208:211]
    v_mfma_f32_16x16x32_f16 v[212:215], v[84:87], v[96:99], v[212:215]
    v_mfma_f32_16x16x32_f16 v[216:219], v[88:91], v[96:99], v[216:219]
    v_mfma_f32_16x16x32_f16 v[220:223], v[92:95], v[96:99], v[220:223]
    s_waitcnt lgkmcnt(0)
    v_mfma_f32_16x16x32_f16 v[208:211], v[128:131], v[176:179], v[208:211]
    ds_read_b64 v[64:65], v228 offset:3648
    v_mfma_f32_16x16x32_f16 v[212:215], v[128:131], v[180:183], v[212:215]
    ds_read_b64 v[66:67], v228 offset:3656
    v_mfma_f32_16x16x32_f16 v[216:219], v[128:131], v[184:187], v[216:219]
    ds_read_b128 v[96:99], v229 offset:96
    v_mfma_f32_16x16x32_f16 v[220:223], v[128:131], v[188:191], v[220:223]
    ds_read_b128 v[100:103], v229 offset:608
    v_mfma_f32_16x16x32_f16 v[204:207], v[128:131], v[172:175], v[204:207]
    ds_read_b128 v[104:107], v229 offset:1120
    v_mfma_f32_16x16x32_f16 v[212:215], v[132:135], v[176:179], v[212:215]
    ds_read_b128 v[108:111], v229 offset:1632
    v_mfma_f32_16x16x32_f16 v[216:219], v[132:135], v[180:183], v[216:219]
    ds_read_b128 v[112:115], v229 offset:2144
    v_mfma_f32_16x16x32_f16 v[220:223], v[132:135], v[184:187], v[220:223]
    ds_read_b128 v[116:119], v229 offset:2656
    v_mfma_f32_16x16x32_f16 v[208:211], v[132:135], v[172:175], v[208:211]
    ds_read_b128 v[120:123], v229 offset:3168
    v_mfma_f32_16x16x32_f16 v[212:215], v[136:139], v[172:175], v[212:215]
    ds_read_b128 v[124:127], v229 offset:3680
    v_mfma_f32_16x16x32_f16 v[216:219], v[136:139], v[176:179], v[216:219]
    ds_read_b64 v[68:69], v228 offset:3136
    v_mfma_f32_16x16x32_f16 v[220:223], v[136:139], v[180:183], v[220:223]
    ds_read_b64 v[70:71], v228 offset:3144
    v_mfma_f32_16x16x32_f16 v[200:203], v[128:131], v[168:171], v[200:203]
    ds_read_b64 v[72:73], v228 offset:2624
    v_mfma_f32_16x16x32_f16 v[204:207], v[132:135], v[168:171], v[204:207]
    ds_read_b64 v[74:75], v228 offset:2632
    v_mfma_f32_16x16x32_f16 v[216:219], v[140:143], v[172:175], v[216:219]
    ds_read_b64 v[76:77], v228 offset:2112
    v_mfma_f32_16x16x32_f16 v[220:223], v[140:143], v[176:179], v[220:223]
    ds_read_b64 v[78:79], v228 offset:2120
    v_mfma_f32_16x16x32_f16 v[208:211], v[136:139], v[168:171], v[208:211]
    ds_read_b64 v[80:81], v228 offset:1600
    v_mfma_f32_16x16x32_f16 v[212:215], v[140:143], v[168:171], v[212:215]
    ds_read_b64 v[82:83], v228 offset:1608
    v_mfma_f32_16x16x32_f16 v[216:219], v[144:147], v[168:171], v[216:219]
    ds_read_b64 v[84:85], v228 offset:1088
    v_mfma_f32_16x16x32_f16 v[220:223], v[144:147], v[172:175], v[220:223]
    ds_read_b64 v[86:87], v228 offset:1096
    v_mfma_f32_16x16x32_f16 v[196:199], v[128:131], v[164:167], v[196:199]
    ds_read_b64 v[88:89], v228 offset:576
    v_mfma_f32_16x16x32_f16 v[200:203], v[132:135], v[164:167], v[200:203]
    ds_read_b64 v[90:91], v228 offset:584
    v_mfma_f32_16x16x32_f16 v[204:207], v[136:139], v[164:167], v[204:207]
    ds_read_b64 v[92:93], v228 offset:64
    v_mfma_f32_16x16x32_f16 v[220:223], v[148:151], v[168:171], v[220:223]
    ds_read_b64 v[94:95], v228 offset:72
    v_mfma_f32_16x16x32_f16 v[208:211], v[140:143], v[164:167], v[208:211]
    v_mfma_f32_16x16x32_f16 v[212:215], v[144:147], v[164:167], v[212:215]
    v_mfma_f32_16x16x32_f16 v[216:219], v[148:151], v[164:167], v[216:219]
    v_mfma_f32_16x16x32_f16 v[220:223], v[152:155], v[164:167], v[220:223]
    v_mfma_f32_16x16x32_f16 v[192:195], v[128:131], v[160:163], v[192:195]
    v_mfma_f32_16x16x32_f16 v[196:199], v[132:135], v[160:163], v[196:199]
    v_mfma_f32_16x16x32_f16 v[200:203], v[136:139], v[160:163], v[200:203]
    v_mfma_f32_16x16x32_f16 v[204:207], v[140:143], v[160:163], v[204:207]
    v_mfma_f32_16x16x32_f16 v[208:211], v[144:147], v[160:163], v[208:211]
    v_mfma_f32_16x16x32_f16 v[212:215], v[148:151], v[160:163], v[212:215]
    v_mfma_f32_16x16x32_f16 v[216:219], v[152:155], v[160:163], v[216:219]
    v_mfma_f32_16x16x32_f16 v[220:223], v[156:159], v[160:163], v[220:223]
    s_waitcnt lgkmcnt(0)
    v_mfma_f32_16x16x32_f16 v[208:211], v[64:67], v[112:115], v[208:211]
    ds_read_b64 v[128:129], v228 offset:3584
    v_mfma_f32_16x16x32_f16 v[212:215], v[64:67], v[116:119], v[212:215]
    ds_read_b64 v[130:131], v228 offset:3592
    v_mfma_f32_16x16x32_f16 v[216:219], v[64:67], v[120:123], v[216:219]
    ds_read_b128 v[160:163], v229 offset:32
    v_mfma_f32_16x16x32_f16 v[220:223], v[64:67], v[124:127], v[220:223]
    ds_read_b128 v[164:167], v229 offset:544
    v_mfma_f32_16x16x32_f16 v[204:207], v[64:67], v[108:111], v[204:207]
    ds_read_b128 v[168:171], v229 offset:1056
    v_mfma_f32_16x16x32_f16 v[212:215], v[68:71], v[112:115], v[212:215]
    ds_read_b128 v[172:175], v229 offset:1568
    v_mfma_f32_16x16x32_f16 v[216:219], v[68:71], v[116:119], v[216:219]
    ds_read_b128 v[176:179], v229 offset:2080
    v_mfma_f32_16x16x32_f16 v[220:223], v[68:71], v[120:123], v[220:223]
    ds_read_b128 v[180:183], v229 offset:2592
    v_mfma_f32_16x16x32_f16 v[208:211], v[68:71], v[108:111], v[208:211]
    ds_read_b128 v[184:187], v229 offset:3104
    v_mfma_f32_16x16x32_f16 v[212:215], v[72:75], v[108:111], v[212:215]
    ds_read_b128 v[188:191], v229 offset:3616
    v_mfma_f32_16x16x32_f16 v[216:219], v[72:75], v[112:115], v[216:219]
    ds_read_b64 v[132:133], v228 offset:3072
    v_mfma_f32_16x16x32_f16 v[220:223], v[72:75], v[116:119], v[220:223]
    ds_read_b64 v[134:135], v228 offset:3080
    v_mfma_f32_16x16x32_f16 v[200:203], v[64:67], v[104:107], v[200:203]
    ds_read_b64 v[136:137], v228 offset:2560
    v_mfma_f32_16x16x32_f16 v[204:207], v[68:71], v[104:107], v[204:207]
    ds_read_b64 v[138:139], v228 offset:2568
    v_mfma_f32_16x16x32_f16 v[216:219], v[76:79], v[108:111], v[216:219]
    ds_read_b64 v[140:141], v228 offset:2048
    v_mfma_f32_16x16x32_f16 v[220:223], v[76:79], v[112:115], v[220:223]
    ds_read_b64 v[142:143], v228 offset:2056
    v_mfma_f32_16x16x32_f16 v[208:211], v[72:75], v[104:107], v[208:211]
    ds_read_b64 v[144:145], v228 offset:1536
    v_mfma_f32_16x16x32_f16 v[212:215], v[76:79], v[104:107], v[212:215]
    ds_read_b64 v[146:147], v228 offset:1544
    v_mfma_f32_16x16x32_f16 v[216:219], v[80:83], v[104:107], v[216:219]
    ds_read_b64 v[148:149], v228 offset:1024
    v_mfma_f32_16x16x32_f16 v[220:223], v[80:83], v[108:111], v[220:223]
    ds_read_b64 v[150:151], v228 offset:1032
    v_mfma_f32_16x16x32_f16 v[196:199], v[64:67], v[100:103], v[196:199]
    ds_read_b64 v[152:153], v228 offset:512
    v_mfma_f32_16x16x32_f16 v[200:203], v[68:71], v[100:103], v[200:203]
    ds_read_b64 v[154:155], v228 offset:520
    v_mfma_f32_16x16x32_f16 v[204:207], v[72:75], v[100:103], v[204:207]
    ds_read_b64 v[156:157], v228 offset:0
    v_mfma_f32_16x16x32_f16 v[220:223], v[84:87], v[104:107], v[220:223]
    ds_read_b64 v[158:159], v228 offset:8
    v_mfma_f32_16x16x32_f16 v[208:211], v[76:79], v[100:103], v[208:211]
    v_mfma_f32_16x16x32_f16 v[212:215], v[80:83], v[100:103], v[212:215]
    v_mfma_f32_16x16x32_f16 v[216:219], v[84:87], v[100:103], v[216:219]
    v_mfma_f32_16x16x32_f16 v[220:223], v[88:91], v[100:103], v[220:223]
    v_mfma_f32_16x16x32_f16 v[192:195], v[64:67], v[96:99], v[192:195]
    v_mfma_f32_16x16x32_f16 v[196:199], v[68:71], v[96:99], v[196:199]
    v_mfma_f32_16x16x32_f16 v[200:203], v[72:75], v[96:99], v[200:203]
    v_mfma_f32_16x16x32_f16 v[204:207], v[76:79], v[96:99], v[204:207]
    v_mfma_f32_16x16x32_f16 v[208:211], v[80:83], v[96:99], v[208:211]
    v_mfma_f32_16x16x32_f16 v[212:215], v[84:87], v[96:99], v[212:215]
    v_mfma_f32_16x16x32_f16 v[216:219], v[88:91], v[96:99], v[216:219]
    v_mfma_f32_16x16x32_f16 v[220:223], v[92:95], v[96:99], v[220:223]
    s_waitcnt lgkmcnt(0)
    v_mfma_f32_16x16x32_f16 v[208:211], v[128:131], v[176:179], v[208:211]
    v_mfma_f32_16x16x32_f16 v[212:215], v[128:131], v[180:183], v[212:215]
    v_mfma_f32_16x16x32_f16 v[216:219], v[128:131], v[184:187], v[216:219]
    v_mfma_f32_16x16x32_f16 v[220:223], v[128:131], v[188:191], v[220:223]
    v_mfma_f32_16x16x32_f16 v[204:207], v[128:131], v[172:175], v[204:207]
    v_mfma_f32_16x16x32_f16 v[212:215], v[132:135], v[176:179], v[212:215]
    v_mfma_f32_16x16x32_f16 v[216:219], v[132:135], v[180:183], v[216:219]
    v_mfma_f32_16x16x32_f16 v[220:223], v[132:135], v[184:187], v[220:223]
    v_mfma_f32_16x16x32_f16 v[208:211], v[132:135], v[172:175], v[208:211]
    v_mfma_f32_16x16x32_f16 v[212:215], v[136:139], v[172:175], v[212:215]
    v_mfma_f32_16x16x32_f16 v[216:219], v[136:139], v[176:179], v[216:219]
    v_mfma_f32_16x16x32_f16 v[220:223], v[136:139], v[180:183], v[220:223]
    v_mfma_f32_16x16x32_f16 v[200:203], v[128:131], v[168:171], v[200:203]
    v_mfma_f32_16x16x32_f16 v[204:207], v[132:135], v[168:171], v[204:207]
    v_mfma_f32_16x16x32_f16 v[216:219], v[140:143], v[172:175], v[216:219]
    v_mfma_f32_16x16x32_f16 v[220:223], v[140:143], v[176:179], v[220:223]
    v_mfma_f32_16x16x32_f16 v[208:211], v[136:139], v[168:171], v[208:211]
    v_mfma_f32_16x16x32_f16 v[212:215], v[140:143], v[168:171], v[212:215]
    v_mfma_f32_16x16x32_f16 v[216:219], v[144:147], v[168:171], v[216:219]
    v_mfma_f32_16x16x32_f16 v[220:223], v[144:147], v[172:175], v[220:223]
    v_mfma_f32_16x16x32_f16 v[196:199], v[128:131], v[164:167], v[196:199]
    v_mfma_f32_16x16x32_f16 v[200:203], v[132:135], v[164:167], v[200:203]
    v_mfma_f32_16x16x32_f16 v[204:207], v[136:139], v[164:167], v[204:207]
    v_mfma_f32_16x16x32_f16 v[220:223], v[148:151], v[168:171], v[220:223]
    v_mfma_f32_16x16x32_f16 v[208:211], v[140:143], v[164:167], v[208:211]
    v_mfma_f32_16x16x32_f16 v[212:215], v[144:147], v[164:167], v[212:215]
    v_mfma_f32_16x16x32_f16 v[216:219], v[148:151], v[164:167], v[216:219]
    v_mfma_f32_16x16x32_f16 v[220:223], v[152:155], v[164:167], v[220:223]
    v_mfma_f32_16x16x32_f16 v[192:195], v[128:131], v[160:163], v[192:195]
    v_mfma_f32_16x16x32_f16 v[196:199], v[132:135], v[160:163], v[196:199]
    v_mfma_f32_16x16x32_f16 v[200:203], v[136:139], v[160:163], v[200:203]
    v_mfma_f32_16x16x32_f16 v[204:207], v[140:143], v[160:163], v[204:207]
    v_mfma_f32_16x16x32_f16 v[208:211], v[144:147], v[160:163], v[208:211]
    v_mfma_f32_16x16x32_f16 v[212:215], v[148:151], v[160:163], v[212:215]
    v_mfma_f32_16x16x32_f16 v[216:219], v[152:155], v[160:163], v[216:219]
    v_mfma_f32_16x16x32_f16 v[220:223], v[156:159], v[160:163], v[220:223]
    v_mov_b32 v234, v233
    v_pk_mul_f32 v[192:193], v[192:193], v[234:235] op_sel_hi:[1,0]
    v_pk_mul_f32 v[194:195], v[194:195], v[234:235] op_sel_hi:[1,0]
    v_cvt_pk_bf16_f32 v192, v192, v193
    v_cvt_pk_bf16_f32 v193, v194, v195
    ds_write_b64 v230, v[192:193] offset:0
    v_pk_mul_f32 v[196:197], v[196:197], v[234:235] op_sel_hi:[1,0]
    v_pk_mul_f32 v[198:199], v[198:199], v[234:235] op_sel_hi:[1,0]
    v_cvt_pk_bf16_f32 v196, v196, v197
    v_cvt_pk_bf16_f32 v197, v198, v199
    ds_write_b64 v230, v[196:197] offset:512
    v_pk_mul_f32 v[200:201], v[200:201], v[234:235] op_sel_hi:[1,0]
    v_pk_mul_f32 v[202:203], v[202:203], v[234:235] op_sel_hi:[1,0]
    v_cvt_pk_bf16_f32 v200, v200, v201
    v_cvt_pk_bf16_f32 v201, v202, v203
    ds_write_b64 v230, v[200:201] offset:1024
    v_pk_mul_f32 v[204:205], v[204:205], v[234:235] op_sel_hi:[1,0]
    v_pk_mul_f32 v[206:207], v[206:207], v[234:235] op_sel_hi:[1,0]
    v_cvt_pk_bf16_f32 v204, v204, v205
    v_cvt_pk_bf16_f32 v205, v206, v207
    ds_write_b64 v230, v[204:205] offset:1536
    v_pk_mul_f32 v[208:209], v[208:209], v[234:235] op_sel_hi:[1,0]
    v_pk_mul_f32 v[210:211], v[210:211], v[234:235] op_sel_hi:[1,0]
    v_cvt_pk_bf16_f32 v208, v208, v209
    v_cvt_pk_bf16_f32 v209, v210, v211
    ds_write_b64 v230, v[208:209] offset:2048
    v_pk_mul_f32 v[212:213], v[212:213], v[234:235] op_sel_hi:[1,0]
    v_pk_mul_f32 v[214:215], v[214:215], v[234:235] op_sel_hi:[1,0]
    v_cvt_pk_bf16_f32 v212, v212, v213
    v_cvt_pk_bf16_f32 v213, v214, v215
    ds_write_b64 v230, v[212:213] offset:2560
    v_pk_mul_f32 v[216:217], v[216:217], v[234:235] op_sel_hi:[1,0]
    v_pk_mul_f32 v[218:219], v[218:219], v[234:235] op_sel_hi:[1,0]
    v_cvt_pk_bf16_f32 v216, v216, v217
    v_cvt_pk_bf16_f32 v217, v218, v219
    ds_write_b64 v230, v[216:217] offset:3072
    v_pk_mul_f32 v[220:221], v[220:221], v[234:235] op_sel_hi:[1,0]
    v_pk_mul_f32 v[222:223], v[222:223], v[234:235] op_sel_hi:[1,0]
    v_cvt_pk_bf16_f32 v220, v220, v221
    v_cvt_pk_bf16_f32 v221, v222, v223
    ds_write_b64 v230, v[220:221] offset:3584
    s_cmp_lg_u32 s3, 0
    s_cbranch_scc1 NOF
    s_cmp_ge_u32 s2, 112
    s_cbranch_scc1 NOF
    s_lshl_b32 s20, s2, 4
    s_add_u32 s20, s20, 20480
    v_mov_b32 v64, s20
    v_mov_b32 v65, 0
    s_mov_b64 exec, 1
    global_store_dword v64, v65, s[68:69] sc1
    s_mov_b64 exec, -1
NOF:
    s_branch CONV_JOIN
CONV_B:
    s_setprio 3
    v_mov_b32 v60, -1
    v_mov_b32 v61, -1
    v_mov_b32 v62, -1
    v_mov_b32 v63, -1
    v_and_b32 v52, 255, v0
    s_lshl_b32 s20, s6, 14
    s_add_u32 s20, s20, 10485760
    v_lshl_add_u32 v112, v52, 4, s20
    v_add_u32 v113, 8192, v112
    s_waitcnt lgkmcnt(0)
    v_add_u32 v114, 4096, v112
    v_add_u32 v115, 4096, v113
    s_cmp_lg_u32 s3, 4
    s_cbranch_scc1 CB_G
    s_cmp_ge_u32 s2, 5
    s_cbranch_scc1 CB_X
    s_lshl_b32 s20, s2, 14
    s_add_u32 s20, s20, 4096
    v_add_u32 v57, s20, v7
    v_add_u32 v56, 8192, v57
    global_store_dwordx4 v57, v[60:63], s[68:69] offset:-4096 sc1
    global_store_dwordx4 v57, v[60:63], s[68:69] offset:-3072 sc1
    global_store_dwordx4 v57, v[60:63], s[68:69] offset:-2048 sc1
    global_store_dwordx4 v57, v[60:63], s[68:69] offset:-1024 sc1
    global_store_dwordx4 v57, v[60:63], s[68:69] sc1
    global_store_dwordx4 v57, v[60:63], s[68:69] offset:1024 sc1
    global_store_dwordx4 v57, v[60:63], s[68:69] offset:2048 sc1
    global_store_dwordx4 v57, v[60:63], s[68:69] offset:3072 sc1
    global_store_dwordx4 v56, v[60:63], s[68:69] offset:-4096 sc1
    global_store_dwordx4 v56, v[60:63], s[68:69] offset:-3072 sc1
    global_store_dwordx4 v56, v[60:63], s[68:69] offset:-2048 sc1
    global_store_dwordx4 v56, v[60:63], s[68:69] offset:-1024 sc1
    global_store_dwordx4 v56, v[60:63], s[68:69] sc1
    global_store_dwordx4 v56, v[60:63], s[68:69] offset:1024 sc1
    global_store_dwordx4 v56, v[60:63], s[68:69] offset:2048 sc1
    global_store_dwordx4 v56, v[60:63], s[68:69] offset:3072 sc1
CB_G:
CB_X:
    s_lshl_b32 s20, s2, 2
    s_add_u32 s20, s20, s9
    s_mul_i32 s20, s20, 2304
    v_add_u32 v58, s20, v7
    v_add_u32 v59, s20, v13
    global_load_dwordx4 v[64:67], v58, s[36:37] nt
    global_load_ushort v68, v59, s[36:37] nt
    global_load_dwordx4 v[70:73], v58, s[36:37] offset:1152 nt
    global_load_ushort v74, v59, s[36:37] offset:1152 nt
    s_cmp_lg_u32 s3, 7
    s_cbranch_scc1 CB_Y
    s_mul_i32 s20, s2, 9216
    s_add_u32 s20, s20, 1052672
    v_add_u32 v57, s20, v7
    v_add_u32 v56, 4096, v57
    global_store_dwordx4 v57, v[60:63], s[68:69] offset:-4096 sc1
    global_store_dwordx4 v57, v[60:63], s[68:69] offset:-3072 sc1
    global_store_dwordx4 v57, v[60:63], s[68:69] offset:-2048 sc1
    global_store_dwordx4 v57, v[60:63], s[68:69] offset:-1024 sc1
    global_store_dwordx4 v57, v[60:63], s[68:69] sc1
    global_store_dwordx4 v57, v[60:63], s[68:69] offset:1024 sc1
    global_store_dwordx4 v57, v[60:63], s[68:69] offset:2048 sc1
    global_store_dwordx4 v57, v[60:63], s[68:69] offset:3072 sc1
    global_store_dwordx4 v56, v[60:63], s[68:69] sc1
CB_Y:
    v_mov_b32 v54, 0
    v_mov_b32 v55, 0
    s_mul_i32 s20, s9, 4640
    s_add_u32 s20, s20, 124928
    v_lshl_add_u32 v53, v1, 3, s20
    ds_write_b64 v53, v[54:55]
    s_waitcnt lgkmcnt(0)
    s_barrier
    s_load_dword s99, s[68:69], 94208
    v_and_b32 v52, 255, v0
    s_cmp_eq_u32 s3, 7
    s_cbranch_scc1 NOIF3
    s_cmp_lg_u32 s3, 4
    s_cbranch_scc1 NOIF
    s_cmp_ge_u32 s2, 5
    s_cbranch_scc1 NOIF
    s_lshl_b32 s20, s2, 2
    v_mov_b32 v54, s20
    s_mov_b64 exec, 1
    s_waitcnt vmcnt(4)
    global_store_dword v54, v60, s[66:67] sc1
    s_mov_b64 exec, -1
    s_waitcnt vmcnt(1)
    s_branch NOIF2
NOIF:
    s_waitcnt vmcnt(0)
NOIF3:
    s_waitcnt vmcnt(9)
NOIF2:
    s_mul_i32 s18, s9, 2304
    s_add_u32 s18, s18, 145024
    v_add_u32 v58, s18, v7
    v_add_u32 v59, s18, v13
    ds_write_b128 v58, v[64:67]
    ds_write_b16 v59, v68
    ds_write_b128 v58, v[70:73] offset:1152
    ds_write_b16 v59, v74 offset:1152
    v_lshlrev_b32 v80, 16, v64
    v_and_b32 v81, s12, v64
    v_lshlrev_b32 v82, 16, v65
    v_and_b32 v83, s12, v65
    v_lshlrev_b32 v84, 16, v66
    v_and_b32 v85, s12, v66
    v_lshlrev_b32 v86, 16, v67
    v_and_b32 v87, s12, v67
    v_lshlrev_b32 v88, 16, v68
    v_lshlrev_b32 v90, 16, v70
    v_and_b32 v91, s12, v70
    v_lshlrev_b32 v92, 16, v71
    v_and_b32 v93, s12, v71
    v_lshlrev_b32 v94, 16, v72
    v_and_b32 v95, s12, v72
    v_lshlrev_b32 v96, 16, v73
    v_and_b32 v97, s12, v73
    v_lshlrev_b32 v98, 16, v74
    v_readfirstlane_b32 s70, v80
    s_nop 1
    v_subrev_f32 v80, s70, v80
    v_subrev_f32 v81, s70, v81
    v_subrev_f32 v82, s70, v82
    v_subrev_f32 v83, s70, v83
    v_subrev_f32 v84, s70, v84
    v_subrev_f32 v85, s70, v85
    v_subrev_f32 v86, s70, v86
    v_subrev_f32 v87, s70, v87
    v_subrev_f32 v88, s70, v88
    v_pk_add_f32 v[100:101], v[80:81], v[82:83]
    v_pk_mul_f32 v[102:103], v[80:81], v[80:81]
    v_pk_add_f32 v[100:101], v[100:101], v[84:85]
    v_pk_fma_f32 v[102:103], v[82:83], v[82:83], v[102:103]
    v_pk_add_f32 v[100:101], v[100:101], v[86:87]
    v_pk_fma_f32 v[102:103], v[84:85], v[84:85], v[102:103]
    v_add_f32 v100, v100, v88
    v_pk_fma_f32 v[102:103], v[86:87], v[86:87], v[102:103]
    v_add_f32 v100, v100, v101
    v_fmac_f32 v102, v88, v88
    v_add_f32 v102, v102, v103
    v_readfirstlane_b32 s71, v90
    s_nop 1
    v_subrev_f32 v90, s71, v90
    v_subrev_f32 v91, s71, v91
    v_subrev_f32 v92, s71, v92
    v_subrev_f32 v93, s71, v93
    v_subrev_f32 v94, s71, v94
    v_subrev_f32 v95, s71, v95
    v_subrev_f32 v96, s71, v96
    v_subrev_f32 v97, s71, v97
    v_subrev_f32 v98, s71, v98
    v_pk_add_f32 v[104:105], v[90:91], v[92:93]
    v_pk_mul_f32 v[106:107], v[90:91], v[90:91]
    v_pk_add_f32 v[104:105], v[104:105], v[94:95]
    v_pk_fma_f32 v[106:107], v[92:93], v[92:93], v[106:107]
    v_pk_add_f32 v[104:105], v[104:105], v[96:97]
    v_pk_fma_f32 v[106:107], v[94:95], v[94:95], v[106:107]
    v_add_f32 v104, v104, v98
    v_pk_fma_f32 v[106:107], v[96:97], v[96:97], v[106:107]
    v_add_f32 v104, v104, v105
    v_fmac_f32 v106, v98, v98
    v_add_f32 v106, v106, v107
    v_permlane32_swap_b32 v100, v104
    s_nop 0
    v_permlane32_swap_b32 v102, v106
    v_add_f32 v100, v100, v104
    v_add_f32 v102, v102, v106
    s_nop 1
    v_permlane16_swap_b32 v100, v102
    v_add_f32 v100, v100, v102
    s_nop 1
    v_add_f32_dpp v100, v100, v100 row_ror:8 row_mask:0xf bank_mask:0xf
    s_nop 1
    v_add_f32_dpp v100, v100, v100 row_ror:4 row_mask:0xf bank_mask:0xf
    s_nop 1
    v_add_f32_dpp v100, v100, v100 row_ror:2 row_mask:0xf bank_mask:0xf
    s_nop 1
    v_add_f32_dpp v100, v100, v100 row_ror:1 row_mask:0xf bank_mask:0xf
    v_mov_b32 v102, v100
    s_nop 1
    v_permlane16_swap_b32 v100, v102
    v_mov_b32 v104, s70
    v_mov_b32 v105, s71
    v_cmp_gt_u32 vcc, 32, v1
    s_nop 1
    v_cndmask_b32 v104, v105, v104, vcc
    v_mul_f32 v100, 0x3ae38e39, v100
    v_mul_f32 v102, 0x3ae38e39, v102
    v_add_f32 v105, v104, v100
    v_fma_f32 v107, -v100, v100, v102
    v_max_f32 v107, 0, v107
    v_cvt_pk_bf16_f32 v107, v107, v107
    v_and_b32 v107, s12, v107
    v_add_f32 v107, 0x3727c5ac, v107
    v_cvt_pk_bf16_f32 v107, v107, v107
    v_and_b32 v107, s12, v107
    v_sqrt_f32 v106, v107
    v_cvt_pk_bf16_f32 v105, v105, v105
    v_and_b32 v105, s12, v105
    v_cvt_pk_bf16_f32 v106, v106, v106
    v_and_b32 v106, s12, v106
    v_rcp_f32 v100, v106
    v_sub_f32 v101, v104, v105
    v_mul_f32 v101, v101, v100
    v_mov_b32 v102, v100
    v_mov_b32 v103, v101
    s_nop 0
    v_permlane32_swap_b32 v100, v102
    v_permlane32_swap_b32 v101, v103
    s_mul_i32 s18, s9, 2304
    s_add_u32 s18, s18, 154240
    v_lshl_add_u32 v58, v1, 5, s18
    v_lshl_add_u32 v59, v1, 2, s18
    v_pk_fma_f32 v[80:81], v[80:81], v[100:101], v[100:101] op_sel:[0,0,1] op_sel_hi:[1,0,1]
    v_pk_fma_f32 v[82:83], v[82:83], v[100:101], v[100:101] op_sel:[0,0,1] op_sel_hi:[1,0,1]
    v_pk_fma_f32 v[84:85], v[84:85], v[100:101], v[100:101] op_sel:[0,0,1] op_sel_hi:[1,0,1]
    v_pk_fma_f32 v[86:87], v[86:87], v[100:101], v[100:101] op_sel:[0,0,1] op_sel_hi:[1,0,1]
    v_fma_f32 v88, v88, v100, v101
    v_pk_fma_f32 v[90:91], v[90:91], v[102:103], v[102:103] op_sel:[0,0,1] op_sel_hi:[1,0,1]
    v_pk_fma_f32 v[92:93], v[92:93], v[102:103], v[102:103] op_sel:[0,0,1] op_sel_hi:[1,0,1]
    v_pk_fma_f32 v[94:95], v[94:95], v[102:103], v[102:103] op_sel:[0,0,1] op_sel_hi:[1,0,1]
    v_pk_fma_f32 v[96:97], v[96:97], v[102:103], v[102:103] op_sel:[0,0,1] op_sel_hi:[1,0,1]
    v_fma_f32 v98, v98, v102, v103
    v_cvt_pkrtz_f16_f32 v64, v80, v90
    v_cvt_pkrtz_f16_f32 v65, v81, v91
    v_cvt_pkrtz_f16_f32 v66, v82, v92
    v_cvt_pkrtz_f16_f32 v67, v83, v93
    v_cvt_pkrtz_f16_f32 v68, v84, v94
    v_cvt_pkrtz_f16_f32 v69, v85, v95
    v_cvt_pkrtz_f16_f32 v70, v86, v96
    v_cvt_pkrtz_f16_f32 v71, v87, v97
    v_cvt_pkrtz_f16_f32 v72, v88, v98
    v_add_u32 v64, 0x00040004, v64
    v_add_u32 v65, 0x00040004, v65
    v_add_u32 v66, 0x00040004, v66
    v_add_u32 v67, 0x00040004, v67
    v_add_u32 v68, 0x00040004, v68
    v_add_u32 v69, 0x00040004, v69
    v_add_u32 v70, 0x00040004, v70
    v_add_u32 v71, 0x00040004, v71
    v_add_u32 v72, 0x00040004, v72
    ds_write_b128 v58, v[64:67]
    ds_write_b128 v58, v[68:71] offset:16
    ds_write_b32 v59, v72 offset:2048
    s_lshl_b32 s14, s9, 2
    s_add_u32 s14, s14, 143584
    v_mov_b32 v58, s14
    v_mov_b32 v59, 0
    v_and_b32 v104, 3, v1
    v_lshlrev_b32 v100, 4, v104
    v_lshlrev_b32 v104, 2, v104
    v_add_u32 v104, 143584, v104
    v_and_b32 v52, 255, v0
    v_lshrrev_b32 v101, 2, v52
    v_lshl_add_u32 v101, v101, 14, v100
    s_lshl_b32 s14, s2, 6
    s_add_u32 s14, s14, 10485760
    v_add_u32 v101, s14, v101
    v_add_u32 v102, 1048576, v101
    v_and_b32 v103, 15, v1
    v_lshl_add_u32 v103, s9, 4, v103
    v_lshrrev_b32 v99, 2, v103
    v_lshl_add_u32 v99, v99, 14, v100
    v_add_u32 v99, s14, v99
    v_add_u32 v99, 2097152, v99
    v_lshlrev_b32 v103, 2, v103
    v_add_u32 v103, 156288, v103
    v_lshlrev_b32 v100, 2, v52
    v_add_u32 v100, 154240, v100
IFD_4:
    ds_write_b32 v58, v59
    s_waitcnt lgkmcnt(0)
    s_add_u32 s99, s99, 1
    s_mov_b32 s98, 458759
    s_lshr_b32 s20, s99, 0
    s_and_b32 s20, s20, s98
    v_mov_b32 v108, s20
    s_lshr_b32 s20, s99, 3
    s_and_b32 s20, s20, s98
    v_mov_b32 v109, s20
    s_lshr_b32 s20, s99, 6
    s_and_b32 s20, s20, s98
    v_mov_b32 v110, s20
    s_lshr_b32 s20, s99, 9
    s_and_b32 s20, s20, s98
    v_mov_b32 v111, s20
SL_1:
    ds_read_b32 v105, v104
    s_waitcnt lgkmcnt(0)
    v_cmp_eq_u32 vcc, -1, v105
    s_cbranch_vccz SLD_2
    s_sub_u32 s10, s10, 1
    s_cbranch_scc1 EXIT
    s_branch SL_1
SLD_2:
    ds_read_b32 v80, v100 offset:0
    ds_read_b32 v81, v100 offset:2304
    ds_read_b32 v82, v100 offset:4608
    ds_read_b32 v83, v100 offset:6912
    ds_read_b32 v84, v100 offset:1024
    ds_read_b32 v85, v100 offset:3328
    ds_read_b32 v86, v100 offset:5632
    ds_read_b32 v87, v100 offset:7936
    ds_read_b32 v88, v103 offset:0
    ds_read_b32 v89, v103 offset:2304
    ds_read_b32 v90, v103 offset:4608
    ds_read_b32 v91, v103 offset:6912
    s_waitcnt lgkmcnt(8)
    v_bfi_b32 v80, s98, v108, v80
    v_bfi_b32 v81, s98, v109, v81
    v_bfi_b32 v82, s98, v110, v82
    v_bfi_b32 v83, s98, v111, v83
    global_store_dwordx4 v101, v[80:83], s[68:69] sc1
    s_waitcnt lgkmcnt(4)
    v_bfi_b32 v84, s98, v108, v84
    v_bfi_b32 v85, s98, v109, v85
    v_bfi_b32 v86, s98, v110, v86
    v_bfi_b32 v87, s98, v111, v87
    global_store_dwordx4 v102, v[84:87], s[68:69] sc1
    s_waitcnt lgkmcnt(0)
    v_bfi_b32 v88, s98, v108, v88
    v_bfi_b32 v89, s98, v109, v89
    v_bfi_b32 v90, s98, v110, v90
    v_bfi_b32 v91, s98, v111, v91
    s_mov_b64 exec, 0xffff
    global_store_dwordx4 v99, v[88:91], s[68:69] sc1
    s_mov_b64 exec, -1
    s_cmp_lg_u32 s3, 7
    s_cbranch_scc1 GIF_5
    s_lshl_b32 s20, s2, 4
    s_add_u32 s20, s20, 90112
    v_mov_b32 v92, s20
    v_mov_b32 v76, s99
    v_mov_b32 v77, s99
    v_mov_b32 v78, s99
    v_mov_b32 v79, s99
    s_mov_b64 exec, 1
    s_waitcnt vmcnt(3)
    global_store_dwordx4 v92, v[76:79], s[68:69] sc1
    s_mov_b64 exec, -1
GIF_5:
    s_setprio 0
    v_and_b32 v52, 7, v1
    v_lshlrev_b32 v52, 3, v52
    v_lshrrev_b32 v53, 4, v1
    s_mul_i32 s20, s9, 294912
    s_lshl_b32 s21, s8, 6
    s_add_u32 s20, s20, s21
    s_add_u32 s20, s20, 0
    s_mov_b32 s21, 73728
    v_mad_u32_u24 v52, v53, s21, v52
    v_add_u32 v52, s20, v52
    v_and_b32 v54, 8, v1
    v_cmp_eq_u32 vcc, 0, v54
    v_mov_b32 v54, s56
    v_mov_b32 v55, s54
    v_cndmask_b32 v54, v54, v55, vcc
    v_mov_b32 v55, s57
    v_mov_b32 v56, s55
    v_cndmask_b32 v55, v55, v56, vcc
    v_add_co_u32 v54, vcc, v54, v52
    s_nop 1
    v_addc_co_u32 v55, vcc, 0, v55, vcc
    s_mov_b32 s20, 9216
    s_mov_b32 s21, 0
    s_mov_b32 s22, 1115136
    s_mov_b32 s23, 0
    global_load_dwordx2 v[128:129], v[54:55], off nt
    v_lshl_add_u64 v[54:55], v[54:55], 0, s[20:21]
    global_load_dwordx2 v[130:131], v[54:55], off nt
    v_lshl_add_u64 v[54:55], v[54:55], 0, s[20:21]
    global_load_dwordx2 v[132:133], v[54:55], off nt
    v_lshl_add_u64 v[54:55], v[54:55], 0, s[20:21]
    global_load_dwordx2 v[134:135], v[54:55], off nt
    v_lshl_add_u64 v[54:55], v[54:55], 0, s[20:21]
    global_load_dwordx2 v[136:137], v[54:55], off nt
    v_lshl_add_u64 v[54:55], v[54:55], 0, s[20:21]
    global_load_dwordx2 v[138:139], v[54:55], off nt
    v_lshl_add_u64 v[54:55], v[54:55], 0, s[20:21]
    global_load_dwordx2 v[140:141], v[54:55], off nt
    v_lshl_add_u64 v[54:55], v[54:55], 0, s[20:21]
    global_load_dwordx2 v[142:143], v[54:55], off nt
W5_6:
    v_and_b32 v52, 255, v0
    v_and_b32 v54, 3, v1
    s_movk_i32 s18, 4640
    v_mul_u32_u24 v55, s18, v54
    v_lshrrev_b32 v53, 2, v52
    v_lshl_add_u32 v55, v53, 4, v55
    v_add_u32 v55, 125440, v55
    s_lshl_b32 s18, s6, 4
    s_add_u32 s18, s18, 81920
    v_lshl_add_u32 v54, v54, 2, s18
    s_waitcnt vmcnt(0) lgkmcnt(0)
    global_load_dwordx4 v[64:67], v112, s[68:69] sc1
    global_load_dwordx4 v[68:71], v114, s[68:69] sc1
    global_load_dwordx4 v[72:75], v113, s[68:69] sc1
    global_load_dwordx4 v[76:79], v115, s[68:69] sc1
    global_load_dword v56, v54, s[68:69] sc1
    global_load_dword v57, v54, s[68:69] offset:2304 sc1
    s_waitcnt vmcnt(2)
NP:
    v_xor_b32 v176, v64, v108
    v_xor_b32 v177, v65, v109
    v_xor_b32 v178, v66, v110
    v_xor_b32 v179, v67, v111
    v_xor_b32 v180, v68, v108
    v_xor_b32 v181, v69, v109
    v_xor_b32 v182, v70, v110
    v_xor_b32 v183, v71, v111
    v_xor_b32 v184, v72, v108
    v_xor_b32 v185, v73, v109
    v_xor_b32 v186, v74, v110
    v_xor_b32 v187, v75, v111
    v_xor_b32 v188, v76, v108
    v_xor_b32 v189, v77, v109
    v_xor_b32 v190, v78, v110
    v_xor_b32 v191, v79, v111
    v_or3_b32 v80, v176, v177, v178
    v_or3_b32 v81, v179, v180, v181
    v_or3_b32 v82, v182, v183, v184
    v_or3_b32 v83, v185, v186, v187
    v_or3_b32 v84, v188, v189, v190
    v_or3_b32 v80, v80, v81, v82
    v_or3_b32 v83, v83, v84, v191
    v_or_b32 v80, v80, v83
    v_and_b32 v80, s98, v80
    s_nop 1
    v_or_b32_dpp v80, v80, v80 quad_perm:[1,0,3,2] row_mask:0xf bank_mask:0xf
    s_nop 1
    v_or_b32_dpp v80, v80, v80 quad_perm:[2,3,0,1] row_mask:0xf bank_mask:0xf
    v_cmp_ne_u32 vcc, 0, v80
    s_cbranch_vccz NPD
    s_mov_b64 exec, vcc
    global_load_dwordx4 v[64:67], v112, s[68:69] sc1
    global_load_dwordx4 v[68:71], v114, s[68:69] sc1
    global_load_dwordx4 v[72:75], v113, s[68:69] sc1
    global_load_dwordx4 v[76:79], v115, s[68:69] sc1
    s_mov_b64 exec, -1
    s_waitcnt vmcnt(0)
    s_sub_u32 s10, s10, 1
    s_cbranch_scc1 EXIT
    s_branch NP
NPD:
    s_waitcnt vmcnt(0)
MDP:
    v_xor_b32 v58, s99, v56
    v_xor_b32 v59, s99, v57
    v_or_b32 v58, v58, v59
    v_lshlrev_b32 v58, 16, v58
    v_cmp_ne_u32 vcc, 0, v58
    s_cbranch_vccz MDPD
    global_load_dword v56, v54, s[68:69] sc1
    global_load_dword v57, v54, s[68:69] offset:2304 sc1
    s_waitcnt vmcnt(0)
    s_sub_u32 s10, s10, 1
    s_cbranch_scc1 EXIT
    s_branch MDP
MDPD:
    v_and_b32 v58, s12, v57
    v_and_b32 v59, s12, v56
    v_add_f32 v58, 1.0, v58
    v_cvt_pk_bf16_f32 v58, v58, v58
    v_and_b32 v58, s12, v58
    v_cvt_pk_f16_f32 v58, v58, v59
    v_pk_fma_f16 v64, v176, v58, v58 op_sel:[0,0,1] op_sel_hi:[1,0,1]
    v_pk_fma_f16 v65, v177, v58, v58 op_sel:[0,0,1] op_sel_hi:[1,0,1]
    v_pk_fma_f16 v66, v178, v58, v58 op_sel:[0,0,1] op_sel_hi:[1,0,1]
    v_pk_fma_f16 v67, v179, v58, v58 op_sel:[0,0,1] op_sel_hi:[1,0,1]
    ds_write_b128 v55, v[64:67] offset:0
    v_pk_fma_f16 v68, v180, v58, v58 op_sel:[0,0,1] op_sel_hi:[1,0,1]
    v_pk_fma_f16 v69, v181, v58, v58 op_sel:[0,0,1] op_sel_hi:[1,0,1]
    v_pk_fma_f16 v70, v182, v58, v58 op_sel:[0,0,1] op_sel_hi:[1,0,1]
    v_pk_fma_f16 v71, v183, v58, v58 op_sel:[0,0,1] op_sel_hi:[1,0,1]
    ds_write_b128 v55, v[68:71] offset:1024
    v_pk_fma_f16 v72, v184, v58, v58 op_sel:[0,0,1] op_sel_hi:[1,0,1]
    v_pk_fma_f16 v73, v185, v58, v58 op_sel:[0,0,1] op_sel_hi:[1,0,1]
    v_pk_fma_f16 v74, v186, v58, v58 op_sel:[0,0,1] op_sel_hi:[1,0,1]
    v_pk_fma_f16 v75, v187, v58, v58 op_sel:[0,0,1] op_sel_hi:[1,0,1]
    ds_write_b128 v55, v[72:75] offset:2048
    v_pk_fma_f16 v76, v188, v58, v58 op_sel:[0,0,1] op_sel_hi:[1,0,1]
    v_pk_fma_f16 v77, v189, v58, v58 op_sel:[0,0,1] op_sel_hi:[1,0,1]
    v_pk_fma_f16 v78, v190, v58, v58 op_sel:[0,0,1] op_sel_hi:[1,0,1]
    v_pk_fma_f16 v79, v191, v58, v58 op_sel:[0,0,1] op_sel_hi:[1,0,1]
    ds_write_b128 v55, v[76:79] offset:3072
    s_waitcnt lgkmcnt(0)
    s_barrier
    s_load_dwordx8 s[28:35], s[66:67], 0
    global_load_dwordx4 v[8:11], v7, s[52:53]
    global_load_ushort v12, v13, s[52:53]
    v_mov_b32 v60, -1
    v_mov_b32 v61, -1
    v_mov_b32 v62, -1
    v_mul_u32_u24 v59, 12, v1
    v_mov_b32 v63, -1
    s_mul_i32 s20, s2, 3
    s_add_u32 s20, s20, s9
    s_mul_i32 s20, s20, 1152
    s_add_u32 s20, s20, 4193152
    v_add_u32 v57, s20, v7
    v_add_u32 v58, s20, v13
    s_cmp_eq_u32 s3, 4
    s_cbranch_scc1 LI1
    global_store_dwordx4 v57, v[60:63], s[68:69] sc1
    global_store_short v58, v60, s[68:69] sc1
LI1:
    s_mul_i32 s20, s6, 18432
    s_mul_i32 s21, s9, 4608
    s_add_u32 s20, s20, s21
    s_add_u32 s20, s20, 7342336
    v_add_u32 v58, s20, v59
    global_store_dwordx3 v58, v[60:62], s[68:69] offset:-2304 sc1
    global_store_dwordx3 v58, v[60:62], s[68:69] offset:-1536 sc1
    global_store_dwordx3 v58, v[60:62], s[68:69] offset:-768 sc1
    global_store_dwordx3 v58, v[60:62], s[68:69] sc1
    global_store_dwordx3 v58, v[60:62], s[68:69] offset:768 sc1
    global_store_dwordx3 v58, v[60:62], s[68:69] offset:1536 sc1
    s_waitcnt lgkmcnt(0)
    s_and_b64 s[28:29], s[28:29], s[30:31]
    s_and_b32 s28, s28, s32
    s_and_b32 s28, s28, s29
    s_cmp_lg_u32 s28, 0
    s_cbranch_scc1 GOK_7
    v_min_u32 v59, 4, v1
    v_lshlrev_b32 v59, 2, v59
    global_load_dword v58, v59, s[66:67] sc1
GO_8:
    s_waitcnt vmcnt(0)
    v_cmp_eq_u32 vcc, 0, v58
    s_cbranch_vccz GOD_9
    global_load_dword v58, v59, s[66:67] sc1
    s_sub_u32 s10, s10, 1
    s_cbranch_scc1 EXIT
    s_branch GO_8
GOD_9:
GOK_7:
    s_lshl_b32 s20, s9, 10
    s_add_u32 s20, s20, 90112
    v_add_u32 v80, s20, v7
    global_load_dwordx4 v[76:79], v80, s[68:69]
    v_and_b32 v52, 7, v1
    v_lshlrev_b32 v52, 3, v52
    v_lshrrev_b32 v53, 4, v1
    s_mul_i32 s20, s9, 294912
    s_lshl_b32 s21, s8, 6
    s_add_u32 s20, s20, s21
    s_add_u32 s20, s20, 1179648
    s_mov_b32 s21, 73728
    v_mad_u32_u24 v52, v53, s21, v52
    v_add_u32 v52, s20, v52
    v_and_b32 v54, 8, v1
    v_cmp_eq_u32 vcc, 0, v54
    v_mov_b32 v54, s56
    v_mov_b32 v55, s54
    v_cndmask_b32 v54, v54, v55, vcc
    v_mov_b32 v55, s57
    v_mov_b32 v56, s55
    v_cndmask_b32 v55, v55, v56, vcc
    v_add_co_u32 v54, vcc, v54, v52
    s_nop 1
    v_addc_co_u32 v55, vcc, 0, v55, vcc
    s_mov_b32 s20, 9216
    s_mov_b32 s21, 0
    s_mov_b32 s22, 1115136
    s_mov_b32 s23, 0
    global_load_dwordx2 v[144:145], v[54:55], off nt
    v_lshl_add_u64 v[54:55], v[54:55], 0, s[20:21]
    global_load_dwordx2 v[146:147], v[54:55], off nt
    v_lshl_add_u64 v[54:55], v[54:55], 0, s[20:21]
    global_load_dwordx2 v[148:149], v[54:55], off nt
    v_lshl_add_u64 v[54:55], v[54:55], 0, s[20:21]
    global_load_dwordx2 v[150:151], v[54:55], off nt
    v_lshl_add_u64 v[54:55], v[54:55], 0, s[20:21]
    global_load_dwordx2 v[152:153], v[54:55], off nt
    v_lshl_add_u64 v[54:55], v[54:55], 0, s[20:21]
    global_load_dwordx2 v[154:155], v[54:55], off nt
    v_lshl_add_u64 v[54:55], v[54:55], 0, s[20:21]
    global_load_dwordx2 v[156:157], v[54:55], off nt
    v_lshl_add_u64 v[54:55], v[54:55], 0, s[20:21]
    global_load_dwordx2 v[158:159], v[54:55], off nt
    v_lshl_add_u64 v[54:55], v[54:55], 0, s[22:23]
    global_load_dwordx2 v[160:161], v[54:55], off nt
    v_lshl_add_u64 v[54:55], v[54:55], 0, s[20:21]
    global_load_dwordx2 v[162:163], v[54:55], off nt
    v_lshl_add_u64 v[54:55], v[54:55], 0, s[20:21]
    global_load_dwordx2 v[164:165], v[54:55], off nt
    v_lshl_add_u64 v[54:55], v[54:55], 0, s[20:21]
    global_load_dwordx2 v[166:167], v[54:55], off nt
    v_lshl_add_u64 v[54:55], v[54:55], 0, s[20:21]
    global_load_dwordx2 v[168:169], v[54:55], off nt
    v_lshl_add_u64 v[54:55], v[54:55], 0, s[20:21]
    global_load_dwordx2 v[170:171], v[54:55], off nt
    v_lshl_add_u64 v[54:55], v[54:55], 0, s[20:21]
    global_load_dwordx2 v[172:173], v[54:55], off nt
    v_lshl_add_u64 v[54:55], v[54:55], 0, s[20:21]
    global_load_dwordx2 v[174:175], v[54:55], off nt
W5_10:
    s_waitcnt vmcnt(16)
GIP:
    v_cmp_ne_u32 vcc, s99, v76
    v_cmp_ne_u32 s[20:21], s99, v77
    v_cmp_ne_u32 s[22:23], s99, v78
    v_cmp_ne_u32 s[24:25], s99, v79
    s_or_b64 vcc, vcc, s[20:21]
    s_or_b64 s[22:23], s[22:23], s[24:25]
    s_or_b64 vcc, vcc, s[22:23]
    s_cbranch_vccz GIPD
    global_load_dwordx4 v[76:79], v80, s[68:69] sc1
    s_waitcnt vmcnt(0)
    s_sub_u32 s10, s10, 1
    s_cbranch_scc1 EXIT
    s_branch GIP
GIPD:
CONV_JOIN:
    v_and_b32 v56, 3, v0
    v_lshrrev_b32 v57, 2, v0
    s_mov_b32 s20, 31296
    v_mul_u32_u24 v58, s20, v56
    v_lshl_add_u32 v58, v57, 4, v58
    s_movk_i32 s20, 9216
    v_mul_u32_u24 v59, s20, v57
    v_lshl_add_u32 v59, v56, 4, v59
    s_lshl_b32 s20, s6, 6
    s_add_u32 s20, s20, 1048576
    v_add_u32 v59, s20, v59
    v_add_u32 v60, 1179648, v59
    s_waitcnt lgkmcnt(0)
    s_barrier
    ds_read_b128 v[64:67], v58
    ds_read_b128 v[68:71], v58 offset:2048
    s_waitcnt lgkmcnt(1)
    global_store_dwordx4 v59, v[64:67], s[68:69] sc1
    s_waitcnt lgkmcnt(0)
    global_store_dwordx4 v60, v[68:71], s[68:69] sc1
    v_add_u32 v52, 8192, v7
    v_add_u32 v53, 8192, v13
    v_add_u32 v54, 2304, v52
    v_add_u32 v55, 2304, v53
    global_load_dwordx4 v[106:109], v54, s[68:69]
    global_load_ushort v110, v55, s[68:69]
    v_add_u32 v54, 3456, v52
    v_add_u32 v55, 3456, v53
    global_load_dwordx4 v[20:23], v54, s[68:69]
    global_load_ushort v24, v55, s[68:69]
    v_add_u32 v54, 4608, v52
    v_add_u32 v55, 4608, v53
    global_load_dwordx4 v[14:17], v54, s[68:69]
    global_load_ushort v18, v55, s[68:69]
    v_add_u32 v54, 5760, v52
    v_add_u32 v55, 5760, v53
    global_load_dwordx4 v[26:29], v54, s[68:69]
    global_load_ushort v30, v55, s[68:69]
    s_waitcnt vmcnt(0)
MC_11:
    v_or_b32 v53, s12, v24
    v_or_b32 v54, s12, v18
    v_or_b32 v55, s12, v30
    v_or_b32 v56, s12, v110
    v_max3_u32 v52, v20, v21, v22
    v_max3_u32 v52, v52, v23, v14
    v_max3_u32 v52, v52, v15, v16
    v_max3_u32 v52, v52, v17, v26
    v_max3_u32 v52, v52, v27, v28
    v_max3_u32 v52, v52, v29, v106
    v_max3_u32 v52, v52, v107, v108
    v_max3_u32 v52, v52, v109, v53
    v_max3_u32 v52, v52, v54, v55
    v_max_u32 v52, v52, v56
    v_cmp_eq_u32 vcc, -1, v52
    s_cbranch_vccz MCD_12
    v_add_u32 v52, 8192, v7
    v_add_u32 v53, 8192, v13
    v_add_u32 v54, 2304, v52
    v_add_u32 v55, 2304, v53
    global_load_dwordx4 v[106:109], v54, s[68:69] sc1
    global_load_ushort v110, v55, s[68:69] sc1
    v_add_u32 v54, 3456, v52
    v_add_u32 v55, 3456, v53
    global_load_dwordx4 v[20:23], v54, s[68:69] sc1
    global_load_ushort v24, v55, s[68:69] sc1
    v_add_u32 v54, 4608, v52
    v_add_u32 v55, 4608, v53
    global_load_dwordx4 v[14:17], v54, s[68:69] sc1
    global_load_ushort v18, v55, s[68:69] sc1
    v_add_u32 v54, 5760, v52
    v_add_u32 v55, 5760, v53
    global_load_dwordx4 v[26:29], v54, s[68:69] sc1
    global_load_ushort v30, v55, s[68:69] sc1
    s_waitcnt vmcnt(0)
    s_sub_u32 s10, s10, 1
    s_cbranch_scc1 EXIT
    s_branch MC_11
MCD_12:
    v_lshlrev_b32 v32, 16, v14
    v_and_b32 v33, s12, v14
    v_lshlrev_b32 v34, 16, v15
    v_and_b32 v35, s12, v15
    v_lshlrev_b32 v36, 16, v16
    v_and_b32 v37, s12, v16
    v_lshlrev_b32 v38, 16, v17
    v_and_b32 v39, s12, v17
    v_lshlrev_b32 v40, 16, v18
    v_lshlrev_b32 v42, 16, v20
    v_and_b32 v43, s12, v20
    v_lshlrev_b32 v44, 16, v21
    v_and_b32 v45, s12, v21
    v_lshlrev_b32 v46, 16, v22
    v_and_b32 v47, s12, v22
    v_lshlrev_b32 v48, 16, v23
    v_and_b32 v49, s12, v23
    v_lshlrev_b32 v50, 16, v24
    v_pk_add_f32 v[32:33], v[32:33], 1.0 op_sel_hi:[1,0]
    v_pk_add_f32 v[34:35], v[34:35], 1.0 op_sel_hi:[1,0]
    v_pk_add_f32 v[36:37], v[36:37], 1.0 op_sel_hi:[1,0]
    v_pk_add_f32 v[38:39], v[38:39], 1.0 op_sel_hi:[1,0]
    v_add_f32 v40, 1.0, v40
    v_cvt_pk_bf16_f32 v52, v32, v33
    v_cvt_pk_bf16_f32 v53, v34, v35
    v_cvt_pk_bf16_f32 v54, v36, v37
    v_cvt_pk_bf16_f32 v55, v38, v39
    v_cvt_pk_bf16_f32 v56, v40, v40
    v_lshlrev_b32 v32, 16, v52
    v_and_b32 v33, s12, v52
    v_lshlrev_b32 v34, 16, v53
    v_and_b32 v35, s12, v53
    v_lshlrev_b32 v36, 16, v54
    v_and_b32 v37, s12, v54
    v_lshlrev_b32 v38, 16, v55
    v_and_b32 v39, s12, v55
    v_lshlrev_b32 v40, 16, v56
    s_branch GPOLL
NONCONV:
    s_cmp_lt_u32 s3, 4
    s_cbranch_scc1 NC_A0
    v_mov_b32 v60, -1
    v_mov_b32 v61, -1
    v_mov_b32 v62, -1
    v_mov_b32 v63, -1
    s_waitcnt lgkmcnt(0)
    s_lshl_b32 s20, s2, 2
    s_add_u32 s20, s20, s9
    s_mul_i32 s20, s20, 2304
    v_add_u32 v58, s20, v7
    v_add_u32 v59, s20, v13
    global_load_dwordx4 v[64:67], v58, s[36:37] nt
    global_load_ushort v68, v59, s[36:37] nt
    global_load_dwordx4 v[70:73], v58, s[36:37] offset:1152 nt
    global_load_ushort v74, v59, s[36:37] offset:1152 nt
    s_cmp_lg_u32 s3, 7
    s_cbranch_scc1 NC_B0
    s_mul_i32 s20, s2, 9216
    s_add_u32 s20, s20, 1052672
    v_add_u32 v57, s20, v7
    v_add_u32 v56, 4096, v57
    global_store_dwordx4 v57, v[60:63], s[68:69] offset:-4096 sc1
    global_store_dwordx4 v57, v[60:63], s[68:69] offset:-3072 sc1
    global_store_dwordx4 v57, v[60:63], s[68:69] offset:-2048 sc1
    global_store_dwordx4 v57, v[60:63], s[68:69] offset:-1024 sc1
    global_store_dwordx4 v57, v[60:63], s[68:69] sc1
    global_store_dwordx4 v57, v[60:63], s[68:69] offset:1024 sc1
    global_store_dwordx4 v57, v[60:63], s[68:69] offset:2048 sc1
    global_store_dwordx4 v57, v[60:63], s[68:69] offset:3072 sc1
    global_store_dwordx4 v56, v[60:63], s[68:69] sc1
NC_B0:
    s_barrier
    s_load_dword s99, s[68:69], 94208
    s_cmp_eq_u32 s3, 7
    s_cbranch_scc1 NC_B1
    s_waitcnt vmcnt(0)
NC_B1:
    s_waitcnt vmcnt(9)
    s_mul_i32 s18, s9, 2304
    s_add_u32 s18, s18, 145024
    v_add_u32 v58, s18, v7
    v_add_u32 v59, s18, v13
    ds_write_b128 v58, v[64:67]
    ds_write_b16 v59, v68
    ds_write_b128 v58, v[70:73] offset:1152
    ds_write_b16 v59, v74 offset:1152
    v_lshlrev_b32 v80, 16, v64
    v_and_b32 v81, s12, v64
    v_lshlrev_b32 v82, 16, v65
    v_and_b32 v83, s12, v65
    v_lshlrev_b32 v84, 16, v66
    v_and_b32 v85, s12, v66
    v_lshlrev_b32 v86, 16, v67
    v_and_b32 v87, s12, v67
    v_lshlrev_b32 v88, 16, v68
    v_lshlrev_b32 v90, 16, v70
    v_and_b32 v91, s12, v70
    v_lshlrev_b32 v92, 16, v71
    v_and_b32 v93, s12, v71
    v_lshlrev_b32 v94, 16, v72
    v_and_b32 v95, s12, v72
    v_lshlrev_b32 v96, 16, v73
    v_and_b32 v97, s12, v73
    v_lshlrev_b32 v98, 16, v74
    v_readfirstlane_b32 s70, v80
    s_nop 1
    v_subrev_f32 v80, s70, v80
    v_subrev_f32 v81, s70, v81
    v_subrev_f32 v82, s70, v82
    v_subrev_f32 v83, s70, v83
    v_subrev_f32 v84, s70, v84
    v_subrev_f32 v85, s70, v85
    v_subrev_f32 v86, s70, v86
    v_subrev_f32 v87, s70, v87
    v_subrev_f32 v88, s70, v88
    v_pk_add_f32 v[100:101], v[80:81], v[82:83]
    v_pk_mul_f32 v[102:103], v[80:81], v[80:81]
    v_pk_add_f32 v[100:101], v[100:101], v[84:85]
    v_pk_fma_f32 v[102:103], v[82:83], v[82:83], v[102:103]
    v_pk_add_f32 v[100:101], v[100:101], v[86:87]
    v_pk_fma_f32 v[102:103], v[84:85], v[84:85], v[102:103]
    v_add_f32 v100, v100, v88
    v_pk_fma_f32 v[102:103], v[86:87], v[86:87], v[102:103]
    v_add_f32 v100, v100, v101
    v_fmac_f32 v102, v88, v88
    v_add_f32 v102, v102, v103
    v_readfirstlane_b32 s71, v90
    s_nop 1
    v_subrev_f32 v90, s71, v90
    v_subrev_f32 v91, s71, v91
    v_subrev_f32 v92, s71, v92
    v_subrev_f32 v93, s71, v93
    v_subrev_f32 v94, s71, v94
    v_subrev_f32 v95, s71, v95
    v_subrev_f32 v96, s71, v96
    v_subrev_f32 v97, s71, v97
    v_subrev_f32 v98, s71, v98
    v_pk_add_f32 v[104:105], v[90:91], v[92:93]
    v_pk_mul_f32 v[106:107], v[90:91], v[90:91]
    v_pk_add_f32 v[104:105], v[104:105], v[94:95]
    v_pk_fma_f32 v[106:107], v[92:93], v[92:93], v[106:107]
    v_pk_add_f32 v[104:105], v[104:105], v[96:97]
    v_pk_fma_f32 v[106:107], v[94:95], v[94:95], v[106:107]
    v_add_f32 v104, v104, v98
    v_pk_fma_f32 v[106:107], v[96:97], v[96:97], v[106:107]
    v_add_f32 v104, v104, v105
    v_fmac_f32 v106, v98, v98
    v_add_f32 v106, v106, v107
    v_permlane32_swap_b32 v100, v104
    s_nop 0
    v_permlane32_swap_b32 v102, v106
    v_add_f32 v100, v100, v104
    v_add_f32 v102, v102, v106
    s_nop 1
    v_permlane16_swap_b32 v100, v102
    v_add_f32 v100, v100, v102
    s_nop 1
    v_add_f32_dpp v100, v100, v100 row_ror:8 row_mask:0xf bank_mask:0xf
    s_nop 1
    v_add_f32_dpp v100, v100, v100 row_ror:4 row_mask:0xf bank_mask:0xf
    s_nop 1
    v_add_f32_dpp v100, v100, v100 row_ror:2 row_mask:0xf bank_mask:0xf
    s_nop 1
    v_add_f32_dpp v100, v100, v100 row_ror:1 row_mask:0xf bank_mask:0xf
    v_mov_b32 v102, v100
    s_nop 1
    v_permlane16_swap_b32 v100, v102
    v_mov_b32 v104, s70
    v_mov_b32 v105, s71
    v_cmp_gt_u32 vcc, 32, v1
    s_nop 1
    v_cndmask_b32 v104, v105, v104, vcc
    v_mul_f32 v100, 0x3ae38e39, v100
    v_mul_f32 v102, 0x3ae38e39, v102
    v_add_f32 v105, v104, v100
    v_fma_f32 v107, -v100, v100, v102
    v_max_f32 v107, 0, v107
    v_cvt_pk_bf16_f32 v107, v107, v107
    v_and_b32 v107, s12, v107
    v_add_f32 v107, 0x3727c5ac, v107
    v_cvt_pk_bf16_f32 v107, v107, v107
    v_and_b32 v107, s12, v107
    v_sqrt_f32 v106, v107
    v_cvt_pk_bf16_f32 v105, v105, v105
    v_and_b32 v105, s12, v105
    v_cvt_pk_bf16_f32 v106, v106, v106
    v_and_b32 v106, s12, v106
    v_rcp_f32 v100, v106
    v_sub_f32 v101, v104, v105
    v_mul_f32 v101, v101, v100
    v_mov_b32 v102, v100
    v_mov_b32 v103, v101
    s_nop 0
    v_permlane32_swap_b32 v100, v102
    v_permlane32_swap_b32 v101, v103
    s_mul_i32 s18, s9, 2304
    s_add_u32 s18, s18, 154240
    v_lshl_add_u32 v58, v1, 5, s18
    v_lshl_add_u32 v59, v1, 2, s18
    v_pk_fma_f32 v[80:81], v[80:81], v[100:101], v[100:101] op_sel:[0,0,1] op_sel_hi:[1,0,1]
    v_pk_fma_f32 v[82:83], v[82:83], v[100:101], v[100:101] op_sel:[0,0,1] op_sel_hi:[1,0,1]
    v_pk_fma_f32 v[84:85], v[84:85], v[100:101], v[100:101] op_sel:[0,0,1] op_sel_hi:[1,0,1]
    v_pk_fma_f32 v[86:87], v[86:87], v[100:101], v[100:101] op_sel:[0,0,1] op_sel_hi:[1,0,1]
    v_fma_f32 v88, v88, v100, v101
    v_pk_fma_f32 v[90:91], v[90:91], v[102:103], v[102:103] op_sel:[0,0,1] op_sel_hi:[1,0,1]
    v_pk_fma_f32 v[92:93], v[92:93], v[102:103], v[102:103] op_sel:[0,0,1] op_sel_hi:[1,0,1]
    v_pk_fma_f32 v[94:95], v[94:95], v[102:103], v[102:103] op_sel:[0,0,1] op_sel_hi:[1,0,1]
    v_pk_fma_f32 v[96:97], v[96:97], v[102:103], v[102:103] op_sel:[0,0,1] op_sel_hi:[1,0,1]
    v_fma_f32 v98, v98, v102, v103
    v_cvt_pkrtz_f16_f32 v64, v80, v90
    v_cvt_pkrtz_f16_f32 v65, v81, v91
    v_cvt_pkrtz_f16_f32 v66, v82, v92
    v_cvt_pkrtz_f16_f32 v67, v83, v93
    v_cvt_pkrtz_f16_f32 v68, v84, v94
    v_cvt_pkrtz_f16_f32 v69, v85, v95
    v_cvt_pkrtz_f16_f32 v70, v86, v96
    v_cvt_pkrtz_f16_f32 v71, v87, v97
    v_cvt_pkrtz_f16_f32 v72, v88, v98
    v_add_u32 v64, 0x00040004, v64
    v_add_u32 v65, 0x00040004, v65
    v_add_u32 v66, 0x00040004, v66
    v_add_u32 v67, 0x00040004, v67
    v_add_u32 v68, 0x00040004, v68
    v_add_u32 v69, 0x00040004, v69
    v_add_u32 v70, 0x00040004, v70
    v_add_u32 v71, 0x00040004, v71
    v_add_u32 v72, 0x00040004, v72
    ds_write_b128 v58, v[64:67]
    ds_write_b128 v58, v[68:71] offset:16
    ds_write_b32 v59, v72 offset:2048
    s_lshl_b32 s14, s9, 2
    s_add_u32 s14, s14, 143584
    v_mov_b32 v58, s14
    v_mov_b32 v59, 0
    v_and_b32 v104, 3, v1
    v_lshlrev_b32 v100, 4, v104
    v_lshlrev_b32 v104, 2, v104
    v_add_u32 v104, 143584, v104
    v_and_b32 v52, 255, v0
    v_lshrrev_b32 v101, 2, v52
    v_lshl_add_u32 v101, v101, 14, v100
    s_lshl_b32 s14, s2, 6
    s_add_u32 s14, s14, 10485760
    v_add_u32 v101, s14, v101
    v_add_u32 v102, 1048576, v101
    v_and_b32 v103, 15, v1
    v_lshl_add_u32 v103, s9, 4, v103
    v_lshrrev_b32 v99, 2, v103
    v_lshl_add_u32 v99, v99, 14, v100
    v_add_u32 v99, s14, v99
    v_add_u32 v99, 2097152, v99
    v_lshlrev_b32 v103, 2, v103
    v_add_u32 v103, 156288, v103
    v_lshlrev_b32 v100, 2, v52
    v_add_u32 v100, 154240, v100
IFD_16:
    ds_write_b32 v58, v59
    s_waitcnt lgkmcnt(0)
    s_add_u32 s99, s99, 1
    s_mov_b32 s98, 458759
    s_lshr_b32 s20, s99, 0
    s_and_b32 s20, s20, s98
    v_mov_b32 v108, s20
    s_lshr_b32 s20, s99, 3
    s_and_b32 s20, s20, s98
    v_mov_b32 v109, s20
    s_lshr_b32 s20, s99, 6
    s_and_b32 s20, s20, s98
    v_mov_b32 v110, s20
    s_lshr_b32 s20, s99, 9
    s_and_b32 s20, s20, s98
    v_mov_b32 v111, s20
SL_13:
    ds_read_b32 v105, v104
    s_waitcnt lgkmcnt(0)
    v_cmp_eq_u32 vcc, -1, v105
    s_cbranch_vccz SLD_14
    s_sub_u32 s10, s10, 1
    s_cbranch_scc1 EXIT
    s_branch SL_13
SLD_14:
    ds_read_b32 v80, v100 offset:0
    ds_read_b32 v81, v100 offset:2304
    ds_read_b32 v82, v100 offset:4608
    ds_read_b32 v83, v100 offset:6912
    ds_read_b32 v84, v100 offset:1024
    ds_read_b32 v85, v100 offset:3328
    ds_read_b32 v86, v100 offset:5632
    ds_read_b32 v87, v100 offset:7936
    ds_read_b32 v88, v103 offset:0
    ds_read_b32 v89, v103 offset:2304
    ds_read_b32 v90, v103 offset:4608
    ds_read_b32 v91, v103 offset:6912
    s_waitcnt lgkmcnt(8)
    v_bfi_b32 v80, s98, v108, v80
    v_bfi_b32 v81, s98, v109, v81
    v_bfi_b32 v82, s98, v110, v82
    v_bfi_b32 v83, s98, v111, v83
    global_store_dwordx4 v101, v[80:83], s[68:69] sc1
    s_waitcnt lgkmcnt(4)
    v_bfi_b32 v84, s98, v108, v84
    v_bfi_b32 v85, s98, v109, v85
    v_bfi_b32 v86, s98, v110, v86
    v_bfi_b32 v87, s98, v111, v87
    global_store_dwordx4 v102, v[84:87], s[68:69] sc1
    s_waitcnt lgkmcnt(0)
    v_bfi_b32 v88, s98, v108, v88
    v_bfi_b32 v89, s98, v109, v89
    v_bfi_b32 v90, s98, v110, v90
    v_bfi_b32 v91, s98, v111, v91
    s_mov_b64 exec, 0xffff
    global_store_dwordx4 v99, v[88:91], s[68:69] sc1
    s_mov_b64 exec, -1
    s_cmp_lg_u32 s3, 7
    s_cbranch_scc1 GIF_17
    s_lshl_b32 s20, s2, 4
    s_add_u32 s20, s20, 90112
    v_mov_b32 v92, s20
    v_mov_b32 v76, s99
    v_mov_b32 v77, s99
    v_mov_b32 v78, s99
    v_mov_b32 v79, s99
    s_mov_b64 exec, 1
    s_waitcnt vmcnt(3)
    global_store_dwordx4 v92, v[76:79], s[68:69] sc1
    s_mov_b64 exec, -1
GIF_17:
    s_barrier
    s_sub_u32 s20, s5, 18
    s_cmp_ge_u32 s20, 5
    s_cbranch_scc1 PFM
    s_mul_i32 s21, s9, 5
    s_add_u32 s20, s20, s21
    s_cmp_ge_u32 s20, 18
    s_cbranch_scc1 PFM
    s_add_u32 s20, s20, 18
    s_mul_i32 s22, s4, 1152
    s_movk_i32 s24, 7282
    s_movk_i32 s25, 9216-9*128
    v_lshl_add_u32 v64, s20, 6, v1
    v_mul_u32_u24 v65, s24, v64
    v_lshrrev_b32 v65, 16, v65
    v_lshl_add_u32 v64, v64, 7, s22
    v_mad_u32_u24 v64, v65, s25, v64
    global_load_dword v65, v64, s[54:55] nt
    global_load_dword v66, v64, s[56:57] nt
    s_add_u32 s20, s20, 18
    s_mul_i32 s22, s4, 1152
    s_movk_i32 s24, 7282
    s_movk_i32 s25, 9216-9*128
    v_lshl_add_u32 v68, s20, 6, v1
    v_mul_u32_u24 v69, s24, v68
    v_lshrrev_b32 v69, 16, v69
    v_lshl_add_u32 v68, v68, 7, s22
    v_mad_u32_u24 v68, v69, s25, v68
    global_load_dword v69, v68, s[54:55] nt
    global_load_dword v70, v68, s[56:57] nt
PFM:
    s_barrier
    global_load_dwordx4 v[8:11], v7, s[52:53]
    global_load_ushort v12, v13, s[52:53]
    v_mov_b32 v60, -1
    v_mov_b32 v61, -1
    v_mov_b32 v62, -1
    v_mul_u32_u24 v59, 12, v1
    v_mov_b32 v63, -1
    s_mul_i32 s20, s2, 3
    s_add_u32 s20, s20, s9
    s_mul_i32 s20, s20, 1152
    s_add_u32 s20, s20, 4193152
    v_add_u32 v57, s20, v7
    v_add_u32 v58, s20, v13
    s_cmp_eq_u32 s3, 4
    s_cbranch_scc1 LI0
    global_store_dwordx4 v57, v[60:63], s[68:69] sc1
    global_store_short v58, v60, s[68:69] sc1
LI0:
    s_branch NC_A2
NC_A0:
    s_cmp_lt_u32 s7, 108
    s_cbranch_scc1 NC_MOD1
    s_waitcnt lgkmcnt(0)
    s_barrier
    s_barrier
    s_barrier
    s_branch NC_A1
NC_MOD1:
    v_lshrrev_b32 v52, 2, v1
    s_mul_i32 s20, s3, 144
    v_add_u32 v52, s20, v52
    v_lshlrev_b32 v53, 1, v52
    s_movk_i32 s20, 6912
    v_mul_u32_u24 v52, s20, v52
    v_and_b32 v54, 3, v1
    s_lshl_b32 s21, s7, 6
    v_lshl_add_u32 v54, v54, 4, s21
    v_add_u32 v52, v52, v54
    s_waitcnt lgkmcnt(0)
    global_load_ushort v148, v53, s[60:61]
    global_load_ushort v149, v53, s[60:61] offset:32
    global_load_ushort v150, v53, s[60:61] offset:64
    global_load_ushort v151, v53, s[60:61] offset:96
    global_load_ushort v152, v53, s[60:61] offset:128
    global_load_ushort v153, v53, s[60:61] offset:160
    global_load_ushort v154, v53, s[60:61] offset:192
    global_load_ushort v155, v53, s[60:61] offset:224
    global_load_ushort v156, v53, s[60:61] offset:256
    s_barrier
    s_load_dword s99, s[68:69], 94208
    s_cmp_lt_u32 s7, 36
    s_cbranch_scc1 NC_CR
    s_barrier
    s_barrier
NC_CR:
    global_load_dwordx4 v[112:115], v52, s[62:63] nt
    v_add_u32 v52, 110592, v52
    global_load_dwordx4 v[116:119], v52, s[62:63] nt
    v_add_u32 v52, 110592, v52
    global_load_dwordx4 v[120:123], v52, s[62:63] nt
    v_add_u32 v52, 110592, v52
    global_load_dwordx4 v[124:127], v52, s[62:63] nt
    v_add_u32 v52, 110592, v52
    global_load_dwordx4 v[128:131], v52, s[62:63] nt
    v_add_u32 v52, 110592, v52
    global_load_dwordx4 v[132:135], v52, s[62:63] nt
    v_add_u32 v52, 110592, v52
    global_load_dwordx4 v[136:139], v52, s[62:63] nt
    v_add_u32 v52, 110592, v52
    global_load_dwordx4 v[140:143], v52, s[62:63] nt
    v_add_u32 v52, 110592, v52
    global_load_dwordx4 v[144:147], v52, s[62:63] nt
    s_waitcnt vmcnt(9)
    v_lshlrev_b32 v148, 16, v148
    v_mul_f32 v64, 0xbfb8aa3b, v148
    v_exp_f32 v64, v64
    v_lshlrev_b32 v149, 16, v149
    v_mul_f32 v65, 0xbfb8aa3b, v149
    v_exp_f32 v65, v65
    v_lshlrev_b32 v150, 16, v150
    v_mul_f32 v66, 0xbfb8aa3b, v150
    v_exp_f32 v66, v66
    v_lshlrev_b32 v151, 16, v151
    v_mul_f32 v67, 0xbfb8aa3b, v151
    v_exp_f32 v67, v67
    v_lshlrev_b32 v152, 16, v152
    v_mul_f32 v68, 0xbfb8aa3b, v152
    v_exp_f32 v68, v68
    v_lshlrev_b32 v153, 16, v153
    v_mul_f32 v69, 0xbfb8aa3b, v153
    v_exp_f32 v69, v69
    v_lshlrev_b32 v154, 16, v154
    v_mul_f32 v70, 0xbfb8aa3b, v154
    v_exp_f32 v70, v70
    v_lshlrev_b32 v155, 16, v155
    v_mul_f32 v71, 0xbfb8aa3b, v155
    v_exp_f32 v71, v71
    v_lshlrev_b32 v156, 16, v156
    v_mul_f32 v72, 0xbfb8aa3b, v156
    v_exp_f32 v72, v72
    v_add_f32 v64, 1.0, v64
    v_rcp_f32 v64, v64
    v_add_f32 v65, 1.0, v65
    v_rcp_f32 v65, v65
    v_add_f32 v66, 1.0, v66
    v_rcp_f32 v66, v66
    v_add_f32 v67, 1.0, v67
    v_rcp_f32 v67, v67
    v_add_f32 v68, 1.0, v68
    v_rcp_f32 v68, v68
    v_add_f32 v69, 1.0, v69
    v_rcp_f32 v69, v69
    v_add_f32 v70, 1.0, v70
    v_rcp_f32 v70, v70
    v_add_f32 v71, 1.0, v71
    v_rcp_f32 v71, v71
    v_add_f32 v72, 1.0, v72
    v_rcp_f32 v72, v72
    v_mul_f32 v64, v148, v64
    v_mul_f32 v65, v149, v65
    v_mul_f32 v66, v150, v66
    v_mul_f32 v67, v151, v67
    v_mul_f32 v68, v152, v68
    v_mul_f32 v69, v153, v69
    v_mul_f32 v70, v154, v70
    v_mul_f32 v71, v155, v71
    v_mul_f32 v72, v156, v72
    v_cvt_pk_bf16_f32 v80, v64, v64
    v_and_b32 v80, s12, v80
    v_cvt_pk_bf16_f32 v82, v65, v65
    v_and_b32 v82, s12, v82
    v_cvt_pk_bf16_f32 v84, v66, v66
    v_and_b32 v84, s12, v84
    v_cvt_pk_bf16_f32 v86, v67, v67
    v_and_b32 v86, s12, v86
    v_cvt_pk_bf16_f32 v88, v68, v68
    v_and_b32 v88, s12, v88
    v_cvt_pk_bf16_f32 v90, v69, v69
    v_and_b32 v90, s12, v90
    v_cvt_pk_bf16_f32 v92, v70, v70
    v_and_b32 v92, s12, v92
    v_cvt_pk_bf16_f32 v94, v71, v71
    v_and_b32 v94, s12, v94
    v_cvt_pk_bf16_f32 v96, v72, v72
    v_and_b32 v96, s12, v96
    s_waitcnt vmcnt(8)
    v_lshlrev_b32 v64, 16, v112
    v_and_b32 v65, s12, v112
    v_lshlrev_b32 v66, 16, v113
    v_and_b32 v67, s12, v113
    v_lshlrev_b32 v68, 16, v114
    v_and_b32 v69, s12, v114
    v_lshlrev_b32 v70, 16, v115
    v_and_b32 v71, s12, v115
    v_pk_mul_f32 v[160:161], v[64:65], v[80:81] op_sel_hi:[1,0]
    v_pk_mul_f32 v[162:163], v[66:67], v[80:81] op_sel_hi:[1,0]
    v_pk_mul_f32 v[164:165], v[68:69], v[80:81] op_sel_hi:[1,0]
    v_pk_mul_f32 v[166:167], v[70:71], v[80:81] op_sel_hi:[1,0]
    s_waitcnt vmcnt(7)
    v_lshlrev_b32 v64, 16, v116
    v_and_b32 v65, s12, v116
    v_lshlrev_b32 v66, 16, v117
    v_and_b32 v67, s12, v117
    v_lshlrev_b32 v68, 16, v118
    v_and_b32 v69, s12, v118
    v_lshlrev_b32 v70, 16, v119
    v_and_b32 v71, s12, v119
    v_pk_fma_f32 v[160:161], v[64:65], v[82:83], v[160:161] op_sel_hi:[1,0,1]
    v_pk_fma_f32 v[162:163], v[66:67], v[82:83], v[162:163] op_sel_hi:[1,0,1]
    v_pk_fma_f32 v[164:165], v[68:69], v[82:83], v[164:165] op_sel_hi:[1,0,1]
    v_pk_fma_f32 v[166:167], v[70:71], v[82:83], v[166:167] op_sel_hi:[1,0,1]
    s_waitcnt vmcnt(6)
    v_lshlrev_b32 v64, 16, v120
    v_and_b32 v65, s12, v120
    v_lshlrev_b32 v66, 16, v121
    v_and_b32 v67, s12, v121
    v_lshlrev_b32 v68, 16, v122
    v_and_b32 v69, s12, v122
    v_lshlrev_b32 v70, 16, v123
    v_and_b32 v71, s12, v123
    v_pk_fma_f32 v[160:161], v[64:65], v[84:85], v[160:161] op_sel_hi:[1,0,1]
    v_pk_fma_f32 v[162:163], v[66:67], v[84:85], v[162:163] op_sel_hi:[1,0,1]
    v_pk_fma_f32 v[164:165], v[68:69], v[84:85], v[164:165] op_sel_hi:[1,0,1]
    v_pk_fma_f32 v[166:167], v[70:71], v[84:85], v[166:167] op_sel_hi:[1,0,1]
    s_waitcnt vmcnt(5)
    v_lshlrev_b32 v64, 16, v124
    v_and_b32 v65, s12, v124
    v_lshlrev_b32 v66, 16, v125
    v_and_b32 v67, s12, v125
    v_lshlrev_b32 v68, 16, v126
    v_and_b32 v69, s12, v126
    v_lshlrev_b32 v70, 16, v127
    v_and_b32 v71, s12, v127
    v_pk_fma_f32 v[160:161], v[64:65], v[86:87], v[160:161] op_sel_hi:[1,0,1]
    v_pk_fma_f32 v[162:163], v[66:67], v[86:87], v[162:163] op_sel_hi:[1,0,1]
    v_pk_fma_f32 v[164:165], v[68:69], v[86:87], v[164:165] op_sel_hi:[1,0,1]
    v_pk_fma_f32 v[166:167], v[70:71], v[86:87], v[166:167] op_sel_hi:[1,0,1]
    s_waitcnt vmcnt(4)
    v_lshlrev_b32 v64, 16, v128
    v_and_b32 v65, s12, v128
    v_lshlrev_b32 v66, 16, v129
    v_and_b32 v67, s12, v129
    v_lshlrev_b32 v68, 16, v130
    v_and_b32 v69, s12, v130
    v_lshlrev_b32 v70, 16, v131
    v_and_b32 v71, s12, v131
    v_pk_fma_f32 v[160:161], v[64:65], v[88:89], v[160:161] op_sel_hi:[1,0,1]
    v_pk_fma_f32 v[162:163], v[66:67], v[88:89], v[162:163] op_sel_hi:[1,0,1]
    v_pk_fma_f32 v[164:165], v[68:69], v[88:89], v[164:165] op_sel_hi:[1,0,1]
    v_pk_fma_f32 v[166:167], v[70:71], v[88:89], v[166:167] op_sel_hi:[1,0,1]
    v_min_u32 v75, 4, v1
    v_lshlrev_b32 v75, 2, v75
    s_cmp_eq_u32 s3, 0
    s_cselect_b64 exec, -1, 0
    global_load_dword v74, v75, s[66:67] sc1
    s_mov_b64 exec, -1
    s_waitcnt vmcnt(4)
    v_lshlrev_b32 v64, 16, v132
    v_and_b32 v65, s12, v132
    v_lshlrev_b32 v66, 16, v133
    v_and_b32 v67, s12, v133
    v_lshlrev_b32 v68, 16, v134
    v_and_b32 v69, s12, v134
    v_lshlrev_b32 v70, 16, v135
    v_and_b32 v71, s12, v135
    v_pk_fma_f32 v[160:161], v[64:65], v[90:91], v[160:161] op_sel_hi:[1,0,1]
    v_pk_fma_f32 v[162:163], v[66:67], v[90:91], v[162:163] op_sel_hi:[1,0,1]
    v_pk_fma_f32 v[164:165], v[68:69], v[90:91], v[164:165] op_sel_hi:[1,0,1]
    v_pk_fma_f32 v[166:167], v[70:71], v[90:91], v[166:167] op_sel_hi:[1,0,1]
    s_waitcnt vmcnt(3)
    v_lshlrev_b32 v64, 16, v136
    v_and_b32 v65, s12, v136
    v_lshlrev_b32 v66, 16, v137
    v_and_b32 v67, s12, v137
    v_lshlrev_b32 v68, 16, v138
    v_and_b32 v69, s12, v138
    v_lshlrev_b32 v70, 16, v139
    v_and_b32 v71, s12, v139
    v_pk_fma_f32 v[160:161], v[64:65], v[92:93], v[160:161] op_sel_hi:[1,0,1]
    v_pk_fma_f32 v[162:163], v[66:67], v[92:93], v[162:163] op_sel_hi:[1,0,1]
    v_pk_fma_f32 v[164:165], v[68:69], v[92:93], v[164:165] op_sel_hi:[1,0,1]
    v_pk_fma_f32 v[166:167], v[70:71], v[92:93], v[166:167] op_sel_hi:[1,0,1]
    s_waitcnt vmcnt(2)
    v_lshlrev_b32 v64, 16, v140
    v_and_b32 v65, s12, v140
    v_lshlrev_b32 v66, 16, v141
    v_and_b32 v67, s12, v141
    v_lshlrev_b32 v68, 16, v142
    v_and_b32 v69, s12, v142
    v_lshlrev_b32 v70, 16, v143
    v_and_b32 v71, s12, v143
    v_pk_fma_f32 v[160:161], v[64:65], v[94:95], v[160:161] op_sel_hi:[1,0,1]
    v_pk_fma_f32 v[162:163], v[66:67], v[94:95], v[162:163] op_sel_hi:[1,0,1]
    v_pk_fma_f32 v[164:165], v[68:69], v[94:95], v[164:165] op_sel_hi:[1,0,1]
    v_pk_fma_f32 v[166:167], v[70:71], v[94:95], v[166:167] op_sel_hi:[1,0,1]
    s_waitcnt vmcnt(1)
    v_lshlrev_b32 v64, 16, v144
    v_and_b32 v65, s12, v144
    v_lshlrev_b32 v66, 16, v145
    v_and_b32 v67, s12, v145
    v_lshlrev_b32 v68, 16, v146
    v_and_b32 v69, s12, v146
    v_lshlrev_b32 v70, 16, v147
    v_and_b32 v71, s12, v147
    v_pk_fma_f32 v[160:161], v[64:65], v[96:97], v[160:161] op_sel_hi:[1,0,1]
    v_pk_fma_f32 v[162:163], v[66:67], v[96:97], v[162:163] op_sel_hi:[1,0,1]
    v_pk_fma_f32 v[164:165], v[68:69], v[96:97], v[164:165] op_sel_hi:[1,0,1]
    v_pk_fma_f32 v[166:167], v[70:71], v[96:97], v[166:167] op_sel_hi:[1,0,1]
    s_nop 0
    v_permlane32_swap_b32 v160, v164
    v_permlane32_swap_b32 v161, v165
    v_permlane32_swap_b32 v162, v166
    v_permlane32_swap_b32 v163, v167
    v_pk_add_f32 v[160:161], v[160:161], v[164:165]
    v_pk_add_f32 v[162:163], v[162:163], v[166:167]
    s_nop 1
    v_permlane16_swap_b32 v160, v162
    v_permlane16_swap_b32 v161, v163
    v_pk_add_f32 v[160:161], v[160:161], v[162:163]
    s_nop 1
    v_add_f32_dpp v160, v160, v160 row_ror:4 row_mask:0xf bank_mask:0xf
    v_add_f32_dpp v161, v161, v161 row_ror:4 row_mask:0xf bank_mask:0xf
    s_nop 0
    v_add_f32_dpp v160, v160, v160 row_ror:8 row_mask:0xf bank_mask:0xf
    v_add_f32_dpp v161, v161, v161 row_ror:8 row_mask:0xf bank_mask:0xf
    v_and_b32 v64, 3, v1
    v_lshlrev_b32 v64, 5, v64
    v_lshrrev_b32 v65, 4, v1
    v_lshl_add_u32 v64, v65, 3, v64
    s_lshl_b32 s18, s3, 7
    s_add_u32 s18, s18, 144000
    v_add_u32 v64, s18, v64
    s_lshl_b32 s18, s3, 2
    s_add_u32 s18, s18, 143568
    v_mov_b32 v66, s18
    v_mov_b32 v67, 0
    s_mov_b32 exec_lo, 0x000f000f
    s_mov_b32 exec_hi, 0x000f000f
    ds_write_b64 v64, v[160:161]
    ds_write_b32 v66, v67
    s_mov_b64 exec, -1
    s_cmp_lg_u32 s3, 0
    s_cbranch_scc1 NC_A1
    v_and_b32 v64, 15, v1
    v_lshlrev_b32 v65, 3, v64
    v_add_u32 v65, 144000, v65
    v_and_b32 v66, 3, v1
    v_lshlrev_b32 v66, 2, v66
    v_add_u32 v66, 143568, v66
    s_lshl_b32 s18, s7, 6
    s_add_u32 s18, s18, 8192
    v_lshl_add_u32 v64, v64, 2, s18
MRP:
    ds_read_b32 v67, v66
    ds_read_b64 v[80:81], v65 offset:0
    ds_read_b64 v[82:83], v65 offset:128
    ds_read_b64 v[84:85], v65 offset:256
    ds_read_b64 v[86:87], v65 offset:384
    s_waitcnt lgkmcnt(0)
    v_cmp_eq_u32 vcc, -1, v67
    s_cbranch_vccz MRD
    s_sub_u32 s10, s10, 1
    s_cbranch_scc1 EXIT
    s_branch MRP
MRD:
    v_pk_add_f32 v[80:81], v[80:81], v[84:85]
    v_pk_add_f32 v[82:83], v[82:83], v[86:87]
    v_pk_add_f32 v[80:81], v[80:81], v[82:83]
    v_cvt_pk_bf16_f32 v66, v80, v81
    s_cmp_ge_u32 s7, 36
    s_cbranch_scc1 MUT
    s_add_u32 s99, s99, 1
    s_and_b32 s20, s99, 0xffff
    v_lshl_or_b32 v80, v66, 16, s20
    v_mov_b32 v81, s20
    v_and_or_b32 v81, v66, s12, v81
    v_lshlrev_b32 v64, 1, v64
    v_add_u32 v64, 65536, v64
    s_mov_b64 exec, 0xffff
    global_store_dwordx2 v64, v[80:81], s[68:69] sc1
    s_branch MUD
MUT:
    v_min_u32 v66, -2, v66
GO_18:
    s_waitcnt vmcnt(0)
    v_cmp_eq_u32 vcc, 0, v74
    s_cbranch_vccz GOD_19
    global_load_dword v74, v75, s[66:67] sc1
    s_sub_u32 s10, s10, 1
    s_cbranch_scc1 EXIT
    s_branch GO_18
GOD_19:
    s_mov_b64 exec, 0xffff
    global_store_dword v64, v66, s[68:69] sc1
MUD:
    s_mov_b64 exec, -1
NC_A1:
    global_load_dwordx4 v[8:11], v7, s[52:53]
    global_load_ushort v12, v13, s[52:53]
    s_cmp_ge_u32 s7, 36
    s_cbranch_scc1 NC_A2
    s_barrier
    s_barrier
NC_A2:
    s_barrier
    s_sub_u32 s20, s5, 23
    s_cbranch_scc1 PF_E
    s_mul_i32 s21, s3, 9
    s_add_u32 s20, s20, s21
    s_cmp_ge_u32 s20, 27
    s_cbranch_scc1 PF_D
    s_add_u32 s20, s20, 54
    s_mul_i32 s22, s4, 1152
    s_movk_i32 s24, 7282
    s_movk_i32 s25, 9216-9*128
    v_lshl_add_u32 v92, s20, 6, v1
    v_mul_u32_u24 v93, s24, v92
    v_lshrrev_b32 v93, 16, v93
    v_lshl_add_u32 v92, v92, 7, s22
    v_mad_u32_u24 v92, v93, s25, v92
    global_load_dword v93, v92, s[54:55] nt
    global_load_dword v94, v92, s[56:57] nt
    s_branch PF_E
PF_D:
    s_sub_u32 s20, s20, 27
    s_mul_i32 s23, s4, 663552
    v_lshl_add_u32 v92, s20, 6, v1
    v_lshl_add_u32 v95, v92, 7, s23
    global_load_dword v96, v95, s[58:59] nt
    s_cmp_ge_u32 s20, 36
    s_cbranch_scc1 PF_E
    v_add_u32 v95, 368640, v95
    global_load_dword v97, v95, s[58:59] nt
PF_E:
NC_A4:
    s_cmp_lg_u32 s3, 4
    s_cbranch_scc1 NC_FD
    s_lshl_b32 s20, s2, 4
    s_add_u32 s20, s20, 18176
    v_mov_b32 v52, s20
    s_waitcnt vmcnt(0)
    v_min_u32 v55, 4, v1
    v_lshlrev_b32 v55, 2, v55
    global_load_dword v54, v55, s[66:67] sc1
GO_20:
    s_waitcnt vmcnt(0)
    v_cmp_eq_u32 vcc, 0, v54
    s_cbranch_vccz GOD_21
    global_load_dword v54, v55, s[66:67] sc1
    s_sub_u32 s10, s10, 1
    s_cbranch_scc1 EXIT
    s_branch GO_20
GOD_21:
NC_FP:
    global_load_dword v53, v52, s[68:69] sc1
    s_waitcnt vmcnt(0)
    v_cmp_eq_u32 vcc, -1, v53
    s_cbranch_vccz NC_FD
    s_sub_u32 s10, s10, 1
    s_cbranch_scc1 EXIT
    s_branch NC_FP
NC_FD:
    s_barrier
    v_add_u32 v52, 8192, v7
    v_add_u32 v53, 8192, v13
    v_add_u32 v54, 2304, v52
    v_add_u32 v55, 2304, v53
    global_load_dwordx4 v[106:109], v54, s[68:69]
    global_load_ushort v110, v55, s[68:69]
    v_add_u32 v54, 3456, v52
    v_add_u32 v55, 3456, v53
    global_load_dwordx4 v[20:23], v54, s[68:69]
    global_load_ushort v24, v55, s[68:69]
    v_add_u32 v54, 4608, v52
    v_add_u32 v55, 4608, v53
    global_load_dwordx4 v[14:17], v54, s[68:69]
    global_load_ushort v18, v55, s[68:69]
    v_add_u32 v54, 5760, v52
    v_add_u32 v55, 5760, v53
    global_load_dwordx4 v[26:29], v54, s[68:69]
    global_load_ushort v30, v55, s[68:69]
    s_waitcnt vmcnt(0)
MC_22:
    v_or_b32 v53, s12, v24
    v_or_b32 v54, s12, v18
    v_or_b32 v55, s12, v30
    v_or_b32 v56, s12, v110
    v_max3_u32 v52, v20, v21, v22
    v_max3_u32 v52, v52, v23, v14
    v_max3_u32 v52, v52, v15, v16
    v_max3_u32 v52, v52, v17, v26
    v_max3_u32 v52, v52, v27, v28
    v_max3_u32 v52, v52, v29, v106
    v_max3_u32 v52, v52, v107, v108
    v_max3_u32 v52, v52, v109, v53
    v_max3_u32 v52, v52, v54, v55
    v_max_u32 v52, v52, v56
    v_cmp_eq_u32 vcc, -1, v52
    s_cbranch_vccz MCD_23
    v_add_u32 v52, 8192, v7
    v_add_u32 v53, 8192, v13
    v_add_u32 v54, 2304, v52
    v_add_u32 v55, 2304, v53
    global_load_dwordx4 v[106:109], v54, s[68:69] sc1
    global_load_ushort v110, v55, s[68:69] sc1
    v_add_u32 v54, 3456, v52
    v_add_u32 v55, 3456, v53
    global_load_dwordx4 v[20:23], v54, s[68:69] sc1
    global_load_ushort v24, v55, s[68:69] sc1
    v_add_u32 v54, 4608, v52
    v_add_u32 v55, 4608, v53
    global_load_dwordx4 v[14:17], v54, s[68:69] sc1
    global_load_ushort v18, v55, s[68:69] sc1
    v_add_u32 v54, 5760, v52
    v_add_u32 v55, 5760, v53
    global_load_dwordx4 v[26:29], v54, s[68:69] sc1
    global_load_ushort v30, v55, s[68:69] sc1
    s_waitcnt vmcnt(0)
    s_sub_u32 s10, s10, 1
    s_cbranch_scc1 EXIT
    s_branch MC_22
MCD_23:
    v_lshlrev_b32 v32, 16, v14
    v_and_b32 v33, s12, v14
    v_lshlrev_b32 v34, 16, v15
    v_and_b32 v35, s12, v15
    v_lshlrev_b32 v36, 16, v16
    v_and_b32 v37, s12, v16
    v_lshlrev_b32 v38, 16, v17
    v_and_b32 v39, s12, v17
    v_lshlrev_b32 v40, 16, v18
    v_lshlrev_b32 v42, 16, v20
    v_and_b32 v43, s12, v20
    v_lshlrev_b32 v44, 16, v21
    v_and_b32 v45, s12, v21
    v_lshlrev_b32 v46, 16, v22
    v_and_b32 v47, s12, v22
    v_lshlrev_b32 v48, 16, v23
    v_and_b32 v49, s12, v23
    v_lshlrev_b32 v50, 16, v24
    v_pk_add_f32 v[32:33], v[32:33], 1.0 op_sel_hi:[1,0]
    v_pk_add_f32 v[34:35], v[34:35], 1.0 op_sel_hi:[1,0]
    v_pk_add_f32 v[36:37], v[36:37], 1.0 op_sel_hi:[1,0]
    v_pk_add_f32 v[38:39], v[38:39], 1.0 op_sel_hi:[1,0]
    v_add_f32 v40, 1.0, v40
    v_cvt_pk_bf16_f32 v52, v32, v33
    v_cvt_pk_bf16_f32 v53, v34, v35
    v_cvt_pk_bf16_f32 v54, v36, v37
    v_cvt_pk_bf16_f32 v55, v38, v39
    v_cvt_pk_bf16_f32 v56, v40, v40
    v_lshlrev_b32 v32, 16, v52
    v_and_b32 v33, s12, v52
    v_lshlrev_b32 v34, 16, v53
    v_and_b32 v35, s12, v53
    v_lshlrev_b32 v36, 16, v54
    v_and_b32 v37, s12, v54
    v_lshlrev_b32 v38, 16, v55
    v_and_b32 v39, s12, v55
    v_lshlrev_b32 v40, 16, v56
GPOLL:
    s_mul_i32 s20, s2, 9216
    s_add_u32 s20, s20, 1048576
    v_lshl_add_u32 v52, v0, 4, s20
    v_and_b32 v53, 7, v1
    v_lshl_add_u32 v53, s3, 3, v53
    v_add_u32 v53, 512, v53
    v_lshlrev_b32 v55, 2, v53
    v_lshl_add_u32 v53, v53, 4, s20
    v_lshlrev_b32 v54, 2, v0
    global_load_dwordx4 v[64:67], v52, s[68:69] sc1
    global_load_dwordx4 v[68:71], v53, s[68:69] sc1
    s_mul_i32 s20, s3, 1152
    s_add_u32 s20, s20, 145024
    v_add_u32 v56, s20, v7
    v_add_u32 v57, s20, v13
    ds_read_b128 v[2:5], v56
    ds_read_u16 v6, v57
    s_waitcnt lgkmcnt(0)
    v_lshlrev_b32 v80, 16, v2
    v_and_b32 v81, s12, v2
    v_lshlrev_b32 v82, 16, v3
    v_and_b32 v83, s12, v3
    v_lshlrev_b32 v84, 16, v4
    v_and_b32 v85, s12, v4
    v_lshlrev_b32 v86, 16, v5
    v_and_b32 v87, s12, v5
    v_lshlrev_b32 v88, 16, v6
    v_lshlrev_b32 v96, 16, v106
    v_and_b32 v97, s12, v106
    v_lshlrev_b32 v98, 16, v107
    v_and_b32 v99, s12, v107
    v_lshlrev_b32 v100, 16, v108
    v_and_b32 v101, s12, v108
    v_lshlrev_b32 v102, 16, v109
    v_and_b32 v103, s12, v109
    v_lshlrev_b32 v104, 16, v110
    s_waitcnt vmcnt(0)
GP:
    v_max3_u32 v72, v64, v65, v66
    v_max3_u32 v72, v72, v67, v68
    v_max3_u32 v72, v72, v69, v70
    v_max_u32 v72, v72, v71
    v_cmp_eq_u32 vcc, -1, v72
    s_cbranch_vccz GPD
    s_mov_b64 exec, vcc
    global_load_dwordx4 v[64:67], v52, s[68:69] sc1
    global_load_dwordx4 v[68:71], v53, s[68:69] sc1
    s_mov_b64 exec, -1
    s_waitcnt vmcnt(0)
    s_sub_u32 s10, s10, 1
    s_cbranch_scc1 EXIT
    s_branch GP
GPD:
    ds_write_b32 v54, v64 offset:8192
    ds_write_b32 v54, v65 offset:10496
    ds_write_b32 v54, v66 offset:12800
    ds_write_b32 v54, v67 offset:15104
    s_mov_b64 exec, 0xff
    ds_write_b32 v55, v68 offset:8192
    ds_write_b32 v55, v69 offset:10496
    ds_write_b32 v55, v70 offset:12800
    ds_write_b32 v55, v71 offset:15104
    s_mov_b64 exec, -1
    s_lshr_b32 s20, s3, 1
    s_mul_i32 s20, s20, 2304
    v_lshl_add_u32 v52, v1, 5, s20
    v_lshl_add_u32 v53, v1, 2, s20
    s_mov_b32 s21, 0x01000c0c
    s_bitcmp1_b32 s3, 0
    s_cselect_b32 s21, 0x03020c0c, s21
    s_mul_i32 s22, s2, 3456
    s_add_u32 s23, s22, 4194304
    v_add_u32 v56, s23, v7
    v_add_u32 v57, s23, v13
    s_waitcnt lgkmcnt(0)
    s_barrier
    ds_read_b128 v[64:67], v52 offset:8192
    ds_read_b128 v[68:71], v52 offset:8208
    ds_read_b32 v72, v53 offset:10240
    s_waitcnt lgkmcnt(0)
    v_perm_b32 v64, v64, v64, s21
    v_perm_b32 v65, v65, v65, s21
    v_perm_b32 v66, v66, v66, s21
    v_perm_b32 v67, v67, v67, s21
    v_perm_b32 v68, v68, v68, s21
    v_perm_b32 v69, v69, v69, s21
    v_perm_b32 v70, v70, v70, s21
    v_perm_b32 v71, v71, v71, s21
    v_perm_b32 v72, v72, v72, s21
    v_pk_fma_f32 v[64:65], v[64:65], v[96:97], v[80:81]
    v_pk_fma_f32 v[66:67], v[66:67], v[98:99], v[82:83]
    v_pk_fma_f32 v[68:69], v[68:69], v[100:101], v[84:85]
    v_pk_fma_f32 v[70:71], v[70:71], v[102:103], v[86:87]
    v_fma_f32 v72, v72, v104, v88
    v_cvt_pk_bf16_f32 v2, v64, v65
    v_cvt_pk_bf16_f32 v3, v66, v67
    v_cvt_pk_bf16_f32 v4, v68, v69
    v_cvt_pk_bf16_f32 v5, v70, v71
    v_cvt_pk_bf16_f32 v6, v72, v72
    v_lshlrev_b32 v64, 16, v2
    v_and_b32 v65, s12, v2
    v_lshlrev_b32 v66, 16, v3
    v_and_b32 v67, s12, v3
    v_lshlrev_b32 v68, 16, v4
    v_and_b32 v69, s12, v4
    v_lshlrev_b32 v70, 16, v5
    v_and_b32 v71, s12, v5
    v_lshlrev_b32 v72, 16, v6
    v_readfirstlane_b32 s24, v64
    s_nop 1
    v_subrev_f32 v64, s24, v64
    v_subrev_f32 v65, s24, v65
    v_subrev_f32 v66, s24, v66
    v_subrev_f32 v67, s24, v67
    v_subrev_f32 v68, s24, v68
    v_subrev_f32 v69, s24, v69
    v_subrev_f32 v70, s24, v70
    v_subrev_f32 v71, s24, v71
    v_subrev_f32 v72, s24, v72
    v_pk_add_f32 v[74:75], v[64:65], v[66:67]
    v_pk_mul_f32 v[76:77], v[64:65], v[64:65]
    v_pk_add_f32 v[74:75], v[74:75], v[68:69]
    v_pk_fma_f32 v[76:77], v[66:67], v[66:67], v[76:77]
    v_pk_add_f32 v[74:75], v[74:75], v[70:71]
    v_pk_fma_f32 v[76:77], v[68:69], v[68:69], v[76:77]
    v_add_f32 v74, v74, v72
    v_pk_fma_f32 v[76:77], v[70:71], v[70:71], v[76:77]
    v_add_f32 v74, v74, v75
    v_fmac_f32 v76, v72, v72
    v_add_f32 v76, v76, v77
    s_nop 1
    v_permlane32_swap_b32 v74, v76
    v_add_f32 v74, v74, v76
    v_mov_b32 v76, v74
    s_nop 1
    v_permlane16_swap_b32 v74, v76
    v_add_f32 v74, v74, v76
    s_nop 1
    v_add_f32_dpp v74, v74, v74 row_ror:8 row_mask:0xf bank_mask:0xf
    s_nop 1
    v_add_f32_dpp v74, v74, v74 row_ror:4 row_mask:0xf bank_mask:0xf
    s_nop 1
    v_add_f32_dpp v74, v74, v74 row_ror:2 row_mask:0xf bank_mask:0xf
    s_nop 1
    v_add_f32_dpp v74, v74, v74 row_ror:1 row_mask:0xf bank_mask:0xf
    v_mov_b32 v76, v74
    s_nop 1
    v_permlane32_swap_b32 v74, v76
    v_mul_f32 v74, 0x3ae38e39, v74
    v_mul_f32 v76, 0x3ae38e39, v76
    v_add_f32 v75, s24, v74
    v_fma_f32 v77, -v74, v74, v76
    v_max_f32 v77, 0, v77
    v_cvt_pk_bf16_f32 v77, v77, v77
    v_and_b32 v77, s12, v77
    v_add_f32 v77, 0x3727c5ac, v77
    v_cvt_pk_bf16_f32 v77, v77, v77
    v_and_b32 v77, s12, v77
    v_sqrt_f32 v78, v77
    v_cvt_pk_bf16_f32 v75, v75, v75
    v_and_b32 v75, s12, v75
    v_cvt_pk_bf16_f32 v78, v78, v78
    v_and_b32 v78, s12, v78
    v_rcp_f32 v78, v78
    v_sub_f32 v79, s24, v75
    v_mul_f32 v79, v79, v78
    v_pk_fma_f32 v[64:65], v[64:65], v[78:79], v[78:79] op_sel:[0,0,1] op_sel_hi:[1,0,1]
    v_pk_fma_f32 v[66:67], v[66:67], v[78:79], v[78:79] op_sel:[0,0,1] op_sel_hi:[1,0,1]
    v_pk_fma_f32 v[68:69], v[68:69], v[78:79], v[78:79] op_sel:[0,0,1] op_sel_hi:[1,0,1]
    v_pk_fma_f32 v[70:71], v[70:71], v[78:79], v[78:79] op_sel:[0,0,1] op_sel_hi:[1,0,1]
    v_fma_f32 v72, v72, v78, v79
    v_pk_fma_f32 v[64:65], v[64:65], v[32:33], v[42:43]
    v_pk_fma_f32 v[66:67], v[66:67], v[34:35], v[44:45]
    v_pk_fma_f32 v[68:69], v[68:69], v[36:37], v[46:47]
    v_pk_fma_f32 v[70:71], v[70:71], v[38:39], v[48:49]
    v_fma_f32 v72, v72, v40, v50
    v_cvt_pk_bf16_f32 v90, v64, v65
    v_cvt_pk_bf16_f32 v91, v66, v67
    v_cvt_pk_bf16_f32 v92, v68, v69
    v_cvt_pk_bf16_f32 v93, v70, v71
    v_cvt_pk_bf16_f32 v94, v72, v72
    v_dot2_f32_bf16 v74, v90, v8, 0
    v_dot2_f32_bf16 v75, v91, v9, 0
    v_dot2_f32_bf16 v74, v92, v10, v74
    v_dot2_f32_bf16 v75, v93, v11, v75
    v_dot2_f32_bf16 v74, v94, v12, v74
    s_nop 2
    v_add_f32 v74, v74, v75
    v_mov_b32 v76, v74
    s_nop 1
    v_permlane32_swap_b32 v74, v76
    v_add_f32 v74, v74, v76
    v_mov_b32 v76, v74
    s_nop 1
    v_permlane16_swap_b32 v74, v76
    v_add_f32 v74, v74, v76
    s_nop 1
    v_add_f32_dpp v74, v74, v74 row_ror:8 row_mask:0xf bank_mask:0xf
    s_nop 1
    v_add_f32_dpp v74, v74, v74 row_ror:4 row_mask:0xf bank_mask:0xf
    s_nop 1
    v_add_f32_dpp v74, v74, v74 row_ror:2 row_mask:0xf bank_mask:0xf
    s_nop 1
    v_add_f32_dpp v74, v74, v74 row_ror:1 row_mask:0xf bank_mask:0xf
    v_cvt_pk_bf16_f32 v74, v74, v74
    v_ashrrev_i32 v75, 31, v74
    v_or_b32 v75, 0x80008000, v75
    v_xor_b32 v74, v74, v75
    v_min_u32 v74, 0xfffefffe, v74
    s_lshl_b32 s20, s3, 1
    s_add_u32 s20, s20, 143552
    v_mov_b32 v75, s20
    s_mov_b64 exec, 1
    ds_write_b16_d16_hi v75, v74
    s_mov_b64 exec, -1
    s_waitcnt lgkmcnt(0)
    v_and_b32 v53, 7, v1
    v_lshlrev_b32 v54, 1, v53
    v_add_u32 v54, 143552, v54
    v_sub_u32 v53, 7, v53
    s_barrier
    ds_read_u16 v54, v54
    s_cmp_lg_u32 s3, 0
    s_cbranch_scc1 NORS
    v_mov_b32 v52, 143552
    ds_read_b128 v[64:67], v52
    s_lshl_b32 s20, s2, 4
    s_add_u32 s20, s20, 49152
    v_lshl_add_u32 v52, v1, 12, s20
    s_mov_b64 exec, 0xff
    s_waitcnt lgkmcnt(0)
    global_store_dwordx4 v52, v[64:67], s[68:69] sc1
    s_mov_b64 exec, -1
NORS:
    s_waitcnt lgkmcnt(0)
    v_lshl_or_b32 v54, v54, 3, v53
    s_nop 0
    v_readlane_b32 s20, v54, s3
    s_nop 1
    v_cmp_lt_u32 vcc, s20, v54
    s_nop 0
    s_and_b32 s14, vcc_lo, 0xff
    s_bcnt1_i32_b32 s14, s14
    s_mul_i32 s20, s14, 1152
    v_add_u32 v56, s20, v56
    v_add_u32 v57, s20, v57
    s_cmp_ge_u32 s14, 3
    s_cbranch_scc1 NOBEST
    global_store_dwordx4 v56, v[90:93], s[68:69] sc1
    global_store_short v57, v94, s[68:69] sc1
NOBEST:
    v_lshlrev_b32 v64, 16, v2
    v_and_b32 v65, s12, v2
    v_lshlrev_b32 v66, 16, v3
    v_and_b32 v67, s12, v3
    v_lshlrev_b32 v68, 16, v4
    v_and_b32 v69, s12, v4
    v_lshlrev_b32 v70, 16, v5
    v_and_b32 v71, s12, v5
    v_lshlrev_b32 v72, 16, v6
    v_lshlrev_b32 v74, 16, v90
    v_and_b32 v75, s12, v90
    v_lshlrev_b32 v76, 16, v91
    v_and_b32 v77, s12, v91
    v_lshlrev_b32 v78, 16, v92
    v_and_b32 v79, s12, v92
    v_lshlrev_b32 v80, 16, v93
    v_and_b32 v81, s12, v93
    v_lshlrev_b32 v82, 16, v94
    v_lshlrev_b32 v96, 16, v26
    v_and_b32 v97, s12, v26
    v_lshlrev_b32 v98, 16, v27
    v_and_b32 v99, s12, v27
    v_lshlrev_b32 v100, 16, v28
    v_and_b32 v101, s12, v28
    v_lshlrev_b32 v102, 16, v29
    v_and_b32 v103, s12, v29
    v_lshlrev_b32 v104, 16, v30
    v_pk_fma_f32 v[64:65], v[74:75], v[96:97], v[64:65]
    v_pk_fma_f32 v[66:67], v[76:77], v[98:99], v[66:67]
    v_pk_fma_f32 v[68:69], v[78:79], v[100:101], v[68:69]
    v_pk_fma_f32 v[70:71], v[80:81], v[102:103], v[70:71]
    v_fma_f32 v72, v82, v104, v72
    v_cvt_pk_bf16_f32 v8, v64, v65
    v_cvt_pk_bf16_f32 v9, v66, v67
    v_cvt_pk_bf16_f32 v10, v68, v69
    v_cvt_pk_bf16_f32 v11, v70, v71
    v_cvt_pk_bf16_f32 v12, v72, v72
    s_cmp_lt_u32 s3, 4
    s_cbranch_scc1 T8_A
    s_cmp_eq_u32 s13, 0
    s_cbranch_scc1 T8_B5
    v_and_b32 v52, 7, v1
    v_lshlrev_b32 v52, 3, v52
    v_lshrrev_b32 v53, 4, v1
    s_mul_i32 s20, s9, 294912
    s_lshl_b32 s21, s8, 6
    s_add_u32 s20, s20, s21
    s_add_u32 s20, s20, 3538944
    s_mov_b32 s21, 73728
    v_mad_u32_u24 v52, v53, s21, v52
    v_add_u32 v52, s20, v52
    v_and_b32 v54, 8, v1
    v_cmp_eq_u32 vcc, 0, v54
    v_mov_b32 v54, s56
    v_mov_b32 v55, s54
    v_cndmask_b32 v54, v54, v55, vcc
    v_mov_b32 v55, s57
    v_mov_b32 v56, s55
    v_cndmask_b32 v55, v55, v56, vcc
    v_add_co_u32 v54, vcc, v54, v52
    s_nop 1
    v_addc_co_u32 v55, vcc, 0, v55, vcc
    s_mov_b32 s20, 9216
    s_mov_b32 s21, 0
    s_mov_b32 s22, 1115136
    s_mov_b32 s23, 0
    global_load_dwordx2 v[176:177], v[54:55], off nt
    v_lshl_add_u64 v[54:55], v[54:55], 0, s[20:21]
    global_load_dwordx2 v[178:179], v[54:55], off nt
    v_lshl_add_u64 v[54:55], v[54:55], 0, s[20:21]
    global_load_dwordx2 v[180:181], v[54:55], off nt
    v_lshl_add_u64 v[54:55], v[54:55], 0, s[20:21]
    global_load_dwordx2 v[182:183], v[54:55], off nt
    v_lshl_add_u64 v[54:55], v[54:55], 0, s[20:21]
    global_load_dwordx2 v[184:185], v[54:55], off nt
    v_lshl_add_u64 v[54:55], v[54:55], 0, s[20:21]
    global_load_dwordx2 v[186:187], v[54:55], off nt
    v_lshl_add_u64 v[54:55], v[54:55], 0, s[20:21]
    global_load_dwordx2 v[188:189], v[54:55], off nt
    v_lshl_add_u64 v[54:55], v[54:55], 0, s[20:21]
    global_load_dwordx2 v[190:191], v[54:55], off nt
    v_lshl_add_u64 v[54:55], v[54:55], 0, s[22:23]
    s_cmp_ge_u32 s9, 2
    s_cbranch_scc1 W5_24
    global_load_dwordx2 v[192:193], v[54:55], off nt
    v_lshl_add_u64 v[54:55], v[54:55], 0, s[20:21]
    global_load_dwordx2 v[194:195], v[54:55], off nt
    v_lshl_add_u64 v[54:55], v[54:55], 0, s[20:21]
    global_load_dwordx2 v[196:197], v[54:55], off nt
    v_lshl_add_u64 v[54:55], v[54:55], 0, s[20:21]
    global_load_dwordx2 v[198:199], v[54:55], off nt
    v_lshl_add_u64 v[54:55], v[54:55], 0, s[20:21]
    global_load_dwordx2 v[200:201], v[54:55], off nt
    v_lshl_add_u64 v[54:55], v[54:55], 0, s[20:21]
    global_load_dwordx2 v[202:203], v[54:55], off nt
    v_lshl_add_u64 v[54:55], v[54:55], 0, s[20:21]
    global_load_dwordx2 v[204:205], v[54:55], off nt
    v_lshl_add_u64 v[54:55], v[54:55], 0, s[20:21]
    global_load_dwordx2 v[206:207], v[54:55], off nt
W5_24:
    v_lshrrev_b32 v53, 4, v1
    v_and_b32 v52, 15, v1
    v_lshlrev_b32 v52, 3, v52
    s_movk_i32 s21, 1152
    v_mad_u32_u24 v52, v53, s21, v52
    s_mul_i32 s20, s8, 36864
    s_lshl_b32 s21, s9, 7
    s_add_u32 s20, s20, s21
    v_add_u32 v52, s20, v52
    global_load_dwordx2 v[208:209], v52, s[58:59] nt
    global_load_dwordx2 v[224:225], v52, s[58:59] offset:512 nt
    v_add_u32 v52, 4608, v52
    global_load_dwordx2 v[210:211], v52, s[58:59] nt
    global_load_dwordx2 v[226:227], v52, s[58:59] offset:512 nt
    v_add_u32 v52, 4608, v52
    global_load_dwordx2 v[212:213], v52, s[58:59] nt
    global_load_dwordx2 v[228:229], v52, s[58:59] offset:512 nt
    v_add_u32 v52, 4608, v52
    global_load_dwordx2 v[214:215], v52, s[58:59] nt
    global_load_dwordx2 v[230:231], v52, s[58:59] offset:512 nt
    v_add_u32 v52, 4608, v52
    global_load_dwordx2 v[216:217], v52, s[58:59] nt
    global_load_dwordx2 v[232:233], v52, s[58:59] offset:512 nt
    v_add_u32 v52, 4608, v52
    global_load_dwordx2 v[218:219], v52, s[58:59] nt
    global_load_dwordx2 v[234:235], v52, s[58:59] offset:512 nt
    v_add_u32 v52, 4608, v52
    global_load_dwordx2 v[220:221], v52, s[58:59] nt
    global_load_dwordx2 v[236:237], v52, s[58:59] offset:512 nt
    v_add_u32 v52, 4608, v52
    global_load_dwordx2 v[222:223], v52, s[58:59] nt
    global_load_dwordx2 v[238:239], v52, s[58:59] offset:512 nt
    s_cmp_lg_u32 s9, 3
    s_cbranch_scc1 W8_25
    global_load_dwordx2 v[254:255], v52, s[58:59] offset:640 nt
    v_subrev_u32 v52, 4608, v52
    global_load_dwordx2 v[252:253], v52, s[58:59] offset:640 nt
    v_subrev_u32 v52, 4608, v52
    global_load_dwordx2 v[250:251], v52, s[58:59] offset:640 nt
    v_subrev_u32 v52, 4608, v52
    global_load_dwordx2 v[248:249], v52, s[58:59] offset:640 nt
    v_subrev_u32 v52, 4608, v52
    global_load_dwordx2 v[246:247], v52, s[58:59] offset:640 nt
    v_subrev_u32 v52, 4608, v52
    global_load_dwordx2 v[244:245], v52, s[58:59] offset:640 nt
    v_subrev_u32 v52, 4608, v52
    global_load_dwordx2 v[242:243], v52, s[58:59] offset:640 nt
    v_subrev_u32 v52, 4608, v52
    global_load_dwordx2 v[240:241], v52, s[58:59] offset:640 nt
W8_25:
    s_branch T8_B5
T8_A:
    v_and_b32 v52, 255, v0
    s_lshl_b32 s20, s4, 12
    s_add_u32 s20, s20, 49152
    v_lshl_add_u32 v53, v52, 4, s20
    v_lshlrev_b32 v52, 3, v52
    v_sub_u32 v52, 2047, v52
    v_and_b32 v54, 1, v1
    v_cmp_eq_u32 s[20:21], 0, v54
    v_and_b32 v54, 2, v1
    v_cmp_eq_u32 s[22:23], 0, v54
    v_and_b32 v54, 4, v1
    v_cmp_eq_u32 s[24:25], 0, v54
    v_and_b32 v54, 7, v1
    v_lshlrev_b32 v54, 2, v54
    s_waitcnt vmcnt(0)
    global_load_dwordx4 v[64:67], v53, s[68:69]
    s_waitcnt vmcnt(0)
RP:
    v_max3_u32 v68, v64, v65, v66
    v_max_u32 v68, v68, v67
    v_cmp_eq_u32 vcc, -1, v68
    s_cbranch_vccz RPD
    s_mov_b64 exec, vcc
    global_load_dwordx4 v[64:67], v53, s[68:69] sc1
    s_mov_b64 exec, -1
    s_waitcnt vmcnt(0)
    s_sub_u32 s10, s10, 1
    s_cbranch_scc1 EXIT
    s_branch RP
RPD:
    s_add_u32 s26, s2, s9
    s_cmp_lg_u32 s26, 0
    s_cbranch_scc1 NOEP
    v_mov_b32 v68, 94208
    v_mov_b32 v69, s99
    global_store_dword v68, v69, s[68:69] sc1
NOEP:
    v_cndmask_b32 v68, v66, v64, s[20:21]
    v_cndmask_b32 v69, v67, v65, s[20:21]
    v_cndmask_b32 v70, v64, v66, s[20:21]
    v_cndmask_b32 v71, v65, v67, s[20:21]
    s_nop 0
    v_mov_b32_dpp v72, v70 quad_perm:[1,0,3,2] row_mask:0xf bank_mask:0xf
    v_mov_b32_dpp v73, v71 quad_perm:[1,0,3,2] row_mask:0xf bank_mask:0xf
    v_pk_max_u16 v68, v68, v72
    v_pk_max_u16 v69, v69, v73
    v_cndmask_b32 v70, v69, v68, s[22:23]
    v_cndmask_b32 v71, v68, v69, s[22:23]
    s_nop 1
    v_mov_b32_dpp v72, v71 quad_perm:[2,3,0,1] row_mask:0xf bank_mask:0xf
    v_pk_max_u16 v70, v70, v72
    s_nop 1
    v_mov_b32_dpp v72, v70 row_ror:4 row_mask:0xf bank_mask:0xf
    v_pk_max_u16 v70, v70, v72
    v_and_b32 v71, 0xffff, v70
    v_lshrrev_b32 v70, 16, v70
    v_cndmask_b32 v70, v70, v71, s[24:25]
    v_add_u32 v54, 143488, v54
    ds_max_u32 v54, v70
    v_subrev_u32 v80, 0, v52
    v_lshl_or_b32 v80, v64, 16, v80
    v_subrev_u32 v81, 1, v52
    v_and_or_b32 v81, v64, s12, v81
    v_subrev_u32 v82, 2, v52
    v_lshl_or_b32 v82, v65, 16, v82
    v_subrev_u32 v83, 3, v52
    v_and_or_b32 v83, v65, s12, v83
    v_subrev_u32 v84, 4, v52
    v_lshl_or_b32 v84, v66, 16, v84
    v_subrev_u32 v85, 5, v52
    v_and_or_b32 v85, v66, s12, v85
    v_subrev_u32 v86, 6, v52
    v_lshl_or_b32 v86, v67, 16, v86
    v_subrev_u32 v87, 7, v52
    v_and_or_b32 v87, v67, s12, v87
    s_waitcnt lgkmcnt(0)
T8_B5:
    s_barrier
    s_cmp_ge_u32 s3, 4
    s_cbranch_scc1 T8_B6
    v_mov_b32 v54, 143488
    ds_read_b128 v[64:67], v54
    ds_read_b128 v[68:71], v54 offset:16
    v_mov_b32 v72, 0
    s_waitcnt lgkmcnt(0)
    v_min3_u32 v64, v64, v65, v66
    v_min3_u32 v67, v67, v68, v69
    v_min3_u32 v64, v64, v70, v71
    v_min_u32 v64, v64, v67
    v_lshlrev_b32 v64, 16, v64
    v_cmp_ge_u32 s[20:21], v80, v64
    v_cmp_ge_u32 s[22:23], v81, v64
    v_cmp_ge_u32 s[24:25], v82, v64
    v_cmp_ge_u32 s[26:27], v83, v64
    v_cmp_ge_u32 s[28:29], v84, v64
    v_cmp_ge_u32 s[30:31], v85, v64
    v_cmp_ge_u32 s[32:33], v86, v64
    v_cmp_ge_u32 s[34:35], v87, v64
    v_addc_co_u32 v72, vcc, 0, v72, s[20:21]
    s_nop 1
    v_addc_co_u32 v72, vcc, 0, v72, s[22:23]
    s_nop 1
    v_addc_co_u32 v72, vcc, 0, v72, s[24:25]
    s_nop 1
    v_addc_co_u32 v72, vcc, 0, v72, s[26:27]
    s_nop 1
    v_addc_co_u32 v72, vcc, 0, v72, s[28:29]
    s_nop 1
    v_addc_co_u32 v72, vcc, 0, v72, s[30:31]
    s_nop 1
    v_addc_co_u32 v72, vcc, 0, v72, s[32:33]
    s_nop 1
    v_addc_co_u32 v72, vcc, 0, v72, s[34:35]
    v_cmp_lt_u32 vcc, 0, v72
    s_nop 0
    s_mov_b64 exec, vcc
    ds_add_rtn_u32 v73, v54, v72 offset:32
    s_waitcnt lgkmcnt(0)
    v_lshlrev_b32 v73, 2, v73
    s_mov_b64 exec, s[20:21]
    ds_write_b32 v73, v80 offset:17408
    v_add_u32 v73, 4, v73
    s_mov_b64 exec, s[22:23]
    ds_write_b32 v73, v81 offset:17408
    v_add_u32 v73, 4, v73
    s_mov_b64 exec, s[24:25]
    ds_write_b32 v73, v82 offset:17408
    v_add_u32 v73, 4, v73
    s_mov_b64 exec, s[26:27]
    ds_write_b32 v73, v83 offset:17408
    v_add_u32 v73, 4, v73
    s_mov_b64 exec, s[28:29]
    ds_write_b32 v73, v84 offset:17408
    v_add_u32 v73, 4, v73
    s_mov_b64 exec, s[30:31]
    ds_write_b32 v73, v85 offset:17408
    v_add_u32 v73, 4, v73
    s_mov_b64 exec, s[32:33]
    ds_write_b32 v73, v86 offset:17408
    v_add_u32 v73, 4, v73
    s_mov_b64 exec, s[34:35]
    ds_write_b32 v73, v87 offset:17408
    v_add_u32 v73, 4, v73
    s_mov_b64 exec, -1
    s_waitcnt lgkmcnt(0)
T8_B6:

    s_barrier
    v_mov_b32 v54, 143520
    ds_read_b32 v55, v54
    v_lshlrev_b32 v52, 2, v1
    ds_read_b32 v64, v52 offset:17408
    v_mov_b32 v53, 0
    s_lshl_b32 s22, s3, 5
    s_add_u32 s22, s22, 143616
    s_mov_b32 s21, 0
    s_waitcnt lgkmcnt(1)
    v_readfirstlane_b32 s20, v55
    v_lshl_add_u32 v55, v55, 2, v52
    s_mov_b64 exec, 0xffff
    ds_write_b32 v55, v53 offset:17408
    s_mov_b64 exec, -1
RK_O:
    v_mov_b32 v65, 0
    v_mov_b32 v54, 0
    s_mov_b32 s23, 0
RK_I:
    ds_read_b128 v[68:71], v54 offset:17408
    ds_read_b128 v[72:75], v54 offset:17424
    ds_read_b128 v[76:79], v54 offset:17440
    ds_read_b128 v[80:83], v54 offset:17456
    v_add_u32 v54, 64, v54
    s_add_u32 s23, s23, 16
    s_waitcnt lgkmcnt(3)
    v_cmp_gt_u32 s[24:25], v68, v64
    v_cmp_gt_u32 s[26:27], v69, v64
    v_cmp_gt_u32 s[28:29], v70, v64
    v_cmp_gt_u32 s[30:31], v71, v64
    v_addc_co_u32 v65, vcc, 0, v65, s[24:25]
    s_nop 1
    v_addc_co_u32 v65, vcc, 0, v65, s[26:27]
    s_nop 1
    v_addc_co_u32 v65, vcc, 0, v65, s[28:29]
    s_nop 1
    v_addc_co_u32 v65, vcc, 0, v65, s[30:31]
    s_waitcnt lgkmcnt(2)
    v_cmp_gt_u32 s[24:25], v72, v64
    v_cmp_gt_u32 s[26:27], v73, v64
    v_cmp_gt_u32 s[28:29], v74, v64
    v_cmp_gt_u32 s[30:31], v75, v64
    v_addc_co_u32 v65, vcc, 0, v65, s[24:25]
    s_nop 1
    v_addc_co_u32 v65, vcc, 0, v65, s[26:27]
    s_nop 1
    v_addc_co_u32 v65, vcc, 0, v65, s[28:29]
    s_nop 1
    v_addc_co_u32 v65, vcc, 0, v65, s[30:31]
    s_waitcnt lgkmcnt(1)
    v_cmp_gt_u32 s[24:25], v76, v64
    v_cmp_gt_u32 s[26:27], v77, v64
    v_cmp_gt_u32 s[28:29], v78, v64
    v_cmp_gt_u32 s[30:31], v79, v64
    v_addc_co_u32 v65, vcc, 0, v65, s[24:25]
    s_nop 1
    v_addc_co_u32 v65, vcc, 0, v65, s[26:27]
    s_nop 1
    v_addc_co_u32 v65, vcc, 0, v65, s[28:29]
    s_nop 1
    v_addc_co_u32 v65, vcc, 0, v65, s[30:31]
    s_waitcnt lgkmcnt(0)
    v_cmp_gt_u32 s[24:25], v80, v64
    v_cmp_gt_u32 s[26:27], v81, v64
    v_cmp_gt_u32 s[28:29], v82, v64
    v_cmp_gt_u32 s[30:31], v83, v64
    v_addc_co_u32 v65, vcc, 0, v65, s[24:25]
    s_nop 1
    v_addc_co_u32 v65, vcc, 0, v65, s[26:27]
    s_nop 1
    v_addc_co_u32 v65, vcc, 0, v65, s[28:29]
    s_nop 1
    v_addc_co_u32 v65, vcc, 0, v65, s[30:31]
    s_cmp_lt_u32 s23, s20
    s_cbranch_scc1 RK_I
    v_add_u32 v66, s21, v1
    v_cmp_gt_u32 vcc, s20, v66
    v_cmp_gt_u32 s[24:25], 8, v65
    s_nop 0
    s_and_b64 exec, vcc, s[24:25]
    v_lshl_add_u32 v65, v65, 2, s22
    ds_write_b32 v65, v64
    s_mov_b64 exec, -1
    s_add_u32 s21, s21, 64
    s_cmp_ge_u32 s21, s20
    s_cbranch_scc1 RK_D
    v_add_u32 v52, 256, v52
    ds_read_b32 v64, v52 offset:17408
    s_branch RK_O
RK_D:
    v_and_b32 v54, 7, v1
    v_lshl_add_u32 v54, v54, 2, s22
    ds_read_b32 v64, v54
    s_mul_i32 s23, s11, 1152
    s_waitcnt lgkmcnt(0)
    v_and_b32 v65, 0x7ff, v64
    v_sub_u32 v65, 2047, v65
    v_lshrrev_b32 v66, 3, v65
    v_mov_b32 v67, 0
    v_readlane_b32 s20, v66, 0
    s_nop 1
    v_cmp_eq_u32 vcc, s20, v66
    s_nop 0
    s_and_b32 s26, vcc_lo, 0xfefefefe
    s_mov_b32 s27, s26
    v_addc_co_u32 v67, vcc, 0, v67, s[26:27]
    v_readlane_b32 s20, v66, 1
    s_nop 1
    v_cmp_eq_u32 vcc, s20, v66
    s_nop 0
    s_and_b32 s26, vcc_lo, 0xfcfcfcfc
    s_mov_b32 s27, s26
    v_addc_co_u32 v67, vcc, 0, v67, s[26:27]
    v_readlane_b32 s20, v66, 2
    s_nop 1
    v_cmp_eq_u32 vcc, s20, v66
    s_nop 0
    s_and_b32 s26, vcc_lo, 0xf8f8f8f8
    s_mov_b32 s27, s26
    v_addc_co_u32 v67, vcc, 0, v67, s[26:27]
    v_readlane_b32 s20, v66, 3
    s_nop 1
    v_cmp_eq_u32 vcc, s20, v66
    s_nop 0
    s_and_b32 s26, vcc_lo, 0xf0f0f0f0
    s_mov_b32 s27, s26
    v_addc_co_u32 v67, vcc, 0, v67, s[26:27]
    v_readlane_b32 s20, v66, 4
    s_nop 1
    v_cmp_eq_u32 vcc, s20, v66
    s_nop 0
    s_and_b32 s26, vcc_lo, 0xe0e0e0e0
    s_mov_b32 s27, s26
    v_addc_co_u32 v67, vcc, 0, v67, s[26:27]
    v_readlane_b32 s20, v66, 5
    s_nop 1
    v_cmp_eq_u32 vcc, s20, v66
    s_nop 0
    s_and_b32 s26, vcc_lo, 0xc0c0c0c0
    s_mov_b32 s27, s26
    v_addc_co_u32 v67, vcc, 0, v67, s[26:27]
    v_readlane_b32 s20, v66, 6
    s_nop 1
    v_cmp_eq_u32 vcc, s20, v66
    s_nop 0
    s_and_b32 s26, vcc_lo, 0x80808080
    s_mov_b32 s27, s26
    v_addc_co_u32 v67, vcc, 0, v67, s[26:27]
    v_cmp_le_u32 vcc, 3, v67
    v_mad_u32_u24 v66, v66, 3, v67
    v_and_b32 v67, 7, v1
    s_movk_i32 s20, 1152
    v_mul_u32_u24 v66, s20, v66
    v_mul_u32_u24 v67, s20, v67
    v_add_u32 v66, 4194304, v66
    v_add_u32 v67, 32768, v67
    v_cndmask_b32 v66, v66, v67, vcc
    s_cmp_eq_u32 s13, 0
    s_cbranch_scc1 NOAF
    s_movk_i32 s20, 1152
    v_lshrrev_b32 v52, 4, v1
    v_lshlrev_b32 v52, 4, v52
    s_lshl_b32 s21, s9, 6
    v_add3_u32 v52, v66, s21, v52
    s_movk_i32 s21, 1024
    s_cmp_ge_u32 s9, 2
    s_cselect_b32 s21, 768, s21
    v_add_u32 v53, s21, v52
    global_load_dwordx4 v[68:71], v52, s[68:69]
    global_load_dwordx4 v[72:75], v52, s[68:69] offset:256
    global_load_dwordx4 v[76:79], v52, s[68:69] offset:512
    global_load_dwordx4 v[80:83], v52, s[68:69] offset:768
    global_load_dwordx4 v[84:87], v53, s[68:69]
NOAF:
    v_cmp_eq_u32 vcc, s11, v65
    s_cbranch_vccnz OWN_SEL
    v_add_u32 v54, s23, v7
    v_add_u32 v55, s23, v13
    global_store_dwordx4 v54, v[8:11], s[64:65] nt
    global_store_short v55, v12, s[64:65] nt
    s_branch OWN_D
OWN_SEL:
    s_ff1_i32_b64 s20, vcc
    s_mul_i32 s20, s20, 1152
    s_add_u32 s20, s20, 22528
    v_add_u32 v54, s20, v7
    v_add_u32 v55, s20, v13
    s_cmp_lt_u32 s14, 3
    s_cbranch_scc1 OWN_B
    v_add_u32 v56, 10240, v54
    v_add_u32 v57, 10240, v55
    global_store_dwordx4 v56, v[90:93], s[68:69] sc1
    global_store_short v57, v94, s[68:69] sc1
OWN_B:
    global_store_dwordx4 v54, v[2:5], s[68:69] sc1
    global_store_short v55, v6, s[68:69] sc1
OWN_D:
    s_cmp_eq_u32 s13, 0
    s_cbranch_scc1 S4PRE
    s_waitcnt vmcnt(7)
    s_mov_b32 s26, 0x05040100
    s_mov_b32 s27, 0x07060302
    v_perm_b32 v112, v130, v128, s26
    v_perm_b32 v116, v130, v128, s27
    v_perm_b32 v120, v131, v129, s26
    v_perm_b32 v124, v131, v129, s27
    v_perm_b32 v113, v134, v132, s26
    v_perm_b32 v117, v134, v132, s27
    v_perm_b32 v121, v135, v133, s26
    v_perm_b32 v125, v135, v133, s27
    v_perm_b32 v114, v138, v136, s26
    v_perm_b32 v118, v138, v136, s27
    v_perm_b32 v122, v139, v137, s26
    v_perm_b32 v126, v139, v137, s27
    v_perm_b32 v115, v142, v140, s26
    v_perm_b32 v119, v142, v140, s27
    v_perm_b32 v123, v143, v141, s26
    v_perm_b32 v127, v143, v141, s27
    v_perm_b32 v128, v146, v144, s26
    v_perm_b32 v132, v146, v144, s27
    v_perm_b32 v136, v147, v145, s26
    v_perm_b32 v140, v147, v145, s27
    v_perm_b32 v129, v150, v148, s26
    v_perm_b32 v133, v150, v148, s27
    v_perm_b32 v137, v151, v149, s26
    v_perm_b32 v141, v151, v149, s27
    v_perm_b32 v130, v154, v152, s26
    v_perm_b32 v134, v154, v152, s27
    v_perm_b32 v138, v155, v153, s26
    v_perm_b32 v142, v155, v153, s27
    v_perm_b32 v131, v158, v156, s26
    v_perm_b32 v135, v158, v156, s27
    v_perm_b32 v139, v159, v157, s26
    v_perm_b32 v143, v159, v157, s27
    v_perm_b32 v144, v162, v160, s26
    v_perm_b32 v148, v162, v160, s27
    v_perm_b32 v152, v163, v161, s26
    v_perm_b32 v156, v163, v161, s27
    v_perm_b32 v145, v166, v164, s26
    v_perm_b32 v149, v166, v164, s27
    v_perm_b32 v153, v167, v165, s26
    v_perm_b32 v157, v167, v165, s27
    v_perm_b32 v146, v170, v168, s26
    v_perm_b32 v150, v170, v168, s27
    v_perm_b32 v154, v171, v169, s26
    v_perm_b32 v158, v171, v169, s27
    v_perm_b32 v147, v174, v172, s26
    v_perm_b32 v151, v174, v172, s27
    v_perm_b32 v155, v175, v173, s26
    v_perm_b32 v159, v175, v173, s27
    v_perm_b32 v160, v178, v176, s26
    v_perm_b32 v164, v178, v176, s27
    v_perm_b32 v168, v179, v177, s26
    v_perm_b32 v172, v179, v177, s27
    v_perm_b32 v161, v182, v180, s26
    v_perm_b32 v165, v182, v180, s27
    v_perm_b32 v169, v183, v181, s26
    v_perm_b32 v173, v183, v181, s27
    v_perm_b32 v162, v186, v184, s26
    v_perm_b32 v166, v186, v184, s27
    v_perm_b32 v170, v187, v185, s26
    v_perm_b32 v174, v187, v185, s27
    v_perm_b32 v163, v190, v188, s26
    v_perm_b32 v167, v190, v188, s27
    v_perm_b32 v171, v191, v189, s26
    v_perm_b32 v175, v191, v189, s27
    v_perm_b32 v176, v194, v192, s26
    v_perm_b32 v180, v194, v192, s27
    v_perm_b32 v184, v195, v193, s26
    v_perm_b32 v188, v195, v193, s27
    v_perm_b32 v177, v198, v196, s26
    v_perm_b32 v181, v198, v196, s27
    v_perm_b32 v185, v199, v197, s26
    v_perm_b32 v189, v199, v197, s27
    v_perm_b32 v178, v202, v200, s26
    v_perm_b32 v182, v202, v200, s27
    v_perm_b32 v186, v203, v201, s26
    v_perm_b32 v190, v203, v201, s27
    v_perm_b32 v179, v206, v204, s26
    v_perm_b32 v183, v206, v204, s27
    v_perm_b32 v187, v207, v205, s26
    v_perm_b32 v191, v207, v205, s27
    v_perm_b32 v192, v210, v208, s26
    v_perm_b32 v196, v210, v208, s27
    v_perm_b32 v200, v211, v209, s26
    v_perm_b32 v204, v211, v209, s27
    v_perm_b32 v193, v214, v212, s26
    v_perm_b32 v197, v214, v212, s27
    v_perm_b32 v201, v215, v213, s26
    v_perm_b32 v205, v215, v213, s27
    v_perm_b32 v194, v218, v216, s26
    v_perm_b32 v198, v218, v216, s27
    v_perm_b32 v202, v219, v217, s26
    v_perm_b32 v206, v219, v217, s27
    v_perm_b32 v195, v222, v220, s26
    v_perm_b32 v199, v222, v220, s27
    v_perm_b32 v203, v223, v221, s26
    v_perm_b32 v207, v223, v221, s27
    v_perm_b32 v208, v226, v224, s26
    v_perm_b32 v212, v226, v224, s27
    v_perm_b32 v216, v227, v225, s26
    v_perm_b32 v220, v227, v225, s27
    v_perm_b32 v209, v230, v228, s26
    v_perm_b32 v213, v230, v228, s27
    v_perm_b32 v217, v231, v229, s26
    v_perm_b32 v221, v231, v229, s27
    v_perm_b32 v210, v234, v232, s26
    v_perm_b32 v214, v234, v232, s27
    v_perm_b32 v218, v235, v233, s26
    v_perm_b32 v222, v235, v233, s27
    v_perm_b32 v211, v238, v236, s26
    v_perm_b32 v215, v238, v236, s27
    v_perm_b32 v219, v239, v237, s26
    v_perm_b32 v223, v239, v237, s27
    v_perm_b32 v224, v242, v240, s26
    v_perm_b32 v228, v242, v240, s27
    v_perm_b32 v232, v243, v241, s26
    v_perm_b32 v236, v243, v241, s27
    v_perm_b32 v225, v246, v244, s26
    v_perm_b32 v229, v246, v244, s27
    v_perm_b32 v233, v247, v245, s26
    v_perm_b32 v237, v247, v245, s27
    v_perm_b32 v226, v250, v248, s26
    v_perm_b32 v230, v250, v248, s27
    v_perm_b32 v234, v251, v249, s26
    v_perm_b32 v238, v251, v249, s27
    v_perm_b32 v227, v254, v252, s26
    v_perm_b32 v231, v254, v252, s27
    v_perm_b32 v235, v255, v253, s26
    v_perm_b32 v239, v255, v253, s27
    s_waitcnt vmcnt(2)
AFP:
    v_max3_u32 v88, v68, v69, v70
    v_max3_u32 v88, v88, v71, v72
    v_max3_u32 v88, v88, v73, v74
    v_max3_u32 v88, v88, v75, v76
    v_max3_u32 v88, v88, v77, v78
    v_max3_u32 v88, v88, v79, v80
    v_max3_u32 v88, v88, v81, v82
    v_max3_u32 v88, v88, v83, v84
    v_max3_u32 v88, v88, v85, v86
    v_max_u32 v88, v88, v87
    v_cmp_eq_u32 vcc, -1, v88
    s_cbranch_vccz AFPD
    s_mov_b64 exec, vcc
    global_load_dwordx4 v[68:71], v52, s[68:69] sc1
    global_load_dwordx4 v[72:75], v52, s[68:69] offset:256 sc1
    global_load_dwordx4 v[76:79], v52, s[68:69] offset:512 sc1
    global_load_dwordx4 v[80:83], v52, s[68:69] offset:768 sc1
    global_load_dwordx4 v[84:87], v53, s[68:69] sc1
    s_mov_b64 exec, -1
    s_waitcnt vmcnt(0)
    s_sub_u32 s10, s10, 1
    s_cbranch_scc1 EXIT
    s_branch AFP
AFPD:
    v_mfma_f32_16x16x32_bf16 v[92:95], v[112:115], v[68:71], 0
    v_mfma_f32_16x16x32_bf16 v[96:99], v[116:119], v[68:71], 0
    v_mfma_f32_16x16x32_bf16 v[100:103], v[120:123], v[68:71], 0
    v_mfma_f32_16x16x32_bf16 v[104:107], v[124:127], v[68:71], 0
    v_mfma_f32_16x16x32_bf16 v[92:95], v[128:131], v[72:75], v[92:95]
    v_mfma_f32_16x16x32_bf16 v[96:99], v[132:135], v[72:75], v[96:99]
    v_mfma_f32_16x16x32_bf16 v[100:103], v[136:139], v[72:75], v[100:103]
    v_mfma_f32_16x16x32_bf16 v[104:107], v[140:143], v[72:75], v[104:107]
    v_mfma_f32_16x16x32_bf16 v[92:95], v[144:147], v[76:79], v[92:95]
    v_mfma_f32_16x16x32_bf16 v[96:99], v[148:151], v[76:79], v[96:99]
    v_mfma_f32_16x16x32_bf16 v[100:103], v[152:155], v[76:79], v[100:103]
    v_mfma_f32_16x16x32_bf16 v[104:107], v[156:159], v[76:79], v[104:107]
    v_mfma_f32_16x16x32_bf16 v[92:95], v[160:163], v[80:83], v[92:95]
    v_mfma_f32_16x16x32_bf16 v[96:99], v[164:167], v[80:83], v[96:99]
    v_mfma_f32_16x16x32_bf16 v[100:103], v[168:171], v[80:83], v[100:103]
    v_mfma_f32_16x16x32_bf16 v[104:107], v[172:175], v[80:83], v[104:107]
    s_cmp_ge_u32 s9, 2
    s_cbranch_scc1 MF4
    v_mfma_f32_16x16x32_bf16 v[92:95], v[176:179], v[84:87], v[92:95]
    v_mfma_f32_16x16x32_bf16 v[96:99], v[180:183], v[84:87], v[96:99]
    v_mfma_f32_16x16x32_bf16 v[100:103], v[184:187], v[84:87], v[100:103]
    v_mfma_f32_16x16x32_bf16 v[104:107], v[188:191], v[84:87], v[104:107]
MF4:
    s_mul_i32 s20, s9, 4608
    v_lshl_add_u32 v52, v1, 4, s20
    v_lshrrev_b32 v53, 4, v1
    s_movk_i32 s20, 1152
    v_mul_u32_u24 v54, s20, v53
    v_and_b32 v55, 7, v1
    v_lshl_add_u32 v54, v55, 4, v54
    v_and_b32 v55, 8, v1
    v_lshl_add_u32 v54, v55, 5, v54
    v_cmp_eq_u32 s[24:25], 0, v55
    s_nop 4
    ds_write_b128 v52, v[92:95] offset:27648
    ds_write_b128 v52, v[96:99] offset:28800
    ds_write_b128 v52, v[100:103] offset:29952
    ds_write_b128 v52, v[104:107] offset:31104
    s_waitcnt lgkmcnt(0)
    s_barrier
    ds_read_b128 v[64:67], v54 offset:27648
    ds_read_b128 v[68:71], v54 offset:28160
    ds_read_b128 v[72:75], v54 offset:32256
    ds_read_b128 v[76:79], v54 offset:32768
    ds_read_b128 v[80:83], v54 offset:36864
    ds_read_b128 v[84:87], v54 offset:37376
    ds_read_b128 v[88:91], v54 offset:41472
    ds_read_b128 v[92:95], v54 offset:41984
    v_and_b32 v53, 1, v53
    s_mov_b32 s20, 1327104
    v_mul_u32_u24 v53, s20, v53
    v_lshrrev_b32 v55, 3, v55
    s_movk_i32 s20, 18432
    v_mad_u32_u24 v53, v55, s20, v53
    v_and_b32 v55, 7, v1
    v_lshl_add_u32 v53, v55, 4, v53
    s_lshl_b32 s20, s8, 7
    s_add_u32 s20, s20, 7340032
    v_add_u32 v53, s20, v53
    s_mul_i32 s21, s9, 147456
    s_waitcnt lgkmcnt(4)
    v_pk_add_f32 v[64:65], v[64:65], v[72:73]
    v_pk_add_f32 v[66:67], v[66:67], v[74:75]
    v_pk_add_f32 v[68:69], v[68:69], v[76:77]
    v_pk_add_f32 v[70:71], v[70:71], v[78:79]
    s_waitcnt lgkmcnt(0)
    v_pk_add_f32 v[80:81], v[80:81], v[88:89]
    v_pk_add_f32 v[82:83], v[82:83], v[90:91]
    v_pk_add_f32 v[84:85], v[84:85], v[92:93]
    v_pk_add_f32 v[86:87], v[86:87], v[94:95]
    v_pk_add_f32 v[64:65], v[64:65], v[80:81]
    v_pk_add_f32 v[66:67], v[66:67], v[82:83]
    v_pk_add_f32 v[68:69], v[68:69], v[84:85]
    v_pk_add_f32 v[70:71], v[70:71], v[86:87]
    v_cvt_pk_bf16_f32 v72, v64, v65
    v_cvt_pk_bf16_f32 v73, v66, v67
    v_cvt_pk_bf16_f32 v74, v68, v69
    v_cvt_pk_bf16_f32 v75, v70, v71
    v_lshlrev_b32 v64, 16, v72
    v_and_b32 v65, s12, v72
    v_lshlrev_b32 v66, 16, v73
    v_and_b32 v67, s12, v73
    v_lshlrev_b32 v68, 16, v74
    v_and_b32 v69, s12, v74
    v_lshlrev_b32 v70, 16, v75
    v_and_b32 v71, s12, v75
    v_mul_f32 v72, 0xbfb8aa3b, v64
    v_exp_f32 v72, v72
    v_mul_f32 v73, 0xbfb8aa3b, v65
    v_exp_f32 v73, v73
    v_mul_f32 v74, 0xbfb8aa3b, v66
    v_exp_f32 v74, v74
    v_mul_f32 v75, 0xbfb8aa3b, v67
    v_exp_f32 v75, v75
    v_add_f32 v72, 1.0, v72
    v_rcp_f32 v72, v72
    v_add_f32 v73, 1.0, v73
    v_rcp_f32 v73, v73
    v_add_f32 v74, 1.0, v74
    v_rcp_f32 v74, v74
    v_add_f32 v75, 1.0, v75
    v_rcp_f32 v75, v75
    v_pk_mul_f32 v[64:65], v[64:65], v[72:73]
    v_pk_mul_f32 v[66:67], v[66:67], v[74:75]
    v_cvt_pk_bf16_f32 v72, v64, v65
    v_cvt_pk_bf16_f32 v73, v66, v67
    v_lshlrev_b32 v64, 16, v72
    v_and_b32 v65, s12, v72
    v_lshlrev_b32 v66, 16, v73
    v_and_b32 v67, s12, v73
    v_pk_mul_f32 v[64:65], v[64:65], v[68:69]
    v_pk_mul_f32 v[66:67], v[66:67], v[70:71]
    v_cvt_pk_bf16_f32 v72, v64, v65
    v_cvt_pk_bf16_f32 v73, v66, v67
    s_nop 0
    v_mov_b32_dpp v74, v72 row_ror:8 row_mask:0xf bank_mask:0xf
    v_mov_b32_dpp v75, v73 row_ror:8 row_mask:0xf bank_mask:0xf
    v_cndmask_b32 v76, v74, v72, s[24:25]
    v_cndmask_b32 v77, v75, v73, s[24:25]
    v_cndmask_b32 v78, v72, v74, s[24:25]
    v_cndmask_b32 v79, v73, v75, s[24:25]
    s_nop 1
    v_mfma_f32_16x16x32_bf16 v[80:83], v[76:79], v[192:195], 0
    v_mfma_f32_16x16x32_bf16 v[84:87], v[76:79], v[196:199], 0
    v_mfma_f32_16x16x32_bf16 v[88:91], v[76:79], v[200:203], 0
    v_mfma_f32_16x16x32_bf16 v[92:95], v[76:79], v[204:207], 0
    v_mfma_f32_16x16x32_bf16 v[96:99], v[76:79], v[208:211], 0
    v_mfma_f32_16x16x32_bf16 v[100:103], v[76:79], v[212:215], 0
    v_mfma_f32_16x16x32_bf16 v[104:107], v[76:79], v[216:219], 0
    v_mfma_f32_16x16x32_bf16 v[108:111], v[76:79], v[220:223], 0
    s_mov_b32 exec_hi, 0
    v_add_u32 v52, s21, v53
    global_store_dwordx4 v52, v[80:83], s[68:69] sc1
    v_add_u32 v52, 36864, v52
    global_store_dwordx4 v52, v[84:87], s[68:69] sc1
    v_add_u32 v52, 36864, v52
    global_store_dwordx4 v52, v[88:91], s[68:69] sc1
    v_add_u32 v52, 36864, v52
    global_store_dwordx4 v52, v[92:95], s[68:69] sc1
    s_add_u32 s21, s21, 589824
    v_add_u32 v52, s21, v53
    global_store_dwordx4 v52, v[96:99], s[68:69] sc1
    v_add_u32 v52, 36864, v52
    global_store_dwordx4 v52, v[100:103], s[68:69] sc1
    v_add_u32 v52, 36864, v52
    global_store_dwordx4 v52, v[104:107], s[68:69] sc1
    v_add_u32 v52, 36864, v52
    global_store_dwordx4 v52, v[108:111], s[68:69] sc1
    s_mov_b32 exec_hi, -1
    s_cmp_lg_u32 s9, 3
    s_cbranch_scc1 NOB8
    v_mfma_f32_16x16x32_bf16 v[80:83], v[76:79], v[224:227], 0
    v_mfma_f32_16x16x32_bf16 v[84:87], v[76:79], v[228:231], 0
    v_mfma_f32_16x16x32_bf16 v[88:91], v[76:79], v[232:235], 0
    v_mfma_f32_16x16x32_bf16 v[92:95], v[76:79], v[236:239], 0
    s_mov_b32 s21, 1179648
    s_mov_b32 exec_hi, 0
    v_add_u32 v52, s21, v53
    s_nop 1
    global_store_dwordx4 v52, v[80:83], s[68:69] sc1
    v_add_u32 v52, 36864, v52
    global_store_dwordx4 v52, v[84:87], s[68:69] sc1
    v_add_u32 v52, 36864, v52
    global_store_dwordx4 v52, v[88:91], s[68:69] sc1
    v_add_u32 v52, 36864, v52
    global_store_dwordx4 v52, v[92:95], s[68:69] sc1
NOB8:
    s_mov_b32 exec_hi, -1
    s_branch S4
S4PRE:
    s_cmp_ge_u32 s5, 18
    s_cbranch_scc1 FIN
    s_barrier
    s_cmp_lg_u32 s3, 0
    s_cbranch_scc1 S4
    s_cmp_ge_u32 s8, 72
    s_cselect_b32 s20, 1, 0
    s_mul_i32 s21, s20, 72
    s_sub_u32 s21, s8, s21
    s_lshr_b32 s23, s21, 3
    s_lshl_b32 s23, s23, 6
    s_and_b32 s24, s21, 1
    s_lshl_b32 s24, s24, 5
    s_add_u32 s23, s23, s24
    s_bfe_u32 s24, s21, 0x20001
    s_add_u32 s23, s23, s24
    s_lshl_b32 s23, s23, 1
    v_and_b32 v52, 7, v1
    v_lshl_add_u32 v52, v52, 3, s23
    v_lshrrev_b32 v53, 4, v1
    v_lshl_add_u32 v53, s20, 2, v53
    v_lshl_add_u32 v54, v53, 2, s22
    ds_read_b32 v40, v54
    v_lshlrev_b32 v44, 2, v53
    ds_bpermute_b32 v44, v44, v66
    s_movk_i32 s20, 1152
    v_mad_u32_u24 v41, v53, s20, v52
    v_add_u32 v41, 22528, v41
    v_add_u32 v42, 13952, v52
    s_movk_i32 s20, 1152
    s_waitcnt lgkmcnt(0)
    v_and_b32 v43, 0x7ff, v40
    v_sub_u32 v43, 2047, v43
    v_mad_u32_u24 v43, v43, s20, v52
    v_add_u32 v44, v44, v52
    v_ashrrev_i32 v45, 31, v40
    v_not_b32 v45, v45
    v_or_b32 v45, 0x80000000, v45
    v_xor_b32 v45, v45, v40
    v_and_b32 v45, s12, v45
    v_mul_f32 v45, 0xbfb8aa3b, v45
    v_exp_f32 v45, v45
    s_nop 0
    v_add_f32 v45, 1.0, v45
    v_rcp_f32 v45, v45
    s_nop 0
    v_cvt_pk_bf16_f32 v45, v45, v45
    v_and_b32 v45, s12, v45
XP:
    global_load_ushort v46, v41, s[68:69] sc1
    global_load_ushort v47, v44, s[68:69] sc1
    global_load_ushort v48, v42, s[68:69] sc1
    s_waitcnt vmcnt(0)
    v_max_u32 v49, v46, v47
    v_cmp_eq_u32 vcc, 0xffff, v49
    s_cbranch_vccz XPD
    s_sub_u32 s10, s10, 1
    s_cbranch_scc1 EXIT
    s_branch XP
XPD:
    v_lshlrev_b32 v46, 16, v46
    v_lshlrev_b32 v47, 16, v47
    v_lshlrev_b32 v48, 16, v48
S4:
    s_mul_i32 s20, s8, 18432
    s_add_u32 s20, s20, 7340032
    v_lshl_add_u32 v52, v0, 4, s20
    v_add_u32 v53, 8192, v52
    v_add_u32 v54, 16384, v52
    v_mov_b32 v72, 0
    v_mov_b32 v73, 0
    v_mov_b32 v74, 0
    v_mov_b32 v75, 0
    v_lshrrev_b32 v55, 4, v1
    v_and_b32 v56, 7, v1
    v_lshl_add_u32 v55, v55, 3, v56
    v_lshlrev_b32 v55, 2, v55
    s_lshl_b32 s20, s3, 7
    v_add_u32 v56, s20, v55
    s_cmp_lg_u32 s3, 1
    s_cbranch_scc1 TRD
    s_mul_i32 s20, s8, 18432
    s_add_u32 s20, s20, 7348224
    v_mov_b32 v57, s20
TRP:
    global_load_dword v58, v57, s[68:69] sc1
    s_waitcnt vmcnt(0)
    v_cmp_eq_u32 vcc, -1, v58
    s_cbranch_vccz TRD
    s_sub_u32 s10, s10, 1
    s_cbranch_scc1 EXIT
    s_branch TRP
TRD:
    s_barrier
PP:
    global_load_dwordx4 v[64:67], v52, s[68:69] sc1
    global_load_dwordx4 v[68:71], v53, s[68:69] sc1
    s_cmp_ge_u32 s3, 2
    s_cbranch_scc1 PP2
    global_load_dwordx4 v[72:75], v54, s[68:69] sc1
PP2:
    s_waitcnt vmcnt(0)
    v_max3_u32 v76, v64, v65, v66
    v_max3_u32 v76, v76, v67, v68
    v_max3_u32 v76, v76, v69, v70
    v_max3_u32 v76, v76, v71, v72
    v_max3_u32 v76, v76, v73, v74
    v_max_u32 v76, v76, v75
    v_cmp_eq_u32 vcc, -1, v76
    s_cbranch_vccz PPD
    s_sub_u32 s10, s10, 1
    s_cbranch_scc1 EXIT
    s_branch PP
PPD:
    v_pk_add_f32 v[64:65], v[64:65], v[68:69]
    v_pk_add_f32 v[66:67], v[66:67], v[70:71]
    v_pk_add_f32 v[64:65], v[64:65], v[72:73]
    v_pk_add_f32 v[66:67], v[66:67], v[74:75]
    s_nop 1
    v_permlane32_swap_b32 v64, v66
    v_permlane32_swap_b32 v65, v67
    v_pk_add_f32 v[64:65], v[64:65], v[66:67]
    s_nop 1
    v_permlane16_swap_b32 v64, v65
    v_add_f32 v64, v64, v65
    s_nop 1
    v_add_f32_dpp v64, v64, v64 row_ror:8 row_mask:0xf bank_mask:0xf
    s_mov_b32 exec_lo, 0x00ff00ff
    s_mov_b32 exec_hi, 0x00ff00ff
    ds_write_b32 v56, v64 offset:26624
    s_waitcnt lgkmcnt(0)
    s_barrier
    s_cmp_lg_u32 s3, 0
    s_cbranch_scc1 FIN
    ds_read_b32 v64, v55 offset:26624
    ds_read_b32 v65, v55 offset:26752
    ds_read_b32 v66, v55 offset:26880
    ds_read_b32 v67, v55 offset:27008
    ds_read_b32 v68, v55 offset:27136
    ds_read_b32 v69, v55 offset:27264
    ds_read_b32 v70, v55 offset:27392
    ds_read_b32 v71, v55 offset:27520
    s_waitcnt lgkmcnt(0)
    v_pk_add_f32 v[64:65], v[64:65], v[68:69]
    v_pk_add_f32 v[66:67], v[66:67], v[70:71]
    v_pk_add_f32 v[64:65], v[64:65], v[66:67]
    v_add_f32 v64, v64, v65
    v_cvt_pk_bf16_f32 v64, v64, v64
    v_and_b32 v64, s12, v64
    v_mul_f32 v64, v64, v45
    v_cvt_pk_bf16_f32 v64, v64, v64
    v_and_b32 v64, s12, v64
    v_add_f32 v64, v64, v47
    v_cvt_pk_bf16_f32 v64, v64, v64
    v_and_b32 v64, s12, v64
    v_mul_f32 v64, v64, v48
    v_cvt_pk_bf16_f32 v64, v64, v64
    v_and_b32 v64, s12, v64
    v_add_f32 v64, v64, v46
    v_cvt_pk_bf16_f32 v64, v64, v64
    global_store_short v43, v64, s[64:65] sc1
FIN:
EXIT:
    s_endpgm
CODE_END:
.section .rodata,"a"
.p2align 6
.amdhsa_kernel adaLN_cond__ssm_conv_s4d__moe_arch_mod__prompt_kernel
  .amdhsa_next_free_vgpr 256
  .amdhsa_next_free_sgpr 102
  .amdhsa_accum_offset 256
  .amdhsa_group_segment_fixed_size 0
  .amdhsa_kernarg_size 136
  .amdhsa_user_sgpr_count 2
  .amdhsa_user_sgpr_kernarg_segment_ptr 1
  .amdhsa_system_sgpr_workgroup_id_x 1
.end_amdhsa_kernel
```

```asm
; @launch grid=(256,1,1) block=(512,1,1) lds=163456
.amdgcn_target "amdgcn-amd-amdhsa--gfx950"
.text
.globl adaLN_cond__ssm_conv_s4d__moe_arch_mod__prompt_kernel
.p2align 8
.type adaLN_cond__ssm_conv_s4d__moe_arch_mod__prompt_kernel,@function
adaLN_cond__ssm_conv_s4d__moe_arch_mod__prompt_kernel:
    s_cmp_ge_u32 s2, 256
    s_cbranch_scc1 EXIT
    s_load_dwordx16 s[36:51], s[0:1], 0
    s_load_dwordx16 s[52:67], s[0:1], 64
    s_load_dwordx2 s[68:69], s[0:1], 128
    v_lshrrev_b32 v2, 6, v0
    v_and_b32 v1, 63, v0
    v_readfirstlane_b32 s3, v2
    s_and_b32 s4, s2, 7
    s_lshr_b32 s5, s2, 3
    s_mul_i32 s6, s4, 18
    s_add_u32 s6, s6, s5
    s_sub_u32 s20, s5, 18
    s_and_b32 s21, s20, 1
    s_lshr_b32 s20, s20, 1
    s_lshl_b32 s20, s20, 4
    s_lshl1_add_u32 s7, s4, s21
    s_add_u32 s7, s7, s20
    s_and_b32 s9, s3, 3
    s_mov_b32 s8, s6
    s_cmp_lt_u32 s5, 18
    s_cselect_b32 s13, 1, 0
    s_cmp_ge_u32 s3, 4
    s_cselect_b32 s13, s13, 0
    s_mov_b32 s10, 0x20000
    s_mov_b32 s12, 0xffff0000
    s_lshl_b32 s11, s2, 3
    s_add_u32 s11, s11, s3
    v_lshlrev_b32 v7, 4, v1
    v_lshlrev_b32 v13, 1, v1
    v_add_u32 v13, 1024, v13
    s_cmp_lt_u32 s3, 4
    s_cbranch_scc1 ENT_A
ENT_B:
    s_cmp_lg_u32 s3, 4
    s_cbranch_scc1 ENT_B2
    v_lshlrev_b32 v64, 2, v1
    v_add_u32 v64, 143488, v64
    v_cmp_gt_u32 vcc, 16, v1
    s_nop 1
    v_cndmask_b32 v65, -1, 0, vcc
    s_mov_b32 exec_hi, 0
    ds_write_b32 v64, v65
    s_mov_b32 exec_hi, -1
ENT_B2:
    s_cmp_ge_u32 s5, 18
    s_cbranch_scc0 CONV_B
    s_branch NONCONV
ENT_A:
    s_cmp_lg_u32 s3, 3
    s_cbranch_scc1 ENT_A2
    s_getpc_b64 s[20:21]
PCREF:
    s_lshl_b32 s22, s5, 10
    v_add_u32 v64, s22, v7
    v_min_u32 v64, CODE_END-PCREF-16, v64
    v_mov_b32 v65, 0
    v_lshl_add_u64 v[64:65], v[64:65], 0, s[20:21]
    global_load_dwordx4 v[240:243], v[64:65], off
ENT_A2:
    s_cmp_ge_u32 s5, 18
    s_cbranch_scc1 NONCONV
    s_lshl_b32 s20, s6, 2
    s_add_u32 s20, s20, s3
    s_lshl_b32 s21, s20, 8
    v_lshl_add_u32 v64, v1, 2, s21
    s_lshl_b32 s14, s20, 1
    v_mov_b32 v65, s14
    s_mul_i32 s15, s3, 31232
    s_waitcnt lgkmcnt(0)
    global_load_ushort v70, v65, s[46:47]
    global_load_dword v66, v64, s[38:39] nt
    global_load_dword v67, v64, s[40:41] nt
    global_load_dword v68, v64, s[42:43] nt
    global_load_dword v69, v64, s[44:45] nt
    global_load_ushort v71, v65, s[48:49]
    global_load_dwordx4 v[8:11], v7, s[52:53]
    global_load_ushort v12, v13, s[52:53]
    s_barrier
    s_load_dword s99, s[68:69], 94208
    v_lshl_add_u32 v224, v1, 3, s15
    v_bfe_u32 v72, v1, 2, 3
    v_mov_b32 v73, 0
    v_cmp_eq_u32 vcc, 0, v72
    v_mov_b32 v74, 0x3020100
    s_nop 0
    v_cndmask_b32 v73, v73, v74, vcc
    v_cmp_eq_u32 vcc, 1, v72
    v_mov_b32 v74, 0x6050404
    s_nop 0
    v_cndmask_b32 v73, v73, v74, vcc
    v_cmp_eq_u32 vcc, 2, v72
    v_mov_b32 v74, 0xa090807
    s_nop 0
    v_cndmask_b32 v73, v73, v74, vcc
    v_cmp_eq_u32 vcc, 3, v72
    v_mov_b32 v74, 0xc0b0606
    s_nop 0
    v_cndmask_b32 v73, v73, v74, vcc
    v_cmp_eq_u32 vcc, 4, v72
    v_mov_b32 v74, 0xf0f0e0d
    s_nop 0
    v_cndmask_b32 v73, v73, v74, vcc
    v_cmp_eq_u32 vcc, 5, v72
    v_mov_b32 v74, 0x12121110
    s_nop 0
    v_cndmask_b32 v73, v73, v74, vcc
    v_cmp_eq_u32 vcc, 6, v72
    v_mov_b32 v74, 0x16151413
    s_nop 0
    v_cndmask_b32 v73, v73, v74, vcc
    v_cmp_eq_u32 vcc, 7, v72
    v_mov_b32 v74, 0x1a191817
    s_nop 0
    v_cndmask_b32 v73, v73, v74, vcc
    v_and_b32 v72, 3, v1
    v_lshlrev_b32 v72, 3, v72
    v_bfe_u32 v73, v73, v72, 8
    v_lshrrev_b32 v72, 5, v1
    v_lshl_add_u32 v72, v72, 4, s15
    s_movk_i32 s20, 528
    v_mad_u32_u24 v225, v73, s20, v72
    v_and_b32 v73, 31, v1
    v_add_u32 v73, 27, v73
    v_mad_u32_u24 v226, v73, s20, v72
    v_lshlrev_b32 v72, 4, v1
    v_sub_u32 v227, 1008, v72
    v_add_u32 v227, s15, v227
    v_and_b32 v72, 3, v1
    v_sub_u32 v72, 3, v72
    s_movk_i32 s20, 4160
    v_mul_u32_u24 v72, s20, v72
    v_bfe_u32 v73, v1, 2, 2
    v_sub_u32 v73, 3, v73
    v_lshl_add_u32 v72, v73, 3, v72
    v_lshrrev_b32 v73, 4, v1
    v_lshl_add_u32 v72, v73, 4, v72
    v_add_u32 v228, s15, v72
    v_and_b32 v72, 15, v1
    v_lshlrev_b32 v72, 5, v72
    v_lshl_add_u32 v74, v73, 4, v72
    s_mul_i32 s20, s3, 4640
    s_add_u32 s20, s20, 124928
    v_add_u32 v229, s20, v74
    v_lshl_add_u32 v74, v73, 3, v72
    s_lshl_b32 s20, s3, 6
    s_add_u32 s20, s20, s15
    v_add_u32 v230, s20, v74
    s_mov_b32 s16, 0x3fb8aa3b
    s_mov_b32 s17, 0x3e22f983
    s_waitcnt vmcnt(6)
    v_lshlrev_b32 v70, 16, v70
    v_mul_f32 v70, s16, v70
    v_exp_f32 v70, v70
    v_lshlrev_b32 v74, 16, v66
    v_and_b32 v75, s12, v66
    v_mul_f32 v74, s16, v74
    v_mul_f32 v75, s16, v75
    v_exp_f32 v74, v74
    v_exp_f32 v75, v75
    v_cvt_pk_bf16_f32 v70, v70, v70
    v_and_b32 v70, s12, v70
    v_cvt_pk_bf16_f32 v74, v74, v75
    v_and_b32 v75, s12, v74
    v_lshlrev_b32 v74, 16, v74
    v_mul_f32 v74, v74, v70
    v_mul_f32 v75, v75, v70
    v_mul_f32 v74, 0xbfb8aa3b, v74
    v_mul_f32 v75, 0xbfb8aa3b, v75
    s_waitcnt vmcnt(5)
    v_lshlrev_b32 v76, 16, v67
    v_and_b32 v77, s12, v67
    v_mul_f32 v76, v76, v70
    v_mul_f32 v77, v77, v70
    v_mul_f32 v76, s17, v76
    v_mul_f32 v77, s17, v77
    v_exp_f32 v96, v74
    v_fract_f32 v97, v76
    v_cos_f32 v98, v97
    v_sin_f32 v99, v97
    v_exp_f32 v100, v75
    v_fract_f32 v101, v77
    v_cos_f32 v102, v101
    v_sin_f32 v103, v101
    v_mul_f32 v84, v96, v98
    v_mul_f32 v86, v96, v99
    v_mul_f32 v85, v100, v102
    v_mul_f32 v87, v100, v103
    v_mul_f32 v96, 0x41000000, v74
    v_mul_f32 v97, 0x41000000, v76
    v_exp_f32 v96, v96
    v_fract_f32 v97, v97
    v_cos_f32 v98, v97
    v_sin_f32 v99, v97
    v_mul_f32 v100, 0x41000000, v75
    v_mul_f32 v101, 0x41000000, v77
    v_exp_f32 v100, v100
    v_fract_f32 v101, v101
    v_cos_f32 v102, v101
    v_sin_f32 v103, v101
    v_mul_f32 v88, v96, v98
    v_mul_f32 v90, v96, v99
    v_mul_f32 v89, v100, v102
    v_mul_f32 v91, v100, v103
    v_mul_f32 v96, 0x43800000, v74
    v_mul_f32 v97, 0x43800000, v76
    v_exp_f32 v96, v96
    v_fract_f32 v97, v97
    v_cos_f32 v98, v97
    v_sin_f32 v99, v97
    v_mul_f32 v100, 0x43800000, v75
    v_mul_f32 v101, 0x43800000, v77
    v_exp_f32 v100, v100
    v_fract_f32 v101, v101
    v_cos_f32 v102, v101
    v_sin_f32 v103, v101
    v_mul_f32 v92, v96, v98
    v_mul_f32 v94, v96, v99
    v_mul_f32 v93, v100, v102
    v_mul_f32 v95, v100, v103
    s_waitcnt vmcnt(2)
    v_lshlrev_b32 v78, 16, v68
    v_and_b32 v79, s12, v68
    v_lshlrev_b32 v80, 16, v69
    v_and_b32 v81, s12, v69
    v_max_f32 v82, |v78|, |v79|
    v_max3_f32 v82, |v80|, |v81|, v82
    s_nop 1
    v_max_f32_dpp v82, v82, v82 row_ror:8 row_mask:0xf bank_mask:0xf
    s_nop 1
    v_max_f32_dpp v82, v82, v82 row_ror:4 row_mask:0xf bank_mask:0xf
    s_nop 1
    v_max_f32_dpp v82, v82, v82 row_ror:2 row_mask:0xf bank_mask:0xf
    s_nop 1
    v_max_f32_dpp v82, v82, v82 row_ror:1 row_mask:0xf bank_mask:0xf
    v_mov_b32 v83, v82
    s_nop 1
    v_permlane16_swap_b32 v82, v83
    v_max_f32 v82, v82, v83
    v_mov_b32 v83, v82
    s_nop 1
    v_permlane32_swap_b32 v82, v83
    v_max_f32 v82, v82, v83
    v_max_f32 v82, 0x0da24260, v82
    v_rcp_f32 v83, v82
    v_lshlrev_b32 v71, 16, v71
    v_mul_f32 v82, v82, v70
    v_add_f32 v82, v82, v82
    v_and_b32 v72, 0x7fffffff, v71
    v_mul_f32 v72, 0x3a800000, v72
    v_max_f32 v72, v72, v82
    v_max_f32 v72, 0x0da24260, v72
    v_rcp_f32 v73, v72
    v_mov_b32 v233, v72
    v_mul_f32 v231, v82, v73
    v_mul_f32 v232, v71, v73
    v_pk_mul_f32 v[104:105], v[78:79], v[82:83] op_sel:[0,1] op_sel_hi:[1,1]
    v_pk_mul_f32 v[106:107], v[80:81], v[82:83] op_sel:[0,1] op_sel_hi:[1,1]
    v_mov_b32 v148, 0x3c00
    v_cvt_pk_f16_f32 v144, v104, v106
    v_mov_b32 v149, 0x3c00
    v_cvt_pk_f16_f32 v145, v105, v107
    ds_write_b64 v224, v[148:149] offset:14256
    ds_write_b64 v224, v[144:145] offset:0
    v_pk_mul_f32 v[128:129], v[88:89], 1.0 op_sel_hi:[1,0]
    v_pk_mul_f32 v[136:137], v[106:107], v[86:87]
    v_pk_mul_f32 v[130:131], v[90:91], -1.0 op_sel_hi:[1,0]
    v_pk_mul_f32 v[138:139], v[106:107], v[84:85]
    v_cvt_pk_f16_f32 v150, v128, v130
    v_pk_fma_f32 v[126:127], v[104:105], v[86:87], v[138:139]
    v_cvt_pk_f16_f32 v151, v129, v131
    v_pk_fma_f32 v[124:125], v[104:105], v[84:85], v[136:137] neg_lo:[0,0,1] neg_hi:[0,0,1]
    ds_write_b64 v224, v[150:151] offset:14784
    v_cvt_pk_f16_f32 v146, v124, v126
    v_pk_mul_f32 v[140:141], v[130:131], v[90:91]
    v_cvt_pk_f16_f32 v147, v125, v127
    v_pk_mul_f32 v[142:143], v[130:131], v[88:89]
    ds_write_b64 v224, v[146:147] offset:528
    v_pk_fma_f32 v[130:131], v[128:129], v[90:91], v[142:143] neg_lo:[0,1,0] neg_hi:[0,1,0]
    v_pk_mul_f32 v[136:137], v[126:127], v[86:87]
    v_pk_fma_f32 v[128:129], v[128:129], v[88:89], v[140:141]
    v_pk_mul_f32 v[138:139], v[126:127], v[84:85]
    v_cvt_pk_f16_f32 v148, v128, v130
    v_pk_fma_f32 v[110:111], v[124:125], v[86:87], v[138:139]
    v_cvt_pk_f16_f32 v149, v129, v131
    v_pk_fma_f32 v[108:109], v[124:125], v[84:85], v[136:137] neg_lo:[0,0,1] neg_hi:[0,0,1]
    ds_write_b64 v224, v[148:149] offset:15312
    v_cvt_pk_f16_f32 v144, v108, v110
    v_pk_mul_f32 v[140:141], v[130:131], v[90:91]
    v_cvt_pk_f16_f32 v145, v109, v111
    v_pk_mul_f32 v[142:143], v[130:131], v[88:89]
    ds_write_b64 v224, v[144:145] offset:1056
    v_pk_fma_f32 v[130:131], v[128:129], v[90:91], v[142:143] neg_lo:[0,1,0] neg_hi:[0,1,0]
    v_pk_mul_f32 v[136:137], v[110:111], v[86:87]
    v_pk_fma_f32 v[128:129], v[128:129], v[88:89], v[140:141]
    v_pk_mul_f32 v[138:139], v[110:111], v[84:85]
    v_cvt_pk_f16_f32 v150, v128, v130
    v_pk_fma_f32 v[126:127], v[108:109], v[86:87], v[138:139]
    v_cvt_pk_f16_f32 v151, v129, v131
    v_pk_fma_f32 v[124:125], v[108:109], v[84:85], v[136:137] neg_lo:[0,0,1] neg_hi:[0,0,1]
    ds_write_b64 v224, v[150:151] offset:15840
    v_cvt_pk_f16_f32 v146, v124, v126
    v_pk_mul_f32 v[140:141], v[130:131], v[90:91]
    v_cvt_pk_f16_f32 v147, v125, v127
    v_pk_mul_f32 v[142:143], v[130:131], v[88:89]
    ds_write_b64 v224, v[146:147] offset:1584
    v_pk_fma_f32 v[130:131], v[128:129], v[90:91], v[142:143] neg_lo:[0,1,0] neg_hi:[0,1,0]
    v_pk_mul_f32 v[136:137], v[126:127], v[86:87]
    v_pk_fma_f32 v[128:129], v[128:129], v[88:89], v[140:141]
    v_pk_mul_f32 v[138:139], v[126:127], v[84:85]
    v_cvt_pk_f16_f32 v148, v128, v130
    v_pk_fma_f32 v[114:115], v[124:125], v[86:87], v[138:139]
    v_cvt_pk_f16_f32 v149, v129, v131
    v_pk_fma_f32 v[112:113], v[124:125], v[84:85], v[136:137] neg_lo:[0,0,1] neg_hi:[0,0,1]
    ds_write_b64 v224, v[148:149] offset:16368
    v_cvt_pk_f16_f32 v144, v112, v114
    v_pk_mul_f32 v[140:141], v[130:131], v[90:91]
    v_cvt_pk_f16_f32 v145, v113, v115
    v_pk_mul_f32 v[142:143], v[130:131], v[88:89]
    ds_write_b64 v224, v[144:145] offset:3696
    v_pk_fma_f32 v[130:131], v[128:129], v[90:91], v[142:143] neg_lo:[0,1,0] neg_hi:[0,1,0]
    v_pk_mul_f32 v[136:137], v[114:115], v[86:87]
    v_pk_fma_f32 v[128:129], v[128:129], v[88:89], v[140:141]
    v_pk_mul_f32 v[138:139], v[114:115], v[84:85]
    v_cvt_pk_f16_f32 v150, v128, v130
    v_pk_fma_f32 v[126:127], v[112:113], v[86:87], v[138:139]
    v_cvt_pk_f16_f32 v151, v129, v131
    v_pk_fma_f32 v[124:125], v[112:113], v[84:85], v[136:137] neg_lo:[0,0,1] neg_hi:[0,0,1]
    ds_write_b64 v224, v[150:151] offset:16896
    v_cvt_pk_f16_f32 v146, v124, v126
    v_pk_mul_f32 v[140:141], v[130:131], v[90:91]
    v_cvt_pk_f16_f32 v147, v125, v127
    v_pk_mul_f32 v[142:143], v[130:131], v[88:89]
    ds_write_b64 v224, v[146:147] offset:4224
    v_pk_fma_f32 v[130:131], v[128:129], v[90:91], v[142:143] neg_lo:[0,1,0] neg_hi:[0,1,0]
    v_pk_mul_f32 v[136:137], v[126:127], v[86:87]
    v_pk_fma_f32 v[128:129], v[128:129], v[88:89], v[140:141]
    v_pk_mul_f32 v[138:139], v[126:127], v[84:85]
    v_cvt_pk_f16_f32 v148, v128, v130
    v_pk_fma_f32 v[118:119], v[124:125], v[86:87], v[138:139]
    v_cvt_pk_f16_f32 v149, v129, v131
    v_pk_fma_f32 v[116:117], v[124:125], v[84:85], v[136:137] neg_lo:[0,0,1] neg_hi:[0,0,1]
    ds_write_b64 v224, v[148:149] offset:17424
    v_cvt_pk_f16_f32 v144, v116, v118
    v_pk_mul_f32 v[140:141], v[130:131], v[90:91]
    v_cvt_pk_f16_f32 v145, v117, v119
    v_pk_mul_f32 v[142:143], v[130:131], v[88:89]
    ds_write_b64 v224, v[144:145] offset:4752
    v_pk_fma_f32 v[130:131], v[128:129], v[90:91], v[142:143] neg_lo:[0,1,0] neg_hi:[0,1,0]
    v_pk_mul_f32 v[136:137], v[118:119], v[86:87]
    v_pk_fma_f32 v[128:129], v[128:129], v[88:89], v[140:141]
    v_pk_mul_f32 v[138:139], v[118:119], v[84:85]
    v_cvt_pk_f16_f32 v150, v128, v130
    v_pk_fma_f32 v[126:127], v[116:117], v[86:87], v[138:139]
    v_cvt_pk_f16_f32 v151, v129, v131
    v_pk_fma_f32 v[124:125], v[116:117], v[84:85], v[136:137] neg_lo:[0,0,1] neg_hi:[0,0,1]
    ds_write_b64 v224, v[150:151] offset:17952
    v_cvt_pk_f16_f32 v146, v124, v126
    v_pk_mul_f32 v[140:141], v[130:131], v[90:91]
    v_cvt_pk_f16_f32 v147, v125, v127
    v_pk_mul_f32 v[142:143], v[130:131], v[88:89]
    ds_write_b64 v224, v[146:147] offset:5280
    v_pk_fma_f32 v[130:131], v[128:129], v[90:91], v[142:143] neg_lo:[0,1,0] neg_hi:[0,1,0]
    v_pk_mul_f32 v[136:137], v[126:127], v[86:87]
    v_pk_fma_f32 v[128:129], v[128:129], v[88:89], v[140:141]
    v_pk_mul_f32 v[138:139], v[126:127], v[84:85]
    v_cvt_pk_f16_f32 v148, v128, v130
    v_pk_fma_f32 v[122:123], v[124:125], v[86:87], v[138:139]
    v_cvt_pk_f16_f32 v149, v129, v131
    v_pk_fma_f32 v[120:121], v[124:125], v[84:85], v[136:137] neg_lo:[0,0,1] neg_hi:[0,0,1]
    ds_write_b64 v224, v[148:149] offset:18480
    v_pk_mul_f32 v[136:137], v[106:107], v[94:95]
    v_pk_mul_f32 v[140:141], v[130:131], v[90:91]
    v_pk_mul_f32 v[138:139], v[106:107], v[92:93]
    v_pk_mul_f32 v[142:143], v[130:131], v[88:89]
    v_pk_fma_f32 v[106:107], v[104:105], v[94:95], v[138:139]
    v_pk_fma_f32 v[130:131], v[128:129], v[90:91], v[142:143] neg_lo:[0,1,0] neg_hi:[0,1,0]
    v_pk_fma_f32 v[104:105], v[104:105], v[92:93], v[136:137] neg_lo:[0,0,1] neg_hi:[0,0,1]
    v_pk_fma_f32 v[128:129], v[128:129], v[88:89], v[140:141]
    v_cvt_pk_f16_f32 v146, v104, v106
    v_cvt_pk_f16_f32 v150, v128, v130
    v_cvt_pk_f16_f32 v147, v105, v107
    v_cvt_pk_f16_f32 v151, v129, v131
    ds_write_b64 v224, v[146:147] offset:2112
    ds_write_b64 v224, v[150:151] offset:19008
    v_pk_mul_f32 v[136:137], v[110:111], v[94:95]
    v_pk_mul_f32 v[140:141], v[130:131], v[90:91]
    v_pk_mul_f32 v[138:139], v[110:111], v[92:93]
    v_pk_mul_f32 v[142:143], v[130:131], v[88:89]
    v_pk_fma_f32 v[110:111], v[108:109], v[94:95], v[138:139]
    v_pk_fma_f32 v[130:131], v[128:129], v[90:91], v[142:143] neg_lo:[0,1,0] neg_hi:[0,1,0]
    v_pk_fma_f32 v[108:109], v[108:109], v[92:93], v[136:137] neg_lo:[0,0,1] neg_hi:[0,0,1]
    v_pk_fma_f32 v[128:129], v[128:129], v[88:89], v[140:141]
    v_cvt_pk_f16_f32 v144, v108, v110
    v_cvt_pk_f16_f32 v148, v128, v130
    v_cvt_pk_f16_f32 v145, v109, v111
    v_cvt_pk_f16_f32 v149, v129, v131
    ds_write_b64 v224, v[144:145] offset:2640
    ds_write_b64 v224, v[148:149] offset:19536
    v_pk_mul_f32 v[136:137], v[114:115], v[94:95]
    v_pk_mul_f32 v[140:141], v[130:131], v[90:91]
    v_pk_mul_f32 v[138:139], v[114:115], v[92:93]
    v_pk_mul_f32 v[142:143], v[130:131], v[88:89]
    v_pk_fma_f32 v[114:115], v[112:113], v[94:95], v[138:139]
    v_pk_fma_f32 v[130:131], v[128:129], v[90:91], v[142:143] neg_lo:[0,1,0] neg_hi:[0,1,0]
    v_pk_fma_f32 v[112:113], v[112:113], v[92:93], v[136:137] neg_lo:[0,0,1] neg_hi:[0,0,1]
    v_pk_fma_f32 v[128:129], v[128:129], v[88:89], v[140:141]
    v_cvt_pk_f16_f32 v146, v112, v114
    v_cvt_pk_f16_f32 v150, v128, v130
    v_cvt_pk_f16_f32 v147, v113, v115
    v_cvt_pk_f16_f32 v151, v129, v131
    ds_write_b64 v224, v[146:147] offset:3168
    ds_write_b64 v224, v[150:151] offset:20064
    v_pk_mul_f32 v[136:137], v[118:119], v[94:95]
    v_pk_mul_f32 v[140:141], v[130:131], v[90:91]
    v_pk_mul_f32 v[138:139], v[118:119], v[92:93]
    v_pk_mul_f32 v[142:143], v[130:131], v[88:89]
    v_pk_fma_f32 v[118:119], v[116:117], v[94:95], v[138:139]
    v_pk_fma_f32 v[130:131], v[128:129], v[90:91], v[142:143] neg_lo:[0,1,0] neg_hi:[0,1,0]
    v_pk_fma_f32 v[116:117], v[116:117], v[92:93], v[136:137] neg_lo:[0,0,1] neg_hi:[0,0,1]
    v_pk_fma_f32 v[128:129], v[128:129], v[88:89], v[140:141]
    v_cvt_pk_f16_f32 v144, v116, v118
    v_cvt_pk_f16_f32 v148, v128, v130
    v_cvt_pk_f16_f32 v145, v117, v119
    v_cvt_pk_f16_f32 v149, v129, v131
    ds_write_b64 v224, v[144:145] offset:5808
    ds_write_b64 v224, v[148:149] offset:20592
    v_pk_mul_f32 v[136:137], v[122:123], v[94:95]
    v_pk_mul_f32 v[140:141], v[130:131], v[90:91]
    v_pk_mul_f32 v[138:139], v[122:123], v[92:93]
    v_pk_mul_f32 v[142:143], v[130:131], v[88:89]
    v_pk_fma_f32 v[122:123], v[120:121], v[94:95], v[138:139]
    v_pk_fma_f32 v[130:131], v[128:129], v[90:91], v[142:143] neg_lo:[0,1,0] neg_hi:[0,1,0]
    v_pk_fma_f32 v[120:121], v[120:121], v[92:93], v[136:137] neg_lo:[0,0,1] neg_hi:[0,0,1]
    v_pk_fma_f32 v[128:129], v[128:129], v[88:89], v[140:141]
    v_cvt_pk_f16_f32 v146, v120, v122
    v_cvt_pk_f16_f32 v150, v128, v130
    v_cvt_pk_f16_f32 v147, v121, v123
    v_cvt_pk_f16_f32 v151, v129, v131
    ds_write_b64 v224, v[146:147] offset:6336
    ds_write_b64 v224, v[150:151] offset:21120
    v_pk_mul_f32 v[136:137], v[106:107], v[94:95]
    v_pk_mul_f32 v[140:141], v[130:131], v[90:91]
    v_pk_mul_f32 v[138:139], v[106:107], v[92:93]
    v_pk_mul_f32 v[142:143], v[130:131], v[88:89]
    v_pk_fma_f32 v[106:107], v[104:105], v[94:95], v[138:139]
    v_pk_fma_f32 v[130:131], v[128:129], v[90:91], v[142:143] neg_lo:[0,1,0] neg_hi:[0,1,0]
    v_pk_fma_f32 v[104:105], v[104:105], v[92:93], v[136:137] neg_lo:[0,0,1] neg_hi:[0,0,1]
    v_pk_fma_f32 v[128:129], v[128:129], v[88:89], v[140:141]
    v_cvt_pk_f16_f32 v144, v104, v106
    v_cvt_pk_f16_f32 v148, v128, v130
    v_cvt_pk_f16_f32 v145, v105, v107
    v_cvt_pk_f16_f32 v149, v129, v131
    ds_write_b64 v224, v[144:145] offset:6864
    ds_write_b64 v224, v[148:149] offset:21648
    v_pk_mul_f32 v[136:137], v[114:115], v[94:95]
    v_pk_mul_f32 v[140:141], v[130:131], v[90:91]
    v_pk_mul_f32 v[138:139], v[114:115], v[92:93]
    v_pk_mul_f32 v[142:143], v[130:131], v[88:89]
    v_pk_fma_f32 v[114:115], v[112:113], v[94:95], v[138:139]
    v_pk_fma_f32 v[130:131], v[128:129], v[90:91], v[142:143] neg_lo:[0,1,0] neg_hi:[0,1,0]
    v_pk_fma_f32 v[112:113], v[112:113], v[92:93], v[136:137] neg_lo:[0,0,1] neg_hi:[0,0,1]
    v_pk_fma_f32 v[128:129], v[128:129], v[88:89], v[140:141]
    v_cvt_pk_f16_f32 v146, v112, v114
    v_cvt_pk_f16_f32 v150, v128, v130
    v_cvt_pk_f16_f32 v147, v113, v115
    v_cvt_pk_f16_f32 v151, v129, v131
    ds_write_b64 v224, v[146:147] offset:7392
    ds_write_b64 v224, v[150:151] offset:22176
    v_pk_mul_f32 v[136:137], v[122:123], v[94:95]
    v_pk_mul_f32 v[140:141], v[130:131], v[90:91]
    v_pk_mul_f32 v[138:139], v[122:123], v[92:93]
    v_pk_mul_f32 v[142:143], v[130:131], v[88:89]
    v_pk_fma_f32 v[122:123], v[120:121], v[94:95], v[138:139]
    v_pk_fma_f32 v[130:131], v[128:129], v[90:91], v[142:143] neg_lo:[0,1,0] neg_hi:[0,1,0]
    v_pk_fma_f32 v[120:121], v[120:121], v[92:93], v[136:137] neg_lo:[0,0,1] neg_hi:[0,0,1]
    v_pk_fma_f32 v[128:129], v[128:129], v[88:89], v[140:141]
    v_cvt_pk_f16_f32 v144, v120, v122
    v_cvt_pk_f16_f32 v148, v128, v130
    v_cvt_pk_f16_f32 v145, v121, v123
    v_cvt_pk_f16_f32 v149, v129, v131
    ds_write_b64 v224, v[144:145] offset:7920
    ds_write_b64 v224, v[148:149] offset:22704
    v_pk_mul_f32 v[136:137], v[106:107], v[94:95]
    v_pk_mul_f32 v[140:141], v[130:131], v[90:91]
    v_pk_mul_f32 v[138:139], v[106:107], v[92:93]
    v_pk_mul_f32 v[142:143], v[130:131], v[88:89]
    v_pk_fma_f32 v[106:107], v[104:105], v[94:95], v[138:139]
    v_pk_fma_f32 v[130:131], v[128:129], v[90:91], v[142:143] neg_lo:[0,1,0] neg_hi:[0,1,0]
    v_pk_fma_f32 v[104:105], v[104:105], v[92:93], v[136:137] neg_lo:[0,0,1] neg_hi:[0,0,1]
    v_pk_fma_f32 v[128:129], v[128:129], v[88:89], v[140:141]
    v_cvt_pk_f16_f32 v146, v104, v106
    v_cvt_pk_f16_f32 v150, v128, v130
    v_cvt_pk_f16_f32 v147, v105, v107
    v_cvt_pk_f16_f32 v151, v129, v131
    ds_write_b64 v224, v[146:147] offset:8448
    ds_write_b64 v224, v[150:151] offset:23232
    v_pk_mul_f32 v[136:137], v[114:115], v[94:95]
    v_pk_mul_f32 v[140:141], v[130:131], v[90:91]
    v_pk_mul_f32 v[138:139], v[114:115], v[92:93]
    v_pk_mul_f32 v[142:143], v[130:131], v[88:89]
    v_pk_fma_f32 v[114:115], v[112:113], v[94:95], v[138:139]
    v_pk_fma_f32 v[130:131], v[128:129], v[90:91], v[142:143] neg_lo:[0,1,0] neg_hi:[0,1,0]
    v_pk_fma_f32 v[112:113], v[112:113], v[92:93], v[136:137] neg_lo:[0,0,1] neg_hi:[0,0,1]
    v_pk_fma_f32 v[128:129], v[128:129], v[88:89], v[140:141]
    v_cvt_pk_f16_f32 v144, v112, v114
    v_cvt_pk_f16_f32 v148, v128, v130
    v_cvt_pk_f16_f32 v145, v113, v115
    v_cvt_pk_f16_f32 v149, v129, v131
    ds_write_b64 v224, v[144:145] offset:8976
    ds_write_b64 v224, v[148:149] offset:23760
    v_pk_mul_f32 v[136:137], v[122:123], v[94:95]
    v_pk_mul_f32 v[140:141], v[130:131], v[90:91]
    v_pk_mul_f32 v[138:139], v[122:123], v[92:93]
    v_pk_mul_f32 v[142:143], v[130:131], v[88:89]
    v_pk_fma_f32 v[122:123], v[120:121], v[94:95], v[138:139]
    v_pk_fma_f32 v[130:131], v[128:129], v[90:91], v[142:143] neg_lo:[0,1,0] neg_hi:[0,1,0]
    v_pk_fma_f32 v[120:121], v[120:121], v[92:93], v[136:137] neg_lo:[0,0,1] neg_hi:[0,0,1]
    v_pk_fma_f32 v[128:129], v[128:129], v[88:89], v[140:141]
    v_cvt_pk_f16_f32 v146, v120, v122
    v_cvt_pk_f16_f32 v150, v128, v130
    v_cvt_pk_f16_f32 v147, v121, v123
    v_cvt_pk_f16_f32 v151, v129, v131
    ds_write_b64 v224, v[146:147] offset:9504
    ds_write_b64 v224, v[150:151] offset:24288
    v_pk_mul_f32 v[136:137], v[106:107], v[94:95]
    v_pk_mul_f32 v[140:141], v[130:131], v[90:91]
    v_pk_mul_f32 v[138:139], v[106:107], v[92:93]
    v_pk_mul_f32 v[142:143], v[130:131], v[88:89]
    v_pk_fma_f32 v[106:107], v[104:105], v[94:95], v[138:139]
    v_pk_fma_f32 v[130:131], v[128:129], v[90:91], v[142:143] neg_lo:[0,1,0] neg_hi:[0,1,0]
    v_pk_fma_f32 v[104:105], v[104:105], v[92:93], v[136:137] neg_lo:[0,0,1] neg_hi:[0,0,1]
    v_pk_fma_f32 v[128:129], v[128:129], v[88:89], v[140:141]
    v_cvt_pk_f16_f32 v144, v104, v106
    v_cvt_pk_f16_f32 v148, v128, v130
    v_cvt_pk_f16_f32 v145, v105, v107
    v_cvt_pk_f16_f32 v149, v129, v131
    ds_write_b64 v224, v[144:145] offset:10032
    ds_write_b64 v224, v[148:149] offset:24816
    v_pk_mul_f32 v[136:137], v[122:123], v[94:95]
    v_pk_mul_f32 v[140:141], v[130:131], v[90:91]
    v_pk_mul_f32 v[138:139], v[122:123], v[92:93]
    v_pk_mul_f32 v[142:143], v[130:131], v[88:89]
    v_pk_fma_f32 v[122:123], v[120:121], v[94:95], v[138:139]
    v_pk_fma_f32 v[130:131], v[128:129], v[90:91], v[142:143] neg_lo:[0,1,0] neg_hi:[0,1,0]
    v_pk_fma_f32 v[120:121], v[120:121], v[92:93], v[136:137] neg_lo:[0,0,1] neg_hi:[0,0,1]
    v_pk_fma_f32 v[128:129], v[128:129], v[88:89], v[140:141]
    v_cvt_pk_f16_f32 v146, v120, v122
    v_cvt_pk_f16_f32 v150, v128, v130
    v_cvt_pk_f16_f32 v147, v121, v123
    v_cvt_pk_f16_f32 v151, v129, v131
    ds_write_b64 v224, v[146:147] offset:10560
    ds_write_b64 v224, v[150:151] offset:25344
    v_pk_mul_f32 v[136:137], v[106:107], v[94:95]
    v_pk_mul_f32 v[140:141], v[130:131], v[90:91]
    v_pk_mul_f32 v[138:139], v[106:107], v[92:93]
    v_pk_mul_f32 v[142:143], v[130:131], v[88:89]
    v_pk_fma_f32 v[106:107], v[104:105], v[94:95], v[138:139]
    v_pk_fma_f32 v[130:131], v[128:129], v[90:91], v[142:143] neg_lo:[0,1,0] neg_hi:[0,1,0]
    v_pk_fma_f32 v[104:105], v[104:105], v[92:93], v[136:137] neg_lo:[0,0,1] neg_hi:[0,0,1]
    v_pk_fma_f32 v[128:129], v[128:129], v[88:89], v[140:141]
    v_cvt_pk_f16_f32 v144, v104, v106
    v_cvt_pk_f16_f32 v148, v128, v130
    v_cvt_pk_f16_f32 v145, v105, v107
    v_cvt_pk_f16_f32 v149, v129, v131
    ds_write_b64 v224, v[144:145] offset:12144
    ds_write_b64 v224, v[148:149] offset:25872
    v_pk_mul_f32 v[136:137], v[122:123], v[94:95]
    v_pk_mul_f32 v[140:141], v[130:131], v[90:91]
    v_pk_mul_f32 v[138:139], v[122:123], v[92:93]
    v_pk_mul_f32 v[142:143], v[130:131], v[88:89]
    v_pk_fma_f32 v[122:123], v[120:121], v[94:95], v[138:139]
    v_pk_fma_f32 v[130:131], v[128:129], v[90:91], v[142:143] neg_lo:[0,1,0] neg_hi:[0,1,0]
    v_pk_fma_f32 v[120:121], v[120:121], v[92:93], v[136:137] neg_lo:[0,0,1] neg_hi:[0,0,1]
    v_pk_fma_f32 v[128:129], v[128:129], v[88:89], v[140:141]
    v_cvt_pk_f16_f32 v146, v120, v122
    v_cvt_pk_f16_f32 v150, v128, v130
    v_cvt_pk_f16_f32 v147, v121, v123
    v_cvt_pk_f16_f32 v151, v129, v131
    ds_write_b64 v224, v[146:147] offset:12672
    ds_write_b64 v224, v[150:151] offset:26400
    v_pk_mul_f32 v[136:137], v[106:107], v[94:95]
    v_pk_mul_f32 v[140:141], v[130:131], v[90:91]
    v_pk_mul_f32 v[138:139], v[106:107], v[92:93]
    v_pk_mul_f32 v[142:143], v[130:131], v[88:89]
    v_pk_fma_f32 v[106:107], v[104:105], v[94:95], v[138:139]
    v_pk_fma_f32 v[130:131], v[128:129], v[90:91], v[142:143] neg_lo:[0,1,0] neg_hi:[0,1,0]
    v_pk_fma_f32 v[104:105], v[104:105], v[92:93], v[136:137] neg_lo:[0,0,1] neg_hi:[0,0,1]
    v_pk_fma_f32 v[128:129], v[128:129], v[88:89], v[140:141]
    v_cvt_pk_f16_f32 v144, v104, v106
    v_cvt_pk_f16_f32 v148, v128, v130
    v_cvt_pk_f16_f32 v145, v105, v107
    v_cvt_pk_f16_f32 v149, v129, v131
    ds_write_b64 v224, v[144:145] offset:11088
    ds_write_b64 v224, v[148:149] offset:26928
    v_pk_mul_f32 v[136:137], v[122:123], v[94:95]
    v_pk_mul_f32 v[140:141], v[130:131], v[90:91]
    v_pk_mul_f32 v[138:139], v[122:123], v[92:93]
    v_pk_mul_f32 v[142:143], v[130:131], v[88:89]
    v_pk_fma_f32 v[122:123], v[120:121], v[94:95], v[138:139]
    v_pk_fma_f32 v[130:131], v[128:129], v[90:91], v[142:143] neg_lo:[0,1,0] neg_hi:[0,1,0]
    v_pk_fma_f32 v[120:121], v[120:121], v[92:93], v[136:137] neg_lo:[0,0,1] neg_hi:[0,0,1]
    v_pk_fma_f32 v[128:129], v[128:129], v[88:89], v[140:141]
    v_cvt_pk_f16_f32 v146, v120, v122
    v_cvt_pk_f16_f32 v150, v128, v130
    v_cvt_pk_f16_f32 v147, v121, v123
    v_cvt_pk_f16_f32 v151, v129, v131
    ds_write_b64 v224, v[146:147] offset:11616
    ds_write_b64 v224, v[150:151] offset:27456
    v_pk_mul_f32 v[136:137], v[106:107], v[94:95]
    v_pk_mul_f32 v[140:141], v[130:131], v[90:91]
    v_pk_mul_f32 v[138:139], v[106:107], v[92:93]
    v_pk_mul_f32 v[142:143], v[130:131], v[88:89]
    v_pk_fma_f32 v[106:107], v[104:105], v[94:95], v[138:139]
    v_pk_fma_f32 v[130:131], v[128:129], v[90:91], v[142:143] neg_lo:[0,1,0] neg_hi:[0,1,0]
    v_pk_fma_f32 v[104:105], v[104:105], v[92:93], v[136:137] neg_lo:[0,0,1] neg_hi:[0,0,1]
    v_pk_fma_f32 v[128:129], v[128:129], v[88:89], v[140:141]
    v_cvt_pk_f16_f32 v144, v104, v106
    v_cvt_pk_f16_f32 v148, v128, v130
    v_cvt_pk_f16_f32 v145, v105, v107
    v_cvt_pk_f16_f32 v149, v129, v131
    ds_write_b64 v224, v[144:145] offset:13200
    ds_write_b64 v224, v[148:149] offset:27984
    v_pk_mul_f32 v[136:137], v[122:123], v[94:95]
    v_pk_mul_f32 v[140:141], v[130:131], v[90:91]
    v_pk_mul_f32 v[138:139], v[122:123], v[92:93]
    v_pk_mul_f32 v[142:143], v[130:131], v[88:89]
    v_pk_fma_f32 v[122:123], v[120:121], v[94:95], v[138:139]
    v_pk_fma_f32 v[130:131], v[128:129], v[90:91], v[142:143] neg_lo:[0,1,0] neg_hi:[0,1,0]
    v_pk_fma_f32 v[120:121], v[120:121], v[92:93], v[136:137] neg_lo:[0,0,1] neg_hi:[0,0,1]
    v_pk_fma_f32 v[128:129], v[128:129], v[88:89], v[140:141]
    v_cvt_pk_f16_f32 v146, v120, v122
    v_cvt_pk_f16_f32 v150, v128, v130
    v_cvt_pk_f16_f32 v147, v121, v123
    v_cvt_pk_f16_f32 v151, v129, v131
    ds_write_b64 v224, v[146:147] offset:13728
    ds_write_b64 v224, v[150:151] offset:28512
    v_pk_mul_f32 v[140:141], v[130:131], v[90:91]
    v_pk_mul_f32 v[142:143], v[130:131], v[88:89]
    v_pk_fma_f32 v[130:131], v[128:129], v[90:91], v[142:143] neg_lo:[0,1,0] neg_hi:[0,1,0]
    v_pk_fma_f32 v[128:129], v[128:129], v[88:89], v[140:141]
    v_cvt_pk_f16_f32 v148, v128, v130
    v_cvt_pk_f16_f32 v149, v129, v131
    ds_write_b64 v224, v[148:149] offset:29040
    v_pk_mul_f32 v[140:141], v[130:131], v[90:91]
    v_pk_mul_f32 v[142:143], v[130:131], v[88:89]
    v_pk_fma_f32 v[130:131], v[128:129], v[90:91], v[142:143] neg_lo:[0,1,0] neg_hi:[0,1,0]
    v_pk_fma_f32 v[128:129], v[128:129], v[88:89], v[140:141]
    v_cvt_pk_f16_f32 v150, v128, v130
    v_cvt_pk_f16_f32 v151, v129, v131
    ds_write_b64 v224, v[150:151] offset:29568
    v_pk_mul_f32 v[140:141], v[130:131], v[90:91]
    v_pk_mul_f32 v[142:143], v[130:131], v[88:89]
    v_pk_fma_f32 v[130:131], v[128:129], v[90:91], v[142:143] neg_lo:[0,1,0] neg_hi:[0,1,0]
    v_pk_fma_f32 v[128:129], v[128:129], v[88:89], v[140:141]
    v_cvt_pk_f16_f32 v148, v128, v130
    v_cvt_pk_f16_f32 v149, v129, v131
    ds_write_b64 v224, v[148:149] offset:30096
    v_pk_mul_f32 v[140:141], v[130:131], v[90:91]
    v_pk_mul_f32 v[142:143], v[130:131], v[88:89]
    v_pk_fma_f32 v[130:131], v[128:129], v[90:91], v[142:143] neg_lo:[0,1,0] neg_hi:[0,1,0]
    v_pk_fma_f32 v[128:129], v[128:129], v[88:89], v[140:141]
    v_cvt_pk_f16_f32 v150, v128, v130
    v_cvt_pk_f16_f32 v151, v129, v131
    ds_write_b64 v224, v[150:151] offset:30624
    s_waitcnt lgkmcnt(0)
    ds_read_b128 v[64:67], v225 offset:0
    ds_read_b128 v[68:71], v226 offset:0
    ds_read_b128 v[72:75], v225 offset:32
    ds_read_b128 v[76:79], v226 offset:32
    ds_read_b128 v[80:83], v225 offset:64
    ds_read_b128 v[84:87], v226 offset:64
    ds_read_b128 v[88:91], v225 offset:96
    ds_read_b128 v[92:95], v226 offset:96
    ds_read_b128 v[96:99], v225 offset:128
    ds_read_b128 v[100:103], v226 offset:128
    ds_read_b128 v[104:107], v225 offset:160
    ds_read_b128 v[108:111], v226 offset:160
    s_waitcnt lgkmcnt(10)
    v_mfma_f32_32x32x16_f16 v[176:191], v[64:67], v[68:71], 0
    ds_read_b128 v[64:67], v225 offset:192
    ds_read_b128 v[68:71], v226 offset:192
    s_waitcnt lgkmcnt(10)
    v_mfma_f32_32x32x16_f16 v[176:191], v[72:75], v[76:79], v[176:191]
    ds_read_b128 v[72:75], v225 offset:224
    ds_read_b128 v[76:79], v226 offset:224
    s_waitcnt lgkmcnt(10)
    v_mfma_f32_32x32x16_f16 v[176:191], v[80:83], v[84:87], v[176:191]
    ds_read_b128 v[80:83], v225 offset:256
    ds_read_b128 v[84:87], v226 offset:256
    s_waitcnt lgkmcnt(10)
    v_mfma_f32_32x32x16_f16 v[176:191], v[88:91], v[92:95], v[176:191]
    ds_read_b128 v[88:91], v225 offset:288
    ds_read_b128 v[92:95], v226 offset:288
    s_waitcnt lgkmcnt(10)
    v_mfma_f32_32x32x16_f16 v[176:191], v[96:99], v[100:103], v[176:191]
    ds_read_b128 v[96:99], v225 offset:320
    ds_read_b128 v[100:103], v226 offset:320
    s_waitcnt lgkmcnt(10)
    v_mfma_f32_32x32x16_f16 v[176:191], v[104:107], v[108:111], v[176:191]
    ds_read_b128 v[104:107], v225 offset:352
    ds_read_b128 v[108:111], v226 offset:352
    s_waitcnt lgkmcnt(10)
    v_mfma_f32_32x32x16_f16 v[176:191], v[64:67], v[68:71], v[176:191]
    ds_read_b128 v[64:67], v225 offset:384
    ds_read_b128 v[68:71], v226 offset:384
    s_waitcnt lgkmcnt(10)
    v_mfma_f32_32x32x16_f16 v[176:191], v[72:75], v[76:79], v[176:191]
    ds_read_b128 v[72:75], v225 offset:416
    ds_read_b128 v[76:79], v226 offset:416
    s_waitcnt lgkmcnt(10)
    v_mfma_f32_32x32x16_f16 v[176:191], v[80:83], v[84:87], v[176:191]
    ds_read_b128 v[80:83], v225 offset:448
    ds_read_b128 v[84:87], v226 offset:448
    s_waitcnt lgkmcnt(10)
    v_mfma_f32_32x32x16_f16 v[176:191], v[88:91], v[92:95], v[176:191]
    ds_read_b128 v[88:91], v225 offset:480
    ds_read_b128 v[92:95], v226 offset:480
    s_waitcnt lgkmcnt(10)
    v_mfma_f32_32x32x16_f16 v[176:191], v[96:99], v[100:103], v[176:191]
    s_waitcnt lgkmcnt(8)
    v_mfma_f32_32x32x16_f16 v[176:191], v[104:107], v[108:111], v[176:191]
    s_waitcnt lgkmcnt(6)
    v_mfma_f32_32x32x16_f16 v[176:191], v[64:67], v[68:71], v[176:191]
    s_waitcnt lgkmcnt(4)
    v_mfma_f32_32x32x16_f16 v[176:191], v[72:75], v[76:79], v[176:191]
    s_waitcnt lgkmcnt(2)
    v_mfma_f32_32x32x16_f16 v[176:191], v[80:83], v[84:87], v[176:191]
    s_waitcnt lgkmcnt(0)
    v_mfma_f32_32x32x16_f16 v[176:191], v[88:91], v[92:95], v[176:191]
    v_mov_b32 v64, 0
    v_mov_b32 v65, 0
    v_mov_b32 v66, 0
    v_mov_b32 v67, 0
    v_lshrrev_b32 v68, 1, v1
    s_movk_i32 s20, 4160
    v_mul_u32_u24 v68, s20, v68
    v_and_b32 v69, 1, v1
    v_lshl_add_u32 v68, v69, 4, v68
    v_add_u32 v68, s15, v68
    v_cmp_eq_u32 vcc, 0, v69
    v_cmp_eq_u32 s[20:21], 0, v1
    s_nop 1
    v_cndmask_b32 v70, 0, v232, s[20:21]
    v_pk_mul_f32 v[176:177], v[176:177], v[230:231] op_sel:[0,1] op_sel_hi:[1,1]
    v_pk_mul_f32 v[178:179], v[178:179], v[230:231] op_sel:[0,1] op_sel_hi:[1,1]
    v_pk_mul_f32 v[180:181], v[180:181], v[230:231] op_sel:[0,1] op_sel_hi:[1,1]
    v_pk_mul_f32 v[182:183], v[182:183], v[230:231] op_sel:[0,1] op_sel_hi:[1,1]
    v_pk_mul_f32 v[184:185], v[184:185], v[230:231] op_sel:[0,1] op_sel_hi:[1,1]
    v_pk_mul_f32 v[186:187], v[186:187], v[230:231] op_sel:[0,1] op_sel_hi:[1,1]
    v_pk_mul_f32 v[188:189], v[188:189], v[230:231] op_sel:[0,1] op_sel_hi:[1,1]
    v_pk_mul_f32 v[190:191], v[190:191], v[230:231] op_sel:[0,1] op_sel_hi:[1,1]
    v_add_f32 v176, v176, v70
    v_cndmask_b32 v71, v189, v188, vcc
    v_cndmask_b32 v72, v191, v190, vcc
    s_mov_b64 exec, 0xff
    ds_write_b128 v68, v[64:67] offset:4096
    s_mov_b64 exec, -1
    v_cvt_pk_f16_f32 v76, v183, v182
    v_cvt_pk_f16_f32 v77, v181, v180
    v_cvt_pk_f16_f32 v78, v179, v178
    v_cvt_pk_f16_f32 v79, v177, v176
    v_mov_b32 v83, 0
    v_mov_b32 v91, 0
    v_cvt_pk_f16_f32 v80, v181, v180
    v_cvt_pk_f16_f32 v81, v179, v178
    v_cvt_pk_f16_f32 v82, v177, v176
    v_alignbit_b32 v84, v77, v76, 16
    v_alignbit_b32 v85, v78, v77, 16
    v_alignbit_b32 v86, v79, v78, 16
    v_mov_b32_dpp v83, v76 wave_shr:1 row_mask:0xf bank_mask:0xf
    v_mov_b32_dpp v91, v84 wave_shr:1 row_mask:0xf bank_mask:0xf
    ds_write_b128 v227, v[76:79] offset:3072
    v_mov_b32 v88, v85
    v_mov_b32 v89, v86
    v_alignbit_b32 v87, v83, v79, 16
    v_alignbit_b32 v90, v83, v79, 16
    ds_write_b128 v227, v[80:83] offset:11392
    ds_write_b128 v227, v[84:87] offset:7232
    ds_write_b128 v227, v[88:91] offset:15552
    v_cvt_pk_f16_f32 v96, v186, v186
    v_cvt_pk_f16_f32 v97, v185, v185
    v_cvt_pk_f16_f32 v98, v185, v184
    v_cvt_pk_f16_f32 v99, v184, v184
    v_mov_b32_dpp v103, v76 wave_ror:1 row_mask:0xf bank_mask:0xf
    v_mov_b32_dpp v111, v84 wave_ror:1 row_mask:0xf bank_mask:0xf
    v_cvt_pk_f16_f32 v100, v185, v185
    v_cvt_pk_f16_f32 v101, v185, v184
    v_cvt_pk_f16_f32 v102, v184, v184
    v_alignbit_b32 v104, v97, v96, 16
    v_alignbit_b32 v105, v98, v97, 16
    v_alignbit_b32 v106, v99, v98, 16
    v_mov_b32_dpp v103, v96 wave_shr:1 row_mask:0xf bank_mask:0xf
    v_mov_b32_dpp v111, v104 wave_shr:1 row_mask:0xf bank_mask:0xf
    ds_write_b128 v227, v[96:99] offset:2048
    v_mov_b32 v108, v105
    v_mov_b32 v109, v106
    v_alignbit_b32 v107, v103, v99, 16
    v_alignbit_b32 v110, v103, v99, 16
    ds_write_b128 v227, v[100:103] offset:10368
    ds_write_b128 v227, v[104:107] offset:6208
    ds_write_b128 v227, v[108:111] offset:14528
    v_cvt_pk_f16_f32 v116, v189, v189
    v_cvt_pk_f16_f32 v117, v189, v71
    v_cvt_pk_f16_f32 v118, v188, v188
    v_cvt_pk_f16_f32 v119, v188, v188
    v_mov_b32_dpp v123, v96 wave_ror:1 row_mask:0xf bank_mask:0xf
    v_mov_b32_dpp v131, v104 wave_ror:1 row_mask:0xf bank_mask:0xf
    v_cvt_pk_f16_f32 v120, v189, v71
    v_cvt_pk_f16_f32 v121, v188, v188
    v_cvt_pk_f16_f32 v122, v188, v188
    v_alignbit_b32 v124, v117, v116, 16
    v_alignbit_b32 v125, v118, v117, 16
    v_alignbit_b32 v126, v119, v118, 16
    v_mov_b32_dpp v123, v116 wave_shr:1 row_mask:0xf bank_mask:0xf
    v_mov_b32_dpp v131, v124 wave_shr:1 row_mask:0xf bank_mask:0xf
    ds_write_b128 v227, v[116:119] offset:1024
    v_mov_b32 v128, v125
    v_mov_b32 v129, v126
    v_alignbit_b32 v127, v123, v119, 16
    v_alignbit_b32 v130, v123, v119, 16
    ds_write_b128 v227, v[120:123] offset:9344
    ds_write_b128 v227, v[124:127] offset:5184
    ds_write_b128 v227, v[128:131] offset:13504
    v_cvt_pk_f16_f32 v136, v191, v191
    v_cvt_pk_f16_f32 v137, v191, v72
    v_cvt_pk_f16_f32 v138, v190, v190
    v_cvt_pk_f16_f32 v139, v190, v190
    v_mov_b32_dpp v143, v116 wave_ror:1 row_mask:0xf bank_mask:0xf
    v_mov_b32_dpp v151, v124 wave_ror:1 row_mask:0xf bank_mask:0xf
    v_cvt_pk_f16_f32 v140, v191, v72
    v_cvt_pk_f16_f32 v141, v190, v190
    v_cvt_pk_f16_f32 v142, v190, v190
    v_alignbit_b32 v144, v137, v136, 16
    v_alignbit_b32 v145, v138, v137, 16
    v_alignbit_b32 v146, v139, v138, 16
    v_mov_b32_dpp v143, v136 wave_shr:1 row_mask:0xf bank_mask:0xf
    v_mov_b32_dpp v151, v144 wave_shr:1 row_mask:0xf bank_mask:0xf
    ds_write_b128 v227, v[136:139] offset:0
    v_mov_b32 v148, v145
    v_mov_b32 v149, v146
    v_alignbit_b32 v147, v143, v139, 16
    v_alignbit_b32 v150, v143, v139, 16
    ds_write_b128 v227, v[140:143] offset:8320
    ds_write_b128 v227, v[144:147] offset:4160
    ds_write_b128 v227, v[148:151] offset:12480
    s_waitcnt lgkmcnt(0)
    ds_read_b64 v[64:65], v228 offset:4032
    ds_read_b64 v[66:67], v228 offset:4040
    ds_read_b64 v[68:69], v228 offset:3520
    ds_read_b64 v[70:71], v228 offset:3528
    ds_read_b64 v[72:73], v228 offset:3008
    ds_read_b64 v[74:75], v228 offset:3016
    ds_read_b64 v[76:77], v228 offset:2496
    ds_read_b64 v[78:79], v228 offset:2504
    ds_read_b64 v[80:81], v228 offset:1984
    ds_read_b64 v[82:83], v228 offset:1992
    ds_read_b64 v[84:85], v228 offset:1472
    ds_read_b64 v[86:87], v228 offset:1480
    ds_read_b64 v[88:89], v228 offset:960
    ds_read_b64 v[90:91], v228 offset:968
    ds_read_b64 v[92:93], v228 offset:448
    ds_read_b64 v[94:95], v228 offset:456
    s_waitcnt lgkmcnt(0)
    s_add_u32 s99, s99, 1
    s_barrier
    ds_read_b128 v[96:99], v229 offset:480
    ds_read_b128 v[100:103], v229 offset:992
    ds_read_b128 v[104:107], v229 offset:1504
    ds_read_b128 v[108:111], v229 offset:2016
    ds_read_b128 v[112:115], v229 offset:2528
    ds_read_b128 v[116:119], v229 offset:3040
    ds_read_b128 v[120:123], v229 offset:3552
    ds_read_b128 v[124:127], v229 offset:4064
    s_waitcnt lgkmcnt(0)
    v_mfma_f32_16x16x32_f16 v[220:223], v[64:67], v[124:127], 0
    ds_read_b64 v[128:129], v228 offset:3968
    v_mfma_f32_16x16x32_f16 v[216:219], v[64:67], v[120:123], 0
    ds_read_b64 v[130:131], v228 offset:3976
    v_mfma_f32_16x16x32_f16 v[212:215], v[64:67], v[116:119], 0
    ds_read_b128 v[160:163], v229 offset:416
    v_mfma_f32_16x16x32_f16 v[208:211], v[64:67], v[112:115], 0
    ds_read_b128 v[164:167], v229 offset:928
    v_mfma_f32_16x16x32_f16 v[220:223], v[68:71], v[120:123], v[220:223]
    ds_read_b128 v[168:171], v229 offset:1440
    v_mfma_f32_16x16x32_f16 v[216:219], v[68:71], v[116:119], v[216:219]
    ds_read_b128 v[172:175], v229 offset:1952
    v_mfma_f32_16x16x32_f16 v[212:215], v[68:71], v[112:115], v[212:215]
    ds_read_b128 v[176:179], v229 offset:2464
    v_mfma_f32_16x16x32_f16 v[204:207], v[64:67], v[108:111], 0
    ds_read_b128 v[180:183], v229 offset:2976
    v_mfma_f32_16x16x32_f16 v[220:223], v[72:75], v[116:119], v[220:223]
    ds_read_b128 v[184:187], v229 offset:3488
    v_mfma_f32_16x16x32_f16 v[216:219], v[72:75], v[112:115], v[216:219]
    ds_read_b128 v[188:191], v229 offset:4000
    v_mfma_f32_16x16x32_f16 v[208:211], v[68:71], v[108:111], v[208:211]
    ds_read_b64 v[132:133], v228 offset:3456
    v_mfma_f32_16x16x32_f16 v[212:215], v[72:75], v[108:111], v[212:215]
    ds_read_b64 v[134:135], v228 offset:3464
    v_mfma_f32_16x16x32_f16 v[220:223], v[76:79], v[112:115], v[220:223]
    ds_read_b64 v[136:137], v228 offset:2944
    v_mfma_f32_16x16x32_f16 v[216:219], v[76:79], v[108:111], v[216:219]
    ds_read_b64 v[138:139], v228 offset:2952
    v_mfma_f32_16x16x32_f16 v[200:203], v[64:67], v[104:107], 0
    ds_read_b64 v[140:141], v228 offset:2432
    v_mfma_f32_16x16x32_f16 v[204:207], v[68:71], v[104:107], v[204:207]
    ds_read_b64 v[142:143], v228 offset:2440
    v_mfma_f32_16x16x32_f16 v[220:223], v[80:83], v[108:111], v[220:223]
    ds_read_b64 v[144:145], v228 offset:1920
    v_mfma_f32_16x16x32_f16 v[208:211], v[72:75], v[104:107], v[208:211]
    ds_read_b64 v[146:147], v228 offset:1928
    v_mfma_f32_16x16x32_f16 v[212:215], v[76:79], v[104:107], v[212:215]
    ds_read_b64 v[148:149], v228 offset:1408
    v_mfma_f32_16x16x32_f16 v[216:219], v[80:83], v[104:107], v[216:219]
    ds_read_b64 v[150:151], v228 offset:1416
    v_mfma_f32_16x16x32_f16 v[220:223], v[84:87], v[104:107], v[220:223]
    ds_read_b64 v[152:153], v228 offset:896
    v_mfma_f32_16x16x32_f16 v[196:199], v[64:67], v[100:103], 0
    ds_read_b64 v[154:155], v228 offset:904
    v_mfma_f32_16x16x32_f16 v[200:203], v[68:71], v[100:103], v[200:203]
    ds_read_b64 v[156:157], v228 offset:384
    v_mfma_f32_16x16x32_f16 v[204:207], v[72:75], v[100:103], v[204:207]
    ds_read_b64 v[158:159], v228 offset:392
    v_mfma_f32_16x16x32_f16 v[208:211], v[76:79], v[100:103], v[208:211]
    v_mfma_f32_16x16x32_f16 v[212:215], v[80:83], v[100:103], v[212:215]
    v_mfma_f32_16x16x32_f16 v[216:219], v[84:87], v[100:103], v[216:219]
    v_mfma_f32_16x16x32_f16 v[220:223], v[88:91], v[100:103], v[220:223]
    v_mfma_f32_16x16x32_f16 v[192:195], v[64:67], v[96:99], 0
    v_mfma_f32_16x16x32_f16 v[196:199], v[68:71], v[96:99], v[196:199]
    v_mfma_f32_16x16x32_f16 v[200:203], v[72:75], v[96:99], v[200:203]
    v_mfma_f32_16x16x32_f16 v[204:207], v[76:79], v[96:99], v[204:207]
    v_mfma_f32_16x16x32_f16 v[208:211], v[80:83], v[96:99], v[208:211]
    v_mfma_f32_16x16x32_f16 v[212:215], v[84:87], v[96:99], v[212:215]
    v_mfma_f32_16x16x32_f16 v[216:219], v[88:91], v[96:99], v[216:219]
    v_mfma_f32_16x16x32_f16 v[220:223], v[92:95], v[96:99], v[220:223]
    s_waitcnt lgkmcnt(0)
    v_mfma_f32_16x16x32_f16 v[208:211], v[128:131], v[176:179], v[208:211]
    ds_read_b64 v[64:65], v228 offset:3904
    v_mfma_f32_16x16x32_f16 v[212:215], v[128:131], v[180:183], v[212:215]
    ds_read_b64 v[66:67], v228 offset:3912
    v_mfma_f32_16x16x32_f16 v[216:219], v[128:131], v[184:187], v[216:219]
    ds_read_b128 v[96:99], v229 offset:352
    v_mfma_f32_16x16x32_f16 v[220:223], v[128:131], v[188:191], v[220:223]
    ds_read_b128 v[100:103], v229 offset:864
    v_mfma_f32_16x16x32_f16 v[204:207], v[128:131], v[172:175], v[204:207]
    ds_read_b128 v[104:107], v229 offset:1376
    v_mfma_f32_16x16x32_f16 v[212:215], v[132:135], v[176:179], v[212:215]
    ds_read_b128 v[108:111], v229 offset:1888
    v_mfma_f32_16x16x32_f16 v[216:219], v[132:135], v[180:183], v[216:219]
    ds_read_b128 v[112:115], v229 offset:2400
    v_mfma_f32_16x16x32_f16 v[220:223], v[132:135], v[184:187], v[220:223]
    ds_read_b128 v[116:119], v229 offset:2912
    v_mfma_f32_16x16x32_f16 v[208:211], v[132:135], v[172:175], v[208:211]
    ds_read_b128 v[120:123], v229 offset:3424
    v_mfma_f32_16x16x32_f16 v[212:215], v[136:139], v[172:175], v[212:215]
    ds_read_b128 v[124:127], v229 offset:3936
    v_mfma_f32_16x16x32_f16 v[216:219], v[136:139], v[176:179], v[216:219]
    ds_read_b64 v[68:69], v228 offset:3392
    v_mfma_f32_16x16x32_f16 v[220:223], v[136:139], v[180:183], v[220:223]
    ds_read_b64 v[70:71], v228 offset:3400
    v_mfma_f32_16x16x32_f16 v[200:203], v[128:131], v[168:171], v[200:203]
    ds_read_b64 v[72:73], v228 offset:2880
    v_mfma_f32_16x16x32_f16 v[204:207], v[132:135], v[168:171], v[204:207]
    ds_read_b64 v[74:75], v228 offset:2888
    v_mfma_f32_16x16x32_f16 v[216:219], v[140:143], v[172:175], v[216:219]
    ds_read_b64 v[76:77], v228 offset:2368
    v_mfma_f32_16x16x32_f16 v[220:223], v[140:143], v[176:179], v[220:223]
    ds_read_b64 v[78:79], v228 offset:2376
    v_mfma_f32_16x16x32_f16 v[208:211], v[136:139], v[168:171], v[208:211]
    ds_read_b64 v[80:81], v228 offset:1856
    v_mfma_f32_16x16x32_f16 v[212:215], v[140:143], v[168:171], v[212:215]
    ds_read_b64 v[82:83], v228 offset:1864
    v_mfma_f32_16x16x32_f16 v[216:219], v[144:147], v[168:171], v[216:219]
    ds_read_b64 v[84:85], v228 offset:1344
    v_mfma_f32_16x16x32_f16 v[220:223], v[144:147], v[172:175], v[220:223]
    ds_read_b64 v[86:87], v228 offset:1352
    v_mfma_f32_16x16x32_f16 v[196:199], v[128:131], v[164:167], v[196:199]
    ds_read_b64 v[88:89], v228 offset:832
    v_mfma_f32_16x16x32_f16 v[200:203], v[132:135], v[164:167], v[200:203]
    ds_read_b64 v[90:91], v228 offset:840
    v_mfma_f32_16x16x32_f16 v[204:207], v[136:139], v[164:167], v[204:207]
    ds_read_b64 v[92:93], v228 offset:320
    v_mfma_f32_16x16x32_f16 v[220:223], v[148:151], v[168:171], v[220:223]
    ds_read_b64 v[94:95], v228 offset:328
    v_mfma_f32_16x16x32_f16 v[208:211], v[140:143], v[164:167], v[208:211]
    v_mfma_f32_16x16x32_f16 v[212:215], v[144:147], v[164:167], v[212:215]
    v_mfma_f32_16x16x32_f16 v[216:219], v[148:151], v[164:167], v[216:219]
    v_mfma_f32_16x16x32_f16 v[220:223], v[152:155], v[164:167], v[220:223]
    v_mfma_f32_16x16x32_f16 v[192:195], v[128:131], v[160:163], v[192:195]
    v_mfma_f32_16x16x32_f16 v[196:199], v[132:135], v[160:163], v[196:199]
    v_mfma_f32_16x16x32_f16 v[200:203], v[136:139], v[160:163], v[200:203]
    v_mfma_f32_16x16x32_f16 v[204:207], v[140:143], v[160:163], v[204:207]
    v_mfma_f32_16x16x32_f16 v[208:211], v[144:147], v[160:163], v[208:211]
    v_mfma_f32_16x16x32_f16 v[212:215], v[148:151], v[160:163], v[212:215]
    v_mfma_f32_16x16x32_f16 v[216:219], v[152:155], v[160:163], v[216:219]
    v_mfma_f32_16x16x32_f16 v[220:223], v[156:159], v[160:163], v[220:223]
    s_waitcnt lgkmcnt(0)
    v_mfma_f32_16x16x32_f16 v[208:211], v[64:67], v[112:115], v[208:211]
    ds_read_b64 v[128:129], v228 offset:3840
    v_mfma_f32_16x16x32_f16 v[212:215], v[64:67], v[116:119], v[212:215]
    ds_read_b64 v[130:131], v228 offset:3848
    v_mfma_f32_16x16x32_f16 v[216:219], v[64:67], v[120:123], v[216:219]
    ds_read_b128 v[160:163], v229 offset:288
    v_mfma_f32_16x16x32_f16 v[220:223], v[64:67], v[124:127], v[220:223]
    ds_read_b128 v[164:167], v229 offset:800
    v_mfma_f32_16x16x32_f16 v[204:207], v[64:67], v[108:111], v[204:207]
    ds_read_b128 v[168:171], v229 offset:1312
    v_mfma_f32_16x16x32_f16 v[212:215], v[68:71], v[112:115], v[212:215]
    ds_read_b128 v[172:175], v229 offset:1824
    v_mfma_f32_16x16x32_f16 v[216:219], v[68:71], v[116:119], v[216:219]
    ds_read_b128 v[176:179], v229 offset:2336
    v_mfma_f32_16x16x32_f16 v[220:223], v[68:71], v[120:123], v[220:223]
    ds_read_b128 v[180:183], v229 offset:2848
    v_mfma_f32_16x16x32_f16 v[208:211], v[68:71], v[108:111], v[208:211]
    ds_read_b128 v[184:187], v229 offset:3360
    v_mfma_f32_16x16x32_f16 v[212:215], v[72:75], v[108:111], v[212:215]
    ds_read_b128 v[188:191], v229 offset:3872
    v_mfma_f32_16x16x32_f16 v[216:219], v[72:75], v[112:115], v[216:219]
    ds_read_b64 v[132:133], v228 offset:3328
    v_mfma_f32_16x16x32_f16 v[220:223], v[72:75], v[116:119], v[220:223]
    ds_read_b64 v[134:135], v228 offset:3336
    v_mfma_f32_16x16x32_f16 v[200:203], v[64:67], v[104:107], v[200:203]
    ds_read_b64 v[136:137], v228 offset:2816
    v_mfma_f32_16x16x32_f16 v[204:207], v[68:71], v[104:107], v[204:207]
    ds_read_b64 v[138:139], v228 offset:2824
    v_mfma_f32_16x16x32_f16 v[216:219], v[76:79], v[108:111], v[216:219]
    ds_read_b64 v[140:141], v228 offset:2304
    v_mfma_f32_16x16x32_f16 v[220:223], v[76:79], v[112:115], v[220:223]
    ds_read_b64 v[142:143], v228 offset:2312
    v_mfma_f32_16x16x32_f16 v[208:211], v[72:75], v[104:107], v[208:211]
    ds_read_b64 v[144:145], v228 offset:1792
    v_mfma_f32_16x16x32_f16 v[212:215], v[76:79], v[104:107], v[212:215]
    ds_read_b64 v[146:147], v228 offset:1800
    v_mfma_f32_16x16x32_f16 v[216:219], v[80:83], v[104:107], v[216:219]
    ds_read_b64 v[148:149], v228 offset:1280
    v_mfma_f32_16x16x32_f16 v[220:223], v[80:83], v[108:111], v[220:223]
    ds_read_b64 v[150:151], v228 offset:1288
    v_mfma_f32_16x16x32_f16 v[196:199], v[64:67], v[100:103], v[196:199]
    ds_read_b64 v[152:153], v228 offset:768
    v_mfma_f32_16x16x32_f16 v[200:203], v[68:71], v[100:103], v[200:203]
    ds_read_b64 v[154:155], v228 offset:776
    v_mfma_f32_16x16x32_f16 v[204:207], v[72:75], v[100:103], v[204:207]
    ds_read_b64 v[156:157], v228 offset:256
    v_mfma_f32_16x16x32_f16 v[220:223], v[84:87], v[104:107], v[220:223]
    ds_read_b64 v[158:159], v228 offset:264
    v_mfma_f32_16x16x32_f16 v[208:211], v[76:79], v[100:103], v[208:211]
    v_mfma_f32_16x16x32_f16 v[212:215], v[80:83], v[100:103], v[212:215]
    v_mfma_f32_16x16x32_f16 v[216:219], v[84:87], v[100:103], v[216:219]
    v_mfma_f32_16x16x32_f16 v[220:223], v[88:91], v[100:103], v[220:223]
    v_mfma_f32_16x16x32_f16 v[192:195], v[64:67], v[96:99], v[192:195]
    v_mfma_f32_16x16x32_f16 v[196:199], v[68:71], v[96:99], v[196:199]
    v_mfma_f32_16x16x32_f16 v[200:203], v[72:75], v[96:99], v[200:203]
    v_mfma_f32_16x16x32_f16 v[204:207], v[76:79], v[96:99], v[204:207]
    v_mfma_f32_16x16x32_f16 v[208:211], v[80:83], v[96:99], v[208:211]
    v_mfma_f32_16x16x32_f16 v[212:215], v[84:87], v[96:99], v[212:215]
    v_mfma_f32_16x16x32_f16 v[216:219], v[88:91], v[96:99], v[216:219]
    v_mfma_f32_16x16x32_f16 v[220:223], v[92:95], v[96:99], v[220:223]
    s_waitcnt lgkmcnt(0)
    v_mfma_f32_16x16x32_f16 v[208:211], v[128:131], v[176:179], v[208:211]
    ds_read_b64 v[64:65], v228 offset:3776
    v_mfma_f32_16x16x32_f16 v[212:215], v[128:131], v[180:183], v[212:215]
    ds_read_b64 v[66:67], v228 offset:3784
    v_mfma_f32_16x16x32_f16 v[216:219], v[128:131], v[184:187], v[216:219]
    ds_read_b128 v[96:99], v229 offset:224
    v_mfma_f32_16x16x32_f16 v[220:223], v[128:131], v[188:191], v[220:223]
    ds_read_b128 v[100:103], v229 offset:736
    v_mfma_f32_16x16x32_f16 v[204:207], v[128:131], v[172:175], v[204:207]
    ds_read_b128 v[104:107], v229 offset:1248
    v_mfma_f32_16x16x32_f16 v[212:215], v[132:135], v[176:179], v[212:215]
    ds_read_b128 v[108:111], v229 offset:1760
    v_mfma_f32_16x16x32_f16 v[216:219], v[132:135], v[180:183], v[216:219]
    ds_read_b128 v[112:115], v229 offset:2272
    v_mfma_f32_16x16x32_f16 v[220:223], v[132:135], v[184:187], v[220:223]
    ds_read_b128 v[116:119], v229 offset:2784
    v_mfma_f32_16x16x32_f16 v[208:211], v[132:135], v[172:175], v[208:211]
    ds_read_b128 v[120:123], v229 offset:3296
    v_mfma_f32_16x16x32_f16 v[212:215], v[136:139], v[172:175], v[212:215]
    ds_read_b128 v[124:127], v229 offset:3808
    v_mfma_f32_16x16x32_f16 v[216:219], v[136:139], v[176:179], v[216:219]
    ds_read_b64 v[68:69], v228 offset:3264
    v_mfma_f32_16x16x32_f16 v[220:223], v[136:139], v[180:183], v[220:223]
    ds_read_b64 v[70:71], v228 offset:3272
    v_mfma_f32_16x16x32_f16 v[200:203], v[128:131], v[168:171], v[200:203]
    ds_read_b64 v[72:73], v228 offset:2752
    v_mfma_f32_16x16x32_f16 v[204:207], v[132:135], v[168:171], v[204:207]
    ds_read_b64 v[74:75], v228 offset:2760
    v_mfma_f32_16x16x32_f16 v[216:219], v[140:143], v[172:175], v[216:219]
    ds_read_b64 v[76:77], v228 offset:2240
    v_mfma_f32_16x16x32_f16 v[220:223], v[140:143], v[176:179], v[220:223]
    ds_read_b64 v[78:79], v228 offset:2248
    v_mfma_f32_16x16x32_f16 v[208:211], v[136:139], v[168:171], v[208:211]
    ds_read_b64 v[80:81], v228 offset:1728
    v_mfma_f32_16x16x32_f16 v[212:215], v[140:143], v[168:171], v[212:215]
    ds_read_b64 v[82:83], v228 offset:1736
    v_mfma_f32_16x16x32_f16 v[216:219], v[144:147], v[168:171], v[216:219]
    ds_read_b64 v[84:85], v228 offset:1216
    v_mfma_f32_16x16x32_f16 v[220:223], v[144:147], v[172:175], v[220:223]
    ds_read_b64 v[86:87], v228 offset:1224
    v_mfma_f32_16x16x32_f16 v[196:199], v[128:131], v[164:167], v[196:199]
    ds_read_b64 v[88:89], v228 offset:704
    v_mfma_f32_16x16x32_f16 v[200:203], v[132:135], v[164:167], v[200:203]
    ds_read_b64 v[90:91], v228 offset:712
    v_mfma_f32_16x16x32_f16 v[204:207], v[136:139], v[164:167], v[204:207]
    ds_read_b64 v[92:93], v228 offset:192
    v_mfma_f32_16x16x32_f16 v[220:223], v[148:151], v[168:171], v[220:223]
    ds_read_b64 v[94:95], v228 offset:200
    v_mfma_f32_16x16x32_f16 v[208:211], v[140:143], v[164:167], v[208:211]
    v_mfma_f32_16x16x32_f16 v[212:215], v[144:147], v[164:167], v[212:215]
    v_mfma_f32_16x16x32_f16 v[216:219], v[148:151], v[164:167], v[216:219]
    v_mfma_f32_16x16x32_f16 v[220:223], v[152:155], v[164:167], v[220:223]
    v_mfma_f32_16x16x32_f16 v[192:195], v[128:131], v[160:163], v[192:195]
    v_mfma_f32_16x16x32_f16 v[196:199], v[132:135], v[160:163], v[196:199]
    v_mfma_f32_16x16x32_f16 v[200:203], v[136:139], v[160:163], v[200:203]
    v_mfma_f32_16x16x32_f16 v[204:207], v[140:143], v[160:163], v[204:207]
    v_mfma_f32_16x16x32_f16 v[208:211], v[144:147], v[160:163], v[208:211]
    v_mfma_f32_16x16x32_f16 v[212:215], v[148:151], v[160:163], v[212:215]
    v_mfma_f32_16x16x32_f16 v[216:219], v[152:155], v[160:163], v[216:219]
    v_mfma_f32_16x16x32_f16 v[220:223], v[156:159], v[160:163], v[220:223]
    s_waitcnt lgkmcnt(0)
    v_mfma_f32_16x16x32_f16 v[208:211], v[64:67], v[112:115], v[208:211]
    ds_read_b64 v[128:129], v228 offset:3712
    v_mfma_f32_16x16x32_f16 v[212:215], v[64:67], v[116:119], v[212:215]
    ds_read_b64 v[130:131], v228 offset:3720
    v_mfma_f32_16x16x32_f16 v[216:219], v[64:67], v[120:123], v[216:219]
    ds_read_b128 v[160:163], v229 offset:160
    v_mfma_f32_16x16x32_f16 v[220:223], v[64:67], v[124:127], v[220:223]
    ds_read_b128 v[164:167], v229 offset:672
    v_mfma_f32_16x16x32_f16 v[204:207], v[64:67], v[108:111], v[204:207]
    ds_read_b128 v[168:171], v229 offset:1184
    v_mfma_f32_16x16x32_f16 v[212:215], v[68:71], v[112:115], v[212:215]
    ds_read_b128 v[172:175], v229 offset:1696
    v_mfma_f32_16x16x32_f16 v[216:219], v[68:71], v[116:119], v[216:219]
    ds_read_b128 v[176:179], v229 offset:2208
    v_mfma_f32_16x16x32_f16 v[220:223], v[68:71], v[120:123], v[220:223]
    ds_read_b128 v[180:183], v229 offset:2720
    v_mfma_f32_16x16x32_f16 v[208:211], v[68:71], v[108:111], v[208:211]
    ds_read_b128 v[184:187], v229 offset:3232
    v_mfma_f32_16x16x32_f16 v[212:215], v[72:75], v[108:111], v[212:215]
    ds_read_b128 v[188:191], v229 offset:3744
    v_mfma_f32_16x16x32_f16 v[216:219], v[72:75], v[112:115], v[216:219]
    ds_read_b64 v[132:133], v228 offset:3200
    v_mfma_f32_16x16x32_f16 v[220:223], v[72:75], v[116:119], v[220:223]
    ds_read_b64 v[134:135], v228 offset:3208
    v_mfma_f32_16x16x32_f16 v[200:203], v[64:67], v[104:107], v[200:203]
    ds_read_b64 v[136:137], v228 offset:2688
    v_mfma_f32_16x16x32_f16 v[204:207], v[68:71], v[104:107], v[204:207]
    ds_read_b64 v[138:139], v228 offset:2696
    v_mfma_f32_16x16x32_f16 v[216:219], v[76:79], v[108:111], v[216:219]
    ds_read_b64 v[140:141], v228 offset:2176
    v_mfma_f32_16x16x32_f16 v[220:223], v[76:79], v[112:115], v[220:223]
    ds_read_b64 v[142:143], v228 offset:2184
    v_mfma_f32_16x16x32_f16 v[208:211], v[72:75], v[104:107], v[208:211]
    ds_read_b64 v[144:145], v228 offset:1664
    v_mfma_f32_16x16x32_f16 v[212:215], v[76:79], v[104:107], v[212:215]
    ds_read_b64 v[146:147], v228 offset:1672
    v_mfma_f32_16x16x32_f16 v[216:219], v[80:83], v[104:107], v[216:219]
    ds_read_b64 v[148:149], v228 offset:1152
    v_mfma_f32_16x16x32_f16 v[220:223], v[80:83], v[108:111], v[220:223]
    ds_read_b64 v[150:151], v228 offset:1160
    v_mfma_f32_16x16x32_f16 v[196:199], v[64:67], v[100:103], v[196:199]
    ds_read_b64 v[152:153], v228 offset:640
    v_mfma_f32_16x16x32_f16 v[200:203], v[68:71], v[100:103], v[200:203]
    ds_read_b64 v[154:155], v228 offset:648
    v_mfma_f32_16x16x32_f16 v[204:207], v[72:75], v[100:103], v[204:207]
    ds_read_b64 v[156:157], v228 offset:128
    v_mfma_f32_16x16x32_f16 v[220:223], v[84:87], v[104:107], v[220:223]
    ds_read_b64 v[158:159], v228 offset:136
    v_mfma_f32_16x16x32_f16 v[208:211], v[76:79], v[100:103], v[208:211]
    v_mfma_f32_16x16x32_f16 v[212:215], v[80:83], v[100:103], v[212:215]
    v_mfma_f32_16x16x32_f16 v[216:219], v[84:87], v[100:103], v[216:219]
    v_mfma_f32_16x16x32_f16 v[220:223], v[88:91], v[100:103], v[220:223]
    v_mfma_f32_16x16x32_f16 v[192:195], v[64:67], v[96:99], v[192:195]
    v_mfma_f32_16x16x32_f16 v[196:199], v[68:71], v[96:99], v[196:199]
    v_mfma_f32_16x16x32_f16 v[200:203], v[72:75], v[96:99], v[200:203]
    v_mfma_f32_16x16x32_f16 v[204:207], v[76:79], v[96:99], v[204:207]
    v_mfma_f32_16x16x32_f16 v[208:211], v[80:83], v[96:99], v[208:211]
    v_mfma_f32_16x16x32_f16 v[212:215], v[84:87], v[96:99], v[212:215]
    v_mfma_f32_16x16x32_f16 v[216:219], v[88:91], v[96:99], v[216:219]
    v_mfma_f32_16x16x32_f16 v[220:223], v[92:95], v[96:99], v[220:223]
    s_waitcnt lgkmcnt(0)
    v_mfma_f32_16x16x32_f16 v[208:211], v[128:131], v[176:179], v[208:211]
    ds_read_b64 v[64:65], v228 offset:3648
    v_mfma_f32_16x16x32_f16 v[212:215], v[128:131], v[180:183], v[212:215]
    ds_read_b64 v[66:67], v228 offset:3656
    v_mfma_f32_16x16x32_f16 v[216:219], v[128:131], v[184:187], v[216:219]
    ds_read_b128 v[96:99], v229 offset:96
    v_mfma_f32_16x16x32_f16 v[220:223], v[128:131], v[188:191], v[220:223]
    ds_read_b128 v[100:103], v229 offset:608
    v_mfma_f32_16x16x32_f16 v[204:207], v[128:131], v[172:175], v[204:207]
    ds_read_b128 v[104:107], v229 offset:1120
    v_mfma_f32_16x16x32_f16 v[212:215], v[132:135], v[176:179], v[212:215]
    ds_read_b128 v[108:111], v229 offset:1632
    v_mfma_f32_16x16x32_f16 v[216:219], v[132:135], v[180:183], v[216:219]
    ds_read_b128 v[112:115], v229 offset:2144
    v_mfma_f32_16x16x32_f16 v[220:223], v[132:135], v[184:187], v[220:223]
    ds_read_b128 v[116:119], v229 offset:2656
    v_mfma_f32_16x16x32_f16 v[208:211], v[132:135], v[172:175], v[208:211]
    ds_read_b128 v[120:123], v229 offset:3168
    v_mfma_f32_16x16x32_f16 v[212:215], v[136:139], v[172:175], v[212:215]
    ds_read_b128 v[124:127], v229 offset:3680
    v_mfma_f32_16x16x32_f16 v[216:219], v[136:139], v[176:179], v[216:219]
    ds_read_b64 v[68:69], v228 offset:3136
    v_mfma_f32_16x16x32_f16 v[220:223], v[136:139], v[180:183], v[220:223]
    ds_read_b64 v[70:71], v228 offset:3144
    v_mfma_f32_16x16x32_f16 v[200:203], v[128:131], v[168:171], v[200:203]
    ds_read_b64 v[72:73], v228 offset:2624
    v_mfma_f32_16x16x32_f16 v[204:207], v[132:135], v[168:171], v[204:207]
    ds_read_b64 v[74:75], v228 offset:2632
    v_mfma_f32_16x16x32_f16 v[216:219], v[140:143], v[172:175], v[216:219]
    ds_read_b64 v[76:77], v228 offset:2112
    v_mfma_f32_16x16x32_f16 v[220:223], v[140:143], v[176:179], v[220:223]
    ds_read_b64 v[78:79], v228 offset:2120
    v_mfma_f32_16x16x32_f16 v[208:211], v[136:139], v[168:171], v[208:211]
    ds_read_b64 v[80:81], v228 offset:1600
    v_mfma_f32_16x16x32_f16 v[212:215], v[140:143], v[168:171], v[212:215]
    ds_read_b64 v[82:83], v228 offset:1608
    v_mfma_f32_16x16x32_f16 v[216:219], v[144:147], v[168:171], v[216:219]
    ds_read_b64 v[84:85], v228 offset:1088
    v_mfma_f32_16x16x32_f16 v[220:223], v[144:147], v[172:175], v[220:223]
    ds_read_b64 v[86:87], v228 offset:1096
    v_mfma_f32_16x16x32_f16 v[196:199], v[128:131], v[164:167], v[196:199]
    ds_read_b64 v[88:89], v228 offset:576
    v_mfma_f32_16x16x32_f16 v[200:203], v[132:135], v[164:167], v[200:203]
    ds_read_b64 v[90:91], v228 offset:584
    v_mfma_f32_16x16x32_f16 v[204:207], v[136:139], v[164:167], v[204:207]
    ds_read_b64 v[92:93], v228 offset:64
    v_mfma_f32_16x16x32_f16 v[220:223], v[148:151], v[168:171], v[220:223]
    ds_read_b64 v[94:95], v228 offset:72
    v_mfma_f32_16x16x32_f16 v[208:211], v[140:143], v[164:167], v[208:211]
    v_mfma_f32_16x16x32_f16 v[212:215], v[144:147], v[164:167], v[212:215]
    v_mfma_f32_16x16x32_f16 v[216:219], v[148:151], v[164:167], v[216:219]
    v_mfma_f32_16x16x32_f16 v[220:223], v[152:155], v[164:167], v[220:223]
    v_mfma_f32_16x16x32_f16 v[192:195], v[128:131], v[160:163], v[192:195]
    v_mfma_f32_16x16x32_f16 v[196:199], v[132:135], v[160:163], v[196:199]
    v_mfma_f32_16x16x32_f16 v[200:203], v[136:139], v[160:163], v[200:203]
    v_mfma_f32_16x16x32_f16 v[204:207], v[140:143], v[160:163], v[204:207]
    v_mfma_f32_16x16x32_f16 v[208:211], v[144:147], v[160:163], v[208:211]
    v_mfma_f32_16x16x32_f16 v[212:215], v[148:151], v[160:163], v[212:215]
    v_mfma_f32_16x16x32_f16 v[216:219], v[152:155], v[160:163], v[216:219]
    v_mfma_f32_16x16x32_f16 v[220:223], v[156:159], v[160:163], v[220:223]
    s_waitcnt lgkmcnt(0)
    v_mfma_f32_16x16x32_f16 v[208:211], v[64:67], v[112:115], v[208:211]
    ds_read_b64 v[128:129], v228 offset:3584
    v_mfma_f32_16x16x32_f16 v[212:215], v[64:67], v[116:119], v[212:215]
    ds_read_b64 v[130:131], v228 offset:3592
    v_mfma_f32_16x16x32_f16 v[216:219], v[64:67], v[120:123], v[216:219]
    ds_read_b128 v[160:163], v229 offset:32
    v_mfma_f32_16x16x32_f16 v[220:223], v[64:67], v[124:127], v[220:223]
    ds_read_b128 v[164:167], v229 offset:544
    v_mfma_f32_16x16x32_f16 v[204:207], v[64:67], v[108:111], v[204:207]
    ds_read_b128 v[168:171], v229 offset:1056
    v_mfma_f32_16x16x32_f16 v[212:215], v[68:71], v[112:115], v[212:215]
    ds_read_b128 v[172:175], v229 offset:1568
    v_mfma_f32_16x16x32_f16 v[216:219], v[68:71], v[116:119], v[216:219]
    ds_read_b128 v[176:179], v229 offset:2080
    v_mfma_f32_16x16x32_f16 v[220:223], v[68:71], v[120:123], v[220:223]
    ds_read_b128 v[180:183], v229 offset:2592
    v_mfma_f32_16x16x32_f16 v[208:211], v[68:71], v[108:111], v[208:211]
    ds_read_b128 v[184:187], v229 offset:3104
    v_mfma_f32_16x16x32_f16 v[212:215], v[72:75], v[108:111], v[212:215]
    ds_read_b128 v[188:191], v229 offset:3616
    v_mfma_f32_16x16x32_f16 v[216:219], v[72:75], v[112:115], v[216:219]
    ds_read_b64 v[132:133], v228 offset:3072
    v_mfma_f32_16x16x32_f16 v[220:223], v[72:75], v[116:119], v[220:223]
    ds_read_b64 v[134:135], v228 offset:3080
    v_mfma_f32_16x16x32_f16 v[200:203], v[64:67], v[104:107], v[200:203]
    ds_read_b64 v[136:137], v228 offset:2560
    v_mfma_f32_16x16x32_f16 v[204:207], v[68:71], v[104:107], v[204:207]
    ds_read_b64 v[138:139], v228 offset:2568
    v_mfma_f32_16x16x32_f16 v[216:219], v[76:79], v[108:111], v[216:219]
    ds_read_b64 v[140:141], v228 offset:2048
    v_mfma_f32_16x16x32_f16 v[220:223], v[76:79], v[112:115], v[220:223]
    ds_read_b64 v[142:143], v228 offset:2056
    v_mfma_f32_16x16x32_f16 v[208:211], v[72:75], v[104:107], v[208:211]
    ds_read_b64 v[144:145], v228 offset:1536
    v_mfma_f32_16x16x32_f16 v[212:215], v[76:79], v[104:107], v[212:215]
    ds_read_b64 v[146:147], v228 offset:1544
    v_mfma_f32_16x16x32_f16 v[216:219], v[80:83], v[104:107], v[216:219]
    ds_read_b64 v[148:149], v228 offset:1024
    v_mfma_f32_16x16x32_f16 v[220:223], v[80:83], v[108:111], v[220:223]
    ds_read_b64 v[150:151], v228 offset:1032
    v_mfma_f32_16x16x32_f16 v[196:199], v[64:67], v[100:103], v[196:199]
    ds_read_b64 v[152:153], v228 offset:512
    v_mfma_f32_16x16x32_f16 v[200:203], v[68:71], v[100:103], v[200:203]
    ds_read_b64 v[154:155], v228 offset:520
    v_mfma_f32_16x16x32_f16 v[204:207], v[72:75], v[100:103], v[204:207]
    ds_read_b64 v[156:157], v228 offset:0
    v_mfma_f32_16x16x32_f16 v[220:223], v[84:87], v[104:107], v[220:223]
    ds_read_b64 v[158:159], v228 offset:8
    v_mfma_f32_16x16x32_f16 v[208:211], v[76:79], v[100:103], v[208:211]
    v_mfma_f32_16x16x32_f16 v[212:215], v[80:83], v[100:103], v[212:215]
    v_mfma_f32_16x16x32_f16 v[216:219], v[84:87], v[100:103], v[216:219]
    v_mfma_f32_16x16x32_f16 v[220:223], v[88:91], v[100:103], v[220:223]
    v_mfma_f32_16x16x32_f16 v[192:195], v[64:67], v[96:99], v[192:195]
    v_mfma_f32_16x16x32_f16 v[196:199], v[68:71], v[96:99], v[196:199]
    v_mfma_f32_16x16x32_f16 v[200:203], v[72:75], v[96:99], v[200:203]
    v_mfma_f32_16x16x32_f16 v[204:207], v[76:79], v[96:99], v[204:207]
    v_mfma_f32_16x16x32_f16 v[208:211], v[80:83], v[96:99], v[208:211]
    v_mfma_f32_16x16x32_f16 v[212:215], v[84:87], v[96:99], v[212:215]
    v_mfma_f32_16x16x32_f16 v[216:219], v[88:91], v[96:99], v[216:219]
    v_mfma_f32_16x16x32_f16 v[220:223], v[92:95], v[96:99], v[220:223]
    s_waitcnt lgkmcnt(0)
    v_mfma_f32_16x16x32_f16 v[208:211], v[128:131], v[176:179], v[208:211]
    v_mfma_f32_16x16x32_f16 v[212:215], v[128:131], v[180:183], v[212:215]
    v_mfma_f32_16x16x32_f16 v[216:219], v[128:131], v[184:187], v[216:219]
    v_mfma_f32_16x16x32_f16 v[220:223], v[128:131], v[188:191], v[220:223]
    v_mfma_f32_16x16x32_f16 v[204:207], v[128:131], v[172:175], v[204:207]
    v_mfma_f32_16x16x32_f16 v[212:215], v[132:135], v[176:179], v[212:215]
    v_mfma_f32_16x16x32_f16 v[216:219], v[132:135], v[180:183], v[216:219]
    v_mfma_f32_16x16x32_f16 v[220:223], v[132:135], v[184:187], v[220:223]
    v_mfma_f32_16x16x32_f16 v[208:211], v[132:135], v[172:175], v[208:211]
    v_mfma_f32_16x16x32_f16 v[212:215], v[136:139], v[172:175], v[212:215]
    v_mfma_f32_16x16x32_f16 v[216:219], v[136:139], v[176:179], v[216:219]
    v_mfma_f32_16x16x32_f16 v[220:223], v[136:139], v[180:183], v[220:223]
    v_mfma_f32_16x16x32_f16 v[200:203], v[128:131], v[168:171], v[200:203]
    v_mfma_f32_16x16x32_f16 v[204:207], v[132:135], v[168:171], v[204:207]
    v_mfma_f32_16x16x32_f16 v[216:219], v[140:143], v[172:175], v[216:219]
    v_mfma_f32_16x16x32_f16 v[220:223], v[140:143], v[176:179], v[220:223]
    v_mfma_f32_16x16x32_f16 v[208:211], v[136:139], v[168:171], v[208:211]
    v_mfma_f32_16x16x32_f16 v[212:215], v[140:143], v[168:171], v[212:215]
    v_mfma_f32_16x16x32_f16 v[216:219], v[144:147], v[168:171], v[216:219]
    v_mfma_f32_16x16x32_f16 v[220:223], v[144:147], v[172:175], v[220:223]
    v_mfma_f32_16x16x32_f16 v[196:199], v[128:131], v[164:167], v[196:199]
    v_mfma_f32_16x16x32_f16 v[200:203], v[132:135], v[164:167], v[200:203]
    v_mfma_f32_16x16x32_f16 v[204:207], v[136:139], v[164:167], v[204:207]
    v_mfma_f32_16x16x32_f16 v[220:223], v[148:151], v[168:171], v[220:223]
    v_mfma_f32_16x16x32_f16 v[208:211], v[140:143], v[164:167], v[208:211]
    v_mfma_f32_16x16x32_f16 v[212:215], v[144:147], v[164:167], v[212:215]
    v_mfma_f32_16x16x32_f16 v[216:219], v[148:151], v[164:167], v[216:219]
    v_mfma_f32_16x16x32_f16 v[220:223], v[152:155], v[164:167], v[220:223]
    v_mfma_f32_16x16x32_f16 v[192:195], v[128:131], v[160:163], v[192:195]
    v_mfma_f32_16x16x32_f16 v[196:199], v[132:135], v[160:163], v[196:199]
    v_mfma_f32_16x16x32_f16 v[200:203], v[136:139], v[160:163], v[200:203]
    v_mfma_f32_16x16x32_f16 v[204:207], v[140:143], v[160:163], v[204:207]
    v_mfma_f32_16x16x32_f16 v[208:211], v[144:147], v[160:163], v[208:211]
    v_mfma_f32_16x16x32_f16 v[212:215], v[148:151], v[160:163], v[212:215]
    v_mfma_f32_16x16x32_f16 v[216:219], v[152:155], v[160:163], v[216:219]
    v_mfma_f32_16x16x32_f16 v[220:223], v[156:159], v[160:163], v[220:223]
    v_mov_b32 v234, v233
    v_pk_mul_f32 v[192:193], v[192:193], v[234:235] op_sel_hi:[1,0]
    v_pk_mul_f32 v[194:195], v[194:195], v[234:235] op_sel_hi:[1,0]
    v_cvt_pk_bf16_f32 v192, v192, v193
    v_cvt_pk_bf16_f32 v193, v194, v195
    ds_write_b64 v230, v[192:193] offset:0
    v_pk_mul_f32 v[196:197], v[196:197], v[234:235] op_sel_hi:[1,0]
    v_pk_mul_f32 v[198:199], v[198:199], v[234:235] op_sel_hi:[1,0]
    v_cvt_pk_bf16_f32 v196, v196, v197
    v_cvt_pk_bf16_f32 v197, v198, v199
    ds_write_b64 v230, v[196:197] offset:512
    v_pk_mul_f32 v[200:201], v[200:201], v[234:235] op_sel_hi:[1,0]
    v_pk_mul_f32 v[202:203], v[202:203], v[234:235] op_sel_hi:[1,0]
    v_cvt_pk_bf16_f32 v200, v200, v201
    v_cvt_pk_bf16_f32 v201, v202, v203
    ds_write_b64 v230, v[200:201] offset:1024
    v_pk_mul_f32 v[204:205], v[204:205], v[234:235] op_sel_hi:[1,0]
    v_pk_mul_f32 v[206:207], v[206:207], v[234:235] op_sel_hi:[1,0]
    v_cvt_pk_bf16_f32 v204, v204, v205
    v_cvt_pk_bf16_f32 v205, v206, v207
    ds_write_b64 v230, v[204:205] offset:1536
    v_pk_mul_f32 v[208:209], v[208:209], v[234:235] op_sel_hi:[1,0]
    v_pk_mul_f32 v[210:211], v[210:211], v[234:235] op_sel_hi:[1,0]
    v_cvt_pk_bf16_f32 v208, v208, v209
    v_cvt_pk_bf16_f32 v209, v210, v211
    ds_write_b64 v230, v[208:209] offset:2048
    v_pk_mul_f32 v[212:213], v[212:213], v[234:235] op_sel_hi:[1,0]
    v_pk_mul_f32 v[214:215], v[214:215], v[234:235] op_sel_hi:[1,0]
    v_cvt_pk_bf16_f32 v212, v212, v213
    v_cvt_pk_bf16_f32 v213, v214, v215
    ds_write_b64 v230, v[212:213] offset:2560
    v_pk_mul_f32 v[216:217], v[216:217], v[234:235] op_sel_hi:[1,0]
    v_pk_mul_f32 v[218:219], v[218:219], v[234:235] op_sel_hi:[1,0]
    v_cvt_pk_bf16_f32 v216, v216, v217
    v_cvt_pk_bf16_f32 v217, v218, v219
    ds_write_b64 v230, v[216:217] offset:3072
    v_pk_mul_f32 v[220:221], v[220:221], v[234:235] op_sel_hi:[1,0]
    v_pk_mul_f32 v[222:223], v[222:223], v[234:235] op_sel_hi:[1,0]
    v_cvt_pk_bf16_f32 v220, v220, v221
    v_cvt_pk_bf16_f32 v221, v222, v223
    ds_write_b64 v230, v[220:221] offset:3584
    s_cmp_lg_u32 s3, 0
    s_cbranch_scc1 NOF
    s_cmp_ge_u32 s2, 112
    s_cbranch_scc1 NOF
    s_lshl_b32 s20, s2, 4
    s_add_u32 s20, s20, 20480
    v_mov_b32 v64, s20
    v_mov_b32 v65, 0
    s_mov_b64 exec, 1
    global_store_dword v64, v65, s[68:69] sc1
    s_mov_b64 exec, -1
NOF:
    s_branch CONV_JOIN
CONV_B:
    s_setprio 3
    v_mov_b32 v60, -1
    v_mov_b32 v61, -1
    v_mov_b32 v62, -1
    v_mov_b32 v63, -1
    v_and_b32 v52, 255, v0
    s_lshl_b32 s20, s6, 14
    s_add_u32 s20, s20, 10485760
    v_lshl_add_u32 v112, v52, 4, s20
    v_add_u32 v113, 8192, v112
    s_waitcnt lgkmcnt(0)
    v_add_u32 v114, 4096, v112
    v_add_u32 v115, 4096, v113
    s_cmp_lg_u32 s3, 4
    s_cbranch_scc1 CB_G
    s_cmp_ge_u32 s2, 5
    s_cbranch_scc1 CB_X
    s_lshl_b32 s20, s2, 14
    s_add_u32 s20, s20, 4096
    v_add_u32 v57, s20, v7
    v_add_u32 v56, 8192, v57
    global_store_dwordx4 v57, v[60:63], s[68:69] offset:-4096 sc1
    global_store_dwordx4 v57, v[60:63], s[68:69] offset:-3072 sc1
    global_store_dwordx4 v57, v[60:63], s[68:69] offset:-2048 sc1
    global_store_dwordx4 v57, v[60:63], s[68:69] offset:-1024 sc1
    global_store_dwordx4 v57, v[60:63], s[68:69] sc1
    global_store_dwordx4 v57, v[60:63], s[68:69] offset:1024 sc1
    global_store_dwordx4 v57, v[60:63], s[68:69] offset:2048 sc1
    global_store_dwordx4 v57, v[60:63], s[68:69] offset:3072 sc1
    global_store_dwordx4 v56, v[60:63], s[68:69] offset:-4096 sc1
    global_store_dwordx4 v56, v[60:63], s[68:69] offset:-3072 sc1
    global_store_dwordx4 v56, v[60:63], s[68:69] offset:-2048 sc1
    global_store_dwordx4 v56, v[60:63], s[68:69] offset:-1024 sc1
    global_store_dwordx4 v56, v[60:63], s[68:69] sc1
    global_store_dwordx4 v56, v[60:63], s[68:69] offset:1024 sc1
    global_store_dwordx4 v56, v[60:63], s[68:69] offset:2048 sc1
    global_store_dwordx4 v56, v[60:63], s[68:69] offset:3072 sc1
CB_G:
CB_X:
    s_lshl_b32 s20, s2, 2
    s_add_u32 s20, s20, s9
    s_mul_i32 s20, s20, 2304
    v_add_u32 v58, s20, v7
    v_add_u32 v59, s20, v13
    global_load_dwordx4 v[64:67], v58, s[36:37] nt
    global_load_ushort v68, v59, s[36:37] nt
    global_load_dwordx4 v[70:73], v58, s[36:37] offset:1152 nt
    global_load_ushort v74, v59, s[36:37] offset:1152 nt
    s_cmp_lg_u32 s3, 7
    s_cbranch_scc1 CB_Y
    s_mul_i32 s20, s2, 9216
    s_add_u32 s20, s20, 1052672
    v_add_u32 v57, s20, v7
    v_add_u32 v56, 4096, v57
    global_store_dwordx4 v57, v[60:63], s[68:69] offset:-4096 sc1
    global_store_dwordx4 v57, v[60:63], s[68:69] offset:-3072 sc1
    global_store_dwordx4 v57, v[60:63], s[68:69] offset:-2048 sc1
    global_store_dwordx4 v57, v[60:63], s[68:69] offset:-1024 sc1
    global_store_dwordx4 v57, v[60:63], s[68:69] sc1
    global_store_dwordx4 v57, v[60:63], s[68:69] offset:1024 sc1
    global_store_dwordx4 v57, v[60:63], s[68:69] offset:2048 sc1
    global_store_dwordx4 v57, v[60:63], s[68:69] offset:3072 sc1
    global_store_dwordx4 v56, v[60:63], s[68:69] sc1
CB_Y:
    v_mov_b32 v54, 0
    v_mov_b32 v55, 0
    s_mul_i32 s20, s9, 4640
    s_add_u32 s20, s20, 124928
    v_lshl_add_u32 v53, v1, 3, s20
    ds_write_b64 v53, v[54:55]
    s_waitcnt lgkmcnt(0)
    s_barrier
    s_load_dword s99, s[68:69], 94208
    v_and_b32 v52, 255, v0
    s_cmp_eq_u32 s3, 7
    s_cbranch_scc1 NOIF3
    s_cmp_lg_u32 s3, 4
    s_cbranch_scc1 NOIF
    s_cmp_ge_u32 s2, 5
    s_cbranch_scc1 NOIF
    s_lshl_b32 s20, s2, 2
    v_mov_b32 v54, s20
    s_mov_b64 exec, 1
    s_waitcnt vmcnt(4)
    global_store_dword v54, v60, s[66:67] sc1
    s_mov_b64 exec, -1
    s_waitcnt vmcnt(1)
    s_branch NOIF2
NOIF:
    s_waitcnt vmcnt(0)
NOIF3:
    s_waitcnt vmcnt(9)
NOIF2:
    s_mul_i32 s18, s9, 2304
    s_add_u32 s18, s18, 145024
    v_add_u32 v58, s18, v7
    v_add_u32 v59, s18, v13
    ds_write_b128 v58, v[64:67]
    ds_write_b16 v59, v68
    ds_write_b128 v58, v[70:73] offset:1152
    ds_write_b16 v59, v74 offset:1152
    v_lshlrev_b32 v80, 16, v64
    v_and_b32 v81, s12, v64
    v_lshlrev_b32 v82, 16, v65
    v_and_b32 v83, s12, v65
    v_lshlrev_b32 v84, 16, v66
    v_and_b32 v85, s12, v66
    v_lshlrev_b32 v86, 16, v67
    v_and_b32 v87, s12, v67
    v_lshlrev_b32 v88, 16, v68
    v_lshlrev_b32 v90, 16, v70
    v_and_b32 v91, s12, v70
    v_lshlrev_b32 v92, 16, v71
    v_and_b32 v93, s12, v71
    v_lshlrev_b32 v94, 16, v72
    v_and_b32 v95, s12, v72
    v_lshlrev_b32 v96, 16, v73
    v_and_b32 v97, s12, v73
    v_lshlrev_b32 v98, 16, v74
    v_readfirstlane_b32 s70, v80
    s_nop 1
    v_subrev_f32 v80, s70, v80
    v_subrev_f32 v81, s70, v81
    v_subrev_f32 v82, s70, v82
    v_subrev_f32 v83, s70, v83
    v_subrev_f32 v84, s70, v84
    v_subrev_f32 v85, s70, v85
    v_subrev_f32 v86, s70, v86
    v_subrev_f32 v87, s70, v87
    v_subrev_f32 v88, s70, v88
    v_pk_add_f32 v[100:101], v[80:81], v[82:83]
    v_pk_mul_f32 v[102:103], v[80:81], v[80:81]
    v_pk_add_f32 v[100:101], v[100:101], v[84:85]
    v_pk_fma_f32 v[102:103], v[82:83], v[82:83], v[102:103]
    v_pk_add_f32 v[100:101], v[100:101], v[86:87]
    v_pk_fma_f32 v[102:103], v[84:85], v[84:85], v[102:103]
    v_add_f32 v100, v100, v88
    v_pk_fma_f32 v[102:103], v[86:87], v[86:87], v[102:103]
    v_add_f32 v100, v100, v101
    v_fmac_f32 v102, v88, v88
    v_add_f32 v102, v102, v103
    v_readfirstlane_b32 s71, v90
    s_nop 1
    v_subrev_f32 v90, s71, v90
    v_subrev_f32 v91, s71, v91
    v_subrev_f32 v92, s71, v92
    v_subrev_f32 v93, s71, v93
    v_subrev_f32 v94, s71, v94
    v_subrev_f32 v95, s71, v95
    v_subrev_f32 v96, s71, v96
    v_subrev_f32 v97, s71, v97
    v_subrev_f32 v98, s71, v98
    v_pk_add_f32 v[104:105], v[90:91], v[92:93]
    v_pk_mul_f32 v[106:107], v[90:91], v[90:91]
    v_pk_add_f32 v[104:105], v[104:105], v[94:95]
    v_pk_fma_f32 v[106:107], v[92:93], v[92:93], v[106:107]
    v_pk_add_f32 v[104:105], v[104:105], v[96:97]
    v_pk_fma_f32 v[106:107], v[94:95], v[94:95], v[106:107]
    v_add_f32 v104, v104, v98
    v_pk_fma_f32 v[106:107], v[96:97], v[96:97], v[106:107]
    v_add_f32 v104, v104, v105
    v_fmac_f32 v106, v98, v98
    v_add_f32 v106, v106, v107
    v_permlane32_swap_b32 v100, v104
    s_nop 0
    v_permlane32_swap_b32 v102, v106
    v_add_f32 v100, v100, v104
    v_add_f32 v102, v102, v106
    s_nop 1
    v_permlane16_swap_b32 v100, v102
    v_add_f32 v100, v100, v102
    s_nop 1
    v_add_f32_dpp v100, v100, v100 row_ror:8 row_mask:0xf bank_mask:0xf
    s_nop 1
    v_add_f32_dpp v100, v100, v100 row_ror:4 row_mask:0xf bank_mask:0xf
    s_nop 1
    v_add_f32_dpp v100, v100, v100 row_ror:2 row_mask:0xf bank_mask:0xf
    s_nop 1
    v_add_f32_dpp v100, v100, v100 row_ror:1 row_mask:0xf bank_mask:0xf
    v_mov_b32 v102, v100
    s_nop 1
    v_permlane16_swap_b32 v100, v102
    v_mov_b32 v104, s70
    v_mov_b32 v105, s71
    v_cmp_gt_u32 vcc, 32, v1
    s_nop 1
    v_cndmask_b32 v104, v105, v104, vcc
    v_mul_f32 v100, 0x3ae38e39, v100
    v_mul_f32 v102, 0x3ae38e39, v102
    v_add_f32 v105, v104, v100
    v_fma_f32 v107, -v100, v100, v102
    v_max_f32 v107, 0, v107
    v_cvt_pk_bf16_f32 v107, v107, v107
    v_and_b32 v107, s12, v107
    v_add_f32 v107, 0x3727c5ac, v107
    v_cvt_pk_bf16_f32 v107, v107, v107
    v_and_b32 v107, s12, v107
    v_sqrt_f32 v106, v107
    v_cvt_pk_bf16_f32 v105, v105, v105
    v_and_b32 v105, s12, v105
    v_cvt_pk_bf16_f32 v106, v106, v106
    v_and_b32 v106, s12, v106
    v_rcp_f32 v100, v106
    v_sub_f32 v101, v104, v105
    v_mul_f32 v101, v101, v100
    v_mov_b32 v102, v100
    v_mov_b32 v103, v101
    s_nop 0
    v_permlane32_swap_b32 v100, v102
    v_permlane32_swap_b32 v101, v103
    s_mul_i32 s18, s9, 2304
    s_add_u32 s18, s18, 154240
    v_lshl_add_u32 v58, v1, 5, s18
    v_lshl_add_u32 v59, v1, 2, s18
    v_pk_fma_f32 v[80:81], v[80:81], v[100:101], v[100:101] op_sel:[0,0,1] op_sel_hi:[1,0,1]
    v_pk_fma_f32 v[82:83], v[82:83], v[100:101], v[100:101] op_sel:[0,0,1] op_sel_hi:[1,0,1]
    v_pk_fma_f32 v[84:85], v[84:85], v[100:101], v[100:101] op_sel:[0,0,1] op_sel_hi:[1,0,1]
    v_pk_fma_f32 v[86:87], v[86:87], v[100:101], v[100:101] op_sel:[0,0,1] op_sel_hi:[1,0,1]
    v_fma_f32 v88, v88, v100, v101
    v_pk_fma_f32 v[90:91], v[90:91], v[102:103], v[102:103] op_sel:[0,0,1] op_sel_hi:[1,0,1]
    v_pk_fma_f32 v[92:93], v[92:93], v[102:103], v[102:103] op_sel:[0,0,1] op_sel_hi:[1,0,1]
    v_pk_fma_f32 v[94:95], v[94:95], v[102:103], v[102:103] op_sel:[0,0,1] op_sel_hi:[1,0,1]
    v_pk_fma_f32 v[96:97], v[96:97], v[102:103], v[102:103] op_sel:[0,0,1] op_sel_hi:[1,0,1]
    v_fma_f32 v98, v98, v102, v103
    v_cvt_pkrtz_f16_f32 v64, v80, v90
    v_cvt_pkrtz_f16_f32 v65, v81, v91
    v_cvt_pkrtz_f16_f32 v66, v82, v92
    v_cvt_pkrtz_f16_f32 v67, v83, v93
    v_cvt_pkrtz_f16_f32 v68, v84, v94
    v_cvt_pkrtz_f16_f32 v69, v85, v95
    v_cvt_pkrtz_f16_f32 v70, v86, v96
    v_cvt_pkrtz_f16_f32 v71, v87, v97
    v_cvt_pkrtz_f16_f32 v72, v88, v98
    v_add_u32 v64, 0x00040004, v64
    v_add_u32 v65, 0x00040004, v65
    v_add_u32 v66, 0x00040004, v66
    v_add_u32 v67, 0x00040004, v67
    v_add_u32 v68, 0x00040004, v68
    v_add_u32 v69, 0x00040004, v69
    v_add_u32 v70, 0x00040004, v70
    v_add_u32 v71, 0x00040004, v71
    v_add_u32 v72, 0x00040004, v72
    ds_write_b128 v58, v[64:67]
    ds_write_b128 v58, v[68:71] offset:16
    ds_write_b32 v59, v72 offset:2048
    s_lshl_b32 s14, s9, 2
    s_add_u32 s14, s14, 143584
    v_mov_b32 v58, s14
    v_mov_b32 v59, 0
    v_and_b32 v104, 3, v1
    v_lshlrev_b32 v100, 4, v104
    v_lshlrev_b32 v104, 2, v104
    v_add_u32 v104, 143584, v104
    v_and_b32 v52, 255, v0
    v_lshrrev_b32 v101, 2, v52
    v_lshl_add_u32 v101, v101, 14, v100
    s_lshl_b32 s14, s2, 6
    s_add_u32 s14, s14, 10485760
    v_add_u32 v101, s14, v101
    v_add_u32 v102, 1048576, v101
    v_and_b32 v103, 15, v1
    v_lshl_add_u32 v103, s9, 4, v103
    v_lshrrev_b32 v99, 2, v103
    v_lshl_add_u32 v99, v99, 14, v100
    v_add_u32 v99, s14, v99
    v_add_u32 v99, 2097152, v99
    v_lshlrev_b32 v103, 2, v103
    v_add_u32 v103, 156288, v103
    v_lshlrev_b32 v100, 2, v52
    v_add_u32 v100, 154240, v100
IFD_4:
    ds_write_b32 v58, v59
    s_waitcnt lgkmcnt(0)
    s_add_u32 s99, s99, 1
    s_mov_b32 s98, 458759
    s_lshr_b32 s20, s99, 0
    s_and_b32 s20, s20, s98
    v_mov_b32 v108, s20
    s_lshr_b32 s20, s99, 3
    s_and_b32 s20, s20, s98
    v_mov_b32 v109, s20
    s_lshr_b32 s20, s99, 6
    s_and_b32 s20, s20, s98
    v_mov_b32 v110, s20
    s_lshr_b32 s20, s99, 9
    s_and_b32 s20, s20, s98
    v_mov_b32 v111, s20
SL_1:
    ds_read_b32 v105, v104
    s_waitcnt lgkmcnt(0)
    v_cmp_eq_u32 vcc, -1, v105
    s_cbranch_vccz SLD_2
    s_sub_u32 s10, s10, 1
    s_cbranch_scc1 EXIT
    s_branch SL_1
SLD_2:
    ds_read_b32 v80, v100 offset:0
    ds_read_b32 v81, v100 offset:2304
    ds_read_b32 v82, v100 offset:4608
    ds_read_b32 v83, v100 offset:6912
    ds_read_b32 v84, v100 offset:1024
    ds_read_b32 v85, v100 offset:3328
    ds_read_b32 v86, v100 offset:5632
    ds_read_b32 v87, v100 offset:7936
    ds_read_b32 v88, v103 offset:0
    ds_read_b32 v89, v103 offset:2304
    ds_read_b32 v90, v103 offset:4608
    ds_read_b32 v91, v103 offset:6912
    s_waitcnt lgkmcnt(8)
    v_bfi_b32 v80, s98, v108, v80
    v_bfi_b32 v81, s98, v109, v81
    v_bfi_b32 v82, s98, v110, v82
    v_bfi_b32 v83, s98, v111, v83
    global_store_dwordx4 v101, v[80:83], s[68:69] sc1
    s_waitcnt lgkmcnt(4)
    v_bfi_b32 v84, s98, v108, v84
    v_bfi_b32 v85, s98, v109, v85
    v_bfi_b32 v86, s98, v110, v86
    v_bfi_b32 v87, s98, v111, v87
    global_store_dwordx4 v102, v[84:87], s[68:69] sc1
    s_waitcnt lgkmcnt(0)
    v_bfi_b32 v88, s98, v108, v88
    v_bfi_b32 v89, s98, v109, v89
    v_bfi_b32 v90, s98, v110, v90
    v_bfi_b32 v91, s98, v111, v91
    s_mov_b64 exec, 0xffff
    global_store_dwordx4 v99, v[88:91], s[68:69] sc1
    s_mov_b64 exec, -1
    s_cmp_lg_u32 s3, 7
    s_cbranch_scc1 GIF_5
    s_lshl_b32 s20, s2, 4
    s_add_u32 s20, s20, 90112
    v_mov_b32 v92, s20
    v_mov_b32 v76, s99
    v_mov_b32 v77, s99
    v_mov_b32 v78, s99
    v_mov_b32 v79, s99
    s_mov_b64 exec, 1
    s_waitcnt vmcnt(3)
    global_store_dwordx4 v92, v[76:79], s[68:69] sc1
    s_mov_b64 exec, -1
GIF_5:
    s_setprio 0
    v_and_b32 v52, 7, v1
    v_lshlrev_b32 v52, 3, v52
    v_lshrrev_b32 v53, 4, v1
    s_mul_i32 s20, s9, 294912
    s_lshl_b32 s21, s8, 6
    s_add_u32 s20, s20, s21
    s_add_u32 s20, s20, 0
    s_mov_b32 s21, 73728
    v_mad_u32_u24 v52, v53, s21, v52
    v_add_u32 v52, s20, v52
    v_and_b32 v54, 8, v1
    v_cmp_eq_u32 vcc, 0, v54
    v_mov_b32 v54, s56
    v_mov_b32 v55, s54
    v_cndmask_b32 v54, v54, v55, vcc
    v_mov_b32 v55, s57
    v_mov_b32 v56, s55
    v_cndmask_b32 v55, v55, v56, vcc
    v_add_co_u32 v54, vcc, v54, v52
    s_nop 1
    v_addc_co_u32 v55, vcc, 0, v55, vcc
    s_mov_b32 s20, 9216
    s_mov_b32 s21, 0
    s_mov_b32 s22, 1115136
    s_mov_b32 s23, 0
    global_load_dwordx2 v[128:129], v[54:55], off nt
    v_lshl_add_u64 v[54:55], v[54:55], 0, s[20:21]
    global_load_dwordx2 v[130:131], v[54:55], off nt
    v_lshl_add_u64 v[54:55], v[54:55], 0, s[20:21]
    global_load_dwordx2 v[132:133], v[54:55], off nt
    v_lshl_add_u64 v[54:55], v[54:55], 0, s[20:21]
    global_load_dwordx2 v[134:135], v[54:55], off nt
    v_lshl_add_u64 v[54:55], v[54:55], 0, s[20:21]
    global_load_dwordx2 v[136:137], v[54:55], off nt
    v_lshl_add_u64 v[54:55], v[54:55], 0, s[20:21]
    global_load_dwordx2 v[138:139], v[54:55], off nt
    v_lshl_add_u64 v[54:55], v[54:55], 0, s[20:21]
    global_load_dwordx2 v[140:141], v[54:55], off nt
    v_lshl_add_u64 v[54:55], v[54:55], 0, s[20:21]
    global_load_dwordx2 v[142:143], v[54:55], off nt
W5_6:
    v_and_b32 v52, 255, v0
    v_and_b32 v54, 3, v1
    s_movk_i32 s18, 4640
    v_mul_u32_u24 v55, s18, v54
    v_lshrrev_b32 v53, 2, v52
    v_lshl_add_u32 v55, v53, 4, v55
    v_add_u32 v55, 125440, v55
    s_lshl_b32 s18, s6, 4
    s_add_u32 s18, s18, 81920
    v_lshl_add_u32 v54, v54, 2, s18
    s_waitcnt vmcnt(0) lgkmcnt(0)
    global_load_dwordx4 v[64:67], v112, s[68:69] sc1
    global_load_dwordx4 v[68:71], v114, s[68:69] sc1
    global_load_dwordx4 v[72:75], v113, s[68:69] sc1
    global_load_dwordx4 v[76:79], v115, s[68:69] sc1
    global_load_dword v56, v54, s[68:69] sc1
    global_load_dword v57, v54, s[68:69] offset:2304 sc1
    s_waitcnt vmcnt(2)
NP:
    v_xor_b32 v176, v64, v108
    v_xor_b32 v177, v65, v109
    v_xor_b32 v178, v66, v110
    v_xor_b32 v179, v67, v111
    v_xor_b32 v180, v68, v108
    v_xor_b32 v181, v69, v109
    v_xor_b32 v182, v70, v110
    v_xor_b32 v183, v71, v111
    v_xor_b32 v184, v72, v108
    v_xor_b32 v185, v73, v109
    v_xor_b32 v186, v74, v110
    v_xor_b32 v187, v75, v111
    v_xor_b32 v188, v76, v108
    v_xor_b32 v189, v77, v109
    v_xor_b32 v190, v78, v110
    v_xor_b32 v191, v79, v111
    v_or3_b32 v80, v176, v177, v178
    v_or3_b32 v81, v179, v180, v181
    v_or3_b32 v82, v182, v183, v184
    v_or3_b32 v83, v185, v186, v187
    v_or3_b32 v84, v188, v189, v190
    v_or3_b32 v80, v80, v81, v82
    v_or3_b32 v83, v83, v84, v191
    v_or_b32 v80, v80, v83
    v_and_b32 v80, s98, v80
    s_nop 1
    v_or_b32_dpp v80, v80, v80 quad_perm:[1,0,3,2] row_mask:0xf bank_mask:0xf
    s_nop 1
    v_or_b32_dpp v80, v80, v80 quad_perm:[2,3,0,1] row_mask:0xf bank_mask:0xf
    v_cmp_ne_u32 vcc, 0, v80
    s_cbranch_vccz NPD
    s_mov_b64 exec, vcc
    global_load_dwordx4 v[64:67], v112, s[68:69] sc1
    global_load_dwordx4 v[68:71], v114, s[68:69] sc1
    global_load_dwordx4 v[72:75], v113, s[68:69] sc1
    global_load_dwordx4 v[76:79], v115, s[68:69] sc1
    s_mov_b64 exec, -1
    s_waitcnt vmcnt(0)
    s_sub_u32 s10, s10, 1
    s_cbranch_scc1 EXIT
    s_branch NP
NPD:
    s_waitcnt vmcnt(0)
MDP:
    v_xor_b32 v58, s99, v56
    v_xor_b32 v59, s99, v57
    v_or_b32 v58, v58, v59
    v_lshlrev_b32 v58, 16, v58
    v_cmp_ne_u32 vcc, 0, v58
    s_cbranch_vccz MDPD
    global_load_dword v56, v54, s[68:69] sc1
    global_load_dword v57, v54, s[68:69] offset:2304 sc1
    s_waitcnt vmcnt(0)
    s_sub_u32 s10, s10, 1
    s_cbranch_scc1 EXIT
    s_branch MDP
MDPD:
    v_and_b32 v58, s12, v57
    v_and_b32 v59, s12, v56
    v_add_f32 v58, 1.0, v58
    v_cvt_pk_bf16_f32 v58, v58, v58
    v_and_b32 v58, s12, v58
    v_cvt_pk_f16_f32 v58, v58, v59
    v_pk_fma_f16 v64, v176, v58, v58 op_sel:[0,0,1] op_sel_hi:[1,0,1]
    v_pk_fma_f16 v65, v177, v58, v58 op_sel:[0,0,1] op_sel_hi:[1,0,1]
    v_pk_fma_f16 v66, v178, v58, v58 op_sel:[0,0,1] op_sel_hi:[1,0,1]
    v_pk_fma_f16 v67, v179, v58, v58 op_sel:[0,0,1] op_sel_hi:[1,0,1]
    ds_write_b128 v55, v[64:67] offset:0
    v_pk_fma_f16 v68, v180, v58, v58 op_sel:[0,0,1] op_sel_hi:[1,0,1]
    v_pk_fma_f16 v69, v181, v58, v58 op_sel:[0,0,1] op_sel_hi:[1,0,1]
    v_pk_fma_f16 v70, v182, v58, v58 op_sel:[0,0,1] op_sel_hi:[1,0,1]
    v_pk_fma_f16 v71, v183, v58, v58 op_sel:[0,0,1] op_sel_hi:[1,0,1]
    ds_write_b128 v55, v[68:71] offset:1024
    v_pk_fma_f16 v72, v184, v58, v58 op_sel:[0,0,1] op_sel_hi:[1,0,1]
    v_pk_fma_f16 v73, v185, v58, v58 op_sel:[0,0,1] op_sel_hi:[1,0,1]
    v_pk_fma_f16 v74, v186, v58, v58 op_sel:[0,0,1] op_sel_hi:[1,0,1]
    v_pk_fma_f16 v75, v187, v58, v58 op_sel:[0,0,1] op_sel_hi:[1,0,1]
    ds_write_b128 v55, v[72:75] offset:2048
    v_pk_fma_f16 v76, v188, v58, v58 op_sel:[0,0,1] op_sel_hi:[1,0,1]
    v_pk_fma_f16 v77, v189, v58, v58 op_sel:[0,0,1] op_sel_hi:[1,0,1]
    v_pk_fma_f16 v78, v190, v58, v58 op_sel:[0,0,1] op_sel_hi:[1,0,1]
    v_pk_fma_f16 v79, v191, v58, v58 op_sel:[0,0,1] op_sel_hi:[1,0,1]
    ds_write_b128 v55, v[76:79] offset:3072
    s_waitcnt lgkmcnt(0)
    s_barrier
    s_load_dwordx8 s[28:35], s[66:67], 0
    global_load_dwordx4 v[8:11], v7, s[52:53]
    global_load_ushort v12, v13, s[52:53]
    v_mov_b32 v60, -1
    v_mov_b32 v61, -1
    v_mov_b32 v62, -1
    v_mul_u32_u24 v59, 12, v1
    v_mov_b32 v63, -1
    s_mul_i32 s20, s2, 3
    s_add_u32 s20, s20, s9
    s_mul_i32 s20, s20, 1152
    s_add_u32 s20, s20, 4193152
    v_add_u32 v57, s20, v7
    v_add_u32 v58, s20, v13
    s_cmp_eq_u32 s3, 4
    s_cbranch_scc1 LI1
    global_store_dwordx4 v57, v[60:63], s[68:69] sc1
    global_store_short v58, v60, s[68:69] sc1
LI1:
    s_mul_i32 s20, s6, 18432
    s_mul_i32 s21, s9, 4608
    s_add_u32 s20, s20, s21
    s_add_u32 s20, s20, 7342336
    v_add_u32 v58, s20, v59
    global_store_dwordx3 v58, v[60:62], s[68:69] offset:-2304 sc1
    global_store_dwordx3 v58, v[60:62], s[68:69] offset:-1536 sc1
    global_store_dwordx3 v58, v[60:62], s[68:69] offset:-768 sc1
    global_store_dwordx3 v58, v[60:62], s[68:69] sc1
    global_store_dwordx3 v58, v[60:62], s[68:69] offset:768 sc1
    global_store_dwordx3 v58, v[60:62], s[68:69] offset:1536 sc1
    s_waitcnt lgkmcnt(0)
    s_and_b64 s[28:29], s[28:29], s[30:31]
    s_and_b32 s28, s28, s32
    s_and_b32 s28, s28, s29
    s_cmp_lg_u32 s28, 0
    s_cbranch_scc1 GOK_7
    v_min_u32 v59, 4, v1
    v_lshlrev_b32 v59, 2, v59
    global_load_dword v58, v59, s[66:67] sc1
GO_8:
    s_waitcnt vmcnt(0)
    v_cmp_eq_u32 vcc, 0, v58
    s_cbranch_vccz GOD_9
    global_load_dword v58, v59, s[66:67] sc1
    s_sub_u32 s10, s10, 1
    s_cbranch_scc1 EXIT
    s_branch GO_8
GOD_9:
GOK_7:
    s_lshl_b32 s20, s9, 10
    s_add_u32 s20, s20, 90112
    v_add_u32 v80, s20, v7
    global_load_dwordx4 v[76:79], v80, s[68:69]
    v_and_b32 v52, 7, v1
    v_lshlrev_b32 v52, 3, v52
    v_lshrrev_b32 v53, 4, v1
    s_mul_i32 s20, s9, 294912
    s_lshl_b32 s21, s8, 6
    s_add_u32 s20, s20, s21
    s_add_u32 s20, s20, 1179648
    s_mov_b32 s21, 73728
    v_mad_u32_u24 v52, v53, s21, v52
    v_add_u32 v52, s20, v52
    v_and_b32 v54, 8, v1
    v_cmp_eq_u32 vcc, 0, v54
    v_mov_b32 v54, s56
    v_mov_b32 v55, s54
    v_cndmask_b32 v54, v54, v55, vcc
    v_mov_b32 v55, s57
    v_mov_b32 v56, s55
    v_cndmask_b32 v55, v55, v56, vcc
    v_add_co_u32 v54, vcc, v54, v52
    s_nop 1
    v_addc_co_u32 v55, vcc, 0, v55, vcc
    s_mov_b32 s20, 9216
    s_mov_b32 s21, 0
    s_mov_b32 s22, 1115136
    s_mov_b32 s23, 0
    global_load_dwordx2 v[144:145], v[54:55], off nt
    v_lshl_add_u64 v[54:55], v[54:55], 0, s[20:21]
    global_load_dwordx2 v[146:147], v[54:55], off nt
    v_lshl_add_u64 v[54:55], v[54:55], 0, s[20:21]
    global_load_dwordx2 v[148:149], v[54:55], off nt
    v_lshl_add_u64 v[54:55], v[54:55], 0, s[20:21]
    global_load_dwordx2 v[150:151], v[54:55], off nt
    v_lshl_add_u64 v[54:55], v[54:55], 0, s[20:21]
    global_load_dwordx2 v[152:153], v[54:55], off nt
    v_lshl_add_u64 v[54:55], v[54:55], 0, s[20:21]
    global_load_dwordx2 v[154:155], v[54:55], off nt
    v_lshl_add_u64 v[54:55], v[54:55], 0, s[20:21]
    global_load_dwordx2 v[156:157], v[54:55], off nt
    v_lshl_add_u64 v[54:55], v[54:55], 0, s[20:21]
    global_load_dwordx2 v[158:159], v[54:55], off nt
    v_lshl_add_u64 v[54:55], v[54:55], 0, s[22:23]
    global_load_dwordx2 v[160:161], v[54:55], off nt
    v_lshl_add_u64 v[54:55], v[54:55], 0, s[20:21]
    global_load_dwordx2 v[162:163], v[54:55], off nt
    v_lshl_add_u64 v[54:55], v[54:55], 0, s[20:21]
    global_load_dwordx2 v[164:165], v[54:55], off nt
    v_lshl_add_u64 v[54:55], v[54:55], 0, s[20:21]
    global_load_dwordx2 v[166:167], v[54:55], off nt
    v_lshl_add_u64 v[54:55], v[54:55], 0, s[20:21]
    global_load_dwordx2 v[168:169], v[54:55], off nt
    v_lshl_add_u64 v[54:55], v[54:55], 0, s[20:21]
    global_load_dwordx2 v[170:171], v[54:55], off nt
    v_lshl_add_u64 v[54:55], v[54:55], 0, s[20:21]
    global_load_dwordx2 v[172:173], v[54:55], off nt
    v_lshl_add_u64 v[54:55], v[54:55], 0, s[20:21]
    global_load_dwordx2 v[174:175], v[54:55], off nt
W5_10:
    s_waitcnt vmcnt(16)
GIP:
    v_cmp_ne_u32 vcc, s99, v76
    v_cmp_ne_u32 s[20:21], s99, v77
    v_cmp_ne_u32 s[22:23], s99, v78
    v_cmp_ne_u32 s[24:25], s99, v79
    s_or_b64 vcc, vcc, s[20:21]
    s_or_b64 s[22:23], s[22:23], s[24:25]
    s_or_b64 vcc, vcc, s[22:23]
    s_cbranch_vccz GIPD
    global_load_dwordx4 v[76:79], v80, s[68:69] sc1
    s_waitcnt vmcnt(0)
    s_sub_u32 s10, s10, 1
    s_cbranch_scc1 EXIT
    s_branch GIP
GIPD:
CONV_JOIN:
    v_and_b32 v56, 3, v0
    v_lshrrev_b32 v57, 2, v0
    s_mov_b32 s20, 31296
    v_mul_u32_u24 v58, s20, v56
    v_lshl_add_u32 v58, v57, 4, v58
    s_movk_i32 s20, 9216
    v_mul_u32_u24 v59, s20, v57
    v_lshl_add_u32 v59, v56, 4, v59
    s_lshl_b32 s20, s6, 6
    s_add_u32 s20, s20, 1048576
    v_add_u32 v59, s20, v59
    v_add_u32 v60, 1179648, v59
    s_waitcnt lgkmcnt(0)
    s_barrier
    ds_read_b128 v[64:67], v58
    ds_read_b128 v[68:71], v58 offset:2048
    s_waitcnt lgkmcnt(1)
    global_store_dwordx4 v59, v[64:67], s[68:69] sc1
    s_waitcnt lgkmcnt(0)
    global_store_dwordx4 v60, v[68:71], s[68:69] sc1
    v_add_u32 v52, 8192, v7
    v_add_u32 v53, 8192, v13
    v_add_u32 v54, 2304, v52
    v_add_u32 v55, 2304, v53
    global_load_dwordx4 v[106:109], v54, s[68:69]
    global_load_ushort v110, v55, s[68:69]
    v_add_u32 v54, 3456, v52
    v_add_u32 v55, 3456, v53
    global_load_dwordx4 v[20:23], v54, s[68:69]
    global_load_ushort v24, v55, s[68:69]
    v_add_u32 v54, 4608, v52
    v_add_u32 v55, 4608, v53
    global_load_dwordx4 v[14:17], v54, s[68:69]
    global_load_ushort v18, v55, s[68:69]
    v_add_u32 v54, 5760, v52
    v_add_u32 v55, 5760, v53
    global_load_dwordx4 v[26:29], v54, s[68:69]
    global_load_ushort v30, v55, s[68:69]
    s_waitcnt vmcnt(0)
MC_11:
    v_or_b32 v53, s12, v24
    v_or_b32 v54, s12, v18
    v_or_b32 v55, s12, v30
    v_or_b32 v56, s12, v110
    v_max3_u32 v52, v20, v21, v22
    v_max3_u32 v52, v52, v23, v14
    v_max3_u32 v52, v52, v15, v16
    v_max3_u32 v52, v52, v17, v26
    v_max3_u32 v52, v52, v27, v28
    v_max3_u32 v52, v52, v29, v106
    v_max3_u32 v52, v52, v107, v108
    v_max3_u32 v52, v52, v109, v53
    v_max3_u32 v52, v52, v54, v55
    v_max_u32 v52, v52, v56
    v_cmp_eq_u32 vcc, -1, v52
    s_cbranch_vccz MCD_12
    v_add_u32 v52, 8192, v7
    v_add_u32 v53, 8192, v13
    v_add_u32 v54, 2304, v52
    v_add_u32 v55, 2304, v53
    global_load_dwordx4 v[106:109], v54, s[68:69] sc1
    global_load_ushort v110, v55, s[68:69] sc1
    v_add_u32 v54, 3456, v52
    v_add_u32 v55, 3456, v53
    global_load_dwordx4 v[20:23], v54, s[68:69] sc1
    global_load_ushort v24, v55, s[68:69] sc1
    v_add_u32 v54, 4608, v52
    v_add_u32 v55, 4608, v53
    global_load_dwordx4 v[14:17], v54, s[68:69] sc1
    global_load_ushort v18, v55, s[68:69] sc1
    v_add_u32 v54, 5760, v52
    v_add_u32 v55, 5760, v53
    global_load_dwordx4 v[26:29], v54, s[68:69] sc1
    global_load_ushort v30, v55, s[68:69] sc1
    s_waitcnt vmcnt(0)
    s_sub_u32 s10, s10, 1
    s_cbranch_scc1 EXIT
    s_branch MC_11
MCD_12:
    v_lshlrev_b32 v32, 16, v14
    v_and_b32 v33, s12, v14
    v_lshlrev_b32 v34, 16, v15
    v_and_b32 v35, s12, v15
    v_lshlrev_b32 v36, 16, v16
    v_and_b32 v37, s12, v16
    v_lshlrev_b32 v38, 16, v17
    v_and_b32 v39, s12, v17
    v_lshlrev_b32 v40, 16, v18
    v_lshlrev_b32 v42, 16, v20
    v_and_b32 v43, s12, v20
    v_lshlrev_b32 v44, 16, v21
    v_and_b32 v45, s12, v21
    v_lshlrev_b32 v46, 16, v22
    v_and_b32 v47, s12, v22
    v_lshlrev_b32 v48, 16, v23
    v_and_b32 v49, s12, v23
    v_lshlrev_b32 v50, 16, v24
    v_pk_add_f32 v[32:33], v[32:33], 1.0 op_sel_hi:[1,0]
    v_pk_add_f32 v[34:35], v[34:35], 1.0 op_sel_hi:[1,0]
    v_pk_add_f32 v[36:37], v[36:37], 1.0 op_sel_hi:[1,0]
    v_pk_add_f32 v[38:39], v[38:39], 1.0 op_sel_hi:[1,0]
    v_add_f32 v40, 1.0, v40
    v_cvt_pk_bf16_f32 v52, v32, v33
    v_cvt_pk_bf16_f32 v53, v34, v35
    v_cvt_pk_bf16_f32 v54, v36, v37
    v_cvt_pk_bf16_f32 v55, v38, v39
    v_cvt_pk_bf16_f32 v56, v40, v40
    v_lshlrev_b32 v32, 16, v52
    v_and_b32 v33, s12, v52
    v_lshlrev_b32 v34, 16, v53
    v_and_b32 v35, s12, v53
    v_lshlrev_b32 v36, 16, v54
    v_and_b32 v37, s12, v54
    v_lshlrev_b32 v38, 16, v55
    v_and_b32 v39, s12, v55
    v_lshlrev_b32 v40, 16, v56
    s_branch GPOLL
NONCONV:
    s_cmp_lt_u32 s3, 4
    s_cbranch_scc1 NC_A0
    v_mov_b32 v60, -1
    v_mov_b32 v61, -1
    v_mov_b32 v62, -1
    v_mov_b32 v63, -1
    s_waitcnt lgkmcnt(0)
    s_lshl_b32 s20, s2, 2
    s_add_u32 s20, s20, s9
    s_mul_i32 s20, s20, 2304
    v_add_u32 v58, s20, v7
    v_add_u32 v59, s20, v13
    global_load_dwordx4 v[64:67], v58, s[36:37] nt
    global_load_ushort v68, v59, s[36:37] nt
    global_load_dwordx4 v[70:73], v58, s[36:37] offset:1152 nt
    global_load_ushort v74, v59, s[36:37] offset:1152 nt
    s_cmp_lg_u32 s3, 7
    s_cbranch_scc1 NC_B0
    s_mul_i32 s20, s2, 9216
    s_add_u32 s20, s20, 1052672
    v_add_u32 v57, s20, v7
    v_add_u32 v56, 4096, v57
    global_store_dwordx4 v57, v[60:63], s[68:69] offset:-4096 sc1
    global_store_dwordx4 v57, v[60:63], s[68:69] offset:-3072 sc1
    global_store_dwordx4 v57, v[60:63], s[68:69] offset:-2048 sc1
    global_store_dwordx4 v57, v[60:63], s[68:69] offset:-1024 sc1
    global_store_dwordx4 v57, v[60:63], s[68:69] sc1
    global_store_dwordx4 v57, v[60:63], s[68:69] offset:1024 sc1
    global_store_dwordx4 v57, v[60:63], s[68:69] offset:2048 sc1
    global_store_dwordx4 v57, v[60:63], s[68:69] offset:3072 sc1
    global_store_dwordx4 v56, v[60:63], s[68:69] sc1
NC_B0:
    s_barrier
    s_load_dword s99, s[68:69], 94208
    s_cmp_eq_u32 s3, 7
    s_cbranch_scc1 NC_B1
    s_waitcnt vmcnt(0)
NC_B1:
    s_waitcnt vmcnt(9)
    s_mul_i32 s18, s9, 2304
    s_add_u32 s18, s18, 145024
    v_add_u32 v58, s18, v7
    v_add_u32 v59, s18, v13
    ds_write_b128 v58, v[64:67]
    ds_write_b16 v59, v68
    ds_write_b128 v58, v[70:73] offset:1152
    ds_write_b16 v59, v74 offset:1152
    v_lshlrev_b32 v80, 16, v64
    v_and_b32 v81, s12, v64
    v_lshlrev_b32 v82, 16, v65
    v_and_b32 v83, s12, v65
    v_lshlrev_b32 v84, 16, v66
    v_and_b32 v85, s12, v66
    v_lshlrev_b32 v86, 16, v67
    v_and_b32 v87, s12, v67
    v_lshlrev_b32 v88, 16, v68
    v_lshlrev_b32 v90, 16, v70
    v_and_b32 v91, s12, v70
    v_lshlrev_b32 v92, 16, v71
    v_and_b32 v93, s12, v71
    v_lshlrev_b32 v94, 16, v72
    v_and_b32 v95, s12, v72
    v_lshlrev_b32 v96, 16, v73
    v_and_b32 v97, s12, v73
    v_lshlrev_b32 v98, 16, v74
    v_readfirstlane_b32 s70, v80
    s_nop 1
    v_subrev_f32 v80, s70, v80
    v_subrev_f32 v81, s70, v81
    v_subrev_f32 v82, s70, v82
    v_subrev_f32 v83, s70, v83
    v_subrev_f32 v84, s70, v84
    v_subrev_f32 v85, s70, v85
    v_subrev_f32 v86, s70, v86
    v_subrev_f32 v87, s70, v87
    v_subrev_f32 v88, s70, v88
    v_pk_add_f32 v[100:101], v[80:81], v[82:83]
    v_pk_mul_f32 v[102:103], v[80:81], v[80:81]
    v_pk_add_f32 v[100:101], v[100:101], v[84:85]
    v_pk_fma_f32 v[102:103], v[82:83], v[82:83], v[102:103]
    v_pk_add_f32 v[100:101], v[100:101], v[86:87]
    v_pk_fma_f32 v[102:103], v[84:85], v[84:85], v[102:103]
    v_add_f32 v100, v100, v88
    v_pk_fma_f32 v[102:103], v[86:87], v[86:87], v[102:103]
    v_add_f32 v100, v100, v101
    v_fmac_f32 v102, v88, v88
    v_add_f32 v102, v102, v103
    v_readfirstlane_b32 s71, v90
    s_nop 1
    v_subrev_f32 v90, s71, v90
    v_subrev_f32 v91, s71, v91
    v_subrev_f32 v92, s71, v92
    v_subrev_f32 v93, s71, v93
    v_subrev_f32 v94, s71, v94
    v_subrev_f32 v95, s71, v95
    v_subrev_f32 v96, s71, v96
    v_subrev_f32 v97, s71, v97
    v_subrev_f32 v98, s71, v98
    v_pk_add_f32 v[104:105], v[90:91], v[92:93]
    v_pk_mul_f32 v[106:107], v[90:91], v[90:91]
    v_pk_add_f32 v[104:105], v[104:105], v[94:95]
    v_pk_fma_f32 v[106:107], v[92:93], v[92:93], v[106:107]
    v_pk_add_f32 v[104:105], v[104:105], v[96:97]
    v_pk_fma_f32 v[106:107], v[94:95], v[94:95], v[106:107]
    v_add_f32 v104, v104, v98
    v_pk_fma_f32 v[106:107], v[96:97], v[96:97], v[106:107]
    v_add_f32 v104, v104, v105
    v_fmac_f32 v106, v98, v98
    v_add_f32 v106, v106, v107
    v_permlane32_swap_b32 v100, v104
    s_nop 0
    v_permlane32_swap_b32 v102, v106
    v_add_f32 v100, v100, v104
    v_add_f32 v102, v102, v106
    s_nop 1
    v_permlane16_swap_b32 v100, v102
    v_add_f32 v100, v100, v102
    s_nop 1
    v_add_f32_dpp v100, v100, v100 row_ror:8 row_mask:0xf bank_mask:0xf
    s_nop 1
    v_add_f32_dpp v100, v100, v100 row_ror:4 row_mask:0xf bank_mask:0xf
    s_nop 1
    v_add_f32_dpp v100, v100, v100 row_ror:2 row_mask:0xf bank_mask:0xf
    s_nop 1
    v_add_f32_dpp v100, v100, v100 row_ror:1 row_mask:0xf bank_mask:0xf
    v_mov_b32 v102, v100
    s_nop 1
    v_permlane16_swap_b32 v100, v102
    v_mov_b32 v104, s70
    v_mov_b32 v105, s71
    v_cmp_gt_u32 vcc, 32, v1
    s_nop 1
    v_cndmask_b32 v104, v105, v104, vcc
    v_mul_f32 v100, 0x3ae38e39, v100
    v_mul_f32 v102, 0x3ae38e39, v102
    v_add_f32 v105, v104, v100
    v_fma_f32 v107, -v100, v100, v102
    v_max_f32 v107, 0, v107
    v_cvt_pk_bf16_f32 v107, v107, v107
    v_and_b32 v107, s12, v107
    v_add_f32 v107, 0x3727c5ac, v107
    v_cvt_pk_bf16_f32 v107, v107, v107
    v_and_b32 v107, s12, v107
    v_sqrt_f32 v106, v107
    v_cvt_pk_bf16_f32 v105, v105, v105
    v_and_b32 v105, s12, v105
    v_cvt_pk_bf16_f32 v106, v106, v106
    v_and_b32 v106, s12, v106
    v_rcp_f32 v100, v106
    v_sub_f32 v101, v104, v105
    v_mul_f32 v101, v101, v100
    v_mov_b32 v102, v100
    v_mov_b32 v103, v101
    s_nop 0
    v_permlane32_swap_b32 v100, v102
    v_permlane32_swap_b32 v101, v103
    s_mul_i32 s18, s9, 2304
    s_add_u32 s18, s18, 154240
    v_lshl_add_u32 v58, v1, 5, s18
    v_lshl_add_u32 v59, v1, 2, s18
    v_pk_fma_f32 v[80:81], v[80:81], v[100:101], v[100:101] op_sel:[0,0,1] op_sel_hi:[1,0,1]
    v_pk_fma_f32 v[82:83], v[82:83], v[100:101], v[100:101] op_sel:[0,0,1] op_sel_hi:[1,0,1]
    v_pk_fma_f32 v[84:85], v[84:85], v[100:101], v[100:101] op_sel:[0,0,1] op_sel_hi:[1,0,1]
    v_pk_fma_f32 v[86:87], v[86:87], v[100:101], v[100:101] op_sel:[0,0,1] op_sel_hi:[1,0,1]
    v_fma_f32 v88, v88, v100, v101
    v_pk_fma_f32 v[90:91], v[90:91], v[102:103], v[102:103] op_sel:[0,0,1] op_sel_hi:[1,0,1]
    v_pk_fma_f32 v[92:93], v[92:93], v[102:103], v[102:103] op_sel:[0,0,1] op_sel_hi:[1,0,1]
    v_pk_fma_f32 v[94:95], v[94:95], v[102:103], v[102:103] op_sel:[0,0,1] op_sel_hi:[1,0,1]
    v_pk_fma_f32 v[96:97], v[96:97], v[102:103], v[102:103] op_sel:[0,0,1] op_sel_hi:[1,0,1]
    v_fma_f32 v98, v98, v102, v103
    v_cvt_pkrtz_f16_f32 v64, v80, v90
    v_cvt_pkrtz_f16_f32 v65, v81, v91
    v_cvt_pkrtz_f16_f32 v66, v82, v92
    v_cvt_pkrtz_f16_f32 v67, v83, v93
    v_cvt_pkrtz_f16_f32 v68, v84, v94
    v_cvt_pkrtz_f16_f32 v69, v85, v95
    v_cvt_pkrtz_f16_f32 v70, v86, v96
    v_cvt_pkrtz_f16_f32 v71, v87, v97
    v_cvt_pkrtz_f16_f32 v72, v88, v98
    v_add_u32 v64, 0x00040004, v64
    v_add_u32 v65, 0x00040004, v65
    v_add_u32 v66, 0x00040004, v66
    v_add_u32 v67, 0x00040004, v67
    v_add_u32 v68, 0x00040004, v68
    v_add_u32 v69, 0x00040004, v69
    v_add_u32 v70, 0x00040004, v70
    v_add_u32 v71, 0x00040004, v71
    v_add_u32 v72, 0x00040004, v72
    ds_write_b128 v58, v[64:67]
    ds_write_b128 v58, v[68:71] offset:16
    ds_write_b32 v59, v72 offset:2048
    s_lshl_b32 s14, s9, 2
    s_add_u32 s14, s14, 143584
    v_mov_b32 v58, s14
    v_mov_b32 v59, 0
    v_and_b32 v104, 3, v1
    v_lshlrev_b32 v100, 4, v104
    v_lshlrev_b32 v104, 2, v104
    v_add_u32 v104, 143584, v104
    v_and_b32 v52, 255, v0
    v_lshrrev_b32 v101, 2, v52
    v_lshl_add_u32 v101, v101, 14, v100
    s_lshl_b32 s14, s2, 6
    s_add_u32 s14, s14, 10485760
    v_add_u32 v101, s14, v101
    v_add_u32 v102, 1048576, v101
    v_and_b32 v103, 15, v1
    v_lshl_add_u32 v103, s9, 4, v103
    v_lshrrev_b32 v99, 2, v103
    v_lshl_add_u32 v99, v99, 14, v100
    v_add_u32 v99, s14, v99
    v_add_u32 v99, 2097152, v99
    v_lshlrev_b32 v103, 2, v103
    v_add_u32 v103, 156288, v103
    v_lshlrev_b32 v100, 2, v52
    v_add_u32 v100, 154240, v100
IFD_16:
    ds_write_b32 v58, v59
    s_waitcnt lgkmcnt(0)
    s_add_u32 s99, s99, 1
    s_mov_b32 s98, 458759
    s_lshr_b32 s20, s99, 0
    s_and_b32 s20, s20, s98
    v_mov_b32 v108, s20
    s_lshr_b32 s20, s99, 3
    s_and_b32 s20, s20, s98
    v_mov_b32 v109, s20
    s_lshr_b32 s20, s99, 6
    s_and_b32 s20, s20, s98
    v_mov_b32 v110, s20
    s_lshr_b32 s20, s99, 9
    s_and_b32 s20, s20, s98
    v_mov_b32 v111, s20
SL_13:
    ds_read_b32 v105, v104
    s_waitcnt lgkmcnt(0)
    v_cmp_eq_u32 vcc, -1, v105
    s_cbranch_vccz SLD_14
    s_sub_u32 s10, s10, 1
    s_cbranch_scc1 EXIT
    s_branch SL_13
SLD_14:
    ds_read_b32 v80, v100 offset:0
    ds_read_b32 v81, v100 offset:2304
    ds_read_b32 v82, v100 offset:4608
    ds_read_b32 v83, v100 offset:6912
    ds_read_b32 v84, v100 offset:1024
    ds_read_b32 v85, v100 offset:3328
    ds_read_b32 v86, v100 offset:5632
    ds_read_b32 v87, v100 offset:7936
    ds_read_b32 v88, v103 offset:0
    ds_read_b32 v89, v103 offset:2304
    ds_read_b32 v90, v103 offset:4608
    ds_read_b32 v91, v103 offset:6912
    s_waitcnt lgkmcnt(8)
    v_bfi_b32 v80, s98, v108, v80
    v_bfi_b32 v81, s98, v109, v81
    v_bfi_b32 v82, s98, v110, v82
    v_bfi_b32 v83, s98, v111, v83
    global_store_dwordx4 v101, v[80:83], s[68:69] sc1
    s_waitcnt lgkmcnt(4)
    v_bfi_b32 v84, s98, v108, v84
    v_bfi_b32 v85, s98, v109, v85
    v_bfi_b32 v86, s98, v110, v86
    v_bfi_b32 v87, s98, v111, v87
    global_store_dwordx4 v102, v[84:87], s[68:69] sc1
    s_waitcnt lgkmcnt(0)
    v_bfi_b32 v88, s98, v108, v88
    v_bfi_b32 v89, s98, v109, v89
    v_bfi_b32 v90, s98, v110, v90
    v_bfi_b32 v91, s98, v111, v91
    s_mov_b64 exec, 0xffff
    global_store_dwordx4 v99, v[88:91], s[68:69] sc1
    s_mov_b64 exec, -1
    s_cmp_lg_u32 s3, 7
    s_cbranch_scc1 GIF_17
    s_lshl_b32 s20, s2, 4
    s_add_u32 s20, s20, 90112
    v_mov_b32 v92, s20
    v_mov_b32 v76, s99
    v_mov_b32 v77, s99
    v_mov_b32 v78, s99
    v_mov_b32 v79, s99
    s_mov_b64 exec, 1
    s_waitcnt vmcnt(3)
    global_store_dwordx4 v92, v[76:79], s[68:69] sc1
    s_mov_b64 exec, -1
GIF_17:
    s_barrier
    s_sub_u32 s20, s5, 18
    s_cmp_ge_u32 s20, 5
    s_cbranch_scc1 PFM
    s_mul_i32 s21, s9, 5
    s_add_u32 s20, s20, s21
    s_cmp_ge_u32 s20, 18
    s_cbranch_scc1 PFM
    s_add_u32 s20, s20, 18
    s_mul_i32 s22, s4, 1152
    s_movk_i32 s24, 7282
    s_movk_i32 s25, 9216-9*128
    v_lshl_add_u32 v64, s20, 6, v1
    v_mul_u32_u24 v65, s24, v64
    v_lshrrev_b32 v65, 16, v65
    v_lshl_add_u32 v64, v64, 7, s22
    v_mad_u32_u24 v64, v65, s25, v64
    global_load_dword v65, v64, s[54:55]
    global_load_dword v66, v64, s[56:57]
    s_add_u32 s20, s20, 18
    s_mul_i32 s22, s4, 1152
    s_movk_i32 s24, 7282
    s_movk_i32 s25, 9216-9*128
    v_lshl_add_u32 v68, s20, 6, v1
    v_mul_u32_u24 v69, s24, v68
    v_lshrrev_b32 v69, 16, v69
    v_lshl_add_u32 v68, v68, 7, s22
    v_mad_u32_u24 v68, v69, s25, v68
    global_load_dword v69, v68, s[54:55]
    global_load_dword v70, v68, s[56:57]
PFM:
    s_barrier
    global_load_dwordx4 v[8:11], v7, s[52:53]
    global_load_ushort v12, v13, s[52:53]
    v_mov_b32 v60, -1
    v_mov_b32 v61, -1
    v_mov_b32 v62, -1
    v_mul_u32_u24 v59, 12, v1
    v_mov_b32 v63, -1
    s_mul_i32 s20, s2, 3
    s_add_u32 s20, s20, s9
    s_mul_i32 s20, s20, 1152
    s_add_u32 s20, s20, 4193152
    v_add_u32 v57, s20, v7
    v_add_u32 v58, s20, v13
    s_cmp_eq_u32 s3, 4
    s_cbranch_scc1 LI0
    global_store_dwordx4 v57, v[60:63], s[68:69] sc1
    global_store_short v58, v60, s[68:69] sc1
LI0:
    s_branch NC_A2
NC_A0:
    s_cmp_lt_u32 s7, 108
    s_cbranch_scc1 NC_MOD1
    s_waitcnt lgkmcnt(0)
    s_barrier
    s_barrier
    s_barrier
    s_branch NC_A1
NC_MOD1:
    v_lshrrev_b32 v52, 2, v1
    s_mul_i32 s20, s3, 144
    v_add_u32 v52, s20, v52
    v_lshlrev_b32 v53, 1, v52
    s_movk_i32 s20, 6912
    v_mul_u32_u24 v52, s20, v52
    v_and_b32 v54, 3, v1
    s_lshl_b32 s21, s7, 6
    v_lshl_add_u32 v54, v54, 4, s21
    v_add_u32 v52, v52, v54
    s_waitcnt lgkmcnt(0)
    global_load_ushort v148, v53, s[60:61]
    global_load_ushort v149, v53, s[60:61] offset:32
    global_load_ushort v150, v53, s[60:61] offset:64
    global_load_ushort v151, v53, s[60:61] offset:96
    global_load_ushort v152, v53, s[60:61] offset:128
    global_load_ushort v153, v53, s[60:61] offset:160
    global_load_ushort v154, v53, s[60:61] offset:192
    global_load_ushort v155, v53, s[60:61] offset:224
    global_load_ushort v156, v53, s[60:61] offset:256
    s_barrier
    s_load_dword s99, s[68:69], 94208
    s_cmp_lt_u32 s7, 36
    s_cbranch_scc1 NC_CR
    s_barrier
    s_barrier
NC_CR:
    global_load_dwordx4 v[112:115], v52, s[62:63] nt
    v_add_u32 v52, 110592, v52
    global_load_dwordx4 v[116:119], v52, s[62:63] nt
    v_add_u32 v52, 110592, v52
    global_load_dwordx4 v[120:123], v52, s[62:63] nt
    v_add_u32 v52, 110592, v52
    global_load_dwordx4 v[124:127], v52, s[62:63] nt
    v_add_u32 v52, 110592, v52
    global_load_dwordx4 v[128:131], v52, s[62:63] nt
    v_add_u32 v52, 110592, v52
    global_load_dwordx4 v[132:135], v52, s[62:63] nt
    v_add_u32 v52, 110592, v52
    global_load_dwordx4 v[136:139], v52, s[62:63] nt
    v_add_u32 v52, 110592, v52
    global_load_dwordx4 v[140:143], v52, s[62:63] nt
    v_add_u32 v52, 110592, v52
    global_load_dwordx4 v[144:147], v52, s[62:63] nt
    s_waitcnt vmcnt(9)
    v_lshlrev_b32 v148, 16, v148
    v_mul_f32 v64, 0xbfb8aa3b, v148
    v_exp_f32 v64, v64
    v_lshlrev_b32 v149, 16, v149
    v_mul_f32 v65, 0xbfb8aa3b, v149
    v_exp_f32 v65, v65
    v_lshlrev_b32 v150, 16, v150
    v_mul_f32 v66, 0xbfb8aa3b, v150
    v_exp_f32 v66, v66
    v_lshlrev_b32 v151, 16, v151
    v_mul_f32 v67, 0xbfb8aa3b, v151
    v_exp_f32 v67, v67
    v_lshlrev_b32 v152, 16, v152
    v_mul_f32 v68, 0xbfb8aa3b, v152
    v_exp_f32 v68, v68
    v_lshlrev_b32 v153, 16, v153
    v_mul_f32 v69, 0xbfb8aa3b, v153
    v_exp_f32 v69, v69
    v_lshlrev_b32 v154, 16, v154
    v_mul_f32 v70, 0xbfb8aa3b, v154
    v_exp_f32 v70, v70
    v_lshlrev_b32 v155, 16, v155
    v_mul_f32 v71, 0xbfb8aa3b, v155
    v_exp_f32 v71, v71
    v_lshlrev_b32 v156, 16, v156
    v_mul_f32 v72, 0xbfb8aa3b, v156
    v_exp_f32 v72, v72
    v_add_f32 v64, 1.0, v64
    v_rcp_f32 v64, v64
    v_add_f32 v65, 1.0, v65
    v_rcp_f32 v65, v65
    v_add_f32 v66, 1.0, v66
    v_rcp_f32 v66, v66
    v_add_f32 v67, 1.0, v67
    v_rcp_f32 v67, v67
    v_add_f32 v68, 1.0, v68
    v_rcp_f32 v68, v68
    v_add_f32 v69, 1.0, v69
    v_rcp_f32 v69, v69
    v_add_f32 v70, 1.0, v70
    v_rcp_f32 v70, v70
    v_add_f32 v71, 1.0, v71
    v_rcp_f32 v71, v71
    v_add_f32 v72, 1.0, v72
    v_rcp_f32 v72, v72
    v_mul_f32 v64, v148, v64
    v_mul_f32 v65, v149, v65
    v_mul_f32 v66, v150, v66
    v_mul_f32 v67, v151, v67
    v_mul_f32 v68, v152, v68
    v_mul_f32 v69, v153, v69
    v_mul_f32 v70, v154, v70
    v_mul_f32 v71, v155, v71
    v_mul_f32 v72, v156, v72
    v_cvt_pk_bf16_f32 v80, v64, v64
    v_and_b32 v80, s12, v80
    v_cvt_pk_bf16_f32 v82, v65, v65
    v_and_b32 v82, s12, v82
    v_cvt_pk_bf16_f32 v84, v66, v66
    v_and_b32 v84, s12, v84
    v_cvt_pk_bf16_f32 v86, v67, v67
    v_and_b32 v86, s12, v86
    v_cvt_pk_bf16_f32 v88, v68, v68
    v_and_b32 v88, s12, v88
    v_cvt_pk_bf16_f32 v90, v69, v69
    v_and_b32 v90, s12, v90
    v_cvt_pk_bf16_f32 v92, v70, v70
    v_and_b32 v92, s12, v92
    v_cvt_pk_bf16_f32 v94, v71, v71
    v_and_b32 v94, s12, v94
    v_cvt_pk_bf16_f32 v96, v72, v72
    v_and_b32 v96, s12, v96
    s_waitcnt vmcnt(8)
    v_lshlrev_b32 v64, 16, v112
    v_and_b32 v65, s12, v112
    v_lshlrev_b32 v66, 16, v113
    v_and_b32 v67, s12, v113
    v_lshlrev_b32 v68, 16, v114
    v_and_b32 v69, s12, v114
    v_lshlrev_b32 v70, 16, v115
    v_and_b32 v71, s12, v115
    v_pk_mul_f32 v[160:161], v[64:65], v[80:81] op_sel_hi:[1,0]
    v_pk_mul_f32 v[162:163], v[66:67], v[80:81] op_sel_hi:[1,0]
    v_pk_mul_f32 v[164:165], v[68:69], v[80:81] op_sel_hi:[1,0]
    v_pk_mul_f32 v[166:167], v[70:71], v[80:81] op_sel_hi:[1,0]
    s_waitcnt vmcnt(7)
    v_lshlrev_b32 v64, 16, v116
    v_and_b32 v65, s12, v116
    v_lshlrev_b32 v66, 16, v117
    v_and_b32 v67, s12, v117
    v_lshlrev_b32 v68, 16, v118
    v_and_b32 v69, s12, v118
    v_lshlrev_b32 v70, 16, v119
    v_and_b32 v71, s12, v119
    v_pk_fma_f32 v[160:161], v[64:65], v[82:83], v[160:161] op_sel_hi:[1,0,1]
    v_pk_fma_f32 v[162:163], v[66:67], v[82:83], v[162:163] op_sel_hi:[1,0,1]
    v_pk_fma_f32 v[164:165], v[68:69], v[82:83], v[164:165] op_sel_hi:[1,0,1]
    v_pk_fma_f32 v[166:167], v[70:71], v[82:83], v[166:167] op_sel_hi:[1,0,1]
    s_waitcnt vmcnt(6)
    v_lshlrev_b32 v64, 16, v120
    v_and_b32 v65, s12, v120
    v_lshlrev_b32 v66, 16, v121
    v_and_b32 v67, s12, v121
    v_lshlrev_b32 v68, 16, v122
    v_and_b32 v69, s12, v122
    v_lshlrev_b32 v70, 16, v123
    v_and_b32 v71, s12, v123
    v_pk_fma_f32 v[160:161], v[64:65], v[84:85], v[160:161] op_sel_hi:[1,0,1]
    v_pk_fma_f32 v[162:163], v[66:67], v[84:85], v[162:163] op_sel_hi:[1,0,1]
    v_pk_fma_f32 v[164:165], v[68:69], v[84:85], v[164:165] op_sel_hi:[1,0,1]
    v_pk_fma_f32 v[166:167], v[70:71], v[84:85], v[166:167] op_sel_hi:[1,0,1]
    s_waitcnt vmcnt(5)
    v_lshlrev_b32 v64, 16, v124
    v_and_b32 v65, s12, v124
    v_lshlrev_b32 v66, 16, v125
    v_and_b32 v67, s12, v125
    v_lshlrev_b32 v68, 16, v126
    v_and_b32 v69, s12, v126
    v_lshlrev_b32 v70, 16, v127
    v_and_b32 v71, s12, v127
    v_pk_fma_f32 v[160:161], v[64:65], v[86:87], v[160:161] op_sel_hi:[1,0,1]
    v_pk_fma_f32 v[162:163], v[66:67], v[86:87], v[162:163] op_sel_hi:[1,0,1]
    v_pk_fma_f32 v[164:165], v[68:69], v[86:87], v[164:165] op_sel_hi:[1,0,1]
    v_pk_fma_f32 v[166:167], v[70:71], v[86:87], v[166:167] op_sel_hi:[1,0,1]
    s_waitcnt vmcnt(4)
    v_lshlrev_b32 v64, 16, v128
    v_and_b32 v65, s12, v128
    v_lshlrev_b32 v66, 16, v129
    v_and_b32 v67, s12, v129
    v_lshlrev_b32 v68, 16, v130
    v_and_b32 v69, s12, v130
    v_lshlrev_b32 v70, 16, v131
    v_and_b32 v71, s12, v131
    v_pk_fma_f32 v[160:161], v[64:65], v[88:89], v[160:161] op_sel_hi:[1,0,1]
    v_pk_fma_f32 v[162:163], v[66:67], v[88:89], v[162:163] op_sel_hi:[1,0,1]
    v_pk_fma_f32 v[164:165], v[68:69], v[88:89], v[164:165] op_sel_hi:[1,0,1]
    v_pk_fma_f32 v[166:167], v[70:71], v[88:89], v[166:167] op_sel_hi:[1,0,1]
    v_min_u32 v75, 4, v1
    v_lshlrev_b32 v75, 2, v75
    s_cmp_eq_u32 s3, 0
    s_cselect_b64 exec, -1, 0
    global_load_dword v74, v75, s[66:67] sc1
    s_mov_b64 exec, -1
    s_waitcnt vmcnt(4)
    v_lshlrev_b32 v64, 16, v132
    v_and_b32 v65, s12, v132
    v_lshlrev_b32 v66, 16, v133
    v_and_b32 v67, s12, v133
    v_lshlrev_b32 v68, 16, v134
    v_and_b32 v69, s12, v134
    v_lshlrev_b32 v70, 16, v135
    v_and_b32 v71, s12, v135
    v_pk_fma_f32 v[160:161], v[64:65], v[90:91], v[160:161] op_sel_hi:[1,0,1]
    v_pk_fma_f32 v[162:163], v[66:67], v[90:91], v[162:163] op_sel_hi:[1,0,1]
    v_pk_fma_f32 v[164:165], v[68:69], v[90:91], v[164:165] op_sel_hi:[1,0,1]
    v_pk_fma_f32 v[166:167], v[70:71], v[90:91], v[166:167] op_sel_hi:[1,0,1]
    s_waitcnt vmcnt(3)
    v_lshlrev_b32 v64, 16, v136
    v_and_b32 v65, s12, v136
    v_lshlrev_b32 v66, 16, v137
    v_and_b32 v67, s12, v137
    v_lshlrev_b32 v68, 16, v138
    v_and_b32 v69, s12, v138
    v_lshlrev_b32 v70, 16, v139
    v_and_b32 v71, s12, v139
    v_pk_fma_f32 v[160:161], v[64:65], v[92:93], v[160:161] op_sel_hi:[1,0,1]
    v_pk_fma_f32 v[162:163], v[66:67], v[92:93], v[162:163] op_sel_hi:[1,0,1]
    v_pk_fma_f32 v[164:165], v[68:69], v[92:93], v[164:165] op_sel_hi:[1,0,1]
    v_pk_fma_f32 v[166:167], v[70:71], v[92:93], v[166:167] op_sel_hi:[1,0,1]
    s_waitcnt vmcnt(2)
    v_lshlrev_b32 v64, 16, v140
    v_and_b32 v65, s12, v140
    v_lshlrev_b32 v66, 16, v141
    v_and_b32 v67, s12, v141
    v_lshlrev_b32 v68, 16, v142
    v_and_b32 v69, s12, v142
    v_lshlrev_b32 v70, 16, v143
    v_and_b32 v71, s12, v143
    v_pk_fma_f32 v[160:161], v[64:65], v[94:95], v[160:161] op_sel_hi:[1,0,1]
    v_pk_fma_f32 v[162:163], v[66:67], v[94:95], v[162:163] op_sel_hi:[1,0,1]
    v_pk_fma_f32 v[164:165], v[68:69], v[94:95], v[164:165] op_sel_hi:[1,0,1]
    v_pk_fma_f32 v[166:167], v[70:71], v[94:95], v[166:167] op_sel_hi:[1,0,1]
    s_waitcnt vmcnt(1)
    v_lshlrev_b32 v64, 16, v144
    v_and_b32 v65, s12, v144
    v_lshlrev_b32 v66, 16, v145
    v_and_b32 v67, s12, v145
    v_lshlrev_b32 v68, 16, v146
    v_and_b32 v69, s12, v146
    v_lshlrev_b32 v70, 16, v147
    v_and_b32 v71, s12, v147
    v_pk_fma_f32 v[160:161], v[64:65], v[96:97], v[160:161] op_sel_hi:[1,0,1]
    v_pk_fma_f32 v[162:163], v[66:67], v[96:97], v[162:163] op_sel_hi:[1,0,1]
    v_pk_fma_f32 v[164:165], v[68:69], v[96:97], v[164:165] op_sel_hi:[1,0,1]
    v_pk_fma_f32 v[166:167], v[70:71], v[96:97], v[166:167] op_sel_hi:[1,0,1]
    s_nop 0
    v_permlane32_swap_b32 v160, v164
    v_permlane32_swap_b32 v161, v165
    v_permlane32_swap_b32 v162, v166
    v_permlane32_swap_b32 v163, v167
    v_pk_add_f32 v[160:161], v[160:161], v[164:165]
    v_pk_add_f32 v[162:163], v[162:163], v[166:167]
    s_nop 1
    v_permlane16_swap_b32 v160, v162
    v_permlane16_swap_b32 v161, v163
    v_pk_add_f32 v[160:161], v[160:161], v[162:163]
    s_nop 1
    v_add_f32_dpp v160, v160, v160 row_ror:4 row_mask:0xf bank_mask:0xf
    v_add_f32_dpp v161, v161, v161 row_ror:4 row_mask:0xf bank_mask:0xf
    s_nop 0
    v_add_f32_dpp v160, v160, v160 row_ror:8 row_mask:0xf bank_mask:0xf
    v_add_f32_dpp v161, v161, v161 row_ror:8 row_mask:0xf bank_mask:0xf
    v_and_b32 v64, 3, v1
    v_lshlrev_b32 v64, 5, v64
    v_lshrrev_b32 v65, 4, v1
    v_lshl_add_u32 v64, v65, 3, v64
    s_lshl_b32 s18, s3, 7
    s_add_u32 s18, s18, 144000
    v_add_u32 v64, s18, v64
    s_lshl_b32 s18, s3, 2
    s_add_u32 s18, s18, 143568
    v_mov_b32 v66, s18
    v_mov_b32 v67, 0
    s_mov_b32 exec_lo, 0x000f000f
    s_mov_b32 exec_hi, 0x000f000f
    ds_write_b64 v64, v[160:161]
    ds_write_b32 v66, v67
    s_mov_b64 exec, -1
    s_cmp_lg_u32 s3, 0
    s_cbranch_scc1 NC_A1
    v_and_b32 v64, 15, v1
    v_lshlrev_b32 v65, 3, v64
    v_add_u32 v65, 144000, v65
    v_and_b32 v66, 3, v1
    v_lshlrev_b32 v66, 2, v66
    v_add_u32 v66, 143568, v66
    s_lshl_b32 s18, s7, 6
    s_add_u32 s18, s18, 8192
    v_lshl_add_u32 v64, v64, 2, s18
MRP:
    ds_read_b32 v67, v66
    ds_read_b64 v[80:81], v65 offset:0
    ds_read_b64 v[82:83], v65 offset:128
    ds_read_b64 v[84:85], v65 offset:256
    ds_read_b64 v[86:87], v65 offset:384
    s_waitcnt lgkmcnt(0)
    v_cmp_eq_u32 vcc, -1, v67
    s_cbranch_vccz MRD
    s_sub_u32 s10, s10, 1
    s_cbranch_scc1 EXIT
    s_branch MRP
MRD:
    v_pk_add_f32 v[80:81], v[80:81], v[84:85]
    v_pk_add_f32 v[82:83], v[82:83], v[86:87]
    v_pk_add_f32 v[80:81], v[80:81], v[82:83]
    v_cvt_pk_bf16_f32 v66, v80, v81
    s_cmp_ge_u32 s7, 36
    s_cbranch_scc1 MUT
    s_add_u32 s99, s99, 1
    s_and_b32 s20, s99, 0xffff
    v_lshl_or_b32 v80, v66, 16, s20
    v_mov_b32 v81, s20
    v_and_or_b32 v81, v66, s12, v81
    v_lshlrev_b32 v64, 1, v64
    v_add_u32 v64, 65536, v64
    s_mov_b64 exec, 0xffff
    global_store_dwordx2 v64, v[80:81], s[68:69] sc1
    s_branch MUD
MUT:
    v_min_u32 v66, -2, v66
GO_18:
    s_waitcnt vmcnt(0)
    v_cmp_eq_u32 vcc, 0, v74
    s_cbranch_vccz GOD_19
    global_load_dword v74, v75, s[66:67] sc1
    s_sub_u32 s10, s10, 1
    s_cbranch_scc1 EXIT
    s_branch GO_18
GOD_19:
    s_mov_b64 exec, 0xffff
    global_store_dword v64, v66, s[68:69] sc1
MUD:
    s_mov_b64 exec, -1
NC_A1:
    global_load_dwordx4 v[8:11], v7, s[52:53]
    global_load_ushort v12, v13, s[52:53]
    s_cmp_ge_u32 s7, 36
    s_cbranch_scc1 NC_A2
    s_barrier
    s_barrier
NC_A2:
    s_barrier
    s_sub_u32 s20, s5, 23
    s_cbranch_scc1 PF_E
    s_mul_i32 s21, s3, 9
    s_add_u32 s20, s20, s21
    s_cmp_ge_u32 s20, 27
    s_cbranch_scc1 PF_D
    s_add_u32 s20, s20, 54
    s_mul_i32 s22, s4, 1152
    s_movk_i32 s24, 7282
    s_movk_i32 s25, 9216-9*128
    v_lshl_add_u32 v92, s20, 6, v1
    v_mul_u32_u24 v93, s24, v92
    v_lshrrev_b32 v93, 16, v93
    v_lshl_add_u32 v92, v92, 7, s22
    v_mad_u32_u24 v92, v93, s25, v92
    global_load_dword v93, v92, s[54:55]
    global_load_dword v94, v92, s[56:57]
    s_branch PF_E
PF_D:
    s_sub_u32 s20, s20, 27
    s_mul_i32 s23, s4, 663552
    v_lshl_add_u32 v92, s20, 6, v1
    v_lshl_add_u32 v95, v92, 7, s23
    global_load_dword v96, v95, s[58:59]
    s_cmp_ge_u32 s20, 36
    s_cbranch_scc1 PF_E
    v_add_u32 v95, 368640, v95
    global_load_dword v97, v95, s[58:59]
PF_E:
NC_A4:
    s_cmp_lg_u32 s3, 4
    s_cbranch_scc1 NC_FD
    s_lshl_b32 s20, s2, 4
    s_add_u32 s20, s20, 18176
    v_mov_b32 v52, s20
    s_waitcnt vmcnt(0)
    v_min_u32 v55, 4, v1
    v_lshlrev_b32 v55, 2, v55
    global_load_dword v54, v55, s[66:67] sc1
GO_20:
    s_waitcnt vmcnt(0)
    v_cmp_eq_u32 vcc, 0, v54
    s_cbranch_vccz GOD_21
    global_load_dword v54, v55, s[66:67] sc1
    s_sub_u32 s10, s10, 1
    s_cbranch_scc1 EXIT
    s_branch GO_20
GOD_21:
NC_FP:
    global_load_dword v53, v52, s[68:69] sc1
    s_waitcnt vmcnt(0)
    v_cmp_eq_u32 vcc, -1, v53
    s_cbranch_vccz NC_FD
    s_sub_u32 s10, s10, 1
    s_cbranch_scc1 EXIT
    s_branch NC_FP
NC_FD:
    s_barrier
    v_add_u32 v52, 8192, v7
    v_add_u32 v53, 8192, v13
    v_add_u32 v54, 2304, v52
    v_add_u32 v55, 2304, v53
    global_load_dwordx4 v[106:109], v54, s[68:69]
    global_load_ushort v110, v55, s[68:69]
    v_add_u32 v54, 3456, v52
    v_add_u32 v55, 3456, v53
    global_load_dwordx4 v[20:23], v54, s[68:69]
    global_load_ushort v24, v55, s[68:69]
    v_add_u32 v54, 4608, v52
    v_add_u32 v55, 4608, v53
    global_load_dwordx4 v[14:17], v54, s[68:69]
    global_load_ushort v18, v55, s[68:69]
    v_add_u32 v54, 5760, v52
    v_add_u32 v55, 5760, v53
    global_load_dwordx4 v[26:29], v54, s[68:69]
    global_load_ushort v30, v55, s[68:69]
    s_waitcnt vmcnt(0)
MC_22:
    v_or_b32 v53, s12, v24
    v_or_b32 v54, s12, v18
    v_or_b32 v55, s12, v30
    v_or_b32 v56, s12, v110
    v_max3_u32 v52, v20, v21, v22
    v_max3_u32 v52, v52, v23, v14
    v_max3_u32 v52, v52, v15, v16
    v_max3_u32 v52, v52, v17, v26
    v_max3_u32 v52, v52, v27, v28
    v_max3_u32 v52, v52, v29, v106
    v_max3_u32 v52, v52, v107, v108
    v_max3_u32 v52, v52, v109, v53
    v_max3_u32 v52, v52, v54, v55
    v_max_u32 v52, v52, v56
    v_cmp_eq_u32 vcc, -1, v52
    s_cbranch_vccz MCD_23
    v_add_u32 v52, 8192, v7
    v_add_u32 v53, 8192, v13
    v_add_u32 v54, 2304, v52
    v_add_u32 v55, 2304, v53
    global_load_dwordx4 v[106:109], v54, s[68:69] sc1
    global_load_ushort v110, v55, s[68:69] sc1
    v_add_u32 v54, 3456, v52
    v_add_u32 v55, 3456, v53
    global_load_dwordx4 v[20:23], v54, s[68:69] sc1
    global_load_ushort v24, v55, s[68:69] sc1
    v_add_u32 v54, 4608, v52
    v_add_u32 v55, 4608, v53
    global_load_dwordx4 v[14:17], v54, s[68:69] sc1
    global_load_ushort v18, v55, s[68:69] sc1
    v_add_u32 v54, 5760, v52
    v_add_u32 v55, 5760, v53
    global_load_dwordx4 v[26:29], v54, s[68:69] sc1
    global_load_ushort v30, v55, s[68:69] sc1
    s_waitcnt vmcnt(0)
    s_sub_u32 s10, s10, 1
    s_cbranch_scc1 EXIT
    s_branch MC_22
MCD_23:
    v_lshlrev_b32 v32, 16, v14
    v_and_b32 v33, s12, v14
    v_lshlrev_b32 v34, 16, v15
    v_and_b32 v35, s12, v15
    v_lshlrev_b32 v36, 16, v16
    v_and_b32 v37, s12, v16
    v_lshlrev_b32 v38, 16, v17
    v_and_b32 v39, s12, v17
    v_lshlrev_b32 v40, 16, v18
    v_lshlrev_b32 v42, 16, v20
    v_and_b32 v43, s12, v20
    v_lshlrev_b32 v44, 16, v21
    v_and_b32 v45, s12, v21
    v_lshlrev_b32 v46, 16, v22
    v_and_b32 v47, s12, v22
    v_lshlrev_b32 v48, 16, v23
    v_and_b32 v49, s12, v23
    v_lshlrev_b32 v50, 16, v24
    v_pk_add_f32 v[32:33], v[32:33], 1.0 op_sel_hi:[1,0]
    v_pk_add_f32 v[34:35], v[34:35], 1.0 op_sel_hi:[1,0]
    v_pk_add_f32 v[36:37], v[36:37], 1.0 op_sel_hi:[1,0]
    v_pk_add_f32 v[38:39], v[38:39], 1.0 op_sel_hi:[1,0]
    v_add_f32 v40, 1.0, v40
    v_cvt_pk_bf16_f32 v52, v32, v33
    v_cvt_pk_bf16_f32 v53, v34, v35
    v_cvt_pk_bf16_f32 v54, v36, v37
    v_cvt_pk_bf16_f32 v55, v38, v39
    v_cvt_pk_bf16_f32 v56, v40, v40
    v_lshlrev_b32 v32, 16, v52
    v_and_b32 v33, s12, v52
    v_lshlrev_b32 v34, 16, v53
    v_and_b32 v35, s12, v53
    v_lshlrev_b32 v36, 16, v54
    v_and_b32 v37, s12, v54
    v_lshlrev_b32 v38, 16, v55
    v_and_b32 v39, s12, v55
    v_lshlrev_b32 v40, 16, v56
GPOLL:
    s_mul_i32 s20, s2, 9216
    s_add_u32 s20, s20, 1048576
    v_lshl_add_u32 v52, v0, 4, s20
    v_and_b32 v53, 7, v1
    v_lshl_add_u32 v53, s3, 3, v53
    v_add_u32 v53, 512, v53
    v_lshlrev_b32 v55, 2, v53
    v_lshl_add_u32 v53, v53, 4, s20
    v_lshlrev_b32 v54, 2, v0
    global_load_dwordx4 v[64:67], v52, s[68:69] sc1
    global_load_dwordx4 v[68:71], v53, s[68:69] sc1
    s_mul_i32 s20, s3, 1152
    s_add_u32 s20, s20, 145024
    v_add_u32 v56, s20, v7
    v_add_u32 v57, s20, v13
    ds_read_b128 v[2:5], v56
    ds_read_u16 v6, v57
    s_waitcnt lgkmcnt(0)
    v_lshlrev_b32 v80, 16, v2
    v_and_b32 v81, s12, v2
    v_lshlrev_b32 v82, 16, v3
    v_and_b32 v83, s12, v3
    v_lshlrev_b32 v84, 16, v4
    v_and_b32 v85, s12, v4
    v_lshlrev_b32 v86, 16, v5
    v_and_b32 v87, s12, v5
    v_lshlrev_b32 v88, 16, v6
    v_lshlrev_b32 v96, 16, v106
    v_and_b32 v97, s12, v106
    v_lshlrev_b32 v98, 16, v107
    v_and_b32 v99, s12, v107
    v_lshlrev_b32 v100, 16, v108
    v_and_b32 v101, s12, v108
    v_lshlrev_b32 v102, 16, v109
    v_and_b32 v103, s12, v109
    v_lshlrev_b32 v104, 16, v110
    s_waitcnt vmcnt(0)
GP:
    v_max3_u32 v72, v64, v65, v66
    v_max3_u32 v72, v72, v67, v68
    v_max3_u32 v72, v72, v69, v70
    v_max_u32 v72, v72, v71
    v_cmp_eq_u32 vcc, -1, v72
    s_cbranch_vccz GPD
    s_mov_b64 exec, vcc
    global_load_dwordx4 v[64:67], v52, s[68:69] sc1
    global_load_dwordx4 v[68:71], v53, s[68:69] sc1
    s_mov_b64 exec, -1
    s_waitcnt vmcnt(0)
    s_sub_u32 s10, s10, 1
    s_cbranch_scc1 EXIT
    s_branch GP
GPD:
    ds_write_b32 v54, v64 offset:8192
    ds_write_b32 v54, v65 offset:10496
    ds_write_b32 v54, v66 offset:12800
    ds_write_b32 v54, v67 offset:15104
    s_mov_b64 exec, 0xff
    ds_write_b32 v55, v68 offset:8192
    ds_write_b32 v55, v69 offset:10496
    ds_write_b32 v55, v70 offset:12800
    ds_write_b32 v55, v71 offset:15104
    s_mov_b64 exec, -1
    s_lshr_b32 s20, s3, 1
    s_mul_i32 s20, s20, 2304
    v_lshl_add_u32 v52, v1, 5, s20
    v_lshl_add_u32 v53, v1, 2, s20
    s_mov_b32 s21, 0x01000c0c
    s_bitcmp1_b32 s3, 0
    s_cselect_b32 s21, 0x03020c0c, s21
    s_mul_i32 s22, s2, 3456
    s_add_u32 s23, s22, 4194304
    v_add_u32 v56, s23, v7
    v_add_u32 v57, s23, v13
    s_waitcnt lgkmcnt(0)
    s_barrier
    ds_read_b128 v[64:67], v52 offset:8192
    ds_read_b128 v[68:71], v52 offset:8208
    ds_read_b32 v72, v53 offset:10240
    s_waitcnt lgkmcnt(0)
    v_perm_b32 v64, v64, v64, s21
    v_perm_b32 v65, v65, v65, s21
    v_perm_b32 v66, v66, v66, s21
    v_perm_b32 v67, v67, v67, s21
    v_perm_b32 v68, v68, v68, s21
    v_perm_b32 v69, v69, v69, s21
    v_perm_b32 v70, v70, v70, s21
    v_perm_b32 v71, v71, v71, s21
    v_perm_b32 v72, v72, v72, s21
    v_pk_fma_f32 v[64:65], v[64:65], v[96:97], v[80:81]
    v_pk_fma_f32 v[66:67], v[66:67], v[98:99], v[82:83]
    v_pk_fma_f32 v[68:69], v[68:69], v[100:101], v[84:85]
    v_pk_fma_f32 v[70:71], v[70:71], v[102:103], v[86:87]
    v_fma_f32 v72, v72, v104, v88
    v_cvt_pk_bf16_f32 v2, v64, v65
    v_cvt_pk_bf16_f32 v3, v66, v67
    v_cvt_pk_bf16_f32 v4, v68, v69
    v_cvt_pk_bf16_f32 v5, v70, v71
    v_cvt_pk_bf16_f32 v6, v72, v72
    v_lshlrev_b32 v64, 16, v2
    v_and_b32 v65, s12, v2
    v_lshlrev_b32 v66, 16, v3
    v_and_b32 v67, s12, v3
    v_lshlrev_b32 v68, 16, v4
    v_and_b32 v69, s12, v4
    v_lshlrev_b32 v70, 16, v5
    v_and_b32 v71, s12, v5
    v_lshlrev_b32 v72, 16, v6
    v_readfirstlane_b32 s24, v64
    s_nop 1
    v_subrev_f32 v64, s24, v64
    v_subrev_f32 v65, s24, v65
    v_subrev_f32 v66, s24, v66
    v_subrev_f32 v67, s24, v67
    v_subrev_f32 v68, s24, v68
    v_subrev_f32 v69, s24, v69
    v_subrev_f32 v70, s24, v70
    v_subrev_f32 v71, s24, v71
    v_subrev_f32 v72, s24, v72
    v_pk_add_f32 v[74:75], v[64:65], v[66:67]
    v_pk_mul_f32 v[76:77], v[64:65], v[64:65]
    v_pk_add_f32 v[74:75], v[74:75], v[68:69]
    v_pk_fma_f32 v[76:77], v[66:67], v[66:67], v[76:77]
    v_pk_add_f32 v[74:75], v[74:75], v[70:71]
    v_pk_fma_f32 v[76:77], v[68:69], v[68:69], v[76:77]
    v_add_f32 v74, v74, v72
    v_pk_fma_f32 v[76:77], v[70:71], v[70:71], v[76:77]
    v_add_f32 v74, v74, v75
    v_fmac_f32 v76, v72, v72
    v_add_f32 v76, v76, v77
    s_nop 1
    v_permlane32_swap_b32 v74, v76
    v_add_f32 v74, v74, v76
    v_mov_b32 v76, v74
    s_nop 1
    v_permlane16_swap_b32 v74, v76
    v_add_f32 v74, v74, v76
    s_nop 1
    v_add_f32_dpp v74, v74, v74 row_ror:8 row_mask:0xf bank_mask:0xf
    s_nop 1
    v_add_f32_dpp v74, v74, v74 row_ror:4 row_mask:0xf bank_mask:0xf
    s_nop 1
    v_add_f32_dpp v74, v74, v74 row_ror:2 row_mask:0xf bank_mask:0xf
    s_nop 1
    v_add_f32_dpp v74, v74, v74 row_ror:1 row_mask:0xf bank_mask:0xf
    v_mov_b32 v76, v74
    s_nop 1
    v_permlane32_swap_b32 v74, v76
    v_mul_f32 v74, 0x3ae38e39, v74
    v_mul_f32 v76, 0x3ae38e39, v76
    v_add_f32 v75, s24, v74
    v_fma_f32 v77, -v74, v74, v76
    v_max_f32 v77, 0, v77
    v_cvt_pk_bf16_f32 v77, v77, v77
    v_and_b32 v77, s12, v77
    v_add_f32 v77, 0x3727c5ac, v77
    v_cvt_pk_bf16_f32 v77, v77, v77
    v_and_b32 v77, s12, v77
    v_sqrt_f32 v78, v77
    v_cvt_pk_bf16_f32 v75, v75, v75
    v_and_b32 v75, s12, v75
    v_cvt_pk_bf16_f32 v78, v78, v78
    v_and_b32 v78, s12, v78
    v_rcp_f32 v78, v78
    v_sub_f32 v79, s24, v75
    v_mul_f32 v79, v79, v78
    v_pk_fma_f32 v[64:65], v[64:65], v[78:79], v[78:79] op_sel:[0,0,1] op_sel_hi:[1,0,1]
    v_pk_fma_f32 v[66:67], v[66:67], v[78:79], v[78:79] op_sel:[0,0,1] op_sel_hi:[1,0,1]
    v_pk_fma_f32 v[68:69], v[68:69], v[78:79], v[78:79] op_sel:[0,0,1] op_sel_hi:[1,0,1]
    v_pk_fma_f32 v[70:71], v[70:71], v[78:79], v[78:79] op_sel:[0,0,1] op_sel_hi:[1,0,1]
    v_fma_f32 v72, v72, v78, v79
    v_pk_fma_f32 v[64:65], v[64:65], v[32:33], v[42:43]
    v_pk_fma_f32 v[66:67], v[66:67], v[34:35], v[44:45]
    v_pk_fma_f32 v[68:69], v[68:69], v[36:37], v[46:47]
    v_pk_fma_f32 v[70:71], v[70:71], v[38:39], v[48:49]
    v_fma_f32 v72, v72, v40, v50
    v_cvt_pk_bf16_f32 v90, v64, v65
    v_cvt_pk_bf16_f32 v91, v66, v67
    v_cvt_pk_bf16_f32 v92, v68, v69
    v_cvt_pk_bf16_f32 v93, v70, v71
    v_cvt_pk_bf16_f32 v94, v72, v72
    v_dot2_f32_bf16 v74, v90, v8, 0
    v_dot2_f32_bf16 v75, v91, v9, 0
    v_dot2_f32_bf16 v74, v92, v10, v74
    v_dot2_f32_bf16 v75, v93, v11, v75
    v_dot2_f32_bf16 v74, v94, v12, v74
    s_nop 2
    v_add_f32 v74, v74, v75
    v_mov_b32 v76, v74
    s_nop 1
    v_permlane32_swap_b32 v74, v76
    v_add_f32 v74, v74, v76
    v_mov_b32 v76, v74
    s_nop 1
    v_permlane16_swap_b32 v74, v76
    v_add_f32 v74, v74, v76
    s_nop 1
    v_add_f32_dpp v74, v74, v74 row_ror:8 row_mask:0xf bank_mask:0xf
    s_nop 1
    v_add_f32_dpp v74, v74, v74 row_ror:4 row_mask:0xf bank_mask:0xf
    s_nop 1
    v_add_f32_dpp v74, v74, v74 row_ror:2 row_mask:0xf bank_mask:0xf
    s_nop 1
    v_add_f32_dpp v74, v74, v74 row_ror:1 row_mask:0xf bank_mask:0xf
    v_cvt_pk_bf16_f32 v74, v74, v74
    v_ashrrev_i32 v75, 31, v74
    v_or_b32 v75, 0x80008000, v75
    v_xor_b32 v74, v74, v75
    v_min_u32 v74, 0xfffefffe, v74
    s_lshl_b32 s20, s3, 1
    s_add_u32 s20, s20, 143552
    v_mov_b32 v75, s20
    s_mov_b64 exec, 1
    ds_write_b16_d16_hi v75, v74
    s_mov_b64 exec, -1
    s_waitcnt lgkmcnt(0)
    v_and_b32 v53, 7, v1
    v_lshlrev_b32 v54, 1, v53
    v_add_u32 v54, 143552, v54
    v_sub_u32 v53, 7, v53
    s_barrier
    ds_read_u16 v54, v54
    s_cmp_lg_u32 s3, 0
    s_cbranch_scc1 NORS
    v_mov_b32 v52, 143552
    ds_read_b128 v[64:67], v52
    s_lshl_b32 s20, s2, 4
    s_add_u32 s20, s20, 49152
    v_lshl_add_u32 v52, v1, 12, s20
    s_mov_b64 exec, 0xff
    s_waitcnt lgkmcnt(0)
    global_store_dwordx4 v52, v[64:67], s[68:69] sc1
    s_mov_b64 exec, -1
NORS:
    s_waitcnt lgkmcnt(0)
    v_lshl_or_b32 v54, v54, 3, v53
    s_nop 0
    v_readlane_b32 s20, v54, s3
    s_nop 1
    v_cmp_lt_u32 vcc, s20, v54
    s_nop 0
    s_and_b32 s14, vcc_lo, 0xff
    s_bcnt1_i32_b32 s14, s14
    s_mul_i32 s20, s14, 1152
    v_add_u32 v56, s20, v56
    v_add_u32 v57, s20, v57
    s_cmp_ge_u32 s14, 3
    s_cbranch_scc1 NOBEST
    global_store_dwordx4 v56, v[90:93], s[68:69] sc1
    global_store_short v57, v94, s[68:69] sc1
NOBEST:
    v_lshlrev_b32 v64, 16, v2
    v_and_b32 v65, s12, v2
    v_lshlrev_b32 v66, 16, v3
    v_and_b32 v67, s12, v3
    v_lshlrev_b32 v68, 16, v4
    v_and_b32 v69, s12, v4
    v_lshlrev_b32 v70, 16, v5
    v_and_b32 v71, s12, v5
    v_lshlrev_b32 v72, 16, v6
    v_lshlrev_b32 v74, 16, v90
    v_and_b32 v75, s12, v90
    v_lshlrev_b32 v76, 16, v91
    v_and_b32 v77, s12, v91
    v_lshlrev_b32 v78, 16, v92
    v_and_b32 v79, s12, v92
    v_lshlrev_b32 v80, 16, v93
    v_and_b32 v81, s12, v93
    v_lshlrev_b32 v82, 16, v94
    v_lshlrev_b32 v96, 16, v26
    v_and_b32 v97, s12, v26
    v_lshlrev_b32 v98, 16, v27
    v_and_b32 v99, s12, v27
    v_lshlrev_b32 v100, 16, v28
    v_and_b32 v101, s12, v28
    v_lshlrev_b32 v102, 16, v29
    v_and_b32 v103, s12, v29
    v_lshlrev_b32 v104, 16, v30
    v_pk_fma_f32 v[64:65], v[74:75], v[96:97], v[64:65]
    v_pk_fma_f32 v[66:67], v[76:77], v[98:99], v[66:67]
    v_pk_fma_f32 v[68:69], v[78:79], v[100:101], v[68:69]
    v_pk_fma_f32 v[70:71], v[80:81], v[102:103], v[70:71]
    v_fma_f32 v72, v82, v104, v72
    v_cvt_pk_bf16_f32 v8, v64, v65
    v_cvt_pk_bf16_f32 v9, v66, v67
    v_cvt_pk_bf16_f32 v10, v68, v69
    v_cvt_pk_bf16_f32 v11, v70, v71
    v_cvt_pk_bf16_f32 v12, v72, v72
    s_cmp_lt_u32 s3, 4
    s_cbranch_scc1 T8_A
    s_cmp_eq_u32 s13, 0
    s_cbranch_scc1 T8_B5
    v_and_b32 v52, 7, v1
    v_lshlrev_b32 v52, 3, v52
    v_lshrrev_b32 v53, 4, v1
    s_mul_i32 s20, s9, 294912
    s_lshl_b32 s21, s8, 6
    s_add_u32 s20, s20, s21
    s_add_u32 s20, s20, 3538944
    s_mov_b32 s21, 73728
    v_mad_u32_u24 v52, v53, s21, v52
    v_add_u32 v52, s20, v52
    v_and_b32 v54, 8, v1
    v_cmp_eq_u32 vcc, 0, v54
    v_mov_b32 v54, s56
    v_mov_b32 v55, s54
    v_cndmask_b32 v54, v54, v55, vcc
    v_mov_b32 v55, s57
    v_mov_b32 v56, s55
    v_cndmask_b32 v55, v55, v56, vcc
    v_add_co_u32 v54, vcc, v54, v52
    s_nop 1
    v_addc_co_u32 v55, vcc, 0, v55, vcc
    s_mov_b32 s20, 9216
    s_mov_b32 s21, 0
    s_mov_b32 s22, 1115136
    s_mov_b32 s23, 0
    global_load_dwordx2 v[176:177], v[54:55], off nt
    v_lshl_add_u64 v[54:55], v[54:55], 0, s[20:21]
    global_load_dwordx2 v[178:179], v[54:55], off nt
    v_lshl_add_u64 v[54:55], v[54:55], 0, s[20:21]
    global_load_dwordx2 v[180:181], v[54:55], off nt
    v_lshl_add_u64 v[54:55], v[54:55], 0, s[20:21]
    global_load_dwordx2 v[182:183], v[54:55], off nt
    v_lshl_add_u64 v[54:55], v[54:55], 0, s[20:21]
    global_load_dwordx2 v[184:185], v[54:55], off nt
    v_lshl_add_u64 v[54:55], v[54:55], 0, s[20:21]
    global_load_dwordx2 v[186:187], v[54:55], off nt
    v_lshl_add_u64 v[54:55], v[54:55], 0, s[20:21]
    global_load_dwordx2 v[188:189], v[54:55], off nt
    v_lshl_add_u64 v[54:55], v[54:55], 0, s[20:21]
    global_load_dwordx2 v[190:191], v[54:55], off nt
    v_lshl_add_u64 v[54:55], v[54:55], 0, s[22:23]
    s_cmp_ge_u32 s9, 2
    s_cbranch_scc1 W5_24
    global_load_dwordx2 v[192:193], v[54:55], off nt
    v_lshl_add_u64 v[54:55], v[54:55], 0, s[20:21]
    global_load_dwordx2 v[194:195], v[54:55], off nt
    v_lshl_add_u64 v[54:55], v[54:55], 0, s[20:21]
    global_load_dwordx2 v[196:197], v[54:55], off nt
    v_lshl_add_u64 v[54:55], v[54:55], 0, s[20:21]
    global_load_dwordx2 v[198:199], v[54:55], off nt
    v_lshl_add_u64 v[54:55], v[54:55], 0, s[20:21]
    global_load_dwordx2 v[200:201], v[54:55], off nt
    v_lshl_add_u64 v[54:55], v[54:55], 0, s[20:21]
    global_load_dwordx2 v[202:203], v[54:55], off nt
    v_lshl_add_u64 v[54:55], v[54:55], 0, s[20:21]
    global_load_dwordx2 v[204:205], v[54:55], off nt
    v_lshl_add_u64 v[54:55], v[54:55], 0, s[20:21]
    global_load_dwordx2 v[206:207], v[54:55], off nt
W5_24:
    v_lshrrev_b32 v53, 4, v1
    v_and_b32 v52, 15, v1
    v_lshlrev_b32 v52, 3, v52
    s_movk_i32 s21, 1152
    v_mad_u32_u24 v52, v53, s21, v52
    s_mul_i32 s20, s8, 36864
    s_lshl_b32 s21, s9, 7
    s_add_u32 s20, s20, s21
    v_add_u32 v52, s20, v52
    global_load_dwordx2 v[208:209], v52, s[58:59] nt
    global_load_dwordx2 v[224:225], v52, s[58:59] offset:512 nt
    v_add_u32 v52, 4608, v52
    global_load_dwordx2 v[210:211], v52, s[58:59] nt
    global_load_dwordx2 v[226:227], v52, s[58:59] offset:512 nt
    v_add_u32 v52, 4608, v52
    global_load_dwordx2 v[212:213], v52, s[58:59] nt
    global_load_dwordx2 v[228:229], v52, s[58:59] offset:512 nt
    v_add_u32 v52, 4608, v52
    global_load_dwordx2 v[214:215], v52, s[58:59] nt
    global_load_dwordx2 v[230:231], v52, s[58:59] offset:512 nt
    v_add_u32 v52, 4608, v52
    global_load_dwordx2 v[216:217], v52, s[58:59] nt
    global_load_dwordx2 v[232:233], v52, s[58:59] offset:512 nt
    v_add_u32 v52, 4608, v52
    global_load_dwordx2 v[218:219], v52, s[58:59] nt
    global_load_dwordx2 v[234:235], v52, s[58:59] offset:512 nt
    v_add_u32 v52, 4608, v52
    global_load_dwordx2 v[220:221], v52, s[58:59] nt
    global_load_dwordx2 v[236:237], v52, s[58:59] offset:512 nt
    v_add_u32 v52, 4608, v52
    global_load_dwordx2 v[222:223], v52, s[58:59] nt
    global_load_dwordx2 v[238:239], v52, s[58:59] offset:512 nt
    s_cmp_lg_u32 s9, 3
    s_cbranch_scc1 W8_25
    global_load_dwordx2 v[254:255], v52, s[58:59] offset:640 nt
    v_subrev_u32 v52, 4608, v52
    global_load_dwordx2 v[252:253], v52, s[58:59] offset:640 nt
    v_subrev_u32 v52, 4608, v52
    global_load_dwordx2 v[250:251], v52, s[58:59] offset:640 nt
    v_subrev_u32 v52, 4608, v52
    global_load_dwordx2 v[248:249], v52, s[58:59] offset:640 nt
    v_subrev_u32 v52, 4608, v52
    global_load_dwordx2 v[246:247], v52, s[58:59] offset:640 nt
    v_subrev_u32 v52, 4608, v52
    global_load_dwordx2 v[244:245], v52, s[58:59] offset:640 nt
    v_subrev_u32 v52, 4608, v52
    global_load_dwordx2 v[242:243], v52, s[58:59] offset:640 nt
    v_subrev_u32 v52, 4608, v52
    global_load_dwordx2 v[240:241], v52, s[58:59] offset:640 nt
W8_25:
    s_branch T8_B5
T8_A:
    v_and_b32 v52, 255, v0
    s_lshl_b32 s20, s4, 12
    s_add_u32 s20, s20, 49152
    v_lshl_add_u32 v53, v52, 4, s20
    v_lshlrev_b32 v52, 3, v52
    v_sub_u32 v52, 2047, v52
    v_and_b32 v54, 1, v1
    v_cmp_eq_u32 s[20:21], 0, v54
    v_and_b32 v54, 2, v1
    v_cmp_eq_u32 s[22:23], 0, v54
    v_and_b32 v54, 4, v1
    v_cmp_eq_u32 s[24:25], 0, v54
    v_and_b32 v54, 7, v1
    v_lshlrev_b32 v54, 2, v54
    s_waitcnt vmcnt(0)
    global_load_dwordx4 v[64:67], v53, s[68:69]
    s_waitcnt vmcnt(0)
RP:
    v_max3_u32 v68, v64, v65, v66
    v_max_u32 v68, v68, v67
    v_cmp_eq_u32 vcc, -1, v68
    s_cbranch_vccz RPD
    s_mov_b64 exec, vcc
    global_load_dwordx4 v[64:67], v53, s[68:69] sc1
    s_mov_b64 exec, -1
    s_waitcnt vmcnt(0)
    s_sub_u32 s10, s10, 1
    s_cbranch_scc1 EXIT
    s_branch RP
RPD:
    s_add_u32 s26, s2, s9
    s_cmp_lg_u32 s26, 0
    s_cbranch_scc1 NOEP
    v_mov_b32 v68, 94208
    v_mov_b32 v69, s99
    global_store_dword v68, v69, s[68:69] sc1
NOEP:
    v_cndmask_b32 v68, v66, v64, s[20:21]
    v_cndmask_b32 v69, v67, v65, s[20:21]
    v_cndmask_b32 v70, v64, v66, s[20:21]
    v_cndmask_b32 v71, v65, v67, s[20:21]
    s_nop 0
    v_mov_b32_dpp v72, v70 quad_perm:[1,0,3,2] row_mask:0xf bank_mask:0xf
    v_mov_b32_dpp v73, v71 quad_perm:[1,0,3,2] row_mask:0xf bank_mask:0xf
    v_pk_max_u16 v68, v68, v72
    v_pk_max_u16 v69, v69, v73
    v_cndmask_b32 v70, v69, v68, s[22:23]
    v_cndmask_b32 v71, v68, v69, s[22:23]
    s_nop 1
    v_mov_b32_dpp v72, v71 quad_perm:[2,3,0,1] row_mask:0xf bank_mask:0xf
    v_pk_max_u16 v70, v70, v72
    s_nop 1
    v_mov_b32_dpp v72, v70 row_ror:4 row_mask:0xf bank_mask:0xf
    v_pk_max_u16 v70, v70, v72
    v_and_b32 v71, 0xffff, v70
    v_lshrrev_b32 v70, 16, v70
    v_cndmask_b32 v70, v70, v71, s[24:25]
    v_add_u32 v54, 143488, v54
    ds_max_u32 v54, v70
    v_subrev_u32 v80, 0, v52
    v_lshl_or_b32 v80, v64, 16, v80
    v_subrev_u32 v81, 1, v52
    v_and_or_b32 v81, v64, s12, v81
    v_subrev_u32 v82, 2, v52
    v_lshl_or_b32 v82, v65, 16, v82
    v_subrev_u32 v83, 3, v52
    v_and_or_b32 v83, v65, s12, v83
    v_subrev_u32 v84, 4, v52
    v_lshl_or_b32 v84, v66, 16, v84
    v_subrev_u32 v85, 5, v52
    v_and_or_b32 v85, v66, s12, v85
    v_subrev_u32 v86, 6, v52
    v_lshl_or_b32 v86, v67, 16, v86
    v_subrev_u32 v87, 7, v52
    v_and_or_b32 v87, v67, s12, v87
    s_waitcnt lgkmcnt(0)
T8_B5:
    s_barrier
    s_cmp_ge_u32 s3, 4
    s_cbranch_scc1 T8_B6
    v_mov_b32 v54, 143488
    ds_read_b128 v[64:67], v54
    ds_read_b128 v[68:71], v54 offset:16
    v_mov_b32 v72, 0
    s_waitcnt lgkmcnt(0)
    v_min3_u32 v64, v64, v65, v66
    v_min3_u32 v67, v67, v68, v69
    v_min3_u32 v64, v64, v70, v71
    v_min_u32 v64, v64, v67
    v_lshlrev_b32 v64, 16, v64
    v_cmp_ge_u32 s[20:21], v80, v64
    v_cmp_ge_u32 s[22:23], v81, v64
    v_cmp_ge_u32 s[24:25], v82, v64
    v_cmp_ge_u32 s[26:27], v83, v64
    v_cmp_ge_u32 s[28:29], v84, v64
    v_cmp_ge_u32 s[30:31], v85, v64
    v_cmp_ge_u32 s[32:33], v86, v64
    v_cmp_ge_u32 s[34:35], v87, v64
    v_addc_co_u32 v72, vcc, 0, v72, s[20:21]
    s_nop 1
    v_addc_co_u32 v72, vcc, 0, v72, s[22:23]
    s_nop 1
    v_addc_co_u32 v72, vcc, 0, v72, s[24:25]
    s_nop 1
    v_addc_co_u32 v72, vcc, 0, v72, s[26:27]
    s_nop 1
    v_addc_co_u32 v72, vcc, 0, v72, s[28:29]
    s_nop 1
    v_addc_co_u32 v72, vcc, 0, v72, s[30:31]
    s_nop 1
    v_addc_co_u32 v72, vcc, 0, v72, s[32:33]
    s_nop 1
    v_addc_co_u32 v72, vcc, 0, v72, s[34:35]
    v_cmp_lt_u32 vcc, 0, v72
    s_nop 0
    s_mov_b64 exec, vcc
    ds_add_rtn_u32 v73, v54, v72 offset:32
    s_waitcnt lgkmcnt(0)
    v_lshlrev_b32 v73, 2, v73
    s_mov_b64 exec, s[20:21]
    ds_write_b32 v73, v80 offset:17408
    v_add_u32 v73, 4, v73
    s_mov_b64 exec, s[22:23]
    ds_write_b32 v73, v81 offset:17408
    v_add_u32 v73, 4, v73
    s_mov_b64 exec, s[24:25]
    ds_write_b32 v73, v82 offset:17408
    v_add_u32 v73, 4, v73
    s_mov_b64 exec, s[26:27]
    ds_write_b32 v73, v83 offset:17408
    v_add_u32 v73, 4, v73
    s_mov_b64 exec, s[28:29]
    ds_write_b32 v73, v84 offset:17408
    v_add_u32 v73, 4, v73
    s_mov_b64 exec, s[30:31]
    ds_write_b32 v73, v85 offset:17408
    v_add_u32 v73, 4, v73
    s_mov_b64 exec, s[32:33]
    ds_write_b32 v73, v86 offset:17408
    v_add_u32 v73, 4, v73
    s_mov_b64 exec, s[34:35]
    ds_write_b32 v73, v87 offset:17408
    v_add_u32 v73, 4, v73
    s_mov_b64 exec, -1
    s_waitcnt lgkmcnt(0)
T8_B6:

    s_barrier
    v_mov_b32 v54, 143520
    ds_read_b32 v55, v54
    v_lshlrev_b32 v52, 2, v1
    ds_read_b32 v64, v52 offset:17408
    v_mov_b32 v53, 0
    s_lshl_b32 s22, s3, 5
    s_add_u32 s22, s22, 143616
    s_mov_b32 s21, 0
    s_waitcnt lgkmcnt(1)
    v_readfirstlane_b32 s20, v55
    v_lshl_add_u32 v55, v55, 2, v52
    s_mov_b64 exec, 0xffff
    ds_write_b32 v55, v53 offset:17408
    s_mov_b64 exec, -1
RK_O:
    v_mov_b32 v65, 0
    v_mov_b32 v54, 0
    s_mov_b32 s23, 0
RK_I:
    ds_read_b128 v[68:71], v54 offset:17408
    ds_read_b128 v[72:75], v54 offset:17424
    ds_read_b128 v[76:79], v54 offset:17440
    ds_read_b128 v[80:83], v54 offset:17456
    v_add_u32 v54, 64, v54
    s_add_u32 s23, s23, 16
    s_waitcnt lgkmcnt(3)
    v_cmp_gt_u32 s[24:25], v68, v64
    v_cmp_gt_u32 s[26:27], v69, v64
    v_cmp_gt_u32 s[28:29], v70, v64
    v_cmp_gt_u32 s[30:31], v71, v64
    v_addc_co_u32 v65, vcc, 0, v65, s[24:25]
    s_nop 1
    v_addc_co_u32 v65, vcc, 0, v65, s[26:27]
    s_nop 1
    v_addc_co_u32 v65, vcc, 0, v65, s[28:29]
    s_nop 1
    v_addc_co_u32 v65, vcc, 0, v65, s[30:31]
    s_waitcnt lgkmcnt(2)
    v_cmp_gt_u32 s[24:25], v72, v64
    v_cmp_gt_u32 s[26:27], v73, v64
    v_cmp_gt_u32 s[28:29], v74, v64
    v_cmp_gt_u32 s[30:31], v75, v64
    v_addc_co_u32 v65, vcc, 0, v65, s[24:25]
    s_nop 1
    v_addc_co_u32 v65, vcc, 0, v65, s[26:27]
    s_nop 1
    v_addc_co_u32 v65, vcc, 0, v65, s[28:29]
    s_nop 1
    v_addc_co_u32 v65, vcc, 0, v65, s[30:31]
    s_waitcnt lgkmcnt(1)
    v_cmp_gt_u32 s[24:25], v76, v64
    v_cmp_gt_u32 s[26:27], v77, v64
    v_cmp_gt_u32 s[28:29], v78, v64
    v_cmp_gt_u32 s[30:31], v79, v64
    v_addc_co_u32 v65, vcc, 0, v65, s[24:25]
    s_nop 1
    v_addc_co_u32 v65, vcc, 0, v65, s[26:27]
    s_nop 1
    v_addc_co_u32 v65, vcc, 0, v65, s[28:29]
    s_nop 1
    v_addc_co_u32 v65, vcc, 0, v65, s[30:31]
    s_waitcnt lgkmcnt(0)
    v_cmp_gt_u32 s[24:25], v80, v64
    v_cmp_gt_u32 s[26:27], v81, v64
    v_cmp_gt_u32 s[28:29], v82, v64
    v_cmp_gt_u32 s[30:31], v83, v64
    v_addc_co_u32 v65, vcc, 0, v65, s[24:25]
    s_nop 1
    v_addc_co_u32 v65, vcc, 0, v65, s[26:27]
    s_nop 1
    v_addc_co_u32 v65, vcc, 0, v65, s[28:29]
    s_nop 1
    v_addc_co_u32 v65, vcc, 0, v65, s[30:31]
    s_cmp_lt_u32 s23, s20
    s_cbranch_scc1 RK_I
    v_add_u32 v66, s21, v1
    v_cmp_gt_u32 vcc, s20, v66
    v_cmp_gt_u32 s[24:25], 8, v65
    s_nop 0
    s_and_b64 exec, vcc, s[24:25]
    v_lshl_add_u32 v65, v65, 2, s22
    ds_write_b32 v65, v64
    s_mov_b64 exec, -1
    s_add_u32 s21, s21, 64
    s_cmp_ge_u32 s21, s20
    s_cbranch_scc1 RK_D
    v_add_u32 v52, 256, v52
    ds_read_b32 v64, v52 offset:17408
    s_branch RK_O
RK_D:
    v_and_b32 v54, 7, v1
    v_lshl_add_u32 v54, v54, 2, s22
    ds_read_b32 v64, v54
    s_mul_i32 s23, s11, 1152
    s_waitcnt lgkmcnt(0)
    v_and_b32 v65, 0x7ff, v64
    v_sub_u32 v65, 2047, v65
    v_lshrrev_b32 v66, 3, v65
    v_mov_b32 v67, 0
    v_readlane_b32 s20, v66, 0
    s_nop 1
    v_cmp_eq_u32 vcc, s20, v66
    s_nop 0
    s_and_b32 s26, vcc_lo, 0xfefefefe
    s_mov_b32 s27, s26
    v_addc_co_u32 v67, vcc, 0, v67, s[26:27]
    v_readlane_b32 s20, v66, 1
    s_nop 1
    v_cmp_eq_u32 vcc, s20, v66
    s_nop 0
    s_and_b32 s26, vcc_lo, 0xfcfcfcfc
    s_mov_b32 s27, s26
    v_addc_co_u32 v67, vcc, 0, v67, s[26:27]
    v_readlane_b32 s20, v66, 2
    s_nop 1
    v_cmp_eq_u32 vcc, s20, v66
    s_nop 0
    s_and_b32 s26, vcc_lo, 0xf8f8f8f8
    s_mov_b32 s27, s26
    v_addc_co_u32 v67, vcc, 0, v67, s[26:27]
    v_readlane_b32 s20, v66, 3
    s_nop 1
    v_cmp_eq_u32 vcc, s20, v66
    s_nop 0
    s_and_b32 s26, vcc_lo, 0xf0f0f0f0
    s_mov_b32 s27, s26
    v_addc_co_u32 v67, vcc, 0, v67, s[26:27]
    v_readlane_b32 s20, v66, 4
    s_nop 1
    v_cmp_eq_u32 vcc, s20, v66
    s_nop 0
    s_and_b32 s26, vcc_lo, 0xe0e0e0e0
    s_mov_b32 s27, s26
    v_addc_co_u32 v67, vcc, 0, v67, s[26:27]
    v_readlane_b32 s20, v66, 5
    s_nop 1
    v_cmp_eq_u32 vcc, s20, v66
    s_nop 0
    s_and_b32 s26, vcc_lo, 0xc0c0c0c0
    s_mov_b32 s27, s26
    v_addc_co_u32 v67, vcc, 0, v67, s[26:27]
    v_readlane_b32 s20, v66, 6
    s_nop 1
    v_cmp_eq_u32 vcc, s20, v66
    s_nop 0
    s_and_b32 s26, vcc_lo, 0x80808080
    s_mov_b32 s27, s26
    v_addc_co_u32 v67, vcc, 0, v67, s[26:27]
    v_cmp_le_u32 vcc, 3, v67
    v_mad_u32_u24 v66, v66, 3, v67
    v_and_b32 v67, 7, v1
    s_movk_i32 s20, 1152
    v_mul_u32_u24 v66, s20, v66
    v_mul_u32_u24 v67, s20, v67
    v_add_u32 v66, 4194304, v66
    v_add_u32 v67, 32768, v67
    v_cndmask_b32 v66, v66, v67, vcc
    s_cmp_eq_u32 s13, 0
    s_cbranch_scc1 NOAF
    s_movk_i32 s20, 1152
    v_lshrrev_b32 v52, 4, v1
    v_lshlrev_b32 v52, 4, v52
    s_lshl_b32 s21, s9, 6
    v_add3_u32 v52, v66, s21, v52
    s_movk_i32 s21, 1024
    s_cmp_ge_u32 s9, 2
    s_cselect_b32 s21, 768, s21
    v_add_u32 v53, s21, v52
    global_load_dwordx4 v[68:71], v52, s[68:69]
    global_load_dwordx4 v[72:75], v52, s[68:69] offset:256
    global_load_dwordx4 v[76:79], v52, s[68:69] offset:512
    global_load_dwordx4 v[80:83], v52, s[68:69] offset:768
    global_load_dwordx4 v[84:87], v53, s[68:69]
NOAF:
    v_cmp_eq_u32 vcc, s11, v65
    s_cbranch_vccnz OWN_SEL
    v_add_u32 v54, s23, v7
    v_add_u32 v55, s23, v13
    global_store_dwordx4 v54, v[8:11], s[64:65] nt
    global_store_short v55, v12, s[64:65] nt
    s_branch OWN_D
OWN_SEL:
    s_ff1_i32_b64 s20, vcc
    s_mul_i32 s20, s20, 1152
    s_add_u32 s20, s20, 22528
    v_add_u32 v54, s20, v7
    v_add_u32 v55, s20, v13
    s_cmp_lt_u32 s14, 3
    s_cbranch_scc1 OWN_B
    v_add_u32 v56, 10240, v54
    v_add_u32 v57, 10240, v55
    global_store_dwordx4 v56, v[90:93], s[68:69] sc1
    global_store_short v57, v94, s[68:69] sc1
OWN_B:
    global_store_dwordx4 v54, v[2:5], s[68:69] sc1
    global_store_short v55, v6, s[68:69] sc1
OWN_D:
    s_cmp_eq_u32 s13, 0
    s_cbranch_scc1 S4PRE
    s_waitcnt vmcnt(7)
    s_mov_b32 s26, 0x05040100
    s_mov_b32 s27, 0x07060302
    v_perm_b32 v112, v130, v128, s26
    v_perm_b32 v116, v130, v128, s27
    v_perm_b32 v120, v131, v129, s26
    v_perm_b32 v124, v131, v129, s27
    v_perm_b32 v113, v134, v132, s26
    v_perm_b32 v117, v134, v132, s27
    v_perm_b32 v121, v135, v133, s26
    v_perm_b32 v125, v135, v133, s27
    v_perm_b32 v114, v138, v136, s26
    v_perm_b32 v118, v138, v136, s27
    v_perm_b32 v122, v139, v137, s26
    v_perm_b32 v126, v139, v137, s27
    v_perm_b32 v115, v142, v140, s26
    v_perm_b32 v119, v142, v140, s27
    v_perm_b32 v123, v143, v141, s26
    v_perm_b32 v127, v143, v141, s27
    v_perm_b32 v128, v146, v144, s26
    v_perm_b32 v132, v146, v144, s27
    v_perm_b32 v136, v147, v145, s26
    v_perm_b32 v140, v147, v145, s27
    v_perm_b32 v129, v150, v148, s26
    v_perm_b32 v133, v150, v148, s27
    v_perm_b32 v137, v151, v149, s26
    v_perm_b32 v141, v151, v149, s27
    v_perm_b32 v130, v154, v152, s26
    v_perm_b32 v134, v154, v152, s27
    v_perm_b32 v138, v155, v153, s26
    v_perm_b32 v142, v155, v153, s27
    v_perm_b32 v131, v158, v156, s26
    v_perm_b32 v135, v158, v156, s27
    v_perm_b32 v139, v159, v157, s26
    v_perm_b32 v143, v159, v157, s27
    v_perm_b32 v144, v162, v160, s26
    v_perm_b32 v148, v162, v160, s27
    v_perm_b32 v152, v163, v161, s26
    v_perm_b32 v156, v163, v161, s27
    v_perm_b32 v145, v166, v164, s26
    v_perm_b32 v149, v166, v164, s27
    v_perm_b32 v153, v167, v165, s26
    v_perm_b32 v157, v167, v165, s27
    v_perm_b32 v146, v170, v168, s26
    v_perm_b32 v150, v170, v168, s27
    v_perm_b32 v154, v171, v169, s26
    v_perm_b32 v158, v171, v169, s27
    v_perm_b32 v147, v174, v172, s26
    v_perm_b32 v151, v174, v172, s27
    v_perm_b32 v155, v175, v173, s26
    v_perm_b32 v159, v175, v173, s27
    v_perm_b32 v160, v178, v176, s26
    v_perm_b32 v164, v178, v176, s27
    v_perm_b32 v168, v179, v177, s26
    v_perm_b32 v172, v179, v177, s27
    v_perm_b32 v161, v182, v180, s26
    v_perm_b32 v165, v182, v180, s27
    v_perm_b32 v169, v183, v181, s26
    v_perm_b32 v173, v183, v181, s27
    v_perm_b32 v162, v186, v184, s26
    v_perm_b32 v166, v186, v184, s27
    v_perm_b32 v170, v187, v185, s26
    v_perm_b32 v174, v187, v185, s27
    v_perm_b32 v163, v190, v188, s26
    v_perm_b32 v167, v190, v188, s27
    v_perm_b32 v171, v191, v189, s26
    v_perm_b32 v175, v191, v189, s27
    v_perm_b32 v176, v194, v192, s26
    v_perm_b32 v180, v194, v192, s27
    v_perm_b32 v184, v195, v193, s26
    v_perm_b32 v188, v195, v193, s27
    v_perm_b32 v177, v198, v196, s26
    v_perm_b32 v181, v198, v196, s27
    v_perm_b32 v185, v199, v197, s26
    v_perm_b32 v189, v199, v197, s27
    v_perm_b32 v178, v202, v200, s26
    v_perm_b32 v182, v202, v200, s27
    v_perm_b32 v186, v203, v201, s26
    v_perm_b32 v190, v203, v201, s27
    v_perm_b32 v179, v206, v204, s26
    v_perm_b32 v183, v206, v204, s27
    v_perm_b32 v187, v207, v205, s26
    v_perm_b32 v191, v207, v205, s27
    v_perm_b32 v192, v210, v208, s26
    v_perm_b32 v196, v210, v208, s27
    v_perm_b32 v200, v211, v209, s26
    v_perm_b32 v204, v211, v209, s27
    v_perm_b32 v193, v214, v212, s26
    v_perm_b32 v197, v214, v212, s27
    v_perm_b32 v201, v215, v213, s26
    v_perm_b32 v205, v215, v213, s27
    v_perm_b32 v194, v218, v216, s26
    v_perm_b32 v198, v218, v216, s27
    v_perm_b32 v202, v219, v217, s26
    v_perm_b32 v206, v219, v217, s27
    v_perm_b32 v195, v222, v220, s26
    v_perm_b32 v199, v222, v220, s27
    v_perm_b32 v203, v223, v221, s26
    v_perm_b32 v207, v223, v221, s27
    v_perm_b32 v208, v226, v224, s26
    v_perm_b32 v212, v226, v224, s27
    v_perm_b32 v216, v227, v225, s26
    v_perm_b32 v220, v227, v225, s27
    v_perm_b32 v209, v230, v228, s26
    v_perm_b32 v213, v230, v228, s27
    v_perm_b32 v217, v231, v229, s26
    v_perm_b32 v221, v231, v229, s27
    v_perm_b32 v210, v234, v232, s26
    v_perm_b32 v214, v234, v232, s27
    v_perm_b32 v218, v235, v233, s26
    v_perm_b32 v222, v235, v233, s27
    v_perm_b32 v211, v238, v236, s26
    v_perm_b32 v215, v238, v236, s27
    v_perm_b32 v219, v239, v237, s26
    v_perm_b32 v223, v239, v237, s27
    v_perm_b32 v224, v242, v240, s26
    v_perm_b32 v228, v242, v240, s27
    v_perm_b32 v232, v243, v241, s26
    v_perm_b32 v236, v243, v241, s27
    v_perm_b32 v225, v246, v244, s26
    v_perm_b32 v229, v246, v244, s27
    v_perm_b32 v233, v247, v245, s26
    v_perm_b32 v237, v247, v245, s27
    v_perm_b32 v226, v250, v248, s26
    v_perm_b32 v230, v250, v248, s27
    v_perm_b32 v234, v251, v249, s26
    v_perm_b32 v238, v251, v249, s27
    v_perm_b32 v227, v254, v252, s26
    v_perm_b32 v231, v254, v252, s27
    v_perm_b32 v235, v255, v253, s26
    v_perm_b32 v239, v255, v253, s27
    s_waitcnt vmcnt(2)
AFP:
    v_max3_u32 v88, v68, v69, v70
    v_max3_u32 v88, v88, v71, v72
    v_max3_u32 v88, v88, v73, v74
    v_max3_u32 v88, v88, v75, v76
    v_max3_u32 v88, v88, v77, v78
    v_max3_u32 v88, v88, v79, v80
    v_max3_u32 v88, v88, v81, v82
    v_max3_u32 v88, v88, v83, v84
    v_max3_u32 v88, v88, v85, v86
    v_max_u32 v88, v88, v87
    v_cmp_eq_u32 vcc, -1, v88
    s_cbranch_vccz AFPD
    s_mov_b64 exec, vcc
    global_load_dwordx4 v[68:71], v52, s[68:69] sc1
    global_load_dwordx4 v[72:75], v52, s[68:69] offset:256 sc1
    global_load_dwordx4 v[76:79], v52, s[68:69] offset:512 sc1
    global_load_dwordx4 v[80:83], v52, s[68:69] offset:768 sc1
    global_load_dwordx4 v[84:87], v53, s[68:69] sc1
    s_mov_b64 exec, -1
    s_waitcnt vmcnt(0)
    s_sub_u32 s10, s10, 1
    s_cbranch_scc1 EXIT
    s_branch AFP
AFPD:
    v_mfma_f32_16x16x32_bf16 v[92:95], v[112:115], v[68:71], 0
    v_mfma_f32_16x16x32_bf16 v[96:99], v[116:119], v[68:71], 0
    v_mfma_f32_16x16x32_bf16 v[100:103], v[120:123], v[68:71], 0
    v_mfma_f32_16x16x32_bf16 v[104:107], v[124:127], v[68:71], 0
    v_mfma_f32_16x16x32_bf16 v[92:95], v[128:131], v[72:75], v[92:95]
    v_mfma_f32_16x16x32_bf16 v[96:99], v[132:135], v[72:75], v[96:99]
    v_mfma_f32_16x16x32_bf16 v[100:103], v[136:139], v[72:75], v[100:103]
    v_mfma_f32_16x16x32_bf16 v[104:107], v[140:143], v[72:75], v[104:107]
    v_mfma_f32_16x16x32_bf16 v[92:95], v[144:147], v[76:79], v[92:95]
    v_mfma_f32_16x16x32_bf16 v[96:99], v[148:151], v[76:79], v[96:99]
    v_mfma_f32_16x16x32_bf16 v[100:103], v[152:155], v[76:79], v[100:103]
    v_mfma_f32_16x16x32_bf16 v[104:107], v[156:159], v[76:79], v[104:107]
    v_mfma_f32_16x16x32_bf16 v[92:95], v[160:163], v[80:83], v[92:95]
    v_mfma_f32_16x16x32_bf16 v[96:99], v[164:167], v[80:83], v[96:99]
    v_mfma_f32_16x16x32_bf16 v[100:103], v[168:171], v[80:83], v[100:103]
    v_mfma_f32_16x16x32_bf16 v[104:107], v[172:175], v[80:83], v[104:107]
    s_cmp_ge_u32 s9, 2
    s_cbranch_scc1 MF4
    v_mfma_f32_16x16x32_bf16 v[92:95], v[176:179], v[84:87], v[92:95]
    v_mfma_f32_16x16x32_bf16 v[96:99], v[180:183], v[84:87], v[96:99]
    v_mfma_f32_16x16x32_bf16 v[100:103], v[184:187], v[84:87], v[100:103]
    v_mfma_f32_16x16x32_bf16 v[104:107], v[188:191], v[84:87], v[104:107]
MF4:
    s_mul_i32 s20, s9, 4608
    v_lshl_add_u32 v52, v1, 4, s20
    v_lshrrev_b32 v53, 4, v1
    s_movk_i32 s20, 1152
    v_mul_u32_u24 v54, s20, v53
    v_and_b32 v55, 7, v1
    v_lshl_add_u32 v54, v55, 4, v54
    v_and_b32 v55, 8, v1
    v_lshl_add_u32 v54, v55, 5, v54
    v_cmp_eq_u32 s[24:25], 0, v55
    s_nop 4
    ds_write_b128 v52, v[92:95] offset:27648
    ds_write_b128 v52, v[96:99] offset:28800
    ds_write_b128 v52, v[100:103] offset:29952
    ds_write_b128 v52, v[104:107] offset:31104
    s_waitcnt lgkmcnt(0)
    s_barrier
    ds_read_b128 v[64:67], v54 offset:27648
    ds_read_b128 v[68:71], v54 offset:28160
    ds_read_b128 v[72:75], v54 offset:32256
    ds_read_b128 v[76:79], v54 offset:32768
    ds_read_b128 v[80:83], v54 offset:36864
    ds_read_b128 v[84:87], v54 offset:37376
    ds_read_b128 v[88:91], v54 offset:41472
    ds_read_b128 v[92:95], v54 offset:41984
    v_and_b32 v53, 1, v53
    s_mov_b32 s20, 1327104
    v_mul_u32_u24 v53, s20, v53
    v_lshrrev_b32 v55, 3, v55
    s_movk_i32 s20, 18432
    v_mad_u32_u24 v53, v55, s20, v53
    v_and_b32 v55, 7, v1
    v_lshl_add_u32 v53, v55, 4, v53
    s_lshl_b32 s20, s8, 7
    s_add_u32 s20, s20, 7340032
    v_add_u32 v53, s20, v53
    s_mul_i32 s21, s9, 147456
    s_waitcnt lgkmcnt(4)
    v_pk_add_f32 v[64:65], v[64:65], v[72:73]
    v_pk_add_f32 v[66:67], v[66:67], v[74:75]
    v_pk_add_f32 v[68:69], v[68:69], v[76:77]
    v_pk_add_f32 v[70:71], v[70:71], v[78:79]
    s_waitcnt lgkmcnt(0)
    v_pk_add_f32 v[80:81], v[80:81], v[88:89]
    v_pk_add_f32 v[82:83], v[82:83], v[90:91]
    v_pk_add_f32 v[84:85], v[84:85], v[92:93]
    v_pk_add_f32 v[86:87], v[86:87], v[94:95]
    v_pk_add_f32 v[64:65], v[64:65], v[80:81]
    v_pk_add_f32 v[66:67], v[66:67], v[82:83]
    v_pk_add_f32 v[68:69], v[68:69], v[84:85]
    v_pk_add_f32 v[70:71], v[70:71], v[86:87]
    v_cvt_pk_bf16_f32 v72, v64, v65
    v_cvt_pk_bf16_f32 v73, v66, v67
    v_cvt_pk_bf16_f32 v74, v68, v69
    v_cvt_pk_bf16_f32 v75, v70, v71
    v_lshlrev_b32 v64, 16, v72
    v_and_b32 v65, s12, v72
    v_lshlrev_b32 v66, 16, v73
    v_and_b32 v67, s12, v73
    v_lshlrev_b32 v68, 16, v74
    v_and_b32 v69, s12, v74
    v_lshlrev_b32 v70, 16, v75
    v_and_b32 v71, s12, v75
    v_mul_f32 v72, 0xbfb8aa3b, v64
    v_exp_f32 v72, v72
    v_mul_f32 v73, 0xbfb8aa3b, v65
    v_exp_f32 v73, v73
    v_mul_f32 v74, 0xbfb8aa3b, v66
    v_exp_f32 v74, v74
    v_mul_f32 v75, 0xbfb8aa3b, v67
    v_exp_f32 v75, v75
    v_add_f32 v72, 1.0, v72
    v_rcp_f32 v72, v72
    v_add_f32 v73, 1.0, v73
    v_rcp_f32 v73, v73
    v_add_f32 v74, 1.0, v74
    v_rcp_f32 v74, v74
    v_add_f32 v75, 1.0, v75
    v_rcp_f32 v75, v75
    v_pk_mul_f32 v[64:65], v[64:65], v[72:73]
    v_pk_mul_f32 v[66:67], v[66:67], v[74:75]
    v_cvt_pk_bf16_f32 v72, v64, v65
    v_cvt_pk_bf16_f32 v73, v66, v67
    v_lshlrev_b32 v64, 16, v72
    v_and_b32 v65, s12, v72
    v_lshlrev_b32 v66, 16, v73
    v_and_b32 v67, s12, v73
    v_pk_mul_f32 v[64:65], v[64:65], v[68:69]
    v_pk_mul_f32 v[66:67], v[66:67], v[70:71]
    v_cvt_pk_bf16_f32 v72, v64, v65
    v_cvt_pk_bf16_f32 v73, v66, v67
    s_nop 0
    v_mov_b32_dpp v74, v72 row_ror:8 row_mask:0xf bank_mask:0xf
    v_mov_b32_dpp v75, v73 row_ror:8 row_mask:0xf bank_mask:0xf
    v_cndmask_b32 v76, v74, v72, s[24:25]
    v_cndmask_b32 v77, v75, v73, s[24:25]
    v_cndmask_b32 v78, v72, v74, s[24:25]
    v_cndmask_b32 v79, v73, v75, s[24:25]
    s_nop 1
    v_mfma_f32_16x16x32_bf16 v[80:83], v[76:79], v[192:195], 0
    v_mfma_f32_16x16x32_bf16 v[84:87], v[76:79], v[196:199], 0
    v_mfma_f32_16x16x32_bf16 v[88:91], v[76:79], v[200:203], 0
    v_mfma_f32_16x16x32_bf16 v[92:95], v[76:79], v[204:207], 0
    v_mfma_f32_16x16x32_bf16 v[96:99], v[76:79], v[208:211], 0
    v_mfma_f32_16x16x32_bf16 v[100:103], v[76:79], v[212:215], 0
    v_mfma_f32_16x16x32_bf16 v[104:107], v[76:79], v[216:219], 0
    v_mfma_f32_16x16x32_bf16 v[108:111], v[76:79], v[220:223], 0
    s_mov_b32 exec_hi, 0
    v_add_u32 v52, s21, v53
    global_store_dwordx4 v52, v[80:83], s[68:69] sc1
    v_add_u32 v52, 36864, v52
    global_store_dwordx4 v52, v[84:87], s[68:69] sc1
    v_add_u32 v52, 36864, v52
    global_store_dwordx4 v52, v[88:91], s[68:69] sc1
    v_add_u32 v52, 36864, v52
    global_store_dwordx4 v52, v[92:95], s[68:69] sc1
    s_add_u32 s21, s21, 589824
    v_add_u32 v52, s21, v53
    global_store_dwordx4 v52, v[96:99], s[68:69] sc1
    v_add_u32 v52, 36864, v52
    global_store_dwordx4 v52, v[100:103], s[68:69] sc1
    v_add_u32 v52, 36864, v52
    global_store_dwordx4 v52, v[104:107], s[68:69] sc1
    v_add_u32 v52, 36864, v52
    global_store_dwordx4 v52, v[108:111], s[68:69] sc1
    s_mov_b32 exec_hi, -1
    s_cmp_lg_u32 s9, 3
    s_cbranch_scc1 NOB8
    v_mfma_f32_16x16x32_bf16 v[80:83], v[76:79], v[224:227], 0
    v_mfma_f32_16x16x32_bf16 v[84:87], v[76:79], v[228:231], 0
    v_mfma_f32_16x16x32_bf16 v[88:91], v[76:79], v[232:235], 0
    v_mfma_f32_16x16x32_bf16 v[92:95], v[76:79], v[236:239], 0
    s_mov_b32 s21, 1179648
    s_mov_b32 exec_hi, 0
    v_add_u32 v52, s21, v53
    s_nop 1
    global_store_dwordx4 v52, v[80:83], s[68:69] sc1
    v_add_u32 v52, 36864, v52
    global_store_dwordx4 v52, v[84:87], s[68:69] sc1
    v_add_u32 v52, 36864, v52
    global_store_dwordx4 v52, v[88:91], s[68:69] sc1
    v_add_u32 v52, 36864, v52
    global_store_dwordx4 v52, v[92:95], s[68:69] sc1
NOB8:
    s_mov_b32 exec_hi, -1
    s_branch S4
S4PRE:
    s_cmp_ge_u32 s5, 18
    s_cbranch_scc1 FIN
    s_barrier
    s_cmp_lg_u32 s3, 0
    s_cbranch_scc1 S4
    s_cmp_ge_u32 s8, 72
    s_cselect_b32 s20, 1, 0
    s_mul_i32 s21, s20, 72
    s_sub_u32 s21, s8, s21
    s_lshr_b32 s23, s21, 3
    s_lshl_b32 s23, s23, 6
    s_and_b32 s24, s21, 1
    s_lshl_b32 s24, s24, 5
    s_add_u32 s23, s23, s24
    s_bfe_u32 s24, s21, 0x20001
    s_add_u32 s23, s23, s24
    s_lshl_b32 s23, s23, 1
    v_and_b32 v52, 7, v1
    v_lshl_add_u32 v52, v52, 3, s23
    v_lshrrev_b32 v53, 4, v1
    v_lshl_add_u32 v53, s20, 2, v53
    v_lshl_add_u32 v54, v53, 2, s22
    ds_read_b32 v40, v54
    v_lshlrev_b32 v44, 2, v53
    ds_bpermute_b32 v44, v44, v66
    s_movk_i32 s20, 1152
    v_mad_u32_u24 v41, v53, s20, v52
    v_add_u32 v41, 22528, v41
    v_add_u32 v42, 13952, v52
    s_movk_i32 s20, 1152
    s_waitcnt lgkmcnt(0)
    v_and_b32 v43, 0x7ff, v40
    v_sub_u32 v43, 2047, v43
    v_mad_u32_u24 v43, v43, s20, v52
    v_add_u32 v44, v44, v52
    v_ashrrev_i32 v45, 31, v40
    v_not_b32 v45, v45
    v_or_b32 v45, 0x80000000, v45
    v_xor_b32 v45, v45, v40
    v_and_b32 v45, s12, v45
    v_mul_f32 v45, 0xbfb8aa3b, v45
    v_exp_f32 v45, v45
    s_nop 0
    v_add_f32 v45, 1.0, v45
    v_rcp_f32 v45, v45
    s_nop 0
    v_cvt_pk_bf16_f32 v45, v45, v45
    v_and_b32 v45, s12, v45
XP:
    global_load_ushort v46, v41, s[68:69] sc1
    global_load_ushort v47, v44, s[68:69] sc1
    global_load_ushort v48, v42, s[68:69] sc1
    s_waitcnt vmcnt(0)
    v_max_u32 v49, v46, v47
    v_cmp_eq_u32 vcc, 0xffff, v49
    s_cbranch_vccz XPD
    s_sub_u32 s10, s10, 1
    s_cbranch_scc1 EXIT
    s_branch XP
XPD:
    v_lshlrev_b32 v46, 16, v46
    v_lshlrev_b32 v47, 16, v47
    v_lshlrev_b32 v48, 16, v48
S4:
    s_mul_i32 s20, s8, 18432
    s_add_u32 s20, s20, 7340032
    v_lshl_add_u32 v52, v0, 4, s20
    v_add_u32 v53, 8192, v52
    v_add_u32 v54, 16384, v52
    v_mov_b32 v72, 0
    v_mov_b32 v73, 0
    v_mov_b32 v74, 0
    v_mov_b32 v75, 0
    v_lshrrev_b32 v55, 4, v1
    v_and_b32 v56, 7, v1
    v_lshl_add_u32 v55, v55, 3, v56
    v_lshlrev_b32 v55, 2, v55
    s_lshl_b32 s20, s3, 7
    v_add_u32 v56, s20, v55
    s_cmp_lg_u32 s3, 1
    s_cbranch_scc1 TRD
    s_mul_i32 s20, s8, 18432
    s_add_u32 s20, s20, 7348224
    v_mov_b32 v57, s20
TRP:
    global_load_dword v58, v57, s[68:69] sc1
    s_waitcnt vmcnt(0)
    v_cmp_eq_u32 vcc, -1, v58
    s_cbranch_vccz TRD
    s_sub_u32 s10, s10, 1
    s_cbranch_scc1 EXIT
    s_branch TRP
TRD:
    s_barrier
PP:
    global_load_dwordx4 v[64:67], v52, s[68:69] sc1
    global_load_dwordx4 v[68:71], v53, s[68:69] sc1
    s_cmp_ge_u32 s3, 2
    s_cbranch_scc1 PP2
    global_load_dwordx4 v[72:75], v54, s[68:69] sc1
PP2:
    s_waitcnt vmcnt(0)
    v_max3_u32 v76, v64, v65, v66
    v_max3_u32 v76, v76, v67, v68
    v_max3_u32 v76, v76, v69, v70
    v_max3_u32 v76, v76, v71, v72
    v_max3_u32 v76, v76, v73, v74
    v_max_u32 v76, v76, v75
    v_cmp_eq_u32 vcc, -1, v76
    s_cbranch_vccz PPD
    s_sub_u32 s10, s10, 1
    s_cbranch_scc1 EXIT
    s_branch PP
PPD:
    v_pk_add_f32 v[64:65], v[64:65], v[68:69]
    v_pk_add_f32 v[66:67], v[66:67], v[70:71]
    v_pk_add_f32 v[64:65], v[64:65], v[72:73]
    v_pk_add_f32 v[66:67], v[66:67], v[74:75]
    s_nop 1
    v_permlane32_swap_b32 v64, v66
    v_permlane32_swap_b32 v65, v67
    v_pk_add_f32 v[64:65], v[64:65], v[66:67]
    s_nop 1
    v_permlane16_swap_b32 v64, v65
    v_add_f32 v64, v64, v65
    s_nop 1
    v_add_f32_dpp v64, v64, v64 row_ror:8 row_mask:0xf bank_mask:0xf
    s_mov_b32 exec_lo, 0x00ff00ff
    s_mov_b32 exec_hi, 0x00ff00ff
    ds_write_b32 v56, v64 offset:26624
    s_waitcnt lgkmcnt(0)
    s_barrier
    s_cmp_lg_u32 s3, 0
    s_cbranch_scc1 FIN
    ds_read_b32 v64, v55 offset:26624
    ds_read_b32 v65, v55 offset:26752
    ds_read_b32 v66, v55 offset:26880
    ds_read_b32 v67, v55 offset:27008
    ds_read_b32 v68, v55 offset:27136
    ds_read_b32 v69, v55 offset:27264
    ds_read_b32 v70, v55 offset:27392
    ds_read_b32 v71, v55 offset:27520
    s_waitcnt lgkmcnt(0)
    v_pk_add_f32 v[64:65], v[64:65], v[68:69]
    v_pk_add_f32 v[66:67], v[66:67], v[70:71]
    v_pk_add_f32 v[64:65], v[64:65], v[66:67]
    v_add_f32 v64, v64, v65
    v_cvt_pk_bf16_f32 v64, v64, v64
    v_and_b32 v64, s12, v64
    v_mul_f32 v64, v64, v45
    v_cvt_pk_bf16_f32 v64, v64, v64
    v_and_b32 v64, s12, v64
    v_add_f32 v64, v64, v47
    v_cvt_pk_bf16_f32 v64, v64, v64
    v_and_b32 v64, s12, v64
    v_mul_f32 v64, v64, v48
    v_cvt_pk_bf16_f32 v64, v64, v64
    v_and_b32 v64, s12, v64
    v_add_f32 v64, v64, v46
    v_cvt_pk_bf16_f32 v64, v64, v64
    global_store_short v43, v64, s[64:65] sc1
FIN:
EXIT:
    s_endpgm
CODE_END:
.section .rodata,"a"
.p2align 6
.amdhsa_kernel adaLN_cond__ssm_conv_s4d__moe_arch_mod__prompt_kernel
  .amdhsa_next_free_vgpr 256
  .amdhsa_next_free_sgpr 102
  .amdhsa_accum_offset 256
  .amdhsa_group_segment_fixed_size 0
  .amdhsa_kernarg_size 136
  .amdhsa_user_sgpr_count 2
  .amdhsa_user_sgpr_kernarg_segment_ptr 1
  .amdhsa_system_sgpr_workgroup_id_x 1
.end_amdhsa_kernel
```
